```python
import torch

def _softmax(x, axis=-1):
    return torch.softmax(x, dim=axis)

def _gelu(x):
    return torch.nn.functional.gelu(x, approximate='tanh')

def _silu(x):
    return torch.nn.functional.silu(x)

def _sigmoid(x):
    return torch.sigmoid(x)

def _layernorm(x, axis=-1, eps=1e-05):
    m = x.mean(dim=axis, keepdim=True)
    v = x.var(dim=axis, keepdim=True, unbiased=False)
    return (x - m) / torch.sqrt(v + eps)

def _scatter_add(tgt, idx, src, axis=0):
    return tgt.clone().index_add_(axis, idx, src)

def _segment_sum(src, seg, n):
    out = torch.zeros((n,) + src.shape[1:], dtype=src.dtype)
    return out.index_add_(0, seg, src)

def _pad(x, pw):
    flat = tuple((v for pair in reversed(pw) for v in pair))
    return torch.nn.functional.pad(x, flat)
kernel_name = 'adaLN_cond__mha_block_cached__swiglu_ffn__prompt'

def setup_inputs():

    _w = lambda a: (lambda t: t.to(torch.bfloat16) if t.is_floating_point() else t)(torch.as_tensor(a))

    def _A_setup():
        B, Sq, D = (1, 2048, 1024)
        H, Sk, Dh = (32, 2048, 128)
        return {'x': _w((lambda *s: torch.randn(*s, dtype=torch.bfloat16) * 0.05)(B, Sq, D)), 'k_cache': _w((lambda *s: torch.randn(*s, dtype=torch.bfloat16) * 3.2)(B, H, Sk, Dh)), 'v_cache': _w((lambda *s: torch.randn(*s, dtype=torch.bfloat16) * 0.4)(B, H, Sk, Dh)), 'wq': _w((lambda *s: torch.randn(*s, dtype=torch.bfloat16) * 3.2)(D, H * Dh) * D ** (-0.5)), 'wo': _w((lambda *s: torch.randn(*s, dtype=torch.bfloat16) * 0.4)(H * Dh, D) * (H * Dh) ** (-0.5))}
    _A_in = _A_setup()

    def _B_setup():
        B, S, D, F = (1, 2048, 1024, 3584)
        return {'x': _w((lambda *s: torch.randn(*s, dtype=torch.bfloat16) * 0.05)(B, S, D)), 'w_gate': _w((lambda *s: torch.randn(*s, dtype=torch.bfloat16) * 0.05)(D, F)), 'w_up': _w((lambda *s: torch.randn(*s, dtype=torch.bfloat16) * 0.05)(D, F)), 'w_down': _w((lambda *s: torch.randn(*s, dtype=torch.bfloat16) * 0.05)(F, D))}
    _B_in = _B_setup()
    return {'A_x': _A_in['x'], 'A_k_cache': _A_in['k_cache'], 'A_v_cache': _A_in['v_cache'], 'A_wq': _A_in['wq'], 'A_wo': _A_in['wo'], 'B_x': _B_in['x'], 'B_w_gate': _B_in['w_gate'], 'B_w_up': _B_in['w_up'], 'B_w_down': _B_in['w_down'], 'c': _w((lambda *s: torch.randn(*s, dtype=torch.bfloat16) * 0.1)(1, 1024) * 8.0), 'w_mod': _w((lambda *s: torch.randn(*s, dtype=torch.bfloat16) * 0.1)(1024, 6 * 1024) * 1024 ** (-0.5) * 8.0)}

def reference(A_x, A_k_cache, A_v_cache, A_wq, A_wo, B_x, B_w_gate, B_w_up, B_w_down, c, w_mod):

    def _A_ref(x, k_cache, v_cache, wq, wo):
        B, Sq, D = x.shape
        H, Dh = (32, 128)
        q = (lambda x, *d: x.permute(*d))((x @ wq).reshape(B, Sq, H, Dh), 0, 2, 1, 3)
        scores = torch.einsum('bhqd,bhkd->bhqk', q, k_cache) * Dh ** (-0.5)
        p = _softmax(scores, axis=-1)
        o = torch.einsum('bhqk,bhkd->bhqd', p, v_cache)
        return (lambda x, *d: x.permute(*d))(o, 0, 2, 1, 3).reshape(B, Sq, H * Dh) @ wo

    def _B_ref(x, w_gate, w_up, w_down):
        g = _silu(x @ w_gate)
        u = x @ w_up
        return g * u @ w_down
    x = A_x
    mod = (_silu(c) @ w_mod).reshape(c.shape[0], 6, 1, -1)
    sa, ca, ga, sb, cb, gb = (mod[:, 0].clone(), mod[:, 1].clone(), mod[:, 2].clone(), mod[:, 3].clone(), mod[:, 4].clone(), mod[:, 5].clone())
    h = _layernorm(x, axis=-1) * (1 + ca) + sa
    x = x + ga * _A_ref(h, A_k_cache, A_v_cache, A_wq, A_wo)
    h = _layernorm(x, axis=-1) * (1 + cb) + sb
    x = x + gb * _B_ref(h, B_w_gate, B_w_up, B_w_down)
    return x
```

```asm
; @launch kernel=prep_kernel grid=(256,1,1) block=(256,1,1) lds=83968
; @launch kernel=attn_kernel grid=(256,1,1) block=(256,1,1) lds=131072
.amdgcn_target "amdgcn-amd-amdhsa--gfx950"
.text
.globl prep_kernel
.p2align 8
.type prep_kernel,@function
prep_kernel:
s_cmp_ge_u32 s2, 256
s_cbranch_scc1 L_prep_kernel_end
s_getpc_b64 s[4:5]
L_prep_kernel_pc:
v_lshrrev_b32 v2, 6, v0
v_and_b32 v3, 63, v0
v_lshlrev_b32 v3, 4, v3
s_lshr_b32 s6, s2, 3
s_lshl_b32 s6, s6, 12
v_lshl_add_u32 v2, v2, 10, v3
v_add_u32 v2, s6, v2
v_min_u32 v3, L_prep_kernel_codeend-L_prep_kernel_pc-16, v2
global_load_dwordx4 v[172:175], v3, s[4:5]
s_getpc_b64 s[4:5]
L_prep_kernel_pco:
s_add_u32 s4, s4, L_attn_kernel_pc-L_prep_kernel_pco
s_addc_u32 s5, s5, 0
v_lshrrev_b32 v2, 6, v0
v_and_b32 v3, 63, v0
v_lshlrev_b32 v3, 4, v3
s_lshr_b32 s6, s2, 3
s_lshl_b32 s6, s6, 12
v_lshl_add_u32 v2, v2, 10, v3
v_add_u32 v2, s6, v2
v_min_u32 v2, L_attn_kernel_codeend-L_attn_kernel_pc-16, v2
global_load_dwordx4 v[168:171], v2, s[4:5]
s_load_dwordx2 s[8:9], s[0:1], 104
s_load_dwordx2 s[4:5], s[0:1], 0
s_load_dwordx2 s[6:7], s[0:1], 72
s_load_dwordx2 s[34:35], s[0:1], 80
s_load_dwordx2 s[36:37], s[0:1], 96
s_load_dwordx2 s[38:39], s[0:1], 24
v_and_b32 v1, 7, v0
v_bfe_u32 v2, v0, 3, 2
v_bfe_u32 v3, v0, 5, 1
v_lshrrev_b32 v4, 6, v0
v_lshl_add_u32 v5, v4, 3, v3
s_lshr_b32 s10, s2, 1
s_lshl_b32 s10, s10, 15
s_and_b32 s11, s2, 1
s_lshl_b32 s11, s11, 7
s_add_u32 s10, s10, s11
v_lshlrev_b32 v6, 10, v5
v_lshl_add_u32 v6, v2, 8, v6
v_lshl_add_u32 v6, v1, 4, v6
v_add_u32 v6, s10, v6
s_lshl_b32 s11, s2, 14
v_lshlrev_b32 v7, 11, v1
v_lshl_add_u32 v7, v5, 6, v7
v_lshl_add_u32 v7, v2, 3, v7
v_add_u32 v7, s11, v7
v_lshlrev_b32 v8, 7, v5
v_lshl_add_u32 v8, v2, 4, v8
s_waitcnt lgkmcnt(0)
s_mov_b32 s12, s8
s_mov_b32 s13, s9
s_mov_b32 s14, 0x20000
s_mov_b32 s15, 0x20000
s_mov_b32 s16, s4
s_mov_b32 s17, s5
s_mov_b32 s18, 0x400000
s_mov_b32 s19, 0x20000
s_add_u32 s20, s8, 0x100000
s_addc_u32 s21, s9, 0
s_mov_b32 s22, 0x400000
s_mov_b32 s23, 0x20000
buffer_load_dwordx2 v[16:17], v7, s[16:19], 0 offen offset:0
buffer_load_dwordx2 v[18:19], v7, s[16:19], 0 offen offset:32
buffer_load_dwordx2 v[20:21], v7, s[16:19], 0 offen offset:128
buffer_load_dwordx2 v[22:23], v7, s[16:19], 0 offen offset:160
buffer_load_dwordx2 v[24:25], v7, s[16:19], 0 offen offset:256
buffer_load_dwordx2 v[26:27], v7, s[16:19], 0 offen offset:288
buffer_load_dwordx2 v[28:29], v7, s[16:19], 0 offen offset:384
buffer_load_dwordx2 v[30:31], v7, s[16:19], 0 offen offset:416
s_add_u32 s52, s8, 0x80000
s_addc_u32 s53, s9, 0
s_mov_b32 s54, 0x20000
s_mov_b32 s55, 0x20000
v_mov_b32 v132, 0
v_mov_b32 v133, 0
v_lshlrev_b32 v9, 3, v0
s_lshl_b32 s24, s2, 9
v_cmp_gt_u32 vcc, 64, v0
s_nop 0
s_and_saveexec_b64 s[30:31], vcc
s_cbranch_execz L_prep_kernel_noclr
buffer_store_dwordx2 v[132:133], v9, s[52:55], s24 offen
L_prep_kernel_noclr:
s_mov_b64 exec, s[30:31]
s_cmp_ge_u32 s2, 128
s_cbranch_scc1 L_prep_kernel_skipc
s_and_b32 s28, s2, 31
s_lshr_b32 s29, s2, 5
s_mov_b32 s40, s34
s_mov_b32 s41, s35
s_mov_b32 s42, 0xc00000
s_mov_b32 s43, 0x20000
s_mov_b32 s44, s6
s_mov_b32 s45, s7
s_mov_b32 s46, 0x800
s_mov_b32 s47, 0x20000
v_lshlrev_b32 v9, 2, v0
s_mul_i32 s30, s29, 512
buffer_load_dword v10, v9, s[44:47], s30 offen
v_lshrrev_b32 v11, 3, v0
v_mul_u32_u24 v12, 0x3000, v11
v_lshl_add_u32 v12, v1, 4, v12
s_mul_i32 s30, s29, 3145728
s_lshl_b32 s31, s28, 7
s_add_u32 s30, s30, s31
buffer_load_dwordx4 v[64:67], v12, s[40:43], s30 offen nt
s_add_u32 s30, s30, 393216
buffer_load_dwordx4 v[68:71], v12, s[40:43], s30 offen nt
s_add_u32 s30, s30, 393216
buffer_load_dwordx4 v[72:75], v12, s[40:43], s30 offen nt
s_add_u32 s30, s30, 393216
buffer_load_dwordx4 v[76:79], v12, s[40:43], s30 offen nt
s_add_u32 s30, s30, 393216
buffer_load_dwordx4 v[80:83], v12, s[40:43], s30 offen nt
s_add_u32 s30, s30, 393216
buffer_load_dwordx4 v[84:87], v12, s[40:43], s30 offen nt
s_add_u32 s30, s30, 393216
buffer_load_dwordx4 v[88:91], v12, s[40:43], s30 offen nt
s_add_u32 s30, s30, 393216
buffer_load_dwordx4 v[92:95], v12, s[40:43], s30 offen nt
s_waitcnt vmcnt(8)
v_lshlrev_b32 v13, 16, v10
v_and_b32 v14, 0xffff0000, v10
v_mul_f32 v15, 0xbfb8aa3b, v13
v_exp_f32 v15, v15
s_nop 0
v_add_f32 v15, 1.0, v15
v_rcp_f32 v15, v15
s_nop 0
v_mul_f32 v13, v13, v15
v_mul_f32 v15, 0xbfb8aa3b, v14
v_exp_f32 v15, v15
s_nop 0
v_add_f32 v15, 1.0, v15
v_rcp_f32 v15, v15
s_nop 0
v_mul_f32 v14, v14, v15
v_cvt_pk_bf16_f32 v15, v13, v14
v_lshlrev_b32 v13, 16, v15
v_and_b32 v14, 0xffff0000, v15
v_lshlrev_b32 v9, 3, v0
v_mov_b32 v132, v13
v_mov_b32 v133, v14
ds_write_b64 v9, v[132:133]
s_waitcnt lgkmcnt(0)
s_barrier
v_lshrrev_b32 v11, 3, v0
v_lshlrev_b32 v9, 2, v11
ds_read_b32 v144, v9 offset:0
ds_read_b32 v145, v9 offset:128
ds_read_b32 v146, v9 offset:256
ds_read_b32 v147, v9 offset:384
ds_read_b32 v148, v9 offset:512
ds_read_b32 v149, v9 offset:640
ds_read_b32 v150, v9 offset:768
ds_read_b32 v151, v9 offset:896
v_mov_b32 v132, 0
v_mov_b32 v133, 0
v_mov_b32 v134, 0
v_mov_b32 v135, 0
v_mov_b32 v136, 0
v_mov_b32 v137, 0
v_mov_b32 v138, 0
v_mov_b32 v139, 0
s_waitcnt vmcnt(7) lgkmcnt(7)
v_lshlrev_b32 v140, 16, v64
v_and_b32 v141, 0xffff0000, v64
v_fmac_f32 v132, v144, v140
v_fmac_f32 v133, v144, v141
v_lshlrev_b32 v140, 16, v65
v_and_b32 v141, 0xffff0000, v65
v_fmac_f32 v134, v144, v140
v_fmac_f32 v135, v144, v141
v_lshlrev_b32 v140, 16, v66
v_and_b32 v141, 0xffff0000, v66
v_fmac_f32 v136, v144, v140
v_fmac_f32 v137, v144, v141
v_lshlrev_b32 v140, 16, v67
v_and_b32 v141, 0xffff0000, v67
v_fmac_f32 v138, v144, v140
v_fmac_f32 v139, v144, v141
s_waitcnt vmcnt(6) lgkmcnt(6)
v_lshlrev_b32 v140, 16, v68
v_and_b32 v141, 0xffff0000, v68
v_fmac_f32 v132, v145, v140
v_fmac_f32 v133, v145, v141
v_lshlrev_b32 v140, 16, v69
v_and_b32 v141, 0xffff0000, v69
v_fmac_f32 v134, v145, v140
v_fmac_f32 v135, v145, v141
v_lshlrev_b32 v140, 16, v70
v_and_b32 v141, 0xffff0000, v70
v_fmac_f32 v136, v145, v140
v_fmac_f32 v137, v145, v141
v_lshlrev_b32 v140, 16, v71
v_and_b32 v141, 0xffff0000, v71
v_fmac_f32 v138, v145, v140
v_fmac_f32 v139, v145, v141
s_waitcnt vmcnt(5) lgkmcnt(5)
v_lshlrev_b32 v140, 16, v72
v_and_b32 v141, 0xffff0000, v72
v_fmac_f32 v132, v146, v140
v_fmac_f32 v133, v146, v141
v_lshlrev_b32 v140, 16, v73
v_and_b32 v141, 0xffff0000, v73
v_fmac_f32 v134, v146, v140
v_fmac_f32 v135, v146, v141
v_lshlrev_b32 v140, 16, v74
v_and_b32 v141, 0xffff0000, v74
v_fmac_f32 v136, v146, v140
v_fmac_f32 v137, v146, v141
v_lshlrev_b32 v140, 16, v75
v_and_b32 v141, 0xffff0000, v75
v_fmac_f32 v138, v146, v140
v_fmac_f32 v139, v146, v141
s_waitcnt vmcnt(4) lgkmcnt(4)
v_lshlrev_b32 v140, 16, v76
v_and_b32 v141, 0xffff0000, v76
v_fmac_f32 v132, v147, v140
v_fmac_f32 v133, v147, v141
v_lshlrev_b32 v140, 16, v77
v_and_b32 v141, 0xffff0000, v77
v_fmac_f32 v134, v147, v140
v_fmac_f32 v135, v147, v141
v_lshlrev_b32 v140, 16, v78
v_and_b32 v141, 0xffff0000, v78
v_fmac_f32 v136, v147, v140
v_fmac_f32 v137, v147, v141
v_lshlrev_b32 v140, 16, v79
v_and_b32 v141, 0xffff0000, v79
v_fmac_f32 v138, v147, v140
v_fmac_f32 v139, v147, v141
s_waitcnt vmcnt(3) lgkmcnt(3)
v_lshlrev_b32 v140, 16, v80
v_and_b32 v141, 0xffff0000, v80
v_fmac_f32 v132, v148, v140
v_fmac_f32 v133, v148, v141
v_lshlrev_b32 v140, 16, v81
v_and_b32 v141, 0xffff0000, v81
v_fmac_f32 v134, v148, v140
v_fmac_f32 v135, v148, v141
v_lshlrev_b32 v140, 16, v82
v_and_b32 v141, 0xffff0000, v82
v_fmac_f32 v136, v148, v140
v_fmac_f32 v137, v148, v141
v_lshlrev_b32 v140, 16, v83
v_and_b32 v141, 0xffff0000, v83
v_fmac_f32 v138, v148, v140
v_fmac_f32 v139, v148, v141
s_waitcnt vmcnt(2) lgkmcnt(2)
v_lshlrev_b32 v140, 16, v84
v_and_b32 v141, 0xffff0000, v84
v_fmac_f32 v132, v149, v140
v_fmac_f32 v133, v149, v141
v_lshlrev_b32 v140, 16, v85
v_and_b32 v141, 0xffff0000, v85
v_fmac_f32 v134, v149, v140
v_fmac_f32 v135, v149, v141
v_lshlrev_b32 v140, 16, v86
v_and_b32 v141, 0xffff0000, v86
v_fmac_f32 v136, v149, v140
v_fmac_f32 v137, v149, v141
v_lshlrev_b32 v140, 16, v87
v_and_b32 v141, 0xffff0000, v87
v_fmac_f32 v138, v149, v140
v_fmac_f32 v139, v149, v141
s_waitcnt vmcnt(1) lgkmcnt(1)
v_lshlrev_b32 v140, 16, v88
v_and_b32 v141, 0xffff0000, v88
v_fmac_f32 v132, v150, v140
v_fmac_f32 v133, v150, v141
v_lshlrev_b32 v140, 16, v89
v_and_b32 v141, 0xffff0000, v89
v_fmac_f32 v134, v150, v140
v_fmac_f32 v135, v150, v141
v_lshlrev_b32 v140, 16, v90
v_and_b32 v141, 0xffff0000, v90
v_fmac_f32 v136, v150, v140
v_fmac_f32 v137, v150, v141
v_lshlrev_b32 v140, 16, v91
v_and_b32 v141, 0xffff0000, v91
v_fmac_f32 v138, v150, v140
v_fmac_f32 v139, v150, v141
s_waitcnt vmcnt(0) lgkmcnt(0)
v_lshlrev_b32 v140, 16, v92
v_and_b32 v141, 0xffff0000, v92
v_fmac_f32 v132, v151, v140
v_fmac_f32 v133, v151, v141
v_lshlrev_b32 v140, 16, v93
v_and_b32 v141, 0xffff0000, v93
v_fmac_f32 v134, v151, v140
v_fmac_f32 v135, v151, v141
v_lshlrev_b32 v140, 16, v94
v_and_b32 v141, 0xffff0000, v94
v_fmac_f32 v136, v151, v140
v_fmac_f32 v137, v151, v141
v_lshlrev_b32 v140, 16, v95
v_and_b32 v141, 0xffff0000, v95
v_fmac_f32 v138, v151, v140
v_fmac_f32 v139, v151, v141
v_add_f32_dpp v132, v132, v132 row_ror:8 row_mask:0xf bank_mask:0xf
v_add_f32_dpp v133, v133, v133 row_ror:8 row_mask:0xf bank_mask:0xf
v_add_f32_dpp v134, v134, v134 row_ror:8 row_mask:0xf bank_mask:0xf
v_add_f32_dpp v135, v135, v135 row_ror:8 row_mask:0xf bank_mask:0xf
v_add_f32_dpp v136, v136, v136 row_ror:8 row_mask:0xf bank_mask:0xf
v_add_f32_dpp v137, v137, v137 row_ror:8 row_mask:0xf bank_mask:0xf
v_add_f32_dpp v138, v138, v138 row_ror:8 row_mask:0xf bank_mask:0xf
v_add_f32_dpp v139, v139, v139 row_ror:8 row_mask:0xf bank_mask:0xf
v_mov_b32 v144, v132
v_mov_b32 v145, v133
v_mov_b32 v146, v134
v_mov_b32 v147, v135
v_mov_b32 v148, v136
v_mov_b32 v149, v137
v_mov_b32 v150, v138
v_mov_b32 v151, v139
v_permlane16_swap_b32 v132, v144
v_permlane16_swap_b32 v133, v145
v_permlane16_swap_b32 v134, v146
v_permlane16_swap_b32 v135, v147
v_permlane16_swap_b32 v136, v148
v_permlane16_swap_b32 v137, v149
v_permlane16_swap_b32 v138, v150
v_permlane16_swap_b32 v139, v151
v_add_f32 v132, v132, v144
v_add_f32 v133, v133, v145
v_add_f32 v134, v134, v146
v_add_f32 v135, v135, v147
v_add_f32 v136, v136, v148
v_add_f32 v137, v137, v149
v_add_f32 v138, v138, v150
v_add_f32 v139, v139, v151
v_mov_b32 v144, v132
v_mov_b32 v145, v133
v_mov_b32 v146, v134
v_mov_b32 v147, v135
v_mov_b32 v148, v136
v_mov_b32 v149, v137
v_mov_b32 v150, v138
v_mov_b32 v151, v139
v_permlane32_swap_b32 v132, v144
v_permlane32_swap_b32 v133, v145
v_permlane32_swap_b32 v134, v146
v_permlane32_swap_b32 v135, v147
v_permlane32_swap_b32 v136, v148
v_permlane32_swap_b32 v137, v149
v_permlane32_swap_b32 v138, v150
v_permlane32_swap_b32 v139, v151
v_add_f32 v132, v132, v144
v_add_f32 v133, v133, v145
v_add_f32 v134, v134, v146
v_add_f32 v135, v135, v147
v_add_f32 v136, v136, v148
v_add_f32 v137, v137, v149
v_add_f32 v138, v138, v150
v_add_f32 v139, v139, v151
v_lshlrev_b32 v9, 8, v4
v_lshl_add_u32 v9, v1, 5, v9
v_and_b32 v10, 63, v0
v_cmp_gt_u32 vcc, 8, v10
s_nop 0
s_and_saveexec_b64 s[30:31], vcc
ds_write_b128 v9, v[132:135] offset:2048
ds_write_b128 v9, v[136:139] offset:2064
s_mov_b64 exec, s[30:31]
s_waitcnt lgkmcnt(0)
s_barrier
v_cmp_gt_u32 vcc, 64, v0
s_nop 0
s_and_saveexec_b64 s[30:31], vcc
s_cbranch_execz L_prep_kernel_gdonec
v_lshlrev_b32 v9, 2, v0
ds_read_b32 v132, v9 offset:2048
ds_read_b32 v133, v9 offset:2304
ds_read_b32 v134, v9 offset:2560
ds_read_b32 v135, v9 offset:2816
s_waitcnt lgkmcnt(0)
v_add_f32 v132, v132, v133
v_add_f32 v134, v134, v135
v_add_f32 v132, v132, v134
s_mul_i32 s48, s29, 32768
s_lshl_b32 s49, s28, 8
s_add_u32 s48, s48, s49
buffer_store_dword v132, v9, s[12:15], s48 offen sc1
s_waitcnt vmcnt(0)
s_lshr_b32 s48, s28, 4
s_lshl_b32 s48, s48, 7
v_mov_b32 v9, s48
v_mov_b32 v10, 1
v_cmp_eq_u32 vcc, 0, v0
s_nop 0
s_and_saveexec_b64 s[48:49], vcc
global_atomic_add v9, v10, s[36:37]
L_prep_kernel_gdonec:
s_mov_b64 exec, s[30:31]
L_prep_kernel_skipc:
s_mov_b64 exec, -1
s_waitcnt vmcnt(2)
s_cmp_lt_u32 s2, 128
s_cbranch_scc1 L_prep_kernel_xok
s_waitcnt vmcnt(0)
L_prep_kernel_xok:
v_lshlrev_b32 v32, 16, v16
v_and_b32 v33, 0xffff0000, v16
v_lshlrev_b32 v34, 16, v17
v_and_b32 v35, 0xffff0000, v17
v_lshlrev_b32 v36, 16, v18
v_and_b32 v37, 0xffff0000, v18
v_lshlrev_b32 v38, 16, v19
v_and_b32 v39, 0xffff0000, v19
v_lshlrev_b32 v40, 16, v20
v_and_b32 v41, 0xffff0000, v20
v_lshlrev_b32 v42, 16, v21
v_and_b32 v43, 0xffff0000, v21
v_lshlrev_b32 v44, 16, v22
v_and_b32 v45, 0xffff0000, v22
v_lshlrev_b32 v46, 16, v23
v_and_b32 v47, 0xffff0000, v23
v_lshlrev_b32 v48, 16, v24
v_and_b32 v49, 0xffff0000, v24
v_lshlrev_b32 v50, 16, v25
v_and_b32 v51, 0xffff0000, v25
v_lshlrev_b32 v52, 16, v26
v_and_b32 v53, 0xffff0000, v26
v_lshlrev_b32 v54, 16, v27
v_and_b32 v55, 0xffff0000, v27
v_lshlrev_b32 v56, 16, v28
v_and_b32 v57, 0xffff0000, v28
v_lshlrev_b32 v58, 16, v29
v_and_b32 v59, 0xffff0000, v29
v_lshlrev_b32 v60, 16, v30
v_and_b32 v61, 0xffff0000, v30
v_lshlrev_b32 v62, 16, v31
v_and_b32 v63, 0xffff0000, v31
v_add_f32 v10, v32, v33
v_add_f32 v11, v34, v35
v_add_f32 v10, v10, v36
v_add_f32 v10, v10, v37
v_add_f32 v11, v11, v38
v_add_f32 v11, v11, v39
v_add_f32 v10, v10, v40
v_add_f32 v10, v10, v41
v_add_f32 v11, v11, v42
v_add_f32 v11, v11, v43
v_add_f32 v10, v10, v44
v_add_f32 v10, v10, v45
v_add_f32 v11, v11, v46
v_add_f32 v11, v11, v47
v_add_f32 v10, v10, v48
v_add_f32 v10, v10, v49
v_add_f32 v11, v11, v50
v_add_f32 v11, v11, v51
v_add_f32 v10, v10, v52
v_add_f32 v10, v10, v53
v_add_f32 v11, v11, v54
v_add_f32 v11, v11, v55
v_add_f32 v10, v10, v56
v_add_f32 v10, v10, v57
v_add_f32 v11, v11, v58
v_add_f32 v11, v11, v59
v_add_f32 v10, v10, v60
v_add_f32 v10, v10, v61
v_add_f32 v11, v11, v62
v_add_f32 v11, v11, v63
v_add_f32 v10, v10, v11
s_nop 1
v_add_f32_dpp v10, v10, v10 row_ror:8 row_mask:0xf bank_mask:0xf
v_mov_b32 v11, v10
s_nop 1
v_permlane16_swap_b32 v10, v11
v_add_f32 v10, v10, v11
v_mov_b32 v11, v10
s_nop 1
v_permlane32_swap_b32 v10, v11
v_add_f32 v10, v10, v11
v_lshlrev_b32 v12, 5, v4
v_lshl_add_u32 v12, v1, 2, v12
ds_write_b32 v12, v10 offset:3072
s_waitcnt lgkmcnt(0)
s_barrier
v_lshlrev_b32 v12, 2, v1
ds_read_b32 v13, v12 offset:3072
ds_read_b32 v14, v12 offset:3104
ds_read_b32 v15, v12 offset:3136
ds_read_b32 v16, v12 offset:3168
s_waitcnt lgkmcnt(0)
v_add_f32 v13, v13, v14
v_add_f32 v15, v15, v16
v_add_f32 v10, v13, v15
v_mov_b32 v18, v10
s_cmp_lt_u32 s2, 128
s_cbranch_scc1 L_prep_kernel_skipn
s_sub_u32 s30, s2, 128
s_and_b32 s28, s30, 63
s_add_u32 s28, s28, 32
s_lshr_b32 s29, s30, 6
s_mov_b32 s40, s34
s_mov_b32 s41, s35
s_mov_b32 s42, 0xc00000
s_mov_b32 s43, 0x20000
s_mov_b32 s44, s6
s_mov_b32 s45, s7
s_mov_b32 s46, 0x800
s_mov_b32 s47, 0x20000
v_lshlrev_b32 v9, 2, v0
s_mul_i32 s30, s29, 1024
buffer_load_dword v10, v9, s[44:47], s30 offen
v_lshrrev_b32 v11, 3, v0
v_mul_u32_u24 v12, 0x3000, v11
v_lshl_add_u32 v12, v1, 4, v12
s_mul_i32 s30, s29, 6291456
s_lshl_b32 s31, s28, 7
s_add_u32 s30, s30, s31
buffer_load_dwordx4 v[64:67], v12, s[40:43], s30 offen nt
s_add_u32 s30, s30, 393216
buffer_load_dwordx4 v[68:71], v12, s[40:43], s30 offen nt
s_add_u32 s30, s30, 393216
buffer_load_dwordx4 v[72:75], v12, s[40:43], s30 offen nt
s_add_u32 s30, s30, 393216
buffer_load_dwordx4 v[76:79], v12, s[40:43], s30 offen nt
s_add_u32 s30, s30, 393216
buffer_load_dwordx4 v[80:83], v12, s[40:43], s30 offen nt
s_add_u32 s30, s30, 393216
buffer_load_dwordx4 v[84:87], v12, s[40:43], s30 offen nt
s_add_u32 s30, s30, 393216
buffer_load_dwordx4 v[88:91], v12, s[40:43], s30 offen nt
s_add_u32 s30, s30, 393216
buffer_load_dwordx4 v[92:95], v12, s[40:43], s30 offen nt
s_add_u32 s30, s30, 393216
buffer_load_dwordx4 v[96:99], v12, s[40:43], s30 offen nt
s_add_u32 s30, s30, 393216
buffer_load_dwordx4 v[100:103], v12, s[40:43], s30 offen nt
s_add_u32 s30, s30, 393216
buffer_load_dwordx4 v[104:107], v12, s[40:43], s30 offen nt
s_add_u32 s30, s30, 393216
buffer_load_dwordx4 v[108:111], v12, s[40:43], s30 offen nt
s_add_u32 s30, s30, 393216
buffer_load_dwordx4 v[112:115], v12, s[40:43], s30 offen nt
s_add_u32 s30, s30, 393216
buffer_load_dwordx4 v[116:119], v12, s[40:43], s30 offen nt
s_add_u32 s30, s30, 393216
buffer_load_dwordx4 v[120:123], v12, s[40:43], s30 offen nt
s_add_u32 s30, s30, 393216
buffer_load_dwordx4 v[124:127], v12, s[40:43], s30 offen nt
s_waitcnt vmcnt(16)
v_lshlrev_b32 v13, 16, v10
v_and_b32 v14, 0xffff0000, v10
v_mul_f32 v15, 0xbfb8aa3b, v13
v_exp_f32 v15, v15
s_nop 0
v_add_f32 v15, 1.0, v15
v_rcp_f32 v15, v15
s_nop 0
v_mul_f32 v13, v13, v15
v_mul_f32 v15, 0xbfb8aa3b, v14
v_exp_f32 v15, v15
s_nop 0
v_add_f32 v15, 1.0, v15
v_rcp_f32 v15, v15
s_nop 0
v_mul_f32 v14, v14, v15
v_cvt_pk_bf16_f32 v15, v13, v14
v_lshlrev_b32 v13, 16, v15
v_and_b32 v14, 0xffff0000, v15
v_lshlrev_b32 v9, 3, v0
v_mov_b32 v132, v13
v_mov_b32 v133, v14
ds_write_b64 v9, v[132:133]
s_waitcnt lgkmcnt(0)
s_barrier
v_lshrrev_b32 v11, 3, v0
v_lshlrev_b32 v9, 2, v11
ds_read_b32 v144, v9 offset:0
ds_read_b32 v145, v9 offset:128
ds_read_b32 v146, v9 offset:256
ds_read_b32 v147, v9 offset:384
ds_read_b32 v148, v9 offset:512
ds_read_b32 v149, v9 offset:640
ds_read_b32 v150, v9 offset:768
ds_read_b32 v151, v9 offset:896
ds_read_b32 v152, v9 offset:1024
ds_read_b32 v153, v9 offset:1152
ds_read_b32 v154, v9 offset:1280
ds_read_b32 v155, v9 offset:1408
ds_read_b32 v156, v9 offset:1536
ds_read_b32 v157, v9 offset:1664
ds_read_b32 v158, v9 offset:1792
ds_read_b32 v159, v9 offset:1920
v_mov_b32 v132, 0
v_mov_b32 v133, 0
v_mov_b32 v134, 0
v_mov_b32 v135, 0
v_mov_b32 v136, 0
v_mov_b32 v137, 0
v_mov_b32 v138, 0
v_mov_b32 v139, 0
s_waitcnt vmcnt(15) lgkmcnt(15)
v_lshlrev_b32 v140, 16, v64
v_and_b32 v141, 0xffff0000, v64
v_fmac_f32 v132, v144, v140
v_fmac_f32 v133, v144, v141
v_lshlrev_b32 v140, 16, v65
v_and_b32 v141, 0xffff0000, v65
v_fmac_f32 v134, v144, v140
v_fmac_f32 v135, v144, v141
v_lshlrev_b32 v140, 16, v66
v_and_b32 v141, 0xffff0000, v66
v_fmac_f32 v136, v144, v140
v_fmac_f32 v137, v144, v141
v_lshlrev_b32 v140, 16, v67
v_and_b32 v141, 0xffff0000, v67
v_fmac_f32 v138, v144, v140
v_fmac_f32 v139, v144, v141
s_waitcnt vmcnt(14) lgkmcnt(14)
v_lshlrev_b32 v140, 16, v68
v_and_b32 v141, 0xffff0000, v68
v_fmac_f32 v132, v145, v140
v_fmac_f32 v133, v145, v141
v_lshlrev_b32 v140, 16, v69
v_and_b32 v141, 0xffff0000, v69
v_fmac_f32 v134, v145, v140
v_fmac_f32 v135, v145, v141
v_lshlrev_b32 v140, 16, v70
v_and_b32 v141, 0xffff0000, v70
v_fmac_f32 v136, v145, v140
v_fmac_f32 v137, v145, v141
v_lshlrev_b32 v140, 16, v71
v_and_b32 v141, 0xffff0000, v71
v_fmac_f32 v138, v145, v140
v_fmac_f32 v139, v145, v141
s_waitcnt vmcnt(13) lgkmcnt(13)
v_lshlrev_b32 v140, 16, v72
v_and_b32 v141, 0xffff0000, v72
v_fmac_f32 v132, v146, v140
v_fmac_f32 v133, v146, v141
v_lshlrev_b32 v140, 16, v73
v_and_b32 v141, 0xffff0000, v73
v_fmac_f32 v134, v146, v140
v_fmac_f32 v135, v146, v141
v_lshlrev_b32 v140, 16, v74
v_and_b32 v141, 0xffff0000, v74
v_fmac_f32 v136, v146, v140
v_fmac_f32 v137, v146, v141
v_lshlrev_b32 v140, 16, v75
v_and_b32 v141, 0xffff0000, v75
v_fmac_f32 v138, v146, v140
v_fmac_f32 v139, v146, v141
s_waitcnt vmcnt(12) lgkmcnt(12)
v_lshlrev_b32 v140, 16, v76
v_and_b32 v141, 0xffff0000, v76
v_fmac_f32 v132, v147, v140
v_fmac_f32 v133, v147, v141
v_lshlrev_b32 v140, 16, v77
v_and_b32 v141, 0xffff0000, v77
v_fmac_f32 v134, v147, v140
v_fmac_f32 v135, v147, v141
v_lshlrev_b32 v140, 16, v78
v_and_b32 v141, 0xffff0000, v78
v_fmac_f32 v136, v147, v140
v_fmac_f32 v137, v147, v141
v_lshlrev_b32 v140, 16, v79
v_and_b32 v141, 0xffff0000, v79
v_fmac_f32 v138, v147, v140
v_fmac_f32 v139, v147, v141
s_waitcnt vmcnt(11) lgkmcnt(11)
v_lshlrev_b32 v140, 16, v80
v_and_b32 v141, 0xffff0000, v80
v_fmac_f32 v132, v148, v140
v_fmac_f32 v133, v148, v141
v_lshlrev_b32 v140, 16, v81
v_and_b32 v141, 0xffff0000, v81
v_fmac_f32 v134, v148, v140
v_fmac_f32 v135, v148, v141
v_lshlrev_b32 v140, 16, v82
v_and_b32 v141, 0xffff0000, v82
v_fmac_f32 v136, v148, v140
v_fmac_f32 v137, v148, v141
v_lshlrev_b32 v140, 16, v83
v_and_b32 v141, 0xffff0000, v83
v_fmac_f32 v138, v148, v140
v_fmac_f32 v139, v148, v141
s_waitcnt vmcnt(10) lgkmcnt(10)
v_lshlrev_b32 v140, 16, v84
v_and_b32 v141, 0xffff0000, v84
v_fmac_f32 v132, v149, v140
v_fmac_f32 v133, v149, v141
v_lshlrev_b32 v140, 16, v85
v_and_b32 v141, 0xffff0000, v85
v_fmac_f32 v134, v149, v140
v_fmac_f32 v135, v149, v141
v_lshlrev_b32 v140, 16, v86
v_and_b32 v141, 0xffff0000, v86
v_fmac_f32 v136, v149, v140
v_fmac_f32 v137, v149, v141
v_lshlrev_b32 v140, 16, v87
v_and_b32 v141, 0xffff0000, v87
v_fmac_f32 v138, v149, v140
v_fmac_f32 v139, v149, v141
s_waitcnt vmcnt(9) lgkmcnt(9)
v_lshlrev_b32 v140, 16, v88
v_and_b32 v141, 0xffff0000, v88
v_fmac_f32 v132, v150, v140
v_fmac_f32 v133, v150, v141
v_lshlrev_b32 v140, 16, v89
v_and_b32 v141, 0xffff0000, v89
v_fmac_f32 v134, v150, v140
v_fmac_f32 v135, v150, v141
v_lshlrev_b32 v140, 16, v90
v_and_b32 v141, 0xffff0000, v90
v_fmac_f32 v136, v150, v140
v_fmac_f32 v137, v150, v141
v_lshlrev_b32 v140, 16, v91
v_and_b32 v141, 0xffff0000, v91
v_fmac_f32 v138, v150, v140
v_fmac_f32 v139, v150, v141
s_waitcnt vmcnt(8) lgkmcnt(8)
v_lshlrev_b32 v140, 16, v92
v_and_b32 v141, 0xffff0000, v92
v_fmac_f32 v132, v151, v140
v_fmac_f32 v133, v151, v141
v_lshlrev_b32 v140, 16, v93
v_and_b32 v141, 0xffff0000, v93
v_fmac_f32 v134, v151, v140
v_fmac_f32 v135, v151, v141
v_lshlrev_b32 v140, 16, v94
v_and_b32 v141, 0xffff0000, v94
v_fmac_f32 v136, v151, v140
v_fmac_f32 v137, v151, v141
v_lshlrev_b32 v140, 16, v95
v_and_b32 v141, 0xffff0000, v95
v_fmac_f32 v138, v151, v140
v_fmac_f32 v139, v151, v141
s_waitcnt vmcnt(7) lgkmcnt(7)
v_lshlrev_b32 v140, 16, v96
v_and_b32 v141, 0xffff0000, v96
v_fmac_f32 v132, v152, v140
v_fmac_f32 v133, v152, v141
v_lshlrev_b32 v140, 16, v97
v_and_b32 v141, 0xffff0000, v97
v_fmac_f32 v134, v152, v140
v_fmac_f32 v135, v152, v141
v_lshlrev_b32 v140, 16, v98
v_and_b32 v141, 0xffff0000, v98
v_fmac_f32 v136, v152, v140
v_fmac_f32 v137, v152, v141
v_lshlrev_b32 v140, 16, v99
v_and_b32 v141, 0xffff0000, v99
v_fmac_f32 v138, v152, v140
v_fmac_f32 v139, v152, v141
s_waitcnt vmcnt(6) lgkmcnt(6)
v_lshlrev_b32 v140, 16, v100
v_and_b32 v141, 0xffff0000, v100
v_fmac_f32 v132, v153, v140
v_fmac_f32 v133, v153, v141
v_lshlrev_b32 v140, 16, v101
v_and_b32 v141, 0xffff0000, v101
v_fmac_f32 v134, v153, v140
v_fmac_f32 v135, v153, v141
v_lshlrev_b32 v140, 16, v102
v_and_b32 v141, 0xffff0000, v102
v_fmac_f32 v136, v153, v140
v_fmac_f32 v137, v153, v141
v_lshlrev_b32 v140, 16, v103
v_and_b32 v141, 0xffff0000, v103
v_fmac_f32 v138, v153, v140
v_fmac_f32 v139, v153, v141
s_waitcnt vmcnt(5) lgkmcnt(5)
v_lshlrev_b32 v140, 16, v104
v_and_b32 v141, 0xffff0000, v104
v_fmac_f32 v132, v154, v140
v_fmac_f32 v133, v154, v141
v_lshlrev_b32 v140, 16, v105
v_and_b32 v141, 0xffff0000, v105
v_fmac_f32 v134, v154, v140
v_fmac_f32 v135, v154, v141
v_lshlrev_b32 v140, 16, v106
v_and_b32 v141, 0xffff0000, v106
v_fmac_f32 v136, v154, v140
v_fmac_f32 v137, v154, v141
v_lshlrev_b32 v140, 16, v107
v_and_b32 v141, 0xffff0000, v107
v_fmac_f32 v138, v154, v140
v_fmac_f32 v139, v154, v141
s_waitcnt vmcnt(4) lgkmcnt(4)
v_lshlrev_b32 v140, 16, v108
v_and_b32 v141, 0xffff0000, v108
v_fmac_f32 v132, v155, v140
v_fmac_f32 v133, v155, v141
v_lshlrev_b32 v140, 16, v109
v_and_b32 v141, 0xffff0000, v109
v_fmac_f32 v134, v155, v140
v_fmac_f32 v135, v155, v141
v_lshlrev_b32 v140, 16, v110
v_and_b32 v141, 0xffff0000, v110
v_fmac_f32 v136, v155, v140
v_fmac_f32 v137, v155, v141
v_lshlrev_b32 v140, 16, v111
v_and_b32 v141, 0xffff0000, v111
v_fmac_f32 v138, v155, v140
v_fmac_f32 v139, v155, v141
s_waitcnt vmcnt(3) lgkmcnt(3)
v_lshlrev_b32 v140, 16, v112
v_and_b32 v141, 0xffff0000, v112
v_fmac_f32 v132, v156, v140
v_fmac_f32 v133, v156, v141
v_lshlrev_b32 v140, 16, v113
v_and_b32 v141, 0xffff0000, v113
v_fmac_f32 v134, v156, v140
v_fmac_f32 v135, v156, v141
v_lshlrev_b32 v140, 16, v114
v_and_b32 v141, 0xffff0000, v114
v_fmac_f32 v136, v156, v140
v_fmac_f32 v137, v156, v141
v_lshlrev_b32 v140, 16, v115
v_and_b32 v141, 0xffff0000, v115
v_fmac_f32 v138, v156, v140
v_fmac_f32 v139, v156, v141
s_waitcnt vmcnt(2) lgkmcnt(2)
v_lshlrev_b32 v140, 16, v116
v_and_b32 v141, 0xffff0000, v116
v_fmac_f32 v132, v157, v140
v_fmac_f32 v133, v157, v141
v_lshlrev_b32 v140, 16, v117
v_and_b32 v141, 0xffff0000, v117
v_fmac_f32 v134, v157, v140
v_fmac_f32 v135, v157, v141
v_lshlrev_b32 v140, 16, v118
v_and_b32 v141, 0xffff0000, v118
v_fmac_f32 v136, v157, v140
v_fmac_f32 v137, v157, v141
v_lshlrev_b32 v140, 16, v119
v_and_b32 v141, 0xffff0000, v119
v_fmac_f32 v138, v157, v140
v_fmac_f32 v139, v157, v141
s_waitcnt vmcnt(1) lgkmcnt(1)
v_lshlrev_b32 v140, 16, v120
v_and_b32 v141, 0xffff0000, v120
v_fmac_f32 v132, v158, v140
v_fmac_f32 v133, v158, v141
v_lshlrev_b32 v140, 16, v121
v_and_b32 v141, 0xffff0000, v121
v_fmac_f32 v134, v158, v140
v_fmac_f32 v135, v158, v141
v_lshlrev_b32 v140, 16, v122
v_and_b32 v141, 0xffff0000, v122
v_fmac_f32 v136, v158, v140
v_fmac_f32 v137, v158, v141
v_lshlrev_b32 v140, 16, v123
v_and_b32 v141, 0xffff0000, v123
v_fmac_f32 v138, v158, v140
v_fmac_f32 v139, v158, v141
s_waitcnt vmcnt(0) lgkmcnt(0)
v_lshlrev_b32 v140, 16, v124
v_and_b32 v141, 0xffff0000, v124
v_fmac_f32 v132, v159, v140
v_fmac_f32 v133, v159, v141
v_lshlrev_b32 v140, 16, v125
v_and_b32 v141, 0xffff0000, v125
v_fmac_f32 v134, v159, v140
v_fmac_f32 v135, v159, v141
v_lshlrev_b32 v140, 16, v126
v_and_b32 v141, 0xffff0000, v126
v_fmac_f32 v136, v159, v140
v_fmac_f32 v137, v159, v141
v_lshlrev_b32 v140, 16, v127
v_and_b32 v141, 0xffff0000, v127
v_fmac_f32 v138, v159, v140
v_fmac_f32 v139, v159, v141
v_add_f32_dpp v132, v132, v132 row_ror:8 row_mask:0xf bank_mask:0xf
v_add_f32_dpp v133, v133, v133 row_ror:8 row_mask:0xf bank_mask:0xf
v_add_f32_dpp v134, v134, v134 row_ror:8 row_mask:0xf bank_mask:0xf
v_add_f32_dpp v135, v135, v135 row_ror:8 row_mask:0xf bank_mask:0xf
v_add_f32_dpp v136, v136, v136 row_ror:8 row_mask:0xf bank_mask:0xf
v_add_f32_dpp v137, v137, v137 row_ror:8 row_mask:0xf bank_mask:0xf
v_add_f32_dpp v138, v138, v138 row_ror:8 row_mask:0xf bank_mask:0xf
v_add_f32_dpp v139, v139, v139 row_ror:8 row_mask:0xf bank_mask:0xf
v_mov_b32 v144, v132
v_mov_b32 v145, v133
v_mov_b32 v146, v134
v_mov_b32 v147, v135
v_mov_b32 v148, v136
v_mov_b32 v149, v137
v_mov_b32 v150, v138
v_mov_b32 v151, v139
v_permlane16_swap_b32 v132, v144
v_permlane16_swap_b32 v133, v145
v_permlane16_swap_b32 v134, v146
v_permlane16_swap_b32 v135, v147
v_permlane16_swap_b32 v136, v148
v_permlane16_swap_b32 v137, v149
v_permlane16_swap_b32 v138, v150
v_permlane16_swap_b32 v139, v151
v_add_f32 v132, v132, v144
v_add_f32 v133, v133, v145
v_add_f32 v134, v134, v146
v_add_f32 v135, v135, v147
v_add_f32 v136, v136, v148
v_add_f32 v137, v137, v149
v_add_f32 v138, v138, v150
v_add_f32 v139, v139, v151
v_mov_b32 v144, v132
v_mov_b32 v145, v133
v_mov_b32 v146, v134
v_mov_b32 v147, v135
v_mov_b32 v148, v136
v_mov_b32 v149, v137
v_mov_b32 v150, v138
v_mov_b32 v151, v139
v_permlane32_swap_b32 v132, v144
v_permlane32_swap_b32 v133, v145
v_permlane32_swap_b32 v134, v146
v_permlane32_swap_b32 v135, v147
v_permlane32_swap_b32 v136, v148
v_permlane32_swap_b32 v137, v149
v_permlane32_swap_b32 v138, v150
v_permlane32_swap_b32 v139, v151
v_add_f32 v132, v132, v144
v_add_f32 v133, v133, v145
v_add_f32 v134, v134, v146
v_add_f32 v135, v135, v147
v_add_f32 v136, v136, v148
v_add_f32 v137, v137, v149
v_add_f32 v138, v138, v150
v_add_f32 v139, v139, v151
v_lshlrev_b32 v9, 8, v4
v_lshl_add_u32 v9, v1, 5, v9
v_and_b32 v10, 63, v0
v_cmp_gt_u32 vcc, 8, v10
s_nop 0
s_and_saveexec_b64 s[30:31], vcc
ds_write_b128 v9, v[132:135] offset:2048
ds_write_b128 v9, v[136:139] offset:2064
s_mov_b64 exec, s[30:31]
s_waitcnt lgkmcnt(0)
s_barrier
v_cmp_gt_u32 vcc, 64, v0
s_nop 0
s_and_saveexec_b64 s[30:31], vcc
s_cbranch_execz L_prep_kernel_gdonen
v_lshlrev_b32 v9, 2, v0
ds_read_b32 v132, v9 offset:2048
ds_read_b32 v133, v9 offset:2304
ds_read_b32 v134, v9 offset:2560
ds_read_b32 v135, v9 offset:2816
s_waitcnt lgkmcnt(0)
v_add_f32 v132, v132, v133
v_add_f32 v134, v134, v135
v_add_f32 v132, v132, v134
s_mul_i32 s48, s29, 32768
s_lshl_b32 s49, s28, 8
s_add_u32 s48, s48, s49
buffer_store_dword v132, v9, s[12:15], s48 offen sc1
L_prep_kernel_gdonen:
s_mov_b64 exec, s[30:31]
L_prep_kernel_skipn:
s_mov_b64 exec, -1
v_mov_b32 v10, v18
v_mul_f32 v10, 0x3a800000, v10
v_sub_f32 v32, v32, v10
v_sub_f32 v33, v33, v10
v_sub_f32 v34, v34, v10
v_sub_f32 v35, v35, v10
v_sub_f32 v36, v36, v10
v_sub_f32 v37, v37, v10
v_sub_f32 v38, v38, v10
v_sub_f32 v39, v39, v10
v_sub_f32 v40, v40, v10
v_sub_f32 v41, v41, v10
v_sub_f32 v42, v42, v10
v_sub_f32 v43, v43, v10
v_sub_f32 v44, v44, v10
v_sub_f32 v45, v45, v10
v_sub_f32 v46, v46, v10
v_sub_f32 v47, v47, v10
v_sub_f32 v48, v48, v10
v_sub_f32 v49, v49, v10
v_sub_f32 v50, v50, v10
v_sub_f32 v51, v51, v10
v_sub_f32 v52, v52, v10
v_sub_f32 v53, v53, v10
v_sub_f32 v54, v54, v10
v_sub_f32 v55, v55, v10
v_sub_f32 v56, v56, v10
v_sub_f32 v57, v57, v10
v_sub_f32 v58, v58, v10
v_sub_f32 v59, v59, v10
v_sub_f32 v60, v60, v10
v_sub_f32 v61, v61, v10
v_sub_f32 v62, v62, v10
v_sub_f32 v63, v63, v10
v_mul_f32 v10, v32, v32
v_mul_f32 v11, v33, v33
v_fmac_f32 v10, v34, v34
v_fmac_f32 v11, v35, v35
v_fmac_f32 v10, v36, v36
v_fmac_f32 v11, v37, v37
v_fmac_f32 v10, v38, v38
v_fmac_f32 v11, v39, v39
v_fmac_f32 v10, v40, v40
v_fmac_f32 v11, v41, v41
v_fmac_f32 v10, v42, v42
v_fmac_f32 v11, v43, v43
v_fmac_f32 v10, v44, v44
v_fmac_f32 v11, v45, v45
v_fmac_f32 v10, v46, v46
v_fmac_f32 v11, v47, v47
v_fmac_f32 v10, v48, v48
v_fmac_f32 v11, v49, v49
v_fmac_f32 v10, v50, v50
v_fmac_f32 v11, v51, v51
v_fmac_f32 v10, v52, v52
v_fmac_f32 v11, v53, v53
v_fmac_f32 v10, v54, v54
v_fmac_f32 v11, v55, v55
v_fmac_f32 v10, v56, v56
v_fmac_f32 v11, v57, v57
v_fmac_f32 v10, v58, v58
v_fmac_f32 v11, v59, v59
v_fmac_f32 v10, v60, v60
v_fmac_f32 v11, v61, v61
v_fmac_f32 v10, v62, v62
v_fmac_f32 v11, v63, v63
v_add_f32 v10, v10, v11
s_nop 1
v_add_f32_dpp v10, v10, v10 row_ror:8 row_mask:0xf bank_mask:0xf
v_mov_b32 v11, v10
s_nop 1
v_permlane16_swap_b32 v10, v11
v_add_f32 v10, v10, v11
v_mov_b32 v11, v10
s_nop 1
v_permlane32_swap_b32 v10, v11
v_add_f32 v10, v10, v11
v_lshlrev_b32 v12, 5, v4
v_lshl_add_u32 v12, v1, 2, v12
ds_write_b32 v12, v10 offset:3200
s_waitcnt lgkmcnt(0)
s_barrier
v_lshlrev_b32 v12, 2, v1
ds_read_b32 v13, v12 offset:3200
ds_read_b32 v14, v12 offset:3232
ds_read_b32 v15, v12 offset:3264
ds_read_b32 v16, v12 offset:3296
s_waitcnt lgkmcnt(0)
v_add_f32 v13, v13, v14
v_add_f32 v15, v15, v16
v_add_f32 v10, v13, v15
v_mul_f32 v10, 0x3a800000, v10
v_add_f32 v10, 0x3727c5ac, v10
v_rsq_f32 v10, v10
s_nop 0
v_mul_f32 v32, v32, v10
v_mul_f32 v33, v33, v10
v_mul_f32 v34, v34, v10
v_mul_f32 v35, v35, v10
v_mul_f32 v36, v36, v10
v_mul_f32 v37, v37, v10
v_mul_f32 v38, v38, v10
v_mul_f32 v39, v39, v10
v_mul_f32 v40, v40, v10
v_mul_f32 v41, v41, v10
v_mul_f32 v42, v42, v10
v_mul_f32 v43, v43, v10
v_mul_f32 v44, v44, v10
v_mul_f32 v45, v45, v10
v_mul_f32 v46, v46, v10
v_mul_f32 v47, v47, v10
v_mul_f32 v48, v48, v10
v_mul_f32 v49, v49, v10
v_mul_f32 v50, v50, v10
v_mul_f32 v51, v51, v10
v_mul_f32 v52, v52, v10
v_mul_f32 v53, v53, v10
v_mul_f32 v54, v54, v10
v_mul_f32 v55, v55, v10
v_mul_f32 v56, v56, v10
v_mul_f32 v57, v57, v10
v_mul_f32 v58, v58, v10
v_mul_f32 v59, v59, v10
v_mul_f32 v60, v60, v10
v_mul_f32 v61, v61, v10
v_mul_f32 v62, v62, v10
v_mul_f32 v63, v63, v10
v_readfirstlane_b32 s48, v4
s_nop 0
s_cmp_lg_u32 s48, 0
s_cbranch_scc1 L_prep_kernel_polled
v_and_b32 v9, 63, v0
v_lshlrev_b32 v9, 7, v9
s_mov_b32 s49, 0x40000
s_mov_b64 s[50:51], exec
s_mov_b64 exec, 3
L_prep_kernel_poll:
global_load_dword v10, v9, s[36:37] sc1
s_waitcnt vmcnt(0)
v_cmp_gt_u32 vcc, 64, v10
s_sub_u32 s49, s49, 1
s_cmp_eq_u32 s49, 0
s_cbranch_scc1 L_prep_kernel_pdone
s_cbranch_vccz L_prep_kernel_pdone
s_branch L_prep_kernel_poll
L_prep_kernel_pdone:
s_mov_b64 exec, s[50:51]
L_prep_kernel_polled:
s_barrier
v_lshlrev_b32 v160, 4, v0
s_mov_b32 s24, 0
buffer_load_dwordx4 v[128:131], v160, s[12:15], s24 offen sc1
s_mov_b32 s24, 32768
buffer_load_dwordx4 v[132:135], v160, s[12:15], s24 offen sc1
s_mov_b32 s24, 65536
buffer_load_dwordx4 v[136:139], v160, s[12:15], s24 offen sc1
s_mov_b32 s24, 98304
buffer_load_dwordx4 v[140:143], v160, s[12:15], s24 offen sc1
s_mov_b32 s24, 4096
buffer_load_dwordx4 v[144:147], v160, s[12:15], s24 offen sc1
s_mov_b32 s24, 36864
buffer_load_dwordx4 v[148:151], v160, s[12:15], s24 offen sc1
s_mov_b32 s24, 69632
buffer_load_dwordx4 v[152:155], v160, s[12:15], s24 offen sc1
s_mov_b32 s24, 102400
buffer_load_dwordx4 v[156:159], v160, s[12:15], s24 offen sc1
s_waitcnt vmcnt(0)
v_add_f32 v128, v128, v132
v_add_f32 v144, v144, v148
v_add_f32 v129, v129, v133
v_add_f32 v145, v145, v149
v_add_f32 v130, v130, v134
v_add_f32 v146, v146, v150
v_add_f32 v131, v131, v135
v_add_f32 v147, v147, v151
v_add_f32 v128, v128, v136
v_add_f32 v144, v144, v152
v_add_f32 v129, v129, v137
v_add_f32 v145, v145, v153
v_add_f32 v130, v130, v138
v_add_f32 v146, v146, v154
v_add_f32 v131, v131, v139
v_add_f32 v147, v147, v155
v_add_f32 v128, v128, v140
v_add_f32 v144, v144, v156
v_add_f32 v129, v129, v141
v_add_f32 v145, v145, v157
v_add_f32 v130, v130, v142
v_add_f32 v146, v146, v158
v_add_f32 v131, v131, v143
v_add_f32 v147, v147, v159
v_cvt_pk_bf16_f32 v132, v128, v129
v_lshlrev_b32 v128, 16, v132
v_and_b32 v129, 0xffff0000, v132
v_cvt_pk_bf16_f32 v132, v144, v145
v_lshlrev_b32 v144, 16, v132
v_and_b32 v145, 0xffff0000, v132
v_cvt_pk_bf16_f32 v132, v130, v131
v_lshlrev_b32 v130, 16, v132
v_and_b32 v131, 0xffff0000, v132
v_cvt_pk_bf16_f32 v132, v146, v147
v_lshlrev_b32 v146, 16, v132
v_and_b32 v147, 0xffff0000, v132
v_add_f32 v144, 1.0, v144
v_add_f32 v145, 1.0, v145
v_add_f32 v146, 1.0, v146
v_add_f32 v147, 1.0, v147
v_cvt_pk_bf16_f32 v132, v144, v145
v_lshlrev_b32 v144, 16, v132
v_and_b32 v145, 0xffff0000, v132
v_cvt_pk_bf16_f32 v132, v146, v147
v_lshlrev_b32 v146, 16, v132
v_and_b32 v147, 0xffff0000, v132
s_mov_b32 s24, 0x3e0293ee
v_mul_f32 v128, s24, v128
v_mul_f32 v144, s24, v144
v_mul_f32 v129, s24, v129
v_mul_f32 v145, s24, v145
v_mul_f32 v130, s24, v130
v_mul_f32 v146, s24, v146
v_mul_f32 v131, s24, v131
v_mul_f32 v147, s24, v147
ds_write_b128 v160, v[128:131] offset:8192
ds_write_b128 v160, v[144:147] offset:4096
s_waitcnt lgkmcnt(0)
s_barrier
ds_read_b128 v[64:67], v8 offset:4096
ds_read_b128 v[96:99], v8 offset:8192
ds_read_b128 v[68:71], v8 offset:4160
ds_read_b128 v[100:103], v8 offset:8256
ds_read_b128 v[72:75], v8 offset:4352
ds_read_b128 v[104:107], v8 offset:8448
ds_read_b128 v[76:79], v8 offset:4416
ds_read_b128 v[108:111], v8 offset:8512
ds_read_b128 v[80:83], v8 offset:4608
ds_read_b128 v[112:115], v8 offset:8704
ds_read_b128 v[84:87], v8 offset:4672
ds_read_b128 v[116:119], v8 offset:8768
ds_read_b128 v[88:91], v8 offset:4864
ds_read_b128 v[120:123], v8 offset:8960
ds_read_b128 v[92:95], v8 offset:4928
ds_read_b128 v[124:127], v8 offset:9024
s_waitcnt lgkmcnt(12)
v_fma_f32 v32, v32, v64, v96
v_fma_f32 v33, v33, v65, v97
v_fma_f32 v34, v34, v66, v98
v_fma_f32 v35, v35, v67, v99
v_fma_f32 v36, v36, v68, v100
v_fma_f32 v37, v37, v69, v101
v_fma_f32 v38, v38, v70, v102
v_fma_f32 v39, v39, v71, v103
v_cvt_pk_bf16_f32 v16, v32, v33
v_cvt_pk_bf16_f32 v17, v34, v35
v_cvt_pk_bf16_f32 v18, v36, v37
v_cvt_pk_bf16_f32 v19, v38, v39
s_mov_b32 s24, 0
buffer_store_dwordx4 v[16:19], v6, s[20:23], s24 offen
s_waitcnt lgkmcnt(8)
v_fma_f32 v40, v40, v72, v104
v_fma_f32 v41, v41, v73, v105
v_fma_f32 v42, v42, v74, v106
v_fma_f32 v43, v43, v75, v107
v_fma_f32 v44, v44, v76, v108
v_fma_f32 v45, v45, v77, v109
v_fma_f32 v46, v46, v78, v110
v_fma_f32 v47, v47, v79, v111
v_cvt_pk_bf16_f32 v20, v40, v41
v_cvt_pk_bf16_f32 v21, v42, v43
v_cvt_pk_bf16_f32 v22, v44, v45
v_cvt_pk_bf16_f32 v23, v46, v47
s_mov_b32 s24, 2048
buffer_store_dwordx4 v[20:23], v6, s[20:23], s24 offen
s_waitcnt lgkmcnt(4)
v_fma_f32 v48, v48, v80, v112
v_fma_f32 v49, v49, v81, v113
v_fma_f32 v50, v50, v82, v114
v_fma_f32 v51, v51, v83, v115
v_fma_f32 v52, v52, v84, v116
v_fma_f32 v53, v53, v85, v117
v_fma_f32 v54, v54, v86, v118
v_fma_f32 v55, v55, v87, v119
v_cvt_pk_bf16_f32 v24, v48, v49
v_cvt_pk_bf16_f32 v25, v50, v51
v_cvt_pk_bf16_f32 v26, v52, v53
v_cvt_pk_bf16_f32 v27, v54, v55
s_mov_b32 s24, 4096
buffer_store_dwordx4 v[24:27], v6, s[20:23], s24 offen
s_waitcnt lgkmcnt(0)
v_fma_f32 v56, v56, v88, v120
v_fma_f32 v57, v57, v89, v121
v_fma_f32 v58, v58, v90, v122
v_fma_f32 v59, v59, v91, v123
v_fma_f32 v60, v60, v92, v124
v_fma_f32 v61, v61, v93, v125
v_fma_f32 v62, v62, v94, v126
v_fma_f32 v63, v63, v95, v127
v_cvt_pk_bf16_f32 v28, v56, v57
v_cvt_pk_bf16_f32 v29, v58, v59
v_cvt_pk_bf16_f32 v30, v60, v61
v_cvt_pk_bf16_f32 v31, v62, v63
s_mov_b32 s24, 6144
buffer_store_dwordx4 v[28:31], v6, s[20:23], s24 offen
s_mov_b32 s40, s38
s_mov_b32 s41, s39
s_mov_b32 s42, 0x800000
s_mov_b32 s43, 0x20000
v_and_b32 v9, 63, v0
v_lshlrev_b32 v9, 4, v9
s_lshl_b32 s30, s2, 2
s_add_u32 s30, s30, s48
s_lshl_b32 s30, s30, 13
buffer_load_dwordx4 v[64:67], v9, s[40:43], s30 offen offset:0
buffer_load_dwordx4 v[68:71], v9, s[40:43], s30 offen offset:1024
buffer_load_dwordx4 v[72:75], v9, s[40:43], s30 offen offset:2048
buffer_load_dwordx4 v[76:79], v9, s[40:43], s30 offen offset:3072
s_add_u32 s30, s30, 4096
buffer_load_dwordx4 v[80:83], v9, s[40:43], s30 offen offset:0
buffer_load_dwordx4 v[84:87], v9, s[40:43], s30 offen offset:1024
buffer_load_dwordx4 v[88:91], v9, s[40:43], s30 offen offset:2048
buffer_load_dwordx4 v[92:95], v9, s[40:43], s30 offen offset:3072
L_prep_kernel_end:
s_endpgm
L_prep_kernel_codeend:
.section .rodata,"a"
.p2align 6
.amdhsa_kernel prep_kernel
  .amdhsa_next_free_vgpr 176
  .amdhsa_next_free_sgpr 64
  .amdhsa_accum_offset 176
  .amdhsa_group_segment_fixed_size 0
  .amdhsa_kernarg_size 112
  .amdhsa_user_sgpr_count 2
  .amdhsa_user_sgpr_kernarg_segment_ptr 1
  .amdhsa_system_sgpr_workgroup_id_x 1
  .amdhsa_float_denorm_mode_32 3
.end_amdhsa_kernel
.text
.globl attn_kernel
.p2align 8
.type attn_kernel,@function
attn_kernel:
s_cmp_lt_u32 s2, 256
s_cbranch_scc1 L_attn_kernel_go
s_endpgm
L_attn_kernel_go:
s_getpc_b64 s[4:5]
L_attn_kernel_pc:
v_lshrrev_b32 v2, 6, v0
v_and_b32 v3, 63, v0
v_lshlrev_b32 v3, 4, v3
s_lshr_b32 s6, s2, 3
s_lshl_b32 s6, s6, 12
v_lshl_add_u32 v2, v2, 10, v3
v_add_u32 v2, s6, v2
v_min_u32 v3, L_attn_kernel_codeend-L_attn_kernel_pc-16, v2
global_load_dwordx4 v[252:255], v3, s[4:5]
v_add_u32 v2, 0x20000, v2
v_min_u32 v3, L_attn_kernel_codeend-L_attn_kernel_pc-16, v2
global_load_dwordx4 v[252:255], v3, s[4:5]
s_load_dwordx2 s[4:5], s[0:1], 104
s_load_dwordx2 s[6:7], s[0:1], 24
s_load_dwordx2 s[8:9], s[0:1], 8
s_load_dwordx2 s[10:11], s[0:1], 16
s_load_dwordx2 s[48:49], s[0:1], 32
s_load_dwordx2 s[54:55], s[0:1], 48
s_load_dwordx2 s[56:57], s[0:1], 56
s_load_dwordx2 s[58:59], s[0:1], 64
v_lshrrev_b32 v2, 6, v0
v_and_b32 v1, 63, v0
v_readfirstlane_b32 s32, v2
s_and_b32 s37, s2, 7
s_lshl_b32 s37, s37, 2
s_lshr_b32 s38, s2, 6
s_add_u32 s37, s37, s38
s_lshr_b32 s38, s2, 3
s_and_b32 s38, s38, 7
s_lshl_b32 s35, s32, 12
v_lshrrev_b32 v4, 4, v1
v_and_b32 v5, 15, v1
v_lshlrev_b32 v3, 4, v1
v_xor_b32 v6, v4, v5
v_lshlrev_b32 v6, 4, v6
v_lshl_add_u32 v6, v5, 8, v6
v_xor_b32 v8, 0, v6
v_xor_b32 v9, 64, v6
v_xor_b32 v10, 128, v6
v_xor_b32 v11, 192, v6
v_bfe_u32 v6, v1, 2, 2
v_lshl_add_u32 v6, v4, 2, v6
v_and_b32 v7, 7, v6
v_lshlrev_b32 v7, 5, v7
v_lshl_add_u32 v7, v6, 8, v7
v_and_b32 v6, 3, v1
v_lshl_add_u32 v7, v6, 3, v7
v_add_u32 v7, 0x8000, v7
v_xor_b32 v12, 0, v7
v_xor_b32 v13, 32, v7
v_xor_b32 v14, 64, v7
v_xor_b32 v15, 96, v7
v_xor_b32 v16, 128, v7
v_xor_b32 v17, 160, v7
v_xor_b32 v18, 192, v7
v_xor_b32 v19, 224, v7
v_add_u32 v6, 0, v4
v_xor_b32 v7, v5, v6
v_lshlrev_b32 v7, 4, v7
v_lshl_add_u32 v20, v4, 8, v7
v_add_u32 v6, 4, v4
v_xor_b32 v7, v5, v6
v_lshlrev_b32 v7, 4, v7
v_lshl_add_u32 v21, v4, 8, v7
v_add_u32 v6, 8, v4
v_xor_b32 v7, v5, v6
v_lshlrev_b32 v7, 4, v7
v_lshl_add_u32 v22, v4, 8, v7
v_add_u32 v6, 12, v4
v_xor_b32 v7, v5, v6
v_lshlrev_b32 v7, 4, v7
v_lshl_add_u32 v23, v4, 8, v7
v_add_u32 v6, 0, v4
v_lshrrev_b32 v7, 1, v5
v_xor_b32 v7, v7, v6
v_lshlrev_b32 v7, 5, v7
v_and_b32 v6, 1, v5
v_lshl_add_u32 v7, v6, 4, v7
v_lshl_add_u32 v24, v4, 8, v7
v_add_u32 v6, 4, v4
v_lshrrev_b32 v7, 1, v5
v_xor_b32 v7, v7, v6
v_lshlrev_b32 v7, 5, v7
v_and_b32 v6, 1, v5
v_lshl_add_u32 v7, v6, 4, v7
v_lshl_add_u32 v25, v4, 8, v7
v_lshlrev_b32 v6, 8, v4
v_sub_u32 v7, v24, v6
v_add_u32 v6, 0, v4
v_lshl_add_u32 v7, v6, 13, v7
v_subrev_u32 v26, 0, v7
v_lshlrev_b32 v6, 8, v4
v_sub_u32 v7, v25, v6
v_add_u32 v6, 4, v4
v_lshl_add_u32 v7, v6, 13, v7
v_subrev_u32 v27, 1024, v7
v_lshlrev_b32 v6, 8, v4
v_sub_u32 v7, v24, v6
v_add_u32 v6, 8, v4
v_lshl_add_u32 v7, v6, 13, v7
v_subrev_u32 v28, 2048, v7
v_lshlrev_b32 v6, 8, v4
v_sub_u32 v7, v25, v6
v_add_u32 v6, 12, v4
v_lshl_add_u32 v7, v6, 13, v7
v_subrev_u32 v29, 3072, v7
v_mov_b32 v30, v3
v_add_u32 v31, 32768, v3
v_add_u32 v32, 65536, v3
v_add_u32 v33, 98304, v3
s_lshl_b32 s33, s38, 4
s_lshl_b32 s39, s32, 2
s_add_u32 s33, s33, s39
s_lshl_b32 s33, s33, 15
s_lshl_b32 s34, s32, 17
s_lshl_b32 s39, s37, 8
s_add_u32 s34, s34, s39
s_waitcnt lgkmcnt(0)
s_add_u32 s12, s4, 0x100000
s_addc_u32 s13, s5, 0
s_mov_b32 s14, 0x400000
s_mov_b32 s15, 0x20000
s_mov_b32 s16, s6
s_mov_b32 s17, s7
s_mov_b32 s18, 0x800000
s_mov_b32 s19, 0x20000
s_lshl_b32 s39, s37, 19
s_add_u32 s39, s39, s35
s_add_u32 s20, s8, s39
s_addc_u32 s21, s9, 0
s_sub_u32 s22, 0x80000, s35
s_mov_b32 s23, 0x20000
s_add_u32 s24, s10, s39
s_addc_u32 s25, s11, 0
s_mov_b32 s26, s22
s_mov_b32 s27, 0x20000
s_add_u32 s28, s4, 0x1000000
s_addc_u32 s29, s5, 0
s_mov_b32 s30, 0x1000000
s_mov_b32 s31, 0x20000
s_mov_b32 s50, 0x800000
s_mov_b32 s51, 0x20000
s_lshl_b32 s60, s2, 2
s_add_u32 s60, s60, s32
s_lshl_b32 s60, s60, 10
s_mov_b32 s52, s60
s_mov_b32 s53, 0
s_mov_b32 s46, 0xc1200000
s_mov_b32 s43, 0x42c80000
s_mov_b32 s45, 0
s_add_u32 m0, s35, 32768
s_nop 0
buffer_load_dwordx4 v26, s[16:19], s34 offen offset:0 lds
buffer_load_dwordx4 v27, s[16:19], s34 offen offset:1024 lds
buffer_load_dwordx4 v28, s[16:19], s34 offen offset:2048 lds
buffer_load_dwordx4 v29, s[16:19], s34 offen offset:3072 lds
s_add_u32 s34, s34, 524288
buffer_load_dwordx4 a[0:3], v30, s[12:15], s33 offen offset:0
buffer_load_dwordx4 a[4:7], v31, s[12:15], s33 offen offset:0
buffer_load_dwordx4 a[8:11], v32, s[12:15], s33 offen offset:0
buffer_load_dwordx4 a[12:15], v33, s[12:15], s33 offen offset:0
buffer_load_dwordx4 a[16:19], v30, s[12:15], s33 offen offset:1024
buffer_load_dwordx4 a[20:23], v31, s[12:15], s33 offen offset:1024
buffer_load_dwordx4 a[24:27], v32, s[12:15], s33 offen offset:1024
buffer_load_dwordx4 a[28:31], v33, s[12:15], s33 offen offset:1024
s_add_u32 s33, s33, 2048
s_add_u32 m0, s35, 49152
s_nop 0
buffer_load_dwordx4 v26, s[16:19], s34 offen offset:0 lds
buffer_load_dwordx4 v27, s[16:19], s34 offen offset:1024 lds
buffer_load_dwordx4 v28, s[16:19], s34 offen offset:2048 lds
buffer_load_dwordx4 v29, s[16:19], s34 offen offset:3072 lds
s_add_u32 s34, s34, 524288
s_waitcnt vmcnt(12)
s_barrier
ds_read_b64_tr_b16 a[212:213], v12 offset:0
ds_read_b64_tr_b16 a[214:215], v12 offset:4096
ds_read_b64_tr_b16 a[216:217], v12 offset:8192
ds_read_b64_tr_b16 a[218:219], v12 offset:12288
ds_read_b64_tr_b16 a[220:221], v13 offset:0
ds_read_b64_tr_b16 a[222:223], v13 offset:4096
ds_read_b64_tr_b16 a[224:225], v13 offset:8192
ds_read_b64_tr_b16 a[226:227], v13 offset:12288
s_waitcnt vmcnt(4) lgkmcnt(4)
v_mfma_f32_16x16x32_bf16 v[64:67], a[212:215], a[0:3], 0
ds_read_b64_tr_b16 a[228:229], v14 offset:0
v_mfma_f32_16x16x32_bf16 v[64:67], a[216:219], a[16:19], v[64:67]
buffer_load_dwordx4 a[32:35], v30, s[12:15], s33 offen offset:0
v_mfma_f32_16x16x32_bf16 v[68:71], a[212:215], a[4:7], 0
ds_read_b64_tr_b16 a[230:231], v14 offset:4096
v_mfma_f32_16x16x32_bf16 v[68:71], a[216:219], a[20:23], v[68:71]
buffer_load_dwordx4 a[36:39], v31, s[12:15], s33 offen offset:0
v_mfma_f32_16x16x32_bf16 v[72:75], a[212:215], a[8:11], 0
ds_read_b64_tr_b16 a[232:233], v14 offset:8192
v_mfma_f32_16x16x32_bf16 v[72:75], a[216:219], a[24:27], v[72:75]
buffer_load_dwordx4 a[40:43], v32, s[12:15], s33 offen offset:0
v_mfma_f32_16x16x32_bf16 v[76:79], a[212:215], a[12:15], 0
ds_read_b64_tr_b16 a[234:235], v14 offset:12288
v_mfma_f32_16x16x32_bf16 v[76:79], a[216:219], a[28:31], v[76:79]
buffer_load_dwordx4 a[44:47], v33, s[12:15], s33 offen offset:0
s_waitcnt lgkmcnt(4)
v_mfma_f32_16x16x32_bf16 v[80:83], a[220:223], a[0:3], 0
ds_read_b64_tr_b16 a[236:237], v15 offset:0
v_mfma_f32_16x16x32_bf16 v[80:83], a[224:227], a[16:19], v[80:83]
buffer_load_dwordx4 a[48:51], v30, s[12:15], s33 offen offset:1024
v_mfma_f32_16x16x32_bf16 v[84:87], a[220:223], a[4:7], 0
ds_read_b64_tr_b16 a[238:239], v15 offset:4096
v_mfma_f32_16x16x32_bf16 v[84:87], a[224:227], a[20:23], v[84:87]
buffer_load_dwordx4 a[52:55], v31, s[12:15], s33 offen offset:1024
v_mfma_f32_16x16x32_bf16 v[88:91], a[220:223], a[8:11], 0
ds_read_b64_tr_b16 a[240:241], v15 offset:8192
v_mfma_f32_16x16x32_bf16 v[88:91], a[224:227], a[24:27], v[88:91]
buffer_load_dwordx4 a[56:59], v32, s[12:15], s33 offen offset:1024
v_mfma_f32_16x16x32_bf16 v[92:95], a[220:223], a[12:15], 0
ds_read_b64_tr_b16 a[242:243], v15 offset:12288
v_mfma_f32_16x16x32_bf16 v[92:95], a[224:227], a[28:31], v[92:95]
buffer_load_dwordx4 a[60:63], v33, s[12:15], s33 offen offset:1024
s_waitcnt lgkmcnt(4)
v_mfma_f32_16x16x32_bf16 v[96:99], a[228:231], a[0:3], 0
ds_read_b64_tr_b16 a[212:213], v16 offset:0
s_add_u32 s33, s33, 2048
v_mfma_f32_16x16x32_bf16 v[96:99], a[232:235], a[16:19], v[96:99]
buffer_load_dwordx4 a[64:67], v30, s[12:15], s33 offen offset:0
v_mfma_f32_16x16x32_bf16 v[100:103], a[228:231], a[4:7], 0
ds_read_b64_tr_b16 a[214:215], v16 offset:4096
v_mfma_f32_16x16x32_bf16 v[100:103], a[232:235], a[20:23], v[100:103]
buffer_load_dwordx4 a[68:71], v31, s[12:15], s33 offen offset:0
v_mfma_f32_16x16x32_bf16 v[104:107], a[228:231], a[8:11], 0
ds_read_b64_tr_b16 a[216:217], v16 offset:8192
v_mfma_f32_16x16x32_bf16 v[104:107], a[232:235], a[24:27], v[104:107]
buffer_load_dwordx4 a[72:75], v32, s[12:15], s33 offen offset:0
v_mfma_f32_16x16x32_bf16 v[108:111], a[228:231], a[12:15], 0
ds_read_b64_tr_b16 a[218:219], v16 offset:12288
v_mfma_f32_16x16x32_bf16 v[108:111], a[232:235], a[28:31], v[108:111]
buffer_load_dwordx4 a[76:79], v33, s[12:15], s33 offen offset:0
s_waitcnt lgkmcnt(4)
v_mfma_f32_16x16x32_bf16 v[112:115], a[236:239], a[0:3], 0
ds_read_b64_tr_b16 a[220:221], v17 offset:0
v_mfma_f32_16x16x32_bf16 v[112:115], a[240:243], a[16:19], v[112:115]
buffer_load_dwordx4 a[80:83], v30, s[12:15], s33 offen offset:1024
v_mfma_f32_16x16x32_bf16 v[116:119], a[236:239], a[4:7], 0
ds_read_b64_tr_b16 a[222:223], v17 offset:4096
v_mfma_f32_16x16x32_bf16 v[116:119], a[240:243], a[20:23], v[116:119]
buffer_load_dwordx4 a[84:87], v31, s[12:15], s33 offen offset:1024
v_mfma_f32_16x16x32_bf16 v[120:123], a[236:239], a[8:11], 0
ds_read_b64_tr_b16 a[224:225], v17 offset:8192
v_mfma_f32_16x16x32_bf16 v[120:123], a[240:243], a[24:27], v[120:123]
buffer_load_dwordx4 a[88:91], v32, s[12:15], s33 offen offset:1024
v_mfma_f32_16x16x32_bf16 v[124:127], a[236:239], a[12:15], 0
ds_read_b64_tr_b16 a[226:227], v17 offset:12288
v_mfma_f32_16x16x32_bf16 v[124:127], a[240:243], a[28:31], v[124:127]
buffer_load_dwordx4 a[92:95], v33, s[12:15], s33 offen offset:1024
s_waitcnt lgkmcnt(4)
v_mfma_f32_16x16x32_bf16 v[128:131], a[212:215], a[0:3], 0
ds_read_b64_tr_b16 a[228:229], v18 offset:0
s_add_u32 m0, s35, 65536
v_mfma_f32_16x16x32_bf16 v[128:131], a[216:219], a[16:19], v[128:131]
ds_read_b64_tr_b16 a[230:231], v18 offset:4096
s_add_u32 s33, s33, 2048
v_mfma_f32_16x16x32_bf16 v[132:135], a[212:215], a[4:7], 0
buffer_load_dwordx4 v26, s[16:19], s34 offen offset:0 lds
v_mfma_f32_16x16x32_bf16 v[132:135], a[216:219], a[20:23], v[132:135]
ds_read_b64_tr_b16 a[232:233], v18 offset:8192
v_mfma_f32_16x16x32_bf16 v[136:139], a[212:215], a[8:11], 0
buffer_load_dwordx4 v27, s[16:19], s34 offen offset:1024 lds
v_mfma_f32_16x16x32_bf16 v[136:139], a[216:219], a[24:27], v[136:139]
ds_read_b64_tr_b16 a[234:235], v18 offset:12288
v_mfma_f32_16x16x32_bf16 v[140:143], a[212:215], a[12:15], 0
buffer_load_dwordx4 v28, s[16:19], s34 offen offset:2048 lds
v_mfma_f32_16x16x32_bf16 v[140:143], a[216:219], a[28:31], v[140:143]
s_waitcnt lgkmcnt(4)
v_mfma_f32_16x16x32_bf16 v[144:147], a[220:223], a[0:3], 0
buffer_load_dwordx4 v29, s[16:19], s34 offen offset:3072 lds
v_mfma_f32_16x16x32_bf16 v[144:147], a[224:227], a[16:19], v[144:147]
ds_read_b64_tr_b16 a[236:237], v19 offset:0
s_add_u32 s34, s34, 524288
v_mfma_f32_16x16x32_bf16 v[148:151], a[220:223], a[4:7], 0
ds_read_b64_tr_b16 a[238:239], v19 offset:4096
v_mfma_f32_16x16x32_bf16 v[148:151], a[224:227], a[20:23], v[148:151]
ds_read_b64_tr_b16 a[240:241], v19 offset:8192
v_mfma_f32_16x16x32_bf16 v[152:155], a[220:223], a[8:11], 0
buffer_load_dwordx4 a[96:99], v30, s[12:15], s33 offen offset:0
v_mfma_f32_16x16x32_bf16 v[152:155], a[224:227], a[24:27], v[152:155]
ds_read_b64_tr_b16 a[242:243], v19 offset:12288
v_mfma_f32_16x16x32_bf16 v[156:159], a[220:223], a[12:15], 0
s_add_u32 m0, s35, 81920
v_mfma_f32_16x16x32_bf16 v[156:159], a[224:227], a[28:31], v[156:159]
buffer_load_dwordx4 a[100:103], v31, s[12:15], s33 offen offset:0
s_waitcnt vmcnt(22) lgkmcnt(4)
s_barrier
v_mfma_f32_16x16x32_bf16 v[160:163], a[228:231], a[0:3], 0
ds_read_b64_tr_b16 a[212:213], v12 offset:16384
v_mfma_f32_16x16x32_bf16 v[160:163], a[232:235], a[16:19], v[160:163]
buffer_load_dwordx4 a[104:107], v32, s[12:15], s33 offen offset:0
v_mfma_f32_16x16x32_bf16 v[164:167], a[228:231], a[4:7], 0
ds_read_b64_tr_b16 a[214:215], v12 offset:20480
v_mfma_f32_16x16x32_bf16 v[164:167], a[232:235], a[20:23], v[164:167]
buffer_load_dwordx4 a[108:111], v33, s[12:15], s33 offen offset:0
buffer_load_dwordx4 v26, s[16:19], s34 offen offset:0 lds
v_mfma_f32_16x16x32_bf16 v[168:171], a[228:231], a[8:11], 0
ds_read_b64_tr_b16 a[216:217], v12 offset:24576
v_mfma_f32_16x16x32_bf16 v[168:171], a[232:235], a[24:27], v[168:171]
buffer_load_dwordx4 a[112:115], v30, s[12:15], s33 offen offset:1024
v_mfma_f32_16x16x32_bf16 v[172:175], a[228:231], a[12:15], 0
ds_read_b64_tr_b16 a[218:219], v12 offset:28672
v_mfma_f32_16x16x32_bf16 v[172:175], a[232:235], a[28:31], v[172:175]
buffer_load_dwordx4 a[116:119], v31, s[12:15], s33 offen offset:1024
buffer_load_dwordx4 v27, s[16:19], s34 offen offset:1024 lds
s_waitcnt lgkmcnt(4)
v_mfma_f32_16x16x32_bf16 v[176:179], a[236:239], a[0:3], 0
ds_read_b64_tr_b16 a[220:221], v13 offset:16384
v_mfma_f32_16x16x32_bf16 v[176:179], a[240:243], a[16:19], v[176:179]
buffer_load_dwordx4 a[120:123], v32, s[12:15], s33 offen offset:1024
v_mfma_f32_16x16x32_bf16 v[180:183], a[236:239], a[4:7], 0
ds_read_b64_tr_b16 a[222:223], v13 offset:20480
v_mfma_f32_16x16x32_bf16 v[180:183], a[240:243], a[20:23], v[180:183]
buffer_load_dwordx4 a[124:127], v33, s[12:15], s33 offen offset:1024
buffer_load_dwordx4 v28, s[16:19], s34 offen offset:2048 lds
v_mfma_f32_16x16x32_bf16 v[184:187], a[236:239], a[8:11], 0
ds_read_b64_tr_b16 a[224:225], v13 offset:24576
s_add_u32 s33, s33, 2048
v_mfma_f32_16x16x32_bf16 v[184:187], a[240:243], a[24:27], v[184:187]
ds_read_b64_tr_b16 a[226:227], v13 offset:28672
v_mfma_f32_16x16x32_bf16 v[188:191], a[236:239], a[12:15], 0
buffer_load_dwordx4 v29, s[16:19], s34 offen offset:3072 lds
v_mfma_f32_16x16x32_bf16 v[188:191], a[240:243], a[28:31], v[188:191]
s_add_u32 s34, s34, 524288
s_waitcnt vmcnt(24) lgkmcnt(4)
v_mfma_f32_16x16x32_bf16 v[64:67], a[212:215], a[32:35], v[64:67]
ds_read_b64_tr_b16 a[228:229], v14 offset:16384
v_mfma_f32_16x16x32_bf16 v[64:67], a[216:219], a[48:51], v[64:67]
ds_read_b64_tr_b16 a[230:231], v14 offset:20480
v_mfma_f32_16x16x32_bf16 v[68:71], a[212:215], a[36:39], v[68:71]
buffer_load_dwordx4 a[0:3], v30, s[12:15], s33 offen offset:0
v_mfma_f32_16x16x32_bf16 v[68:71], a[216:219], a[52:55], v[68:71]
ds_read_b64_tr_b16 a[232:233], v14 offset:24576
v_mfma_f32_16x16x32_bf16 v[72:75], a[212:215], a[40:43], v[72:75]
ds_read_b64_tr_b16 a[234:235], v14 offset:28672
v_mfma_f32_16x16x32_bf16 v[72:75], a[216:219], a[56:59], v[72:75]
v_mfma_f32_16x16x32_bf16 v[76:79], a[212:215], a[44:47], v[76:79]
v_mfma_f32_16x16x32_bf16 v[76:79], a[216:219], a[60:63], v[76:79]
s_waitcnt lgkmcnt(4)
v_mfma_f32_16x16x32_bf16 v[80:83], a[220:223], a[32:35], v[80:83]
buffer_load_dwordx4 a[4:7], v31, s[12:15], s33 offen offset:0
v_mfma_f32_16x16x32_bf16 v[80:83], a[224:227], a[48:51], v[80:83]
ds_read_b64_tr_b16 a[236:237], v15 offset:16384
v_mfma_f32_16x16x32_bf16 v[84:87], a[220:223], a[36:39], v[84:87]
ds_read_b64_tr_b16 a[238:239], v15 offset:20480
v_mfma_f32_16x16x32_bf16 v[84:87], a[224:227], a[52:55], v[84:87]
ds_read_b64_tr_b16 a[240:241], v15 offset:24576
v_mfma_f32_16x16x32_bf16 v[88:91], a[220:223], a[40:43], v[88:91]
ds_read_b64_tr_b16 a[242:243], v15 offset:28672
v_mfma_f32_16x16x32_bf16 v[88:91], a[224:227], a[56:59], v[88:91]
buffer_load_dwordx4 a[8:11], v32, s[12:15], s33 offen offset:0
v_mfma_f32_16x16x32_bf16 v[92:95], a[220:223], a[44:47], v[92:95]
v_mfma_f32_16x16x32_bf16 v[92:95], a[224:227], a[60:63], v[92:95]
s_waitcnt lgkmcnt(4)
v_mfma_f32_16x16x32_bf16 v[96:99], a[228:231], a[32:35], v[96:99]
ds_read_b64_tr_b16 a[212:213], v16 offset:16384
v_mfma_f32_16x16x32_bf16 v[96:99], a[232:235], a[48:51], v[96:99]
buffer_load_dwordx4 a[12:15], v33, s[12:15], s33 offen offset:0
v_mfma_f32_16x16x32_bf16 v[100:103], a[228:231], a[36:39], v[100:103]
ds_read_b64_tr_b16 a[214:215], v16 offset:20480
v_mfma_f32_16x16x32_bf16 v[100:103], a[232:235], a[52:55], v[100:103]
ds_read_b64_tr_b16 a[216:217], v16 offset:24576
v_mfma_f32_16x16x32_bf16 v[104:107], a[228:231], a[40:43], v[104:107]
ds_read_b64_tr_b16 a[218:219], v16 offset:28672
v_mfma_f32_16x16x32_bf16 v[104:107], a[232:235], a[56:59], v[104:107]
v_mfma_f32_16x16x32_bf16 v[108:111], a[228:231], a[44:47], v[108:111]
buffer_load_dwordx4 a[16:19], v30, s[12:15], s33 offen offset:1024
v_mfma_f32_16x16x32_bf16 v[108:111], a[232:235], a[60:63], v[108:111]
s_waitcnt lgkmcnt(4)
v_mfma_f32_16x16x32_bf16 v[112:115], a[236:239], a[32:35], v[112:115]
ds_read_b64_tr_b16 a[220:221], v17 offset:16384
v_mfma_f32_16x16x32_bf16 v[112:115], a[240:243], a[48:51], v[112:115]
ds_read_b64_tr_b16 a[222:223], v17 offset:20480
v_mfma_f32_16x16x32_bf16 v[116:119], a[236:239], a[36:39], v[116:119]
ds_read_b64_tr_b16 a[224:225], v17 offset:24576
v_mfma_f32_16x16x32_bf16 v[116:119], a[240:243], a[52:55], v[116:119]
buffer_load_dwordx4 a[20:23], v31, s[12:15], s33 offen offset:1024
v_mfma_f32_16x16x32_bf16 v[120:123], a[236:239], a[40:43], v[120:123]
ds_read_b64_tr_b16 a[226:227], v17 offset:28672
v_mfma_f32_16x16x32_bf16 v[120:123], a[240:243], a[56:59], v[120:123]
v_mfma_f32_16x16x32_bf16 v[124:127], a[236:239], a[44:47], v[124:127]
v_mfma_f32_16x16x32_bf16 v[124:127], a[240:243], a[60:63], v[124:127]
s_waitcnt lgkmcnt(4)
v_mfma_f32_16x16x32_bf16 v[128:131], a[212:215], a[32:35], v[128:131]
buffer_load_dwordx4 a[24:27], v32, s[12:15], s33 offen offset:1024
v_mfma_f32_16x16x32_bf16 v[128:131], a[216:219], a[48:51], v[128:131]
ds_read_b64_tr_b16 a[228:229], v18 offset:16384
v_mfma_f32_16x16x32_bf16 v[132:135], a[212:215], a[36:39], v[132:135]
ds_read_b64_tr_b16 a[230:231], v18 offset:20480
v_mfma_f32_16x16x32_bf16 v[132:135], a[216:219], a[52:55], v[132:135]
ds_read_b64_tr_b16 a[232:233], v18 offset:24576
v_mfma_f32_16x16x32_bf16 v[136:139], a[212:215], a[40:43], v[136:139]
ds_read_b64_tr_b16 a[234:235], v18 offset:28672
v_mfma_f32_16x16x32_bf16 v[136:139], a[216:219], a[56:59], v[136:139]
buffer_load_dwordx4 a[28:31], v33, s[12:15], s33 offen offset:1024
v_mfma_f32_16x16x32_bf16 v[140:143], a[212:215], a[44:47], v[140:143]
s_add_u32 s33, s33, 2048
v_mfma_f32_16x16x32_bf16 v[140:143], a[216:219], a[60:63], v[140:143]
s_waitcnt lgkmcnt(4)
v_mfma_f32_16x16x32_bf16 v[144:147], a[220:223], a[32:35], v[144:147]
ds_read_b64_tr_b16 a[236:237], v19 offset:16384
v_mfma_f32_16x16x32_bf16 v[144:147], a[224:227], a[48:51], v[144:147]
ds_read_b64_tr_b16 a[238:239], v19 offset:20480
v_mfma_f32_16x16x32_bf16 v[148:151], a[220:223], a[36:39], v[148:151]
ds_read_b64_tr_b16 a[240:241], v19 offset:24576
v_mfma_f32_16x16x32_bf16 v[148:151], a[224:227], a[52:55], v[148:151]
ds_read_b64_tr_b16 a[242:243], v19 offset:28672
v_mfma_f32_16x16x32_bf16 v[152:155], a[220:223], a[40:43], v[152:155]
v_mfma_f32_16x16x32_bf16 v[152:155], a[224:227], a[56:59], v[152:155]
v_mfma_f32_16x16x32_bf16 v[156:159], a[220:223], a[44:47], v[156:159]
s_add_u32 m0, s35, 32768
v_mfma_f32_16x16x32_bf16 v[156:159], a[224:227], a[60:63], v[156:159]
s_waitcnt vmcnt(20) lgkmcnt(4)
s_barrier
v_mfma_f32_16x16x32_bf16 v[160:163], a[228:231], a[32:35], v[160:163]
ds_read_b64_tr_b16 a[212:213], v12 offset:32768
v_mfma_f32_16x16x32_bf16 v[160:163], a[232:235], a[48:51], v[160:163]
buffer_load_dwordx4 v26, s[16:19], s34 offen offset:0 lds
v_mfma_f32_16x16x32_bf16 v[164:167], a[228:231], a[36:39], v[164:167]
ds_read_b64_tr_b16 a[214:215], v12 offset:36864
v_mfma_f32_16x16x32_bf16 v[164:167], a[232:235], a[52:55], v[164:167]
ds_read_b64_tr_b16 a[216:217], v12 offset:40960
v_mfma_f32_16x16x32_bf16 v[168:171], a[228:231], a[40:43], v[168:171]
ds_read_b64_tr_b16 a[218:219], v12 offset:45056
v_mfma_f32_16x16x32_bf16 v[168:171], a[232:235], a[56:59], v[168:171]
buffer_load_dwordx4 v27, s[16:19], s34 offen offset:1024 lds
v_mfma_f32_16x16x32_bf16 v[172:175], a[228:231], a[44:47], v[172:175]
v_mfma_f32_16x16x32_bf16 v[172:175], a[232:235], a[60:63], v[172:175]
s_waitcnt lgkmcnt(4)
v_mfma_f32_16x16x32_bf16 v[176:179], a[236:239], a[32:35], v[176:179]
ds_read_b64_tr_b16 a[220:221], v13 offset:32768
v_mfma_f32_16x16x32_bf16 v[176:179], a[240:243], a[48:51], v[176:179]
buffer_load_dwordx4 v28, s[16:19], s34 offen offset:2048 lds
v_mfma_f32_16x16x32_bf16 v[180:183], a[236:239], a[36:39], v[180:183]
ds_read_b64_tr_b16 a[222:223], v13 offset:36864
v_mfma_f32_16x16x32_bf16 v[180:183], a[240:243], a[52:55], v[180:183]
ds_read_b64_tr_b16 a[224:225], v13 offset:40960
v_mfma_f32_16x16x32_bf16 v[184:187], a[236:239], a[40:43], v[184:187]
ds_read_b64_tr_b16 a[226:227], v13 offset:45056
v_mfma_f32_16x16x32_bf16 v[184:187], a[240:243], a[56:59], v[184:187]
buffer_load_dwordx4 v29, s[16:19], s34 offen offset:3072 lds
v_mfma_f32_16x16x32_bf16 v[188:191], a[236:239], a[44:47], v[188:191]
s_add_u32 s34, s34, 524288
v_mfma_f32_16x16x32_bf16 v[188:191], a[240:243], a[60:63], v[188:191]
s_waitcnt vmcnt(28) lgkmcnt(4)
v_mfma_f32_16x16x32_bf16 v[64:67], a[212:215], a[64:67], v[64:67]
ds_read_b64_tr_b16 a[228:229], v14 offset:32768
v_mfma_f32_16x16x32_bf16 v[64:67], a[216:219], a[80:83], v[64:67]
ds_read_b64_tr_b16 a[230:231], v14 offset:36864
v_mfma_f32_16x16x32_bf16 v[68:71], a[212:215], a[68:71], v[68:71]
buffer_load_dwordx4 a[32:35], v30, s[12:15], s33 offen offset:0
v_mfma_f32_16x16x32_bf16 v[68:71], a[216:219], a[84:87], v[68:71]
ds_read_b64_tr_b16 a[232:233], v14 offset:40960
v_mfma_f32_16x16x32_bf16 v[72:75], a[212:215], a[72:75], v[72:75]
ds_read_b64_tr_b16 a[234:235], v14 offset:45056
v_mfma_f32_16x16x32_bf16 v[72:75], a[216:219], a[88:91], v[72:75]
v_mfma_f32_16x16x32_bf16 v[76:79], a[212:215], a[76:79], v[76:79]
v_mfma_f32_16x16x32_bf16 v[76:79], a[216:219], a[92:95], v[76:79]
s_waitcnt lgkmcnt(4)
v_mfma_f32_16x16x32_bf16 v[80:83], a[220:223], a[64:67], v[80:83]
buffer_load_dwordx4 a[36:39], v31, s[12:15], s33 offen offset:0
v_mfma_f32_16x16x32_bf16 v[80:83], a[224:227], a[80:83], v[80:83]
ds_read_b64_tr_b16 a[236:237], v15 offset:32768
v_mfma_f32_16x16x32_bf16 v[84:87], a[220:223], a[68:71], v[84:87]
ds_read_b64_tr_b16 a[238:239], v15 offset:36864
v_mfma_f32_16x16x32_bf16 v[84:87], a[224:227], a[84:87], v[84:87]
ds_read_b64_tr_b16 a[240:241], v15 offset:40960
v_mfma_f32_16x16x32_bf16 v[88:91], a[220:223], a[72:75], v[88:91]
ds_read_b64_tr_b16 a[242:243], v15 offset:45056
v_mfma_f32_16x16x32_bf16 v[88:91], a[224:227], a[88:91], v[88:91]
buffer_load_dwordx4 a[40:43], v32, s[12:15], s33 offen offset:0
v_mfma_f32_16x16x32_bf16 v[92:95], a[220:223], a[76:79], v[92:95]
v_mfma_f32_16x16x32_bf16 v[92:95], a[224:227], a[92:95], v[92:95]
s_waitcnt lgkmcnt(4)
v_mfma_f32_16x16x32_bf16 v[96:99], a[228:231], a[64:67], v[96:99]
ds_read_b64_tr_b16 a[212:213], v16 offset:32768
v_mfma_f32_16x16x32_bf16 v[96:99], a[232:235], a[80:83], v[96:99]
buffer_load_dwordx4 a[44:47], v33, s[12:15], s33 offen offset:0
v_mfma_f32_16x16x32_bf16 v[100:103], a[228:231], a[68:71], v[100:103]
ds_read_b64_tr_b16 a[214:215], v16 offset:36864
v_mfma_f32_16x16x32_bf16 v[100:103], a[232:235], a[84:87], v[100:103]
ds_read_b64_tr_b16 a[216:217], v16 offset:40960
v_mfma_f32_16x16x32_bf16 v[104:107], a[228:231], a[72:75], v[104:107]
ds_read_b64_tr_b16 a[218:219], v16 offset:45056
v_mfma_f32_16x16x32_bf16 v[104:107], a[232:235], a[88:91], v[104:107]
v_mfma_f32_16x16x32_bf16 v[108:111], a[228:231], a[76:79], v[108:111]
buffer_load_dwordx4 a[48:51], v30, s[12:15], s33 offen offset:1024
v_mfma_f32_16x16x32_bf16 v[108:111], a[232:235], a[92:95], v[108:111]
s_waitcnt lgkmcnt(4)
v_mfma_f32_16x16x32_bf16 v[112:115], a[236:239], a[64:67], v[112:115]
ds_read_b64_tr_b16 a[220:221], v17 offset:32768
v_mfma_f32_16x16x32_bf16 v[112:115], a[240:243], a[80:83], v[112:115]
ds_read_b64_tr_b16 a[222:223], v17 offset:36864
v_mfma_f32_16x16x32_bf16 v[116:119], a[236:239], a[68:71], v[116:119]
ds_read_b64_tr_b16 a[224:225], v17 offset:40960
v_mfma_f32_16x16x32_bf16 v[116:119], a[240:243], a[84:87], v[116:119]
buffer_load_dwordx4 a[52:55], v31, s[12:15], s33 offen offset:1024
v_mfma_f32_16x16x32_bf16 v[120:123], a[236:239], a[72:75], v[120:123]
ds_read_b64_tr_b16 a[226:227], v17 offset:45056
v_mfma_f32_16x16x32_bf16 v[120:123], a[240:243], a[88:91], v[120:123]
v_mfma_f32_16x16x32_bf16 v[124:127], a[236:239], a[76:79], v[124:127]
v_mfma_f32_16x16x32_bf16 v[124:127], a[240:243], a[92:95], v[124:127]
s_waitcnt lgkmcnt(4)
v_mfma_f32_16x16x32_bf16 v[128:131], a[212:215], a[64:67], v[128:131]
buffer_load_dwordx4 a[56:59], v32, s[12:15], s33 offen offset:1024
v_mfma_f32_16x16x32_bf16 v[128:131], a[216:219], a[80:83], v[128:131]
ds_read_b64_tr_b16 a[228:229], v18 offset:32768
v_mfma_f32_16x16x32_bf16 v[132:135], a[212:215], a[68:71], v[132:135]
ds_read_b64_tr_b16 a[230:231], v18 offset:36864
v_mfma_f32_16x16x32_bf16 v[132:135], a[216:219], a[84:87], v[132:135]
ds_read_b64_tr_b16 a[232:233], v18 offset:40960
v_mfma_f32_16x16x32_bf16 v[136:139], a[212:215], a[72:75], v[136:139]
ds_read_b64_tr_b16 a[234:235], v18 offset:45056
v_mfma_f32_16x16x32_bf16 v[136:139], a[216:219], a[88:91], v[136:139]
buffer_load_dwordx4 a[60:63], v33, s[12:15], s33 offen offset:1024
v_mfma_f32_16x16x32_bf16 v[140:143], a[212:215], a[76:79], v[140:143]
s_add_u32 s33, s33, 2048
v_mfma_f32_16x16x32_bf16 v[140:143], a[216:219], a[92:95], v[140:143]
s_waitcnt lgkmcnt(4)
v_mfma_f32_16x16x32_bf16 v[144:147], a[220:223], a[64:67], v[144:147]
ds_read_b64_tr_b16 a[236:237], v19 offset:32768
v_mfma_f32_16x16x32_bf16 v[144:147], a[224:227], a[80:83], v[144:147]
ds_read_b64_tr_b16 a[238:239], v19 offset:36864
v_mfma_f32_16x16x32_bf16 v[148:151], a[220:223], a[68:71], v[148:151]
ds_read_b64_tr_b16 a[240:241], v19 offset:40960
v_mfma_f32_16x16x32_bf16 v[148:151], a[224:227], a[84:87], v[148:151]
ds_read_b64_tr_b16 a[242:243], v19 offset:45056
v_mfma_f32_16x16x32_bf16 v[152:155], a[220:223], a[72:75], v[152:155]
v_mfma_f32_16x16x32_bf16 v[152:155], a[224:227], a[88:91], v[152:155]
v_mfma_f32_16x16x32_bf16 v[156:159], a[220:223], a[76:79], v[156:159]
s_add_u32 m0, s35, 49152
v_mfma_f32_16x16x32_bf16 v[156:159], a[224:227], a[92:95], v[156:159]
s_waitcnt vmcnt(20) lgkmcnt(4)
s_barrier
v_mfma_f32_16x16x32_bf16 v[160:163], a[228:231], a[64:67], v[160:163]
ds_read_b64_tr_b16 a[212:213], v12 offset:49152
v_mfma_f32_16x16x32_bf16 v[160:163], a[232:235], a[80:83], v[160:163]
buffer_load_dwordx4 v26, s[16:19], s34 offen offset:0 lds
v_mfma_f32_16x16x32_bf16 v[164:167], a[228:231], a[68:71], v[164:167]
ds_read_b64_tr_b16 a[214:215], v12 offset:53248
v_mfma_f32_16x16x32_bf16 v[164:167], a[232:235], a[84:87], v[164:167]
ds_read_b64_tr_b16 a[216:217], v12 offset:57344
v_mfma_f32_16x16x32_bf16 v[168:171], a[228:231], a[72:75], v[168:171]
ds_read_b64_tr_b16 a[218:219], v12 offset:61440
v_mfma_f32_16x16x32_bf16 v[168:171], a[232:235], a[88:91], v[168:171]
buffer_load_dwordx4 v27, s[16:19], s34 offen offset:1024 lds
v_mfma_f32_16x16x32_bf16 v[172:175], a[228:231], a[76:79], v[172:175]
v_mfma_f32_16x16x32_bf16 v[172:175], a[232:235], a[92:95], v[172:175]
s_waitcnt lgkmcnt(4)
v_mfma_f32_16x16x32_bf16 v[176:179], a[236:239], a[64:67], v[176:179]
ds_read_b64_tr_b16 a[220:221], v13 offset:49152
v_mfma_f32_16x16x32_bf16 v[176:179], a[240:243], a[80:83], v[176:179]
buffer_load_dwordx4 v28, s[16:19], s34 offen offset:2048 lds
v_mfma_f32_16x16x32_bf16 v[180:183], a[236:239], a[68:71], v[180:183]
ds_read_b64_tr_b16 a[222:223], v13 offset:53248
v_mfma_f32_16x16x32_bf16 v[180:183], a[240:243], a[84:87], v[180:183]
ds_read_b64_tr_b16 a[224:225], v13 offset:57344
v_mfma_f32_16x16x32_bf16 v[184:187], a[236:239], a[72:75], v[184:187]
ds_read_b64_tr_b16 a[226:227], v13 offset:61440
v_mfma_f32_16x16x32_bf16 v[184:187], a[240:243], a[88:91], v[184:187]
buffer_load_dwordx4 v29, s[16:19], s34 offen offset:3072 lds
v_mfma_f32_16x16x32_bf16 v[188:191], a[236:239], a[76:79], v[188:191]
s_add_u32 s34, s34, 524288
v_mfma_f32_16x16x32_bf16 v[188:191], a[240:243], a[92:95], v[188:191]
s_waitcnt vmcnt(26) lgkmcnt(4)
v_mfma_f32_16x16x32_bf16 v[64:67], a[212:215], a[96:99], v[64:67]
ds_read_b64_tr_b16 a[228:229], v14 offset:49152
v_mfma_f32_16x16x32_bf16 v[64:67], a[216:219], a[112:115], v[64:67]
ds_read_b64_tr_b16 a[230:231], v14 offset:53248
v_mfma_f32_16x16x32_bf16 v[68:71], a[212:215], a[100:103], v[68:71]
buffer_load_dwordx4 a[64:67], v30, s[12:15], s33 offen offset:0
v_mfma_f32_16x16x32_bf16 v[68:71], a[216:219], a[116:119], v[68:71]
ds_read_b64_tr_b16 a[232:233], v14 offset:57344
v_mfma_f32_16x16x32_bf16 v[72:75], a[212:215], a[104:107], v[72:75]
ds_read_b64_tr_b16 a[234:235], v14 offset:61440
v_mfma_f32_16x16x32_bf16 v[72:75], a[216:219], a[120:123], v[72:75]
v_mfma_f32_16x16x32_bf16 v[76:79], a[212:215], a[108:111], v[76:79]
v_mfma_f32_16x16x32_bf16 v[76:79], a[216:219], a[124:127], v[76:79]
s_waitcnt lgkmcnt(4)
v_mfma_f32_16x16x32_bf16 v[80:83], a[220:223], a[96:99], v[80:83]
buffer_load_dwordx4 a[68:71], v31, s[12:15], s33 offen offset:0
v_mfma_f32_16x16x32_bf16 v[80:83], a[224:227], a[112:115], v[80:83]
ds_read_b64_tr_b16 a[236:237], v15 offset:49152
v_mfma_f32_16x16x32_bf16 v[84:87], a[220:223], a[100:103], v[84:87]
ds_read_b64_tr_b16 a[238:239], v15 offset:53248
v_mfma_f32_16x16x32_bf16 v[84:87], a[224:227], a[116:119], v[84:87]
ds_read_b64_tr_b16 a[240:241], v15 offset:57344
v_mfma_f32_16x16x32_bf16 v[88:91], a[220:223], a[104:107], v[88:91]
ds_read_b64_tr_b16 a[242:243], v15 offset:61440
v_mfma_f32_16x16x32_bf16 v[88:91], a[224:227], a[120:123], v[88:91]
buffer_load_dwordx4 a[72:75], v32, s[12:15], s33 offen offset:0
v_mfma_f32_16x16x32_bf16 v[92:95], a[220:223], a[108:111], v[92:95]
v_mfma_f32_16x16x32_bf16 v[92:95], a[224:227], a[124:127], v[92:95]
s_waitcnt lgkmcnt(4)
v_mfma_f32_16x16x32_bf16 v[96:99], a[228:231], a[96:99], v[96:99]
ds_read_b64_tr_b16 a[212:213], v16 offset:49152
v_mfma_f32_16x16x32_bf16 v[96:99], a[232:235], a[112:115], v[96:99]
buffer_load_dwordx4 a[76:79], v33, s[12:15], s33 offen offset:0
v_mfma_f32_16x16x32_bf16 v[100:103], a[228:231], a[100:103], v[100:103]
ds_read_b64_tr_b16 a[214:215], v16 offset:53248
v_mfma_f32_16x16x32_bf16 v[100:103], a[232:235], a[116:119], v[100:103]
ds_read_b64_tr_b16 a[216:217], v16 offset:57344
v_mfma_f32_16x16x32_bf16 v[104:107], a[228:231], a[104:107], v[104:107]
ds_read_b64_tr_b16 a[218:219], v16 offset:61440
v_mfma_f32_16x16x32_bf16 v[104:107], a[232:235], a[120:123], v[104:107]
v_mfma_f32_16x16x32_bf16 v[108:111], a[228:231], a[108:111], v[108:111]
buffer_load_dwordx4 a[80:83], v30, s[12:15], s33 offen offset:1024
v_mfma_f32_16x16x32_bf16 v[108:111], a[232:235], a[124:127], v[108:111]
s_waitcnt lgkmcnt(4)
v_mfma_f32_16x16x32_bf16 v[112:115], a[236:239], a[96:99], v[112:115]
ds_read_b64_tr_b16 a[220:221], v17 offset:49152
v_mfma_f32_16x16x32_bf16 v[112:115], a[240:243], a[112:115], v[112:115]
ds_read_b64_tr_b16 a[222:223], v17 offset:53248
v_mfma_f32_16x16x32_bf16 v[116:119], a[236:239], a[100:103], v[116:119]
ds_read_b64_tr_b16 a[224:225], v17 offset:57344
v_mfma_f32_16x16x32_bf16 v[116:119], a[240:243], a[116:119], v[116:119]
buffer_load_dwordx4 a[84:87], v31, s[12:15], s33 offen offset:1024
v_mfma_f32_16x16x32_bf16 v[120:123], a[236:239], a[104:107], v[120:123]
ds_read_b64_tr_b16 a[226:227], v17 offset:61440
v_mfma_f32_16x16x32_bf16 v[120:123], a[240:243], a[120:123], v[120:123]
v_mfma_f32_16x16x32_bf16 v[124:127], a[236:239], a[108:111], v[124:127]
v_mfma_f32_16x16x32_bf16 v[124:127], a[240:243], a[124:127], v[124:127]
s_waitcnt lgkmcnt(4)
v_mfma_f32_16x16x32_bf16 v[128:131], a[212:215], a[96:99], v[128:131]
buffer_load_dwordx4 a[88:91], v32, s[12:15], s33 offen offset:1024
v_mfma_f32_16x16x32_bf16 v[128:131], a[216:219], a[112:115], v[128:131]
ds_read_b64_tr_b16 a[228:229], v18 offset:49152
v_mfma_f32_16x16x32_bf16 v[132:135], a[212:215], a[100:103], v[132:135]
ds_read_b64_tr_b16 a[230:231], v18 offset:53248
v_mfma_f32_16x16x32_bf16 v[132:135], a[216:219], a[116:119], v[132:135]
ds_read_b64_tr_b16 a[232:233], v18 offset:57344
v_mfma_f32_16x16x32_bf16 v[136:139], a[212:215], a[104:107], v[136:139]
ds_read_b64_tr_b16 a[234:235], v18 offset:61440
v_mfma_f32_16x16x32_bf16 v[136:139], a[216:219], a[120:123], v[136:139]
buffer_load_dwordx4 a[92:95], v33, s[12:15], s33 offen offset:1024
v_mfma_f32_16x16x32_bf16 v[140:143], a[212:215], a[108:111], v[140:143]
s_add_u32 s33, s33, 2048
v_mfma_f32_16x16x32_bf16 v[140:143], a[216:219], a[124:127], v[140:143]
s_waitcnt lgkmcnt(4)
v_mfma_f32_16x16x32_bf16 v[144:147], a[220:223], a[96:99], v[144:147]
ds_read_b64_tr_b16 a[236:237], v19 offset:49152
v_mfma_f32_16x16x32_bf16 v[144:147], a[224:227], a[112:115], v[144:147]
ds_read_b64_tr_b16 a[238:239], v19 offset:53248
v_mfma_f32_16x16x32_bf16 v[148:151], a[220:223], a[100:103], v[148:151]
ds_read_b64_tr_b16 a[240:241], v19 offset:57344
v_mfma_f32_16x16x32_bf16 v[148:151], a[224:227], a[116:119], v[148:151]
ds_read_b64_tr_b16 a[242:243], v19 offset:61440
v_mfma_f32_16x16x32_bf16 v[152:155], a[220:223], a[104:107], v[152:155]
v_mfma_f32_16x16x32_bf16 v[152:155], a[224:227], a[120:123], v[152:155]
v_mfma_f32_16x16x32_bf16 v[156:159], a[220:223], a[108:111], v[156:159]
s_add_u32 m0, s35, 65536
v_mfma_f32_16x16x32_bf16 v[156:159], a[224:227], a[124:127], v[156:159]
s_waitcnt vmcnt(20) lgkmcnt(4)
s_barrier
v_mfma_f32_16x16x32_bf16 v[160:163], a[228:231], a[96:99], v[160:163]
ds_read_b64_tr_b16 a[212:213], v12 offset:0
v_mfma_f32_16x16x32_bf16 v[160:163], a[232:235], a[112:115], v[160:163]
buffer_load_dwordx4 v26, s[16:19], s34 offen offset:0 lds
v_mfma_f32_16x16x32_bf16 v[164:167], a[228:231], a[100:103], v[164:167]
ds_read_b64_tr_b16 a[214:215], v12 offset:4096
v_mfma_f32_16x16x32_bf16 v[164:167], a[232:235], a[116:119], v[164:167]
ds_read_b64_tr_b16 a[216:217], v12 offset:8192
v_mfma_f32_16x16x32_bf16 v[168:171], a[228:231], a[104:107], v[168:171]
ds_read_b64_tr_b16 a[218:219], v12 offset:12288
v_mfma_f32_16x16x32_bf16 v[168:171], a[232:235], a[120:123], v[168:171]
buffer_load_dwordx4 v27, s[16:19], s34 offen offset:1024 lds
v_mfma_f32_16x16x32_bf16 v[172:175], a[228:231], a[108:111], v[172:175]
v_mfma_f32_16x16x32_bf16 v[172:175], a[232:235], a[124:127], v[172:175]
s_waitcnt lgkmcnt(4)
v_mfma_f32_16x16x32_bf16 v[176:179], a[236:239], a[96:99], v[176:179]
ds_read_b64_tr_b16 a[220:221], v13 offset:0
v_mfma_f32_16x16x32_bf16 v[176:179], a[240:243], a[112:115], v[176:179]
buffer_load_dwordx4 v28, s[16:19], s34 offen offset:2048 lds
v_mfma_f32_16x16x32_bf16 v[180:183], a[236:239], a[100:103], v[180:183]
ds_read_b64_tr_b16 a[222:223], v13 offset:4096
v_mfma_f32_16x16x32_bf16 v[180:183], a[240:243], a[116:119], v[180:183]
ds_read_b64_tr_b16 a[224:225], v13 offset:8192
v_mfma_f32_16x16x32_bf16 v[184:187], a[236:239], a[104:107], v[184:187]
ds_read_b64_tr_b16 a[226:227], v13 offset:12288
v_mfma_f32_16x16x32_bf16 v[184:187], a[240:243], a[120:123], v[184:187]
buffer_load_dwordx4 v29, s[16:19], s34 offen offset:3072 lds
v_mfma_f32_16x16x32_bf16 v[188:191], a[236:239], a[108:111], v[188:191]
s_add_u32 s34, s34, 524288
v_mfma_f32_16x16x32_bf16 v[188:191], a[240:243], a[124:127], v[188:191]
s_mov_b32 s36, 2
L_attn_kernel_qloop:
s_waitcnt vmcnt(28) lgkmcnt(4)
v_mfma_f32_16x16x32_bf16 v[64:67], a[212:215], a[0:3], v[64:67]
ds_read_b64_tr_b16 a[228:229], v14 offset:0
v_mfma_f32_16x16x32_bf16 v[64:67], a[216:219], a[16:19], v[64:67]
ds_read_b64_tr_b16 a[230:231], v14 offset:4096
v_mfma_f32_16x16x32_bf16 v[68:71], a[212:215], a[4:7], v[68:71]
buffer_load_dwordx4 a[96:99], v30, s[12:15], s33 offen offset:0
v_mfma_f32_16x16x32_bf16 v[68:71], a[216:219], a[20:23], v[68:71]
ds_read_b64_tr_b16 a[232:233], v14 offset:8192
v_mfma_f32_16x16x32_bf16 v[72:75], a[212:215], a[8:11], v[72:75]
ds_read_b64_tr_b16 a[234:235], v14 offset:12288
v_mfma_f32_16x16x32_bf16 v[72:75], a[216:219], a[24:27], v[72:75]
v_mfma_f32_16x16x32_bf16 v[76:79], a[212:215], a[12:15], v[76:79]
v_mfma_f32_16x16x32_bf16 v[76:79], a[216:219], a[28:31], v[76:79]
s_waitcnt lgkmcnt(4)
v_mfma_f32_16x16x32_bf16 v[80:83], a[220:223], a[0:3], v[80:83]
buffer_load_dwordx4 a[100:103], v31, s[12:15], s33 offen offset:0
v_mfma_f32_16x16x32_bf16 v[80:83], a[224:227], a[16:19], v[80:83]
ds_read_b64_tr_b16 a[236:237], v15 offset:0
v_mfma_f32_16x16x32_bf16 v[84:87], a[220:223], a[4:7], v[84:87]
ds_read_b64_tr_b16 a[238:239], v15 offset:4096
v_mfma_f32_16x16x32_bf16 v[84:87], a[224:227], a[20:23], v[84:87]
ds_read_b64_tr_b16 a[240:241], v15 offset:8192
v_mfma_f32_16x16x32_bf16 v[88:91], a[220:223], a[8:11], v[88:91]
ds_read_b64_tr_b16 a[242:243], v15 offset:12288
v_mfma_f32_16x16x32_bf16 v[88:91], a[224:227], a[24:27], v[88:91]
buffer_load_dwordx4 a[104:107], v32, s[12:15], s33 offen offset:0
v_mfma_f32_16x16x32_bf16 v[92:95], a[220:223], a[12:15], v[92:95]
v_mfma_f32_16x16x32_bf16 v[92:95], a[224:227], a[28:31], v[92:95]
s_waitcnt lgkmcnt(4)
v_mfma_f32_16x16x32_bf16 v[96:99], a[228:231], a[0:3], v[96:99]
ds_read_b64_tr_b16 a[212:213], v16 offset:0
v_mfma_f32_16x16x32_bf16 v[96:99], a[232:235], a[16:19], v[96:99]
buffer_load_dwordx4 a[108:111], v33, s[12:15], s33 offen offset:0
v_mfma_f32_16x16x32_bf16 v[100:103], a[228:231], a[4:7], v[100:103]
ds_read_b64_tr_b16 a[214:215], v16 offset:4096
v_mfma_f32_16x16x32_bf16 v[100:103], a[232:235], a[20:23], v[100:103]
ds_read_b64_tr_b16 a[216:217], v16 offset:8192
v_mfma_f32_16x16x32_bf16 v[104:107], a[228:231], a[8:11], v[104:107]
ds_read_b64_tr_b16 a[218:219], v16 offset:12288
v_mfma_f32_16x16x32_bf16 v[104:107], a[232:235], a[24:27], v[104:107]
v_mfma_f32_16x16x32_bf16 v[108:111], a[228:231], a[12:15], v[108:111]
buffer_load_dwordx4 a[112:115], v30, s[12:15], s33 offen offset:1024
v_mfma_f32_16x16x32_bf16 v[108:111], a[232:235], a[28:31], v[108:111]
s_waitcnt lgkmcnt(4)
v_mfma_f32_16x16x32_bf16 v[112:115], a[236:239], a[0:3], v[112:115]
ds_read_b64_tr_b16 a[220:221], v17 offset:0
v_mfma_f32_16x16x32_bf16 v[112:115], a[240:243], a[16:19], v[112:115]
ds_read_b64_tr_b16 a[222:223], v17 offset:4096
v_mfma_f32_16x16x32_bf16 v[116:119], a[236:239], a[4:7], v[116:119]
ds_read_b64_tr_b16 a[224:225], v17 offset:8192
v_mfma_f32_16x16x32_bf16 v[116:119], a[240:243], a[20:23], v[116:119]
buffer_load_dwordx4 a[116:119], v31, s[12:15], s33 offen offset:1024
v_mfma_f32_16x16x32_bf16 v[120:123], a[236:239], a[8:11], v[120:123]
ds_read_b64_tr_b16 a[226:227], v17 offset:12288
v_mfma_f32_16x16x32_bf16 v[120:123], a[240:243], a[24:27], v[120:123]
v_mfma_f32_16x16x32_bf16 v[124:127], a[236:239], a[12:15], v[124:127]
v_mfma_f32_16x16x32_bf16 v[124:127], a[240:243], a[28:31], v[124:127]
s_waitcnt lgkmcnt(4)
v_mfma_f32_16x16x32_bf16 v[128:131], a[212:215], a[0:3], v[128:131]
buffer_load_dwordx4 a[120:123], v32, s[12:15], s33 offen offset:1024
v_mfma_f32_16x16x32_bf16 v[128:131], a[216:219], a[16:19], v[128:131]
ds_read_b64_tr_b16 a[228:229], v18 offset:0
v_mfma_f32_16x16x32_bf16 v[132:135], a[212:215], a[4:7], v[132:135]
ds_read_b64_tr_b16 a[230:231], v18 offset:4096
v_mfma_f32_16x16x32_bf16 v[132:135], a[216:219], a[20:23], v[132:135]
ds_read_b64_tr_b16 a[232:233], v18 offset:8192
v_mfma_f32_16x16x32_bf16 v[136:139], a[212:215], a[8:11], v[136:139]
ds_read_b64_tr_b16 a[234:235], v18 offset:12288
v_mfma_f32_16x16x32_bf16 v[136:139], a[216:219], a[24:27], v[136:139]
buffer_load_dwordx4 a[124:127], v33, s[12:15], s33 offen offset:1024
v_mfma_f32_16x16x32_bf16 v[140:143], a[212:215], a[12:15], v[140:143]
s_add_u32 s33, s33, 2048
v_mfma_f32_16x16x32_bf16 v[140:143], a[216:219], a[28:31], v[140:143]
s_waitcnt lgkmcnt(4)
v_mfma_f32_16x16x32_bf16 v[144:147], a[220:223], a[0:3], v[144:147]
ds_read_b64_tr_b16 a[236:237], v19 offset:0
v_mfma_f32_16x16x32_bf16 v[144:147], a[224:227], a[16:19], v[144:147]
ds_read_b64_tr_b16 a[238:239], v19 offset:4096
v_mfma_f32_16x16x32_bf16 v[148:151], a[220:223], a[4:7], v[148:151]
ds_read_b64_tr_b16 a[240:241], v19 offset:8192
v_mfma_f32_16x16x32_bf16 v[148:151], a[224:227], a[20:23], v[148:151]
ds_read_b64_tr_b16 a[242:243], v19 offset:12288
v_mfma_f32_16x16x32_bf16 v[152:155], a[220:223], a[8:11], v[152:155]
v_mfma_f32_16x16x32_bf16 v[152:155], a[224:227], a[24:27], v[152:155]
v_mfma_f32_16x16x32_bf16 v[156:159], a[220:223], a[12:15], v[156:159]
s_add_u32 m0, s35, 81920
v_mfma_f32_16x16x32_bf16 v[156:159], a[224:227], a[28:31], v[156:159]
s_waitcnt vmcnt(20) lgkmcnt(4)
s_barrier
v_mfma_f32_16x16x32_bf16 v[160:163], a[228:231], a[0:3], v[160:163]
ds_read_b64_tr_b16 a[212:213], v12 offset:16384
v_mfma_f32_16x16x32_bf16 v[160:163], a[232:235], a[16:19], v[160:163]
buffer_load_dwordx4 v26, s[16:19], s34 offen offset:0 lds
v_mfma_f32_16x16x32_bf16 v[164:167], a[228:231], a[4:7], v[164:167]
ds_read_b64_tr_b16 a[214:215], v12 offset:20480
v_mfma_f32_16x16x32_bf16 v[164:167], a[232:235], a[20:23], v[164:167]
ds_read_b64_tr_b16 a[216:217], v12 offset:24576
v_mfma_f32_16x16x32_bf16 v[168:171], a[228:231], a[8:11], v[168:171]
ds_read_b64_tr_b16 a[218:219], v12 offset:28672
v_mfma_f32_16x16x32_bf16 v[168:171], a[232:235], a[24:27], v[168:171]
buffer_load_dwordx4 v27, s[16:19], s34 offen offset:1024 lds
v_mfma_f32_16x16x32_bf16 v[172:175], a[228:231], a[12:15], v[172:175]
v_mfma_f32_16x16x32_bf16 v[172:175], a[232:235], a[28:31], v[172:175]
s_waitcnt lgkmcnt(4)
v_mfma_f32_16x16x32_bf16 v[176:179], a[236:239], a[0:3], v[176:179]
ds_read_b64_tr_b16 a[220:221], v13 offset:16384
v_mfma_f32_16x16x32_bf16 v[176:179], a[240:243], a[16:19], v[176:179]
buffer_load_dwordx4 v28, s[16:19], s34 offen offset:2048 lds
v_mfma_f32_16x16x32_bf16 v[180:183], a[236:239], a[4:7], v[180:183]
ds_read_b64_tr_b16 a[222:223], v13 offset:20480
v_mfma_f32_16x16x32_bf16 v[180:183], a[240:243], a[20:23], v[180:183]
ds_read_b64_tr_b16 a[224:225], v13 offset:24576
v_mfma_f32_16x16x32_bf16 v[184:187], a[236:239], a[8:11], v[184:187]
ds_read_b64_tr_b16 a[226:227], v13 offset:28672
v_mfma_f32_16x16x32_bf16 v[184:187], a[240:243], a[24:27], v[184:187]
buffer_load_dwordx4 v29, s[16:19], s34 offen offset:3072 lds
v_mfma_f32_16x16x32_bf16 v[188:191], a[236:239], a[12:15], v[188:191]
s_add_u32 s34, s34, 524288
v_mfma_f32_16x16x32_bf16 v[188:191], a[240:243], a[28:31], v[188:191]
s_waitcnt vmcnt(28) lgkmcnt(4)
v_mfma_f32_16x16x32_bf16 v[64:67], a[212:215], a[32:35], v[64:67]
ds_read_b64_tr_b16 a[228:229], v14 offset:16384
v_mfma_f32_16x16x32_bf16 v[64:67], a[216:219], a[48:51], v[64:67]
ds_read_b64_tr_b16 a[230:231], v14 offset:20480
v_mfma_f32_16x16x32_bf16 v[68:71], a[212:215], a[36:39], v[68:71]
buffer_load_dwordx4 a[0:3], v30, s[12:15], s33 offen offset:0
v_mfma_f32_16x16x32_bf16 v[68:71], a[216:219], a[52:55], v[68:71]
ds_read_b64_tr_b16 a[232:233], v14 offset:24576
v_mfma_f32_16x16x32_bf16 v[72:75], a[212:215], a[40:43], v[72:75]
ds_read_b64_tr_b16 a[234:235], v14 offset:28672
v_mfma_f32_16x16x32_bf16 v[72:75], a[216:219], a[56:59], v[72:75]
v_mfma_f32_16x16x32_bf16 v[76:79], a[212:215], a[44:47], v[76:79]
v_mfma_f32_16x16x32_bf16 v[76:79], a[216:219], a[60:63], v[76:79]
s_waitcnt lgkmcnt(4)
v_mfma_f32_16x16x32_bf16 v[80:83], a[220:223], a[32:35], v[80:83]
buffer_load_dwordx4 a[4:7], v31, s[12:15], s33 offen offset:0
v_mfma_f32_16x16x32_bf16 v[80:83], a[224:227], a[48:51], v[80:83]
ds_read_b64_tr_b16 a[236:237], v15 offset:16384
v_mfma_f32_16x16x32_bf16 v[84:87], a[220:223], a[36:39], v[84:87]
ds_read_b64_tr_b16 a[238:239], v15 offset:20480
v_mfma_f32_16x16x32_bf16 v[84:87], a[224:227], a[52:55], v[84:87]
ds_read_b64_tr_b16 a[240:241], v15 offset:24576
v_mfma_f32_16x16x32_bf16 v[88:91], a[220:223], a[40:43], v[88:91]
ds_read_b64_tr_b16 a[242:243], v15 offset:28672
v_mfma_f32_16x16x32_bf16 v[88:91], a[224:227], a[56:59], v[88:91]
buffer_load_dwordx4 a[8:11], v32, s[12:15], s33 offen offset:0
v_mfma_f32_16x16x32_bf16 v[92:95], a[220:223], a[44:47], v[92:95]
v_mfma_f32_16x16x32_bf16 v[92:95], a[224:227], a[60:63], v[92:95]
s_waitcnt lgkmcnt(4)
v_mfma_f32_16x16x32_bf16 v[96:99], a[228:231], a[32:35], v[96:99]
ds_read_b64_tr_b16 a[212:213], v16 offset:16384
v_mfma_f32_16x16x32_bf16 v[96:99], a[232:235], a[48:51], v[96:99]
buffer_load_dwordx4 a[12:15], v33, s[12:15], s33 offen offset:0
v_mfma_f32_16x16x32_bf16 v[100:103], a[228:231], a[36:39], v[100:103]
ds_read_b64_tr_b16 a[214:215], v16 offset:20480
v_mfma_f32_16x16x32_bf16 v[100:103], a[232:235], a[52:55], v[100:103]
ds_read_b64_tr_b16 a[216:217], v16 offset:24576
v_mfma_f32_16x16x32_bf16 v[104:107], a[228:231], a[40:43], v[104:107]
ds_read_b64_tr_b16 a[218:219], v16 offset:28672
v_mfma_f32_16x16x32_bf16 v[104:107], a[232:235], a[56:59], v[104:107]
v_mfma_f32_16x16x32_bf16 v[108:111], a[228:231], a[44:47], v[108:111]
buffer_load_dwordx4 a[16:19], v30, s[12:15], s33 offen offset:1024
v_mfma_f32_16x16x32_bf16 v[108:111], a[232:235], a[60:63], v[108:111]
s_waitcnt lgkmcnt(4)
v_mfma_f32_16x16x32_bf16 v[112:115], a[236:239], a[32:35], v[112:115]
ds_read_b64_tr_b16 a[220:221], v17 offset:16384
v_mfma_f32_16x16x32_bf16 v[112:115], a[240:243], a[48:51], v[112:115]
ds_read_b64_tr_b16 a[222:223], v17 offset:20480
v_mfma_f32_16x16x32_bf16 v[116:119], a[236:239], a[36:39], v[116:119]
ds_read_b64_tr_b16 a[224:225], v17 offset:24576
v_mfma_f32_16x16x32_bf16 v[116:119], a[240:243], a[52:55], v[116:119]
buffer_load_dwordx4 a[20:23], v31, s[12:15], s33 offen offset:1024
v_mfma_f32_16x16x32_bf16 v[120:123], a[236:239], a[40:43], v[120:123]
ds_read_b64_tr_b16 a[226:227], v17 offset:28672
v_mfma_f32_16x16x32_bf16 v[120:123], a[240:243], a[56:59], v[120:123]
v_mfma_f32_16x16x32_bf16 v[124:127], a[236:239], a[44:47], v[124:127]
v_mfma_f32_16x16x32_bf16 v[124:127], a[240:243], a[60:63], v[124:127]
s_waitcnt lgkmcnt(4)
v_mfma_f32_16x16x32_bf16 v[128:131], a[212:215], a[32:35], v[128:131]
buffer_load_dwordx4 a[24:27], v32, s[12:15], s33 offen offset:1024
v_mfma_f32_16x16x32_bf16 v[128:131], a[216:219], a[48:51], v[128:131]
ds_read_b64_tr_b16 a[228:229], v18 offset:16384
v_mfma_f32_16x16x32_bf16 v[132:135], a[212:215], a[36:39], v[132:135]
ds_read_b64_tr_b16 a[230:231], v18 offset:20480
v_mfma_f32_16x16x32_bf16 v[132:135], a[216:219], a[52:55], v[132:135]
ds_read_b64_tr_b16 a[232:233], v18 offset:24576
v_mfma_f32_16x16x32_bf16 v[136:139], a[212:215], a[40:43], v[136:139]
ds_read_b64_tr_b16 a[234:235], v18 offset:28672
v_mfma_f32_16x16x32_bf16 v[136:139], a[216:219], a[56:59], v[136:139]
buffer_load_dwordx4 a[28:31], v33, s[12:15], s33 offen offset:1024
v_mfma_f32_16x16x32_bf16 v[140:143], a[212:215], a[44:47], v[140:143]
s_add_u32 s33, s33, 2048
v_mfma_f32_16x16x32_bf16 v[140:143], a[216:219], a[60:63], v[140:143]
s_waitcnt lgkmcnt(4)
v_mfma_f32_16x16x32_bf16 v[144:147], a[220:223], a[32:35], v[144:147]
ds_read_b64_tr_b16 a[236:237], v19 offset:16384
v_mfma_f32_16x16x32_bf16 v[144:147], a[224:227], a[48:51], v[144:147]
ds_read_b64_tr_b16 a[238:239], v19 offset:20480
v_mfma_f32_16x16x32_bf16 v[148:151], a[220:223], a[36:39], v[148:151]
ds_read_b64_tr_b16 a[240:241], v19 offset:24576
v_mfma_f32_16x16x32_bf16 v[148:151], a[224:227], a[52:55], v[148:151]
ds_read_b64_tr_b16 a[242:243], v19 offset:28672
v_mfma_f32_16x16x32_bf16 v[152:155], a[220:223], a[40:43], v[152:155]
v_mfma_f32_16x16x32_bf16 v[152:155], a[224:227], a[56:59], v[152:155]
v_mfma_f32_16x16x32_bf16 v[156:159], a[220:223], a[44:47], v[156:159]
s_add_u32 m0, s35, 32768
v_mfma_f32_16x16x32_bf16 v[156:159], a[224:227], a[60:63], v[156:159]
s_waitcnt vmcnt(20) lgkmcnt(4)
s_barrier
v_mfma_f32_16x16x32_bf16 v[160:163], a[228:231], a[32:35], v[160:163]
ds_read_b64_tr_b16 a[212:213], v12 offset:32768
v_mfma_f32_16x16x32_bf16 v[160:163], a[232:235], a[48:51], v[160:163]
buffer_load_dwordx4 v26, s[16:19], s34 offen offset:0 lds
v_mfma_f32_16x16x32_bf16 v[164:167], a[228:231], a[36:39], v[164:167]
ds_read_b64_tr_b16 a[214:215], v12 offset:36864
v_mfma_f32_16x16x32_bf16 v[164:167], a[232:235], a[52:55], v[164:167]
ds_read_b64_tr_b16 a[216:217], v12 offset:40960
v_mfma_f32_16x16x32_bf16 v[168:171], a[228:231], a[40:43], v[168:171]
ds_read_b64_tr_b16 a[218:219], v12 offset:45056
v_mfma_f32_16x16x32_bf16 v[168:171], a[232:235], a[56:59], v[168:171]
buffer_load_dwordx4 v27, s[16:19], s34 offen offset:1024 lds
v_mfma_f32_16x16x32_bf16 v[172:175], a[228:231], a[44:47], v[172:175]
v_mfma_f32_16x16x32_bf16 v[172:175], a[232:235], a[60:63], v[172:175]
s_waitcnt lgkmcnt(4)
v_mfma_f32_16x16x32_bf16 v[176:179], a[236:239], a[32:35], v[176:179]
ds_read_b64_tr_b16 a[220:221], v13 offset:32768
v_mfma_f32_16x16x32_bf16 v[176:179], a[240:243], a[48:51], v[176:179]
buffer_load_dwordx4 v28, s[16:19], s34 offen offset:2048 lds
v_mfma_f32_16x16x32_bf16 v[180:183], a[236:239], a[36:39], v[180:183]
ds_read_b64_tr_b16 a[222:223], v13 offset:36864
v_mfma_f32_16x16x32_bf16 v[180:183], a[240:243], a[52:55], v[180:183]
ds_read_b64_tr_b16 a[224:225], v13 offset:40960
v_mfma_f32_16x16x32_bf16 v[184:187], a[236:239], a[40:43], v[184:187]
ds_read_b64_tr_b16 a[226:227], v13 offset:45056
v_mfma_f32_16x16x32_bf16 v[184:187], a[240:243], a[56:59], v[184:187]
buffer_load_dwordx4 v29, s[16:19], s34 offen offset:3072 lds
v_mfma_f32_16x16x32_bf16 v[188:191], a[236:239], a[44:47], v[188:191]
s_add_u32 s34, s34, 524288
v_mfma_f32_16x16x32_bf16 v[188:191], a[240:243], a[60:63], v[188:191]
s_waitcnt vmcnt(28) lgkmcnt(4)
v_mfma_f32_16x16x32_bf16 v[64:67], a[212:215], a[64:67], v[64:67]
ds_read_b64_tr_b16 a[228:229], v14 offset:32768
v_mfma_f32_16x16x32_bf16 v[64:67], a[216:219], a[80:83], v[64:67]
ds_read_b64_tr_b16 a[230:231], v14 offset:36864
v_mfma_f32_16x16x32_bf16 v[68:71], a[212:215], a[68:71], v[68:71]
buffer_load_dwordx4 a[32:35], v30, s[12:15], s33 offen offset:0
v_mfma_f32_16x16x32_bf16 v[68:71], a[216:219], a[84:87], v[68:71]
ds_read_b64_tr_b16 a[232:233], v14 offset:40960
v_mfma_f32_16x16x32_bf16 v[72:75], a[212:215], a[72:75], v[72:75]
ds_read_b64_tr_b16 a[234:235], v14 offset:45056
v_mfma_f32_16x16x32_bf16 v[72:75], a[216:219], a[88:91], v[72:75]
v_mfma_f32_16x16x32_bf16 v[76:79], a[212:215], a[76:79], v[76:79]
v_mfma_f32_16x16x32_bf16 v[76:79], a[216:219], a[92:95], v[76:79]
s_waitcnt lgkmcnt(4)
v_mfma_f32_16x16x32_bf16 v[80:83], a[220:223], a[64:67], v[80:83]
buffer_load_dwordx4 a[36:39], v31, s[12:15], s33 offen offset:0
v_mfma_f32_16x16x32_bf16 v[80:83], a[224:227], a[80:83], v[80:83]
ds_read_b64_tr_b16 a[236:237], v15 offset:32768
v_mfma_f32_16x16x32_bf16 v[84:87], a[220:223], a[68:71], v[84:87]
ds_read_b64_tr_b16 a[238:239], v15 offset:36864
v_mfma_f32_16x16x32_bf16 v[84:87], a[224:227], a[84:87], v[84:87]
ds_read_b64_tr_b16 a[240:241], v15 offset:40960
v_mfma_f32_16x16x32_bf16 v[88:91], a[220:223], a[72:75], v[88:91]
ds_read_b64_tr_b16 a[242:243], v15 offset:45056
v_mfma_f32_16x16x32_bf16 v[88:91], a[224:227], a[88:91], v[88:91]
buffer_load_dwordx4 a[40:43], v32, s[12:15], s33 offen offset:0
v_mfma_f32_16x16x32_bf16 v[92:95], a[220:223], a[76:79], v[92:95]
v_mfma_f32_16x16x32_bf16 v[92:95], a[224:227], a[92:95], v[92:95]
s_waitcnt lgkmcnt(4)
v_mfma_f32_16x16x32_bf16 v[96:99], a[228:231], a[64:67], v[96:99]
ds_read_b64_tr_b16 a[212:213], v16 offset:32768
v_mfma_f32_16x16x32_bf16 v[96:99], a[232:235], a[80:83], v[96:99]
buffer_load_dwordx4 a[44:47], v33, s[12:15], s33 offen offset:0
v_mfma_f32_16x16x32_bf16 v[100:103], a[228:231], a[68:71], v[100:103]
ds_read_b64_tr_b16 a[214:215], v16 offset:36864
v_mfma_f32_16x16x32_bf16 v[100:103], a[232:235], a[84:87], v[100:103]
ds_read_b64_tr_b16 a[216:217], v16 offset:40960
v_mfma_f32_16x16x32_bf16 v[104:107], a[228:231], a[72:75], v[104:107]
ds_read_b64_tr_b16 a[218:219], v16 offset:45056
v_mfma_f32_16x16x32_bf16 v[104:107], a[232:235], a[88:91], v[104:107]
v_mfma_f32_16x16x32_bf16 v[108:111], a[228:231], a[76:79], v[108:111]
buffer_load_dwordx4 a[48:51], v30, s[12:15], s33 offen offset:1024
v_mfma_f32_16x16x32_bf16 v[108:111], a[232:235], a[92:95], v[108:111]
s_waitcnt lgkmcnt(4)
v_mfma_f32_16x16x32_bf16 v[112:115], a[236:239], a[64:67], v[112:115]
ds_read_b64_tr_b16 a[220:221], v17 offset:32768
v_mfma_f32_16x16x32_bf16 v[112:115], a[240:243], a[80:83], v[112:115]
ds_read_b64_tr_b16 a[222:223], v17 offset:36864
v_mfma_f32_16x16x32_bf16 v[116:119], a[236:239], a[68:71], v[116:119]
ds_read_b64_tr_b16 a[224:225], v17 offset:40960
v_mfma_f32_16x16x32_bf16 v[116:119], a[240:243], a[84:87], v[116:119]
buffer_load_dwordx4 a[52:55], v31, s[12:15], s33 offen offset:1024
v_mfma_f32_16x16x32_bf16 v[120:123], a[236:239], a[72:75], v[120:123]
ds_read_b64_tr_b16 a[226:227], v17 offset:45056
v_mfma_f32_16x16x32_bf16 v[120:123], a[240:243], a[88:91], v[120:123]
v_mfma_f32_16x16x32_bf16 v[124:127], a[236:239], a[76:79], v[124:127]
v_mfma_f32_16x16x32_bf16 v[124:127], a[240:243], a[92:95], v[124:127]
s_waitcnt lgkmcnt(4)
v_mfma_f32_16x16x32_bf16 v[128:131], a[212:215], a[64:67], v[128:131]
buffer_load_dwordx4 a[56:59], v32, s[12:15], s33 offen offset:1024
v_mfma_f32_16x16x32_bf16 v[128:131], a[216:219], a[80:83], v[128:131]
ds_read_b64_tr_b16 a[228:229], v18 offset:32768
v_mfma_f32_16x16x32_bf16 v[132:135], a[212:215], a[68:71], v[132:135]
ds_read_b64_tr_b16 a[230:231], v18 offset:36864
v_mfma_f32_16x16x32_bf16 v[132:135], a[216:219], a[84:87], v[132:135]
ds_read_b64_tr_b16 a[232:233], v18 offset:40960
v_mfma_f32_16x16x32_bf16 v[136:139], a[212:215], a[72:75], v[136:139]
ds_read_b64_tr_b16 a[234:235], v18 offset:45056
v_mfma_f32_16x16x32_bf16 v[136:139], a[216:219], a[88:91], v[136:139]
buffer_load_dwordx4 a[60:63], v33, s[12:15], s33 offen offset:1024
v_mfma_f32_16x16x32_bf16 v[140:143], a[212:215], a[76:79], v[140:143]
s_add_u32 s33, s33, 2048
v_mfma_f32_16x16x32_bf16 v[140:143], a[216:219], a[92:95], v[140:143]
s_waitcnt lgkmcnt(4)
v_mfma_f32_16x16x32_bf16 v[144:147], a[220:223], a[64:67], v[144:147]
ds_read_b64_tr_b16 a[236:237], v19 offset:32768
v_mfma_f32_16x16x32_bf16 v[144:147], a[224:227], a[80:83], v[144:147]
ds_read_b64_tr_b16 a[238:239], v19 offset:36864
v_mfma_f32_16x16x32_bf16 v[148:151], a[220:223], a[68:71], v[148:151]
ds_read_b64_tr_b16 a[240:241], v19 offset:40960
v_mfma_f32_16x16x32_bf16 v[148:151], a[224:227], a[84:87], v[148:151]
ds_read_b64_tr_b16 a[242:243], v19 offset:45056
v_mfma_f32_16x16x32_bf16 v[152:155], a[220:223], a[72:75], v[152:155]
v_mfma_f32_16x16x32_bf16 v[152:155], a[224:227], a[88:91], v[152:155]
v_mfma_f32_16x16x32_bf16 v[156:159], a[220:223], a[76:79], v[156:159]
s_add_u32 m0, s35, 49152
v_mfma_f32_16x16x32_bf16 v[156:159], a[224:227], a[92:95], v[156:159]
s_waitcnt vmcnt(20) lgkmcnt(4)
s_barrier
v_mfma_f32_16x16x32_bf16 v[160:163], a[228:231], a[64:67], v[160:163]
ds_read_b64_tr_b16 a[212:213], v12 offset:49152
v_mfma_f32_16x16x32_bf16 v[160:163], a[232:235], a[80:83], v[160:163]
buffer_load_dwordx4 v26, s[16:19], s34 offen offset:0 lds
v_mfma_f32_16x16x32_bf16 v[164:167], a[228:231], a[68:71], v[164:167]
ds_read_b64_tr_b16 a[214:215], v12 offset:53248
v_mfma_f32_16x16x32_bf16 v[164:167], a[232:235], a[84:87], v[164:167]
ds_read_b64_tr_b16 a[216:217], v12 offset:57344
v_mfma_f32_16x16x32_bf16 v[168:171], a[228:231], a[72:75], v[168:171]
ds_read_b64_tr_b16 a[218:219], v12 offset:61440
v_mfma_f32_16x16x32_bf16 v[168:171], a[232:235], a[88:91], v[168:171]
buffer_load_dwordx4 v27, s[16:19], s34 offen offset:1024 lds
v_mfma_f32_16x16x32_bf16 v[172:175], a[228:231], a[76:79], v[172:175]
v_mfma_f32_16x16x32_bf16 v[172:175], a[232:235], a[92:95], v[172:175]
s_waitcnt lgkmcnt(4)
v_mfma_f32_16x16x32_bf16 v[176:179], a[236:239], a[64:67], v[176:179]
ds_read_b64_tr_b16 a[220:221], v13 offset:49152
v_mfma_f32_16x16x32_bf16 v[176:179], a[240:243], a[80:83], v[176:179]
buffer_load_dwordx4 v28, s[16:19], s34 offen offset:2048 lds
v_mfma_f32_16x16x32_bf16 v[180:183], a[236:239], a[68:71], v[180:183]
ds_read_b64_tr_b16 a[222:223], v13 offset:53248
v_mfma_f32_16x16x32_bf16 v[180:183], a[240:243], a[84:87], v[180:183]
ds_read_b64_tr_b16 a[224:225], v13 offset:57344
v_mfma_f32_16x16x32_bf16 v[184:187], a[236:239], a[72:75], v[184:187]
ds_read_b64_tr_b16 a[226:227], v13 offset:61440
v_mfma_f32_16x16x32_bf16 v[184:187], a[240:243], a[88:91], v[184:187]
buffer_load_dwordx4 v29, s[16:19], s34 offen offset:3072 lds
v_mfma_f32_16x16x32_bf16 v[188:191], a[236:239], a[76:79], v[188:191]
s_add_u32 s34, s34, 524288
v_mfma_f32_16x16x32_bf16 v[188:191], a[240:243], a[92:95], v[188:191]
s_waitcnt vmcnt(28) lgkmcnt(4)
v_mfma_f32_16x16x32_bf16 v[64:67], a[212:215], a[96:99], v[64:67]
ds_read_b64_tr_b16 a[228:229], v14 offset:49152
v_mfma_f32_16x16x32_bf16 v[64:67], a[216:219], a[112:115], v[64:67]
ds_read_b64_tr_b16 a[230:231], v14 offset:53248
v_mfma_f32_16x16x32_bf16 v[68:71], a[212:215], a[100:103], v[68:71]
buffer_load_dwordx4 a[64:67], v30, s[12:15], s33 offen offset:0
v_mfma_f32_16x16x32_bf16 v[68:71], a[216:219], a[116:119], v[68:71]
ds_read_b64_tr_b16 a[232:233], v14 offset:57344
v_mfma_f32_16x16x32_bf16 v[72:75], a[212:215], a[104:107], v[72:75]
ds_read_b64_tr_b16 a[234:235], v14 offset:61440
v_mfma_f32_16x16x32_bf16 v[72:75], a[216:219], a[120:123], v[72:75]
v_mfma_f32_16x16x32_bf16 v[76:79], a[212:215], a[108:111], v[76:79]
v_mfma_f32_16x16x32_bf16 v[76:79], a[216:219], a[124:127], v[76:79]
s_waitcnt lgkmcnt(4)
v_mfma_f32_16x16x32_bf16 v[80:83], a[220:223], a[96:99], v[80:83]
buffer_load_dwordx4 a[68:71], v31, s[12:15], s33 offen offset:0
v_mfma_f32_16x16x32_bf16 v[80:83], a[224:227], a[112:115], v[80:83]
ds_read_b64_tr_b16 a[236:237], v15 offset:49152
v_mfma_f32_16x16x32_bf16 v[84:87], a[220:223], a[100:103], v[84:87]
ds_read_b64_tr_b16 a[238:239], v15 offset:53248
v_mfma_f32_16x16x32_bf16 v[84:87], a[224:227], a[116:119], v[84:87]
ds_read_b64_tr_b16 a[240:241], v15 offset:57344
v_mfma_f32_16x16x32_bf16 v[88:91], a[220:223], a[104:107], v[88:91]
ds_read_b64_tr_b16 a[242:243], v15 offset:61440
v_mfma_f32_16x16x32_bf16 v[88:91], a[224:227], a[120:123], v[88:91]
buffer_load_dwordx4 a[72:75], v32, s[12:15], s33 offen offset:0
v_mfma_f32_16x16x32_bf16 v[92:95], a[220:223], a[108:111], v[92:95]
v_mfma_f32_16x16x32_bf16 v[92:95], a[224:227], a[124:127], v[92:95]
s_waitcnt lgkmcnt(4)
v_mfma_f32_16x16x32_bf16 v[96:99], a[228:231], a[96:99], v[96:99]
ds_read_b64_tr_b16 a[212:213], v16 offset:49152
v_mfma_f32_16x16x32_bf16 v[96:99], a[232:235], a[112:115], v[96:99]
buffer_load_dwordx4 a[76:79], v33, s[12:15], s33 offen offset:0
v_mfma_f32_16x16x32_bf16 v[100:103], a[228:231], a[100:103], v[100:103]
ds_read_b64_tr_b16 a[214:215], v16 offset:53248
v_mfma_f32_16x16x32_bf16 v[100:103], a[232:235], a[116:119], v[100:103]
ds_read_b64_tr_b16 a[216:217], v16 offset:57344
v_mfma_f32_16x16x32_bf16 v[104:107], a[228:231], a[104:107], v[104:107]
ds_read_b64_tr_b16 a[218:219], v16 offset:61440
v_mfma_f32_16x16x32_bf16 v[104:107], a[232:235], a[120:123], v[104:107]
v_mfma_f32_16x16x32_bf16 v[108:111], a[228:231], a[108:111], v[108:111]
buffer_load_dwordx4 a[80:83], v30, s[12:15], s33 offen offset:1024
v_mfma_f32_16x16x32_bf16 v[108:111], a[232:235], a[124:127], v[108:111]
s_waitcnt lgkmcnt(4)
v_mfma_f32_16x16x32_bf16 v[112:115], a[236:239], a[96:99], v[112:115]
ds_read_b64_tr_b16 a[220:221], v17 offset:49152
v_mfma_f32_16x16x32_bf16 v[112:115], a[240:243], a[112:115], v[112:115]
ds_read_b64_tr_b16 a[222:223], v17 offset:53248
v_mfma_f32_16x16x32_bf16 v[116:119], a[236:239], a[100:103], v[116:119]
ds_read_b64_tr_b16 a[224:225], v17 offset:57344
v_mfma_f32_16x16x32_bf16 v[116:119], a[240:243], a[116:119], v[116:119]
buffer_load_dwordx4 a[84:87], v31, s[12:15], s33 offen offset:1024
v_mfma_f32_16x16x32_bf16 v[120:123], a[236:239], a[104:107], v[120:123]
ds_read_b64_tr_b16 a[226:227], v17 offset:61440
v_mfma_f32_16x16x32_bf16 v[120:123], a[240:243], a[120:123], v[120:123]
v_mfma_f32_16x16x32_bf16 v[124:127], a[236:239], a[108:111], v[124:127]
v_mfma_f32_16x16x32_bf16 v[124:127], a[240:243], a[124:127], v[124:127]
s_waitcnt lgkmcnt(4)
v_mfma_f32_16x16x32_bf16 v[128:131], a[212:215], a[96:99], v[128:131]
buffer_load_dwordx4 a[88:91], v32, s[12:15], s33 offen offset:1024
v_mfma_f32_16x16x32_bf16 v[128:131], a[216:219], a[112:115], v[128:131]
ds_read_b64_tr_b16 a[228:229], v18 offset:49152
v_mfma_f32_16x16x32_bf16 v[132:135], a[212:215], a[100:103], v[132:135]
ds_read_b64_tr_b16 a[230:231], v18 offset:53248
v_mfma_f32_16x16x32_bf16 v[132:135], a[216:219], a[116:119], v[132:135]
ds_read_b64_tr_b16 a[232:233], v18 offset:57344
v_mfma_f32_16x16x32_bf16 v[136:139], a[212:215], a[104:107], v[136:139]
ds_read_b64_tr_b16 a[234:235], v18 offset:61440
v_mfma_f32_16x16x32_bf16 v[136:139], a[216:219], a[120:123], v[136:139]
buffer_load_dwordx4 a[92:95], v33, s[12:15], s33 offen offset:1024
v_mfma_f32_16x16x32_bf16 v[140:143], a[212:215], a[108:111], v[140:143]
s_add_u32 s33, s33, 2048
v_mfma_f32_16x16x32_bf16 v[140:143], a[216:219], a[124:127], v[140:143]
s_waitcnt lgkmcnt(4)
v_mfma_f32_16x16x32_bf16 v[144:147], a[220:223], a[96:99], v[144:147]
ds_read_b64_tr_b16 a[236:237], v19 offset:49152
v_mfma_f32_16x16x32_bf16 v[144:147], a[224:227], a[112:115], v[144:147]
ds_read_b64_tr_b16 a[238:239], v19 offset:53248
v_mfma_f32_16x16x32_bf16 v[148:151], a[220:223], a[100:103], v[148:151]
ds_read_b64_tr_b16 a[240:241], v19 offset:57344
v_mfma_f32_16x16x32_bf16 v[148:151], a[224:227], a[116:119], v[148:151]
ds_read_b64_tr_b16 a[242:243], v19 offset:61440
v_mfma_f32_16x16x32_bf16 v[152:155], a[220:223], a[104:107], v[152:155]
v_mfma_f32_16x16x32_bf16 v[152:155], a[224:227], a[120:123], v[152:155]
v_mfma_f32_16x16x32_bf16 v[156:159], a[220:223], a[108:111], v[156:159]
s_add_u32 m0, s35, 65536
v_mfma_f32_16x16x32_bf16 v[156:159], a[224:227], a[124:127], v[156:159]
s_waitcnt vmcnt(20) lgkmcnt(4)
s_barrier
v_mfma_f32_16x16x32_bf16 v[160:163], a[228:231], a[96:99], v[160:163]
ds_read_b64_tr_b16 a[212:213], v12 offset:0
v_mfma_f32_16x16x32_bf16 v[160:163], a[232:235], a[112:115], v[160:163]
buffer_load_dwordx4 v26, s[16:19], s34 offen offset:0 lds
v_mfma_f32_16x16x32_bf16 v[164:167], a[228:231], a[100:103], v[164:167]
ds_read_b64_tr_b16 a[214:215], v12 offset:4096
v_mfma_f32_16x16x32_bf16 v[164:167], a[232:235], a[116:119], v[164:167]
ds_read_b64_tr_b16 a[216:217], v12 offset:8192
v_mfma_f32_16x16x32_bf16 v[168:171], a[228:231], a[104:107], v[168:171]
ds_read_b64_tr_b16 a[218:219], v12 offset:12288
v_mfma_f32_16x16x32_bf16 v[168:171], a[232:235], a[120:123], v[168:171]
buffer_load_dwordx4 v27, s[16:19], s34 offen offset:1024 lds
v_mfma_f32_16x16x32_bf16 v[172:175], a[228:231], a[108:111], v[172:175]
v_mfma_f32_16x16x32_bf16 v[172:175], a[232:235], a[124:127], v[172:175]
s_waitcnt lgkmcnt(4)
v_mfma_f32_16x16x32_bf16 v[176:179], a[236:239], a[96:99], v[176:179]
ds_read_b64_tr_b16 a[220:221], v13 offset:0
v_mfma_f32_16x16x32_bf16 v[176:179], a[240:243], a[112:115], v[176:179]
buffer_load_dwordx4 v28, s[16:19], s34 offen offset:2048 lds
v_mfma_f32_16x16x32_bf16 v[180:183], a[236:239], a[100:103], v[180:183]
ds_read_b64_tr_b16 a[222:223], v13 offset:4096
v_mfma_f32_16x16x32_bf16 v[180:183], a[240:243], a[116:119], v[180:183]
ds_read_b64_tr_b16 a[224:225], v13 offset:8192
v_mfma_f32_16x16x32_bf16 v[184:187], a[236:239], a[104:107], v[184:187]
ds_read_b64_tr_b16 a[226:227], v13 offset:12288
v_mfma_f32_16x16x32_bf16 v[184:187], a[240:243], a[120:123], v[184:187]
buffer_load_dwordx4 v29, s[16:19], s34 offen offset:3072 lds
v_mfma_f32_16x16x32_bf16 v[188:191], a[236:239], a[108:111], v[188:191]
s_add_u32 s34, s34, 524288
v_mfma_f32_16x16x32_bf16 v[188:191], a[240:243], a[124:127], v[188:191]
s_sub_u32 s36, s36, 1
s_cmp_lg_u32 s36, 0
s_cbranch_scc1 L_attn_kernel_qloop
s_mov_b32 s44, 0
s_mov_b32 s47, 16384
s_waitcnt vmcnt(28) lgkmcnt(4)
v_mfma_f32_16x16x32_bf16 v[64:67], a[212:215], a[0:3], v[64:67]
ds_read_b64_tr_b16 a[228:229], v14 offset:0
v_mfma_f32_16x16x32_bf16 v[64:67], a[216:219], a[16:19], v[64:67]
ds_read_b64_tr_b16 a[230:231], v14 offset:4096
v_mfma_f32_16x16x32_bf16 v[68:71], a[212:215], a[4:7], v[68:71]
buffer_load_dwordx4 a[96:99], v30, s[12:15], s33 offen offset:0
v_mfma_f32_16x16x32_bf16 v[68:71], a[216:219], a[20:23], v[68:71]
ds_read_b64_tr_b16 a[232:233], v14 offset:8192
v_mfma_f32_16x16x32_bf16 v[72:75], a[212:215], a[8:11], v[72:75]
ds_read_b64_tr_b16 a[234:235], v14 offset:12288
v_mfma_f32_16x16x32_bf16 v[72:75], a[216:219], a[24:27], v[72:75]
v_mfma_f32_16x16x32_bf16 v[76:79], a[212:215], a[12:15], v[76:79]
v_mfma_f32_16x16x32_bf16 v[76:79], a[216:219], a[28:31], v[76:79]
s_waitcnt lgkmcnt(4)
v_mfma_f32_16x16x32_bf16 v[80:83], a[220:223], a[0:3], v[80:83]
buffer_load_dwordx4 a[100:103], v31, s[12:15], s33 offen offset:0
v_mfma_f32_16x16x32_bf16 v[80:83], a[224:227], a[16:19], v[80:83]
ds_read_b64_tr_b16 a[236:237], v15 offset:0
v_mfma_f32_16x16x32_bf16 v[84:87], a[220:223], a[4:7], v[84:87]
ds_read_b64_tr_b16 a[238:239], v15 offset:4096
v_mfma_f32_16x16x32_bf16 v[84:87], a[224:227], a[20:23], v[84:87]
ds_read_b64_tr_b16 a[240:241], v15 offset:8192
v_mfma_f32_16x16x32_bf16 v[88:91], a[220:223], a[8:11], v[88:91]
ds_read_b64_tr_b16 a[242:243], v15 offset:12288
v_mfma_f32_16x16x32_bf16 v[88:91], a[224:227], a[24:27], v[88:91]
buffer_load_dwordx4 a[104:107], v32, s[12:15], s33 offen offset:0
v_mfma_f32_16x16x32_bf16 v[92:95], a[220:223], a[12:15], v[92:95]
v_mfma_f32_16x16x32_bf16 v[92:95], a[224:227], a[28:31], v[92:95]
s_waitcnt lgkmcnt(4)
v_mfma_f32_16x16x32_bf16 v[96:99], a[228:231], a[0:3], v[96:99]
ds_read_b64_tr_b16 a[212:213], v16 offset:0
v_mfma_f32_16x16x32_bf16 v[96:99], a[232:235], a[16:19], v[96:99]
buffer_load_dwordx4 a[108:111], v33, s[12:15], s33 offen offset:0
v_mfma_f32_16x16x32_bf16 v[100:103], a[228:231], a[4:7], v[100:103]
ds_read_b64_tr_b16 a[214:215], v16 offset:4096
v_mfma_f32_16x16x32_bf16 v[100:103], a[232:235], a[20:23], v[100:103]
ds_read_b64_tr_b16 a[216:217], v16 offset:8192
v_mfma_f32_16x16x32_bf16 v[104:107], a[228:231], a[8:11], v[104:107]
ds_read_b64_tr_b16 a[218:219], v16 offset:12288
v_mfma_f32_16x16x32_bf16 v[104:107], a[232:235], a[24:27], v[104:107]
v_mfma_f32_16x16x32_bf16 v[108:111], a[228:231], a[12:15], v[108:111]
buffer_load_dwordx4 a[112:115], v30, s[12:15], s33 offen offset:1024
v_mfma_f32_16x16x32_bf16 v[108:111], a[232:235], a[28:31], v[108:111]
s_waitcnt lgkmcnt(4)
v_mfma_f32_16x16x32_bf16 v[112:115], a[236:239], a[0:3], v[112:115]
ds_read_b64_tr_b16 a[220:221], v17 offset:0
v_mfma_f32_16x16x32_bf16 v[112:115], a[240:243], a[16:19], v[112:115]
ds_read_b64_tr_b16 a[222:223], v17 offset:4096
v_mfma_f32_16x16x32_bf16 v[116:119], a[236:239], a[4:7], v[116:119]
ds_read_b64_tr_b16 a[224:225], v17 offset:8192
v_mfma_f32_16x16x32_bf16 v[116:119], a[240:243], a[20:23], v[116:119]
buffer_load_dwordx4 a[116:119], v31, s[12:15], s33 offen offset:1024
v_mfma_f32_16x16x32_bf16 v[120:123], a[236:239], a[8:11], v[120:123]
ds_read_b64_tr_b16 a[226:227], v17 offset:12288
v_mfma_f32_16x16x32_bf16 v[120:123], a[240:243], a[24:27], v[120:123]
v_mfma_f32_16x16x32_bf16 v[124:127], a[236:239], a[12:15], v[124:127]
v_mfma_f32_16x16x32_bf16 v[124:127], a[240:243], a[28:31], v[124:127]
s_waitcnt lgkmcnt(4)
v_mfma_f32_16x16x32_bf16 v[128:131], a[212:215], a[0:3], v[128:131]
buffer_load_dwordx4 a[120:123], v32, s[12:15], s33 offen offset:1024
v_mfma_f32_16x16x32_bf16 v[128:131], a[216:219], a[16:19], v[128:131]
ds_read_b64_tr_b16 a[228:229], v18 offset:0
v_mfma_f32_16x16x32_bf16 v[132:135], a[212:215], a[4:7], v[132:135]
ds_read_b64_tr_b16 a[230:231], v18 offset:4096
v_mfma_f32_16x16x32_bf16 v[132:135], a[216:219], a[20:23], v[132:135]
ds_read_b64_tr_b16 a[232:233], v18 offset:8192
v_mfma_f32_16x16x32_bf16 v[136:139], a[212:215], a[8:11], v[136:139]
ds_read_b64_tr_b16 a[234:235], v18 offset:12288
v_mfma_f32_16x16x32_bf16 v[136:139], a[216:219], a[24:27], v[136:139]
buffer_load_dwordx4 a[124:127], v33, s[12:15], s33 offen offset:1024
v_mfma_f32_16x16x32_bf16 v[140:143], a[212:215], a[12:15], v[140:143]
s_add_u32 s33, s33, 2048
v_mfma_f32_16x16x32_bf16 v[140:143], a[216:219], a[28:31], v[140:143]
s_waitcnt lgkmcnt(4)
v_mfma_f32_16x16x32_bf16 v[144:147], a[220:223], a[0:3], v[144:147]
ds_read_b64_tr_b16 a[236:237], v19 offset:0
v_mfma_f32_16x16x32_bf16 v[144:147], a[224:227], a[16:19], v[144:147]
ds_read_b64_tr_b16 a[238:239], v19 offset:4096
v_mfma_f32_16x16x32_bf16 v[148:151], a[220:223], a[4:7], v[148:151]
ds_read_b64_tr_b16 a[240:241], v19 offset:8192
v_mfma_f32_16x16x32_bf16 v[148:151], a[224:227], a[20:23], v[148:151]
ds_read_b64_tr_b16 a[242:243], v19 offset:12288
v_mfma_f32_16x16x32_bf16 v[152:155], a[220:223], a[8:11], v[152:155]
v_mfma_f32_16x16x32_bf16 v[152:155], a[224:227], a[24:27], v[152:155]
v_mfma_f32_16x16x32_bf16 v[156:159], a[220:223], a[12:15], v[156:159]
s_add_u32 m0, s35, 81920
v_mfma_f32_16x16x32_bf16 v[156:159], a[224:227], a[28:31], v[156:159]
s_waitcnt vmcnt(20) lgkmcnt(4)
s_barrier
v_mfma_f32_16x16x32_bf16 v[160:163], a[228:231], a[0:3], v[160:163]
ds_read_b64_tr_b16 a[212:213], v12 offset:16384
v_mfma_f32_16x16x32_bf16 v[160:163], a[232:235], a[16:19], v[160:163]
buffer_load_dwordx4 v26, s[16:19], s34 offen offset:0 lds
v_mfma_f32_16x16x32_bf16 v[164:167], a[228:231], a[4:7], v[164:167]
ds_read_b64_tr_b16 a[214:215], v12 offset:20480
v_mfma_f32_16x16x32_bf16 v[164:167], a[232:235], a[20:23], v[164:167]
ds_read_b64_tr_b16 a[216:217], v12 offset:24576
v_mfma_f32_16x16x32_bf16 v[168:171], a[228:231], a[8:11], v[168:171]
ds_read_b64_tr_b16 a[218:219], v12 offset:28672
v_mfma_f32_16x16x32_bf16 v[168:171], a[232:235], a[24:27], v[168:171]
buffer_load_dwordx4 v27, s[16:19], s34 offen offset:1024 lds
v_mfma_f32_16x16x32_bf16 v[172:175], a[228:231], a[12:15], v[172:175]
v_mfma_f32_16x16x32_bf16 v[172:175], a[232:235], a[28:31], v[172:175]
s_waitcnt lgkmcnt(4)
v_mfma_f32_16x16x32_bf16 v[176:179], a[236:239], a[0:3], v[176:179]
ds_read_b64_tr_b16 a[220:221], v13 offset:16384
v_mfma_f32_16x16x32_bf16 v[176:179], a[240:243], a[16:19], v[176:179]
buffer_load_dwordx4 v28, s[16:19], s34 offen offset:2048 lds
v_mfma_f32_16x16x32_bf16 v[180:183], a[236:239], a[4:7], v[180:183]
ds_read_b64_tr_b16 a[222:223], v13 offset:20480
v_mfma_f32_16x16x32_bf16 v[180:183], a[240:243], a[20:23], v[180:183]
ds_read_b64_tr_b16 a[224:225], v13 offset:24576
v_mfma_f32_16x16x32_bf16 v[184:187], a[236:239], a[8:11], v[184:187]
ds_read_b64_tr_b16 a[226:227], v13 offset:28672
v_mfma_f32_16x16x32_bf16 v[184:187], a[240:243], a[24:27], v[184:187]
buffer_load_dwordx4 v29, s[16:19], s34 offen offset:3072 lds
v_mfma_f32_16x16x32_bf16 v[188:191], a[236:239], a[12:15], v[188:191]
s_add_u32 s34, s34, 524288
v_mfma_f32_16x16x32_bf16 v[188:191], a[240:243], a[28:31], v[188:191]
s_waitcnt vmcnt(28) lgkmcnt(4)
v_mfma_f32_16x16x32_bf16 v[64:67], a[212:215], a[32:35], v[64:67]
ds_read_b64_tr_b16 a[228:229], v14 offset:16384
v_mfma_f32_16x16x32_bf16 v[64:67], a[216:219], a[48:51], v[64:67]
ds_read_b64_tr_b16 a[230:231], v14 offset:20480
s_add_u32 m0, s35, 0
v_mfma_f32_16x16x32_bf16 v[68:71], a[212:215], a[36:39], v[68:71]
ds_read_b64_tr_b16 a[232:233], v14 offset:24576
v_mfma_f32_16x16x32_bf16 v[68:71], a[216:219], a[52:55], v[68:71]
ds_read_b64_tr_b16 a[234:235], v14 offset:28672
v_mfma_f32_16x16x32_bf16 v[72:75], a[212:215], a[40:43], v[72:75]
buffer_load_dwordx4 v20, s[20:23], s44 offen offset:0 lds
v_mfma_f32_16x16x32_bf16 v[72:75], a[216:219], a[56:59], v[72:75]
v_mfma_f32_16x16x32_bf16 v[76:79], a[212:215], a[44:47], v[76:79]
v_mfma_f32_16x16x32_bf16 v[76:79], a[216:219], a[60:63], v[76:79]
s_waitcnt lgkmcnt(4)
v_mfma_f32_16x16x32_bf16 v[80:83], a[220:223], a[32:35], v[80:83]
ds_read_b64_tr_b16 a[236:237], v15 offset:16384
v_mfma_f32_16x16x32_bf16 v[80:83], a[224:227], a[48:51], v[80:83]
ds_read_b64_tr_b16 a[238:239], v15 offset:20480
v_mfma_f32_16x16x32_bf16 v[84:87], a[220:223], a[36:39], v[84:87]
ds_read_b64_tr_b16 a[240:241], v15 offset:24576
v_mfma_f32_16x16x32_bf16 v[84:87], a[224:227], a[52:55], v[84:87]
ds_read_b64_tr_b16 a[242:243], v15 offset:28672
v_mfma_f32_16x16x32_bf16 v[88:91], a[220:223], a[40:43], v[88:91]
buffer_load_dwordx4 v21, s[20:23], s44 offen offset:1024 lds
v_mfma_f32_16x16x32_bf16 v[88:91], a[224:227], a[56:59], v[88:91]
v_mfma_f32_16x16x32_bf16 v[92:95], a[220:223], a[44:47], v[92:95]
v_mfma_f32_16x16x32_bf16 v[92:95], a[224:227], a[60:63], v[92:95]
s_waitcnt lgkmcnt(4)
v_mfma_f32_16x16x32_bf16 v[96:99], a[228:231], a[32:35], v[96:99]
ds_read_b64_tr_b16 a[212:213], v16 offset:16384
v_mfma_f32_16x16x32_bf16 v[96:99], a[232:235], a[48:51], v[96:99]
ds_read_b64_tr_b16 a[214:215], v16 offset:20480
v_mfma_f32_16x16x32_bf16 v[100:103], a[228:231], a[36:39], v[100:103]
ds_read_b64_tr_b16 a[216:217], v16 offset:24576
v_mfma_f32_16x16x32_bf16 v[100:103], a[232:235], a[52:55], v[100:103]
ds_read_b64_tr_b16 a[218:219], v16 offset:28672
v_mfma_f32_16x16x32_bf16 v[104:107], a[228:231], a[40:43], v[104:107]
buffer_load_dwordx4 v22, s[20:23], s44 offen offset:2048 lds
v_mfma_f32_16x16x32_bf16 v[104:107], a[232:235], a[56:59], v[104:107]
v_mfma_f32_16x16x32_bf16 v[108:111], a[228:231], a[44:47], v[108:111]
v_mfma_f32_16x16x32_bf16 v[108:111], a[232:235], a[60:63], v[108:111]
s_waitcnt lgkmcnt(4)
v_mfma_f32_16x16x32_bf16 v[112:115], a[236:239], a[32:35], v[112:115]
ds_read_b64_tr_b16 a[220:221], v17 offset:16384
v_mfma_f32_16x16x32_bf16 v[112:115], a[240:243], a[48:51], v[112:115]
buffer_load_dwordx4 v23, s[20:23], s44 offen offset:3072 lds
v_mfma_f32_16x16x32_bf16 v[116:119], a[236:239], a[36:39], v[116:119]
ds_read_b64_tr_b16 a[222:223], v17 offset:20480
v_mfma_f32_16x16x32_bf16 v[116:119], a[240:243], a[52:55], v[116:119]
ds_read_b64_tr_b16 a[224:225], v17 offset:24576
v_mfma_f32_16x16x32_bf16 v[120:123], a[236:239], a[40:43], v[120:123]
ds_read_b64_tr_b16 a[226:227], v17 offset:28672
v_mfma_f32_16x16x32_bf16 v[120:123], a[240:243], a[56:59], v[120:123]
s_add_u32 m0, s35, 98304
v_mfma_f32_16x16x32_bf16 v[124:127], a[236:239], a[44:47], v[124:127]
v_mfma_f32_16x16x32_bf16 v[124:127], a[240:243], a[60:63], v[124:127]
s_waitcnt lgkmcnt(4)
v_mfma_f32_16x16x32_bf16 v[128:131], a[212:215], a[32:35], v[128:131]
buffer_load_dwordx4 v24, s[24:27], s44 offen offset:0 lds
v_mfma_f32_16x16x32_bf16 v[128:131], a[216:219], a[48:51], v[128:131]
ds_read_b64_tr_b16 a[228:229], v18 offset:16384
v_mfma_f32_16x16x32_bf16 v[132:135], a[212:215], a[36:39], v[132:135]
ds_read_b64_tr_b16 a[230:231], v18 offset:20480
v_mfma_f32_16x16x32_bf16 v[132:135], a[216:219], a[52:55], v[132:135]
ds_read_b64_tr_b16 a[232:233], v18 offset:24576
v_mfma_f32_16x16x32_bf16 v[136:139], a[212:215], a[40:43], v[136:139]
ds_read_b64_tr_b16 a[234:235], v18 offset:28672
v_mfma_f32_16x16x32_bf16 v[136:139], a[216:219], a[56:59], v[136:139]
v_mfma_f32_16x16x32_bf16 v[140:143], a[212:215], a[44:47], v[140:143]
v_mfma_f32_16x16x32_bf16 v[140:143], a[216:219], a[60:63], v[140:143]
s_waitcnt lgkmcnt(4)
v_mfma_f32_16x16x32_bf16 v[144:147], a[220:223], a[32:35], v[144:147]
buffer_load_dwordx4 v25, s[24:27], s44 offen offset:1024 lds
v_mfma_f32_16x16x32_bf16 v[144:147], a[224:227], a[48:51], v[144:147]
ds_read_b64_tr_b16 a[236:237], v19 offset:16384
v_mfma_f32_16x16x32_bf16 v[148:151], a[220:223], a[36:39], v[148:151]
ds_read_b64_tr_b16 a[238:239], v19 offset:20480
v_mfma_f32_16x16x32_bf16 v[148:151], a[224:227], a[52:55], v[148:151]
ds_read_b64_tr_b16 a[240:241], v19 offset:24576
v_mfma_f32_16x16x32_bf16 v[152:155], a[220:223], a[40:43], v[152:155]
ds_read_b64_tr_b16 a[242:243], v19 offset:28672
v_mfma_f32_16x16x32_bf16 v[152:155], a[224:227], a[56:59], v[152:155]
v_mfma_f32_16x16x32_bf16 v[156:159], a[220:223], a[44:47], v[156:159]
buffer_load_dwordx4 v24, s[24:27], s44 offen offset:2048 lds
v_mfma_f32_16x16x32_bf16 v[156:159], a[224:227], a[60:63], v[156:159]
s_waitcnt vmcnt(19) lgkmcnt(4)
s_barrier
v_mfma_f32_16x16x32_bf16 v[160:163], a[228:231], a[32:35], v[160:163]
ds_read_b64_tr_b16 a[212:213], v12 offset:32768
v_mfma_f32_16x16x32_bf16 v[160:163], a[232:235], a[48:51], v[160:163]
ds_read_b64_tr_b16 a[214:215], v12 offset:36864
v_mfma_f32_16x16x32_bf16 v[164:167], a[228:231], a[36:39], v[164:167]
ds_read_b64_tr_b16 a[216:217], v12 offset:40960
v_mfma_f32_16x16x32_bf16 v[164:167], a[232:235], a[52:55], v[164:167]
ds_read_b64_tr_b16 a[218:219], v12 offset:45056
v_mfma_f32_16x16x32_bf16 v[168:171], a[228:231], a[40:43], v[168:171]
v_mfma_f32_16x16x32_bf16 v[168:171], a[232:235], a[56:59], v[168:171]
buffer_load_dwordx4 v25, s[24:27], s44 offen offset:3072 lds
v_mfma_f32_16x16x32_bf16 v[172:175], a[228:231], a[44:47], v[172:175]
v_mfma_f32_16x16x32_bf16 v[172:175], a[232:235], a[60:63], v[172:175]
s_waitcnt lgkmcnt(4)
v_mfma_f32_16x16x32_bf16 v[176:179], a[236:239], a[32:35], v[176:179]
ds_read_b64_tr_b16 a[220:221], v13 offset:32768
v_mfma_f32_16x16x32_bf16 v[176:179], a[240:243], a[48:51], v[176:179]
ds_read_b64_tr_b16 a[222:223], v13 offset:36864
v_mfma_f32_16x16x32_bf16 v[180:183], a[236:239], a[36:39], v[180:183]
ds_read_b64_tr_b16 a[224:225], v13 offset:40960
v_mfma_f32_16x16x32_bf16 v[180:183], a[240:243], a[52:55], v[180:183]
ds_read_b64_tr_b16 a[226:227], v13 offset:45056
v_mfma_f32_16x16x32_bf16 v[184:187], a[236:239], a[40:43], v[184:187]
v_mfma_f32_16x16x32_bf16 v[184:187], a[240:243], a[56:59], v[184:187]
v_mfma_f32_16x16x32_bf16 v[188:191], a[236:239], a[44:47], v[188:191]
v_mfma_f32_16x16x32_bf16 v[188:191], a[240:243], a[60:63], v[188:191]
s_waitcnt vmcnt(24) lgkmcnt(4)
v_mfma_f32_16x16x32_bf16 v[64:67], a[212:215], a[64:67], v[64:67]
ds_read_b64_tr_b16 a[228:229], v14 offset:32768
v_mfma_f32_16x16x32_bf16 v[64:67], a[216:219], a[80:83], v[64:67]
ds_read_b64_tr_b16 a[230:231], v14 offset:36864
s_add_u32 m0, s35, 16384
v_mfma_f32_16x16x32_bf16 v[68:71], a[212:215], a[68:71], v[68:71]
ds_read_b64_tr_b16 a[232:233], v14 offset:40960
v_mfma_f32_16x16x32_bf16 v[68:71], a[216:219], a[84:87], v[68:71]
ds_read_b64_tr_b16 a[234:235], v14 offset:45056
v_mfma_f32_16x16x32_bf16 v[72:75], a[212:215], a[72:75], v[72:75]
buffer_load_dwordx4 v20, s[20:23], s47 offen offset:0 lds
v_mfma_f32_16x16x32_bf16 v[72:75], a[216:219], a[88:91], v[72:75]
v_mfma_f32_16x16x32_bf16 v[76:79], a[212:215], a[76:79], v[76:79]
v_mfma_f32_16x16x32_bf16 v[76:79], a[216:219], a[92:95], v[76:79]
s_waitcnt lgkmcnt(4)
v_mfma_f32_16x16x32_bf16 v[80:83], a[220:223], a[64:67], v[80:83]
ds_read_b64_tr_b16 a[236:237], v15 offset:32768
v_mfma_f32_16x16x32_bf16 v[80:83], a[224:227], a[80:83], v[80:83]
ds_read_b64_tr_b16 a[238:239], v15 offset:36864
v_mfma_f32_16x16x32_bf16 v[84:87], a[220:223], a[68:71], v[84:87]
ds_read_b64_tr_b16 a[240:241], v15 offset:40960
v_mfma_f32_16x16x32_bf16 v[84:87], a[224:227], a[84:87], v[84:87]
ds_read_b64_tr_b16 a[242:243], v15 offset:45056
v_mfma_f32_16x16x32_bf16 v[88:91], a[220:223], a[72:75], v[88:91]
buffer_load_dwordx4 v21, s[20:23], s47 offen offset:1024 lds
v_mfma_f32_16x16x32_bf16 v[88:91], a[224:227], a[88:91], v[88:91]
v_mfma_f32_16x16x32_bf16 v[92:95], a[220:223], a[76:79], v[92:95]
v_mfma_f32_16x16x32_bf16 v[92:95], a[224:227], a[92:95], v[92:95]
s_waitcnt lgkmcnt(4)
v_mfma_f32_16x16x32_bf16 v[96:99], a[228:231], a[64:67], v[96:99]
ds_read_b64_tr_b16 a[212:213], v16 offset:32768
v_mfma_f32_16x16x32_bf16 v[96:99], a[232:235], a[80:83], v[96:99]
ds_read_b64_tr_b16 a[214:215], v16 offset:36864
v_mfma_f32_16x16x32_bf16 v[100:103], a[228:231], a[68:71], v[100:103]
ds_read_b64_tr_b16 a[216:217], v16 offset:40960
v_mfma_f32_16x16x32_bf16 v[100:103], a[232:235], a[84:87], v[100:103]
ds_read_b64_tr_b16 a[218:219], v16 offset:45056
v_mfma_f32_16x16x32_bf16 v[104:107], a[228:231], a[72:75], v[104:107]
buffer_load_dwordx4 v22, s[20:23], s47 offen offset:2048 lds
v_mfma_f32_16x16x32_bf16 v[104:107], a[232:235], a[88:91], v[104:107]
v_mfma_f32_16x16x32_bf16 v[108:111], a[228:231], a[76:79], v[108:111]
v_mfma_f32_16x16x32_bf16 v[108:111], a[232:235], a[92:95], v[108:111]
s_waitcnt lgkmcnt(4)
v_mfma_f32_16x16x32_bf16 v[112:115], a[236:239], a[64:67], v[112:115]
ds_read_b64_tr_b16 a[220:221], v17 offset:32768
v_mfma_f32_16x16x32_bf16 v[112:115], a[240:243], a[80:83], v[112:115]
buffer_load_dwordx4 v23, s[20:23], s47 offen offset:3072 lds
v_mfma_f32_16x16x32_bf16 v[116:119], a[236:239], a[68:71], v[116:119]
ds_read_b64_tr_b16 a[222:223], v17 offset:36864
v_mfma_f32_16x16x32_bf16 v[116:119], a[240:243], a[84:87], v[116:119]
ds_read_b64_tr_b16 a[224:225], v17 offset:40960
v_mfma_f32_16x16x32_bf16 v[120:123], a[236:239], a[72:75], v[120:123]
ds_read_b64_tr_b16 a[226:227], v17 offset:45056
v_mfma_f32_16x16x32_bf16 v[120:123], a[240:243], a[88:91], v[120:123]
s_add_u32 m0, s35, 114688
v_mfma_f32_16x16x32_bf16 v[124:127], a[236:239], a[76:79], v[124:127]
v_mfma_f32_16x16x32_bf16 v[124:127], a[240:243], a[92:95], v[124:127]
s_waitcnt lgkmcnt(4)
v_mfma_f32_16x16x32_bf16 v[128:131], a[212:215], a[64:67], v[128:131]
buffer_load_dwordx4 v24, s[24:27], s47 offen offset:0 lds
v_mfma_f32_16x16x32_bf16 v[128:131], a[216:219], a[80:83], v[128:131]
ds_read_b64_tr_b16 a[228:229], v18 offset:32768
v_mfma_f32_16x16x32_bf16 v[132:135], a[212:215], a[68:71], v[132:135]
ds_read_b64_tr_b16 a[230:231], v18 offset:36864
v_mfma_f32_16x16x32_bf16 v[132:135], a[216:219], a[84:87], v[132:135]
ds_read_b64_tr_b16 a[232:233], v18 offset:40960
v_mfma_f32_16x16x32_bf16 v[136:139], a[212:215], a[72:75], v[136:139]
ds_read_b64_tr_b16 a[234:235], v18 offset:45056
v_mfma_f32_16x16x32_bf16 v[136:139], a[216:219], a[88:91], v[136:139]
v_mfma_f32_16x16x32_bf16 v[140:143], a[212:215], a[76:79], v[140:143]
v_mfma_f32_16x16x32_bf16 v[140:143], a[216:219], a[92:95], v[140:143]
s_waitcnt lgkmcnt(4)
v_mfma_f32_16x16x32_bf16 v[144:147], a[220:223], a[64:67], v[144:147]
buffer_load_dwordx4 v25, s[24:27], s47 offen offset:1024 lds
v_mfma_f32_16x16x32_bf16 v[144:147], a[224:227], a[80:83], v[144:147]
ds_read_b64_tr_b16 a[236:237], v19 offset:32768
v_mfma_f32_16x16x32_bf16 v[148:151], a[220:223], a[68:71], v[148:151]
ds_read_b64_tr_b16 a[238:239], v19 offset:36864
v_mfma_f32_16x16x32_bf16 v[148:151], a[224:227], a[84:87], v[148:151]
ds_read_b64_tr_b16 a[240:241], v19 offset:40960
v_mfma_f32_16x16x32_bf16 v[152:155], a[220:223], a[72:75], v[152:155]
ds_read_b64_tr_b16 a[242:243], v19 offset:45056
v_mfma_f32_16x16x32_bf16 v[152:155], a[224:227], a[88:91], v[152:155]
v_mfma_f32_16x16x32_bf16 v[156:159], a[220:223], a[76:79], v[156:159]
buffer_load_dwordx4 v24, s[24:27], s47 offen offset:2048 lds
v_mfma_f32_16x16x32_bf16 v[156:159], a[224:227], a[92:95], v[156:159]
s_waitcnt vmcnt(15) lgkmcnt(4)
s_barrier
v_mfma_f32_16x16x32_bf16 v[160:163], a[228:231], a[64:67], v[160:163]
ds_read_b64_tr_b16 a[212:213], v12 offset:49152
v_mfma_f32_16x16x32_bf16 v[160:163], a[232:235], a[80:83], v[160:163]
ds_read_b64_tr_b16 a[214:215], v12 offset:53248
v_mfma_f32_16x16x32_bf16 v[164:167], a[228:231], a[68:71], v[164:167]
ds_read_b64_tr_b16 a[216:217], v12 offset:57344
v_mfma_f32_16x16x32_bf16 v[164:167], a[232:235], a[84:87], v[164:167]
ds_read_b64_tr_b16 a[218:219], v12 offset:61440
v_mfma_f32_16x16x32_bf16 v[168:171], a[228:231], a[72:75], v[168:171]
v_mfma_f32_16x16x32_bf16 v[168:171], a[232:235], a[88:91], v[168:171]
buffer_load_dwordx4 v25, s[24:27], s47 offen offset:3072 lds
v_mfma_f32_16x16x32_bf16 v[172:175], a[228:231], a[76:79], v[172:175]
v_mfma_f32_16x16x32_bf16 v[172:175], a[232:235], a[92:95], v[172:175]
s_waitcnt lgkmcnt(4)
v_mfma_f32_16x16x32_bf16 v[176:179], a[236:239], a[64:67], v[176:179]
ds_read_b64_tr_b16 a[220:221], v13 offset:49152
v_mfma_f32_16x16x32_bf16 v[176:179], a[240:243], a[80:83], v[176:179]
ds_read_b64_tr_b16 a[222:223], v13 offset:53248
v_mfma_f32_16x16x32_bf16 v[180:183], a[236:239], a[68:71], v[180:183]
ds_read_b64_tr_b16 a[224:225], v13 offset:57344
v_mfma_f32_16x16x32_bf16 v[180:183], a[240:243], a[84:87], v[180:183]
ds_read_b64_tr_b16 a[226:227], v13 offset:61440
v_mfma_f32_16x16x32_bf16 v[184:187], a[236:239], a[72:75], v[184:187]
v_mfma_f32_16x16x32_bf16 v[184:187], a[240:243], a[88:91], v[184:187]
v_mfma_f32_16x16x32_bf16 v[188:191], a[236:239], a[76:79], v[188:191]
v_mfma_f32_16x16x32_bf16 v[188:191], a[240:243], a[92:95], v[188:191]
s_waitcnt vmcnt(20) lgkmcnt(4)
v_mfma_f32_16x16x32_bf16 v[64:67], a[212:215], a[96:99], v[64:67]
ds_read_b64_tr_b16 a[228:229], v14 offset:49152
v_mfma_f32_16x16x32_bf16 v[64:67], a[216:219], a[112:115], v[64:67]
ds_read_b64_tr_b16 a[230:231], v14 offset:53248
v_mfma_f32_16x16x32_bf16 v[68:71], a[212:215], a[100:103], v[68:71]
ds_read_b64_tr_b16 a[232:233], v14 offset:57344
v_mfma_f32_16x16x32_bf16 v[68:71], a[216:219], a[116:119], v[68:71]
ds_read_b64_tr_b16 a[234:235], v14 offset:61440
v_mfma_f32_16x16x32_bf16 v[72:75], a[212:215], a[104:107], v[72:75]
v_mfma_f32_16x16x32_bf16 v[72:75], a[216:219], a[120:123], v[72:75]
v_mfma_f32_16x16x32_bf16 v[76:79], a[212:215], a[108:111], v[76:79]
v_mfma_f32_16x16x32_bf16 v[76:79], a[216:219], a[124:127], v[76:79]
s_waitcnt lgkmcnt(4)
v_mfma_f32_16x16x32_bf16 v[80:83], a[220:223], a[96:99], v[80:83]
ds_read_b64_tr_b16 a[236:237], v15 offset:49152
v_mfma_f32_16x16x32_bf16 v[80:83], a[224:227], a[112:115], v[80:83]
ds_read_b64_tr_b16 a[238:239], v15 offset:53248
v_mfma_f32_16x16x32_bf16 v[84:87], a[220:223], a[100:103], v[84:87]
ds_read_b64_tr_b16 a[240:241], v15 offset:57344
v_mfma_f32_16x16x32_bf16 v[84:87], a[224:227], a[116:119], v[84:87]
ds_read_b64_tr_b16 a[242:243], v15 offset:61440
v_mfma_f32_16x16x32_bf16 v[88:91], a[220:223], a[104:107], v[88:91]
v_mfma_f32_16x16x32_bf16 v[88:91], a[224:227], a[120:123], v[88:91]
v_mfma_f32_16x16x32_bf16 v[92:95], a[220:223], a[108:111], v[92:95]
v_mfma_f32_16x16x32_bf16 v[92:95], a[224:227], a[124:127], v[92:95]
s_waitcnt lgkmcnt(4)
v_mfma_f32_16x16x32_bf16 v[96:99], a[228:231], a[96:99], v[96:99]
ds_read_b64_tr_b16 a[212:213], v16 offset:49152
v_mfma_f32_16x16x32_bf16 v[96:99], a[232:235], a[112:115], v[96:99]
ds_read_b64_tr_b16 a[214:215], v16 offset:53248
v_mfma_f32_16x16x32_bf16 v[100:103], a[228:231], a[100:103], v[100:103]
ds_read_b64_tr_b16 a[216:217], v16 offset:57344
v_mfma_f32_16x16x32_bf16 v[100:103], a[232:235], a[116:119], v[100:103]
ds_read_b64_tr_b16 a[218:219], v16 offset:61440
v_mfma_f32_16x16x32_bf16 v[104:107], a[228:231], a[104:107], v[104:107]
v_mfma_f32_16x16x32_bf16 v[104:107], a[232:235], a[120:123], v[104:107]
v_mfma_f32_16x16x32_bf16 v[108:111], a[228:231], a[108:111], v[108:111]
v_mfma_f32_16x16x32_bf16 v[108:111], a[232:235], a[124:127], v[108:111]
s_waitcnt lgkmcnt(4)
v_mfma_f32_16x16x32_bf16 v[112:115], a[236:239], a[96:99], v[112:115]
ds_read_b64_tr_b16 a[220:221], v17 offset:49152
v_mfma_f32_16x16x32_bf16 v[112:115], a[240:243], a[112:115], v[112:115]
ds_read_b64_tr_b16 a[222:223], v17 offset:53248
v_mfma_f32_16x16x32_bf16 v[116:119], a[236:239], a[100:103], v[116:119]
ds_read_b64_tr_b16 a[224:225], v17 offset:57344
v_mfma_f32_16x16x32_bf16 v[116:119], a[240:243], a[116:119], v[116:119]
ds_read_b64_tr_b16 a[226:227], v17 offset:61440
v_mfma_f32_16x16x32_bf16 v[120:123], a[236:239], a[104:107], v[120:123]
v_mfma_f32_16x16x32_bf16 v[120:123], a[240:243], a[120:123], v[120:123]
v_mfma_f32_16x16x32_bf16 v[124:127], a[236:239], a[108:111], v[124:127]
v_mfma_f32_16x16x32_bf16 v[124:127], a[240:243], a[124:127], v[124:127]
s_waitcnt lgkmcnt(4)
v_mfma_f32_16x16x32_bf16 v[128:131], a[212:215], a[96:99], v[128:131]
ds_read_b64_tr_b16 a[228:229], v18 offset:49152
v_mfma_f32_16x16x32_bf16 v[128:131], a[216:219], a[112:115], v[128:131]
ds_read_b64_tr_b16 a[230:231], v18 offset:53248
v_mfma_f32_16x16x32_bf16 v[132:135], a[212:215], a[100:103], v[132:135]
ds_read_b64_tr_b16 a[232:233], v18 offset:57344
v_mfma_f32_16x16x32_bf16 v[132:135], a[216:219], a[116:119], v[132:135]
ds_read_b64_tr_b16 a[234:235], v18 offset:61440
v_mfma_f32_16x16x32_bf16 v[136:139], a[212:215], a[104:107], v[136:139]
v_mfma_f32_16x16x32_bf16 v[136:139], a[216:219], a[120:123], v[136:139]
v_mfma_f32_16x16x32_bf16 v[140:143], a[212:215], a[108:111], v[140:143]
v_mfma_f32_16x16x32_bf16 v[140:143], a[216:219], a[124:127], v[140:143]
s_waitcnt lgkmcnt(4)
v_mfma_f32_16x16x32_bf16 v[144:147], a[220:223], a[96:99], v[144:147]
ds_read_b64_tr_b16 a[236:237], v19 offset:49152
v_mfma_f32_16x16x32_bf16 v[144:147], a[224:227], a[112:115], v[144:147]
ds_read_b64_tr_b16 a[238:239], v19 offset:53248
v_mfma_f32_16x16x32_bf16 v[148:151], a[220:223], a[100:103], v[148:151]
ds_read_b64_tr_b16 a[240:241], v19 offset:57344
v_mfma_f32_16x16x32_bf16 v[148:151], a[224:227], a[116:119], v[148:151]
ds_read_b64_tr_b16 a[242:243], v19 offset:61440
v_mfma_f32_16x16x32_bf16 v[152:155], a[220:223], a[104:107], v[152:155]
v_mfma_f32_16x16x32_bf16 v[152:155], a[224:227], a[120:123], v[152:155]
v_mfma_f32_16x16x32_bf16 v[156:159], a[220:223], a[108:111], v[156:159]
v_mfma_f32_16x16x32_bf16 v[156:159], a[224:227], a[124:127], v[156:159]
s_waitcnt lgkmcnt(4)
v_mfma_f32_16x16x32_bf16 v[160:163], a[228:231], a[96:99], v[160:163]
v_mfma_f32_16x16x32_bf16 v[160:163], a[232:235], a[112:115], v[160:163]
v_mfma_f32_16x16x32_bf16 v[164:167], a[228:231], a[100:103], v[164:167]
v_mfma_f32_16x16x32_bf16 v[164:167], a[232:235], a[116:119], v[164:167]
v_mfma_f32_16x16x32_bf16 v[168:171], a[228:231], a[104:107], v[168:171]
v_mfma_f32_16x16x32_bf16 v[168:171], a[232:235], a[120:123], v[168:171]
v_mfma_f32_16x16x32_bf16 v[172:175], a[228:231], a[108:111], v[172:175]
v_mfma_f32_16x16x32_bf16 v[172:175], a[232:235], a[124:127], v[172:175]
s_waitcnt lgkmcnt(0)
v_mfma_f32_16x16x32_bf16 v[176:179], a[236:239], a[96:99], v[176:179]
v_mfma_f32_16x16x32_bf16 v[176:179], a[240:243], a[112:115], v[176:179]
v_mfma_f32_16x16x32_bf16 v[180:183], a[236:239], a[100:103], v[180:183]
v_mfma_f32_16x16x32_bf16 v[180:183], a[240:243], a[116:119], v[180:183]
v_mfma_f32_16x16x32_bf16 v[184:187], a[236:239], a[104:107], v[184:187]
v_mfma_f32_16x16x32_bf16 v[184:187], a[240:243], a[120:123], v[184:187]
v_mfma_f32_16x16x32_bf16 v[188:191], a[236:239], a[108:111], v[188:191]
v_mfma_f32_16x16x32_bf16 v[188:191], a[240:243], a[124:127], v[188:191]
v_cvt_pk_bf16_f32 v192, v64, v65
v_cvt_pk_bf16_f32 v193, v66, v67
v_cvt_pk_bf16_f32 v194, v80, v81
v_cvt_pk_bf16_f32 v195, v82, v83
s_nop 1
v_permlane32_swap_b32 v192, v194
v_permlane32_swap_b32 v193, v195
s_nop 1
v_permlane16_swap_b32 v192, v194
v_permlane16_swap_b32 v193, v195
v_accvgpr_write_b32 a128, v192
v_accvgpr_write_b32 a129, v193
v_accvgpr_write_b32 a130, v194
v_accvgpr_write_b32 a131, v195
v_cvt_pk_bf16_f32 v196, v96, v97
v_cvt_pk_bf16_f32 v197, v98, v99
v_cvt_pk_bf16_f32 v198, v112, v113
v_cvt_pk_bf16_f32 v199, v114, v115
s_nop 1
v_permlane32_swap_b32 v196, v198
v_permlane32_swap_b32 v197, v199
s_nop 1
v_permlane16_swap_b32 v196, v198
v_permlane16_swap_b32 v197, v199
v_accvgpr_write_b32 a132, v196
v_accvgpr_write_b32 a133, v197
v_accvgpr_write_b32 a134, v198
v_accvgpr_write_b32 a135, v199
v_cvt_pk_bf16_f32 v200, v128, v129
v_cvt_pk_bf16_f32 v201, v130, v131
v_cvt_pk_bf16_f32 v202, v144, v145
v_cvt_pk_bf16_f32 v203, v146, v147
s_nop 1
v_permlane32_swap_b32 v200, v202
v_permlane32_swap_b32 v201, v203
s_nop 1
v_permlane16_swap_b32 v200, v202
v_permlane16_swap_b32 v201, v203
v_accvgpr_write_b32 a136, v200
v_accvgpr_write_b32 a137, v201
v_accvgpr_write_b32 a138, v202
v_accvgpr_write_b32 a139, v203
v_cvt_pk_bf16_f32 v204, v160, v161
v_cvt_pk_bf16_f32 v205, v162, v163
v_cvt_pk_bf16_f32 v206, v176, v177
v_cvt_pk_bf16_f32 v207, v178, v179
s_nop 1
v_permlane32_swap_b32 v204, v206
v_permlane32_swap_b32 v205, v207
s_nop 1
v_permlane16_swap_b32 v204, v206
v_permlane16_swap_b32 v205, v207
v_accvgpr_write_b32 a140, v204
v_accvgpr_write_b32 a141, v205
v_accvgpr_write_b32 a142, v206
v_accvgpr_write_b32 a143, v207
v_cvt_pk_bf16_f32 v208, v68, v69
v_cvt_pk_bf16_f32 v209, v70, v71
v_cvt_pk_bf16_f32 v210, v84, v85
v_cvt_pk_bf16_f32 v211, v86, v87
s_nop 1
v_permlane32_swap_b32 v208, v210
v_permlane32_swap_b32 v209, v211
s_nop 1
v_permlane16_swap_b32 v208, v210
v_permlane16_swap_b32 v209, v211
v_accvgpr_write_b32 a144, v208
v_accvgpr_write_b32 a145, v209
v_accvgpr_write_b32 a146, v210
v_accvgpr_write_b32 a147, v211
v_cvt_pk_bf16_f32 v212, v100, v101
v_cvt_pk_bf16_f32 v213, v102, v103
v_cvt_pk_bf16_f32 v214, v116, v117
v_cvt_pk_bf16_f32 v215, v118, v119
s_nop 1
v_permlane32_swap_b32 v212, v214
v_permlane32_swap_b32 v213, v215
s_nop 1
v_permlane16_swap_b32 v212, v214
v_permlane16_swap_b32 v213, v215
v_accvgpr_write_b32 a148, v212
v_accvgpr_write_b32 a149, v213
v_accvgpr_write_b32 a150, v214
v_accvgpr_write_b32 a151, v215
v_cvt_pk_bf16_f32 v216, v132, v133
v_cvt_pk_bf16_f32 v217, v134, v135
v_cvt_pk_bf16_f32 v218, v148, v149
v_cvt_pk_bf16_f32 v219, v150, v151
s_nop 1
v_permlane32_swap_b32 v216, v218
v_permlane32_swap_b32 v217, v219
s_nop 1
v_permlane16_swap_b32 v216, v218
v_permlane16_swap_b32 v217, v219
v_accvgpr_write_b32 a152, v216
v_accvgpr_write_b32 a153, v217
v_accvgpr_write_b32 a154, v218
v_accvgpr_write_b32 a155, v219
v_cvt_pk_bf16_f32 v220, v164, v165
v_cvt_pk_bf16_f32 v221, v166, v167
v_cvt_pk_bf16_f32 v222, v180, v181
v_cvt_pk_bf16_f32 v223, v182, v183
s_nop 1
v_permlane32_swap_b32 v220, v222
v_permlane32_swap_b32 v221, v223
s_nop 1
v_permlane16_swap_b32 v220, v222
v_permlane16_swap_b32 v221, v223
v_accvgpr_write_b32 a156, v220
v_accvgpr_write_b32 a157, v221
v_accvgpr_write_b32 a158, v222
v_accvgpr_write_b32 a159, v223
v_cvt_pk_bf16_f32 v192, v72, v73
v_cvt_pk_bf16_f32 v193, v74, v75
v_cvt_pk_bf16_f32 v194, v88, v89
v_cvt_pk_bf16_f32 v195, v90, v91
s_nop 1
v_permlane32_swap_b32 v192, v194
v_permlane32_swap_b32 v193, v195
s_nop 1
v_permlane16_swap_b32 v192, v194
v_permlane16_swap_b32 v193, v195
v_accvgpr_write_b32 a160, v192
v_accvgpr_write_b32 a161, v193
v_accvgpr_write_b32 a162, v194
v_accvgpr_write_b32 a163, v195
v_cvt_pk_bf16_f32 v196, v104, v105
v_cvt_pk_bf16_f32 v197, v106, v107
v_cvt_pk_bf16_f32 v198, v120, v121
v_cvt_pk_bf16_f32 v199, v122, v123
s_nop 1
v_permlane32_swap_b32 v196, v198
v_permlane32_swap_b32 v197, v199
s_nop 1
v_permlane16_swap_b32 v196, v198
v_permlane16_swap_b32 v197, v199
v_accvgpr_write_b32 a164, v196
v_accvgpr_write_b32 a165, v197
v_accvgpr_write_b32 a166, v198
v_accvgpr_write_b32 a167, v199
v_cvt_pk_bf16_f32 v200, v136, v137
v_cvt_pk_bf16_f32 v201, v138, v139
v_cvt_pk_bf16_f32 v202, v152, v153
v_cvt_pk_bf16_f32 v203, v154, v155
s_nop 1
v_permlane32_swap_b32 v200, v202
v_permlane32_swap_b32 v201, v203
s_nop 1
v_permlane16_swap_b32 v200, v202
v_permlane16_swap_b32 v201, v203
v_accvgpr_write_b32 a168, v200
v_accvgpr_write_b32 a169, v201
v_accvgpr_write_b32 a170, v202
v_accvgpr_write_b32 a171, v203
v_cvt_pk_bf16_f32 v204, v168, v169
v_cvt_pk_bf16_f32 v205, v170, v171
v_cvt_pk_bf16_f32 v206, v184, v185
v_cvt_pk_bf16_f32 v207, v186, v187
s_nop 1
v_permlane32_swap_b32 v204, v206
v_permlane32_swap_b32 v205, v207
s_nop 1
v_permlane16_swap_b32 v204, v206
v_permlane16_swap_b32 v205, v207
v_accvgpr_write_b32 a172, v204
v_accvgpr_write_b32 a173, v205
v_accvgpr_write_b32 a174, v206
v_accvgpr_write_b32 a175, v207
v_cvt_pk_bf16_f32 v208, v76, v77
v_cvt_pk_bf16_f32 v209, v78, v79
v_cvt_pk_bf16_f32 v210, v92, v93
v_cvt_pk_bf16_f32 v211, v94, v95
s_nop 1
v_permlane32_swap_b32 v208, v210
v_permlane32_swap_b32 v209, v211
s_nop 1
v_permlane16_swap_b32 v208, v210
v_permlane16_swap_b32 v209, v211
v_accvgpr_write_b32 a176, v208
v_accvgpr_write_b32 a177, v209
v_accvgpr_write_b32 a178, v210
v_accvgpr_write_b32 a179, v211
v_cvt_pk_bf16_f32 v212, v108, v109
v_cvt_pk_bf16_f32 v213, v110, v111
v_cvt_pk_bf16_f32 v214, v124, v125
v_cvt_pk_bf16_f32 v215, v126, v127
s_nop 1
v_permlane32_swap_b32 v212, v214
v_permlane32_swap_b32 v213, v215
s_nop 1
v_permlane16_swap_b32 v212, v214
v_permlane16_swap_b32 v213, v215
v_accvgpr_write_b32 a180, v212
v_accvgpr_write_b32 a181, v213
v_accvgpr_write_b32 a182, v214
v_accvgpr_write_b32 a183, v215
v_cvt_pk_bf16_f32 v216, v140, v141
v_cvt_pk_bf16_f32 v217, v142, v143
v_cvt_pk_bf16_f32 v218, v156, v157
v_cvt_pk_bf16_f32 v219, v158, v159
s_nop 1
v_permlane32_swap_b32 v216, v218
v_permlane32_swap_b32 v217, v219
s_nop 1
v_permlane16_swap_b32 v216, v218
v_permlane16_swap_b32 v217, v219
v_accvgpr_write_b32 a184, v216
v_accvgpr_write_b32 a185, v217
v_accvgpr_write_b32 a186, v218
v_accvgpr_write_b32 a187, v219
v_cvt_pk_bf16_f32 v220, v172, v173
v_cvt_pk_bf16_f32 v221, v174, v175
v_cvt_pk_bf16_f32 v222, v188, v189
v_cvt_pk_bf16_f32 v223, v190, v191
s_nop 1
v_permlane32_swap_b32 v220, v222
v_permlane32_swap_b32 v221, v223
s_nop 1
v_permlane16_swap_b32 v220, v222
v_permlane16_swap_b32 v221, v223
v_accvgpr_write_b32 a188, v220
v_accvgpr_write_b32 a189, v221
v_accvgpr_write_b32 a190, v222
v_accvgpr_write_b32 a191, v223
s_waitcnt vmcnt(0)
s_barrier
s_mov_b32 s47, 32768
s_add_u32 m0, s35, 32768
s_nop 0
buffer_load_dwordx4 v20, s[20:23], s47 offen offset:0 lds
buffer_load_dwordx4 v21, s[20:23], s47 offen offset:1024 lds
buffer_load_dwordx4 v22, s[20:23], s47 offen offset:2048 lds
buffer_load_dwordx4 v23, s[20:23], s47 offen offset:3072 lds
ds_read_b128 a[212:215], v8 offset:0
ds_read_b128 a[216:219], v9 offset:0
ds_read_b128 a[220:223], v10 offset:0
ds_read_b128 a[224:227], v11 offset:0
ds_read_b128 a[228:231], v8 offset:4096
ds_read_b128 a[232:235], v9 offset:4096
ds_read_b128 a[236:239], v10 offset:4096
ds_read_b128 a[240:243], v11 offset:4096
s_waitcnt lgkmcnt(4)
v_mfma_f32_16x16x32_bf16 v[64:67], a[212:215], a[128:131], 0
v_add_u32 v12, 0x8000, v12
v_add_u32 v13, 0x8000, v13
v_mfma_f32_16x16x32_bf16 v[64:67], a[216:219], a[132:135], v[64:67]
v_add_u32 v14, 0x8000, v14
v_add_u32 v15, 0x8000, v15
v_mfma_f32_16x16x32_bf16 v[64:67], a[220:223], a[136:139], v[64:67]
v_add_u32 v16, 0x8000, v16
v_add_u32 v17, 0x8000, v17
v_mfma_f32_16x16x32_bf16 v[64:67], a[224:227], a[140:143], v[64:67]
v_add_u32 v18, 0x8000, v18
v_add_u32 v19, 0x8000, v19
v_mfma_f32_16x16x32_bf16 v[80:83], a[212:215], a[144:147], 0
v_mov_b32 v2, 0x3f803f80
v_cmp_eq_u32 vcc, 0, v5
s_nop 1
v_mfma_f32_16x16x32_bf16 v[80:83], a[216:219], a[148:151], v[80:83]
v_cndmask_b32 v2, 0, v2, vcc
v_accvgpr_write_b32 a208, v2
v_mfma_f32_16x16x32_bf16 v[80:83], a[220:223], a[152:155], v[80:83]
v_accvgpr_write_b32 a209, v2
v_accvgpr_write_b32 a210, v2
v_accvgpr_write_b32 a211, v2
v_mfma_f32_16x16x32_bf16 v[80:83], a[224:227], a[156:159], v[80:83]
v_accvgpr_write_b32 a192, 0
v_accvgpr_write_b32 a193, 0
v_accvgpr_write_b32 a194, 0
v_mfma_f32_16x16x32_bf16 v[96:99], a[212:215], a[160:163], 0
v_accvgpr_write_b32 a195, 0
v_accvgpr_write_b32 a196, 0
v_mfma_f32_16x16x32_bf16 v[96:99], a[216:219], a[164:167], v[96:99]
v_accvgpr_write_b32 a197, 0
v_accvgpr_write_b32 a198, 0
v_accvgpr_write_b32 a199, 0
v_mfma_f32_16x16x32_bf16 v[96:99], a[220:223], a[168:171], v[96:99]
v_accvgpr_write_b32 a200, 0
v_accvgpr_write_b32 a201, 0
v_mfma_f32_16x16x32_bf16 v[96:99], a[224:227], a[172:175], v[96:99]
v_accvgpr_write_b32 a202, 0
v_accvgpr_write_b32 a203, 0
v_accvgpr_write_b32 a204, 0
v_mfma_f32_16x16x32_bf16 v[112:115], a[212:215], a[176:179], 0
v_accvgpr_write_b32 a205, 0
v_accvgpr_write_b32 a206, 0
v_mfma_f32_16x16x32_bf16 v[112:115], a[216:219], a[180:183], v[112:115]
v_accvgpr_write_b32 a207, 0
v_accvgpr_write_b32 a0, 0
v_accvgpr_write_b32 a1, 0
v_mfma_f32_16x16x32_bf16 v[112:115], a[220:223], a[184:187], v[112:115]
v_accvgpr_write_b32 a2, 0
v_accvgpr_write_b32 a3, 0
v_mfma_f32_16x16x32_bf16 v[112:115], a[224:227], a[188:191], v[112:115]
v_accvgpr_write_b32 a4, 0
v_accvgpr_write_b32 a5, 0
v_accvgpr_write_b32 a6, 0
s_waitcnt lgkmcnt(0)
v_mfma_f32_16x16x32_bf16 v[68:71], a[228:231], a[128:131], 0
v_accvgpr_write_b32 a7, 0
v_accvgpr_write_b32 a8, 0
v_mfma_f32_16x16x32_bf16 v[68:71], a[232:235], a[132:135], v[68:71]
v_accvgpr_write_b32 a9, 0
v_accvgpr_write_b32 a10, 0
v_accvgpr_write_b32 a11, 0
v_mfma_f32_16x16x32_bf16 v[68:71], a[236:239], a[136:139], v[68:71]
v_accvgpr_write_b32 a12, 0
v_accvgpr_write_b32 a13, 0
v_mfma_f32_16x16x32_bf16 v[68:71], a[240:243], a[140:143], v[68:71]
v_accvgpr_write_b32 a14, 0
v_accvgpr_write_b32 a15, 0
v_accvgpr_write_b32 a16, 0
v_mfma_f32_16x16x32_bf16 v[84:87], a[228:231], a[144:147], 0
v_accvgpr_write_b32 a17, 0
v_accvgpr_write_b32 a18, 0
v_accvgpr_write_b32 a19, 0
v_mfma_f32_16x16x32_bf16 v[84:87], a[232:235], a[148:151], v[84:87]
v_accvgpr_write_b32 a20, 0
v_accvgpr_write_b32 a21, 0
v_mfma_f32_16x16x32_bf16 v[84:87], a[236:239], a[152:155], v[84:87]
v_accvgpr_write_b32 a22, 0
v_accvgpr_write_b32 a23, 0
v_accvgpr_write_b32 a24, 0
v_mfma_f32_16x16x32_bf16 v[84:87], a[240:243], a[156:159], v[84:87]
v_accvgpr_write_b32 a25, 0
v_accvgpr_write_b32 a26, 0
v_mfma_f32_16x16x32_bf16 v[100:103], a[228:231], a[160:163], 0
ds_read_b128 a[212:215], v8 offset:8192
ds_read_b128 a[216:219], v9 offset:8192
ds_read_b128 a[220:223], v10 offset:8192
ds_read_b128 a[224:227], v11 offset:8192
v_accvgpr_write_b32 a27, 0
v_accvgpr_write_b32 a28, 0
v_accvgpr_write_b32 a29, 0
v_mfma_f32_16x16x32_bf16 v[100:103], a[232:235], a[164:167], v[100:103]
v_accvgpr_write_b32 a30, 0
v_accvgpr_write_b32 a31, 0
v_mfma_f32_16x16x32_bf16 v[100:103], a[236:239], a[168:171], v[100:103]
v_accvgpr_write_b32 a32, 0
v_accvgpr_write_b32 a33, 0
v_accvgpr_write_b32 a34, 0
v_mfma_f32_16x16x32_bf16 v[100:103], a[240:243], a[172:175], v[100:103]
v_accvgpr_write_b32 a35, 0
v_accvgpr_write_b32 a36, 0
v_mfma_f32_16x16x32_bf16 v[116:119], a[228:231], a[176:179], 0
v_accvgpr_write_b32 a37, 0
v_accvgpr_write_b32 a38, 0
v_accvgpr_write_b32 a39, 0
v_mfma_f32_16x16x32_bf16 v[116:119], a[232:235], a[180:183], v[116:119]
v_accvgpr_write_b32 a40, 0
v_accvgpr_write_b32 a41, 0
v_mfma_f32_16x16x32_bf16 v[116:119], a[236:239], a[184:187], v[116:119]
v_accvgpr_write_b32 a42, 0
v_accvgpr_write_b32 a43, 0
v_accvgpr_write_b32 a44, 0
v_mfma_f32_16x16x32_bf16 v[116:119], a[240:243], a[188:191], v[116:119]
v_accvgpr_write_b32 a45, 0
v_accvgpr_write_b32 a46, 0
s_waitcnt lgkmcnt(0)
v_mfma_f32_16x16x32_bf16 v[72:75], a[212:215], a[128:131], 0
v_accvgpr_write_b32 a47, 0
v_accvgpr_write_b32 a48, 0
v_accvgpr_write_b32 a49, 0
v_mfma_f32_16x16x32_bf16 v[72:75], a[216:219], a[132:135], v[72:75]
v_accvgpr_write_b32 a50, 0
v_accvgpr_write_b32 a51, 0
v_accvgpr_write_b32 a52, 0
v_mfma_f32_16x16x32_bf16 v[72:75], a[220:223], a[136:139], v[72:75]
v_accvgpr_write_b32 a53, 0
v_accvgpr_write_b32 a54, 0
v_mfma_f32_16x16x32_bf16 v[72:75], a[224:227], a[140:143], v[72:75]
v_accvgpr_write_b32 a55, 0
v_accvgpr_write_b32 a56, 0
v_accvgpr_write_b32 a57, 0
v_mfma_f32_16x16x32_bf16 v[88:91], a[212:215], a[144:147], 0
v_accvgpr_write_b32 a58, 0
v_accvgpr_write_b32 a59, 0
v_mfma_f32_16x16x32_bf16 v[88:91], a[216:219], a[148:151], v[88:91]
v_accvgpr_write_b32 a60, 0
v_accvgpr_write_b32 a61, 0
v_accvgpr_write_b32 a62, 0
v_mfma_f32_16x16x32_bf16 v[88:91], a[220:223], a[152:155], v[88:91]
v_accvgpr_write_b32 a63, 0
v_accvgpr_write_b32 a64, 0
v_mfma_f32_16x16x32_bf16 v[88:91], a[224:227], a[156:159], v[88:91]
v_accvgpr_write_b32 a65, 0
v_accvgpr_write_b32 a66, 0
v_accvgpr_write_b32 a67, 0
v_mfma_f32_16x16x32_bf16 v[104:107], a[212:215], a[160:163], 0
ds_read_b128 a[228:231], v8 offset:12288
ds_read_b128 a[232:235], v9 offset:12288
ds_read_b128 a[236:239], v10 offset:12288
ds_read_b128 a[240:243], v11 offset:12288
v_accvgpr_write_b32 a68, 0
v_accvgpr_write_b32 a69, 0
v_mfma_f32_16x16x32_bf16 v[104:107], a[216:219], a[164:167], v[104:107]
v_accvgpr_write_b32 a70, 0
v_accvgpr_write_b32 a71, 0
v_accvgpr_write_b32 a72, 0
v_mfma_f32_16x16x32_bf16 v[104:107], a[220:223], a[168:171], v[104:107]
v_accvgpr_write_b32 a73, 0
v_accvgpr_write_b32 a74, 0
v_mfma_f32_16x16x32_bf16 v[104:107], a[224:227], a[172:175], v[104:107]
v_accvgpr_write_b32 a75, 0
v_accvgpr_write_b32 a76, 0
v_accvgpr_write_b32 a77, 0
v_mfma_f32_16x16x32_bf16 v[120:123], a[212:215], a[176:179], 0
v_accvgpr_write_b32 a78, 0
v_accvgpr_write_b32 a79, 0
v_accvgpr_write_b32 a80, 0
v_mfma_f32_16x16x32_bf16 v[120:123], a[216:219], a[180:183], v[120:123]
v_accvgpr_write_b32 a81, 0
v_accvgpr_write_b32 a82, 0
v_mfma_f32_16x16x32_bf16 v[120:123], a[220:223], a[184:187], v[120:123]
v_accvgpr_write_b32 a83, 0
v_accvgpr_write_b32 a84, 0
v_accvgpr_write_b32 a85, 0
v_mfma_f32_16x16x32_bf16 v[120:123], a[224:227], a[188:191], v[120:123]
v_accvgpr_write_b32 a86, 0
v_accvgpr_write_b32 a87, 0
s_waitcnt lgkmcnt(0)
v_mfma_f32_16x16x32_bf16 v[76:79], a[228:231], a[128:131], 0
v_accvgpr_write_b32 a88, 0
v_accvgpr_write_b32 a89, 0
v_accvgpr_write_b32 a90, 0
v_mfma_f32_16x16x32_bf16 v[76:79], a[232:235], a[132:135], v[76:79]
v_accvgpr_write_b32 a91, 0
v_accvgpr_write_b32 a92, 0
v_mfma_f32_16x16x32_bf16 v[76:79], a[236:239], a[136:139], v[76:79]
v_accvgpr_write_b32 a93, 0
v_accvgpr_write_b32 a94, 0
v_accvgpr_write_b32 a95, 0
v_mfma_f32_16x16x32_bf16 v[76:79], a[240:243], a[140:143], v[76:79]
v_accvgpr_write_b32 a96, 0
v_accvgpr_write_b32 a97, 0
v_mfma_f32_16x16x32_bf16 v[92:95], a[228:231], a[144:147], 0
v_accvgpr_write_b32 a98, 0
v_accvgpr_write_b32 a99, 0
v_accvgpr_write_b32 a100, 0
v_mfma_f32_16x16x32_bf16 v[92:95], a[232:235], a[148:151], v[92:95]
v_accvgpr_write_b32 a101, 0
v_accvgpr_write_b32 a102, 0
v_mfma_f32_16x16x32_bf16 v[92:95], a[236:239], a[152:155], v[92:95]
v_accvgpr_write_b32 a103, 0
v_accvgpr_write_b32 a104, 0
v_accvgpr_write_b32 a105, 0
v_mfma_f32_16x16x32_bf16 v[92:95], a[240:243], a[156:159], v[92:95]
v_accvgpr_write_b32 a106, 0
v_accvgpr_write_b32 a107, 0
v_mfma_f32_16x16x32_bf16 v[108:111], a[228:231], a[160:163], 0
ds_read_b128 a[212:215], v8 offset:16384
ds_read_b128 a[216:219], v9 offset:16384
ds_read_b128 a[220:223], v10 offset:16384
ds_read_b128 a[224:227], v11 offset:16384
v_accvgpr_write_b32 a108, 0
v_accvgpr_write_b32 a109, 0
v_accvgpr_write_b32 a110, 0
v_mfma_f32_16x16x32_bf16 v[108:111], a[232:235], a[164:167], v[108:111]
v_accvgpr_write_b32 a111, 0
v_accvgpr_write_b32 a112, 0
v_accvgpr_write_b32 a113, 0
v_mfma_f32_16x16x32_bf16 v[108:111], a[236:239], a[168:171], v[108:111]
v_accvgpr_write_b32 a114, 0
v_accvgpr_write_b32 a115, 0
v_mfma_f32_16x16x32_bf16 v[108:111], a[240:243], a[172:175], v[108:111]
v_accvgpr_write_b32 a116, 0
v_accvgpr_write_b32 a117, 0
v_accvgpr_write_b32 a118, 0
v_mfma_f32_16x16x32_bf16 v[124:127], a[228:231], a[176:179], 0
v_accvgpr_write_b32 a119, 0
v_accvgpr_write_b32 a120, 0
v_mfma_f32_16x16x32_bf16 v[124:127], a[232:235], a[180:183], v[124:127]
v_accvgpr_write_b32 a121, 0
v_accvgpr_write_b32 a122, 0
v_accvgpr_write_b32 a123, 0
v_mfma_f32_16x16x32_bf16 v[124:127], a[236:239], a[184:187], v[124:127]
v_accvgpr_write_b32 a124, 0
v_accvgpr_write_b32 a125, 0
v_mfma_f32_16x16x32_bf16 v[124:127], a[240:243], a[188:191], v[124:127]
v_accvgpr_write_b32 a126, 0
v_accvgpr_write_b32 a127, 0
s_nop 7
v_max3_f32 v52, v64, v65, v66
v_max3_f32 v52, v52, v67, v68
v_max3_f32 v52, v52, v69, v70
v_max3_f32 v52, v52, v71, v72
v_max3_f32 v52, v52, v73, v74
v_max3_f32 v52, v52, v75, v76
v_max3_f32 v52, v52, v77, v78
v_max_f32 v52, v52, v79
v_max3_f32 v53, v80, v81, v82
v_max3_f32 v53, v53, v83, v84
v_max3_f32 v53, v53, v85, v86
v_max3_f32 v53, v53, v87, v88
v_max3_f32 v53, v53, v89, v90
v_max3_f32 v53, v53, v91, v92
v_max3_f32 v53, v53, v93, v94
v_max_f32 v53, v53, v95
v_max3_f32 v54, v96, v97, v98
v_max3_f32 v54, v54, v99, v100
v_max3_f32 v54, v54, v101, v102
v_max3_f32 v54, v54, v103, v104
v_max3_f32 v54, v54, v105, v106
v_max3_f32 v54, v54, v107, v108
v_max3_f32 v54, v54, v109, v110
v_max_f32 v54, v54, v111
v_max3_f32 v55, v112, v113, v114
v_max3_f32 v55, v55, v115, v116
v_max3_f32 v55, v55, v117, v118
v_max3_f32 v55, v55, v119, v120
v_max3_f32 v55, v55, v121, v122
v_max3_f32 v55, v55, v123, v124
v_max3_f32 v55, v55, v125, v126
v_max_f32 v55, v55, v127
v_mov_b32 v60, v52
s_nop 1
v_permlane16_swap_b32 v52, v60
v_max_f32 v52, v52, v60
v_mov_b32 v60, v52
s_nop 1
v_permlane32_swap_b32 v52, v60
v_max_f32 v52, v52, v60
v_mov_b32 v60, v53
s_nop 1
v_permlane16_swap_b32 v53, v60
v_max_f32 v53, v53, v60
v_mov_b32 v60, v53
s_nop 1
v_permlane32_swap_b32 v53, v60
v_max_f32 v53, v53, v60
v_mov_b32 v60, v54
s_nop 1
v_permlane16_swap_b32 v54, v60
v_max_f32 v54, v54, v60
v_mov_b32 v60, v54
s_nop 1
v_permlane32_swap_b32 v54, v60
v_max_f32 v54, v54, v60
v_mov_b32 v60, v55
s_nop 1
v_permlane16_swap_b32 v55, v60
v_max_f32 v55, v55, v60
v_mov_b32 v60, v55
s_nop 1
v_permlane32_swap_b32 v55, v60
v_max_f32 v55, v55, v60
v_add_f32 v52, s43, v52
v_sub_f32 v36, 0, v52
v_sub_f32 v37, 0, v52
v_sub_f32 v38, 0, v52
v_sub_f32 v39, 0, v52
v_sub_f32 v64, v64, v52
v_sub_f32 v65, v65, v52
v_sub_f32 v66, v66, v52
v_sub_f32 v67, v67, v52
v_sub_f32 v68, v68, v52
v_sub_f32 v69, v69, v52
v_sub_f32 v70, v70, v52
v_sub_f32 v71, v71, v52
v_sub_f32 v72, v72, v52
v_sub_f32 v73, v73, v52
v_sub_f32 v74, v74, v52
v_sub_f32 v75, v75, v52
v_sub_f32 v76, v76, v52
v_sub_f32 v77, v77, v52
v_sub_f32 v78, v78, v52
v_sub_f32 v79, v79, v52
v_add_f32 v53, s43, v53
v_sub_f32 v40, 0, v53
v_sub_f32 v41, 0, v53
v_sub_f32 v42, 0, v53
v_sub_f32 v43, 0, v53
v_sub_f32 v80, v80, v53
v_sub_f32 v81, v81, v53
v_sub_f32 v82, v82, v53
v_sub_f32 v83, v83, v53
v_sub_f32 v84, v84, v53
v_sub_f32 v85, v85, v53
v_sub_f32 v86, v86, v53
v_sub_f32 v87, v87, v53
v_sub_f32 v88, v88, v53
v_sub_f32 v89, v89, v53
v_sub_f32 v90, v90, v53
v_sub_f32 v91, v91, v53
v_sub_f32 v92, v92, v53
v_sub_f32 v93, v93, v53
v_sub_f32 v94, v94, v53
v_sub_f32 v95, v95, v53
v_add_f32 v54, s43, v54
v_sub_f32 v44, 0, v54
v_sub_f32 v45, 0, v54
v_sub_f32 v46, 0, v54
v_sub_f32 v47, 0, v54
v_sub_f32 v96, v96, v54
v_sub_f32 v97, v97, v54
v_sub_f32 v98, v98, v54
v_sub_f32 v99, v99, v54
v_sub_f32 v100, v100, v54
v_sub_f32 v101, v101, v54
v_sub_f32 v102, v102, v54
v_sub_f32 v103, v103, v54
v_sub_f32 v104, v104, v54
v_sub_f32 v105, v105, v54
v_sub_f32 v106, v106, v54
v_sub_f32 v107, v107, v54
v_sub_f32 v108, v108, v54
v_sub_f32 v109, v109, v54
v_sub_f32 v110, v110, v54
v_sub_f32 v111, v111, v54
v_add_f32 v55, s43, v55
v_sub_f32 v48, 0, v55
v_sub_f32 v49, 0, v55
v_sub_f32 v50, 0, v55
v_sub_f32 v51, 0, v55
v_sub_f32 v112, v112, v55
v_sub_f32 v113, v113, v55
v_sub_f32 v114, v114, v55
v_sub_f32 v115, v115, v55
v_sub_f32 v116, v116, v55
v_sub_f32 v117, v117, v55
v_sub_f32 v118, v118, v55
v_sub_f32 v119, v119, v55
v_sub_f32 v120, v120, v55
v_sub_f32 v121, v121, v55
v_sub_f32 v122, v122, v55
v_sub_f32 v123, v123, v55
v_sub_f32 v124, v124, v55
v_sub_f32 v125, v125, v55
v_sub_f32 v126, v126, v55
v_sub_f32 v127, v127, v55
v_exp_f32 v64, v64
v_exp_f32 v65, v65
v_exp_f32 v66, v66
v_exp_f32 v67, v67
v_exp_f32 v68, v68
v_exp_f32 v69, v69
v_exp_f32 v70, v70
v_exp_f32 v71, v71
s_nop 0
v_cvt_pk_bf16_f32 v64, v64, v65
v_cvt_pk_bf16_f32 v65, v66, v67
v_cvt_pk_bf16_f32 v66, v68, v69
v_cvt_pk_bf16_f32 v67, v70, v71
v_exp_f32 v72, v72
v_exp_f32 v73, v73
v_exp_f32 v74, v74
v_exp_f32 v75, v75
v_exp_f32 v76, v76
v_exp_f32 v77, v77
v_exp_f32 v78, v78
v_exp_f32 v79, v79
s_nop 0
v_cvt_pk_bf16_f32 v72, v72, v73
v_cvt_pk_bf16_f32 v73, v74, v75
v_cvt_pk_bf16_f32 v74, v76, v77
v_cvt_pk_bf16_f32 v75, v78, v79
v_exp_f32 v80, v80
v_exp_f32 v81, v81
v_exp_f32 v82, v82
v_exp_f32 v83, v83
v_exp_f32 v84, v84
v_exp_f32 v85, v85
v_exp_f32 v86, v86
v_exp_f32 v87, v87
s_nop 0
v_cvt_pk_bf16_f32 v80, v80, v81
v_cvt_pk_bf16_f32 v81, v82, v83
v_cvt_pk_bf16_f32 v82, v84, v85
v_cvt_pk_bf16_f32 v83, v86, v87
v_exp_f32 v88, v88
v_exp_f32 v89, v89
v_exp_f32 v90, v90
v_exp_f32 v91, v91
v_exp_f32 v92, v92
v_exp_f32 v93, v93
v_exp_f32 v94, v94
v_exp_f32 v95, v95
s_nop 0
v_cvt_pk_bf16_f32 v88, v88, v89
v_cvt_pk_bf16_f32 v89, v90, v91
v_cvt_pk_bf16_f32 v90, v92, v93
v_cvt_pk_bf16_f32 v91, v94, v95
s_mov_b32 s44, 49152
s_mov_b32 s47, 32768
s_mov_b32 s36, 7
L_attn_kernel_loop:
s_waitcnt lgkmcnt(0)
v_mfma_f32_16x16x32_bf16 v[128:131], a[212:215], a[128:131], v[36:39]
v_exp_f32 v96, v96
v_mfma_f32_16x16x32_bf16 v[128:131], a[216:219], a[132:135], v[128:131]
v_exp_f32 v97, v97
v_mfma_f32_16x16x32_bf16 v[128:131], a[220:223], a[136:139], v[128:131]
v_exp_f32 v98, v98
v_mfma_f32_16x16x32_bf16 v[128:131], a[224:227], a[140:143], v[128:131]
ds_read_b128 a[228:231], v8 offset:20480
v_cvt_pk_bf16_f32 v96, v96, v97
v_mfma_f32_16x16x32_bf16 v[144:147], a[212:215], a[144:147], v[40:43]
ds_read_b128 a[232:235], v9 offset:20480
s_add_u32 m0, s35, 49152
v_mfma_f32_16x16x32_bf16 v[144:147], a[216:219], a[148:151], v[144:147]
buffer_load_dwordx4 v20, s[20:23], s44 offen offset:0 lds
v_mfma_f32_16x16x32_bf16 v[144:147], a[220:223], a[152:155], v[144:147]
v_exp_f32 v99, v99
v_mfma_f32_16x16x32_bf16 v[144:147], a[224:227], a[156:159], v[144:147]
ds_read_b128 a[236:239], v10 offset:20480
v_cvt_pk_bf16_f32 v97, v98, v99
v_mfma_f32_16x16x32_bf16 v[160:163], a[212:215], a[160:163], v[44:47]
ds_read_b128 a[240:243], v11 offset:20480
v_exp_f32 v100, v100
v_mfma_f32_16x16x32_bf16 v[160:163], a[216:219], a[164:167], v[160:163]
v_exp_f32 v101, v101
v_mfma_f32_16x16x32_bf16 v[160:163], a[220:223], a[168:171], v[160:163]
buffer_load_dwordx4 v21, s[20:23], s44 offen offset:1024 lds
v_mfma_f32_16x16x32_bf16 v[160:163], a[224:227], a[172:175], v[160:163]
v_exp_f32 v102, v102
v_mfma_f32_16x16x32_bf16 v[176:179], a[212:215], a[176:179], v[48:51]
v_max3_f32 v52, v128, v129, v130
v_max3_f32 v53, v144, v145, v146
v_mfma_f32_16x16x32_bf16 v[176:179], a[216:219], a[180:183], v[176:179]
v_exp_f32 v103, v103
v_mfma_f32_16x16x32_bf16 v[176:179], a[220:223], a[184:187], v[176:179]
v_exp_f32 v104, v104
v_mfma_f32_16x16x32_bf16 v[176:179], a[224:227], a[188:191], v[176:179]
ds_read_b128 a[212:215], v8 offset:24576
s_waitcnt lgkmcnt(1)
v_mfma_f32_16x16x32_bf16 v[132:135], a[228:231], a[128:131], v[36:39]
v_exp_f32 v105, v105
v_mfma_f32_16x16x32_bf16 v[132:135], a[232:235], a[132:135], v[132:135]
v_exp_f32 v106, v106
v_mfma_f32_16x16x32_bf16 v[132:135], a[236:239], a[136:139], v[132:135]
v_exp_f32 v107, v107
v_mfma_f32_16x16x32_bf16 v[132:135], a[240:243], a[140:143], v[132:135]
ds_read_b128 a[216:219], v9 offset:24576
v_max3_f32 v54, v160, v161, v162
v_mfma_f32_16x16x32_bf16 v[148:151], a[228:231], a[144:147], v[40:43]
v_exp_f32 v108, v108
v_mfma_f32_16x16x32_bf16 v[148:151], a[232:235], a[148:151], v[148:151]
v_exp_f32 v109, v109
v_mfma_f32_16x16x32_bf16 v[148:151], a[236:239], a[152:155], v[148:151]
ds_read_b128 a[220:223], v10 offset:24576
v_max3_f32 v55, v176, v177, v178
v_mfma_f32_16x16x32_bf16 v[148:151], a[240:243], a[156:159], v[148:151]
v_exp_f32 v110, v110
v_mfma_f32_16x16x32_bf16 v[164:167], a[228:231], a[160:163], v[44:47]
ds_read_b128 a[224:227], v11 offset:24576
v_cvt_pk_bf16_f32 v98, v100, v101
v_mfma_f32_16x16x32_bf16 v[164:167], a[232:235], a[164:167], v[164:167]
v_exp_f32 v111, v111
v_mfma_f32_16x16x32_bf16 v[164:167], a[236:239], a[168:171], v[164:167]
s_cmp_lg_u32 s45, 0
s_cbranch_scc1 L_attn_kernel_resc_a_0
L_attn_kernel_rback_a_0:
v_mfma_f32_16x16x32_bf16 v[164:167], a[240:243], a[172:175], v[164:167]
v_exp_f32 v112, v112
v_mfma_f32_16x16x32_bf16 v[180:183], a[228:231], a[176:179], v[48:51]
v_exp_f32 v113, v113
v_mfma_f32_16x16x32_bf16 v[180:183], a[232:235], a[180:183], v[180:183]
v_max3_f32 v52, v52, v131, v132
v_cvt_pk_bf16_f32 v99, v102, v103
v_mfma_f32_16x16x32_bf16 v[180:183], a[236:239], a[184:187], v[180:183]
v_exp_f32 v114, v114
v_mfma_f32_16x16x32_bf16 v[180:183], a[240:243], a[188:191], v[180:183]
v_max3_f32 v53, v53, v147, v148
s_waitcnt lgkmcnt(0)
v_mfma_f32_16x16x32_bf16 v[136:139], a[212:215], a[128:131], v[36:39]
v_cvt_pk_bf16_f32 v104, v104, v105
v_max3_f32 v54, v54, v163, v164
v_mfma_f32_16x16x32_bf16 v[136:139], a[216:219], a[132:135], v[136:139]
ds_read_b128 a[228:231], v8 offset:28672
v_cvt_pk_bf16_f32 v105, v106, v107
v_mfma_f32_16x16x32_bf16 v[136:139], a[220:223], a[136:139], v[136:139]
ds_read_b128 a[232:235], v9 offset:28672
v_cvt_pk_bf16_f32 v106, v108, v109
v_mfma_f32_16x16x32_bf16 v[136:139], a[224:227], a[140:143], v[136:139]
v_exp_f32 v115, v115
v_mfma_f32_16x16x32_bf16 v[152:155], a[212:215], a[144:147], v[40:43]
ds_read_b128 a[236:239], v10 offset:28672
v_cvt_pk_bf16_f32 v107, v110, v111
v_mfma_f32_16x16x32_bf16 v[152:155], a[216:219], a[148:151], v[152:155]
v_exp_f32 v116, v116
v_mfma_f32_16x16x32_bf16 v[152:155], a[220:223], a[152:155], v[152:155]
v_cvt_pk_bf16_f32 v112, v112, v113
v_max3_f32 v55, v55, v179, v180
v_mfma_f32_16x16x32_bf16 v[152:155], a[224:227], a[156:159], v[152:155]
ds_read_b128 a[240:243], v11 offset:28672
v_max3_f32 v52, v52, v133, v134
v_mfma_f32_16x16x32_bf16 v[168:171], a[212:215], a[160:163], v[44:47]
v_exp_f32 v117, v117
v_mfma_f32_16x16x32_bf16 v[168:171], a[216:219], a[164:167], v[168:171]
v_max3_f32 v53, v53, v149, v150
v_max3_f32 v54, v54, v165, v166
v_mfma_f32_16x16x32_bf16 v[168:171], a[220:223], a[168:171], v[168:171]
buffer_load_dwordx4 v22, s[20:23], s44 offen offset:2048 lds
v_mfma_f32_16x16x32_bf16 v[168:171], a[224:227], a[172:175], v[168:171]
v_exp_f32 v118, v118
v_mfma_f32_16x16x32_bf16 v[184:187], a[212:215], a[176:179], v[48:51]
v_exp_f32 v119, v119
v_mfma_f32_16x16x32_bf16 v[184:187], a[216:219], a[180:183], v[184:187]
v_exp_f32 v120, v120
v_mfma_f32_16x16x32_bf16 v[184:187], a[220:223], a[184:187], v[184:187]
v_exp_f32 v121, v121
v_mfma_f32_16x16x32_bf16 v[184:187], a[224:227], a[188:191], v[184:187]
ds_read_b64_tr_b16 a[212:213], v12 offset:32768
s_waitcnt lgkmcnt(1)
v_mfma_f32_16x16x32_bf16 v[140:143], a[228:231], a[128:131], v[36:39]
v_exp_f32 v122, v122
v_mfma_f32_16x16x32_bf16 v[140:143], a[232:235], a[132:135], v[140:143]
ds_read_b64_tr_b16 a[214:215], v12 offset:36864
v_cvt_pk_bf16_f32 v113, v114, v115
v_cvt_pk_bf16_f32 v114, v116, v117
v_mfma_f32_16x16x32_bf16 v[140:143], a[236:239], a[136:139], v[140:143]
v_exp_f32 v123, v123
v_mfma_f32_16x16x32_bf16 v[140:143], a[240:243], a[140:143], v[140:143]
ds_read_b64_tr_b16 a[216:217], v12 offset:40960
v_max3_f32 v55, v55, v181, v182
v_mfma_f32_16x16x32_bf16 v[156:159], a[228:231], a[144:147], v[40:43]
ds_read_b64_tr_b16 a[218:219], v12 offset:45056
v_cvt_pk_bf16_f32 v115, v118, v119
v_mfma_f32_16x16x32_bf16 v[156:159], a[232:235], a[148:151], v[156:159]
ds_read_b64_tr_b16 a[220:221], v13 offset:32768
v_max3_f32 v52, v52, v135, v136
v_mfma_f32_16x16x32_bf16 v[156:159], a[236:239], a[152:155], v[156:159]
v_exp_f32 v124, v124
v_mfma_f32_16x16x32_bf16 v[156:159], a[240:243], a[156:159], v[156:159]
ds_read_b64_tr_b16 a[222:223], v13 offset:36864
v_max3_f32 v53, v53, v151, v152
v_mfma_f32_16x16x32_bf16 v[172:175], a[228:231], a[160:163], v[44:47]
v_exp_f32 v125, v125
v_mfma_f32_16x16x32_bf16 v[172:175], a[232:235], a[164:167], v[172:175]
buffer_load_dwordx4 v23, s[20:23], s44 offen offset:3072 lds
v_mfma_f32_16x16x32_bf16 v[172:175], a[236:239], a[168:171], v[172:175]
s_add_u32 m0, s35, 65536
v_cvt_pk_bf16_f32 v120, v120, v121
v_mfma_f32_16x16x32_bf16 v[172:175], a[240:243], a[172:175], v[172:175]
v_cvt_pk_bf16_f32 v121, v122, v123
v_max3_f32 v54, v54, v167, v168
v_mfma_f32_16x16x32_bf16 v[188:191], a[228:231], a[176:179], v[48:51]
v_exp_f32 v126, v126
v_mfma_f32_16x16x32_bf16 v[188:191], a[232:235], a[180:183], v[188:191]
ds_read_b64_tr_b16 a[224:225], v13 offset:40960
v_max3_f32 v55, v55, v183, v184
v_mfma_f32_16x16x32_bf16 v[188:191], a[236:239], a[184:187], v[188:191]
v_exp_f32 v127, v127
v_mfma_f32_16x16x32_bf16 v[188:191], a[240:243], a[188:191], v[188:191]
v_cvt_pk_bf16_f32 v122, v124, v125
v_cvt_pk_bf16_f32 v123, v126, v127
v_mfma_f32_16x16x32_bf16 a[192:195], a[208:211], v[64:67], a[192:195]
v_max3_f32 v52, v52, v137, v138
v_max3_f32 v53, v53, v153, v154
v_mfma_f32_16x16x32_bf16 a[192:195], a[208:211], v[72:75], a[192:195]
ds_read_b64_tr_b16 a[226:227], v13 offset:45056
v_max3_f32 v54, v54, v169, v170
v_max3_f32 v55, v55, v185, v186
v_mfma_f32_16x16x32_bf16 a[196:199], a[208:211], v[80:83], a[196:199]
ds_read_b64_tr_b16 a[228:229], v14 offset:32768
v_max3_f32 v52, v52, v139, v140
v_mfma_f32_16x16x32_bf16 a[196:199], a[208:211], v[88:91], a[196:199]
v_max3_f32 v53, v53, v155, v156
v_max3_f32 v54, v54, v171, v172
v_max3_f32 v55, v55, v187, v188
v_mfma_f32_16x16x32_bf16 a[200:203], a[208:211], v[96:99], a[200:203]
ds_read_b64_tr_b16 a[230:231], v14 offset:36864
v_max3_f32 v52, v52, v141, v142
v_mfma_f32_16x16x32_bf16 a[200:203], a[208:211], v[104:107], a[200:203]
ds_read_b64_tr_b16 a[232:233], v14 offset:40960
v_max3_f32 v53, v53, v157, v158
v_mfma_f32_16x16x32_bf16 a[204:207], a[208:211], v[112:115], a[204:207]
ds_read_b64_tr_b16 a[234:235], v14 offset:45056
v_max3_f32 v54, v54, v173, v174
v_mfma_f32_16x16x32_bf16 a[204:207], a[208:211], v[120:123], a[204:207]
ds_read_b64_tr_b16 a[236:237], v15 offset:32768
s_waitcnt lgkmcnt(5)
v_mfma_f32_16x16x32_bf16 a[0:3], a[212:215], v[64:67], a[0:3]
ds_read_b64_tr_b16 a[238:239], v15 offset:36864
v_max3_f32 v55, v55, v189, v190
v_mfma_f32_16x16x32_bf16 a[0:3], a[216:219], v[72:75], a[0:3]
v_max_f32 v52, v52, v143
v_max_f32 v53, v53, v159
v_mfma_f32_16x16x32_bf16 a[4:7], a[212:215], v[80:83], a[4:7]
v_max_f32 v54, v54, v175
v_max_f32 v55, v55, v191
v_mfma_f32_16x16x32_bf16 a[4:7], a[216:219], v[88:91], a[4:7]
buffer_load_dwordx4 v24, s[24:27], s47 offen offset:0 lds
v_mfma_f32_16x16x32_bf16 a[8:11], a[212:215], v[96:99], a[8:11]
ds_read_b64_tr_b16 a[240:241], v15 offset:40960
v_max3_f32 v60, v52, v53, v54
v_mfma_f32_16x16x32_bf16 a[8:11], a[216:219], v[104:107], a[8:11]
ds_read_b64_tr_b16 a[242:243], v15 offset:45056
v_max_f32 v60, v60, v55
v_mfma_f32_16x16x32_bf16 a[12:15], a[212:215], v[112:115], a[12:15]
v_cmp_lt_f32 vcc, s46, v60
s_cbranch_vccnz L_attn_kernel_rare_a_0
L_attn_kernel_back_a_0:
v_mfma_f32_16x16x32_bf16 a[12:15], a[216:219], v[120:123], a[12:15]
v_exp_f32 v128, v128
v_mfma_f32_16x16x32_bf16 a[16:19], a[220:223], v[64:67], a[16:19]
buffer_load_dwordx4 v25, s[24:27], s47 offen offset:1024 lds
v_mfma_f32_16x16x32_bf16 a[16:19], a[224:227], v[72:75], a[16:19]
ds_read_b64_tr_b16 a[212:213], v16 offset:32768
v_mfma_f32_16x16x32_bf16 a[20:23], a[220:223], v[80:83], a[20:23]
v_exp_f32 v129, v129
v_mfma_f32_16x16x32_bf16 a[20:23], a[224:227], v[88:91], a[20:23]
v_exp_f32 v130, v130
v_mfma_f32_16x16x32_bf16 a[24:27], a[220:223], v[96:99], a[24:27]
buffer_load_dwordx4 v24, s[24:27], s47 offen offset:2048 lds
v_mfma_f32_16x16x32_bf16 a[24:27], a[224:227], v[104:107], a[24:27]
v_exp_f32 v131, v131
v_mfma_f32_16x16x32_bf16 a[28:31], a[220:223], v[112:115], a[28:31]
ds_read_b64_tr_b16 a[214:215], v16 offset:36864
v_cvt_pk_bf16_f32 v128, v128, v129
v_mfma_f32_16x16x32_bf16 a[28:31], a[224:227], v[120:123], a[28:31]
ds_read_b64_tr_b16 a[216:217], v16 offset:40960
s_waitcnt lgkmcnt(3)
v_mfma_f32_16x16x32_bf16 a[32:35], a[228:231], v[64:67], a[32:35]
v_exp_f32 v132, v132
v_mfma_f32_16x16x32_bf16 a[32:35], a[232:235], v[72:75], a[32:35]
v_exp_f32 v133, v133
v_mfma_f32_16x16x32_bf16 a[36:39], a[228:231], v[80:83], a[36:39]
ds_read_b64_tr_b16 a[218:219], v16 offset:45056
v_exp_f32 v134, v134
v_mfma_f32_16x16x32_bf16 a[36:39], a[232:235], v[88:91], a[36:39]
ds_read_b64_tr_b16 a[220:221], v17 offset:32768
v_exp_f32 v135, v135
v_mfma_f32_16x16x32_bf16 a[40:43], a[228:231], v[96:99], a[40:43]
ds_read_b64_tr_b16 a[222:223], v17 offset:36864
v_cvt_pk_bf16_f32 v129, v130, v131
v_mfma_f32_16x16x32_bf16 a[40:43], a[232:235], v[104:107], a[40:43]
ds_read_b64_tr_b16 a[224:225], v17 offset:40960
v_cvt_pk_bf16_f32 v130, v132, v133
v_mfma_f32_16x16x32_bf16 a[44:47], a[228:231], v[112:115], a[44:47]
ds_read_b64_tr_b16 a[226:227], v17 offset:45056
v_exp_f32 v136, v136
v_mfma_f32_16x16x32_bf16 a[44:47], a[232:235], v[120:123], a[44:47]
v_exp_f32 v137, v137
v_mfma_f32_16x16x32_bf16 a[48:51], a[236:239], v[64:67], a[48:51]
buffer_load_dwordx4 v25, s[24:27], s47 offen offset:3072 lds
v_mfma_f32_16x16x32_bf16 a[48:51], a[240:243], v[72:75], a[48:51]
v_exp_f32 v138, v138
v_mfma_f32_16x16x32_bf16 a[52:55], a[236:239], v[80:83], a[52:55]
v_exp_f32 v139, v139
v_mfma_f32_16x16x32_bf16 a[52:55], a[240:243], v[88:91], a[52:55]
v_exp_f32 v140, v140
v_mfma_f32_16x16x32_bf16 a[56:59], a[236:239], v[96:99], a[56:59]
buffer_load_dwordx4 v[192:195], v3, s[48:51], s52 offen
v_mfma_f32_16x16x32_bf16 a[56:59], a[240:243], v[104:107], a[56:59]
v_exp_f32 v141, v141
v_mfma_f32_16x16x32_bf16 a[60:63], a[236:239], v[112:115], a[60:63]
ds_read_b64_tr_b16 a[228:229], v18 offset:32768
v_mfma_f32_16x16x32_bf16 a[60:63], a[240:243], v[120:123], a[60:63]
ds_read_b64_tr_b16 a[230:231], v18 offset:36864
s_waitcnt lgkmcnt(2)
v_mfma_f32_16x16x32_bf16 a[64:67], a[212:215], v[64:67], a[64:67]
ds_read_b64_tr_b16 a[232:233], v18 offset:40960
v_cvt_pk_bf16_f32 v131, v134, v135
v_mfma_f32_16x16x32_bf16 a[64:67], a[216:219], v[72:75], a[64:67]
ds_read_b64_tr_b16 a[234:235], v18 offset:45056
v_cvt_pk_bf16_f32 v136, v136, v137
v_mfma_f32_16x16x32_bf16 a[68:71], a[212:215], v[80:83], a[68:71]
v_exp_f32 v142, v142
v_mfma_f32_16x16x32_bf16 a[68:71], a[216:219], v[88:91], a[68:71]
ds_read_b64_tr_b16 a[236:237], v19 offset:32768
v_exp_f32 v143, v143
v_mfma_f32_16x16x32_bf16 a[72:75], a[212:215], v[96:99], a[72:75]
v_exp_f32 v144, v144
v_mfma_f32_16x16x32_bf16 a[72:75], a[216:219], v[104:107], a[72:75]
ds_read_b64_tr_b16 a[238:239], v19 offset:36864
v_cvt_pk_bf16_f32 v137, v138, v139
v_mfma_f32_16x16x32_bf16 a[76:79], a[212:215], v[112:115], a[76:79]
ds_read_b64_tr_b16 a[240:241], v19 offset:40960
v_cvt_pk_bf16_f32 v138, v140, v141
v_mfma_f32_16x16x32_bf16 a[76:79], a[216:219], v[120:123], a[76:79]
ds_read_b64_tr_b16 a[242:243], v19 offset:45056
v_exp_f32 v145, v145
v_mfma_f32_16x16x32_bf16 a[80:83], a[220:223], v[64:67], a[80:83]
v_exp_f32 v146, v146
v_mfma_f32_16x16x32_bf16 a[80:83], a[224:227], v[72:75], a[80:83]
v_exp_f32 v147, v147
v_mfma_f32_16x16x32_bf16 a[84:87], a[220:223], v[80:83], a[84:87]
v_exp_f32 v148, v148
v_mfma_f32_16x16x32_bf16 a[84:87], a[224:227], v[88:91], a[84:87]
v_exp_f32 v149, v149
v_mfma_f32_16x16x32_bf16 a[88:91], a[220:223], v[96:99], a[88:91]
v_exp_f32 v150, v150
v_mfma_f32_16x16x32_bf16 a[88:91], a[224:227], v[104:107], a[88:91]
v_exp_f32 v151, v151
v_mfma_f32_16x16x32_bf16 a[92:95], a[220:223], v[112:115], a[92:95]
v_cvt_pk_bf16_f32 v139, v142, v143
v_mfma_f32_16x16x32_bf16 a[92:95], a[224:227], v[120:123], a[92:95]
s_waitcnt vmcnt(9) lgkmcnt(0)
s_barrier
v_mfma_f32_16x16x32_bf16 a[96:99], a[228:231], v[64:67], a[96:99]
s_add_u32 s52, s52, 0x100000
s_add_u32 s44, s44, 16384
v_mfma_f32_16x16x32_bf16 a[96:99], a[232:235], v[72:75], a[96:99]
ds_read_b128 a[212:215], v8 offset:32768
v_cvt_pk_bf16_f32 v144, v144, v145
v_mfma_f32_16x16x32_bf16 a[100:103], a[228:231], v[80:83], a[100:103]
v_exp_f32 v152, v152
v_mfma_f32_16x16x32_bf16 a[100:103], a[232:235], v[88:91], a[100:103]
v_exp_f32 v153, v153
v_mfma_f32_16x16x32_bf16 a[104:107], a[228:231], v[96:99], a[104:107]
v_exp_f32 v154, v154
v_mfma_f32_16x16x32_bf16 a[104:107], a[232:235], v[104:107], a[104:107]
ds_read_b128 a[216:219], v9 offset:32768
v_cvt_pk_bf16_f32 v145, v146, v147
v_mfma_f32_16x16x32_bf16 a[108:111], a[228:231], v[112:115], a[108:111]
v_exp_f32 v155, v155
v_mfma_f32_16x16x32_bf16 a[108:111], a[232:235], v[120:123], a[108:111]
v_cvt_pk_bf16_f32 v146, v148, v149
v_cvt_pk_bf16_f32 v147, v150, v151
v_mfma_f32_16x16x32_bf16 a[112:115], a[236:239], v[64:67], a[112:115]
ds_read_b128 a[220:223], v10 offset:32768
v_cvt_pk_bf16_f32 v152, v152, v153
v_mfma_f32_16x16x32_bf16 a[112:115], a[240:243], v[72:75], a[112:115]
ds_read_b128 a[224:227], v11 offset:32768
s_add_u32 s47, s47, 16384
v_mfma_f32_16x16x32_bf16 a[116:119], a[236:239], v[80:83], a[116:119]
v_exp_f32 v156, v156
v_mfma_f32_16x16x32_bf16 a[116:119], a[240:243], v[88:91], a[116:119]
v_exp_f32 v157, v157
v_mfma_f32_16x16x32_bf16 a[120:123], a[236:239], v[96:99], a[120:123]
v_cvt_pk_bf16_f32 v153, v154, v155
v_cvt_pk_bf16_f32 v154, v156, v157
v_mfma_f32_16x16x32_bf16 a[120:123], a[240:243], v[104:107], a[120:123]
v_exp_f32 v158, v158
v_mfma_f32_16x16x32_bf16 a[124:127], a[236:239], v[112:115], a[124:127]
v_exp_f32 v159, v159
v_mfma_f32_16x16x32_bf16 a[124:127], a[240:243], v[120:123], a[124:127]
v_cvt_pk_bf16_f32 v155, v158, v159
s_waitcnt lgkmcnt(0)
v_mfma_f32_16x16x32_bf16 v[64:67], a[212:215], a[128:131], v[36:39]
v_exp_f32 v160, v160
v_mfma_f32_16x16x32_bf16 v[64:67], a[216:219], a[132:135], v[64:67]
v_exp_f32 v161, v161
v_mfma_f32_16x16x32_bf16 v[64:67], a[220:223], a[136:139], v[64:67]
v_exp_f32 v162, v162
v_mfma_f32_16x16x32_bf16 v[64:67], a[224:227], a[140:143], v[64:67]
ds_read_b128 a[228:231], v8 offset:36864
v_cvt_pk_bf16_f32 v160, v160, v161
v_mfma_f32_16x16x32_bf16 v[80:83], a[212:215], a[144:147], v[40:43]
ds_read_b128 a[232:235], v9 offset:36864
s_add_u32 m0, s35, 0
v_mfma_f32_16x16x32_bf16 v[80:83], a[216:219], a[148:151], v[80:83]
buffer_load_dwordx4 v20, s[20:23], s44 offen offset:0 lds
v_mfma_f32_16x16x32_bf16 v[80:83], a[220:223], a[152:155], v[80:83]
v_exp_f32 v163, v163
v_mfma_f32_16x16x32_bf16 v[80:83], a[224:227], a[156:159], v[80:83]
ds_read_b128 a[236:239], v10 offset:36864
v_cvt_pk_bf16_f32 v161, v162, v163
v_mfma_f32_16x16x32_bf16 v[96:99], a[212:215], a[160:163], v[44:47]
ds_read_b128 a[240:243], v11 offset:36864
v_exp_f32 v164, v164
v_mfma_f32_16x16x32_bf16 v[96:99], a[216:219], a[164:167], v[96:99]
v_exp_f32 v165, v165
v_mfma_f32_16x16x32_bf16 v[96:99], a[220:223], a[168:171], v[96:99]
buffer_load_dwordx4 v21, s[20:23], s44 offen offset:1024 lds
v_mfma_f32_16x16x32_bf16 v[96:99], a[224:227], a[172:175], v[96:99]
v_exp_f32 v166, v166
v_mfma_f32_16x16x32_bf16 v[112:115], a[212:215], a[176:179], v[48:51]
v_max3_f32 v52, v64, v65, v66
v_max3_f32 v53, v80, v81, v82
v_mfma_f32_16x16x32_bf16 v[112:115], a[216:219], a[180:183], v[112:115]
v_exp_f32 v167, v167
v_mfma_f32_16x16x32_bf16 v[112:115], a[220:223], a[184:187], v[112:115]
v_exp_f32 v168, v168
v_mfma_f32_16x16x32_bf16 v[112:115], a[224:227], a[188:191], v[112:115]
ds_read_b128 a[212:215], v8 offset:40960
s_waitcnt lgkmcnt(1)
v_mfma_f32_16x16x32_bf16 v[68:71], a[228:231], a[128:131], v[36:39]
v_exp_f32 v169, v169
v_mfma_f32_16x16x32_bf16 v[68:71], a[232:235], a[132:135], v[68:71]
v_exp_f32 v170, v170
v_mfma_f32_16x16x32_bf16 v[68:71], a[236:239], a[136:139], v[68:71]
v_exp_f32 v171, v171
v_mfma_f32_16x16x32_bf16 v[68:71], a[240:243], a[140:143], v[68:71]
ds_read_b128 a[216:219], v9 offset:40960
v_max3_f32 v54, v96, v97, v98
v_mfma_f32_16x16x32_bf16 v[84:87], a[228:231], a[144:147], v[40:43]
v_exp_f32 v172, v172
v_mfma_f32_16x16x32_bf16 v[84:87], a[232:235], a[148:151], v[84:87]
v_exp_f32 v173, v173
v_mfma_f32_16x16x32_bf16 v[84:87], a[236:239], a[152:155], v[84:87]
ds_read_b128 a[220:223], v10 offset:40960
v_max3_f32 v55, v112, v113, v114
v_mfma_f32_16x16x32_bf16 v[84:87], a[240:243], a[156:159], v[84:87]
v_exp_f32 v174, v174
v_mfma_f32_16x16x32_bf16 v[100:103], a[228:231], a[160:163], v[44:47]
ds_read_b128 a[224:227], v11 offset:40960
v_cvt_pk_bf16_f32 v162, v164, v165
v_mfma_f32_16x16x32_bf16 v[100:103], a[232:235], a[164:167], v[100:103]
v_exp_f32 v175, v175
v_mfma_f32_16x16x32_bf16 v[100:103], a[236:239], a[168:171], v[100:103]
s_cmp_lg_u32 s45, 0
s_cbranch_scc1 L_attn_kernel_resc_a_1
L_attn_kernel_rback_a_1:
v_mfma_f32_16x16x32_bf16 v[100:103], a[240:243], a[172:175], v[100:103]
v_exp_f32 v176, v176
v_mfma_f32_16x16x32_bf16 v[116:119], a[228:231], a[176:179], v[48:51]
v_exp_f32 v177, v177
v_mfma_f32_16x16x32_bf16 v[116:119], a[232:235], a[180:183], v[116:119]
v_max3_f32 v52, v52, v67, v68
v_cvt_pk_bf16_f32 v163, v166, v167
v_mfma_f32_16x16x32_bf16 v[116:119], a[236:239], a[184:187], v[116:119]
v_exp_f32 v178, v178
v_mfma_f32_16x16x32_bf16 v[116:119], a[240:243], a[188:191], v[116:119]
v_max3_f32 v53, v53, v83, v84
s_waitcnt lgkmcnt(0)
v_mfma_f32_16x16x32_bf16 v[72:75], a[212:215], a[128:131], v[36:39]
v_cvt_pk_bf16_f32 v168, v168, v169
v_max3_f32 v54, v54, v99, v100
v_mfma_f32_16x16x32_bf16 v[72:75], a[216:219], a[132:135], v[72:75]
ds_read_b128 a[228:231], v8 offset:45056
v_cvt_pk_bf16_f32 v169, v170, v171
v_mfma_f32_16x16x32_bf16 v[72:75], a[220:223], a[136:139], v[72:75]
ds_read_b128 a[232:235], v9 offset:45056
v_cvt_pk_bf16_f32 v170, v172, v173
v_mfma_f32_16x16x32_bf16 v[72:75], a[224:227], a[140:143], v[72:75]
v_exp_f32 v179, v179
v_mfma_f32_16x16x32_bf16 v[88:91], a[212:215], a[144:147], v[40:43]
ds_read_b128 a[236:239], v10 offset:45056
v_cvt_pk_bf16_f32 v171, v174, v175
v_mfma_f32_16x16x32_bf16 v[88:91], a[216:219], a[148:151], v[88:91]
v_exp_f32 v180, v180
v_mfma_f32_16x16x32_bf16 v[88:91], a[220:223], a[152:155], v[88:91]
v_cvt_pk_bf16_f32 v176, v176, v177
v_max3_f32 v55, v55, v115, v116
v_mfma_f32_16x16x32_bf16 v[88:91], a[224:227], a[156:159], v[88:91]
ds_read_b128 a[240:243], v11 offset:45056
v_max3_f32 v52, v52, v69, v70
v_mfma_f32_16x16x32_bf16 v[104:107], a[212:215], a[160:163], v[44:47]
v_exp_f32 v181, v181
v_mfma_f32_16x16x32_bf16 v[104:107], a[216:219], a[164:167], v[104:107]
v_max3_f32 v53, v53, v85, v86
v_max3_f32 v54, v54, v101, v102
v_mfma_f32_16x16x32_bf16 v[104:107], a[220:223], a[168:171], v[104:107]
buffer_load_dwordx4 v22, s[20:23], s44 offen offset:2048 lds
v_mfma_f32_16x16x32_bf16 v[104:107], a[224:227], a[172:175], v[104:107]
v_exp_f32 v182, v182
v_mfma_f32_16x16x32_bf16 v[120:123], a[212:215], a[176:179], v[48:51]
v_exp_f32 v183, v183
v_mfma_f32_16x16x32_bf16 v[120:123], a[216:219], a[180:183], v[120:123]
v_exp_f32 v184, v184
v_mfma_f32_16x16x32_bf16 v[120:123], a[220:223], a[184:187], v[120:123]
v_exp_f32 v185, v185
v_mfma_f32_16x16x32_bf16 v[120:123], a[224:227], a[188:191], v[120:123]
ds_read_b64_tr_b16 a[212:213], v12 offset:49152
s_waitcnt lgkmcnt(1)
v_mfma_f32_16x16x32_bf16 v[76:79], a[228:231], a[128:131], v[36:39]
v_exp_f32 v186, v186
v_mfma_f32_16x16x32_bf16 v[76:79], a[232:235], a[132:135], v[76:79]
ds_read_b64_tr_b16 a[214:215], v12 offset:53248
v_cvt_pk_bf16_f32 v177, v178, v179
v_cvt_pk_bf16_f32 v178, v180, v181
v_mfma_f32_16x16x32_bf16 v[76:79], a[236:239], a[136:139], v[76:79]
v_exp_f32 v187, v187
v_mfma_f32_16x16x32_bf16 v[76:79], a[240:243], a[140:143], v[76:79]
ds_read_b64_tr_b16 a[216:217], v12 offset:57344
v_max3_f32 v55, v55, v117, v118
v_mfma_f32_16x16x32_bf16 v[92:95], a[228:231], a[144:147], v[40:43]
ds_read_b64_tr_b16 a[218:219], v12 offset:61440
v_cvt_pk_bf16_f32 v179, v182, v183
v_mfma_f32_16x16x32_bf16 v[92:95], a[232:235], a[148:151], v[92:95]
ds_read_b64_tr_b16 a[220:221], v13 offset:49152
v_max3_f32 v52, v52, v71, v72
v_mfma_f32_16x16x32_bf16 v[92:95], a[236:239], a[152:155], v[92:95]
v_exp_f32 v188, v188
v_mfma_f32_16x16x32_bf16 v[92:95], a[240:243], a[156:159], v[92:95]
ds_read_b64_tr_b16 a[222:223], v13 offset:53248
v_max3_f32 v53, v53, v87, v88
v_mfma_f32_16x16x32_bf16 v[108:111], a[228:231], a[160:163], v[44:47]
v_exp_f32 v189, v189
v_mfma_f32_16x16x32_bf16 v[108:111], a[232:235], a[164:167], v[108:111]
buffer_load_dwordx4 v23, s[20:23], s44 offen offset:3072 lds
v_mfma_f32_16x16x32_bf16 v[108:111], a[236:239], a[168:171], v[108:111]
s_add_u32 m0, s35, 81920
v_cvt_pk_bf16_f32 v184, v184, v185
v_mfma_f32_16x16x32_bf16 v[108:111], a[240:243], a[172:175], v[108:111]
v_cvt_pk_bf16_f32 v185, v186, v187
v_max3_f32 v54, v54, v103, v104
v_mfma_f32_16x16x32_bf16 v[124:127], a[228:231], a[176:179], v[48:51]
v_exp_f32 v190, v190
v_mfma_f32_16x16x32_bf16 v[124:127], a[232:235], a[180:183], v[124:127]
ds_read_b64_tr_b16 a[224:225], v13 offset:57344
v_max3_f32 v55, v55, v119, v120
v_mfma_f32_16x16x32_bf16 v[124:127], a[236:239], a[184:187], v[124:127]
v_exp_f32 v191, v191
v_mfma_f32_16x16x32_bf16 v[124:127], a[240:243], a[188:191], v[124:127]
v_cvt_pk_bf16_f32 v186, v188, v189
v_cvt_pk_bf16_f32 v187, v190, v191
v_mfma_f32_16x16x32_bf16 a[192:195], a[208:211], v[128:131], a[192:195]
v_max3_f32 v52, v52, v73, v74
v_max3_f32 v53, v53, v89, v90
v_mfma_f32_16x16x32_bf16 a[192:195], a[208:211], v[136:139], a[192:195]
ds_read_b64_tr_b16 a[226:227], v13 offset:61440
v_max3_f32 v54, v54, v105, v106
v_max3_f32 v55, v55, v121, v122
v_mfma_f32_16x16x32_bf16 a[196:199], a[208:211], v[144:147], a[196:199]
ds_read_b64_tr_b16 a[228:229], v14 offset:49152
v_max3_f32 v52, v52, v75, v76
v_mfma_f32_16x16x32_bf16 a[196:199], a[208:211], v[152:155], a[196:199]
v_max3_f32 v53, v53, v91, v92
v_max3_f32 v54, v54, v107, v108
v_max3_f32 v55, v55, v123, v124
v_mfma_f32_16x16x32_bf16 a[200:203], a[208:211], v[160:163], a[200:203]
ds_read_b64_tr_b16 a[230:231], v14 offset:53248
v_max3_f32 v52, v52, v77, v78
v_mfma_f32_16x16x32_bf16 a[200:203], a[208:211], v[168:171], a[200:203]
ds_read_b64_tr_b16 a[232:233], v14 offset:57344
v_max3_f32 v53, v53, v93, v94
v_mfma_f32_16x16x32_bf16 a[204:207], a[208:211], v[176:179], a[204:207]
ds_read_b64_tr_b16 a[234:235], v14 offset:61440
v_max3_f32 v54, v54, v109, v110
v_mfma_f32_16x16x32_bf16 a[204:207], a[208:211], v[184:187], a[204:207]
ds_read_b64_tr_b16 a[236:237], v15 offset:49152
s_waitcnt lgkmcnt(5)
v_mfma_f32_16x16x32_bf16 a[0:3], a[212:215], v[128:131], a[0:3]
ds_read_b64_tr_b16 a[238:239], v15 offset:53248
v_max3_f32 v55, v55, v125, v126
v_mfma_f32_16x16x32_bf16 a[0:3], a[216:219], v[136:139], a[0:3]
v_max_f32 v52, v52, v79
v_max_f32 v53, v53, v95
v_mfma_f32_16x16x32_bf16 a[4:7], a[212:215], v[144:147], a[4:7]
v_max_f32 v54, v54, v111
v_max_f32 v55, v55, v127
v_mfma_f32_16x16x32_bf16 a[4:7], a[216:219], v[152:155], a[4:7]
buffer_load_dwordx4 v24, s[24:27], s47 offen offset:0 lds
v_mfma_f32_16x16x32_bf16 a[8:11], a[212:215], v[160:163], a[8:11]
ds_read_b64_tr_b16 a[240:241], v15 offset:57344
v_max3_f32 v60, v52, v53, v54
v_mfma_f32_16x16x32_bf16 a[8:11], a[216:219], v[168:171], a[8:11]
ds_read_b64_tr_b16 a[242:243], v15 offset:61440
v_max_f32 v60, v60, v55
v_mfma_f32_16x16x32_bf16 a[12:15], a[212:215], v[176:179], a[12:15]
v_cmp_lt_f32 vcc, s46, v60
s_cbranch_vccnz L_attn_kernel_rare_a_1
L_attn_kernel_back_a_1:
v_mfma_f32_16x16x32_bf16 a[12:15], a[216:219], v[184:187], a[12:15]
v_exp_f32 v64, v64
v_mfma_f32_16x16x32_bf16 a[16:19], a[220:223], v[128:131], a[16:19]
buffer_load_dwordx4 v25, s[24:27], s47 offen offset:1024 lds
v_mfma_f32_16x16x32_bf16 a[16:19], a[224:227], v[136:139], a[16:19]
ds_read_b64_tr_b16 a[212:213], v16 offset:49152
v_mfma_f32_16x16x32_bf16 a[20:23], a[220:223], v[144:147], a[20:23]
v_exp_f32 v65, v65
v_mfma_f32_16x16x32_bf16 a[20:23], a[224:227], v[152:155], a[20:23]
v_exp_f32 v66, v66
v_mfma_f32_16x16x32_bf16 a[24:27], a[220:223], v[160:163], a[24:27]
buffer_load_dwordx4 v24, s[24:27], s47 offen offset:2048 lds
v_mfma_f32_16x16x32_bf16 a[24:27], a[224:227], v[168:171], a[24:27]
v_exp_f32 v67, v67
v_mfma_f32_16x16x32_bf16 a[28:31], a[220:223], v[176:179], a[28:31]
ds_read_b64_tr_b16 a[214:215], v16 offset:53248
v_cvt_pk_bf16_f32 v64, v64, v65
v_mfma_f32_16x16x32_bf16 a[28:31], a[224:227], v[184:187], a[28:31]
ds_read_b64_tr_b16 a[216:217], v16 offset:57344
s_waitcnt lgkmcnt(3)
v_mfma_f32_16x16x32_bf16 a[32:35], a[228:231], v[128:131], a[32:35]
v_exp_f32 v68, v68
v_mfma_f32_16x16x32_bf16 a[32:35], a[232:235], v[136:139], a[32:35]
v_exp_f32 v69, v69
v_mfma_f32_16x16x32_bf16 a[36:39], a[228:231], v[144:147], a[36:39]
ds_read_b64_tr_b16 a[218:219], v16 offset:61440
v_exp_f32 v70, v70
v_mfma_f32_16x16x32_bf16 a[36:39], a[232:235], v[152:155], a[36:39]
ds_read_b64_tr_b16 a[220:221], v17 offset:49152
v_exp_f32 v71, v71
v_mfma_f32_16x16x32_bf16 a[40:43], a[228:231], v[160:163], a[40:43]
ds_read_b64_tr_b16 a[222:223], v17 offset:53248
v_cvt_pk_bf16_f32 v65, v66, v67
v_mfma_f32_16x16x32_bf16 a[40:43], a[232:235], v[168:171], a[40:43]
ds_read_b64_tr_b16 a[224:225], v17 offset:57344
v_cvt_pk_bf16_f32 v66, v68, v69
v_mfma_f32_16x16x32_bf16 a[44:47], a[228:231], v[176:179], a[44:47]
ds_read_b64_tr_b16 a[226:227], v17 offset:61440
v_exp_f32 v72, v72
v_mfma_f32_16x16x32_bf16 a[44:47], a[232:235], v[184:187], a[44:47]
v_exp_f32 v73, v73
v_mfma_f32_16x16x32_bf16 a[48:51], a[236:239], v[128:131], a[48:51]
buffer_load_dwordx4 v25, s[24:27], s47 offen offset:3072 lds
v_mfma_f32_16x16x32_bf16 a[48:51], a[240:243], v[136:139], a[48:51]
v_exp_f32 v74, v74
v_mfma_f32_16x16x32_bf16 a[52:55], a[236:239], v[144:147], a[52:55]
v_exp_f32 v75, v75
v_mfma_f32_16x16x32_bf16 a[52:55], a[240:243], v[152:155], a[52:55]
v_exp_f32 v76, v76
v_mfma_f32_16x16x32_bf16 a[56:59], a[236:239], v[160:163], a[56:59]
buffer_load_dwordx4 v[192:195], v3, s[48:51], s52 offen
v_mfma_f32_16x16x32_bf16 a[56:59], a[240:243], v[168:171], a[56:59]
v_exp_f32 v77, v77
v_mfma_f32_16x16x32_bf16 a[60:63], a[236:239], v[176:179], a[60:63]
ds_read_b64_tr_b16 a[228:229], v18 offset:49152
v_mfma_f32_16x16x32_bf16 a[60:63], a[240:243], v[184:187], a[60:63]
ds_read_b64_tr_b16 a[230:231], v18 offset:53248
s_waitcnt lgkmcnt(2)
v_mfma_f32_16x16x32_bf16 a[64:67], a[212:215], v[128:131], a[64:67]
ds_read_b64_tr_b16 a[232:233], v18 offset:57344
v_cvt_pk_bf16_f32 v67, v70, v71
v_mfma_f32_16x16x32_bf16 a[64:67], a[216:219], v[136:139], a[64:67]
ds_read_b64_tr_b16 a[234:235], v18 offset:61440
v_cvt_pk_bf16_f32 v72, v72, v73
v_mfma_f32_16x16x32_bf16 a[68:71], a[212:215], v[144:147], a[68:71]
v_exp_f32 v78, v78
v_mfma_f32_16x16x32_bf16 a[68:71], a[216:219], v[152:155], a[68:71]
ds_read_b64_tr_b16 a[236:237], v19 offset:49152
v_exp_f32 v79, v79
v_mfma_f32_16x16x32_bf16 a[72:75], a[212:215], v[160:163], a[72:75]
v_exp_f32 v80, v80
v_mfma_f32_16x16x32_bf16 a[72:75], a[216:219], v[168:171], a[72:75]
ds_read_b64_tr_b16 a[238:239], v19 offset:53248
v_cvt_pk_bf16_f32 v73, v74, v75
v_mfma_f32_16x16x32_bf16 a[76:79], a[212:215], v[176:179], a[76:79]
ds_read_b64_tr_b16 a[240:241], v19 offset:57344
v_cvt_pk_bf16_f32 v74, v76, v77
v_mfma_f32_16x16x32_bf16 a[76:79], a[216:219], v[184:187], a[76:79]
ds_read_b64_tr_b16 a[242:243], v19 offset:61440
v_exp_f32 v81, v81
v_mfma_f32_16x16x32_bf16 a[80:83], a[220:223], v[128:131], a[80:83]
v_exp_f32 v82, v82
v_mfma_f32_16x16x32_bf16 a[80:83], a[224:227], v[136:139], a[80:83]
v_exp_f32 v83, v83
v_mfma_f32_16x16x32_bf16 a[84:87], a[220:223], v[144:147], a[84:87]
v_exp_f32 v84, v84
v_mfma_f32_16x16x32_bf16 a[84:87], a[224:227], v[152:155], a[84:87]
v_exp_f32 v85, v85
v_mfma_f32_16x16x32_bf16 a[88:91], a[220:223], v[160:163], a[88:91]
v_exp_f32 v86, v86
v_mfma_f32_16x16x32_bf16 a[88:91], a[224:227], v[168:171], a[88:91]
v_exp_f32 v87, v87
v_mfma_f32_16x16x32_bf16 a[92:95], a[220:223], v[176:179], a[92:95]
v_cvt_pk_bf16_f32 v75, v78, v79
v_mfma_f32_16x16x32_bf16 a[92:95], a[224:227], v[184:187], a[92:95]
s_waitcnt vmcnt(10) lgkmcnt(0)
s_barrier
v_mfma_f32_16x16x32_bf16 a[96:99], a[228:231], v[128:131], a[96:99]
s_add_u32 s52, s52, 0x100000
s_add_u32 s44, s44, 16384
v_mfma_f32_16x16x32_bf16 a[96:99], a[232:235], v[136:139], a[96:99]
ds_read_b128 a[212:215], v8 offset:49152
v_cvt_pk_bf16_f32 v80, v80, v81
v_mfma_f32_16x16x32_bf16 a[100:103], a[228:231], v[144:147], a[100:103]
v_exp_f32 v88, v88
v_mfma_f32_16x16x32_bf16 a[100:103], a[232:235], v[152:155], a[100:103]
v_exp_f32 v89, v89
v_mfma_f32_16x16x32_bf16 a[104:107], a[228:231], v[160:163], a[104:107]
v_exp_f32 v90, v90
v_mfma_f32_16x16x32_bf16 a[104:107], a[232:235], v[168:171], a[104:107]
ds_read_b128 a[216:219], v9 offset:49152
v_cvt_pk_bf16_f32 v81, v82, v83
v_mfma_f32_16x16x32_bf16 a[108:111], a[228:231], v[176:179], a[108:111]
v_exp_f32 v91, v91
v_mfma_f32_16x16x32_bf16 a[108:111], a[232:235], v[184:187], a[108:111]
v_cvt_pk_bf16_f32 v82, v84, v85
v_cvt_pk_bf16_f32 v83, v86, v87
v_mfma_f32_16x16x32_bf16 a[112:115], a[236:239], v[128:131], a[112:115]
ds_read_b128 a[220:223], v10 offset:49152
v_cvt_pk_bf16_f32 v88, v88, v89
v_mfma_f32_16x16x32_bf16 a[112:115], a[240:243], v[136:139], a[112:115]
ds_read_b128 a[224:227], v11 offset:49152
s_add_u32 s47, s47, 16384
v_mfma_f32_16x16x32_bf16 a[116:119], a[236:239], v[144:147], a[116:119]
v_exp_f32 v92, v92
v_mfma_f32_16x16x32_bf16 a[116:119], a[240:243], v[152:155], a[116:119]
v_exp_f32 v93, v93
v_mfma_f32_16x16x32_bf16 a[120:123], a[236:239], v[160:163], a[120:123]
v_cvt_pk_bf16_f32 v89, v90, v91
v_cvt_pk_bf16_f32 v90, v92, v93
v_mfma_f32_16x16x32_bf16 a[120:123], a[240:243], v[168:171], a[120:123]
v_exp_f32 v94, v94
v_mfma_f32_16x16x32_bf16 a[124:127], a[236:239], v[176:179], a[124:127]
v_exp_f32 v95, v95
v_mfma_f32_16x16x32_bf16 a[124:127], a[240:243], v[184:187], a[124:127]
v_cvt_pk_bf16_f32 v91, v94, v95
s_waitcnt lgkmcnt(0)
v_mfma_f32_16x16x32_bf16 v[128:131], a[212:215], a[128:131], v[36:39]
v_exp_f32 v96, v96
v_mfma_f32_16x16x32_bf16 v[128:131], a[216:219], a[132:135], v[128:131]
v_exp_f32 v97, v97
v_mfma_f32_16x16x32_bf16 v[128:131], a[220:223], a[136:139], v[128:131]
v_exp_f32 v98, v98
v_mfma_f32_16x16x32_bf16 v[128:131], a[224:227], a[140:143], v[128:131]
ds_read_b128 a[228:231], v8 offset:53248
v_cvt_pk_bf16_f32 v96, v96, v97
v_mfma_f32_16x16x32_bf16 v[144:147], a[212:215], a[144:147], v[40:43]
ds_read_b128 a[232:235], v9 offset:53248
s_add_u32 m0, s35, 16384
v_mfma_f32_16x16x32_bf16 v[144:147], a[216:219], a[148:151], v[144:147]
buffer_load_dwordx4 v20, s[20:23], s44 offen offset:0 lds
v_mfma_f32_16x16x32_bf16 v[144:147], a[220:223], a[152:155], v[144:147]
v_exp_f32 v99, v99
v_mfma_f32_16x16x32_bf16 v[144:147], a[224:227], a[156:159], v[144:147]
ds_read_b128 a[236:239], v10 offset:53248
v_cvt_pk_bf16_f32 v97, v98, v99
v_mfma_f32_16x16x32_bf16 v[160:163], a[212:215], a[160:163], v[44:47]
ds_read_b128 a[240:243], v11 offset:53248
v_exp_f32 v100, v100
v_mfma_f32_16x16x32_bf16 v[160:163], a[216:219], a[164:167], v[160:163]
v_exp_f32 v101, v101
v_mfma_f32_16x16x32_bf16 v[160:163], a[220:223], a[168:171], v[160:163]
buffer_load_dwordx4 v21, s[20:23], s44 offen offset:1024 lds
v_mfma_f32_16x16x32_bf16 v[160:163], a[224:227], a[172:175], v[160:163]
v_exp_f32 v102, v102
v_mfma_f32_16x16x32_bf16 v[176:179], a[212:215], a[176:179], v[48:51]
v_max3_f32 v52, v128, v129, v130
v_max3_f32 v53, v144, v145, v146
v_mfma_f32_16x16x32_bf16 v[176:179], a[216:219], a[180:183], v[176:179]
v_exp_f32 v103, v103
v_mfma_f32_16x16x32_bf16 v[176:179], a[220:223], a[184:187], v[176:179]
v_exp_f32 v104, v104
v_mfma_f32_16x16x32_bf16 v[176:179], a[224:227], a[188:191], v[176:179]
ds_read_b128 a[212:215], v8 offset:57344
s_waitcnt lgkmcnt(1)
v_mfma_f32_16x16x32_bf16 v[132:135], a[228:231], a[128:131], v[36:39]
v_exp_f32 v105, v105
v_mfma_f32_16x16x32_bf16 v[132:135], a[232:235], a[132:135], v[132:135]
v_exp_f32 v106, v106
v_mfma_f32_16x16x32_bf16 v[132:135], a[236:239], a[136:139], v[132:135]
v_exp_f32 v107, v107
v_mfma_f32_16x16x32_bf16 v[132:135], a[240:243], a[140:143], v[132:135]
ds_read_b128 a[216:219], v9 offset:57344
v_max3_f32 v54, v160, v161, v162
v_mfma_f32_16x16x32_bf16 v[148:151], a[228:231], a[144:147], v[40:43]
v_exp_f32 v108, v108
v_mfma_f32_16x16x32_bf16 v[148:151], a[232:235], a[148:151], v[148:151]
v_exp_f32 v109, v109
v_mfma_f32_16x16x32_bf16 v[148:151], a[236:239], a[152:155], v[148:151]
ds_read_b128 a[220:223], v10 offset:57344
v_max3_f32 v55, v176, v177, v178
v_mfma_f32_16x16x32_bf16 v[148:151], a[240:243], a[156:159], v[148:151]
v_exp_f32 v110, v110
v_mfma_f32_16x16x32_bf16 v[164:167], a[228:231], a[160:163], v[44:47]
ds_read_b128 a[224:227], v11 offset:57344
v_cvt_pk_bf16_f32 v98, v100, v101
v_mfma_f32_16x16x32_bf16 v[164:167], a[232:235], a[164:167], v[164:167]
v_exp_f32 v111, v111
v_mfma_f32_16x16x32_bf16 v[164:167], a[236:239], a[168:171], v[164:167]
s_cmp_lg_u32 s45, 0
s_cbranch_scc1 L_attn_kernel_resc_a_2
L_attn_kernel_rback_a_2:
v_mfma_f32_16x16x32_bf16 v[164:167], a[240:243], a[172:175], v[164:167]
v_exp_f32 v112, v112
v_mfma_f32_16x16x32_bf16 v[180:183], a[228:231], a[176:179], v[48:51]
v_exp_f32 v113, v113
v_mfma_f32_16x16x32_bf16 v[180:183], a[232:235], a[180:183], v[180:183]
v_max3_f32 v52, v52, v131, v132
v_cvt_pk_bf16_f32 v99, v102, v103
v_mfma_f32_16x16x32_bf16 v[180:183], a[236:239], a[184:187], v[180:183]
v_exp_f32 v114, v114
v_mfma_f32_16x16x32_bf16 v[180:183], a[240:243], a[188:191], v[180:183]
v_max3_f32 v53, v53, v147, v148
s_waitcnt lgkmcnt(0)
v_mfma_f32_16x16x32_bf16 v[136:139], a[212:215], a[128:131], v[36:39]
v_cvt_pk_bf16_f32 v104, v104, v105
v_max3_f32 v54, v54, v163, v164
v_mfma_f32_16x16x32_bf16 v[136:139], a[216:219], a[132:135], v[136:139]
ds_read_b128 a[228:231], v8 offset:61440
v_cvt_pk_bf16_f32 v105, v106, v107
v_mfma_f32_16x16x32_bf16 v[136:139], a[220:223], a[136:139], v[136:139]
ds_read_b128 a[232:235], v9 offset:61440
v_cvt_pk_bf16_f32 v106, v108, v109
v_mfma_f32_16x16x32_bf16 v[136:139], a[224:227], a[140:143], v[136:139]
v_exp_f32 v115, v115
v_mfma_f32_16x16x32_bf16 v[152:155], a[212:215], a[144:147], v[40:43]
ds_read_b128 a[236:239], v10 offset:61440
v_cvt_pk_bf16_f32 v107, v110, v111
v_mfma_f32_16x16x32_bf16 v[152:155], a[216:219], a[148:151], v[152:155]
v_exp_f32 v116, v116
v_mfma_f32_16x16x32_bf16 v[152:155], a[220:223], a[152:155], v[152:155]
v_cvt_pk_bf16_f32 v112, v112, v113
v_max3_f32 v55, v55, v179, v180
v_mfma_f32_16x16x32_bf16 v[152:155], a[224:227], a[156:159], v[152:155]
ds_read_b128 a[240:243], v11 offset:61440
v_max3_f32 v52, v52, v133, v134
v_mfma_f32_16x16x32_bf16 v[168:171], a[212:215], a[160:163], v[44:47]
v_exp_f32 v117, v117
v_mfma_f32_16x16x32_bf16 v[168:171], a[216:219], a[164:167], v[168:171]
v_max3_f32 v53, v53, v149, v150
v_max3_f32 v54, v54, v165, v166
v_mfma_f32_16x16x32_bf16 v[168:171], a[220:223], a[168:171], v[168:171]
buffer_load_dwordx4 v22, s[20:23], s44 offen offset:2048 lds
v_mfma_f32_16x16x32_bf16 v[168:171], a[224:227], a[172:175], v[168:171]
v_exp_f32 v118, v118
v_mfma_f32_16x16x32_bf16 v[184:187], a[212:215], a[176:179], v[48:51]
v_exp_f32 v119, v119
v_mfma_f32_16x16x32_bf16 v[184:187], a[216:219], a[180:183], v[184:187]
v_exp_f32 v120, v120
v_mfma_f32_16x16x32_bf16 v[184:187], a[220:223], a[184:187], v[184:187]
v_exp_f32 v121, v121
v_mfma_f32_16x16x32_bf16 v[184:187], a[224:227], a[188:191], v[184:187]
ds_read_b64_tr_b16 a[212:213], v12 offset:0
s_waitcnt lgkmcnt(1)
v_mfma_f32_16x16x32_bf16 v[140:143], a[228:231], a[128:131], v[36:39]
v_exp_f32 v122, v122
v_mfma_f32_16x16x32_bf16 v[140:143], a[232:235], a[132:135], v[140:143]
ds_read_b64_tr_b16 a[214:215], v12 offset:4096
v_cvt_pk_bf16_f32 v113, v114, v115
v_cvt_pk_bf16_f32 v114, v116, v117
v_mfma_f32_16x16x32_bf16 v[140:143], a[236:239], a[136:139], v[140:143]
v_exp_f32 v123, v123
v_mfma_f32_16x16x32_bf16 v[140:143], a[240:243], a[140:143], v[140:143]
ds_read_b64_tr_b16 a[216:217], v12 offset:8192
v_max3_f32 v55, v55, v181, v182
v_mfma_f32_16x16x32_bf16 v[156:159], a[228:231], a[144:147], v[40:43]
ds_read_b64_tr_b16 a[218:219], v12 offset:12288
v_cvt_pk_bf16_f32 v115, v118, v119
v_mfma_f32_16x16x32_bf16 v[156:159], a[232:235], a[148:151], v[156:159]
ds_read_b64_tr_b16 a[220:221], v13 offset:0
v_max3_f32 v52, v52, v135, v136
v_mfma_f32_16x16x32_bf16 v[156:159], a[236:239], a[152:155], v[156:159]
v_exp_f32 v124, v124
v_mfma_f32_16x16x32_bf16 v[156:159], a[240:243], a[156:159], v[156:159]
ds_read_b64_tr_b16 a[222:223], v13 offset:4096
v_max3_f32 v53, v53, v151, v152
v_mfma_f32_16x16x32_bf16 v[172:175], a[228:231], a[160:163], v[44:47]
v_exp_f32 v125, v125
v_mfma_f32_16x16x32_bf16 v[172:175], a[232:235], a[164:167], v[172:175]
buffer_load_dwordx4 v23, s[20:23], s44 offen offset:3072 lds
v_mfma_f32_16x16x32_bf16 v[172:175], a[236:239], a[168:171], v[172:175]
s_add_u32 m0, s35, 98304
v_cvt_pk_bf16_f32 v120, v120, v121
v_mfma_f32_16x16x32_bf16 v[172:175], a[240:243], a[172:175], v[172:175]
v_cvt_pk_bf16_f32 v121, v122, v123
v_max3_f32 v54, v54, v167, v168
v_mfma_f32_16x16x32_bf16 v[188:191], a[228:231], a[176:179], v[48:51]
v_exp_f32 v126, v126
v_mfma_f32_16x16x32_bf16 v[188:191], a[232:235], a[180:183], v[188:191]
ds_read_b64_tr_b16 a[224:225], v13 offset:8192
v_max3_f32 v55, v55, v183, v184
v_mfma_f32_16x16x32_bf16 v[188:191], a[236:239], a[184:187], v[188:191]
v_exp_f32 v127, v127
v_mfma_f32_16x16x32_bf16 v[188:191], a[240:243], a[188:191], v[188:191]
v_cvt_pk_bf16_f32 v122, v124, v125
v_cvt_pk_bf16_f32 v123, v126, v127
v_mfma_f32_16x16x32_bf16 a[192:195], a[208:211], v[64:67], a[192:195]
v_max3_f32 v52, v52, v137, v138
v_max3_f32 v53, v53, v153, v154
v_mfma_f32_16x16x32_bf16 a[192:195], a[208:211], v[72:75], a[192:195]
ds_read_b64_tr_b16 a[226:227], v13 offset:12288
v_max3_f32 v54, v54, v169, v170
v_max3_f32 v55, v55, v185, v186
v_mfma_f32_16x16x32_bf16 a[196:199], a[208:211], v[80:83], a[196:199]
ds_read_b64_tr_b16 a[228:229], v14 offset:0
v_max3_f32 v52, v52, v139, v140
v_mfma_f32_16x16x32_bf16 a[196:199], a[208:211], v[88:91], a[196:199]
v_max3_f32 v53, v53, v155, v156
v_max3_f32 v54, v54, v171, v172
v_max3_f32 v55, v55, v187, v188
v_mfma_f32_16x16x32_bf16 a[200:203], a[208:211], v[96:99], a[200:203]
ds_read_b64_tr_b16 a[230:231], v14 offset:4096
v_max3_f32 v52, v52, v141, v142
v_mfma_f32_16x16x32_bf16 a[200:203], a[208:211], v[104:107], a[200:203]
ds_read_b64_tr_b16 a[232:233], v14 offset:8192
v_max3_f32 v53, v53, v157, v158
v_mfma_f32_16x16x32_bf16 a[204:207], a[208:211], v[112:115], a[204:207]
ds_read_b64_tr_b16 a[234:235], v14 offset:12288
v_max3_f32 v54, v54, v173, v174
v_mfma_f32_16x16x32_bf16 a[204:207], a[208:211], v[120:123], a[204:207]
ds_read_b64_tr_b16 a[236:237], v15 offset:0
s_waitcnt lgkmcnt(5)
v_mfma_f32_16x16x32_bf16 a[0:3], a[212:215], v[64:67], a[0:3]
ds_read_b64_tr_b16 a[238:239], v15 offset:4096
v_max3_f32 v55, v55, v189, v190
v_mfma_f32_16x16x32_bf16 a[0:3], a[216:219], v[72:75], a[0:3]
v_max_f32 v52, v52, v143
v_max_f32 v53, v53, v159
v_mfma_f32_16x16x32_bf16 a[4:7], a[212:215], v[80:83], a[4:7]
v_max_f32 v54, v54, v175
v_max_f32 v55, v55, v191
v_mfma_f32_16x16x32_bf16 a[4:7], a[216:219], v[88:91], a[4:7]
buffer_load_dwordx4 v24, s[24:27], s47 offen offset:0 lds
v_mfma_f32_16x16x32_bf16 a[8:11], a[212:215], v[96:99], a[8:11]
ds_read_b64_tr_b16 a[240:241], v15 offset:8192
v_max3_f32 v60, v52, v53, v54
v_mfma_f32_16x16x32_bf16 a[8:11], a[216:219], v[104:107], a[8:11]
ds_read_b64_tr_b16 a[242:243], v15 offset:12288
v_max_f32 v60, v60, v55
v_mfma_f32_16x16x32_bf16 a[12:15], a[212:215], v[112:115], a[12:15]
v_cmp_lt_f32 vcc, s46, v60
s_cbranch_vccnz L_attn_kernel_rare_a_2
L_attn_kernel_back_a_2:
v_mfma_f32_16x16x32_bf16 a[12:15], a[216:219], v[120:123], a[12:15]
v_exp_f32 v128, v128
v_mfma_f32_16x16x32_bf16 a[16:19], a[220:223], v[64:67], a[16:19]
buffer_load_dwordx4 v25, s[24:27], s47 offen offset:1024 lds
v_mfma_f32_16x16x32_bf16 a[16:19], a[224:227], v[72:75], a[16:19]
ds_read_b64_tr_b16 a[212:213], v16 offset:0
v_mfma_f32_16x16x32_bf16 a[20:23], a[220:223], v[80:83], a[20:23]
v_exp_f32 v129, v129
v_mfma_f32_16x16x32_bf16 a[20:23], a[224:227], v[88:91], a[20:23]
v_exp_f32 v130, v130
v_mfma_f32_16x16x32_bf16 a[24:27], a[220:223], v[96:99], a[24:27]
buffer_load_dwordx4 v24, s[24:27], s47 offen offset:2048 lds
v_mfma_f32_16x16x32_bf16 a[24:27], a[224:227], v[104:107], a[24:27]
v_exp_f32 v131, v131
v_mfma_f32_16x16x32_bf16 a[28:31], a[220:223], v[112:115], a[28:31]
ds_read_b64_tr_b16 a[214:215], v16 offset:4096
v_cvt_pk_bf16_f32 v128, v128, v129
v_mfma_f32_16x16x32_bf16 a[28:31], a[224:227], v[120:123], a[28:31]
ds_read_b64_tr_b16 a[216:217], v16 offset:8192
s_waitcnt lgkmcnt(3)
v_mfma_f32_16x16x32_bf16 a[32:35], a[228:231], v[64:67], a[32:35]
v_exp_f32 v132, v132
v_mfma_f32_16x16x32_bf16 a[32:35], a[232:235], v[72:75], a[32:35]
v_exp_f32 v133, v133
v_mfma_f32_16x16x32_bf16 a[36:39], a[228:231], v[80:83], a[36:39]
ds_read_b64_tr_b16 a[218:219], v16 offset:12288
v_exp_f32 v134, v134
v_mfma_f32_16x16x32_bf16 a[36:39], a[232:235], v[88:91], a[36:39]
ds_read_b64_tr_b16 a[220:221], v17 offset:0
v_exp_f32 v135, v135
v_mfma_f32_16x16x32_bf16 a[40:43], a[228:231], v[96:99], a[40:43]
ds_read_b64_tr_b16 a[222:223], v17 offset:4096
v_cvt_pk_bf16_f32 v129, v130, v131
v_mfma_f32_16x16x32_bf16 a[40:43], a[232:235], v[104:107], a[40:43]
ds_read_b64_tr_b16 a[224:225], v17 offset:8192
v_cvt_pk_bf16_f32 v130, v132, v133
v_mfma_f32_16x16x32_bf16 a[44:47], a[228:231], v[112:115], a[44:47]
ds_read_b64_tr_b16 a[226:227], v17 offset:12288
v_exp_f32 v136, v136
v_mfma_f32_16x16x32_bf16 a[44:47], a[232:235], v[120:123], a[44:47]
v_exp_f32 v137, v137
v_mfma_f32_16x16x32_bf16 a[48:51], a[236:239], v[64:67], a[48:51]
buffer_load_dwordx4 v25, s[24:27], s47 offen offset:3072 lds
v_mfma_f32_16x16x32_bf16 a[48:51], a[240:243], v[72:75], a[48:51]
v_exp_f32 v138, v138
v_mfma_f32_16x16x32_bf16 a[52:55], a[236:239], v[80:83], a[52:55]
v_exp_f32 v139, v139
v_mfma_f32_16x16x32_bf16 a[52:55], a[240:243], v[88:91], a[52:55]
v_exp_f32 v140, v140
v_mfma_f32_16x16x32_bf16 a[56:59], a[236:239], v[96:99], a[56:59]
buffer_load_dwordx4 v[192:195], v3, s[48:51], s52 offen
v_mfma_f32_16x16x32_bf16 a[56:59], a[240:243], v[104:107], a[56:59]
v_exp_f32 v141, v141
v_mfma_f32_16x16x32_bf16 a[60:63], a[236:239], v[112:115], a[60:63]
ds_read_b64_tr_b16 a[228:229], v18 offset:0
v_mfma_f32_16x16x32_bf16 a[60:63], a[240:243], v[120:123], a[60:63]
ds_read_b64_tr_b16 a[230:231], v18 offset:4096
s_waitcnt lgkmcnt(2)
v_mfma_f32_16x16x32_bf16 a[64:67], a[212:215], v[64:67], a[64:67]
ds_read_b64_tr_b16 a[232:233], v18 offset:8192
v_cvt_pk_bf16_f32 v131, v134, v135
v_mfma_f32_16x16x32_bf16 a[64:67], a[216:219], v[72:75], a[64:67]
ds_read_b64_tr_b16 a[234:235], v18 offset:12288
v_cvt_pk_bf16_f32 v136, v136, v137
v_mfma_f32_16x16x32_bf16 a[68:71], a[212:215], v[80:83], a[68:71]
v_exp_f32 v142, v142
v_mfma_f32_16x16x32_bf16 a[68:71], a[216:219], v[88:91], a[68:71]
ds_read_b64_tr_b16 a[236:237], v19 offset:0
v_exp_f32 v143, v143
v_mfma_f32_16x16x32_bf16 a[72:75], a[212:215], v[96:99], a[72:75]
v_exp_f32 v144, v144
v_mfma_f32_16x16x32_bf16 a[72:75], a[216:219], v[104:107], a[72:75]
ds_read_b64_tr_b16 a[238:239], v19 offset:4096
v_cvt_pk_bf16_f32 v137, v138, v139
v_mfma_f32_16x16x32_bf16 a[76:79], a[212:215], v[112:115], a[76:79]
ds_read_b64_tr_b16 a[240:241], v19 offset:8192
v_cvt_pk_bf16_f32 v138, v140, v141
v_mfma_f32_16x16x32_bf16 a[76:79], a[216:219], v[120:123], a[76:79]
ds_read_b64_tr_b16 a[242:243], v19 offset:12288
v_exp_f32 v145, v145
v_mfma_f32_16x16x32_bf16 a[80:83], a[220:223], v[64:67], a[80:83]
v_exp_f32 v146, v146
v_mfma_f32_16x16x32_bf16 a[80:83], a[224:227], v[72:75], a[80:83]
v_exp_f32 v147, v147
v_mfma_f32_16x16x32_bf16 a[84:87], a[220:223], v[80:83], a[84:87]
v_exp_f32 v148, v148
v_mfma_f32_16x16x32_bf16 a[84:87], a[224:227], v[88:91], a[84:87]
v_exp_f32 v149, v149
v_mfma_f32_16x16x32_bf16 a[88:91], a[220:223], v[96:99], a[88:91]
v_exp_f32 v150, v150
v_mfma_f32_16x16x32_bf16 a[88:91], a[224:227], v[104:107], a[88:91]
v_exp_f32 v151, v151
v_mfma_f32_16x16x32_bf16 a[92:95], a[220:223], v[112:115], a[92:95]
v_cvt_pk_bf16_f32 v139, v142, v143
v_mfma_f32_16x16x32_bf16 a[92:95], a[224:227], v[120:123], a[92:95]
s_waitcnt vmcnt(10) lgkmcnt(0)
s_barrier
v_mfma_f32_16x16x32_bf16 a[96:99], a[228:231], v[64:67], a[96:99]
s_add_u32 s52, s52, 0x100000
s_add_u32 s44, s44, 16384
v_mfma_f32_16x16x32_bf16 a[96:99], a[232:235], v[72:75], a[96:99]
ds_read_b128 a[212:215], v8 offset:0
v_cvt_pk_bf16_f32 v144, v144, v145
v_mfma_f32_16x16x32_bf16 a[100:103], a[228:231], v[80:83], a[100:103]
v_exp_f32 v152, v152
v_mfma_f32_16x16x32_bf16 a[100:103], a[232:235], v[88:91], a[100:103]
v_exp_f32 v153, v153
v_mfma_f32_16x16x32_bf16 a[104:107], a[228:231], v[96:99], a[104:107]
v_exp_f32 v154, v154
v_mfma_f32_16x16x32_bf16 a[104:107], a[232:235], v[104:107], a[104:107]
ds_read_b128 a[216:219], v9 offset:0
v_cvt_pk_bf16_f32 v145, v146, v147
v_mfma_f32_16x16x32_bf16 a[108:111], a[228:231], v[112:115], a[108:111]
v_exp_f32 v155, v155
v_mfma_f32_16x16x32_bf16 a[108:111], a[232:235], v[120:123], a[108:111]
v_cvt_pk_bf16_f32 v146, v148, v149
v_cvt_pk_bf16_f32 v147, v150, v151
v_mfma_f32_16x16x32_bf16 a[112:115], a[236:239], v[64:67], a[112:115]
ds_read_b128 a[220:223], v10 offset:0
v_cvt_pk_bf16_f32 v152, v152, v153
v_mfma_f32_16x16x32_bf16 a[112:115], a[240:243], v[72:75], a[112:115]
ds_read_b128 a[224:227], v11 offset:0
s_add_u32 s47, s47, 16384
v_mfma_f32_16x16x32_bf16 a[116:119], a[236:239], v[80:83], a[116:119]
v_exp_f32 v156, v156
v_mfma_f32_16x16x32_bf16 a[116:119], a[240:243], v[88:91], a[116:119]
v_exp_f32 v157, v157
v_mfma_f32_16x16x32_bf16 a[120:123], a[236:239], v[96:99], a[120:123]
v_cvt_pk_bf16_f32 v153, v154, v155
v_cvt_pk_bf16_f32 v154, v156, v157
v_mfma_f32_16x16x32_bf16 a[120:123], a[240:243], v[104:107], a[120:123]
v_exp_f32 v158, v158
v_mfma_f32_16x16x32_bf16 a[124:127], a[236:239], v[112:115], a[124:127]
v_exp_f32 v159, v159
v_mfma_f32_16x16x32_bf16 a[124:127], a[240:243], v[120:123], a[124:127]
v_cvt_pk_bf16_f32 v155, v158, v159
s_waitcnt lgkmcnt(0)
v_mfma_f32_16x16x32_bf16 v[64:67], a[212:215], a[128:131], v[36:39]
v_exp_f32 v160, v160
v_mfma_f32_16x16x32_bf16 v[64:67], a[216:219], a[132:135], v[64:67]
v_exp_f32 v161, v161
v_mfma_f32_16x16x32_bf16 v[64:67], a[220:223], a[136:139], v[64:67]
v_exp_f32 v162, v162
v_mfma_f32_16x16x32_bf16 v[64:67], a[224:227], a[140:143], v[64:67]
ds_read_b128 a[228:231], v8 offset:4096
v_cvt_pk_bf16_f32 v160, v160, v161
v_mfma_f32_16x16x32_bf16 v[80:83], a[212:215], a[144:147], v[40:43]
ds_read_b128 a[232:235], v9 offset:4096
s_add_u32 m0, s35, 32768
v_mfma_f32_16x16x32_bf16 v[80:83], a[216:219], a[148:151], v[80:83]
buffer_load_dwordx4 v20, s[20:23], s44 offen offset:0 lds
v_mfma_f32_16x16x32_bf16 v[80:83], a[220:223], a[152:155], v[80:83]
v_exp_f32 v163, v163
v_mfma_f32_16x16x32_bf16 v[80:83], a[224:227], a[156:159], v[80:83]
ds_read_b128 a[236:239], v10 offset:4096
v_cvt_pk_bf16_f32 v161, v162, v163
v_mfma_f32_16x16x32_bf16 v[96:99], a[212:215], a[160:163], v[44:47]
ds_read_b128 a[240:243], v11 offset:4096
v_exp_f32 v164, v164
v_mfma_f32_16x16x32_bf16 v[96:99], a[216:219], a[164:167], v[96:99]
v_exp_f32 v165, v165
v_mfma_f32_16x16x32_bf16 v[96:99], a[220:223], a[168:171], v[96:99]
buffer_load_dwordx4 v21, s[20:23], s44 offen offset:1024 lds
v_mfma_f32_16x16x32_bf16 v[96:99], a[224:227], a[172:175], v[96:99]
v_exp_f32 v166, v166
v_mfma_f32_16x16x32_bf16 v[112:115], a[212:215], a[176:179], v[48:51]
v_max3_f32 v52, v64, v65, v66
v_max3_f32 v53, v80, v81, v82
v_mfma_f32_16x16x32_bf16 v[112:115], a[216:219], a[180:183], v[112:115]
v_exp_f32 v167, v167
v_mfma_f32_16x16x32_bf16 v[112:115], a[220:223], a[184:187], v[112:115]
v_exp_f32 v168, v168
v_mfma_f32_16x16x32_bf16 v[112:115], a[224:227], a[188:191], v[112:115]
ds_read_b128 a[212:215], v8 offset:8192
s_waitcnt lgkmcnt(1)
v_mfma_f32_16x16x32_bf16 v[68:71], a[228:231], a[128:131], v[36:39]
v_exp_f32 v169, v169
v_mfma_f32_16x16x32_bf16 v[68:71], a[232:235], a[132:135], v[68:71]
v_exp_f32 v170, v170
v_mfma_f32_16x16x32_bf16 v[68:71], a[236:239], a[136:139], v[68:71]
v_exp_f32 v171, v171
v_mfma_f32_16x16x32_bf16 v[68:71], a[240:243], a[140:143], v[68:71]
ds_read_b128 a[216:219], v9 offset:8192
v_max3_f32 v54, v96, v97, v98
v_mfma_f32_16x16x32_bf16 v[84:87], a[228:231], a[144:147], v[40:43]
v_exp_f32 v172, v172
v_mfma_f32_16x16x32_bf16 v[84:87], a[232:235], a[148:151], v[84:87]
v_exp_f32 v173, v173
v_mfma_f32_16x16x32_bf16 v[84:87], a[236:239], a[152:155], v[84:87]
ds_read_b128 a[220:223], v10 offset:8192
v_max3_f32 v55, v112, v113, v114
v_mfma_f32_16x16x32_bf16 v[84:87], a[240:243], a[156:159], v[84:87]
v_exp_f32 v174, v174
v_mfma_f32_16x16x32_bf16 v[100:103], a[228:231], a[160:163], v[44:47]
ds_read_b128 a[224:227], v11 offset:8192
v_cvt_pk_bf16_f32 v162, v164, v165
v_mfma_f32_16x16x32_bf16 v[100:103], a[232:235], a[164:167], v[100:103]
v_exp_f32 v175, v175
v_mfma_f32_16x16x32_bf16 v[100:103], a[236:239], a[168:171], v[100:103]
s_cmp_lg_u32 s45, 0
s_cbranch_scc1 L_attn_kernel_resc_a_3
L_attn_kernel_rback_a_3:
v_mfma_f32_16x16x32_bf16 v[100:103], a[240:243], a[172:175], v[100:103]
v_exp_f32 v176, v176
v_mfma_f32_16x16x32_bf16 v[116:119], a[228:231], a[176:179], v[48:51]
v_exp_f32 v177, v177
v_mfma_f32_16x16x32_bf16 v[116:119], a[232:235], a[180:183], v[116:119]
v_max3_f32 v52, v52, v67, v68
v_cvt_pk_bf16_f32 v163, v166, v167
v_mfma_f32_16x16x32_bf16 v[116:119], a[236:239], a[184:187], v[116:119]
v_exp_f32 v178, v178
v_mfma_f32_16x16x32_bf16 v[116:119], a[240:243], a[188:191], v[116:119]
v_max3_f32 v53, v53, v83, v84
s_waitcnt lgkmcnt(0)
v_mfma_f32_16x16x32_bf16 v[72:75], a[212:215], a[128:131], v[36:39]
v_cvt_pk_bf16_f32 v168, v168, v169
v_max3_f32 v54, v54, v99, v100
v_mfma_f32_16x16x32_bf16 v[72:75], a[216:219], a[132:135], v[72:75]
ds_read_b128 a[228:231], v8 offset:12288
v_cvt_pk_bf16_f32 v169, v170, v171
v_mfma_f32_16x16x32_bf16 v[72:75], a[220:223], a[136:139], v[72:75]
ds_read_b128 a[232:235], v9 offset:12288
v_cvt_pk_bf16_f32 v170, v172, v173
v_mfma_f32_16x16x32_bf16 v[72:75], a[224:227], a[140:143], v[72:75]
v_exp_f32 v179, v179
v_mfma_f32_16x16x32_bf16 v[88:91], a[212:215], a[144:147], v[40:43]
ds_read_b128 a[236:239], v10 offset:12288
v_cvt_pk_bf16_f32 v171, v174, v175
v_mfma_f32_16x16x32_bf16 v[88:91], a[216:219], a[148:151], v[88:91]
v_exp_f32 v180, v180
v_mfma_f32_16x16x32_bf16 v[88:91], a[220:223], a[152:155], v[88:91]
v_cvt_pk_bf16_f32 v176, v176, v177
v_max3_f32 v55, v55, v115, v116
v_mfma_f32_16x16x32_bf16 v[88:91], a[224:227], a[156:159], v[88:91]
ds_read_b128 a[240:243], v11 offset:12288
v_max3_f32 v52, v52, v69, v70
v_mfma_f32_16x16x32_bf16 v[104:107], a[212:215], a[160:163], v[44:47]
v_exp_f32 v181, v181
v_mfma_f32_16x16x32_bf16 v[104:107], a[216:219], a[164:167], v[104:107]
v_max3_f32 v53, v53, v85, v86
v_max3_f32 v54, v54, v101, v102
v_mfma_f32_16x16x32_bf16 v[104:107], a[220:223], a[168:171], v[104:107]
buffer_load_dwordx4 v22, s[20:23], s44 offen offset:2048 lds
v_mfma_f32_16x16x32_bf16 v[104:107], a[224:227], a[172:175], v[104:107]
v_exp_f32 v182, v182
v_mfma_f32_16x16x32_bf16 v[120:123], a[212:215], a[176:179], v[48:51]
v_exp_f32 v183, v183
v_mfma_f32_16x16x32_bf16 v[120:123], a[216:219], a[180:183], v[120:123]
v_exp_f32 v184, v184
v_mfma_f32_16x16x32_bf16 v[120:123], a[220:223], a[184:187], v[120:123]
v_exp_f32 v185, v185
v_mfma_f32_16x16x32_bf16 v[120:123], a[224:227], a[188:191], v[120:123]
ds_read_b64_tr_b16 a[212:213], v12 offset:16384
s_waitcnt lgkmcnt(1)
v_mfma_f32_16x16x32_bf16 v[76:79], a[228:231], a[128:131], v[36:39]
v_exp_f32 v186, v186
v_mfma_f32_16x16x32_bf16 v[76:79], a[232:235], a[132:135], v[76:79]
ds_read_b64_tr_b16 a[214:215], v12 offset:20480
v_cvt_pk_bf16_f32 v177, v178, v179
v_cvt_pk_bf16_f32 v178, v180, v181
v_mfma_f32_16x16x32_bf16 v[76:79], a[236:239], a[136:139], v[76:79]
v_exp_f32 v187, v187
v_mfma_f32_16x16x32_bf16 v[76:79], a[240:243], a[140:143], v[76:79]
ds_read_b64_tr_b16 a[216:217], v12 offset:24576
v_max3_f32 v55, v55, v117, v118
v_mfma_f32_16x16x32_bf16 v[92:95], a[228:231], a[144:147], v[40:43]
ds_read_b64_tr_b16 a[218:219], v12 offset:28672
v_cvt_pk_bf16_f32 v179, v182, v183
v_mfma_f32_16x16x32_bf16 v[92:95], a[232:235], a[148:151], v[92:95]
ds_read_b64_tr_b16 a[220:221], v13 offset:16384
v_max3_f32 v52, v52, v71, v72
v_mfma_f32_16x16x32_bf16 v[92:95], a[236:239], a[152:155], v[92:95]
v_exp_f32 v188, v188
v_mfma_f32_16x16x32_bf16 v[92:95], a[240:243], a[156:159], v[92:95]
ds_read_b64_tr_b16 a[222:223], v13 offset:20480
v_max3_f32 v53, v53, v87, v88
v_mfma_f32_16x16x32_bf16 v[108:111], a[228:231], a[160:163], v[44:47]
v_exp_f32 v189, v189
v_mfma_f32_16x16x32_bf16 v[108:111], a[232:235], a[164:167], v[108:111]
buffer_load_dwordx4 v23, s[20:23], s44 offen offset:3072 lds
v_mfma_f32_16x16x32_bf16 v[108:111], a[236:239], a[168:171], v[108:111]
s_add_u32 m0, s35, 114688
v_cvt_pk_bf16_f32 v184, v184, v185
v_mfma_f32_16x16x32_bf16 v[108:111], a[240:243], a[172:175], v[108:111]
v_cvt_pk_bf16_f32 v185, v186, v187
v_max3_f32 v54, v54, v103, v104
v_mfma_f32_16x16x32_bf16 v[124:127], a[228:231], a[176:179], v[48:51]
v_exp_f32 v190, v190
v_mfma_f32_16x16x32_bf16 v[124:127], a[232:235], a[180:183], v[124:127]
ds_read_b64_tr_b16 a[224:225], v13 offset:24576
v_max3_f32 v55, v55, v119, v120
v_mfma_f32_16x16x32_bf16 v[124:127], a[236:239], a[184:187], v[124:127]
v_exp_f32 v191, v191
v_mfma_f32_16x16x32_bf16 v[124:127], a[240:243], a[188:191], v[124:127]
v_cvt_pk_bf16_f32 v186, v188, v189
v_cvt_pk_bf16_f32 v187, v190, v191
v_mfma_f32_16x16x32_bf16 a[192:195], a[208:211], v[128:131], a[192:195]
v_max3_f32 v52, v52, v73, v74
v_max3_f32 v53, v53, v89, v90
v_mfma_f32_16x16x32_bf16 a[192:195], a[208:211], v[136:139], a[192:195]
ds_read_b64_tr_b16 a[226:227], v13 offset:28672
v_max3_f32 v54, v54, v105, v106
v_max3_f32 v55, v55, v121, v122
v_mfma_f32_16x16x32_bf16 a[196:199], a[208:211], v[144:147], a[196:199]
ds_read_b64_tr_b16 a[228:229], v14 offset:16384
v_max3_f32 v52, v52, v75, v76
v_mfma_f32_16x16x32_bf16 a[196:199], a[208:211], v[152:155], a[196:199]
v_max3_f32 v53, v53, v91, v92
v_max3_f32 v54, v54, v107, v108
v_max3_f32 v55, v55, v123, v124
v_mfma_f32_16x16x32_bf16 a[200:203], a[208:211], v[160:163], a[200:203]
ds_read_b64_tr_b16 a[230:231], v14 offset:20480
v_max3_f32 v52, v52, v77, v78
v_mfma_f32_16x16x32_bf16 a[200:203], a[208:211], v[168:171], a[200:203]
ds_read_b64_tr_b16 a[232:233], v14 offset:24576
v_max3_f32 v53, v53, v93, v94
v_mfma_f32_16x16x32_bf16 a[204:207], a[208:211], v[176:179], a[204:207]
ds_read_b64_tr_b16 a[234:235], v14 offset:28672
v_max3_f32 v54, v54, v109, v110
v_mfma_f32_16x16x32_bf16 a[204:207], a[208:211], v[184:187], a[204:207]
ds_read_b64_tr_b16 a[236:237], v15 offset:16384
s_waitcnt lgkmcnt(5)
v_mfma_f32_16x16x32_bf16 a[0:3], a[212:215], v[128:131], a[0:3]
ds_read_b64_tr_b16 a[238:239], v15 offset:20480
v_max3_f32 v55, v55, v125, v126
v_mfma_f32_16x16x32_bf16 a[0:3], a[216:219], v[136:139], a[0:3]
v_max_f32 v52, v52, v79
v_max_f32 v53, v53, v95
v_mfma_f32_16x16x32_bf16 a[4:7], a[212:215], v[144:147], a[4:7]
v_max_f32 v54, v54, v111
v_max_f32 v55, v55, v127
v_mfma_f32_16x16x32_bf16 a[4:7], a[216:219], v[152:155], a[4:7]
buffer_load_dwordx4 v24, s[24:27], s47 offen offset:0 lds
v_mfma_f32_16x16x32_bf16 a[8:11], a[212:215], v[160:163], a[8:11]
ds_read_b64_tr_b16 a[240:241], v15 offset:24576
v_max3_f32 v60, v52, v53, v54
v_mfma_f32_16x16x32_bf16 a[8:11], a[216:219], v[168:171], a[8:11]
ds_read_b64_tr_b16 a[242:243], v15 offset:28672
v_max_f32 v60, v60, v55
v_mfma_f32_16x16x32_bf16 a[12:15], a[212:215], v[176:179], a[12:15]
v_cmp_lt_f32 vcc, s46, v60
s_cbranch_vccnz L_attn_kernel_rare_a_3
L_attn_kernel_back_a_3:
v_mfma_f32_16x16x32_bf16 a[12:15], a[216:219], v[184:187], a[12:15]
v_exp_f32 v64, v64
v_mfma_f32_16x16x32_bf16 a[16:19], a[220:223], v[128:131], a[16:19]
buffer_load_dwordx4 v25, s[24:27], s47 offen offset:1024 lds
v_mfma_f32_16x16x32_bf16 a[16:19], a[224:227], v[136:139], a[16:19]
ds_read_b64_tr_b16 a[212:213], v16 offset:16384
v_mfma_f32_16x16x32_bf16 a[20:23], a[220:223], v[144:147], a[20:23]
v_exp_f32 v65, v65
v_mfma_f32_16x16x32_bf16 a[20:23], a[224:227], v[152:155], a[20:23]
v_exp_f32 v66, v66
v_mfma_f32_16x16x32_bf16 a[24:27], a[220:223], v[160:163], a[24:27]
buffer_load_dwordx4 v24, s[24:27], s47 offen offset:2048 lds
v_mfma_f32_16x16x32_bf16 a[24:27], a[224:227], v[168:171], a[24:27]
v_exp_f32 v67, v67
v_mfma_f32_16x16x32_bf16 a[28:31], a[220:223], v[176:179], a[28:31]
ds_read_b64_tr_b16 a[214:215], v16 offset:20480
v_cvt_pk_bf16_f32 v64, v64, v65
v_mfma_f32_16x16x32_bf16 a[28:31], a[224:227], v[184:187], a[28:31]
ds_read_b64_tr_b16 a[216:217], v16 offset:24576
s_waitcnt lgkmcnt(3)
v_mfma_f32_16x16x32_bf16 a[32:35], a[228:231], v[128:131], a[32:35]
v_exp_f32 v68, v68
v_mfma_f32_16x16x32_bf16 a[32:35], a[232:235], v[136:139], a[32:35]
v_exp_f32 v69, v69
v_mfma_f32_16x16x32_bf16 a[36:39], a[228:231], v[144:147], a[36:39]
ds_read_b64_tr_b16 a[218:219], v16 offset:28672
v_exp_f32 v70, v70
v_mfma_f32_16x16x32_bf16 a[36:39], a[232:235], v[152:155], a[36:39]
ds_read_b64_tr_b16 a[220:221], v17 offset:16384
v_exp_f32 v71, v71
v_mfma_f32_16x16x32_bf16 a[40:43], a[228:231], v[160:163], a[40:43]
ds_read_b64_tr_b16 a[222:223], v17 offset:20480
v_cvt_pk_bf16_f32 v65, v66, v67
v_mfma_f32_16x16x32_bf16 a[40:43], a[232:235], v[168:171], a[40:43]
ds_read_b64_tr_b16 a[224:225], v17 offset:24576
v_cvt_pk_bf16_f32 v66, v68, v69
v_mfma_f32_16x16x32_bf16 a[44:47], a[228:231], v[176:179], a[44:47]
ds_read_b64_tr_b16 a[226:227], v17 offset:28672
v_exp_f32 v72, v72
v_mfma_f32_16x16x32_bf16 a[44:47], a[232:235], v[184:187], a[44:47]
v_exp_f32 v73, v73
v_mfma_f32_16x16x32_bf16 a[48:51], a[236:239], v[128:131], a[48:51]
buffer_load_dwordx4 v25, s[24:27], s47 offen offset:3072 lds
v_mfma_f32_16x16x32_bf16 a[48:51], a[240:243], v[136:139], a[48:51]
v_exp_f32 v74, v74
v_mfma_f32_16x16x32_bf16 a[52:55], a[236:239], v[144:147], a[52:55]
v_exp_f32 v75, v75
v_mfma_f32_16x16x32_bf16 a[52:55], a[240:243], v[152:155], a[52:55]
v_exp_f32 v76, v76
v_mfma_f32_16x16x32_bf16 a[56:59], a[236:239], v[160:163], a[56:59]
buffer_load_dwordx4 v[192:195], v3, s[48:51], s52 offen
v_mfma_f32_16x16x32_bf16 a[56:59], a[240:243], v[168:171], a[56:59]
v_exp_f32 v77, v77
v_mfma_f32_16x16x32_bf16 a[60:63], a[236:239], v[176:179], a[60:63]
ds_read_b64_tr_b16 a[228:229], v18 offset:16384
v_mfma_f32_16x16x32_bf16 a[60:63], a[240:243], v[184:187], a[60:63]
ds_read_b64_tr_b16 a[230:231], v18 offset:20480
s_waitcnt lgkmcnt(2)
v_mfma_f32_16x16x32_bf16 a[64:67], a[212:215], v[128:131], a[64:67]
ds_read_b64_tr_b16 a[232:233], v18 offset:24576
v_cvt_pk_bf16_f32 v67, v70, v71
v_mfma_f32_16x16x32_bf16 a[64:67], a[216:219], v[136:139], a[64:67]
ds_read_b64_tr_b16 a[234:235], v18 offset:28672
v_cvt_pk_bf16_f32 v72, v72, v73
v_mfma_f32_16x16x32_bf16 a[68:71], a[212:215], v[144:147], a[68:71]
v_exp_f32 v78, v78
v_mfma_f32_16x16x32_bf16 a[68:71], a[216:219], v[152:155], a[68:71]
ds_read_b64_tr_b16 a[236:237], v19 offset:16384
v_exp_f32 v79, v79
v_mfma_f32_16x16x32_bf16 a[72:75], a[212:215], v[160:163], a[72:75]
v_exp_f32 v80, v80
v_mfma_f32_16x16x32_bf16 a[72:75], a[216:219], v[168:171], a[72:75]
ds_read_b64_tr_b16 a[238:239], v19 offset:20480
v_cvt_pk_bf16_f32 v73, v74, v75
v_mfma_f32_16x16x32_bf16 a[76:79], a[212:215], v[176:179], a[76:79]
ds_read_b64_tr_b16 a[240:241], v19 offset:24576
v_cvt_pk_bf16_f32 v74, v76, v77
v_mfma_f32_16x16x32_bf16 a[76:79], a[216:219], v[184:187], a[76:79]
ds_read_b64_tr_b16 a[242:243], v19 offset:28672
v_exp_f32 v81, v81
v_mfma_f32_16x16x32_bf16 a[80:83], a[220:223], v[128:131], a[80:83]
v_exp_f32 v82, v82
v_mfma_f32_16x16x32_bf16 a[80:83], a[224:227], v[136:139], a[80:83]
v_exp_f32 v83, v83
v_mfma_f32_16x16x32_bf16 a[84:87], a[220:223], v[144:147], a[84:87]
v_exp_f32 v84, v84
v_mfma_f32_16x16x32_bf16 a[84:87], a[224:227], v[152:155], a[84:87]
v_exp_f32 v85, v85
v_mfma_f32_16x16x32_bf16 a[88:91], a[220:223], v[160:163], a[88:91]
v_exp_f32 v86, v86
v_mfma_f32_16x16x32_bf16 a[88:91], a[224:227], v[168:171], a[88:91]
v_exp_f32 v87, v87
v_mfma_f32_16x16x32_bf16 a[92:95], a[220:223], v[176:179], a[92:95]
v_cvt_pk_bf16_f32 v75, v78, v79
v_mfma_f32_16x16x32_bf16 a[92:95], a[224:227], v[184:187], a[92:95]
s_waitcnt vmcnt(10) lgkmcnt(0)
s_barrier
v_mfma_f32_16x16x32_bf16 a[96:99], a[228:231], v[128:131], a[96:99]
s_add_u32 s52, s52, 0x100000
s_add_u32 s44, s44, 16384
v_mfma_f32_16x16x32_bf16 a[96:99], a[232:235], v[136:139], a[96:99]
ds_read_b128 a[212:215], v8 offset:16384
v_cvt_pk_bf16_f32 v80, v80, v81
v_mfma_f32_16x16x32_bf16 a[100:103], a[228:231], v[144:147], a[100:103]
v_exp_f32 v88, v88
v_mfma_f32_16x16x32_bf16 a[100:103], a[232:235], v[152:155], a[100:103]
v_exp_f32 v89, v89
v_mfma_f32_16x16x32_bf16 a[104:107], a[228:231], v[160:163], a[104:107]
v_exp_f32 v90, v90
v_mfma_f32_16x16x32_bf16 a[104:107], a[232:235], v[168:171], a[104:107]
ds_read_b128 a[216:219], v9 offset:16384
v_cvt_pk_bf16_f32 v81, v82, v83
v_mfma_f32_16x16x32_bf16 a[108:111], a[228:231], v[176:179], a[108:111]
v_exp_f32 v91, v91
v_mfma_f32_16x16x32_bf16 a[108:111], a[232:235], v[184:187], a[108:111]
v_cvt_pk_bf16_f32 v82, v84, v85
v_cvt_pk_bf16_f32 v83, v86, v87
v_mfma_f32_16x16x32_bf16 a[112:115], a[236:239], v[128:131], a[112:115]
ds_read_b128 a[220:223], v10 offset:16384
v_cvt_pk_bf16_f32 v88, v88, v89
v_mfma_f32_16x16x32_bf16 a[112:115], a[240:243], v[136:139], a[112:115]
ds_read_b128 a[224:227], v11 offset:16384
s_add_u32 s47, s47, 16384
v_mfma_f32_16x16x32_bf16 a[116:119], a[236:239], v[144:147], a[116:119]
v_exp_f32 v92, v92
v_mfma_f32_16x16x32_bf16 a[116:119], a[240:243], v[152:155], a[116:119]
v_exp_f32 v93, v93
v_mfma_f32_16x16x32_bf16 a[120:123], a[236:239], v[160:163], a[120:123]
v_cvt_pk_bf16_f32 v89, v90, v91
v_cvt_pk_bf16_f32 v90, v92, v93
v_mfma_f32_16x16x32_bf16 a[120:123], a[240:243], v[168:171], a[120:123]
v_exp_f32 v94, v94
v_mfma_f32_16x16x32_bf16 a[124:127], a[236:239], v[176:179], a[124:127]
v_exp_f32 v95, v95
v_mfma_f32_16x16x32_bf16 a[124:127], a[240:243], v[184:187], a[124:127]
v_cvt_pk_bf16_f32 v91, v94, v95
s_add_u32 s53, s53, 1
s_cmp_eq_u32 s53, 2
s_cselect_b32 s48, s54, s48
s_cselect_b32 s49, s55, s49
s_cmp_eq_u32 s53, 4
s_cselect_b32 s48, s56, s48
s_cselect_b32 s49, s57, s49
s_cmp_eq_u32 s53, 6
s_cselect_b32 s48, s58, s48
s_cselect_b32 s49, s59, s49
s_cmp_ge_u32 s53, 2
s_cselect_b32 s50, 0x700000, s50
s_bitcmp1_b32 s53, 0
s_cselect_b32 s52, s52, s60
s_sub_u32 s36, s36, 1
s_cmp_lg_u32 s36, 0
s_cbranch_scc1 L_attn_kernel_loop
s_waitcnt lgkmcnt(0)
v_mfma_f32_16x16x32_bf16 v[128:131], a[212:215], a[128:131], v[36:39]
v_exp_f32 v96, v96
v_mfma_f32_16x16x32_bf16 v[128:131], a[216:219], a[132:135], v[128:131]
v_exp_f32 v97, v97
v_mfma_f32_16x16x32_bf16 v[128:131], a[220:223], a[136:139], v[128:131]
v_exp_f32 v98, v98
v_mfma_f32_16x16x32_bf16 v[128:131], a[224:227], a[140:143], v[128:131]
ds_read_b128 a[228:231], v8 offset:20480
v_cvt_pk_bf16_f32 v96, v96, v97
v_mfma_f32_16x16x32_bf16 v[144:147], a[212:215], a[144:147], v[40:43]
ds_read_b128 a[232:235], v9 offset:20480
s_add_u32 m0, s35, 49152
v_mfma_f32_16x16x32_bf16 v[144:147], a[216:219], a[148:151], v[144:147]
buffer_load_dwordx4 v20, s[20:23], s44 offen offset:0 lds
v_mfma_f32_16x16x32_bf16 v[144:147], a[220:223], a[152:155], v[144:147]
v_exp_f32 v99, v99
v_mfma_f32_16x16x32_bf16 v[144:147], a[224:227], a[156:159], v[144:147]
ds_read_b128 a[236:239], v10 offset:20480
v_cvt_pk_bf16_f32 v97, v98, v99
v_mfma_f32_16x16x32_bf16 v[160:163], a[212:215], a[160:163], v[44:47]
ds_read_b128 a[240:243], v11 offset:20480
v_exp_f32 v100, v100
v_mfma_f32_16x16x32_bf16 v[160:163], a[216:219], a[164:167], v[160:163]
v_exp_f32 v101, v101
v_mfma_f32_16x16x32_bf16 v[160:163], a[220:223], a[168:171], v[160:163]
buffer_load_dwordx4 v21, s[20:23], s44 offen offset:1024 lds
v_mfma_f32_16x16x32_bf16 v[160:163], a[224:227], a[172:175], v[160:163]
v_exp_f32 v102, v102
v_mfma_f32_16x16x32_bf16 v[176:179], a[212:215], a[176:179], v[48:51]
v_max3_f32 v52, v128, v129, v130
v_max3_f32 v53, v144, v145, v146
v_mfma_f32_16x16x32_bf16 v[176:179], a[216:219], a[180:183], v[176:179]
v_exp_f32 v103, v103
v_mfma_f32_16x16x32_bf16 v[176:179], a[220:223], a[184:187], v[176:179]
v_exp_f32 v104, v104
v_mfma_f32_16x16x32_bf16 v[176:179], a[224:227], a[188:191], v[176:179]
ds_read_b128 a[212:215], v8 offset:24576
s_waitcnt lgkmcnt(1)
v_mfma_f32_16x16x32_bf16 v[132:135], a[228:231], a[128:131], v[36:39]
v_exp_f32 v105, v105
v_mfma_f32_16x16x32_bf16 v[132:135], a[232:235], a[132:135], v[132:135]
v_exp_f32 v106, v106
v_mfma_f32_16x16x32_bf16 v[132:135], a[236:239], a[136:139], v[132:135]
v_exp_f32 v107, v107
v_mfma_f32_16x16x32_bf16 v[132:135], a[240:243], a[140:143], v[132:135]
ds_read_b128 a[216:219], v9 offset:24576
v_max3_f32 v54, v160, v161, v162
v_mfma_f32_16x16x32_bf16 v[148:151], a[228:231], a[144:147], v[40:43]
v_exp_f32 v108, v108
v_mfma_f32_16x16x32_bf16 v[148:151], a[232:235], a[148:151], v[148:151]
v_exp_f32 v109, v109
v_mfma_f32_16x16x32_bf16 v[148:151], a[236:239], a[152:155], v[148:151]
ds_read_b128 a[220:223], v10 offset:24576
v_max3_f32 v55, v176, v177, v178
v_mfma_f32_16x16x32_bf16 v[148:151], a[240:243], a[156:159], v[148:151]
v_exp_f32 v110, v110
v_mfma_f32_16x16x32_bf16 v[164:167], a[228:231], a[160:163], v[44:47]
ds_read_b128 a[224:227], v11 offset:24576
v_cvt_pk_bf16_f32 v98, v100, v101
v_mfma_f32_16x16x32_bf16 v[164:167], a[232:235], a[164:167], v[164:167]
v_exp_f32 v111, v111
v_mfma_f32_16x16x32_bf16 v[164:167], a[236:239], a[168:171], v[164:167]
s_cmp_lg_u32 s45, 0
s_cbranch_scc1 L_attn_kernel_resc_c_0
L_attn_kernel_rback_c_0:
v_mfma_f32_16x16x32_bf16 v[164:167], a[240:243], a[172:175], v[164:167]
v_exp_f32 v112, v112
v_mfma_f32_16x16x32_bf16 v[180:183], a[228:231], a[176:179], v[48:51]
v_exp_f32 v113, v113
v_mfma_f32_16x16x32_bf16 v[180:183], a[232:235], a[180:183], v[180:183]
v_max3_f32 v52, v52, v131, v132
v_cvt_pk_bf16_f32 v99, v102, v103
v_mfma_f32_16x16x32_bf16 v[180:183], a[236:239], a[184:187], v[180:183]
v_exp_f32 v114, v114
v_mfma_f32_16x16x32_bf16 v[180:183], a[240:243], a[188:191], v[180:183]
v_max3_f32 v53, v53, v147, v148
s_waitcnt lgkmcnt(0)
v_mfma_f32_16x16x32_bf16 v[136:139], a[212:215], a[128:131], v[36:39]
v_cvt_pk_bf16_f32 v104, v104, v105
v_max3_f32 v54, v54, v163, v164
v_mfma_f32_16x16x32_bf16 v[136:139], a[216:219], a[132:135], v[136:139]
ds_read_b128 a[228:231], v8 offset:28672
v_cvt_pk_bf16_f32 v105, v106, v107
v_mfma_f32_16x16x32_bf16 v[136:139], a[220:223], a[136:139], v[136:139]
ds_read_b128 a[232:235], v9 offset:28672
v_cvt_pk_bf16_f32 v106, v108, v109
v_mfma_f32_16x16x32_bf16 v[136:139], a[224:227], a[140:143], v[136:139]
v_exp_f32 v115, v115
v_mfma_f32_16x16x32_bf16 v[152:155], a[212:215], a[144:147], v[40:43]
ds_read_b128 a[236:239], v10 offset:28672
v_cvt_pk_bf16_f32 v107, v110, v111
v_mfma_f32_16x16x32_bf16 v[152:155], a[216:219], a[148:151], v[152:155]
v_exp_f32 v116, v116
v_mfma_f32_16x16x32_bf16 v[152:155], a[220:223], a[152:155], v[152:155]
v_cvt_pk_bf16_f32 v112, v112, v113
v_max3_f32 v55, v55, v179, v180
v_mfma_f32_16x16x32_bf16 v[152:155], a[224:227], a[156:159], v[152:155]
ds_read_b128 a[240:243], v11 offset:28672
v_max3_f32 v52, v52, v133, v134
v_mfma_f32_16x16x32_bf16 v[168:171], a[212:215], a[160:163], v[44:47]
v_exp_f32 v117, v117
v_mfma_f32_16x16x32_bf16 v[168:171], a[216:219], a[164:167], v[168:171]
v_max3_f32 v53, v53, v149, v150
v_max3_f32 v54, v54, v165, v166
v_mfma_f32_16x16x32_bf16 v[168:171], a[220:223], a[168:171], v[168:171]
buffer_load_dwordx4 v22, s[20:23], s44 offen offset:2048 lds
v_mfma_f32_16x16x32_bf16 v[168:171], a[224:227], a[172:175], v[168:171]
v_exp_f32 v118, v118
v_mfma_f32_16x16x32_bf16 v[184:187], a[212:215], a[176:179], v[48:51]
v_exp_f32 v119, v119
v_mfma_f32_16x16x32_bf16 v[184:187], a[216:219], a[180:183], v[184:187]
v_exp_f32 v120, v120
v_mfma_f32_16x16x32_bf16 v[184:187], a[220:223], a[184:187], v[184:187]
v_exp_f32 v121, v121
v_mfma_f32_16x16x32_bf16 v[184:187], a[224:227], a[188:191], v[184:187]
ds_read_b64_tr_b16 a[212:213], v12 offset:32768
s_waitcnt lgkmcnt(1)
v_mfma_f32_16x16x32_bf16 v[140:143], a[228:231], a[128:131], v[36:39]
v_exp_f32 v122, v122
v_mfma_f32_16x16x32_bf16 v[140:143], a[232:235], a[132:135], v[140:143]
ds_read_b64_tr_b16 a[214:215], v12 offset:36864
v_cvt_pk_bf16_f32 v113, v114, v115
v_cvt_pk_bf16_f32 v114, v116, v117
v_mfma_f32_16x16x32_bf16 v[140:143], a[236:239], a[136:139], v[140:143]
v_exp_f32 v123, v123
v_mfma_f32_16x16x32_bf16 v[140:143], a[240:243], a[140:143], v[140:143]
ds_read_b64_tr_b16 a[216:217], v12 offset:40960
v_max3_f32 v55, v55, v181, v182
v_mfma_f32_16x16x32_bf16 v[156:159], a[228:231], a[144:147], v[40:43]
ds_read_b64_tr_b16 a[218:219], v12 offset:45056
v_cvt_pk_bf16_f32 v115, v118, v119
v_mfma_f32_16x16x32_bf16 v[156:159], a[232:235], a[148:151], v[156:159]
ds_read_b64_tr_b16 a[220:221], v13 offset:32768
v_max3_f32 v52, v52, v135, v136
v_mfma_f32_16x16x32_bf16 v[156:159], a[236:239], a[152:155], v[156:159]
v_exp_f32 v124, v124
v_mfma_f32_16x16x32_bf16 v[156:159], a[240:243], a[156:159], v[156:159]
ds_read_b64_tr_b16 a[222:223], v13 offset:36864
v_max3_f32 v53, v53, v151, v152
v_mfma_f32_16x16x32_bf16 v[172:175], a[228:231], a[160:163], v[44:47]
v_exp_f32 v125, v125
v_mfma_f32_16x16x32_bf16 v[172:175], a[232:235], a[164:167], v[172:175]
buffer_load_dwordx4 v23, s[20:23], s44 offen offset:3072 lds
v_mfma_f32_16x16x32_bf16 v[172:175], a[236:239], a[168:171], v[172:175]
s_add_u32 m0, s35, 65536
v_cvt_pk_bf16_f32 v120, v120, v121
v_mfma_f32_16x16x32_bf16 v[172:175], a[240:243], a[172:175], v[172:175]
v_cvt_pk_bf16_f32 v121, v122, v123
v_max3_f32 v54, v54, v167, v168
v_mfma_f32_16x16x32_bf16 v[188:191], a[228:231], a[176:179], v[48:51]
v_exp_f32 v126, v126
v_mfma_f32_16x16x32_bf16 v[188:191], a[232:235], a[180:183], v[188:191]
ds_read_b64_tr_b16 a[224:225], v13 offset:40960
v_max3_f32 v55, v55, v183, v184
v_mfma_f32_16x16x32_bf16 v[188:191], a[236:239], a[184:187], v[188:191]
v_exp_f32 v127, v127
v_mfma_f32_16x16x32_bf16 v[188:191], a[240:243], a[188:191], v[188:191]
v_cvt_pk_bf16_f32 v122, v124, v125
v_cvt_pk_bf16_f32 v123, v126, v127
v_mfma_f32_16x16x32_bf16 a[192:195], a[208:211], v[64:67], a[192:195]
v_max3_f32 v52, v52, v137, v138
v_max3_f32 v53, v53, v153, v154
v_mfma_f32_16x16x32_bf16 a[192:195], a[208:211], v[72:75], a[192:195]
ds_read_b64_tr_b16 a[226:227], v13 offset:45056
v_max3_f32 v54, v54, v169, v170
v_max3_f32 v55, v55, v185, v186
v_mfma_f32_16x16x32_bf16 a[196:199], a[208:211], v[80:83], a[196:199]
ds_read_b64_tr_b16 a[228:229], v14 offset:32768
v_max3_f32 v52, v52, v139, v140
v_mfma_f32_16x16x32_bf16 a[196:199], a[208:211], v[88:91], a[196:199]
v_max3_f32 v53, v53, v155, v156
v_max3_f32 v54, v54, v171, v172
v_max3_f32 v55, v55, v187, v188
v_mfma_f32_16x16x32_bf16 a[200:203], a[208:211], v[96:99], a[200:203]
ds_read_b64_tr_b16 a[230:231], v14 offset:36864
v_max3_f32 v52, v52, v141, v142
v_mfma_f32_16x16x32_bf16 a[200:203], a[208:211], v[104:107], a[200:203]
ds_read_b64_tr_b16 a[232:233], v14 offset:40960
v_max3_f32 v53, v53, v157, v158
v_mfma_f32_16x16x32_bf16 a[204:207], a[208:211], v[112:115], a[204:207]
ds_read_b64_tr_b16 a[234:235], v14 offset:45056
v_max3_f32 v54, v54, v173, v174
v_mfma_f32_16x16x32_bf16 a[204:207], a[208:211], v[120:123], a[204:207]
ds_read_b64_tr_b16 a[236:237], v15 offset:32768
s_waitcnt lgkmcnt(5)
v_mfma_f32_16x16x32_bf16 a[0:3], a[212:215], v[64:67], a[0:3]
ds_read_b64_tr_b16 a[238:239], v15 offset:36864
v_max3_f32 v55, v55, v189, v190
v_mfma_f32_16x16x32_bf16 a[0:3], a[216:219], v[72:75], a[0:3]
v_max_f32 v52, v52, v143
v_max_f32 v53, v53, v159
v_mfma_f32_16x16x32_bf16 a[4:7], a[212:215], v[80:83], a[4:7]
v_max_f32 v54, v54, v175
v_max_f32 v55, v55, v191
v_mfma_f32_16x16x32_bf16 a[4:7], a[216:219], v[88:91], a[4:7]
buffer_load_dwordx4 v24, s[24:27], s47 offen offset:0 lds
v_mfma_f32_16x16x32_bf16 a[8:11], a[212:215], v[96:99], a[8:11]
ds_read_b64_tr_b16 a[240:241], v15 offset:40960
v_max3_f32 v60, v52, v53, v54
v_mfma_f32_16x16x32_bf16 a[8:11], a[216:219], v[104:107], a[8:11]
ds_read_b64_tr_b16 a[242:243], v15 offset:45056
v_max_f32 v60, v60, v55
v_mfma_f32_16x16x32_bf16 a[12:15], a[212:215], v[112:115], a[12:15]
v_cmp_lt_f32 vcc, s46, v60
s_cbranch_vccnz L_attn_kernel_rare_c_0
L_attn_kernel_back_c_0:
v_mfma_f32_16x16x32_bf16 a[12:15], a[216:219], v[120:123], a[12:15]
v_exp_f32 v128, v128
v_mfma_f32_16x16x32_bf16 a[16:19], a[220:223], v[64:67], a[16:19]
buffer_load_dwordx4 v25, s[24:27], s47 offen offset:1024 lds
v_mfma_f32_16x16x32_bf16 a[16:19], a[224:227], v[72:75], a[16:19]
ds_read_b64_tr_b16 a[212:213], v16 offset:32768
v_mfma_f32_16x16x32_bf16 a[20:23], a[220:223], v[80:83], a[20:23]
v_exp_f32 v129, v129
v_mfma_f32_16x16x32_bf16 a[20:23], a[224:227], v[88:91], a[20:23]
v_exp_f32 v130, v130
v_mfma_f32_16x16x32_bf16 a[24:27], a[220:223], v[96:99], a[24:27]
buffer_load_dwordx4 v24, s[24:27], s47 offen offset:2048 lds
v_mfma_f32_16x16x32_bf16 a[24:27], a[224:227], v[104:107], a[24:27]
v_exp_f32 v131, v131
v_mfma_f32_16x16x32_bf16 a[28:31], a[220:223], v[112:115], a[28:31]
ds_read_b64_tr_b16 a[214:215], v16 offset:36864
v_cvt_pk_bf16_f32 v128, v128, v129
v_mfma_f32_16x16x32_bf16 a[28:31], a[224:227], v[120:123], a[28:31]
ds_read_b64_tr_b16 a[216:217], v16 offset:40960
s_waitcnt lgkmcnt(3)
v_mfma_f32_16x16x32_bf16 a[32:35], a[228:231], v[64:67], a[32:35]
v_exp_f32 v132, v132
v_mfma_f32_16x16x32_bf16 a[32:35], a[232:235], v[72:75], a[32:35]
v_exp_f32 v133, v133
v_mfma_f32_16x16x32_bf16 a[36:39], a[228:231], v[80:83], a[36:39]
ds_read_b64_tr_b16 a[218:219], v16 offset:45056
v_exp_f32 v134, v134
v_mfma_f32_16x16x32_bf16 a[36:39], a[232:235], v[88:91], a[36:39]
ds_read_b64_tr_b16 a[220:221], v17 offset:32768
v_exp_f32 v135, v135
v_mfma_f32_16x16x32_bf16 a[40:43], a[228:231], v[96:99], a[40:43]
ds_read_b64_tr_b16 a[222:223], v17 offset:36864
v_cvt_pk_bf16_f32 v129, v130, v131
v_mfma_f32_16x16x32_bf16 a[40:43], a[232:235], v[104:107], a[40:43]
ds_read_b64_tr_b16 a[224:225], v17 offset:40960
v_cvt_pk_bf16_f32 v130, v132, v133
v_mfma_f32_16x16x32_bf16 a[44:47], a[228:231], v[112:115], a[44:47]
ds_read_b64_tr_b16 a[226:227], v17 offset:45056
v_exp_f32 v136, v136
v_mfma_f32_16x16x32_bf16 a[44:47], a[232:235], v[120:123], a[44:47]
v_exp_f32 v137, v137
v_mfma_f32_16x16x32_bf16 a[48:51], a[236:239], v[64:67], a[48:51]
buffer_load_dwordx4 v25, s[24:27], s47 offen offset:3072 lds
v_mfma_f32_16x16x32_bf16 a[48:51], a[240:243], v[72:75], a[48:51]
v_exp_f32 v138, v138
v_mfma_f32_16x16x32_bf16 a[52:55], a[236:239], v[80:83], a[52:55]
v_exp_f32 v139, v139
v_mfma_f32_16x16x32_bf16 a[52:55], a[240:243], v[88:91], a[52:55]
v_exp_f32 v140, v140
v_mfma_f32_16x16x32_bf16 a[56:59], a[236:239], v[96:99], a[56:59]
buffer_load_dwordx4 v[192:195], v3, s[48:51], s52 offen
v_mfma_f32_16x16x32_bf16 a[56:59], a[240:243], v[104:107], a[56:59]
v_exp_f32 v141, v141
v_mfma_f32_16x16x32_bf16 a[60:63], a[236:239], v[112:115], a[60:63]
ds_read_b64_tr_b16 a[228:229], v18 offset:32768
v_mfma_f32_16x16x32_bf16 a[60:63], a[240:243], v[120:123], a[60:63]
ds_read_b64_tr_b16 a[230:231], v18 offset:36864
s_waitcnt lgkmcnt(2)
v_mfma_f32_16x16x32_bf16 a[64:67], a[212:215], v[64:67], a[64:67]
ds_read_b64_tr_b16 a[232:233], v18 offset:40960
v_cvt_pk_bf16_f32 v131, v134, v135
v_mfma_f32_16x16x32_bf16 a[64:67], a[216:219], v[72:75], a[64:67]
ds_read_b64_tr_b16 a[234:235], v18 offset:45056
v_cvt_pk_bf16_f32 v136, v136, v137
v_mfma_f32_16x16x32_bf16 a[68:71], a[212:215], v[80:83], a[68:71]
v_exp_f32 v142, v142
v_mfma_f32_16x16x32_bf16 a[68:71], a[216:219], v[88:91], a[68:71]
ds_read_b64_tr_b16 a[236:237], v19 offset:32768
v_exp_f32 v143, v143
v_mfma_f32_16x16x32_bf16 a[72:75], a[212:215], v[96:99], a[72:75]
v_exp_f32 v144, v144
v_mfma_f32_16x16x32_bf16 a[72:75], a[216:219], v[104:107], a[72:75]
ds_read_b64_tr_b16 a[238:239], v19 offset:36864
v_cvt_pk_bf16_f32 v137, v138, v139
v_mfma_f32_16x16x32_bf16 a[76:79], a[212:215], v[112:115], a[76:79]
ds_read_b64_tr_b16 a[240:241], v19 offset:40960
v_cvt_pk_bf16_f32 v138, v140, v141
v_mfma_f32_16x16x32_bf16 a[76:79], a[216:219], v[120:123], a[76:79]
ds_read_b64_tr_b16 a[242:243], v19 offset:45056
v_exp_f32 v145, v145
v_mfma_f32_16x16x32_bf16 a[80:83], a[220:223], v[64:67], a[80:83]
v_exp_f32 v146, v146
v_mfma_f32_16x16x32_bf16 a[80:83], a[224:227], v[72:75], a[80:83]
v_exp_f32 v147, v147
v_mfma_f32_16x16x32_bf16 a[84:87], a[220:223], v[80:83], a[84:87]
v_exp_f32 v148, v148
v_mfma_f32_16x16x32_bf16 a[84:87], a[224:227], v[88:91], a[84:87]
v_exp_f32 v149, v149
v_mfma_f32_16x16x32_bf16 a[88:91], a[220:223], v[96:99], a[88:91]
v_exp_f32 v150, v150
v_mfma_f32_16x16x32_bf16 a[88:91], a[224:227], v[104:107], a[88:91]
v_exp_f32 v151, v151
v_mfma_f32_16x16x32_bf16 a[92:95], a[220:223], v[112:115], a[92:95]
v_cvt_pk_bf16_f32 v139, v142, v143
v_mfma_f32_16x16x32_bf16 a[92:95], a[224:227], v[120:123], a[92:95]
s_waitcnt vmcnt(10) lgkmcnt(0)
s_barrier
v_mfma_f32_16x16x32_bf16 a[96:99], a[228:231], v[64:67], a[96:99]
s_add_u32 s52, s52, 0x100000
s_add_u32 s44, s44, 16384
v_mfma_f32_16x16x32_bf16 a[96:99], a[232:235], v[72:75], a[96:99]
ds_read_b128 a[212:215], v8 offset:32768
v_cvt_pk_bf16_f32 v144, v144, v145
v_mfma_f32_16x16x32_bf16 a[100:103], a[228:231], v[80:83], a[100:103]
v_exp_f32 v152, v152
v_mfma_f32_16x16x32_bf16 a[100:103], a[232:235], v[88:91], a[100:103]
v_exp_f32 v153, v153
v_mfma_f32_16x16x32_bf16 a[104:107], a[228:231], v[96:99], a[104:107]
v_exp_f32 v154, v154
v_mfma_f32_16x16x32_bf16 a[104:107], a[232:235], v[104:107], a[104:107]
ds_read_b128 a[216:219], v9 offset:32768
v_cvt_pk_bf16_f32 v145, v146, v147
v_mfma_f32_16x16x32_bf16 a[108:111], a[228:231], v[112:115], a[108:111]
v_exp_f32 v155, v155
v_mfma_f32_16x16x32_bf16 a[108:111], a[232:235], v[120:123], a[108:111]
v_cvt_pk_bf16_f32 v146, v148, v149
v_cvt_pk_bf16_f32 v147, v150, v151
v_mfma_f32_16x16x32_bf16 a[112:115], a[236:239], v[64:67], a[112:115]
ds_read_b128 a[220:223], v10 offset:32768
v_cvt_pk_bf16_f32 v152, v152, v153
v_mfma_f32_16x16x32_bf16 a[112:115], a[240:243], v[72:75], a[112:115]
ds_read_b128 a[224:227], v11 offset:32768
s_add_u32 s47, s47, 16384
v_mfma_f32_16x16x32_bf16 a[116:119], a[236:239], v[80:83], a[116:119]
v_exp_f32 v156, v156
v_mfma_f32_16x16x32_bf16 a[116:119], a[240:243], v[88:91], a[116:119]
v_exp_f32 v157, v157
v_mfma_f32_16x16x32_bf16 a[120:123], a[236:239], v[96:99], a[120:123]
v_cvt_pk_bf16_f32 v153, v154, v155
v_cvt_pk_bf16_f32 v154, v156, v157
v_mfma_f32_16x16x32_bf16 a[120:123], a[240:243], v[104:107], a[120:123]
v_exp_f32 v158, v158
v_mfma_f32_16x16x32_bf16 a[124:127], a[236:239], v[112:115], a[124:127]
v_exp_f32 v159, v159
v_mfma_f32_16x16x32_bf16 a[124:127], a[240:243], v[120:123], a[124:127]
v_cvt_pk_bf16_f32 v155, v158, v159
s_waitcnt lgkmcnt(0)
v_mfma_f32_16x16x32_bf16 v[64:67], a[212:215], a[128:131], v[36:39]
v_exp_f32 v160, v160
v_mfma_f32_16x16x32_bf16 v[64:67], a[216:219], a[132:135], v[64:67]
v_exp_f32 v161, v161
v_mfma_f32_16x16x32_bf16 v[64:67], a[220:223], a[136:139], v[64:67]
v_exp_f32 v162, v162
v_mfma_f32_16x16x32_bf16 v[64:67], a[224:227], a[140:143], v[64:67]
ds_read_b128 a[228:231], v8 offset:36864
s_add_u32 m0, s35, 81920
v_mfma_f32_16x16x32_bf16 v[80:83], a[212:215], a[144:147], v[40:43]
v_exp_f32 v163, v163
v_mfma_f32_16x16x32_bf16 v[80:83], a[216:219], a[148:151], v[80:83]
v_exp_f32 v164, v164
v_mfma_f32_16x16x32_bf16 v[80:83], a[220:223], a[152:155], v[80:83]
ds_read_b128 a[232:235], v9 offset:36864
v_cvt_pk_bf16_f32 v160, v160, v161
v_mfma_f32_16x16x32_bf16 v[80:83], a[224:227], a[156:159], v[80:83]
ds_read_b128 a[236:239], v10 offset:36864
v_max3_f32 v52, v64, v65, v66
v_mfma_f32_16x16x32_bf16 v[96:99], a[212:215], a[160:163], v[44:47]
v_exp_f32 v165, v165
v_mfma_f32_16x16x32_bf16 v[96:99], a[216:219], a[164:167], v[96:99]
ds_read_b128 a[240:243], v11 offset:36864
v_cvt_pk_bf16_f32 v161, v162, v163
v_mfma_f32_16x16x32_bf16 v[96:99], a[220:223], a[168:171], v[96:99]
buffer_load_dwordx4 v24, s[24:27], s47 offen offset:0 lds
v_mfma_f32_16x16x32_bf16 v[96:99], a[224:227], a[172:175], v[96:99]
v_exp_f32 v166, v166
v_mfma_f32_16x16x32_bf16 v[112:115], a[212:215], a[176:179], v[48:51]
s_cmp_lg_u32 s45, 0
s_cbranch_scc1 L_attn_kernel_resc_c_1
L_attn_kernel_rback_c_1:
v_mfma_f32_16x16x32_bf16 v[112:115], a[216:219], a[180:183], v[112:115]
v_exp_f32 v167, v167
v_mfma_f32_16x16x32_bf16 v[112:115], a[220:223], a[184:187], v[112:115]
v_cvt_pk_bf16_f32 v162, v164, v165
v_max3_f32 v53, v80, v81, v82
v_mfma_f32_16x16x32_bf16 v[112:115], a[224:227], a[188:191], v[112:115]
ds_read_b128 a[212:215], v8 offset:40960
s_waitcnt lgkmcnt(1)
v_mfma_f32_16x16x32_bf16 v[68:71], a[228:231], a[128:131], v[36:39]
v_exp_f32 v168, v168
v_max3_f32 v54, v96, v97, v98
v_mfma_f32_16x16x32_bf16 v[68:71], a[232:235], a[132:135], v[68:71]
v_exp_f32 v169, v169
v_mfma_f32_16x16x32_bf16 v[68:71], a[236:239], a[136:139], v[68:71]
buffer_load_dwordx4 v25, s[24:27], s47 offen offset:1024 lds
v_mfma_f32_16x16x32_bf16 v[68:71], a[240:243], a[140:143], v[68:71]
v_exp_f32 v170, v170
v_mfma_f32_16x16x32_bf16 v[84:87], a[228:231], a[144:147], v[40:43]
v_exp_f32 v171, v171
v_mfma_f32_16x16x32_bf16 v[84:87], a[232:235], a[148:151], v[84:87]
v_exp_f32 v172, v172
v_mfma_f32_16x16x32_bf16 v[84:87], a[236:239], a[152:155], v[84:87]
ds_read_b128 a[216:219], v9 offset:40960
v_max3_f32 v55, v112, v113, v114
v_mfma_f32_16x16x32_bf16 v[84:87], a[240:243], a[156:159], v[84:87]
ds_read_b128 a[220:223], v10 offset:40960
v_max3_f32 v52, v52, v67, v68
v_mfma_f32_16x16x32_bf16 v[100:103], a[228:231], a[160:163], v[44:47]
ds_read_b128 a[224:227], v11 offset:40960
v_cvt_pk_bf16_f32 v163, v166, v167
v_mfma_f32_16x16x32_bf16 v[100:103], a[232:235], a[164:167], v[100:103]
v_exp_f32 v173, v173
v_mfma_f32_16x16x32_bf16 v[100:103], a[236:239], a[168:171], v[100:103]
v_exp_f32 v174, v174
v_mfma_f32_16x16x32_bf16 v[100:103], a[240:243], a[172:175], v[100:103]
buffer_load_dwordx4 v24, s[24:27], s47 offen offset:2048 lds
v_mfma_f32_16x16x32_bf16 v[116:119], a[228:231], a[176:179], v[48:51]
v_exp_f32 v175, v175
v_mfma_f32_16x16x32_bf16 v[116:119], a[232:235], a[180:183], v[116:119]
v_exp_f32 v176, v176
v_mfma_f32_16x16x32_bf16 v[116:119], a[236:239], a[184:187], v[116:119]
v_exp_f32 v177, v177
v_mfma_f32_16x16x32_bf16 v[116:119], a[240:243], a[188:191], v[116:119]
ds_read_b128 a[228:231], v8 offset:45056
s_waitcnt lgkmcnt(1)
v_mfma_f32_16x16x32_bf16 v[72:75], a[212:215], a[128:131], v[36:39]
ds_read_b128 a[232:235], v9 offset:45056
v_cvt_pk_bf16_f32 v168, v168, v169
v_mfma_f32_16x16x32_bf16 v[72:75], a[216:219], a[132:135], v[72:75]
v_exp_f32 v178, v178
v_mfma_f32_16x16x32_bf16 v[72:75], a[220:223], a[136:139], v[72:75]
v_cvt_pk_bf16_f32 v169, v170, v171
v_cvt_pk_bf16_f32 v170, v172, v173
v_mfma_f32_16x16x32_bf16 v[72:75], a[224:227], a[140:143], v[72:75]
v_exp_f32 v179, v179
v_mfma_f32_16x16x32_bf16 v[88:91], a[212:215], a[144:147], v[40:43]
ds_read_b128 a[236:239], v10 offset:45056
v_max3_f32 v53, v53, v83, v84
v_mfma_f32_16x16x32_bf16 v[88:91], a[216:219], a[148:151], v[88:91]
v_exp_f32 v180, v180
v_mfma_f32_16x16x32_bf16 v[88:91], a[220:223], a[152:155], v[88:91]
v_max3_f32 v54, v54, v99, v100
v_max3_f32 v55, v55, v115, v116
v_mfma_f32_16x16x32_bf16 v[88:91], a[224:227], a[156:159], v[88:91]
v_cvt_pk_bf16_f32 v171, v174, v175
v_cvt_pk_bf16_f32 v176, v176, v177
v_mfma_f32_16x16x32_bf16 v[104:107], a[212:215], a[160:163], v[44:47]
v_exp_f32 v181, v181
v_mfma_f32_16x16x32_bf16 v[104:107], a[216:219], a[164:167], v[104:107]
ds_read_b128 a[240:243], v11 offset:45056
v_max3_f32 v52, v52, v69, v70
v_mfma_f32_16x16x32_bf16 v[104:107], a[220:223], a[168:171], v[104:107]
v_max3_f32 v53, v53, v85, v86
v_max3_f32 v54, v54, v101, v102
v_mfma_f32_16x16x32_bf16 v[104:107], a[224:227], a[172:175], v[104:107]
v_cvt_pk_bf16_f32 v177, v178, v179
v_cvt_pk_bf16_f32 v178, v180, v181
v_mfma_f32_16x16x32_bf16 v[120:123], a[212:215], a[176:179], v[48:51]
v_exp_f32 v182, v182
v_mfma_f32_16x16x32_bf16 v[120:123], a[216:219], a[180:183], v[120:123]
v_exp_f32 v183, v183
v_mfma_f32_16x16x32_bf16 v[120:123], a[220:223], a[184:187], v[120:123]
v_cvt_pk_bf16_f32 v179, v182, v183
v_max3_f32 v55, v55, v117, v118
v_mfma_f32_16x16x32_bf16 v[120:123], a[224:227], a[188:191], v[120:123]
v_exp_f32 v184, v184
s_waitcnt lgkmcnt(0)
v_mfma_f32_16x16x32_bf16 v[76:79], a[228:231], a[128:131], v[36:39]
v_exp_f32 v185, v185
v_mfma_f32_16x16x32_bf16 v[76:79], a[232:235], a[132:135], v[76:79]
ds_read_b64_tr_b16 a[212:213], v12 offset:49152
v_cvt_pk_bf16_f32 v184, v184, v185
v_mfma_f32_16x16x32_bf16 v[76:79], a[236:239], a[136:139], v[76:79]
buffer_load_dwordx4 v25, s[24:27], s47 offen offset:3072 lds
v_mfma_f32_16x16x32_bf16 v[76:79], a[240:243], a[140:143], v[76:79]
v_exp_f32 v186, v186
v_mfma_f32_16x16x32_bf16 v[92:95], a[228:231], a[144:147], v[40:43]
ds_read_b64_tr_b16 a[214:215], v12 offset:53248
v_max3_f32 v52, v52, v71, v72
v_mfma_f32_16x16x32_bf16 v[92:95], a[232:235], a[148:151], v[92:95]
v_exp_f32 v187, v187
v_mfma_f32_16x16x32_bf16 v[92:95], a[236:239], a[152:155], v[92:95]
v_max3_f32 v53, v53, v87, v88
v_max3_f32 v54, v54, v103, v104
v_mfma_f32_16x16x32_bf16 v[92:95], a[240:243], a[156:159], v[92:95]
v_exp_f32 v188, v188
v_mfma_f32_16x16x32_bf16 v[108:111], a[228:231], a[160:163], v[44:47]
v_exp_f32 v189, v189
v_mfma_f32_16x16x32_bf16 v[108:111], a[232:235], a[164:167], v[108:111]
ds_read_b64_tr_b16 a[216:217], v12 offset:57344
v_exp_f32 v190, v190
v_mfma_f32_16x16x32_bf16 v[108:111], a[236:239], a[168:171], v[108:111]
ds_read_b64_tr_b16 a[218:219], v12 offset:61440
v_max3_f32 v55, v55, v119, v120
v_mfma_f32_16x16x32_bf16 v[108:111], a[240:243], a[172:175], v[108:111]
ds_read_b64_tr_b16 a[220:221], v13 offset:49152
v_exp_f32 v191, v191
v_mfma_f32_16x16x32_bf16 v[124:127], a[228:231], a[176:179], v[48:51]
v_cvt_pk_bf16_f32 v185, v186, v187
v_cvt_pk_bf16_f32 v186, v188, v189
v_mfma_f32_16x16x32_bf16 v[124:127], a[232:235], a[180:183], v[124:127]
v_max3_f32 v52, v52, v73, v74
v_max3_f32 v53, v53, v89, v90
v_mfma_f32_16x16x32_bf16 v[124:127], a[236:239], a[184:187], v[124:127]
v_max3_f32 v54, v54, v105, v106
v_max3_f32 v55, v55, v121, v122
v_mfma_f32_16x16x32_bf16 v[124:127], a[240:243], a[188:191], v[124:127]
ds_read_b64_tr_b16 a[222:223], v13 offset:53248
v_cvt_pk_bf16_f32 v187, v190, v191
v_mfma_f32_16x16x32_bf16 a[192:195], a[208:211], v[128:131], a[192:195]
v_max3_f32 v52, v52, v75, v76
v_max3_f32 v53, v53, v91, v92
v_mfma_f32_16x16x32_bf16 a[192:195], a[208:211], v[136:139], a[192:195]
ds_read_b64_tr_b16 a[224:225], v13 offset:57344
v_max3_f32 v54, v54, v107, v108
v_mfma_f32_16x16x32_bf16 a[196:199], a[208:211], v[144:147], a[196:199]
ds_read_b64_tr_b16 a[226:227], v13 offset:61440
v_max3_f32 v55, v55, v123, v124
v_mfma_f32_16x16x32_bf16 a[196:199], a[208:211], v[152:155], a[196:199]
ds_read_b64_tr_b16 a[228:229], v14 offset:49152
v_max3_f32 v52, v52, v77, v78
v_mfma_f32_16x16x32_bf16 a[200:203], a[208:211], v[160:163], a[200:203]
v_max3_f32 v53, v53, v93, v94
v_max3_f32 v54, v54, v109, v110
v_mfma_f32_16x16x32_bf16 a[200:203], a[208:211], v[168:171], a[200:203]
buffer_load_dwordx4 v[192:195], v3, s[48:51], s52 offen
v_mfma_f32_16x16x32_bf16 a[204:207], a[208:211], v[176:179], a[204:207]
ds_read_b64_tr_b16 a[230:231], v14 offset:53248
v_max3_f32 v55, v55, v125, v126
v_mfma_f32_16x16x32_bf16 a[204:207], a[208:211], v[184:187], a[204:207]
ds_read_b64_tr_b16 a[232:233], v14 offset:57344
s_waitcnt lgkmcnt(3)
v_mfma_f32_16x16x32_bf16 a[0:3], a[212:215], v[128:131], a[0:3]
ds_read_b64_tr_b16 a[234:235], v14 offset:61440
v_max_f32 v52, v52, v79
v_mfma_f32_16x16x32_bf16 a[0:3], a[216:219], v[136:139], a[0:3]
ds_read_b64_tr_b16 a[236:237], v15 offset:49152
v_max_f32 v53, v53, v95
v_max_f32 v54, v54, v111
v_mfma_f32_16x16x32_bf16 a[4:7], a[212:215], v[144:147], a[4:7]
ds_read_b64_tr_b16 a[238:239], v15 offset:53248
v_max_f32 v55, v55, v127
v_mfma_f32_16x16x32_bf16 a[4:7], a[216:219], v[152:155], a[4:7]
ds_read_b64_tr_b16 a[240:241], v15 offset:57344
v_max3_f32 v60, v52, v53, v54
v_mfma_f32_16x16x32_bf16 a[8:11], a[212:215], v[160:163], a[8:11]
ds_read_b64_tr_b16 a[242:243], v15 offset:61440
v_max_f32 v60, v60, v55
v_mfma_f32_16x16x32_bf16 a[8:11], a[216:219], v[168:171], a[8:11]
v_cmp_lt_f32 vcc, s46, v60
s_cbranch_vccnz L_attn_kernel_rare_c_1
L_attn_kernel_back_c_1:
v_mfma_f32_16x16x32_bf16 a[12:15], a[212:215], v[176:179], a[12:15]
v_exp_f32 v64, v64
v_mfma_f32_16x16x32_bf16 a[12:15], a[216:219], v[184:187], a[12:15]
v_exp_f32 v65, v65
v_mfma_f32_16x16x32_bf16 a[16:19], a[220:223], v[128:131], a[16:19]
ds_read_b64_tr_b16 a[212:213], v16 offset:49152
s_add_u32 s52, s52, 0x100000
v_mfma_f32_16x16x32_bf16 a[16:19], a[224:227], v[136:139], a[16:19]
v_exp_f32 v66, v66
v_mfma_f32_16x16x32_bf16 a[20:23], a[220:223], v[144:147], a[20:23]
v_exp_f32 v67, v67
v_mfma_f32_16x16x32_bf16 a[20:23], a[224:227], v[152:155], a[20:23]
v_exp_f32 v68, v68
v_mfma_f32_16x16x32_bf16 a[24:27], a[220:223], v[160:163], a[24:27]
ds_read_b64_tr_b16 a[214:215], v16 offset:53248
v_cvt_pk_bf16_f32 v64, v64, v65
v_mfma_f32_16x16x32_bf16 a[24:27], a[224:227], v[168:171], a[24:27]
v_exp_f32 v69, v69
v_mfma_f32_16x16x32_bf16 a[28:31], a[220:223], v[176:179], a[28:31]
v_exp_f32 v70, v70
v_mfma_f32_16x16x32_bf16 a[28:31], a[224:227], v[184:187], a[28:31]
ds_read_b64_tr_b16 a[216:217], v16 offset:57344
s_waitcnt lgkmcnt(3)
v_mfma_f32_16x16x32_bf16 a[32:35], a[228:231], v[128:131], a[32:35]
v_exp_f32 v71, v71
v_mfma_f32_16x16x32_bf16 a[32:35], a[232:235], v[136:139], a[32:35]
ds_read_b64_tr_b16 a[218:219], v16 offset:61440
v_cvt_pk_bf16_f32 v65, v66, v67
v_mfma_f32_16x16x32_bf16 a[36:39], a[228:231], v[144:147], a[36:39]
ds_read_b64_tr_b16 a[220:221], v17 offset:49152
v_mfma_f32_16x16x32_bf16 a[36:39], a[232:235], v[152:155], a[36:39]
ds_read_b64_tr_b16 a[222:223], v17 offset:53248
v_mfma_f32_16x16x32_bf16 a[40:43], a[228:231], v[160:163], a[40:43]
v_exp_f32 v72, v72
v_mfma_f32_16x16x32_bf16 a[40:43], a[232:235], v[168:171], a[40:43]
v_exp_f32 v73, v73
v_mfma_f32_16x16x32_bf16 a[44:47], a[228:231], v[176:179], a[44:47]
v_exp_f32 v74, v74
v_mfma_f32_16x16x32_bf16 a[44:47], a[232:235], v[184:187], a[44:47]
ds_read_b64_tr_b16 a[224:225], v17 offset:57344
s_add_u32 s44, s44, 16384
v_mfma_f32_16x16x32_bf16 a[48:51], a[236:239], v[128:131], a[48:51]
ds_read_b64_tr_b16 a[226:227], v17 offset:61440
s_add_u32 s47, s47, 16384
v_mfma_f32_16x16x32_bf16 a[48:51], a[240:243], v[136:139], a[48:51]
ds_read_b64_tr_b16 a[228:229], v18 offset:49152
v_mfma_f32_16x16x32_bf16 a[52:55], a[236:239], v[144:147], a[52:55]
ds_read_b64_tr_b16 a[230:231], v18 offset:53248
v_mfma_f32_16x16x32_bf16 a[52:55], a[240:243], v[152:155], a[52:55]
ds_read_b64_tr_b16 a[232:233], v18 offset:57344
v_cvt_pk_bf16_f32 v66, v68, v69
v_mfma_f32_16x16x32_bf16 a[56:59], a[236:239], v[160:163], a[56:59]
v_exp_f32 v75, v75
v_mfma_f32_16x16x32_bf16 a[56:59], a[240:243], v[168:171], a[56:59]
v_exp_f32 v76, v76
v_mfma_f32_16x16x32_bf16 a[60:63], a[236:239], v[176:179], a[60:63]
ds_read_b64_tr_b16 a[234:235], v18 offset:61440
v_cvt_pk_bf16_f32 v67, v70, v71
v_mfma_f32_16x16x32_bf16 a[60:63], a[240:243], v[184:187], a[60:63]
ds_read_b64_tr_b16 a[236:237], v19 offset:49152
s_waitcnt lgkmcnt(5)
v_mfma_f32_16x16x32_bf16 a[64:67], a[212:215], v[128:131], a[64:67]
v_exp_f32 v77, v77
v_mfma_f32_16x16x32_bf16 a[64:67], a[216:219], v[136:139], a[64:67]
v_cvt_pk_bf16_f32 v72, v72, v73
v_cvt_pk_bf16_f32 v73, v74, v75
v_mfma_f32_16x16x32_bf16 a[68:71], a[212:215], v[144:147], a[68:71]
v_exp_f32 v78, v78
v_mfma_f32_16x16x32_bf16 a[68:71], a[216:219], v[152:155], a[68:71]
ds_read_b64_tr_b16 a[238:239], v19 offset:53248
v_mfma_f32_16x16x32_bf16 a[72:75], a[212:215], v[160:163], a[72:75]
v_exp_f32 v79, v79
v_mfma_f32_16x16x32_bf16 a[72:75], a[216:219], v[168:171], a[72:75]
v_exp_f32 v80, v80
v_mfma_f32_16x16x32_bf16 a[76:79], a[212:215], v[176:179], a[76:79]
v_exp_f32 v81, v81
v_mfma_f32_16x16x32_bf16 a[76:79], a[216:219], v[184:187], a[76:79]
ds_read_b64_tr_b16 a[240:241], v19 offset:57344
v_cvt_pk_bf16_f32 v74, v76, v77
v_mfma_f32_16x16x32_bf16 a[80:83], a[220:223], v[128:131], a[80:83]
v_exp_f32 v82, v82
v_mfma_f32_16x16x32_bf16 a[80:83], a[224:227], v[136:139], a[80:83]
ds_read_b64_tr_b16 a[242:243], v19 offset:61440
v_cvt_pk_bf16_f32 v75, v78, v79
v_mfma_f32_16x16x32_bf16 a[84:87], a[220:223], v[144:147], a[84:87]
v_exp_f32 v83, v83
v_mfma_f32_16x16x32_bf16 a[84:87], a[224:227], v[152:155], a[84:87]
v_mfma_f32_16x16x32_bf16 a[88:91], a[220:223], v[160:163], a[88:91]
v_exp_f32 v84, v84
v_mfma_f32_16x16x32_bf16 a[88:91], a[224:227], v[168:171], a[88:91]
v_exp_f32 v85, v85
v_mfma_f32_16x16x32_bf16 a[92:95], a[220:223], v[176:179], a[92:95]
v_mfma_f32_16x16x32_bf16 a[92:95], a[224:227], v[184:187], a[92:95]
s_waitcnt vmcnt(6) lgkmcnt(0)
s_barrier
v_mfma_f32_16x16x32_bf16 a[96:99], a[228:231], v[128:131], a[96:99]
v_exp_f32 v86, v86
v_mfma_f32_16x16x32_bf16 a[96:99], a[232:235], v[136:139], a[96:99]
v_exp_f32 v87, v87
v_mfma_f32_16x16x32_bf16 a[100:103], a[228:231], v[144:147], a[100:103]
v_exp_f32 v88, v88
v_mfma_f32_16x16x32_bf16 a[100:103], a[232:235], v[152:155], a[100:103]
ds_read_b128 a[212:215], v8 offset:49152
v_cvt_pk_bf16_f32 v80, v80, v81
v_mfma_f32_16x16x32_bf16 a[104:107], a[228:231], v[160:163], a[104:107]
ds_read_b128 a[216:219], v9 offset:49152
v_cvt_pk_bf16_f32 v81, v82, v83
v_mfma_f32_16x16x32_bf16 a[104:107], a[232:235], v[168:171], a[104:107]
ds_read_b128 a[220:223], v10 offset:49152
v_cvt_pk_bf16_f32 v82, v84, v85
v_mfma_f32_16x16x32_bf16 a[108:111], a[228:231], v[176:179], a[108:111]
v_exp_f32 v89, v89
v_mfma_f32_16x16x32_bf16 a[108:111], a[232:235], v[184:187], a[108:111]
ds_read_b128 a[224:227], v11 offset:49152
v_cvt_pk_bf16_f32 v83, v86, v87
v_mfma_f32_16x16x32_bf16 a[112:115], a[236:239], v[128:131], a[112:115]
v_exp_f32 v90, v90
v_mfma_f32_16x16x32_bf16 a[112:115], a[240:243], v[136:139], a[112:115]
v_exp_f32 v91, v91
v_mfma_f32_16x16x32_bf16 a[116:119], a[236:239], v[144:147], a[116:119]
v_cvt_pk_bf16_f32 v88, v88, v89
v_cvt_pk_bf16_f32 v89, v90, v91
v_mfma_f32_16x16x32_bf16 a[116:119], a[240:243], v[152:155], a[116:119]
v_exp_f32 v92, v92
v_mfma_f32_16x16x32_bf16 a[120:123], a[236:239], v[160:163], a[120:123]
v_exp_f32 v93, v93
v_mfma_f32_16x16x32_bf16 a[120:123], a[240:243], v[168:171], a[120:123]
v_exp_f32 v94, v94
v_mfma_f32_16x16x32_bf16 a[124:127], a[236:239], v[176:179], a[124:127]
v_exp_f32 v95, v95
v_mfma_f32_16x16x32_bf16 a[124:127], a[240:243], v[184:187], a[124:127]
v_cvt_pk_bf16_f32 v90, v92, v93
v_cvt_pk_bf16_f32 v91, v94, v95
s_waitcnt lgkmcnt(0)
v_mfma_f32_16x16x32_bf16 v[128:131], a[212:215], a[128:131], v[36:39]
ds_read_b128 a[228:231], v8 offset:53248
v_mfma_f32_16x16x32_bf16 v[128:131], a[216:219], a[132:135], v[128:131]
v_exp_f32 v96, v96
v_mfma_f32_16x16x32_bf16 v[128:131], a[220:223], a[136:139], v[128:131]
v_exp_f32 v97, v97
v_mfma_f32_16x16x32_bf16 v[128:131], a[224:227], a[140:143], v[128:131]
ds_read_b128 a[232:235], v9 offset:53248
v_exp_f32 v98, v98
v_mfma_f32_16x16x32_bf16 v[144:147], a[212:215], a[144:147], v[40:43]
v_exp_f32 v99, v99
v_mfma_f32_16x16x32_bf16 v[144:147], a[216:219], a[148:151], v[144:147]
v_exp_f32 v100, v100
v_mfma_f32_16x16x32_bf16 v[144:147], a[220:223], a[152:155], v[144:147]
v_exp_f32 v101, v101
v_mfma_f32_16x16x32_bf16 v[144:147], a[224:227], a[156:159], v[144:147]
ds_read_b128 a[236:239], v10 offset:53248
v_cvt_pk_bf16_f32 v96, v96, v97
v_mfma_f32_16x16x32_bf16 v[160:163], a[212:215], a[160:163], v[44:47]
ds_read_b128 a[240:243], v11 offset:53248
v_max3_f32 v52, v128, v129, v130
v_mfma_f32_16x16x32_bf16 v[160:163], a[216:219], a[164:167], v[160:163]
v_exp_f32 v102, v102
v_mfma_f32_16x16x32_bf16 v[160:163], a[220:223], a[168:171], v[160:163]
buffer_load_dwordx4 v[192:195], v3, s[48:51], s52 offen
v_mfma_f32_16x16x32_bf16 v[160:163], a[224:227], a[172:175], v[160:163]
v_exp_f32 v103, v103
v_mfma_f32_16x16x32_bf16 v[176:179], a[212:215], a[176:179], v[48:51]
v_exp_f32 v104, v104
v_mfma_f32_16x16x32_bf16 v[176:179], a[216:219], a[180:183], v[176:179]
v_exp_f32 v105, v105
v_mfma_f32_16x16x32_bf16 v[176:179], a[220:223], a[184:187], v[176:179]
v_cvt_pk_bf16_f32 v97, v98, v99
v_max3_f32 v53, v144, v145, v146
v_mfma_f32_16x16x32_bf16 v[176:179], a[224:227], a[188:191], v[176:179]
v_cvt_pk_bf16_f32 v98, v100, v101
s_waitcnt lgkmcnt(0)
v_mfma_f32_16x16x32_bf16 v[132:135], a[228:231], a[128:131], v[36:39]
v_exp_f32 v106, v106
v_mfma_f32_16x16x32_bf16 v[132:135], a[232:235], a[132:135], v[132:135]
v_exp_f32 v107, v107
v_mfma_f32_16x16x32_bf16 v[132:135], a[236:239], a[136:139], v[132:135]
ds_read_b128 a[212:215], v8 offset:57344
v_cvt_pk_bf16_f32 v99, v102, v103
v_mfma_f32_16x16x32_bf16 v[132:135], a[240:243], a[140:143], v[132:135]
v_exp_f32 v108, v108
v_mfma_f32_16x16x32_bf16 v[148:151], a[228:231], a[144:147], v[40:43]
ds_read_b128 a[216:219], v9 offset:57344
v_max3_f32 v54, v160, v161, v162
v_mfma_f32_16x16x32_bf16 v[148:151], a[232:235], a[148:151], v[148:151]
v_exp_f32 v109, v109
v_mfma_f32_16x16x32_bf16 v[148:151], a[236:239], a[152:155], v[148:151]
ds_read_b128 a[220:223], v10 offset:57344
v_mfma_f32_16x16x32_bf16 v[148:151], a[240:243], a[156:159], v[148:151]
v_cvt_pk_bf16_f32 v104, v104, v105
v_max3_f32 v55, v176, v177, v178
v_mfma_f32_16x16x32_bf16 v[164:167], a[228:231], a[160:163], v[44:47]
ds_read_b128 a[224:227], v11 offset:57344
v_max3_f32 v52, v52, v131, v132
v_mfma_f32_16x16x32_bf16 v[164:167], a[232:235], a[164:167], v[164:167]
v_exp_f32 v110, v110
v_mfma_f32_16x16x32_bf16 v[164:167], a[236:239], a[168:171], v[164:167]
v_exp_f32 v111, v111
v_mfma_f32_16x16x32_bf16 v[164:167], a[240:243], a[172:175], v[164:167]
v_cvt_pk_bf16_f32 v105, v106, v107
v_cvt_pk_bf16_f32 v106, v108, v109
v_mfma_f32_16x16x32_bf16 v[180:183], a[228:231], a[176:179], v[48:51]
v_exp_f32 v112, v112
v_mfma_f32_16x16x32_bf16 v[180:183], a[232:235], a[180:183], v[180:183]
v_exp_f32 v113, v113
v_mfma_f32_16x16x32_bf16 v[180:183], a[236:239], a[184:187], v[180:183]
v_exp_f32 v114, v114
v_mfma_f32_16x16x32_bf16 v[180:183], a[240:243], a[188:191], v[180:183]
ds_read_b128 a[228:231], v8 offset:61440
s_waitcnt lgkmcnt(1)
v_mfma_f32_16x16x32_bf16 v[136:139], a[212:215], a[128:131], v[36:39]
v_cvt_pk_bf16_f32 v107, v110, v111
v_cvt_pk_bf16_f32 v112, v112, v113
v_mfma_f32_16x16x32_bf16 v[136:139], a[216:219], a[132:135], v[136:139]
v_exp_f32 v115, v115
v_mfma_f32_16x16x32_bf16 v[136:139], a[220:223], a[136:139], v[136:139]
ds_read_b128 a[232:235], v9 offset:61440
v_cvt_pk_bf16_f32 v113, v114, v115
v_mfma_f32_16x16x32_bf16 v[136:139], a[224:227], a[140:143], v[136:139]
ds_read_b128 a[236:239], v10 offset:61440
v_max3_f32 v53, v53, v147, v148
v_mfma_f32_16x16x32_bf16 v[152:155], a[212:215], a[144:147], v[40:43]
v_exp_f32 v116, v116
v_mfma_f32_16x16x32_bf16 v[152:155], a[216:219], a[148:151], v[152:155]
v_exp_f32 v117, v117
v_mfma_f32_16x16x32_bf16 v[152:155], a[220:223], a[152:155], v[152:155]
ds_read_b128 a[240:243], v11 offset:61440
v_exp_f32 v118, v118
v_mfma_f32_16x16x32_bf16 v[152:155], a[224:227], a[156:159], v[152:155]
v_exp_f32 v119, v119
v_mfma_f32_16x16x32_bf16 v[168:171], a[212:215], a[160:163], v[44:47]
v_cvt_pk_bf16_f32 v114, v116, v117
v_cvt_pk_bf16_f32 v115, v118, v119
v_mfma_f32_16x16x32_bf16 v[168:171], a[216:219], a[164:167], v[168:171]
v_max3_f32 v54, v54, v163, v164
v_max3_f32 v55, v55, v179, v180
v_mfma_f32_16x16x32_bf16 v[168:171], a[220:223], a[168:171], v[168:171]
v_max3_f32 v52, v52, v133, v134
v_max3_f32 v53, v53, v149, v150
v_mfma_f32_16x16x32_bf16 v[168:171], a[224:227], a[172:175], v[168:171]
v_exp_f32 v120, v120
v_mfma_f32_16x16x32_bf16 v[184:187], a[212:215], a[176:179], v[48:51]
v_exp_f32 v121, v121
v_mfma_f32_16x16x32_bf16 v[184:187], a[216:219], a[180:183], v[184:187]
v_exp_f32 v122, v122
v_mfma_f32_16x16x32_bf16 v[184:187], a[220:223], a[184:187], v[184:187]
v_exp_f32 v123, v123
v_mfma_f32_16x16x32_bf16 v[184:187], a[224:227], a[188:191], v[184:187]
v_cvt_pk_bf16_f32 v120, v120, v121
s_waitcnt lgkmcnt(0)
v_mfma_f32_16x16x32_bf16 v[140:143], a[228:231], a[128:131], v[36:39]
v_exp_f32 v124, v124
v_mfma_f32_16x16x32_bf16 v[140:143], a[232:235], a[132:135], v[140:143]
ds_read_b64_tr_b16 a[212:213], v12 offset:0
v_max3_f32 v54, v54, v165, v166
v_mfma_f32_16x16x32_bf16 v[140:143], a[236:239], a[136:139], v[140:143]
ds_read_b64_tr_b16 a[214:215], v12 offset:4096
v_max3_f32 v55, v55, v181, v182
v_mfma_f32_16x16x32_bf16 v[140:143], a[240:243], a[140:143], v[140:143]
s_cmp_lg_u32 s45, 0
s_cbranch_scc1 L_attn_kernel_resc_c_2
L_attn_kernel_rback_c_2:
v_mfma_f32_16x16x32_bf16 v[156:159], a[228:231], a[144:147], v[40:43]
ds_read_b64_tr_b16 a[216:217], v12 offset:8192
v_max3_f32 v52, v52, v135, v136
v_mfma_f32_16x16x32_bf16 v[156:159], a[232:235], a[148:151], v[156:159]
v_max3_f32 v53, v53, v151, v152
v_max3_f32 v54, v54, v167, v168
v_mfma_f32_16x16x32_bf16 v[156:159], a[236:239], a[152:155], v[156:159]
v_max3_f32 v55, v55, v183, v184
v_max3_f32 v52, v52, v137, v138
v_mfma_f32_16x16x32_bf16 v[156:159], a[240:243], a[156:159], v[156:159]
v_max3_f32 v53, v53, v153, v154
v_max3_f32 v54, v54, v169, v170
v_mfma_f32_16x16x32_bf16 v[172:175], a[228:231], a[160:163], v[44:47]
v_exp_f32 v125, v125
v_mfma_f32_16x16x32_bf16 v[172:175], a[232:235], a[164:167], v[172:175]
ds_read_b64_tr_b16 a[218:219], v12 offset:12288
v_max3_f32 v55, v55, v185, v186
v_mfma_f32_16x16x32_bf16 v[172:175], a[236:239], a[168:171], v[172:175]
ds_read_b64_tr_b16 a[220:221], v13 offset:0
v_cvt_pk_bf16_f32 v121, v122, v123
v_mfma_f32_16x16x32_bf16 v[172:175], a[240:243], a[172:175], v[172:175]
ds_read_b64_tr_b16 a[222:223], v13 offset:4096
v_max3_f32 v52, v52, v139, v140
v_mfma_f32_16x16x32_bf16 v[188:191], a[228:231], a[176:179], v[48:51]
v_exp_f32 v126, v126
v_mfma_f32_16x16x32_bf16 v[188:191], a[232:235], a[180:183], v[188:191]
ds_read_b64_tr_b16 a[224:225], v13 offset:8192
v_cvt_pk_bf16_f32 v122, v124, v125
v_mfma_f32_16x16x32_bf16 v[188:191], a[236:239], a[184:187], v[188:191]
v_exp_f32 v127, v127
v_mfma_f32_16x16x32_bf16 v[188:191], a[240:243], a[188:191], v[188:191]
ds_read_b64_tr_b16 a[226:227], v13 offset:12288
v_cvt_pk_bf16_f32 v123, v126, v127
v_mfma_f32_16x16x32_bf16 a[192:195], a[208:211], v[64:67], a[192:195]
ds_read_b64_tr_b16 a[228:229], v14 offset:0
v_max3_f32 v53, v53, v155, v156
v_mfma_f32_16x16x32_bf16 a[192:195], a[208:211], v[72:75], a[192:195]
ds_read_b64_tr_b16 a[230:231], v14 offset:4096
v_max3_f32 v54, v54, v171, v172
v_mfma_f32_16x16x32_bf16 a[196:199], a[208:211], v[80:83], a[196:199]
v_max3_f32 v55, v55, v187, v188
v_max3_f32 v52, v52, v141, v142
v_mfma_f32_16x16x32_bf16 a[196:199], a[208:211], v[88:91], a[196:199]
v_max3_f32 v53, v53, v157, v158
v_max3_f32 v54, v54, v173, v174
v_mfma_f32_16x16x32_bf16 a[200:203], a[208:211], v[96:99], a[200:203]
v_max3_f32 v55, v55, v189, v190
v_max_f32 v52, v52, v143
v_mfma_f32_16x16x32_bf16 a[200:203], a[208:211], v[104:107], a[200:203]
ds_read_b64_tr_b16 a[232:233], v14 offset:8192
v_max_f32 v53, v53, v159
v_max_f32 v54, v54, v175
v_mfma_f32_16x16x32_bf16 a[204:207], a[208:211], v[112:115], a[204:207]
ds_read_b64_tr_b16 a[234:235], v14 offset:12288
v_max_f32 v55, v55, v191
v_mfma_f32_16x16x32_bf16 a[204:207], a[208:211], v[120:123], a[204:207]
ds_read_b64_tr_b16 a[236:237], v15 offset:0
s_waitcnt lgkmcnt(5)
v_mfma_f32_16x16x32_bf16 a[0:3], a[212:215], v[64:67], a[0:3]
ds_read_b64_tr_b16 a[238:239], v15 offset:4096
v_max3_f32 v60, v52, v53, v54
v_mfma_f32_16x16x32_bf16 a[0:3], a[216:219], v[72:75], a[0:3]
ds_read_b64_tr_b16 a[240:241], v15 offset:8192
v_max_f32 v60, v60, v55
v_mfma_f32_16x16x32_bf16 a[4:7], a[212:215], v[80:83], a[4:7]
v_cmp_lt_f32 vcc, s46, v60
s_cbranch_vccnz L_attn_kernel_rare_c_2
L_attn_kernel_back_c_2:
v_mfma_f32_16x16x32_bf16 a[4:7], a[216:219], v[88:91], a[4:7]
v_exp_f32 v128, v128
v_mfma_f32_16x16x32_bf16 a[8:11], a[212:215], v[96:99], a[8:11]
v_exp_f32 v129, v129
v_mfma_f32_16x16x32_bf16 a[8:11], a[216:219], v[104:107], a[8:11]
v_exp_f32 v130, v130
v_mfma_f32_16x16x32_bf16 a[12:15], a[212:215], v[112:115], a[12:15]
v_exp_f32 v131, v131
v_mfma_f32_16x16x32_bf16 a[12:15], a[216:219], v[120:123], a[12:15]
ds_read_b64_tr_b16 a[242:243], v15 offset:12288
v_mfma_f32_16x16x32_bf16 a[16:19], a[220:223], v[64:67], a[16:19]
v_exp_f32 v132, v132
v_mfma_f32_16x16x32_bf16 a[16:19], a[224:227], v[72:75], a[16:19]
v_exp_f32 v133, v133
v_mfma_f32_16x16x32_bf16 a[20:23], a[220:223], v[80:83], a[20:23]
ds_read_b64_tr_b16 a[212:213], v16 offset:0
s_add_u32 s52, s52, 0x100000
v_mfma_f32_16x16x32_bf16 a[20:23], a[224:227], v[88:91], a[20:23]
v_exp_f32 v134, v134
v_mfma_f32_16x16x32_bf16 a[24:27], a[220:223], v[96:99], a[24:27]
v_exp_f32 v135, v135
v_mfma_f32_16x16x32_bf16 a[24:27], a[224:227], v[104:107], a[24:27]
v_exp_f32 v136, v136
v_mfma_f32_16x16x32_bf16 a[28:31], a[220:223], v[112:115], a[28:31]
ds_read_b64_tr_b16 a[214:215], v16 offset:4096
v_cvt_pk_bf16_f32 v128, v128, v129
v_mfma_f32_16x16x32_bf16 a[28:31], a[224:227], v[120:123], a[28:31]
ds_read_b64_tr_b16 a[216:217], v16 offset:8192
s_waitcnt lgkmcnt(3)
v_mfma_f32_16x16x32_bf16 a[32:35], a[228:231], v[64:67], a[32:35]
ds_read_b64_tr_b16 a[218:219], v16 offset:12288
v_cvt_pk_bf16_f32 v129, v130, v131
v_mfma_f32_16x16x32_bf16 a[32:35], a[232:235], v[72:75], a[32:35]
ds_read_b64_tr_b16 a[220:221], v17 offset:0
v_cvt_pk_bf16_f32 v130, v132, v133
v_mfma_f32_16x16x32_bf16 a[36:39], a[228:231], v[80:83], a[36:39]
v_exp_f32 v137, v137
v_mfma_f32_16x16x32_bf16 a[36:39], a[232:235], v[88:91], a[36:39]
ds_read_b64_tr_b16 a[222:223], v17 offset:4096
v_cvt_pk_bf16_f32 v131, v134, v135
v_mfma_f32_16x16x32_bf16 a[40:43], a[228:231], v[96:99], a[40:43]
v_exp_f32 v138, v138
v_mfma_f32_16x16x32_bf16 a[40:43], a[232:235], v[104:107], a[40:43]
ds_read_b64_tr_b16 a[224:225], v17 offset:8192
s_add_u32 s44, s44, 16384
v_mfma_f32_16x16x32_bf16 a[44:47], a[228:231], v[112:115], a[44:47]
ds_read_b64_tr_b16 a[226:227], v17 offset:12288
v_mfma_f32_16x16x32_bf16 a[44:47], a[232:235], v[120:123], a[44:47]
v_exp_f32 v139, v139
v_mfma_f32_16x16x32_bf16 a[48:51], a[236:239], v[64:67], a[48:51]
v_exp_f32 v140, v140
v_mfma_f32_16x16x32_bf16 a[48:51], a[240:243], v[72:75], a[48:51]
v_exp_f32 v141, v141
v_mfma_f32_16x16x32_bf16 a[52:55], a[236:239], v[80:83], a[52:55]
v_exp_f32 v142, v142
v_mfma_f32_16x16x32_bf16 a[52:55], a[240:243], v[88:91], a[52:55]
v_mfma_f32_16x16x32_bf16 a[56:59], a[236:239], v[96:99], a[56:59]
v_cvt_pk_bf16_f32 v136, v136, v137
v_cvt_pk_bf16_f32 v137, v138, v139
v_mfma_f32_16x16x32_bf16 a[56:59], a[240:243], v[104:107], a[56:59]
v_exp_f32 v143, v143
v_mfma_f32_16x16x32_bf16 a[60:63], a[236:239], v[112:115], a[60:63]
ds_read_b64_tr_b16 a[228:229], v18 offset:0
s_add_u32 s47, s47, 16384
v_mfma_f32_16x16x32_bf16 a[60:63], a[240:243], v[120:123], a[60:63]
ds_read_b64_tr_b16 a[230:231], v18 offset:4096
s_waitcnt lgkmcnt(2)
v_mfma_f32_16x16x32_bf16 a[64:67], a[212:215], v[64:67], a[64:67]
ds_read_b64_tr_b16 a[232:233], v18 offset:8192
v_mfma_f32_16x16x32_bf16 a[64:67], a[216:219], v[72:75], a[64:67]
ds_read_b64_tr_b16 a[234:235], v18 offset:12288
v_cvt_pk_bf16_f32 v138, v140, v141
v_mfma_f32_16x16x32_bf16 a[68:71], a[212:215], v[80:83], a[68:71]
ds_read_b64_tr_b16 a[236:237], v19 offset:0
v_mfma_f32_16x16x32_bf16 a[68:71], a[216:219], v[88:91], a[68:71]
v_exp_f32 v144, v144
v_mfma_f32_16x16x32_bf16 a[72:75], a[212:215], v[96:99], a[72:75]
v_exp_f32 v145, v145
v_mfma_f32_16x16x32_bf16 a[72:75], a[216:219], v[104:107], a[72:75]
v_mfma_f32_16x16x32_bf16 a[76:79], a[212:215], v[112:115], a[76:79]
ds_read_b64_tr_b16 a[238:239], v19 offset:4096
v_cvt_pk_bf16_f32 v139, v142, v143
v_mfma_f32_16x16x32_bf16 a[76:79], a[216:219], v[120:123], a[76:79]
ds_read_b64_tr_b16 a[240:241], v19 offset:8192
v_mfma_f32_16x16x32_bf16 a[80:83], a[220:223], v[64:67], a[80:83]
ds_read_b64_tr_b16 a[242:243], v19 offset:12288
v_mfma_f32_16x16x32_bf16 a[80:83], a[224:227], v[72:75], a[80:83]
v_exp_f32 v146, v146
v_mfma_f32_16x16x32_bf16 a[84:87], a[220:223], v[80:83], a[84:87]
v_exp_f32 v147, v147
v_mfma_f32_16x16x32_bf16 a[84:87], a[224:227], v[88:91], a[84:87]
v_exp_f32 v148, v148
v_mfma_f32_16x16x32_bf16 a[88:91], a[220:223], v[96:99], a[88:91]
v_cvt_pk_bf16_f32 v144, v144, v145
v_cvt_pk_bf16_f32 v145, v146, v147
v_mfma_f32_16x16x32_bf16 a[88:91], a[224:227], v[104:107], a[88:91]
v_exp_f32 v149, v149
v_mfma_f32_16x16x32_bf16 a[92:95], a[220:223], v[112:115], a[92:95]
v_exp_f32 v150, v150
v_mfma_f32_16x16x32_bf16 a[92:95], a[224:227], v[120:123], a[92:95]
s_waitcnt vmcnt(2) lgkmcnt(0)
s_barrier
v_mfma_f32_16x16x32_bf16 a[96:99], a[228:231], v[64:67], a[96:99]
v_exp_f32 v151, v151
v_mfma_f32_16x16x32_bf16 a[96:99], a[232:235], v[72:75], a[96:99]
v_exp_f32 v152, v152
v_mfma_f32_16x16x32_bf16 a[100:103], a[228:231], v[80:83], a[100:103]
v_cvt_pk_bf16_f32 v146, v148, v149
v_mfma_f32_16x16x32_bf16 a[100:103], a[232:235], v[88:91], a[100:103]
v_mfma_f32_16x16x32_bf16 a[104:107], a[228:231], v[96:99], a[104:107]
v_exp_f32 v153, v153
v_mfma_f32_16x16x32_bf16 a[104:107], a[232:235], v[104:107], a[104:107]
v_exp_f32 v154, v154
v_mfma_f32_16x16x32_bf16 a[108:111], a[228:231], v[112:115], a[108:111]
v_mfma_f32_16x16x32_bf16 a[108:111], a[232:235], v[120:123], a[108:111]
v_exp_f32 v155, v155
v_mfma_f32_16x16x32_bf16 a[112:115], a[236:239], v[64:67], a[112:115]
v_mfma_f32_16x16x32_bf16 a[112:115], a[240:243], v[72:75], a[112:115]
v_exp_f32 v156, v156
v_mfma_f32_16x16x32_bf16 a[116:119], a[236:239], v[80:83], a[116:119]
v_exp_f32 v157, v157
v_mfma_f32_16x16x32_bf16 a[116:119], a[240:243], v[88:91], a[116:119]
v_cvt_pk_bf16_f32 v147, v150, v151
v_cvt_pk_bf16_f32 v152, v152, v153
v_mfma_f32_16x16x32_bf16 a[120:123], a[236:239], v[96:99], a[120:123]
v_exp_f32 v158, v158
v_mfma_f32_16x16x32_bf16 a[120:123], a[240:243], v[104:107], a[120:123]
v_exp_f32 v159, v159
v_mfma_f32_16x16x32_bf16 a[124:127], a[236:239], v[112:115], a[124:127]
v_cvt_pk_bf16_f32 v153, v154, v155
v_cvt_pk_bf16_f32 v154, v156, v157
v_mfma_f32_16x16x32_bf16 a[124:127], a[240:243], v[120:123], a[124:127]
v_cvt_pk_bf16_f32 v155, v158, v159
v_exp_f32 v160, v160
v_exp_f32 v161, v161
v_exp_f32 v162, v162
v_exp_f32 v163, v163
v_exp_f32 v164, v164
v_exp_f32 v165, v165
v_exp_f32 v166, v166
v_exp_f32 v167, v167
v_cvt_pk_bf16_f32 v160, v160, v161
v_cvt_pk_bf16_f32 v161, v162, v163
v_cvt_pk_bf16_f32 v162, v164, v165
v_cvt_pk_bf16_f32 v163, v166, v167
v_exp_f32 v168, v168
v_exp_f32 v169, v169
v_exp_f32 v170, v170
v_exp_f32 v171, v171
v_exp_f32 v172, v172
v_exp_f32 v173, v173
v_exp_f32 v174, v174
v_exp_f32 v175, v175
v_cvt_pk_bf16_f32 v168, v168, v169
v_cvt_pk_bf16_f32 v169, v170, v171
v_cvt_pk_bf16_f32 v170, v172, v173
v_cvt_pk_bf16_f32 v171, v174, v175
v_exp_f32 v176, v176
v_exp_f32 v177, v177
v_exp_f32 v178, v178
v_exp_f32 v179, v179
v_exp_f32 v180, v180
v_exp_f32 v181, v181
v_exp_f32 v182, v182
v_exp_f32 v183, v183
v_cvt_pk_bf16_f32 v176, v176, v177
v_cvt_pk_bf16_f32 v177, v178, v179
v_cvt_pk_bf16_f32 v178, v180, v181
v_cvt_pk_bf16_f32 v179, v182, v183
v_exp_f32 v184, v184
v_exp_f32 v185, v185
v_exp_f32 v186, v186
v_exp_f32 v187, v187
v_exp_f32 v188, v188
v_exp_f32 v189, v189
v_exp_f32 v190, v190
v_exp_f32 v191, v191
v_cvt_pk_bf16_f32 v184, v184, v185
v_cvt_pk_bf16_f32 v185, v186, v187
v_cvt_pk_bf16_f32 v186, v188, v189
v_cvt_pk_bf16_f32 v187, v190, v191
s_cmp_lg_u32 s45, 0
s_cbranch_scc1 L_attn_kernel_resc_c_3
L_attn_kernel_rback_c_3:
ds_read_b64_tr_b16 a[212:213], v12 offset:16384
ds_read_b64_tr_b16 a[214:215], v12 offset:20480
ds_read_b64_tr_b16 a[216:217], v12 offset:24576
ds_read_b64_tr_b16 a[218:219], v12 offset:28672
ds_read_b64_tr_b16 a[220:221], v13 offset:16384
ds_read_b64_tr_b16 a[222:223], v13 offset:20480
ds_read_b64_tr_b16 a[224:225], v13 offset:24576
ds_read_b64_tr_b16 a[226:227], v13 offset:28672
v_mfma_f32_16x16x32_bf16 a[192:195], a[208:211], v[128:131], a[192:195]
ds_read_b64_tr_b16 a[228:229], v14 offset:16384
v_mfma_f32_16x16x32_bf16 a[192:195], a[208:211], v[136:139], a[192:195]
ds_read_b64_tr_b16 a[230:231], v14 offset:20480
v_mfma_f32_16x16x32_bf16 a[196:199], a[208:211], v[144:147], a[196:199]
ds_read_b64_tr_b16 a[232:233], v14 offset:24576
v_mfma_f32_16x16x32_bf16 a[196:199], a[208:211], v[152:155], a[196:199]
ds_read_b64_tr_b16 a[234:235], v14 offset:28672
v_mfma_f32_16x16x32_bf16 a[200:203], a[208:211], v[160:163], a[200:203]
ds_read_b64_tr_b16 a[236:237], v15 offset:16384
v_mfma_f32_16x16x32_bf16 a[200:203], a[208:211], v[168:171], a[200:203]
ds_read_b64_tr_b16 a[238:239], v15 offset:20480
v_mfma_f32_16x16x32_bf16 a[204:207], a[208:211], v[176:179], a[204:207]
ds_read_b64_tr_b16 a[240:241], v15 offset:24576
v_mfma_f32_16x16x32_bf16 a[204:207], a[208:211], v[184:187], a[204:207]
ds_read_b64_tr_b16 a[242:243], v15 offset:28672
s_waitcnt lgkmcnt(8)
v_mfma_f32_16x16x32_bf16 a[0:3], a[212:215], v[128:131], a[0:3]
v_mfma_f32_16x16x32_bf16 a[0:3], a[216:219], v[136:139], a[0:3]
v_mfma_f32_16x16x32_bf16 a[4:7], a[212:215], v[144:147], a[4:7]
v_mfma_f32_16x16x32_bf16 a[4:7], a[216:219], v[152:155], a[4:7]
v_mfma_f32_16x16x32_bf16 a[8:11], a[212:215], v[160:163], a[8:11]
v_accvgpr_read_b32 v52, a192
v_accvgpr_read_b32 v53, a196
v_accvgpr_read_b32 v54, a200
v_accvgpr_read_b32 v55, a204
v_mov_b32 v60, v52
v_mov_b32 v61, v53
v_mov_b32 v62, v54
v_mov_b32 v63, v55
s_nop 0
v_permlane16_swap_b32 v52, v60
v_permlane16_swap_b32 v53, v61
v_permlane16_swap_b32 v54, v62
v_permlane16_swap_b32 v55, v63
v_add_f32 v52, v52, v60
v_add_f32 v53, v53, v61
v_add_f32 v54, v54, v62
v_add_f32 v55, v55, v63
v_mov_b32 v60, v52
v_mov_b32 v61, v53
v_mov_b32 v62, v54
v_mov_b32 v63, v55
s_nop 0
v_permlane32_swap_b32 v52, v60
v_permlane32_swap_b32 v53, v61
v_permlane32_swap_b32 v54, v62
v_permlane32_swap_b32 v55, v63
v_add_f32 v52, v52, v60
v_add_f32 v53, v53, v61
v_add_f32 v54, v54, v62
v_add_f32 v55, v55, v63
v_rcp_f32 v52, v52
v_rcp_f32 v53, v53
v_rcp_f32 v54, v54
v_rcp_f32 v55, v55
v_mfma_f32_16x16x32_bf16 a[8:11], a[216:219], v[168:171], a[8:11]
v_mfma_f32_16x16x32_bf16 a[12:15], a[212:215], v[176:179], a[12:15]
s_lshl_b32 s54, s38, 4
s_lshl_b32 s40, s32, 2
s_add_u32 s54, s54, s40
s_lshl_b32 s54, s54, 17
s_lshl_b32 s40, s37, 12
s_add_u32 s54, s54, s40
s_add_u32 s55, s54, 0x20000
s_add_u32 s56, s55, 0x20000
s_add_u32 s57, s56, 0x20000
v_mfma_f32_16x16x32_bf16 a[12:15], a[216:219], v[184:187], a[12:15]
ds_read_b64_tr_b16 a[212:213], v16 offset:16384
v_mfma_f32_16x16x32_bf16 a[16:19], a[220:223], v[128:131], a[16:19]
ds_read_b64_tr_b16 a[214:215], v16 offset:20480
v_mfma_f32_16x16x32_bf16 a[16:19], a[224:227], v[136:139], a[16:19]
ds_read_b64_tr_b16 a[216:217], v16 offset:24576
v_mfma_f32_16x16x32_bf16 a[20:23], a[220:223], v[144:147], a[20:23]
ds_read_b64_tr_b16 a[218:219], v16 offset:28672
v_mfma_f32_16x16x32_bf16 a[20:23], a[224:227], v[152:155], a[20:23]
v_mfma_f32_16x16x32_bf16 a[24:27], a[220:223], v[160:163], a[24:27]
v_accvgpr_read_b32 v64, a0
v_accvgpr_read_b32 v65, a1
v_mfma_f32_16x16x32_bf16 a[24:27], a[224:227], v[168:171], a[24:27]
v_accvgpr_read_b32 v66, a2
v_accvgpr_read_b32 v67, a3
v_mfma_f32_16x16x32_bf16 a[28:31], a[220:223], v[176:179], a[28:31]
v_accvgpr_read_b32 v68, a16
v_accvgpr_read_b32 v69, a17
v_mfma_f32_16x16x32_bf16 a[28:31], a[224:227], v[184:187], a[28:31]
ds_read_b64_tr_b16 a[220:221], v17 offset:16384
s_waitcnt lgkmcnt(5)
v_mfma_f32_16x16x32_bf16 a[32:35], a[228:231], v[128:131], a[32:35]
ds_read_b64_tr_b16 a[222:223], v17 offset:20480
v_accvgpr_read_b32 v70, a18
v_mfma_f32_16x16x32_bf16 a[32:35], a[232:235], v[136:139], a[32:35]
ds_read_b64_tr_b16 a[224:225], v17 offset:24576
v_accvgpr_read_b32 v71, a19
v_mfma_f32_16x16x32_bf16 a[36:39], a[228:231], v[144:147], a[36:39]
ds_read_b64_tr_b16 a[226:227], v17 offset:28672
v_mul_f32 v64, v64, v52
v_mfma_f32_16x16x32_bf16 a[36:39], a[232:235], v[152:155], a[36:39]
v_mul_f32 v65, v65, v52
v_mul_f32 v66, v66, v52
v_mfma_f32_16x16x32_bf16 a[40:43], a[228:231], v[160:163], a[40:43]
v_mul_f32 v67, v67, v52
v_mul_f32 v68, v68, v52
v_mfma_f32_16x16x32_bf16 a[40:43], a[232:235], v[168:171], a[40:43]
v_mul_f32 v69, v69, v52
v_mul_f32 v70, v70, v52
v_mfma_f32_16x16x32_bf16 a[44:47], a[228:231], v[176:179], a[44:47]
v_mul_f32 v71, v71, v52
v_cvt_pk_bf16_f32 v72, v64, v65
v_mfma_f32_16x16x32_bf16 a[44:47], a[232:235], v[184:187], a[44:47]
ds_read_b64_tr_b16 a[228:229], v18 offset:16384
v_cvt_pk_bf16_f32 v73, v66, v67
v_mfma_f32_16x16x32_bf16 a[48:51], a[236:239], v[128:131], a[48:51]
ds_read_b64_tr_b16 a[230:231], v18 offset:20480
v_cvt_pk_bf16_f32 v74, v68, v69
v_mfma_f32_16x16x32_bf16 a[48:51], a[240:243], v[136:139], a[48:51]
ds_read_b64_tr_b16 a[232:233], v18 offset:24576
v_cvt_pk_bf16_f32 v75, v70, v71
v_mfma_f32_16x16x32_bf16 a[52:55], a[236:239], v[144:147], a[52:55]
ds_read_b64_tr_b16 a[234:235], v18 offset:28672
v_mfma_f32_16x16x32_bf16 a[52:55], a[240:243], v[152:155], a[52:55]
buffer_store_dwordx4 v[72:75], v3, s[28:31], s54 offen offset:0 sc1
v_mfma_f32_16x16x32_bf16 a[56:59], a[236:239], v[160:163], a[56:59]
v_accvgpr_read_b32 v80, a4
v_accvgpr_read_b32 v81, a5
v_mfma_f32_16x16x32_bf16 a[56:59], a[240:243], v[168:171], a[56:59]
v_accvgpr_read_b32 v82, a6
v_accvgpr_read_b32 v83, a7
v_mfma_f32_16x16x32_bf16 a[60:63], a[236:239], v[176:179], a[60:63]
v_accvgpr_read_b32 v84, a20
v_accvgpr_read_b32 v85, a21
v_mfma_f32_16x16x32_bf16 a[60:63], a[240:243], v[184:187], a[60:63]
ds_read_b64_tr_b16 a[236:237], v19 offset:16384
s_waitcnt lgkmcnt(5)
v_mfma_f32_16x16x32_bf16 a[64:67], a[212:215], v[128:131], a[64:67]
ds_read_b64_tr_b16 a[238:239], v19 offset:20480
v_accvgpr_read_b32 v86, a22
v_mfma_f32_16x16x32_bf16 a[64:67], a[216:219], v[136:139], a[64:67]
ds_read_b64_tr_b16 a[240:241], v19 offset:24576
v_accvgpr_read_b32 v87, a23
v_mfma_f32_16x16x32_bf16 a[68:71], a[212:215], v[144:147], a[68:71]
ds_read_b64_tr_b16 a[242:243], v19 offset:28672
v_mul_f32 v80, v80, v53
v_mfma_f32_16x16x32_bf16 a[68:71], a[216:219], v[152:155], a[68:71]
v_mul_f32 v81, v81, v53
v_mul_f32 v82, v82, v53
v_mfma_f32_16x16x32_bf16 a[72:75], a[212:215], v[160:163], a[72:75]
v_mul_f32 v83, v83, v53
v_mul_f32 v84, v84, v53
v_mfma_f32_16x16x32_bf16 a[72:75], a[216:219], v[168:171], a[72:75]
v_mul_f32 v85, v85, v53
v_mul_f32 v86, v86, v53
v_mfma_f32_16x16x32_bf16 a[76:79], a[212:215], v[176:179], a[76:79]
v_mul_f32 v87, v87, v53
v_cvt_pk_bf16_f32 v88, v80, v81
v_mfma_f32_16x16x32_bf16 a[76:79], a[216:219], v[184:187], a[76:79]
v_cvt_pk_bf16_f32 v89, v82, v83
v_cvt_pk_bf16_f32 v90, v84, v85
v_mfma_f32_16x16x32_bf16 a[80:83], a[220:223], v[128:131], a[80:83]
v_cvt_pk_bf16_f32 v91, v86, v87
v_mfma_f32_16x16x32_bf16 a[80:83], a[224:227], v[136:139], a[80:83]
buffer_store_dwordx4 v[88:91], v3, s[28:31], s55 offen offset:0 sc1
v_mfma_f32_16x16x32_bf16 a[84:87], a[220:223], v[144:147], a[84:87]
v_accvgpr_read_b32 v96, a8
v_accvgpr_read_b32 v97, a9
v_mfma_f32_16x16x32_bf16 a[84:87], a[224:227], v[152:155], a[84:87]
v_accvgpr_read_b32 v98, a10
v_accvgpr_read_b32 v99, a11
v_mfma_f32_16x16x32_bf16 a[88:91], a[220:223], v[160:163], a[88:91]
v_accvgpr_read_b32 v100, a24
v_accvgpr_read_b32 v101, a25
v_mfma_f32_16x16x32_bf16 a[88:91], a[224:227], v[168:171], a[88:91]
v_accvgpr_read_b32 v102, a26
v_accvgpr_read_b32 v103, a27
v_mfma_f32_16x16x32_bf16 a[92:95], a[220:223], v[176:179], a[92:95]
v_mul_f32 v96, v96, v54
v_mul_f32 v97, v97, v54
v_mfma_f32_16x16x32_bf16 a[92:95], a[224:227], v[184:187], a[92:95]
v_mul_f32 v98, v98, v54
s_waitcnt lgkmcnt(0)
v_mfma_f32_16x16x32_bf16 a[96:99], a[228:231], v[128:131], a[96:99]
v_mul_f32 v99, v99, v54
v_mul_f32 v100, v100, v54
v_mfma_f32_16x16x32_bf16 a[96:99], a[232:235], v[136:139], a[96:99]
v_mul_f32 v101, v101, v54
v_mul_f32 v102, v102, v54
v_mfma_f32_16x16x32_bf16 a[100:103], a[228:231], v[144:147], a[100:103]
v_mul_f32 v103, v103, v54
v_cvt_pk_bf16_f32 v104, v96, v97
v_mfma_f32_16x16x32_bf16 a[100:103], a[232:235], v[152:155], a[100:103]
v_cvt_pk_bf16_f32 v105, v98, v99
v_cvt_pk_bf16_f32 v106, v100, v101
v_mfma_f32_16x16x32_bf16 a[104:107], a[228:231], v[160:163], a[104:107]
v_cvt_pk_bf16_f32 v107, v102, v103
v_mfma_f32_16x16x32_bf16 a[104:107], a[232:235], v[168:171], a[104:107]
buffer_store_dwordx4 v[104:107], v3, s[28:31], s56 offen offset:0 sc1
v_mfma_f32_16x16x32_bf16 a[108:111], a[228:231], v[176:179], a[108:111]
v_accvgpr_read_b32 v112, a12
v_accvgpr_read_b32 v113, a13
v_mfma_f32_16x16x32_bf16 a[108:111], a[232:235], v[184:187], a[108:111]
v_accvgpr_read_b32 v114, a14
v_accvgpr_read_b32 v115, a15
v_mfma_f32_16x16x32_bf16 a[112:115], a[236:239], v[128:131], a[112:115]
v_accvgpr_read_b32 v116, a28
v_accvgpr_read_b32 v117, a29
v_mfma_f32_16x16x32_bf16 a[112:115], a[240:243], v[136:139], a[112:115]
v_accvgpr_read_b32 v118, a30
v_accvgpr_read_b32 v119, a31
v_mfma_f32_16x16x32_bf16 a[116:119], a[236:239], v[144:147], a[116:119]
v_mul_f32 v112, v112, v55
v_mul_f32 v113, v113, v55
v_mfma_f32_16x16x32_bf16 a[116:119], a[240:243], v[152:155], a[116:119]
v_mul_f32 v114, v114, v55
v_mul_f32 v115, v115, v55
v_mfma_f32_16x16x32_bf16 a[120:123], a[236:239], v[160:163], a[120:123]
v_mul_f32 v116, v116, v55
v_mul_f32 v117, v117, v55
v_mfma_f32_16x16x32_bf16 a[120:123], a[240:243], v[168:171], a[120:123]
v_mul_f32 v118, v118, v55
v_mul_f32 v119, v119, v55
v_mfma_f32_16x16x32_bf16 a[124:127], a[236:239], v[176:179], a[124:127]
v_cvt_pk_bf16_f32 v120, v112, v113
v_cvt_pk_bf16_f32 v121, v114, v115
v_mfma_f32_16x16x32_bf16 a[124:127], a[240:243], v[184:187], a[124:127]
v_cvt_pk_bf16_f32 v122, v116, v117
v_cvt_pk_bf16_f32 v123, v118, v119
buffer_store_dwordx4 v[120:123], v3, s[28:31], s57 offen offset:0 sc1
v_accvgpr_read_b32 v64, a32
v_accvgpr_read_b32 v65, a33
v_accvgpr_read_b32 v66, a34
v_accvgpr_read_b32 v67, a35
v_accvgpr_read_b32 v68, a48
v_accvgpr_read_b32 v69, a49
v_accvgpr_read_b32 v70, a50
v_accvgpr_read_b32 v71, a51
v_mul_f32 v64, v64, v52
v_mul_f32 v65, v65, v52
v_mul_f32 v66, v66, v52
v_mul_f32 v67, v67, v52
v_mul_f32 v68, v68, v52
v_mul_f32 v69, v69, v52
v_mul_f32 v70, v70, v52
v_mul_f32 v71, v71, v52
v_cvt_pk_bf16_f32 v72, v64, v65
v_cvt_pk_bf16_f32 v73, v66, v67
v_cvt_pk_bf16_f32 v74, v68, v69
v_cvt_pk_bf16_f32 v75, v70, v71
buffer_store_dwordx4 v[72:75], v3, s[28:31], s54 offen offset:1024 sc1
v_accvgpr_read_b32 v80, a36
v_accvgpr_read_b32 v81, a37
v_accvgpr_read_b32 v82, a38
v_accvgpr_read_b32 v83, a39
v_accvgpr_read_b32 v84, a52
v_accvgpr_read_b32 v85, a53
v_accvgpr_read_b32 v86, a54
v_accvgpr_read_b32 v87, a55
v_mul_f32 v80, v80, v53
v_mul_f32 v81, v81, v53
v_mul_f32 v82, v82, v53
v_mul_f32 v83, v83, v53
v_mul_f32 v84, v84, v53
v_mul_f32 v85, v85, v53
v_mul_f32 v86, v86, v53
v_mul_f32 v87, v87, v53
v_cvt_pk_bf16_f32 v88, v80, v81
v_cvt_pk_bf16_f32 v89, v82, v83
v_cvt_pk_bf16_f32 v90, v84, v85
v_cvt_pk_bf16_f32 v91, v86, v87
buffer_store_dwordx4 v[88:91], v3, s[28:31], s55 offen offset:1024 sc1
v_accvgpr_read_b32 v96, a40
v_accvgpr_read_b32 v97, a41
v_accvgpr_read_b32 v98, a42
v_accvgpr_read_b32 v99, a43
v_accvgpr_read_b32 v100, a56
v_accvgpr_read_b32 v101, a57
v_accvgpr_read_b32 v102, a58
v_accvgpr_read_b32 v103, a59
v_mul_f32 v96, v96, v54
v_mul_f32 v97, v97, v54
v_mul_f32 v98, v98, v54
v_mul_f32 v99, v99, v54
v_mul_f32 v100, v100, v54
v_mul_f32 v101, v101, v54
v_mul_f32 v102, v102, v54
v_mul_f32 v103, v103, v54
v_cvt_pk_bf16_f32 v104, v96, v97
v_cvt_pk_bf16_f32 v105, v98, v99
v_cvt_pk_bf16_f32 v106, v100, v101
v_cvt_pk_bf16_f32 v107, v102, v103
buffer_store_dwordx4 v[104:107], v3, s[28:31], s56 offen offset:1024 sc1
v_accvgpr_read_b32 v112, a44
v_accvgpr_read_b32 v113, a45
v_accvgpr_read_b32 v114, a46
v_accvgpr_read_b32 v115, a47
v_accvgpr_read_b32 v116, a60
v_accvgpr_read_b32 v117, a61
v_accvgpr_read_b32 v118, a62
v_accvgpr_read_b32 v119, a63
v_mul_f32 v112, v112, v55
v_mul_f32 v113, v113, v55
v_mul_f32 v114, v114, v55
v_mul_f32 v115, v115, v55
v_mul_f32 v116, v116, v55
v_mul_f32 v117, v117, v55
v_mul_f32 v118, v118, v55
v_mul_f32 v119, v119, v55
v_cvt_pk_bf16_f32 v120, v112, v113
v_cvt_pk_bf16_f32 v121, v114, v115
v_cvt_pk_bf16_f32 v122, v116, v117
v_cvt_pk_bf16_f32 v123, v118, v119
buffer_store_dwordx4 v[120:123], v3, s[28:31], s57 offen offset:1024 sc1
v_accvgpr_read_b32 v64, a64
v_accvgpr_read_b32 v65, a65
v_accvgpr_read_b32 v66, a66
v_accvgpr_read_b32 v67, a67
v_accvgpr_read_b32 v68, a80
v_accvgpr_read_b32 v69, a81
v_accvgpr_read_b32 v70, a82
v_accvgpr_read_b32 v71, a83
v_mul_f32 v64, v64, v52
v_mul_f32 v65, v65, v52
v_mul_f32 v66, v66, v52
v_mul_f32 v67, v67, v52
v_mul_f32 v68, v68, v52
v_mul_f32 v69, v69, v52
v_mul_f32 v70, v70, v52
v_mul_f32 v71, v71, v52
v_cvt_pk_bf16_f32 v72, v64, v65
v_cvt_pk_bf16_f32 v73, v66, v67
v_cvt_pk_bf16_f32 v74, v68, v69
v_cvt_pk_bf16_f32 v75, v70, v71
buffer_store_dwordx4 v[72:75], v3, s[28:31], s54 offen offset:2048 sc1
v_accvgpr_read_b32 v80, a68
v_accvgpr_read_b32 v81, a69
v_accvgpr_read_b32 v82, a70
v_accvgpr_read_b32 v83, a71
v_accvgpr_read_b32 v84, a84
v_accvgpr_read_b32 v85, a85
v_accvgpr_read_b32 v86, a86
v_accvgpr_read_b32 v87, a87
v_mul_f32 v80, v80, v53
v_mul_f32 v81, v81, v53
v_mul_f32 v82, v82, v53
v_mul_f32 v83, v83, v53
v_mul_f32 v84, v84, v53
v_mul_f32 v85, v85, v53
v_mul_f32 v86, v86, v53
v_mul_f32 v87, v87, v53
v_cvt_pk_bf16_f32 v88, v80, v81
v_cvt_pk_bf16_f32 v89, v82, v83
v_cvt_pk_bf16_f32 v90, v84, v85
v_cvt_pk_bf16_f32 v91, v86, v87
buffer_store_dwordx4 v[88:91], v3, s[28:31], s55 offen offset:2048 sc1
v_accvgpr_read_b32 v96, a72
v_accvgpr_read_b32 v97, a73
v_accvgpr_read_b32 v98, a74
v_accvgpr_read_b32 v99, a75
v_accvgpr_read_b32 v100, a88
v_accvgpr_read_b32 v101, a89
v_accvgpr_read_b32 v102, a90
v_accvgpr_read_b32 v103, a91
v_mul_f32 v96, v96, v54
v_mul_f32 v97, v97, v54
v_mul_f32 v98, v98, v54
v_mul_f32 v99, v99, v54
v_mul_f32 v100, v100, v54
v_mul_f32 v101, v101, v54
v_mul_f32 v102, v102, v54
v_mul_f32 v103, v103, v54
v_cvt_pk_bf16_f32 v104, v96, v97
v_cvt_pk_bf16_f32 v105, v98, v99
v_cvt_pk_bf16_f32 v106, v100, v101
v_cvt_pk_bf16_f32 v107, v102, v103
buffer_store_dwordx4 v[104:107], v3, s[28:31], s56 offen offset:2048 sc1
v_accvgpr_read_b32 v112, a76
v_accvgpr_read_b32 v113, a77
v_accvgpr_read_b32 v114, a78
v_accvgpr_read_b32 v115, a79
v_accvgpr_read_b32 v116, a92
v_accvgpr_read_b32 v117, a93
v_accvgpr_read_b32 v118, a94
v_accvgpr_read_b32 v119, a95
v_mul_f32 v112, v112, v55
v_mul_f32 v113, v113, v55
v_mul_f32 v114, v114, v55
v_mul_f32 v115, v115, v55
v_mul_f32 v116, v116, v55
v_mul_f32 v117, v117, v55
v_mul_f32 v118, v118, v55
v_mul_f32 v119, v119, v55
v_cvt_pk_bf16_f32 v120, v112, v113
v_cvt_pk_bf16_f32 v121, v114, v115
v_cvt_pk_bf16_f32 v122, v116, v117
v_cvt_pk_bf16_f32 v123, v118, v119
buffer_store_dwordx4 v[120:123], v3, s[28:31], s57 offen offset:2048 sc1
v_accvgpr_read_b32 v64, a96
v_accvgpr_read_b32 v65, a97
v_accvgpr_read_b32 v66, a98
v_accvgpr_read_b32 v67, a99
v_accvgpr_read_b32 v68, a112
v_accvgpr_read_b32 v69, a113
v_accvgpr_read_b32 v70, a114
v_accvgpr_read_b32 v71, a115
v_mul_f32 v64, v64, v52
v_mul_f32 v65, v65, v52
v_mul_f32 v66, v66, v52
v_mul_f32 v67, v67, v52
v_mul_f32 v68, v68, v52
v_mul_f32 v69, v69, v52
v_mul_f32 v70, v70, v52
v_mul_f32 v71, v71, v52
v_cvt_pk_bf16_f32 v72, v64, v65
v_cvt_pk_bf16_f32 v73, v66, v67
v_cvt_pk_bf16_f32 v74, v68, v69
v_cvt_pk_bf16_f32 v75, v70, v71
buffer_store_dwordx4 v[72:75], v3, s[28:31], s54 offen offset:3072 sc1
v_accvgpr_read_b32 v80, a100
v_accvgpr_read_b32 v81, a101
v_accvgpr_read_b32 v82, a102
v_accvgpr_read_b32 v83, a103
v_accvgpr_read_b32 v84, a116
v_accvgpr_read_b32 v85, a117
v_accvgpr_read_b32 v86, a118
v_accvgpr_read_b32 v87, a119
v_mul_f32 v80, v80, v53
v_mul_f32 v81, v81, v53
v_mul_f32 v82, v82, v53
v_mul_f32 v83, v83, v53
v_mul_f32 v84, v84, v53
v_mul_f32 v85, v85, v53
v_mul_f32 v86, v86, v53
v_mul_f32 v87, v87, v53
v_cvt_pk_bf16_f32 v88, v80, v81
v_cvt_pk_bf16_f32 v89, v82, v83
v_cvt_pk_bf16_f32 v90, v84, v85
v_cvt_pk_bf16_f32 v91, v86, v87
buffer_store_dwordx4 v[88:91], v3, s[28:31], s55 offen offset:3072 sc1
v_accvgpr_read_b32 v96, a104
v_accvgpr_read_b32 v97, a105
v_accvgpr_read_b32 v98, a106
v_accvgpr_read_b32 v99, a107
v_accvgpr_read_b32 v100, a120
v_accvgpr_read_b32 v101, a121
v_accvgpr_read_b32 v102, a122
v_accvgpr_read_b32 v103, a123
v_mul_f32 v96, v96, v54
v_mul_f32 v97, v97, v54
v_mul_f32 v98, v98, v54
v_mul_f32 v99, v99, v54
v_mul_f32 v100, v100, v54
v_mul_f32 v101, v101, v54
v_mul_f32 v102, v102, v54
v_mul_f32 v103, v103, v54
v_cvt_pk_bf16_f32 v104, v96, v97
v_cvt_pk_bf16_f32 v105, v98, v99
v_cvt_pk_bf16_f32 v106, v100, v101
v_cvt_pk_bf16_f32 v107, v102, v103
buffer_store_dwordx4 v[104:107], v3, s[28:31], s56 offen offset:3072 sc1
v_accvgpr_read_b32 v112, a108
v_accvgpr_read_b32 v113, a109
v_accvgpr_read_b32 v114, a110
v_accvgpr_read_b32 v115, a111
v_accvgpr_read_b32 v116, a124
v_accvgpr_read_b32 v117, a125
v_accvgpr_read_b32 v118, a126
v_accvgpr_read_b32 v119, a127
v_mul_f32 v112, v112, v55
v_mul_f32 v113, v113, v55
v_mul_f32 v114, v114, v55
v_mul_f32 v115, v115, v55
v_mul_f32 v116, v116, v55
v_mul_f32 v117, v117, v55
v_mul_f32 v118, v118, v55
v_mul_f32 v119, v119, v55
v_cvt_pk_bf16_f32 v120, v112, v113
v_cvt_pk_bf16_f32 v121, v114, v115
v_cvt_pk_bf16_f32 v122, v116, v117
v_cvt_pk_bf16_f32 v123, v118, v119
buffer_store_dwordx4 v[120:123], v3, s[28:31], s57 offen offset:3072 sc1
s_branch L_attn_kernel_afterrare
L_attn_kernel_rare_a_0:
v_mov_b32 v60, v52
s_nop 1
v_permlane16_swap_b32 v52, v60
v_max_f32 v52, v52, v60
v_mov_b32 v60, v52
s_nop 1
v_permlane32_swap_b32 v52, v60
v_max_f32 v52, v52, v60
v_mov_b32 v60, v53
s_nop 1
v_permlane16_swap_b32 v53, v60
v_max_f32 v53, v53, v60
v_mov_b32 v60, v53
s_nop 1
v_permlane32_swap_b32 v53, v60
v_max_f32 v53, v53, v60
v_mov_b32 v60, v54
s_nop 1
v_permlane16_swap_b32 v54, v60
v_max_f32 v54, v54, v60
v_mov_b32 v60, v54
s_nop 1
v_permlane32_swap_b32 v54, v60
v_max_f32 v54, v54, v60
v_mov_b32 v60, v55
s_nop 1
v_permlane16_swap_b32 v55, v60
v_max_f32 v55, v55, v60
v_mov_b32 v60, v55
s_nop 1
v_permlane32_swap_b32 v55, v60
v_max_f32 v55, v55, v60
v_add_f32 v52, s43, v52
v_max_f32 v52, 0, v52
v_mul_f32 v60, -0.5, v52
v_exp_f32 v56, v60
v_sub_f32 v36, v36, v52
v_sub_f32 v37, v37, v52
v_sub_f32 v38, v38, v52
v_sub_f32 v39, v39, v52
v_sub_f32 v128, v128, v52
v_sub_f32 v129, v129, v52
v_sub_f32 v130, v130, v52
v_sub_f32 v131, v131, v52
v_sub_f32 v132, v132, v52
v_sub_f32 v133, v133, v52
v_sub_f32 v134, v134, v52
v_sub_f32 v135, v135, v52
v_sub_f32 v136, v136, v52
v_sub_f32 v137, v137, v52
v_sub_f32 v138, v138, v52
v_sub_f32 v139, v139, v52
v_sub_f32 v140, v140, v52
v_sub_f32 v141, v141, v52
v_sub_f32 v142, v142, v52
v_sub_f32 v143, v143, v52
v_add_f32 v53, s43, v53
v_max_f32 v53, 0, v53
v_mul_f32 v60, -0.5, v53
v_exp_f32 v57, v60
v_sub_f32 v40, v40, v53
v_sub_f32 v41, v41, v53
v_sub_f32 v42, v42, v53
v_sub_f32 v43, v43, v53
v_sub_f32 v144, v144, v53
v_sub_f32 v145, v145, v53
v_sub_f32 v146, v146, v53
v_sub_f32 v147, v147, v53
v_sub_f32 v148, v148, v53
v_sub_f32 v149, v149, v53
v_sub_f32 v150, v150, v53
v_sub_f32 v151, v151, v53
v_sub_f32 v152, v152, v53
v_sub_f32 v153, v153, v53
v_sub_f32 v154, v154, v53
v_sub_f32 v155, v155, v53
v_sub_f32 v156, v156, v53
v_sub_f32 v157, v157, v53
v_sub_f32 v158, v158, v53
v_sub_f32 v159, v159, v53
v_add_f32 v54, s43, v54
v_max_f32 v54, 0, v54
v_mul_f32 v60, -0.5, v54
v_exp_f32 v58, v60
v_sub_f32 v44, v44, v54
v_sub_f32 v45, v45, v54
v_sub_f32 v46, v46, v54
v_sub_f32 v47, v47, v54
v_sub_f32 v160, v160, v54
v_sub_f32 v161, v161, v54
v_sub_f32 v162, v162, v54
v_sub_f32 v163, v163, v54
v_sub_f32 v164, v164, v54
v_sub_f32 v165, v165, v54
v_sub_f32 v166, v166, v54
v_sub_f32 v167, v167, v54
v_sub_f32 v168, v168, v54
v_sub_f32 v169, v169, v54
v_sub_f32 v170, v170, v54
v_sub_f32 v171, v171, v54
v_sub_f32 v172, v172, v54
v_sub_f32 v173, v173, v54
v_sub_f32 v174, v174, v54
v_sub_f32 v175, v175, v54
v_add_f32 v55, s43, v55
v_max_f32 v55, 0, v55
v_mul_f32 v60, -0.5, v55
v_exp_f32 v59, v60
v_sub_f32 v48, v48, v55
v_sub_f32 v49, v49, v55
v_sub_f32 v50, v50, v55
v_sub_f32 v51, v51, v55
v_sub_f32 v176, v176, v55
v_sub_f32 v177, v177, v55
v_sub_f32 v178, v178, v55
v_sub_f32 v179, v179, v55
v_sub_f32 v180, v180, v55
v_sub_f32 v181, v181, v55
v_sub_f32 v182, v182, v55
v_sub_f32 v183, v183, v55
v_sub_f32 v184, v184, v55
v_sub_f32 v185, v185, v55
v_sub_f32 v186, v186, v55
v_sub_f32 v187, v187, v55
v_sub_f32 v188, v188, v55
v_sub_f32 v189, v189, v55
v_sub_f32 v190, v190, v55
v_sub_f32 v191, v191, v55
s_mov_b32 s45, 1
s_nop 1
s_branch L_attn_kernel_back_a_0
L_attn_kernel_rare_a_1:
v_mov_b32 v60, v52
s_nop 1
v_permlane16_swap_b32 v52, v60
v_max_f32 v52, v52, v60
v_mov_b32 v60, v52
s_nop 1
v_permlane32_swap_b32 v52, v60
v_max_f32 v52, v52, v60
v_mov_b32 v60, v53
s_nop 1
v_permlane16_swap_b32 v53, v60
v_max_f32 v53, v53, v60
v_mov_b32 v60, v53
s_nop 1
v_permlane32_swap_b32 v53, v60
v_max_f32 v53, v53, v60
v_mov_b32 v60, v54
s_nop 1
v_permlane16_swap_b32 v54, v60
v_max_f32 v54, v54, v60
v_mov_b32 v60, v54
s_nop 1
v_permlane32_swap_b32 v54, v60
v_max_f32 v54, v54, v60
v_mov_b32 v60, v55
s_nop 1
v_permlane16_swap_b32 v55, v60
v_max_f32 v55, v55, v60
v_mov_b32 v60, v55
s_nop 1
v_permlane32_swap_b32 v55, v60
v_max_f32 v55, v55, v60
v_add_f32 v52, s43, v52
v_max_f32 v52, 0, v52
v_mul_f32 v60, -0.5, v52
v_exp_f32 v56, v60
v_sub_f32 v36, v36, v52
v_sub_f32 v37, v37, v52
v_sub_f32 v38, v38, v52
v_sub_f32 v39, v39, v52
v_sub_f32 v64, v64, v52
v_sub_f32 v65, v65, v52
v_sub_f32 v66, v66, v52
v_sub_f32 v67, v67, v52
v_sub_f32 v68, v68, v52
v_sub_f32 v69, v69, v52
v_sub_f32 v70, v70, v52
v_sub_f32 v71, v71, v52
v_sub_f32 v72, v72, v52
v_sub_f32 v73, v73, v52
v_sub_f32 v74, v74, v52
v_sub_f32 v75, v75, v52
v_sub_f32 v76, v76, v52
v_sub_f32 v77, v77, v52
v_sub_f32 v78, v78, v52
v_sub_f32 v79, v79, v52
v_add_f32 v53, s43, v53
v_max_f32 v53, 0, v53
v_mul_f32 v60, -0.5, v53
v_exp_f32 v57, v60
v_sub_f32 v40, v40, v53
v_sub_f32 v41, v41, v53
v_sub_f32 v42, v42, v53
v_sub_f32 v43, v43, v53
v_sub_f32 v80, v80, v53
v_sub_f32 v81, v81, v53
v_sub_f32 v82, v82, v53
v_sub_f32 v83, v83, v53
v_sub_f32 v84, v84, v53
v_sub_f32 v85, v85, v53
v_sub_f32 v86, v86, v53
v_sub_f32 v87, v87, v53
v_sub_f32 v88, v88, v53
v_sub_f32 v89, v89, v53
v_sub_f32 v90, v90, v53
v_sub_f32 v91, v91, v53
v_sub_f32 v92, v92, v53
v_sub_f32 v93, v93, v53
v_sub_f32 v94, v94, v53
v_sub_f32 v95, v95, v53
v_add_f32 v54, s43, v54
v_max_f32 v54, 0, v54
v_mul_f32 v60, -0.5, v54
v_exp_f32 v58, v60
v_sub_f32 v44, v44, v54
v_sub_f32 v45, v45, v54
v_sub_f32 v46, v46, v54
v_sub_f32 v47, v47, v54
v_sub_f32 v96, v96, v54
v_sub_f32 v97, v97, v54
v_sub_f32 v98, v98, v54
v_sub_f32 v99, v99, v54
v_sub_f32 v100, v100, v54
v_sub_f32 v101, v101, v54
v_sub_f32 v102, v102, v54
v_sub_f32 v103, v103, v54
v_sub_f32 v104, v104, v54
v_sub_f32 v105, v105, v54
v_sub_f32 v106, v106, v54
v_sub_f32 v107, v107, v54
v_sub_f32 v108, v108, v54
v_sub_f32 v109, v109, v54
v_sub_f32 v110, v110, v54
v_sub_f32 v111, v111, v54
v_add_f32 v55, s43, v55
v_max_f32 v55, 0, v55
v_mul_f32 v60, -0.5, v55
v_exp_f32 v59, v60
v_sub_f32 v48, v48, v55
v_sub_f32 v49, v49, v55
v_sub_f32 v50, v50, v55
v_sub_f32 v51, v51, v55
v_sub_f32 v112, v112, v55
v_sub_f32 v113, v113, v55
v_sub_f32 v114, v114, v55
v_sub_f32 v115, v115, v55
v_sub_f32 v116, v116, v55
v_sub_f32 v117, v117, v55
v_sub_f32 v118, v118, v55
v_sub_f32 v119, v119, v55
v_sub_f32 v120, v120, v55
v_sub_f32 v121, v121, v55
v_sub_f32 v122, v122, v55
v_sub_f32 v123, v123, v55
v_sub_f32 v124, v124, v55
v_sub_f32 v125, v125, v55
v_sub_f32 v126, v126, v55
v_sub_f32 v127, v127, v55
s_mov_b32 s45, 1
s_nop 1
s_branch L_attn_kernel_back_a_1
L_attn_kernel_rare_a_2:
v_mov_b32 v60, v52
s_nop 1
v_permlane16_swap_b32 v52, v60
v_max_f32 v52, v52, v60
v_mov_b32 v60, v52
s_nop 1
v_permlane32_swap_b32 v52, v60
v_max_f32 v52, v52, v60
v_mov_b32 v60, v53
s_nop 1
v_permlane16_swap_b32 v53, v60
v_max_f32 v53, v53, v60
v_mov_b32 v60, v53
s_nop 1
v_permlane32_swap_b32 v53, v60
v_max_f32 v53, v53, v60
v_mov_b32 v60, v54
s_nop 1
v_permlane16_swap_b32 v54, v60
v_max_f32 v54, v54, v60
v_mov_b32 v60, v54
s_nop 1
v_permlane32_swap_b32 v54, v60
v_max_f32 v54, v54, v60
v_mov_b32 v60, v55
s_nop 1
v_permlane16_swap_b32 v55, v60
v_max_f32 v55, v55, v60
v_mov_b32 v60, v55
s_nop 1
v_permlane32_swap_b32 v55, v60
v_max_f32 v55, v55, v60
v_add_f32 v52, s43, v52
v_max_f32 v52, 0, v52
v_mul_f32 v60, -0.5, v52
v_exp_f32 v56, v60
v_sub_f32 v36, v36, v52
v_sub_f32 v37, v37, v52
v_sub_f32 v38, v38, v52
v_sub_f32 v39, v39, v52
v_sub_f32 v128, v128, v52
v_sub_f32 v129, v129, v52
v_sub_f32 v130, v130, v52
v_sub_f32 v131, v131, v52
v_sub_f32 v132, v132, v52
v_sub_f32 v133, v133, v52
v_sub_f32 v134, v134, v52
v_sub_f32 v135, v135, v52
v_sub_f32 v136, v136, v52
v_sub_f32 v137, v137, v52
v_sub_f32 v138, v138, v52
v_sub_f32 v139, v139, v52
v_sub_f32 v140, v140, v52
v_sub_f32 v141, v141, v52
v_sub_f32 v142, v142, v52
v_sub_f32 v143, v143, v52
v_add_f32 v53, s43, v53
v_max_f32 v53, 0, v53
v_mul_f32 v60, -0.5, v53
v_exp_f32 v57, v60
v_sub_f32 v40, v40, v53
v_sub_f32 v41, v41, v53
v_sub_f32 v42, v42, v53
v_sub_f32 v43, v43, v53
v_sub_f32 v144, v144, v53
v_sub_f32 v145, v145, v53
v_sub_f32 v146, v146, v53
v_sub_f32 v147, v147, v53
v_sub_f32 v148, v148, v53
v_sub_f32 v149, v149, v53
v_sub_f32 v150, v150, v53
v_sub_f32 v151, v151, v53
v_sub_f32 v152, v152, v53
v_sub_f32 v153, v153, v53
v_sub_f32 v154, v154, v53
v_sub_f32 v155, v155, v53
v_sub_f32 v156, v156, v53
v_sub_f32 v157, v157, v53
v_sub_f32 v158, v158, v53
v_sub_f32 v159, v159, v53
v_add_f32 v54, s43, v54
v_max_f32 v54, 0, v54
v_mul_f32 v60, -0.5, v54
v_exp_f32 v58, v60
v_sub_f32 v44, v44, v54
v_sub_f32 v45, v45, v54
v_sub_f32 v46, v46, v54
v_sub_f32 v47, v47, v54
v_sub_f32 v160, v160, v54
v_sub_f32 v161, v161, v54
v_sub_f32 v162, v162, v54
v_sub_f32 v163, v163, v54
v_sub_f32 v164, v164, v54
v_sub_f32 v165, v165, v54
v_sub_f32 v166, v166, v54
v_sub_f32 v167, v167, v54
v_sub_f32 v168, v168, v54
v_sub_f32 v169, v169, v54
v_sub_f32 v170, v170, v54
v_sub_f32 v171, v171, v54
v_sub_f32 v172, v172, v54
v_sub_f32 v173, v173, v54
v_sub_f32 v174, v174, v54
v_sub_f32 v175, v175, v54
v_add_f32 v55, s43, v55
v_max_f32 v55, 0, v55
v_mul_f32 v60, -0.5, v55
v_exp_f32 v59, v60
v_sub_f32 v48, v48, v55
v_sub_f32 v49, v49, v55
v_sub_f32 v50, v50, v55
v_sub_f32 v51, v51, v55
v_sub_f32 v176, v176, v55
v_sub_f32 v177, v177, v55
v_sub_f32 v178, v178, v55
v_sub_f32 v179, v179, v55
v_sub_f32 v180, v180, v55
v_sub_f32 v181, v181, v55
v_sub_f32 v182, v182, v55
v_sub_f32 v183, v183, v55
v_sub_f32 v184, v184, v55
v_sub_f32 v185, v185, v55
v_sub_f32 v186, v186, v55
v_sub_f32 v187, v187, v55
v_sub_f32 v188, v188, v55
v_sub_f32 v189, v189, v55
v_sub_f32 v190, v190, v55
v_sub_f32 v191, v191, v55
s_mov_b32 s45, 1
s_nop 1
s_branch L_attn_kernel_back_a_2
L_attn_kernel_rare_a_3:
v_mov_b32 v60, v52
s_nop 1
v_permlane16_swap_b32 v52, v60
v_max_f32 v52, v52, v60
v_mov_b32 v60, v52
s_nop 1
v_permlane32_swap_b32 v52, v60
v_max_f32 v52, v52, v60
v_mov_b32 v60, v53
s_nop 1
v_permlane16_swap_b32 v53, v60
v_max_f32 v53, v53, v60
v_mov_b32 v60, v53
s_nop 1
v_permlane32_swap_b32 v53, v60
v_max_f32 v53, v53, v60
v_mov_b32 v60, v54
s_nop 1
v_permlane16_swap_b32 v54, v60
v_max_f32 v54, v54, v60
v_mov_b32 v60, v54
s_nop 1
v_permlane32_swap_b32 v54, v60
v_max_f32 v54, v54, v60
v_mov_b32 v60, v55
s_nop 1
v_permlane16_swap_b32 v55, v60
v_max_f32 v55, v55, v60
v_mov_b32 v60, v55
s_nop 1
v_permlane32_swap_b32 v55, v60
v_max_f32 v55, v55, v60
v_add_f32 v52, s43, v52
v_max_f32 v52, 0, v52
v_mul_f32 v60, -0.5, v52
v_exp_f32 v56, v60
v_sub_f32 v36, v36, v52
v_sub_f32 v37, v37, v52
v_sub_f32 v38, v38, v52
v_sub_f32 v39, v39, v52
v_sub_f32 v64, v64, v52
v_sub_f32 v65, v65, v52
v_sub_f32 v66, v66, v52
v_sub_f32 v67, v67, v52
v_sub_f32 v68, v68, v52
v_sub_f32 v69, v69, v52
v_sub_f32 v70, v70, v52
v_sub_f32 v71, v71, v52
v_sub_f32 v72, v72, v52
v_sub_f32 v73, v73, v52
v_sub_f32 v74, v74, v52
v_sub_f32 v75, v75, v52
v_sub_f32 v76, v76, v52
v_sub_f32 v77, v77, v52
v_sub_f32 v78, v78, v52
v_sub_f32 v79, v79, v52
v_add_f32 v53, s43, v53
v_max_f32 v53, 0, v53
v_mul_f32 v60, -0.5, v53
v_exp_f32 v57, v60
v_sub_f32 v40, v40, v53
v_sub_f32 v41, v41, v53
v_sub_f32 v42, v42, v53
v_sub_f32 v43, v43, v53
v_sub_f32 v80, v80, v53
v_sub_f32 v81, v81, v53
v_sub_f32 v82, v82, v53
v_sub_f32 v83, v83, v53
v_sub_f32 v84, v84, v53
v_sub_f32 v85, v85, v53
v_sub_f32 v86, v86, v53
v_sub_f32 v87, v87, v53
v_sub_f32 v88, v88, v53
v_sub_f32 v89, v89, v53
v_sub_f32 v90, v90, v53
v_sub_f32 v91, v91, v53
v_sub_f32 v92, v92, v53
v_sub_f32 v93, v93, v53
v_sub_f32 v94, v94, v53
v_sub_f32 v95, v95, v53
v_add_f32 v54, s43, v54
v_max_f32 v54, 0, v54
v_mul_f32 v60, -0.5, v54
v_exp_f32 v58, v60
v_sub_f32 v44, v44, v54
v_sub_f32 v45, v45, v54
v_sub_f32 v46, v46, v54
v_sub_f32 v47, v47, v54
v_sub_f32 v96, v96, v54
v_sub_f32 v97, v97, v54
v_sub_f32 v98, v98, v54
v_sub_f32 v99, v99, v54
v_sub_f32 v100, v100, v54
v_sub_f32 v101, v101, v54
v_sub_f32 v102, v102, v54
v_sub_f32 v103, v103, v54
v_sub_f32 v104, v104, v54
v_sub_f32 v105, v105, v54
v_sub_f32 v106, v106, v54
v_sub_f32 v107, v107, v54
v_sub_f32 v108, v108, v54
v_sub_f32 v109, v109, v54
v_sub_f32 v110, v110, v54
v_sub_f32 v111, v111, v54
v_add_f32 v55, s43, v55
v_max_f32 v55, 0, v55
v_mul_f32 v60, -0.5, v55
v_exp_f32 v59, v60
v_sub_f32 v48, v48, v55
v_sub_f32 v49, v49, v55
v_sub_f32 v50, v50, v55
v_sub_f32 v51, v51, v55
v_sub_f32 v112, v112, v55
v_sub_f32 v113, v113, v55
v_sub_f32 v114, v114, v55
v_sub_f32 v115, v115, v55
v_sub_f32 v116, v116, v55
v_sub_f32 v117, v117, v55
v_sub_f32 v118, v118, v55
v_sub_f32 v119, v119, v55
v_sub_f32 v120, v120, v55
v_sub_f32 v121, v121, v55
v_sub_f32 v122, v122, v55
v_sub_f32 v123, v123, v55
v_sub_f32 v124, v124, v55
v_sub_f32 v125, v125, v55
v_sub_f32 v126, v126, v55
v_sub_f32 v127, v127, v55
s_mov_b32 s45, 1
s_nop 1
s_branch L_attn_kernel_back_a_3
L_attn_kernel_rare_c_0:
v_mov_b32 v60, v52
s_nop 1
v_permlane16_swap_b32 v52, v60
v_max_f32 v52, v52, v60
v_mov_b32 v60, v52
s_nop 1
v_permlane32_swap_b32 v52, v60
v_max_f32 v52, v52, v60
v_mov_b32 v60, v53
s_nop 1
v_permlane16_swap_b32 v53, v60
v_max_f32 v53, v53, v60
v_mov_b32 v60, v53
s_nop 1
v_permlane32_swap_b32 v53, v60
v_max_f32 v53, v53, v60
v_mov_b32 v60, v54
s_nop 1
v_permlane16_swap_b32 v54, v60
v_max_f32 v54, v54, v60
v_mov_b32 v60, v54
s_nop 1
v_permlane32_swap_b32 v54, v60
v_max_f32 v54, v54, v60
v_mov_b32 v60, v55
s_nop 1
v_permlane16_swap_b32 v55, v60
v_max_f32 v55, v55, v60
v_mov_b32 v60, v55
s_nop 1
v_permlane32_swap_b32 v55, v60
v_max_f32 v55, v55, v60
v_add_f32 v52, s43, v52
v_max_f32 v52, 0, v52
v_mul_f32 v60, -0.5, v52
v_exp_f32 v56, v60
v_sub_f32 v36, v36, v52
v_sub_f32 v37, v37, v52
v_sub_f32 v38, v38, v52
v_sub_f32 v39, v39, v52
v_sub_f32 v128, v128, v52
v_sub_f32 v129, v129, v52
v_sub_f32 v130, v130, v52
v_sub_f32 v131, v131, v52
v_sub_f32 v132, v132, v52
v_sub_f32 v133, v133, v52
v_sub_f32 v134, v134, v52
v_sub_f32 v135, v135, v52
v_sub_f32 v136, v136, v52
v_sub_f32 v137, v137, v52
v_sub_f32 v138, v138, v52
v_sub_f32 v139, v139, v52
v_sub_f32 v140, v140, v52
v_sub_f32 v141, v141, v52
v_sub_f32 v142, v142, v52
v_sub_f32 v143, v143, v52
v_add_f32 v53, s43, v53
v_max_f32 v53, 0, v53
v_mul_f32 v60, -0.5, v53
v_exp_f32 v57, v60
v_sub_f32 v40, v40, v53
v_sub_f32 v41, v41, v53
v_sub_f32 v42, v42, v53
v_sub_f32 v43, v43, v53
v_sub_f32 v144, v144, v53
v_sub_f32 v145, v145, v53
v_sub_f32 v146, v146, v53
v_sub_f32 v147, v147, v53
v_sub_f32 v148, v148, v53
v_sub_f32 v149, v149, v53
v_sub_f32 v150, v150, v53
v_sub_f32 v151, v151, v53
v_sub_f32 v152, v152, v53
v_sub_f32 v153, v153, v53
v_sub_f32 v154, v154, v53
v_sub_f32 v155, v155, v53
v_sub_f32 v156, v156, v53
v_sub_f32 v157, v157, v53
v_sub_f32 v158, v158, v53
v_sub_f32 v159, v159, v53
v_add_f32 v54, s43, v54
v_max_f32 v54, 0, v54
v_mul_f32 v60, -0.5, v54
v_exp_f32 v58, v60
v_sub_f32 v44, v44, v54
v_sub_f32 v45, v45, v54
v_sub_f32 v46, v46, v54
v_sub_f32 v47, v47, v54
v_sub_f32 v160, v160, v54
v_sub_f32 v161, v161, v54
v_sub_f32 v162, v162, v54
v_sub_f32 v163, v163, v54
v_sub_f32 v164, v164, v54
v_sub_f32 v165, v165, v54
v_sub_f32 v166, v166, v54
v_sub_f32 v167, v167, v54
v_sub_f32 v168, v168, v54
v_sub_f32 v169, v169, v54
v_sub_f32 v170, v170, v54
v_sub_f32 v171, v171, v54
v_sub_f32 v172, v172, v54
v_sub_f32 v173, v173, v54
v_sub_f32 v174, v174, v54
v_sub_f32 v175, v175, v54
v_add_f32 v55, s43, v55
v_max_f32 v55, 0, v55
v_mul_f32 v60, -0.5, v55
v_exp_f32 v59, v60
v_sub_f32 v48, v48, v55
v_sub_f32 v49, v49, v55
v_sub_f32 v50, v50, v55
v_sub_f32 v51, v51, v55
v_sub_f32 v176, v176, v55
v_sub_f32 v177, v177, v55
v_sub_f32 v178, v178, v55
v_sub_f32 v179, v179, v55
v_sub_f32 v180, v180, v55
v_sub_f32 v181, v181, v55
v_sub_f32 v182, v182, v55
v_sub_f32 v183, v183, v55
v_sub_f32 v184, v184, v55
v_sub_f32 v185, v185, v55
v_sub_f32 v186, v186, v55
v_sub_f32 v187, v187, v55
v_sub_f32 v188, v188, v55
v_sub_f32 v189, v189, v55
v_sub_f32 v190, v190, v55
v_sub_f32 v191, v191, v55
s_mov_b32 s45, 1
s_nop 1
s_branch L_attn_kernel_back_c_0
L_attn_kernel_rare_c_1:
v_mov_b32 v60, v52
s_nop 1
v_permlane16_swap_b32 v52, v60
v_max_f32 v52, v52, v60
v_mov_b32 v60, v52
s_nop 1
v_permlane32_swap_b32 v52, v60
v_max_f32 v52, v52, v60
v_mov_b32 v60, v53
s_nop 1
v_permlane16_swap_b32 v53, v60
v_max_f32 v53, v53, v60
v_mov_b32 v60, v53
s_nop 1
v_permlane32_swap_b32 v53, v60
v_max_f32 v53, v53, v60
v_mov_b32 v60, v54
s_nop 1
v_permlane16_swap_b32 v54, v60
v_max_f32 v54, v54, v60
v_mov_b32 v60, v54
s_nop 1
v_permlane32_swap_b32 v54, v60
v_max_f32 v54, v54, v60
v_mov_b32 v60, v55
s_nop 1
v_permlane16_swap_b32 v55, v60
v_max_f32 v55, v55, v60
v_mov_b32 v60, v55
s_nop 1
v_permlane32_swap_b32 v55, v60
v_max_f32 v55, v55, v60
v_add_f32 v52, s43, v52
v_max_f32 v52, 0, v52
v_mul_f32 v60, -0.5, v52
v_exp_f32 v56, v60
v_sub_f32 v36, v36, v52
v_sub_f32 v37, v37, v52
v_sub_f32 v38, v38, v52
v_sub_f32 v39, v39, v52
v_sub_f32 v64, v64, v52
v_sub_f32 v65, v65, v52
v_sub_f32 v66, v66, v52
v_sub_f32 v67, v67, v52
v_sub_f32 v68, v68, v52
v_sub_f32 v69, v69, v52
v_sub_f32 v70, v70, v52
v_sub_f32 v71, v71, v52
v_sub_f32 v72, v72, v52
v_sub_f32 v73, v73, v52
v_sub_f32 v74, v74, v52
v_sub_f32 v75, v75, v52
v_sub_f32 v76, v76, v52
v_sub_f32 v77, v77, v52
v_sub_f32 v78, v78, v52
v_sub_f32 v79, v79, v52
v_add_f32 v53, s43, v53
v_max_f32 v53, 0, v53
v_mul_f32 v60, -0.5, v53
v_exp_f32 v57, v60
v_sub_f32 v40, v40, v53
v_sub_f32 v41, v41, v53
v_sub_f32 v42, v42, v53
v_sub_f32 v43, v43, v53
v_sub_f32 v80, v80, v53
v_sub_f32 v81, v81, v53
v_sub_f32 v82, v82, v53
v_sub_f32 v83, v83, v53
v_sub_f32 v84, v84, v53
v_sub_f32 v85, v85, v53
v_sub_f32 v86, v86, v53
v_sub_f32 v87, v87, v53
v_sub_f32 v88, v88, v53
v_sub_f32 v89, v89, v53
v_sub_f32 v90, v90, v53
v_sub_f32 v91, v91, v53
v_sub_f32 v92, v92, v53
v_sub_f32 v93, v93, v53
v_sub_f32 v94, v94, v53
v_sub_f32 v95, v95, v53
v_add_f32 v54, s43, v54
v_max_f32 v54, 0, v54
v_mul_f32 v60, -0.5, v54
v_exp_f32 v58, v60
v_sub_f32 v44, v44, v54
v_sub_f32 v45, v45, v54
v_sub_f32 v46, v46, v54
v_sub_f32 v47, v47, v54
v_sub_f32 v96, v96, v54
v_sub_f32 v97, v97, v54
v_sub_f32 v98, v98, v54
v_sub_f32 v99, v99, v54
v_sub_f32 v100, v100, v54
v_sub_f32 v101, v101, v54
v_sub_f32 v102, v102, v54
v_sub_f32 v103, v103, v54
v_sub_f32 v104, v104, v54
v_sub_f32 v105, v105, v54
v_sub_f32 v106, v106, v54
v_sub_f32 v107, v107, v54
v_sub_f32 v108, v108, v54
v_sub_f32 v109, v109, v54
v_sub_f32 v110, v110, v54
v_sub_f32 v111, v111, v54
v_add_f32 v55, s43, v55
v_max_f32 v55, 0, v55
v_mul_f32 v60, -0.5, v55
v_exp_f32 v59, v60
v_sub_f32 v48, v48, v55
v_sub_f32 v49, v49, v55
v_sub_f32 v50, v50, v55
v_sub_f32 v51, v51, v55
v_sub_f32 v112, v112, v55
v_sub_f32 v113, v113, v55
v_sub_f32 v114, v114, v55
v_sub_f32 v115, v115, v55
v_sub_f32 v116, v116, v55
v_sub_f32 v117, v117, v55
v_sub_f32 v118, v118, v55
v_sub_f32 v119, v119, v55
v_sub_f32 v120, v120, v55
v_sub_f32 v121, v121, v55
v_sub_f32 v122, v122, v55
v_sub_f32 v123, v123, v55
v_sub_f32 v124, v124, v55
v_sub_f32 v125, v125, v55
v_sub_f32 v126, v126, v55
v_sub_f32 v127, v127, v55
s_mov_b32 s45, 1
s_nop 1
s_branch L_attn_kernel_back_c_1
L_attn_kernel_rare_c_2:
v_mov_b32 v60, v52
s_nop 1
v_permlane16_swap_b32 v52, v60
v_max_f32 v52, v52, v60
v_mov_b32 v60, v52
s_nop 1
v_permlane32_swap_b32 v52, v60
v_max_f32 v52, v52, v60
v_mov_b32 v60, v53
s_nop 1
v_permlane16_swap_b32 v53, v60
v_max_f32 v53, v53, v60
v_mov_b32 v60, v53
s_nop 1
v_permlane32_swap_b32 v53, v60
v_max_f32 v53, v53, v60
v_mov_b32 v60, v54
s_nop 1
v_permlane16_swap_b32 v54, v60
v_max_f32 v54, v54, v60
v_mov_b32 v60, v54
s_nop 1
v_permlane32_swap_b32 v54, v60
v_max_f32 v54, v54, v60
v_mov_b32 v60, v55
s_nop 1
v_permlane16_swap_b32 v55, v60
v_max_f32 v55, v55, v60
v_mov_b32 v60, v55
s_nop 1
v_permlane32_swap_b32 v55, v60
v_max_f32 v55, v55, v60
v_add_f32 v52, s43, v52
v_max_f32 v52, 0, v52
v_mul_f32 v60, -0.5, v52
v_exp_f32 v56, v60
v_sub_f32 v36, v36, v52
v_sub_f32 v37, v37, v52
v_sub_f32 v38, v38, v52
v_sub_f32 v39, v39, v52
v_sub_f32 v128, v128, v52
v_sub_f32 v129, v129, v52
v_sub_f32 v130, v130, v52
v_sub_f32 v131, v131, v52
v_sub_f32 v132, v132, v52
v_sub_f32 v133, v133, v52
v_sub_f32 v134, v134, v52
v_sub_f32 v135, v135, v52
v_sub_f32 v136, v136, v52
v_sub_f32 v137, v137, v52
v_sub_f32 v138, v138, v52
v_sub_f32 v139, v139, v52
v_sub_f32 v140, v140, v52
v_sub_f32 v141, v141, v52
v_sub_f32 v142, v142, v52
v_sub_f32 v143, v143, v52
v_add_f32 v53, s43, v53
v_max_f32 v53, 0, v53
v_mul_f32 v60, -0.5, v53
v_exp_f32 v57, v60
v_sub_f32 v40, v40, v53
v_sub_f32 v41, v41, v53
v_sub_f32 v42, v42, v53
v_sub_f32 v43, v43, v53
v_sub_f32 v144, v144, v53
v_sub_f32 v145, v145, v53
v_sub_f32 v146, v146, v53
v_sub_f32 v147, v147, v53
v_sub_f32 v148, v148, v53
v_sub_f32 v149, v149, v53
v_sub_f32 v150, v150, v53
v_sub_f32 v151, v151, v53
v_sub_f32 v152, v152, v53
v_sub_f32 v153, v153, v53
v_sub_f32 v154, v154, v53
v_sub_f32 v155, v155, v53
v_sub_f32 v156, v156, v53
v_sub_f32 v157, v157, v53
v_sub_f32 v158, v158, v53
v_sub_f32 v159, v159, v53
v_add_f32 v54, s43, v54
v_max_f32 v54, 0, v54
v_mul_f32 v60, -0.5, v54
v_exp_f32 v58, v60
v_sub_f32 v44, v44, v54
v_sub_f32 v45, v45, v54
v_sub_f32 v46, v46, v54
v_sub_f32 v47, v47, v54
v_sub_f32 v160, v160, v54
v_sub_f32 v161, v161, v54
v_sub_f32 v162, v162, v54
v_sub_f32 v163, v163, v54
v_sub_f32 v164, v164, v54
v_sub_f32 v165, v165, v54
v_sub_f32 v166, v166, v54
v_sub_f32 v167, v167, v54
v_sub_f32 v168, v168, v54
v_sub_f32 v169, v169, v54
v_sub_f32 v170, v170, v54
v_sub_f32 v171, v171, v54
v_sub_f32 v172, v172, v54
v_sub_f32 v173, v173, v54
v_sub_f32 v174, v174, v54
v_sub_f32 v175, v175, v54
v_add_f32 v55, s43, v55
v_max_f32 v55, 0, v55
v_mul_f32 v60, -0.5, v55
v_exp_f32 v59, v60
v_sub_f32 v48, v48, v55
v_sub_f32 v49, v49, v55
v_sub_f32 v50, v50, v55
v_sub_f32 v51, v51, v55
v_sub_f32 v176, v176, v55
v_sub_f32 v177, v177, v55
v_sub_f32 v178, v178, v55
v_sub_f32 v179, v179, v55
v_sub_f32 v180, v180, v55
v_sub_f32 v181, v181, v55
v_sub_f32 v182, v182, v55
v_sub_f32 v183, v183, v55
v_sub_f32 v184, v184, v55
v_sub_f32 v185, v185, v55
v_sub_f32 v186, v186, v55
v_sub_f32 v187, v187, v55
v_sub_f32 v188, v188, v55
v_sub_f32 v189, v189, v55
v_sub_f32 v190, v190, v55
v_sub_f32 v191, v191, v55
s_mov_b32 s45, 1
s_nop 1
s_branch L_attn_kernel_back_c_2
L_attn_kernel_resc_a_0:
s_nop 7
s_nop 7
v_accvgpr_read_b32 v60, a0
v_accvgpr_read_b32 v61, a1
v_accvgpr_read_b32 v62, a2
v_accvgpr_read_b32 v63, a3
v_mul_f32 v60, v60, v56
v_mul_f32 v61, v61, v56
v_mul_f32 v62, v62, v56
v_mul_f32 v63, v63, v56
v_mul_f32 v60, v60, v56
v_mul_f32 v61, v61, v56
v_mul_f32 v62, v62, v56
v_mul_f32 v63, v63, v56
v_accvgpr_write_b32 a0, v60
v_accvgpr_write_b32 a1, v61
v_accvgpr_write_b32 a2, v62
v_accvgpr_write_b32 a3, v63
v_accvgpr_read_b32 v60, a16
v_accvgpr_read_b32 v61, a17
v_accvgpr_read_b32 v62, a18
v_accvgpr_read_b32 v63, a19
v_mul_f32 v60, v60, v56
v_mul_f32 v61, v61, v56
v_mul_f32 v62, v62, v56
v_mul_f32 v63, v63, v56
v_mul_f32 v60, v60, v56
v_mul_f32 v61, v61, v56
v_mul_f32 v62, v62, v56
v_mul_f32 v63, v63, v56
v_accvgpr_write_b32 a16, v60
v_accvgpr_write_b32 a17, v61
v_accvgpr_write_b32 a18, v62
v_accvgpr_write_b32 a19, v63
v_accvgpr_read_b32 v60, a32
v_accvgpr_read_b32 v61, a33
v_accvgpr_read_b32 v62, a34
v_accvgpr_read_b32 v63, a35
v_mul_f32 v60, v60, v56
v_mul_f32 v61, v61, v56
v_mul_f32 v62, v62, v56
v_mul_f32 v63, v63, v56
v_mul_f32 v60, v60, v56
v_mul_f32 v61, v61, v56
v_mul_f32 v62, v62, v56
v_mul_f32 v63, v63, v56
v_accvgpr_write_b32 a32, v60
v_accvgpr_write_b32 a33, v61
v_accvgpr_write_b32 a34, v62
v_accvgpr_write_b32 a35, v63
v_accvgpr_read_b32 v60, a48
v_accvgpr_read_b32 v61, a49
v_accvgpr_read_b32 v62, a50
v_accvgpr_read_b32 v63, a51
v_mul_f32 v60, v60, v56
v_mul_f32 v61, v61, v56
v_mul_f32 v62, v62, v56
v_mul_f32 v63, v63, v56
v_mul_f32 v60, v60, v56
v_mul_f32 v61, v61, v56
v_mul_f32 v62, v62, v56
v_mul_f32 v63, v63, v56
v_accvgpr_write_b32 a48, v60
v_accvgpr_write_b32 a49, v61
v_accvgpr_write_b32 a50, v62
v_accvgpr_write_b32 a51, v63
v_accvgpr_read_b32 v60, a64
v_accvgpr_read_b32 v61, a65
v_accvgpr_read_b32 v62, a66
v_accvgpr_read_b32 v63, a67
v_mul_f32 v60, v60, v56
v_mul_f32 v61, v61, v56
v_mul_f32 v62, v62, v56
v_mul_f32 v63, v63, v56
v_mul_f32 v60, v60, v56
v_mul_f32 v61, v61, v56
v_mul_f32 v62, v62, v56
v_mul_f32 v63, v63, v56
v_accvgpr_write_b32 a64, v60
v_accvgpr_write_b32 a65, v61
v_accvgpr_write_b32 a66, v62
v_accvgpr_write_b32 a67, v63
v_accvgpr_read_b32 v60, a80
v_accvgpr_read_b32 v61, a81
v_accvgpr_read_b32 v62, a82
v_accvgpr_read_b32 v63, a83
v_mul_f32 v60, v60, v56
v_mul_f32 v61, v61, v56
v_mul_f32 v62, v62, v56
v_mul_f32 v63, v63, v56
v_mul_f32 v60, v60, v56
v_mul_f32 v61, v61, v56
v_mul_f32 v62, v62, v56
v_mul_f32 v63, v63, v56
v_accvgpr_write_b32 a80, v60
v_accvgpr_write_b32 a81, v61
v_accvgpr_write_b32 a82, v62
v_accvgpr_write_b32 a83, v63
v_accvgpr_read_b32 v60, a96
v_accvgpr_read_b32 v61, a97
v_accvgpr_read_b32 v62, a98
v_accvgpr_read_b32 v63, a99
v_mul_f32 v60, v60, v56
v_mul_f32 v61, v61, v56
v_mul_f32 v62, v62, v56
v_mul_f32 v63, v63, v56
v_mul_f32 v60, v60, v56
v_mul_f32 v61, v61, v56
v_mul_f32 v62, v62, v56
v_mul_f32 v63, v63, v56
v_accvgpr_write_b32 a96, v60
v_accvgpr_write_b32 a97, v61
v_accvgpr_write_b32 a98, v62
v_accvgpr_write_b32 a99, v63
v_accvgpr_read_b32 v60, a112
v_accvgpr_read_b32 v61, a113
v_accvgpr_read_b32 v62, a114
v_accvgpr_read_b32 v63, a115
v_mul_f32 v60, v60, v56
v_mul_f32 v61, v61, v56
v_mul_f32 v62, v62, v56
v_mul_f32 v63, v63, v56
v_mul_f32 v60, v60, v56
v_mul_f32 v61, v61, v56
v_mul_f32 v62, v62, v56
v_mul_f32 v63, v63, v56
v_accvgpr_write_b32 a112, v60
v_accvgpr_write_b32 a113, v61
v_accvgpr_write_b32 a114, v62
v_accvgpr_write_b32 a115, v63
v_accvgpr_read_b32 v60, a192
v_accvgpr_read_b32 v61, a193
v_accvgpr_read_b32 v62, a194
v_accvgpr_read_b32 v63, a195
v_mul_f32 v60, v60, v56
v_mul_f32 v61, v61, v56
v_mul_f32 v62, v62, v56
v_mul_f32 v63, v63, v56
v_mul_f32 v60, v60, v56
v_mul_f32 v61, v61, v56
v_mul_f32 v62, v62, v56
v_mul_f32 v63, v63, v56
v_accvgpr_write_b32 a192, v60
v_accvgpr_write_b32 a193, v61
v_accvgpr_write_b32 a194, v62
v_accvgpr_write_b32 a195, v63
v_accvgpr_read_b32 v60, a4
v_accvgpr_read_b32 v61, a5
v_accvgpr_read_b32 v62, a6
v_accvgpr_read_b32 v63, a7
v_mul_f32 v60, v60, v57
v_mul_f32 v61, v61, v57
v_mul_f32 v62, v62, v57
v_mul_f32 v63, v63, v57
v_mul_f32 v60, v60, v57
v_mul_f32 v61, v61, v57
v_mul_f32 v62, v62, v57
v_mul_f32 v63, v63, v57
v_accvgpr_write_b32 a4, v60
v_accvgpr_write_b32 a5, v61
v_accvgpr_write_b32 a6, v62
v_accvgpr_write_b32 a7, v63
v_accvgpr_read_b32 v60, a20
v_accvgpr_read_b32 v61, a21
v_accvgpr_read_b32 v62, a22
v_accvgpr_read_b32 v63, a23
v_mul_f32 v60, v60, v57
v_mul_f32 v61, v61, v57
v_mul_f32 v62, v62, v57
v_mul_f32 v63, v63, v57
v_mul_f32 v60, v60, v57
v_mul_f32 v61, v61, v57
v_mul_f32 v62, v62, v57
v_mul_f32 v63, v63, v57
v_accvgpr_write_b32 a20, v60
v_accvgpr_write_b32 a21, v61
v_accvgpr_write_b32 a22, v62
v_accvgpr_write_b32 a23, v63
v_accvgpr_read_b32 v60, a36
v_accvgpr_read_b32 v61, a37
v_accvgpr_read_b32 v62, a38
v_accvgpr_read_b32 v63, a39
v_mul_f32 v60, v60, v57
v_mul_f32 v61, v61, v57
v_mul_f32 v62, v62, v57
v_mul_f32 v63, v63, v57
v_mul_f32 v60, v60, v57
v_mul_f32 v61, v61, v57
v_mul_f32 v62, v62, v57
v_mul_f32 v63, v63, v57
v_accvgpr_write_b32 a36, v60
v_accvgpr_write_b32 a37, v61
v_accvgpr_write_b32 a38, v62
v_accvgpr_write_b32 a39, v63
v_accvgpr_read_b32 v60, a52
v_accvgpr_read_b32 v61, a53
v_accvgpr_read_b32 v62, a54
v_accvgpr_read_b32 v63, a55
v_mul_f32 v60, v60, v57
v_mul_f32 v61, v61, v57
v_mul_f32 v62, v62, v57
v_mul_f32 v63, v63, v57
v_mul_f32 v60, v60, v57
v_mul_f32 v61, v61, v57
v_mul_f32 v62, v62, v57
v_mul_f32 v63, v63, v57
v_accvgpr_write_b32 a52, v60
v_accvgpr_write_b32 a53, v61
v_accvgpr_write_b32 a54, v62
v_accvgpr_write_b32 a55, v63
v_accvgpr_read_b32 v60, a68
v_accvgpr_read_b32 v61, a69
v_accvgpr_read_b32 v62, a70
v_accvgpr_read_b32 v63, a71
v_mul_f32 v60, v60, v57
v_mul_f32 v61, v61, v57
v_mul_f32 v62, v62, v57
v_mul_f32 v63, v63, v57
v_mul_f32 v60, v60, v57
v_mul_f32 v61, v61, v57
v_mul_f32 v62, v62, v57
v_mul_f32 v63, v63, v57
v_accvgpr_write_b32 a68, v60
v_accvgpr_write_b32 a69, v61
v_accvgpr_write_b32 a70, v62
v_accvgpr_write_b32 a71, v63
v_accvgpr_read_b32 v60, a84
v_accvgpr_read_b32 v61, a85
v_accvgpr_read_b32 v62, a86
v_accvgpr_read_b32 v63, a87
v_mul_f32 v60, v60, v57
v_mul_f32 v61, v61, v57
v_mul_f32 v62, v62, v57
v_mul_f32 v63, v63, v57
v_mul_f32 v60, v60, v57
v_mul_f32 v61, v61, v57
v_mul_f32 v62, v62, v57
v_mul_f32 v63, v63, v57
v_accvgpr_write_b32 a84, v60
v_accvgpr_write_b32 a85, v61
v_accvgpr_write_b32 a86, v62
v_accvgpr_write_b32 a87, v63
v_accvgpr_read_b32 v60, a100
v_accvgpr_read_b32 v61, a101
v_accvgpr_read_b32 v62, a102
v_accvgpr_read_b32 v63, a103
v_mul_f32 v60, v60, v57
v_mul_f32 v61, v61, v57
v_mul_f32 v62, v62, v57
v_mul_f32 v63, v63, v57
v_mul_f32 v60, v60, v57
v_mul_f32 v61, v61, v57
v_mul_f32 v62, v62, v57
v_mul_f32 v63, v63, v57
v_accvgpr_write_b32 a100, v60
v_accvgpr_write_b32 a101, v61
v_accvgpr_write_b32 a102, v62
v_accvgpr_write_b32 a103, v63
v_accvgpr_read_b32 v60, a116
v_accvgpr_read_b32 v61, a117
v_accvgpr_read_b32 v62, a118
v_accvgpr_read_b32 v63, a119
v_mul_f32 v60, v60, v57
v_mul_f32 v61, v61, v57
v_mul_f32 v62, v62, v57
v_mul_f32 v63, v63, v57
v_mul_f32 v60, v60, v57
v_mul_f32 v61, v61, v57
v_mul_f32 v62, v62, v57
v_mul_f32 v63, v63, v57
v_accvgpr_write_b32 a116, v60
v_accvgpr_write_b32 a117, v61
v_accvgpr_write_b32 a118, v62
v_accvgpr_write_b32 a119, v63
v_accvgpr_read_b32 v60, a196
v_accvgpr_read_b32 v61, a197
v_accvgpr_read_b32 v62, a198
v_accvgpr_read_b32 v63, a199
v_mul_f32 v60, v60, v57
v_mul_f32 v61, v61, v57
v_mul_f32 v62, v62, v57
v_mul_f32 v63, v63, v57
v_mul_f32 v60, v60, v57
v_mul_f32 v61, v61, v57
v_mul_f32 v62, v62, v57
v_mul_f32 v63, v63, v57
v_accvgpr_write_b32 a196, v60
v_accvgpr_write_b32 a197, v61
v_accvgpr_write_b32 a198, v62
v_accvgpr_write_b32 a199, v63
v_accvgpr_read_b32 v60, a8
v_accvgpr_read_b32 v61, a9
v_accvgpr_read_b32 v62, a10
v_accvgpr_read_b32 v63, a11
v_mul_f32 v60, v60, v58
v_mul_f32 v61, v61, v58
v_mul_f32 v62, v62, v58
v_mul_f32 v63, v63, v58
v_mul_f32 v60, v60, v58
v_mul_f32 v61, v61, v58
v_mul_f32 v62, v62, v58
v_mul_f32 v63, v63, v58
v_accvgpr_write_b32 a8, v60
v_accvgpr_write_b32 a9, v61
v_accvgpr_write_b32 a10, v62
v_accvgpr_write_b32 a11, v63
v_accvgpr_read_b32 v60, a24
v_accvgpr_read_b32 v61, a25
v_accvgpr_read_b32 v62, a26
v_accvgpr_read_b32 v63, a27
v_mul_f32 v60, v60, v58
v_mul_f32 v61, v61, v58
v_mul_f32 v62, v62, v58
v_mul_f32 v63, v63, v58
v_mul_f32 v60, v60, v58
v_mul_f32 v61, v61, v58
v_mul_f32 v62, v62, v58
v_mul_f32 v63, v63, v58
v_accvgpr_write_b32 a24, v60
v_accvgpr_write_b32 a25, v61
v_accvgpr_write_b32 a26, v62
v_accvgpr_write_b32 a27, v63
v_accvgpr_read_b32 v60, a40
v_accvgpr_read_b32 v61, a41
v_accvgpr_read_b32 v62, a42
v_accvgpr_read_b32 v63, a43
v_mul_f32 v60, v60, v58
v_mul_f32 v61, v61, v58
v_mul_f32 v62, v62, v58
v_mul_f32 v63, v63, v58
v_mul_f32 v60, v60, v58
v_mul_f32 v61, v61, v58
v_mul_f32 v62, v62, v58
v_mul_f32 v63, v63, v58
v_accvgpr_write_b32 a40, v60
v_accvgpr_write_b32 a41, v61
v_accvgpr_write_b32 a42, v62
v_accvgpr_write_b32 a43, v63
v_accvgpr_read_b32 v60, a56
v_accvgpr_read_b32 v61, a57
v_accvgpr_read_b32 v62, a58
v_accvgpr_read_b32 v63, a59
v_mul_f32 v60, v60, v58
v_mul_f32 v61, v61, v58
v_mul_f32 v62, v62, v58
v_mul_f32 v63, v63, v58
v_mul_f32 v60, v60, v58
v_mul_f32 v61, v61, v58
v_mul_f32 v62, v62, v58
v_mul_f32 v63, v63, v58
v_accvgpr_write_b32 a56, v60
v_accvgpr_write_b32 a57, v61
v_accvgpr_write_b32 a58, v62
v_accvgpr_write_b32 a59, v63
v_accvgpr_read_b32 v60, a72
v_accvgpr_read_b32 v61, a73
v_accvgpr_read_b32 v62, a74
v_accvgpr_read_b32 v63, a75
v_mul_f32 v60, v60, v58
v_mul_f32 v61, v61, v58
v_mul_f32 v62, v62, v58
v_mul_f32 v63, v63, v58
v_mul_f32 v60, v60, v58
v_mul_f32 v61, v61, v58
v_mul_f32 v62, v62, v58
v_mul_f32 v63, v63, v58
v_accvgpr_write_b32 a72, v60
v_accvgpr_write_b32 a73, v61
v_accvgpr_write_b32 a74, v62
v_accvgpr_write_b32 a75, v63
v_accvgpr_read_b32 v60, a88
v_accvgpr_read_b32 v61, a89
v_accvgpr_read_b32 v62, a90
v_accvgpr_read_b32 v63, a91
v_mul_f32 v60, v60, v58
v_mul_f32 v61, v61, v58
v_mul_f32 v62, v62, v58
v_mul_f32 v63, v63, v58
v_mul_f32 v60, v60, v58
v_mul_f32 v61, v61, v58
v_mul_f32 v62, v62, v58
v_mul_f32 v63, v63, v58
v_accvgpr_write_b32 a88, v60
v_accvgpr_write_b32 a89, v61
v_accvgpr_write_b32 a90, v62
v_accvgpr_write_b32 a91, v63
v_accvgpr_read_b32 v60, a104
v_accvgpr_read_b32 v61, a105
v_accvgpr_read_b32 v62, a106
v_accvgpr_read_b32 v63, a107
v_mul_f32 v60, v60, v58
v_mul_f32 v61, v61, v58
v_mul_f32 v62, v62, v58
v_mul_f32 v63, v63, v58
v_mul_f32 v60, v60, v58
v_mul_f32 v61, v61, v58
v_mul_f32 v62, v62, v58
v_mul_f32 v63, v63, v58
v_accvgpr_write_b32 a104, v60
v_accvgpr_write_b32 a105, v61
v_accvgpr_write_b32 a106, v62
v_accvgpr_write_b32 a107, v63
v_accvgpr_read_b32 v60, a120
v_accvgpr_read_b32 v61, a121
v_accvgpr_read_b32 v62, a122
v_accvgpr_read_b32 v63, a123
v_mul_f32 v60, v60, v58
v_mul_f32 v61, v61, v58
v_mul_f32 v62, v62, v58
v_mul_f32 v63, v63, v58
v_mul_f32 v60, v60, v58
v_mul_f32 v61, v61, v58
v_mul_f32 v62, v62, v58
v_mul_f32 v63, v63, v58
v_accvgpr_write_b32 a120, v60
v_accvgpr_write_b32 a121, v61
v_accvgpr_write_b32 a122, v62
v_accvgpr_write_b32 a123, v63
v_accvgpr_read_b32 v60, a200
v_accvgpr_read_b32 v61, a201
v_accvgpr_read_b32 v62, a202
v_accvgpr_read_b32 v63, a203
v_mul_f32 v60, v60, v58
v_mul_f32 v61, v61, v58
v_mul_f32 v62, v62, v58
v_mul_f32 v63, v63, v58
v_mul_f32 v60, v60, v58
v_mul_f32 v61, v61, v58
v_mul_f32 v62, v62, v58
v_mul_f32 v63, v63, v58
v_accvgpr_write_b32 a200, v60
v_accvgpr_write_b32 a201, v61
v_accvgpr_write_b32 a202, v62
v_accvgpr_write_b32 a203, v63
v_accvgpr_read_b32 v60, a12
v_accvgpr_read_b32 v61, a13
v_accvgpr_read_b32 v62, a14
v_accvgpr_read_b32 v63, a15
v_mul_f32 v60, v60, v59
v_mul_f32 v61, v61, v59
v_mul_f32 v62, v62, v59
v_mul_f32 v63, v63, v59
v_mul_f32 v60, v60, v59
v_mul_f32 v61, v61, v59
v_mul_f32 v62, v62, v59
v_mul_f32 v63, v63, v59
v_accvgpr_write_b32 a12, v60
v_accvgpr_write_b32 a13, v61
v_accvgpr_write_b32 a14, v62
v_accvgpr_write_b32 a15, v63
v_accvgpr_read_b32 v60, a28
v_accvgpr_read_b32 v61, a29
v_accvgpr_read_b32 v62, a30
v_accvgpr_read_b32 v63, a31
v_mul_f32 v60, v60, v59
v_mul_f32 v61, v61, v59
v_mul_f32 v62, v62, v59
v_mul_f32 v63, v63, v59
v_mul_f32 v60, v60, v59
v_mul_f32 v61, v61, v59
v_mul_f32 v62, v62, v59
v_mul_f32 v63, v63, v59
v_accvgpr_write_b32 a28, v60
v_accvgpr_write_b32 a29, v61
v_accvgpr_write_b32 a30, v62
v_accvgpr_write_b32 a31, v63
v_accvgpr_read_b32 v60, a44
v_accvgpr_read_b32 v61, a45
v_accvgpr_read_b32 v62, a46
v_accvgpr_read_b32 v63, a47
v_mul_f32 v60, v60, v59
v_mul_f32 v61, v61, v59
v_mul_f32 v62, v62, v59
v_mul_f32 v63, v63, v59
v_mul_f32 v60, v60, v59
v_mul_f32 v61, v61, v59
v_mul_f32 v62, v62, v59
v_mul_f32 v63, v63, v59
v_accvgpr_write_b32 a44, v60
v_accvgpr_write_b32 a45, v61
v_accvgpr_write_b32 a46, v62
v_accvgpr_write_b32 a47, v63
v_accvgpr_read_b32 v60, a60
v_accvgpr_read_b32 v61, a61
v_accvgpr_read_b32 v62, a62
v_accvgpr_read_b32 v63, a63
v_mul_f32 v60, v60, v59
v_mul_f32 v61, v61, v59
v_mul_f32 v62, v62, v59
v_mul_f32 v63, v63, v59
v_mul_f32 v60, v60, v59
v_mul_f32 v61, v61, v59
v_mul_f32 v62, v62, v59
v_mul_f32 v63, v63, v59
v_accvgpr_write_b32 a60, v60
v_accvgpr_write_b32 a61, v61
v_accvgpr_write_b32 a62, v62
v_accvgpr_write_b32 a63, v63
v_accvgpr_read_b32 v60, a76
v_accvgpr_read_b32 v61, a77
v_accvgpr_read_b32 v62, a78
v_accvgpr_read_b32 v63, a79
v_mul_f32 v60, v60, v59
v_mul_f32 v61, v61, v59
v_mul_f32 v62, v62, v59
v_mul_f32 v63, v63, v59
v_mul_f32 v60, v60, v59
v_mul_f32 v61, v61, v59
v_mul_f32 v62, v62, v59
v_mul_f32 v63, v63, v59
v_accvgpr_write_b32 a76, v60
v_accvgpr_write_b32 a77, v61
v_accvgpr_write_b32 a78, v62
v_accvgpr_write_b32 a79, v63
v_accvgpr_read_b32 v60, a92
v_accvgpr_read_b32 v61, a93
v_accvgpr_read_b32 v62, a94
v_accvgpr_read_b32 v63, a95
v_mul_f32 v60, v60, v59
v_mul_f32 v61, v61, v59
v_mul_f32 v62, v62, v59
v_mul_f32 v63, v63, v59
v_mul_f32 v60, v60, v59
v_mul_f32 v61, v61, v59
v_mul_f32 v62, v62, v59
v_mul_f32 v63, v63, v59
v_accvgpr_write_b32 a92, v60
v_accvgpr_write_b32 a93, v61
v_accvgpr_write_b32 a94, v62
v_accvgpr_write_b32 a95, v63
v_accvgpr_read_b32 v60, a108
v_accvgpr_read_b32 v61, a109
v_accvgpr_read_b32 v62, a110
v_accvgpr_read_b32 v63, a111
v_mul_f32 v60, v60, v59
v_mul_f32 v61, v61, v59
v_mul_f32 v62, v62, v59
v_mul_f32 v63, v63, v59
v_mul_f32 v60, v60, v59
v_mul_f32 v61, v61, v59
v_mul_f32 v62, v62, v59
v_mul_f32 v63, v63, v59
v_accvgpr_write_b32 a108, v60
v_accvgpr_write_b32 a109, v61
v_accvgpr_write_b32 a110, v62
v_accvgpr_write_b32 a111, v63
v_accvgpr_read_b32 v60, a124
v_accvgpr_read_b32 v61, a125
v_accvgpr_read_b32 v62, a126
v_accvgpr_read_b32 v63, a127
v_mul_f32 v60, v60, v59
v_mul_f32 v61, v61, v59
v_mul_f32 v62, v62, v59
v_mul_f32 v63, v63, v59
v_mul_f32 v60, v60, v59
v_mul_f32 v61, v61, v59
v_mul_f32 v62, v62, v59
v_mul_f32 v63, v63, v59
v_accvgpr_write_b32 a124, v60
v_accvgpr_write_b32 a125, v61
v_accvgpr_write_b32 a126, v62
v_accvgpr_write_b32 a127, v63
v_accvgpr_read_b32 v60, a204
v_accvgpr_read_b32 v61, a205
v_accvgpr_read_b32 v62, a206
v_accvgpr_read_b32 v63, a207
v_mul_f32 v60, v60, v59
v_mul_f32 v61, v61, v59
v_mul_f32 v62, v62, v59
v_mul_f32 v63, v63, v59
v_mul_f32 v60, v60, v59
v_mul_f32 v61, v61, v59
v_mul_f32 v62, v62, v59
v_mul_f32 v63, v63, v59
v_accvgpr_write_b32 a204, v60
v_accvgpr_write_b32 a205, v61
v_accvgpr_write_b32 a206, v62
v_accvgpr_write_b32 a207, v63
s_mov_b32 s45, 0
s_nop 1
s_branch L_attn_kernel_rback_a_0
L_attn_kernel_resc_a_1:
s_nop 7
s_nop 7
v_accvgpr_read_b32 v60, a0
v_accvgpr_read_b32 v61, a1
v_accvgpr_read_b32 v62, a2
v_accvgpr_read_b32 v63, a3
v_mul_f32 v60, v60, v56
v_mul_f32 v61, v61, v56
v_mul_f32 v62, v62, v56
v_mul_f32 v63, v63, v56
v_mul_f32 v60, v60, v56
v_mul_f32 v61, v61, v56
v_mul_f32 v62, v62, v56
v_mul_f32 v63, v63, v56
v_accvgpr_write_b32 a0, v60
v_accvgpr_write_b32 a1, v61
v_accvgpr_write_b32 a2, v62
v_accvgpr_write_b32 a3, v63
v_accvgpr_read_b32 v60, a16
v_accvgpr_read_b32 v61, a17
v_accvgpr_read_b32 v62, a18
v_accvgpr_read_b32 v63, a19
v_mul_f32 v60, v60, v56
v_mul_f32 v61, v61, v56
v_mul_f32 v62, v62, v56
v_mul_f32 v63, v63, v56
v_mul_f32 v60, v60, v56
v_mul_f32 v61, v61, v56
v_mul_f32 v62, v62, v56
v_mul_f32 v63, v63, v56
v_accvgpr_write_b32 a16, v60
v_accvgpr_write_b32 a17, v61
v_accvgpr_write_b32 a18, v62
v_accvgpr_write_b32 a19, v63
v_accvgpr_read_b32 v60, a32
v_accvgpr_read_b32 v61, a33
v_accvgpr_read_b32 v62, a34
v_accvgpr_read_b32 v63, a35
v_mul_f32 v60, v60, v56
v_mul_f32 v61, v61, v56
v_mul_f32 v62, v62, v56
v_mul_f32 v63, v63, v56
v_mul_f32 v60, v60, v56
v_mul_f32 v61, v61, v56
v_mul_f32 v62, v62, v56
v_mul_f32 v63, v63, v56
v_accvgpr_write_b32 a32, v60
v_accvgpr_write_b32 a33, v61
v_accvgpr_write_b32 a34, v62
v_accvgpr_write_b32 a35, v63
v_accvgpr_read_b32 v60, a48
v_accvgpr_read_b32 v61, a49
v_accvgpr_read_b32 v62, a50
v_accvgpr_read_b32 v63, a51
v_mul_f32 v60, v60, v56
v_mul_f32 v61, v61, v56
v_mul_f32 v62, v62, v56
v_mul_f32 v63, v63, v56
v_mul_f32 v60, v60, v56
v_mul_f32 v61, v61, v56
v_mul_f32 v62, v62, v56
v_mul_f32 v63, v63, v56
v_accvgpr_write_b32 a48, v60
v_accvgpr_write_b32 a49, v61
v_accvgpr_write_b32 a50, v62
v_accvgpr_write_b32 a51, v63
v_accvgpr_read_b32 v60, a64
v_accvgpr_read_b32 v61, a65
v_accvgpr_read_b32 v62, a66
v_accvgpr_read_b32 v63, a67
v_mul_f32 v60, v60, v56
v_mul_f32 v61, v61, v56
v_mul_f32 v62, v62, v56
v_mul_f32 v63, v63, v56
v_mul_f32 v60, v60, v56
v_mul_f32 v61, v61, v56
v_mul_f32 v62, v62, v56
v_mul_f32 v63, v63, v56
v_accvgpr_write_b32 a64, v60
v_accvgpr_write_b32 a65, v61
v_accvgpr_write_b32 a66, v62
v_accvgpr_write_b32 a67, v63
v_accvgpr_read_b32 v60, a80
v_accvgpr_read_b32 v61, a81
v_accvgpr_read_b32 v62, a82
v_accvgpr_read_b32 v63, a83
v_mul_f32 v60, v60, v56
v_mul_f32 v61, v61, v56
v_mul_f32 v62, v62, v56
v_mul_f32 v63, v63, v56
v_mul_f32 v60, v60, v56
v_mul_f32 v61, v61, v56
v_mul_f32 v62, v62, v56
v_mul_f32 v63, v63, v56
v_accvgpr_write_b32 a80, v60
v_accvgpr_write_b32 a81, v61
v_accvgpr_write_b32 a82, v62
v_accvgpr_write_b32 a83, v63
v_accvgpr_read_b32 v60, a96
v_accvgpr_read_b32 v61, a97
v_accvgpr_read_b32 v62, a98
v_accvgpr_read_b32 v63, a99
v_mul_f32 v60, v60, v56
v_mul_f32 v61, v61, v56
v_mul_f32 v62, v62, v56
v_mul_f32 v63, v63, v56
v_mul_f32 v60, v60, v56
v_mul_f32 v61, v61, v56
v_mul_f32 v62, v62, v56
v_mul_f32 v63, v63, v56
v_accvgpr_write_b32 a96, v60
v_accvgpr_write_b32 a97, v61
v_accvgpr_write_b32 a98, v62
v_accvgpr_write_b32 a99, v63
v_accvgpr_read_b32 v60, a112
v_accvgpr_read_b32 v61, a113
v_accvgpr_read_b32 v62, a114
v_accvgpr_read_b32 v63, a115
v_mul_f32 v60, v60, v56
v_mul_f32 v61, v61, v56
v_mul_f32 v62, v62, v56
v_mul_f32 v63, v63, v56
v_mul_f32 v60, v60, v56
v_mul_f32 v61, v61, v56
v_mul_f32 v62, v62, v56
v_mul_f32 v63, v63, v56
v_accvgpr_write_b32 a112, v60
v_accvgpr_write_b32 a113, v61
v_accvgpr_write_b32 a114, v62
v_accvgpr_write_b32 a115, v63
v_accvgpr_read_b32 v60, a192
v_accvgpr_read_b32 v61, a193
v_accvgpr_read_b32 v62, a194
v_accvgpr_read_b32 v63, a195
v_mul_f32 v60, v60, v56
v_mul_f32 v61, v61, v56
v_mul_f32 v62, v62, v56
v_mul_f32 v63, v63, v56
v_mul_f32 v60, v60, v56
v_mul_f32 v61, v61, v56
v_mul_f32 v62, v62, v56
v_mul_f32 v63, v63, v56
v_accvgpr_write_b32 a192, v60
v_accvgpr_write_b32 a193, v61
v_accvgpr_write_b32 a194, v62
v_accvgpr_write_b32 a195, v63
v_accvgpr_read_b32 v60, a4
v_accvgpr_read_b32 v61, a5
v_accvgpr_read_b32 v62, a6
v_accvgpr_read_b32 v63, a7
v_mul_f32 v60, v60, v57
v_mul_f32 v61, v61, v57
v_mul_f32 v62, v62, v57
v_mul_f32 v63, v63, v57
v_mul_f32 v60, v60, v57
v_mul_f32 v61, v61, v57
v_mul_f32 v62, v62, v57
v_mul_f32 v63, v63, v57
v_accvgpr_write_b32 a4, v60
v_accvgpr_write_b32 a5, v61
v_accvgpr_write_b32 a6, v62
v_accvgpr_write_b32 a7, v63
v_accvgpr_read_b32 v60, a20
v_accvgpr_read_b32 v61, a21
v_accvgpr_read_b32 v62, a22
v_accvgpr_read_b32 v63, a23
v_mul_f32 v60, v60, v57
v_mul_f32 v61, v61, v57
v_mul_f32 v62, v62, v57
v_mul_f32 v63, v63, v57
v_mul_f32 v60, v60, v57
v_mul_f32 v61, v61, v57
v_mul_f32 v62, v62, v57
v_mul_f32 v63, v63, v57
v_accvgpr_write_b32 a20, v60
v_accvgpr_write_b32 a21, v61
v_accvgpr_write_b32 a22, v62
v_accvgpr_write_b32 a23, v63
v_accvgpr_read_b32 v60, a36
v_accvgpr_read_b32 v61, a37
v_accvgpr_read_b32 v62, a38
v_accvgpr_read_b32 v63, a39
v_mul_f32 v60, v60, v57
v_mul_f32 v61, v61, v57
v_mul_f32 v62, v62, v57
v_mul_f32 v63, v63, v57
v_mul_f32 v60, v60, v57
v_mul_f32 v61, v61, v57
v_mul_f32 v62, v62, v57
v_mul_f32 v63, v63, v57
v_accvgpr_write_b32 a36, v60
v_accvgpr_write_b32 a37, v61
v_accvgpr_write_b32 a38, v62
v_accvgpr_write_b32 a39, v63
v_accvgpr_read_b32 v60, a52
v_accvgpr_read_b32 v61, a53
v_accvgpr_read_b32 v62, a54
v_accvgpr_read_b32 v63, a55
v_mul_f32 v60, v60, v57
v_mul_f32 v61, v61, v57
v_mul_f32 v62, v62, v57
v_mul_f32 v63, v63, v57
v_mul_f32 v60, v60, v57
v_mul_f32 v61, v61, v57
v_mul_f32 v62, v62, v57
v_mul_f32 v63, v63, v57
v_accvgpr_write_b32 a52, v60
v_accvgpr_write_b32 a53, v61
v_accvgpr_write_b32 a54, v62
v_accvgpr_write_b32 a55, v63
v_accvgpr_read_b32 v60, a68
v_accvgpr_read_b32 v61, a69
v_accvgpr_read_b32 v62, a70
v_accvgpr_read_b32 v63, a71
v_mul_f32 v60, v60, v57
v_mul_f32 v61, v61, v57
v_mul_f32 v62, v62, v57
v_mul_f32 v63, v63, v57
v_mul_f32 v60, v60, v57
v_mul_f32 v61, v61, v57
v_mul_f32 v62, v62, v57
v_mul_f32 v63, v63, v57
v_accvgpr_write_b32 a68, v60
v_accvgpr_write_b32 a69, v61
v_accvgpr_write_b32 a70, v62
v_accvgpr_write_b32 a71, v63
v_accvgpr_read_b32 v60, a84
v_accvgpr_read_b32 v61, a85
v_accvgpr_read_b32 v62, a86
v_accvgpr_read_b32 v63, a87
v_mul_f32 v60, v60, v57
v_mul_f32 v61, v61, v57
v_mul_f32 v62, v62, v57
v_mul_f32 v63, v63, v57
v_mul_f32 v60, v60, v57
v_mul_f32 v61, v61, v57
v_mul_f32 v62, v62, v57
v_mul_f32 v63, v63, v57
v_accvgpr_write_b32 a84, v60
v_accvgpr_write_b32 a85, v61
v_accvgpr_write_b32 a86, v62
v_accvgpr_write_b32 a87, v63
v_accvgpr_read_b32 v60, a100
v_accvgpr_read_b32 v61, a101
v_accvgpr_read_b32 v62, a102
v_accvgpr_read_b32 v63, a103
v_mul_f32 v60, v60, v57
v_mul_f32 v61, v61, v57
v_mul_f32 v62, v62, v57
v_mul_f32 v63, v63, v57
v_mul_f32 v60, v60, v57
v_mul_f32 v61, v61, v57
v_mul_f32 v62, v62, v57
v_mul_f32 v63, v63, v57
v_accvgpr_write_b32 a100, v60
v_accvgpr_write_b32 a101, v61
v_accvgpr_write_b32 a102, v62
v_accvgpr_write_b32 a103, v63
v_accvgpr_read_b32 v60, a116
v_accvgpr_read_b32 v61, a117
v_accvgpr_read_b32 v62, a118
v_accvgpr_read_b32 v63, a119
v_mul_f32 v60, v60, v57
v_mul_f32 v61, v61, v57
v_mul_f32 v62, v62, v57
v_mul_f32 v63, v63, v57
v_mul_f32 v60, v60, v57
v_mul_f32 v61, v61, v57
v_mul_f32 v62, v62, v57
v_mul_f32 v63, v63, v57
v_accvgpr_write_b32 a116, v60
v_accvgpr_write_b32 a117, v61
v_accvgpr_write_b32 a118, v62
v_accvgpr_write_b32 a119, v63
v_accvgpr_read_b32 v60, a196
v_accvgpr_read_b32 v61, a197
v_accvgpr_read_b32 v62, a198
v_accvgpr_read_b32 v63, a199
v_mul_f32 v60, v60, v57
v_mul_f32 v61, v61, v57
v_mul_f32 v62, v62, v57
v_mul_f32 v63, v63, v57
v_mul_f32 v60, v60, v57
v_mul_f32 v61, v61, v57
v_mul_f32 v62, v62, v57
v_mul_f32 v63, v63, v57
v_accvgpr_write_b32 a196, v60
v_accvgpr_write_b32 a197, v61
v_accvgpr_write_b32 a198, v62
v_accvgpr_write_b32 a199, v63
v_accvgpr_read_b32 v60, a8
v_accvgpr_read_b32 v61, a9
v_accvgpr_read_b32 v62, a10
v_accvgpr_read_b32 v63, a11
v_mul_f32 v60, v60, v58
v_mul_f32 v61, v61, v58
v_mul_f32 v62, v62, v58
v_mul_f32 v63, v63, v58
v_mul_f32 v60, v60, v58
v_mul_f32 v61, v61, v58
v_mul_f32 v62, v62, v58
v_mul_f32 v63, v63, v58
v_accvgpr_write_b32 a8, v60
v_accvgpr_write_b32 a9, v61
v_accvgpr_write_b32 a10, v62
v_accvgpr_write_b32 a11, v63
v_accvgpr_read_b32 v60, a24
v_accvgpr_read_b32 v61, a25
v_accvgpr_read_b32 v62, a26
v_accvgpr_read_b32 v63, a27
v_mul_f32 v60, v60, v58
v_mul_f32 v61, v61, v58
v_mul_f32 v62, v62, v58
v_mul_f32 v63, v63, v58
v_mul_f32 v60, v60, v58
v_mul_f32 v61, v61, v58
v_mul_f32 v62, v62, v58
v_mul_f32 v63, v63, v58
v_accvgpr_write_b32 a24, v60
v_accvgpr_write_b32 a25, v61
v_accvgpr_write_b32 a26, v62
v_accvgpr_write_b32 a27, v63
v_accvgpr_read_b32 v60, a40
v_accvgpr_read_b32 v61, a41
v_accvgpr_read_b32 v62, a42
v_accvgpr_read_b32 v63, a43
v_mul_f32 v60, v60, v58
v_mul_f32 v61, v61, v58
v_mul_f32 v62, v62, v58
v_mul_f32 v63, v63, v58
v_mul_f32 v60, v60, v58
v_mul_f32 v61, v61, v58
v_mul_f32 v62, v62, v58
v_mul_f32 v63, v63, v58
v_accvgpr_write_b32 a40, v60
v_accvgpr_write_b32 a41, v61
v_accvgpr_write_b32 a42, v62
v_accvgpr_write_b32 a43, v63
v_accvgpr_read_b32 v60, a56
v_accvgpr_read_b32 v61, a57
v_accvgpr_read_b32 v62, a58
v_accvgpr_read_b32 v63, a59
v_mul_f32 v60, v60, v58
v_mul_f32 v61, v61, v58
v_mul_f32 v62, v62, v58
v_mul_f32 v63, v63, v58
v_mul_f32 v60, v60, v58
v_mul_f32 v61, v61, v58
v_mul_f32 v62, v62, v58
v_mul_f32 v63, v63, v58
v_accvgpr_write_b32 a56, v60
v_accvgpr_write_b32 a57, v61
v_accvgpr_write_b32 a58, v62
v_accvgpr_write_b32 a59, v63
v_accvgpr_read_b32 v60, a72
v_accvgpr_read_b32 v61, a73
v_accvgpr_read_b32 v62, a74
v_accvgpr_read_b32 v63, a75
v_mul_f32 v60, v60, v58
v_mul_f32 v61, v61, v58
v_mul_f32 v62, v62, v58
v_mul_f32 v63, v63, v58
v_mul_f32 v60, v60, v58
v_mul_f32 v61, v61, v58
v_mul_f32 v62, v62, v58
v_mul_f32 v63, v63, v58
v_accvgpr_write_b32 a72, v60
v_accvgpr_write_b32 a73, v61
v_accvgpr_write_b32 a74, v62
v_accvgpr_write_b32 a75, v63
v_accvgpr_read_b32 v60, a88
v_accvgpr_read_b32 v61, a89
v_accvgpr_read_b32 v62, a90
v_accvgpr_read_b32 v63, a91
v_mul_f32 v60, v60, v58
v_mul_f32 v61, v61, v58
v_mul_f32 v62, v62, v58
v_mul_f32 v63, v63, v58
v_mul_f32 v60, v60, v58
v_mul_f32 v61, v61, v58
v_mul_f32 v62, v62, v58
v_mul_f32 v63, v63, v58
v_accvgpr_write_b32 a88, v60
v_accvgpr_write_b32 a89, v61
v_accvgpr_write_b32 a90, v62
v_accvgpr_write_b32 a91, v63
v_accvgpr_read_b32 v60, a104
v_accvgpr_read_b32 v61, a105
v_accvgpr_read_b32 v62, a106
v_accvgpr_read_b32 v63, a107
v_mul_f32 v60, v60, v58
v_mul_f32 v61, v61, v58
v_mul_f32 v62, v62, v58
v_mul_f32 v63, v63, v58
v_mul_f32 v60, v60, v58
v_mul_f32 v61, v61, v58
v_mul_f32 v62, v62, v58
v_mul_f32 v63, v63, v58
v_accvgpr_write_b32 a104, v60
v_accvgpr_write_b32 a105, v61
v_accvgpr_write_b32 a106, v62
v_accvgpr_write_b32 a107, v63
v_accvgpr_read_b32 v60, a120
v_accvgpr_read_b32 v61, a121
v_accvgpr_read_b32 v62, a122
v_accvgpr_read_b32 v63, a123
v_mul_f32 v60, v60, v58
v_mul_f32 v61, v61, v58
v_mul_f32 v62, v62, v58
v_mul_f32 v63, v63, v58
v_mul_f32 v60, v60, v58
v_mul_f32 v61, v61, v58
v_mul_f32 v62, v62, v58
v_mul_f32 v63, v63, v58
v_accvgpr_write_b32 a120, v60
v_accvgpr_write_b32 a121, v61
v_accvgpr_write_b32 a122, v62
v_accvgpr_write_b32 a123, v63
v_accvgpr_read_b32 v60, a200
v_accvgpr_read_b32 v61, a201
v_accvgpr_read_b32 v62, a202
v_accvgpr_read_b32 v63, a203
v_mul_f32 v60, v60, v58
v_mul_f32 v61, v61, v58
v_mul_f32 v62, v62, v58
v_mul_f32 v63, v63, v58
v_mul_f32 v60, v60, v58
v_mul_f32 v61, v61, v58
v_mul_f32 v62, v62, v58
v_mul_f32 v63, v63, v58
v_accvgpr_write_b32 a200, v60
v_accvgpr_write_b32 a201, v61
v_accvgpr_write_b32 a202, v62
v_accvgpr_write_b32 a203, v63
v_accvgpr_read_b32 v60, a12
v_accvgpr_read_b32 v61, a13
v_accvgpr_read_b32 v62, a14
v_accvgpr_read_b32 v63, a15
v_mul_f32 v60, v60, v59
v_mul_f32 v61, v61, v59
v_mul_f32 v62, v62, v59
v_mul_f32 v63, v63, v59
v_mul_f32 v60, v60, v59
v_mul_f32 v61, v61, v59
v_mul_f32 v62, v62, v59
v_mul_f32 v63, v63, v59
v_accvgpr_write_b32 a12, v60
v_accvgpr_write_b32 a13, v61
v_accvgpr_write_b32 a14, v62
v_accvgpr_write_b32 a15, v63
v_accvgpr_read_b32 v60, a28
v_accvgpr_read_b32 v61, a29
v_accvgpr_read_b32 v62, a30
v_accvgpr_read_b32 v63, a31
v_mul_f32 v60, v60, v59
v_mul_f32 v61, v61, v59
v_mul_f32 v62, v62, v59
v_mul_f32 v63, v63, v59
v_mul_f32 v60, v60, v59
v_mul_f32 v61, v61, v59
v_mul_f32 v62, v62, v59
v_mul_f32 v63, v63, v59
v_accvgpr_write_b32 a28, v60
v_accvgpr_write_b32 a29, v61
v_accvgpr_write_b32 a30, v62
v_accvgpr_write_b32 a31, v63
v_accvgpr_read_b32 v60, a44
v_accvgpr_read_b32 v61, a45
v_accvgpr_read_b32 v62, a46
v_accvgpr_read_b32 v63, a47
v_mul_f32 v60, v60, v59
v_mul_f32 v61, v61, v59
v_mul_f32 v62, v62, v59
v_mul_f32 v63, v63, v59
v_mul_f32 v60, v60, v59
v_mul_f32 v61, v61, v59
v_mul_f32 v62, v62, v59
v_mul_f32 v63, v63, v59
v_accvgpr_write_b32 a44, v60
v_accvgpr_write_b32 a45, v61
v_accvgpr_write_b32 a46, v62
v_accvgpr_write_b32 a47, v63
v_accvgpr_read_b32 v60, a60
v_accvgpr_read_b32 v61, a61
v_accvgpr_read_b32 v62, a62
v_accvgpr_read_b32 v63, a63
v_mul_f32 v60, v60, v59
v_mul_f32 v61, v61, v59
v_mul_f32 v62, v62, v59
v_mul_f32 v63, v63, v59
v_mul_f32 v60, v60, v59
v_mul_f32 v61, v61, v59
v_mul_f32 v62, v62, v59
v_mul_f32 v63, v63, v59
v_accvgpr_write_b32 a60, v60
v_accvgpr_write_b32 a61, v61
v_accvgpr_write_b32 a62, v62
v_accvgpr_write_b32 a63, v63
v_accvgpr_read_b32 v60, a76
v_accvgpr_read_b32 v61, a77
v_accvgpr_read_b32 v62, a78
v_accvgpr_read_b32 v63, a79
v_mul_f32 v60, v60, v59
v_mul_f32 v61, v61, v59
v_mul_f32 v62, v62, v59
v_mul_f32 v63, v63, v59
v_mul_f32 v60, v60, v59
v_mul_f32 v61, v61, v59
v_mul_f32 v62, v62, v59
v_mul_f32 v63, v63, v59
v_accvgpr_write_b32 a76, v60
v_accvgpr_write_b32 a77, v61
v_accvgpr_write_b32 a78, v62
v_accvgpr_write_b32 a79, v63
v_accvgpr_read_b32 v60, a92
v_accvgpr_read_b32 v61, a93
v_accvgpr_read_b32 v62, a94
v_accvgpr_read_b32 v63, a95
v_mul_f32 v60, v60, v59
v_mul_f32 v61, v61, v59
v_mul_f32 v62, v62, v59
v_mul_f32 v63, v63, v59
v_mul_f32 v60, v60, v59
v_mul_f32 v61, v61, v59
v_mul_f32 v62, v62, v59
v_mul_f32 v63, v63, v59
v_accvgpr_write_b32 a92, v60
v_accvgpr_write_b32 a93, v61
v_accvgpr_write_b32 a94, v62
v_accvgpr_write_b32 a95, v63
v_accvgpr_read_b32 v60, a108
v_accvgpr_read_b32 v61, a109
v_accvgpr_read_b32 v62, a110
v_accvgpr_read_b32 v63, a111
v_mul_f32 v60, v60, v59
v_mul_f32 v61, v61, v59
v_mul_f32 v62, v62, v59
v_mul_f32 v63, v63, v59
v_mul_f32 v60, v60, v59
v_mul_f32 v61, v61, v59
v_mul_f32 v62, v62, v59
v_mul_f32 v63, v63, v59
v_accvgpr_write_b32 a108, v60
v_accvgpr_write_b32 a109, v61
v_accvgpr_write_b32 a110, v62
v_accvgpr_write_b32 a111, v63
v_accvgpr_read_b32 v60, a124
v_accvgpr_read_b32 v61, a125
v_accvgpr_read_b32 v62, a126
v_accvgpr_read_b32 v63, a127
v_mul_f32 v60, v60, v59
v_mul_f32 v61, v61, v59
v_mul_f32 v62, v62, v59
v_mul_f32 v63, v63, v59
v_mul_f32 v60, v60, v59
v_mul_f32 v61, v61, v59
v_mul_f32 v62, v62, v59
v_mul_f32 v63, v63, v59
v_accvgpr_write_b32 a124, v60
v_accvgpr_write_b32 a125, v61
v_accvgpr_write_b32 a126, v62
v_accvgpr_write_b32 a127, v63
v_accvgpr_read_b32 v60, a204
v_accvgpr_read_b32 v61, a205
v_accvgpr_read_b32 v62, a206
v_accvgpr_read_b32 v63, a207
v_mul_f32 v60, v60, v59
v_mul_f32 v61, v61, v59
v_mul_f32 v62, v62, v59
v_mul_f32 v63, v63, v59
v_mul_f32 v60, v60, v59
v_mul_f32 v61, v61, v59
v_mul_f32 v62, v62, v59
v_mul_f32 v63, v63, v59
v_accvgpr_write_b32 a204, v60
v_accvgpr_write_b32 a205, v61
v_accvgpr_write_b32 a206, v62
v_accvgpr_write_b32 a207, v63
s_mov_b32 s45, 0
s_nop 1
s_branch L_attn_kernel_rback_a_1
L_attn_kernel_resc_a_2:
s_nop 7
s_nop 7
v_accvgpr_read_b32 v60, a0
v_accvgpr_read_b32 v61, a1
v_accvgpr_read_b32 v62, a2
v_accvgpr_read_b32 v63, a3
v_mul_f32 v60, v60, v56
v_mul_f32 v61, v61, v56
v_mul_f32 v62, v62, v56
v_mul_f32 v63, v63, v56
v_mul_f32 v60, v60, v56
v_mul_f32 v61, v61, v56
v_mul_f32 v62, v62, v56
v_mul_f32 v63, v63, v56
v_accvgpr_write_b32 a0, v60
v_accvgpr_write_b32 a1, v61
v_accvgpr_write_b32 a2, v62
v_accvgpr_write_b32 a3, v63
v_accvgpr_read_b32 v60, a16
v_accvgpr_read_b32 v61, a17
v_accvgpr_read_b32 v62, a18
v_accvgpr_read_b32 v63, a19
v_mul_f32 v60, v60, v56
v_mul_f32 v61, v61, v56
v_mul_f32 v62, v62, v56
v_mul_f32 v63, v63, v56
v_mul_f32 v60, v60, v56
v_mul_f32 v61, v61, v56
v_mul_f32 v62, v62, v56
v_mul_f32 v63, v63, v56
v_accvgpr_write_b32 a16, v60
v_accvgpr_write_b32 a17, v61
v_accvgpr_write_b32 a18, v62
v_accvgpr_write_b32 a19, v63
v_accvgpr_read_b32 v60, a32
v_accvgpr_read_b32 v61, a33
v_accvgpr_read_b32 v62, a34
v_accvgpr_read_b32 v63, a35
v_mul_f32 v60, v60, v56
v_mul_f32 v61, v61, v56
v_mul_f32 v62, v62, v56
v_mul_f32 v63, v63, v56
v_mul_f32 v60, v60, v56
v_mul_f32 v61, v61, v56
v_mul_f32 v62, v62, v56
v_mul_f32 v63, v63, v56
v_accvgpr_write_b32 a32, v60
v_accvgpr_write_b32 a33, v61
v_accvgpr_write_b32 a34, v62
v_accvgpr_write_b32 a35, v63
v_accvgpr_read_b32 v60, a48
v_accvgpr_read_b32 v61, a49
v_accvgpr_read_b32 v62, a50
v_accvgpr_read_b32 v63, a51
v_mul_f32 v60, v60, v56
v_mul_f32 v61, v61, v56
v_mul_f32 v62, v62, v56
v_mul_f32 v63, v63, v56
v_mul_f32 v60, v60, v56
v_mul_f32 v61, v61, v56
v_mul_f32 v62, v62, v56
v_mul_f32 v63, v63, v56
v_accvgpr_write_b32 a48, v60
v_accvgpr_write_b32 a49, v61
v_accvgpr_write_b32 a50, v62
v_accvgpr_write_b32 a51, v63
v_accvgpr_read_b32 v60, a64
v_accvgpr_read_b32 v61, a65
v_accvgpr_read_b32 v62, a66
v_accvgpr_read_b32 v63, a67
v_mul_f32 v60, v60, v56
v_mul_f32 v61, v61, v56
v_mul_f32 v62, v62, v56
v_mul_f32 v63, v63, v56
v_mul_f32 v60, v60, v56
v_mul_f32 v61, v61, v56
v_mul_f32 v62, v62, v56
v_mul_f32 v63, v63, v56
v_accvgpr_write_b32 a64, v60
v_accvgpr_write_b32 a65, v61
v_accvgpr_write_b32 a66, v62
v_accvgpr_write_b32 a67, v63
v_accvgpr_read_b32 v60, a80
v_accvgpr_read_b32 v61, a81
v_accvgpr_read_b32 v62, a82
v_accvgpr_read_b32 v63, a83
v_mul_f32 v60, v60, v56
v_mul_f32 v61, v61, v56
v_mul_f32 v62, v62, v56
v_mul_f32 v63, v63, v56
v_mul_f32 v60, v60, v56
v_mul_f32 v61, v61, v56
v_mul_f32 v62, v62, v56
v_mul_f32 v63, v63, v56
v_accvgpr_write_b32 a80, v60
v_accvgpr_write_b32 a81, v61
v_accvgpr_write_b32 a82, v62
v_accvgpr_write_b32 a83, v63
v_accvgpr_read_b32 v60, a96
v_accvgpr_read_b32 v61, a97
v_accvgpr_read_b32 v62, a98
v_accvgpr_read_b32 v63, a99
v_mul_f32 v60, v60, v56
v_mul_f32 v61, v61, v56
v_mul_f32 v62, v62, v56
v_mul_f32 v63, v63, v56
v_mul_f32 v60, v60, v56
v_mul_f32 v61, v61, v56
v_mul_f32 v62, v62, v56
v_mul_f32 v63, v63, v56
v_accvgpr_write_b32 a96, v60
v_accvgpr_write_b32 a97, v61
v_accvgpr_write_b32 a98, v62
v_accvgpr_write_b32 a99, v63
v_accvgpr_read_b32 v60, a112
v_accvgpr_read_b32 v61, a113
v_accvgpr_read_b32 v62, a114
v_accvgpr_read_b32 v63, a115
v_mul_f32 v60, v60, v56
v_mul_f32 v61, v61, v56
v_mul_f32 v62, v62, v56
v_mul_f32 v63, v63, v56
v_mul_f32 v60, v60, v56
v_mul_f32 v61, v61, v56
v_mul_f32 v62, v62, v56
v_mul_f32 v63, v63, v56
v_accvgpr_write_b32 a112, v60
v_accvgpr_write_b32 a113, v61
v_accvgpr_write_b32 a114, v62
v_accvgpr_write_b32 a115, v63
v_accvgpr_read_b32 v60, a192
v_accvgpr_read_b32 v61, a193
v_accvgpr_read_b32 v62, a194
v_accvgpr_read_b32 v63, a195
v_mul_f32 v60, v60, v56
v_mul_f32 v61, v61, v56
v_mul_f32 v62, v62, v56
v_mul_f32 v63, v63, v56
v_mul_f32 v60, v60, v56
v_mul_f32 v61, v61, v56
v_mul_f32 v62, v62, v56
v_mul_f32 v63, v63, v56
v_accvgpr_write_b32 a192, v60
v_accvgpr_write_b32 a193, v61
v_accvgpr_write_b32 a194, v62
v_accvgpr_write_b32 a195, v63
v_accvgpr_read_b32 v60, a4
v_accvgpr_read_b32 v61, a5
v_accvgpr_read_b32 v62, a6
v_accvgpr_read_b32 v63, a7
v_mul_f32 v60, v60, v57
v_mul_f32 v61, v61, v57
v_mul_f32 v62, v62, v57
v_mul_f32 v63, v63, v57
v_mul_f32 v60, v60, v57
v_mul_f32 v61, v61, v57
v_mul_f32 v62, v62, v57
v_mul_f32 v63, v63, v57
v_accvgpr_write_b32 a4, v60
v_accvgpr_write_b32 a5, v61
v_accvgpr_write_b32 a6, v62
v_accvgpr_write_b32 a7, v63
v_accvgpr_read_b32 v60, a20
v_accvgpr_read_b32 v61, a21
v_accvgpr_read_b32 v62, a22
v_accvgpr_read_b32 v63, a23
v_mul_f32 v60, v60, v57
v_mul_f32 v61, v61, v57
v_mul_f32 v62, v62, v57
v_mul_f32 v63, v63, v57
v_mul_f32 v60, v60, v57
v_mul_f32 v61, v61, v57
v_mul_f32 v62, v62, v57
v_mul_f32 v63, v63, v57
v_accvgpr_write_b32 a20, v60
v_accvgpr_write_b32 a21, v61
v_accvgpr_write_b32 a22, v62
v_accvgpr_write_b32 a23, v63
v_accvgpr_read_b32 v60, a36
v_accvgpr_read_b32 v61, a37
v_accvgpr_read_b32 v62, a38
v_accvgpr_read_b32 v63, a39
v_mul_f32 v60, v60, v57
v_mul_f32 v61, v61, v57
v_mul_f32 v62, v62, v57
v_mul_f32 v63, v63, v57
v_mul_f32 v60, v60, v57
v_mul_f32 v61, v61, v57
v_mul_f32 v62, v62, v57
v_mul_f32 v63, v63, v57
v_accvgpr_write_b32 a36, v60
v_accvgpr_write_b32 a37, v61
v_accvgpr_write_b32 a38, v62
v_accvgpr_write_b32 a39, v63
v_accvgpr_read_b32 v60, a52
v_accvgpr_read_b32 v61, a53
v_accvgpr_read_b32 v62, a54
v_accvgpr_read_b32 v63, a55
v_mul_f32 v60, v60, v57
v_mul_f32 v61, v61, v57
v_mul_f32 v62, v62, v57
v_mul_f32 v63, v63, v57
v_mul_f32 v60, v60, v57
v_mul_f32 v61, v61, v57
v_mul_f32 v62, v62, v57
v_mul_f32 v63, v63, v57
v_accvgpr_write_b32 a52, v60
v_accvgpr_write_b32 a53, v61
v_accvgpr_write_b32 a54, v62
v_accvgpr_write_b32 a55, v63
v_accvgpr_read_b32 v60, a68
v_accvgpr_read_b32 v61, a69
v_accvgpr_read_b32 v62, a70
v_accvgpr_read_b32 v63, a71
v_mul_f32 v60, v60, v57
v_mul_f32 v61, v61, v57
v_mul_f32 v62, v62, v57
v_mul_f32 v63, v63, v57
v_mul_f32 v60, v60, v57
v_mul_f32 v61, v61, v57
v_mul_f32 v62, v62, v57
v_mul_f32 v63, v63, v57
v_accvgpr_write_b32 a68, v60
v_accvgpr_write_b32 a69, v61
v_accvgpr_write_b32 a70, v62
v_accvgpr_write_b32 a71, v63
v_accvgpr_read_b32 v60, a84
v_accvgpr_read_b32 v61, a85
v_accvgpr_read_b32 v62, a86
v_accvgpr_read_b32 v63, a87
v_mul_f32 v60, v60, v57
v_mul_f32 v61, v61, v57
v_mul_f32 v62, v62, v57
v_mul_f32 v63, v63, v57
v_mul_f32 v60, v60, v57
v_mul_f32 v61, v61, v57
v_mul_f32 v62, v62, v57
v_mul_f32 v63, v63, v57
v_accvgpr_write_b32 a84, v60
v_accvgpr_write_b32 a85, v61
v_accvgpr_write_b32 a86, v62
v_accvgpr_write_b32 a87, v63
v_accvgpr_read_b32 v60, a100
v_accvgpr_read_b32 v61, a101
v_accvgpr_read_b32 v62, a102
v_accvgpr_read_b32 v63, a103
v_mul_f32 v60, v60, v57
v_mul_f32 v61, v61, v57
v_mul_f32 v62, v62, v57
v_mul_f32 v63, v63, v57
v_mul_f32 v60, v60, v57
v_mul_f32 v61, v61, v57
v_mul_f32 v62, v62, v57
v_mul_f32 v63, v63, v57
v_accvgpr_write_b32 a100, v60
v_accvgpr_write_b32 a101, v61
v_accvgpr_write_b32 a102, v62
v_accvgpr_write_b32 a103, v63
v_accvgpr_read_b32 v60, a116
v_accvgpr_read_b32 v61, a117
v_accvgpr_read_b32 v62, a118
v_accvgpr_read_b32 v63, a119
v_mul_f32 v60, v60, v57
v_mul_f32 v61, v61, v57
v_mul_f32 v62, v62, v57
v_mul_f32 v63, v63, v57
v_mul_f32 v60, v60, v57
v_mul_f32 v61, v61, v57
v_mul_f32 v62, v62, v57
v_mul_f32 v63, v63, v57
v_accvgpr_write_b32 a116, v60
v_accvgpr_write_b32 a117, v61
v_accvgpr_write_b32 a118, v62
v_accvgpr_write_b32 a119, v63
v_accvgpr_read_b32 v60, a196
v_accvgpr_read_b32 v61, a197
v_accvgpr_read_b32 v62, a198
v_accvgpr_read_b32 v63, a199
v_mul_f32 v60, v60, v57
v_mul_f32 v61, v61, v57
v_mul_f32 v62, v62, v57
v_mul_f32 v63, v63, v57
v_mul_f32 v60, v60, v57
v_mul_f32 v61, v61, v57
v_mul_f32 v62, v62, v57
v_mul_f32 v63, v63, v57
v_accvgpr_write_b32 a196, v60
v_accvgpr_write_b32 a197, v61
v_accvgpr_write_b32 a198, v62
v_accvgpr_write_b32 a199, v63
v_accvgpr_read_b32 v60, a8
v_accvgpr_read_b32 v61, a9
v_accvgpr_read_b32 v62, a10
v_accvgpr_read_b32 v63, a11
v_mul_f32 v60, v60, v58
v_mul_f32 v61, v61, v58
v_mul_f32 v62, v62, v58
v_mul_f32 v63, v63, v58
v_mul_f32 v60, v60, v58
v_mul_f32 v61, v61, v58
v_mul_f32 v62, v62, v58
v_mul_f32 v63, v63, v58
v_accvgpr_write_b32 a8, v60
v_accvgpr_write_b32 a9, v61
v_accvgpr_write_b32 a10, v62
v_accvgpr_write_b32 a11, v63
v_accvgpr_read_b32 v60, a24
v_accvgpr_read_b32 v61, a25
v_accvgpr_read_b32 v62, a26
v_accvgpr_read_b32 v63, a27
v_mul_f32 v60, v60, v58
v_mul_f32 v61, v61, v58
v_mul_f32 v62, v62, v58
v_mul_f32 v63, v63, v58
v_mul_f32 v60, v60, v58
v_mul_f32 v61, v61, v58
v_mul_f32 v62, v62, v58
v_mul_f32 v63, v63, v58
v_accvgpr_write_b32 a24, v60
v_accvgpr_write_b32 a25, v61
v_accvgpr_write_b32 a26, v62
v_accvgpr_write_b32 a27, v63
v_accvgpr_read_b32 v60, a40
v_accvgpr_read_b32 v61, a41
v_accvgpr_read_b32 v62, a42
v_accvgpr_read_b32 v63, a43
v_mul_f32 v60, v60, v58
v_mul_f32 v61, v61, v58
v_mul_f32 v62, v62, v58
v_mul_f32 v63, v63, v58
v_mul_f32 v60, v60, v58
v_mul_f32 v61, v61, v58
v_mul_f32 v62, v62, v58
v_mul_f32 v63, v63, v58
v_accvgpr_write_b32 a40, v60
v_accvgpr_write_b32 a41, v61
v_accvgpr_write_b32 a42, v62
v_accvgpr_write_b32 a43, v63
v_accvgpr_read_b32 v60, a56
v_accvgpr_read_b32 v61, a57
v_accvgpr_read_b32 v62, a58
v_accvgpr_read_b32 v63, a59
v_mul_f32 v60, v60, v58
v_mul_f32 v61, v61, v58
v_mul_f32 v62, v62, v58
v_mul_f32 v63, v63, v58
v_mul_f32 v60, v60, v58
v_mul_f32 v61, v61, v58
v_mul_f32 v62, v62, v58
v_mul_f32 v63, v63, v58
v_accvgpr_write_b32 a56, v60
v_accvgpr_write_b32 a57, v61
v_accvgpr_write_b32 a58, v62
v_accvgpr_write_b32 a59, v63
v_accvgpr_read_b32 v60, a72
v_accvgpr_read_b32 v61, a73
v_accvgpr_read_b32 v62, a74
v_accvgpr_read_b32 v63, a75
v_mul_f32 v60, v60, v58
v_mul_f32 v61, v61, v58
v_mul_f32 v62, v62, v58
v_mul_f32 v63, v63, v58
v_mul_f32 v60, v60, v58
v_mul_f32 v61, v61, v58
v_mul_f32 v62, v62, v58
v_mul_f32 v63, v63, v58
v_accvgpr_write_b32 a72, v60
v_accvgpr_write_b32 a73, v61
v_accvgpr_write_b32 a74, v62
v_accvgpr_write_b32 a75, v63
v_accvgpr_read_b32 v60, a88
v_accvgpr_read_b32 v61, a89
v_accvgpr_read_b32 v62, a90
v_accvgpr_read_b32 v63, a91
v_mul_f32 v60, v60, v58
v_mul_f32 v61, v61, v58
v_mul_f32 v62, v62, v58
v_mul_f32 v63, v63, v58
v_mul_f32 v60, v60, v58
v_mul_f32 v61, v61, v58
v_mul_f32 v62, v62, v58
v_mul_f32 v63, v63, v58
v_accvgpr_write_b32 a88, v60
v_accvgpr_write_b32 a89, v61
v_accvgpr_write_b32 a90, v62
v_accvgpr_write_b32 a91, v63
v_accvgpr_read_b32 v60, a104
v_accvgpr_read_b32 v61, a105
v_accvgpr_read_b32 v62, a106
v_accvgpr_read_b32 v63, a107
v_mul_f32 v60, v60, v58
v_mul_f32 v61, v61, v58
v_mul_f32 v62, v62, v58
v_mul_f32 v63, v63, v58
v_mul_f32 v60, v60, v58
v_mul_f32 v61, v61, v58
v_mul_f32 v62, v62, v58
v_mul_f32 v63, v63, v58
v_accvgpr_write_b32 a104, v60
v_accvgpr_write_b32 a105, v61
v_accvgpr_write_b32 a106, v62
v_accvgpr_write_b32 a107, v63
v_accvgpr_read_b32 v60, a120
v_accvgpr_read_b32 v61, a121
v_accvgpr_read_b32 v62, a122
v_accvgpr_read_b32 v63, a123
v_mul_f32 v60, v60, v58
v_mul_f32 v61, v61, v58
v_mul_f32 v62, v62, v58
v_mul_f32 v63, v63, v58
v_mul_f32 v60, v60, v58
v_mul_f32 v61, v61, v58
v_mul_f32 v62, v62, v58
v_mul_f32 v63, v63, v58
v_accvgpr_write_b32 a120, v60
v_accvgpr_write_b32 a121, v61
v_accvgpr_write_b32 a122, v62
v_accvgpr_write_b32 a123, v63
v_accvgpr_read_b32 v60, a200
v_accvgpr_read_b32 v61, a201
v_accvgpr_read_b32 v62, a202
v_accvgpr_read_b32 v63, a203
v_mul_f32 v60, v60, v58
v_mul_f32 v61, v61, v58
v_mul_f32 v62, v62, v58
v_mul_f32 v63, v63, v58
v_mul_f32 v60, v60, v58
v_mul_f32 v61, v61, v58
v_mul_f32 v62, v62, v58
v_mul_f32 v63, v63, v58
v_accvgpr_write_b32 a200, v60
v_accvgpr_write_b32 a201, v61
v_accvgpr_write_b32 a202, v62
v_accvgpr_write_b32 a203, v63
v_accvgpr_read_b32 v60, a12
v_accvgpr_read_b32 v61, a13
v_accvgpr_read_b32 v62, a14
v_accvgpr_read_b32 v63, a15
v_mul_f32 v60, v60, v59
v_mul_f32 v61, v61, v59
v_mul_f32 v62, v62, v59
v_mul_f32 v63, v63, v59
v_mul_f32 v60, v60, v59
v_mul_f32 v61, v61, v59
v_mul_f32 v62, v62, v59
v_mul_f32 v63, v63, v59
v_accvgpr_write_b32 a12, v60
v_accvgpr_write_b32 a13, v61
v_accvgpr_write_b32 a14, v62
v_accvgpr_write_b32 a15, v63
v_accvgpr_read_b32 v60, a28
v_accvgpr_read_b32 v61, a29
v_accvgpr_read_b32 v62, a30
v_accvgpr_read_b32 v63, a31
v_mul_f32 v60, v60, v59
v_mul_f32 v61, v61, v59
v_mul_f32 v62, v62, v59
v_mul_f32 v63, v63, v59
v_mul_f32 v60, v60, v59
v_mul_f32 v61, v61, v59
v_mul_f32 v62, v62, v59
v_mul_f32 v63, v63, v59
v_accvgpr_write_b32 a28, v60
v_accvgpr_write_b32 a29, v61
v_accvgpr_write_b32 a30, v62
v_accvgpr_write_b32 a31, v63
v_accvgpr_read_b32 v60, a44
v_accvgpr_read_b32 v61, a45
v_accvgpr_read_b32 v62, a46
v_accvgpr_read_b32 v63, a47
v_mul_f32 v60, v60, v59
v_mul_f32 v61, v61, v59
v_mul_f32 v62, v62, v59
v_mul_f32 v63, v63, v59
v_mul_f32 v60, v60, v59
v_mul_f32 v61, v61, v59
v_mul_f32 v62, v62, v59
v_mul_f32 v63, v63, v59
v_accvgpr_write_b32 a44, v60
v_accvgpr_write_b32 a45, v61
v_accvgpr_write_b32 a46, v62
v_accvgpr_write_b32 a47, v63
v_accvgpr_read_b32 v60, a60
v_accvgpr_read_b32 v61, a61
v_accvgpr_read_b32 v62, a62
v_accvgpr_read_b32 v63, a63
v_mul_f32 v60, v60, v59
v_mul_f32 v61, v61, v59
v_mul_f32 v62, v62, v59
v_mul_f32 v63, v63, v59
v_mul_f32 v60, v60, v59
v_mul_f32 v61, v61, v59
v_mul_f32 v62, v62, v59
v_mul_f32 v63, v63, v59
v_accvgpr_write_b32 a60, v60
v_accvgpr_write_b32 a61, v61
v_accvgpr_write_b32 a62, v62
v_accvgpr_write_b32 a63, v63
v_accvgpr_read_b32 v60, a76
v_accvgpr_read_b32 v61, a77
v_accvgpr_read_b32 v62, a78
v_accvgpr_read_b32 v63, a79
v_mul_f32 v60, v60, v59
v_mul_f32 v61, v61, v59
v_mul_f32 v62, v62, v59
v_mul_f32 v63, v63, v59
v_mul_f32 v60, v60, v59
v_mul_f32 v61, v61, v59
v_mul_f32 v62, v62, v59
v_mul_f32 v63, v63, v59
v_accvgpr_write_b32 a76, v60
v_accvgpr_write_b32 a77, v61
v_accvgpr_write_b32 a78, v62
v_accvgpr_write_b32 a79, v63
v_accvgpr_read_b32 v60, a92
v_accvgpr_read_b32 v61, a93
v_accvgpr_read_b32 v62, a94
v_accvgpr_read_b32 v63, a95
v_mul_f32 v60, v60, v59
v_mul_f32 v61, v61, v59
v_mul_f32 v62, v62, v59
v_mul_f32 v63, v63, v59
v_mul_f32 v60, v60, v59
v_mul_f32 v61, v61, v59
v_mul_f32 v62, v62, v59
v_mul_f32 v63, v63, v59
v_accvgpr_write_b32 a92, v60
v_accvgpr_write_b32 a93, v61
v_accvgpr_write_b32 a94, v62
v_accvgpr_write_b32 a95, v63
v_accvgpr_read_b32 v60, a108
v_accvgpr_read_b32 v61, a109
v_accvgpr_read_b32 v62, a110
v_accvgpr_read_b32 v63, a111
v_mul_f32 v60, v60, v59
v_mul_f32 v61, v61, v59
v_mul_f32 v62, v62, v59
v_mul_f32 v63, v63, v59
v_mul_f32 v60, v60, v59
v_mul_f32 v61, v61, v59
v_mul_f32 v62, v62, v59
v_mul_f32 v63, v63, v59
v_accvgpr_write_b32 a108, v60
v_accvgpr_write_b32 a109, v61
v_accvgpr_write_b32 a110, v62
v_accvgpr_write_b32 a111, v63
v_accvgpr_read_b32 v60, a124
v_accvgpr_read_b32 v61, a125
v_accvgpr_read_b32 v62, a126
v_accvgpr_read_b32 v63, a127
v_mul_f32 v60, v60, v59
v_mul_f32 v61, v61, v59
v_mul_f32 v62, v62, v59
v_mul_f32 v63, v63, v59
v_mul_f32 v60, v60, v59
v_mul_f32 v61, v61, v59
v_mul_f32 v62, v62, v59
v_mul_f32 v63, v63, v59
v_accvgpr_write_b32 a124, v60
v_accvgpr_write_b32 a125, v61
v_accvgpr_write_b32 a126, v62
v_accvgpr_write_b32 a127, v63
v_accvgpr_read_b32 v60, a204
v_accvgpr_read_b32 v61, a205
v_accvgpr_read_b32 v62, a206
v_accvgpr_read_b32 v63, a207
v_mul_f32 v60, v60, v59
v_mul_f32 v61, v61, v59
v_mul_f32 v62, v62, v59
v_mul_f32 v63, v63, v59
v_mul_f32 v60, v60, v59
v_mul_f32 v61, v61, v59
v_mul_f32 v62, v62, v59
v_mul_f32 v63, v63, v59
v_accvgpr_write_b32 a204, v60
v_accvgpr_write_b32 a205, v61
v_accvgpr_write_b32 a206, v62
v_accvgpr_write_b32 a207, v63
s_mov_b32 s45, 0
s_nop 1
s_branch L_attn_kernel_rback_a_2
L_attn_kernel_resc_a_3:
s_nop 7
s_nop 7
v_accvgpr_read_b32 v60, a0
v_accvgpr_read_b32 v61, a1
v_accvgpr_read_b32 v62, a2
v_accvgpr_read_b32 v63, a3
v_mul_f32 v60, v60, v56
v_mul_f32 v61, v61, v56
v_mul_f32 v62, v62, v56
v_mul_f32 v63, v63, v56
v_mul_f32 v60, v60, v56
v_mul_f32 v61, v61, v56
v_mul_f32 v62, v62, v56
v_mul_f32 v63, v63, v56
v_accvgpr_write_b32 a0, v60
v_accvgpr_write_b32 a1, v61
v_accvgpr_write_b32 a2, v62
v_accvgpr_write_b32 a3, v63
v_accvgpr_read_b32 v60, a16
v_accvgpr_read_b32 v61, a17
v_accvgpr_read_b32 v62, a18
v_accvgpr_read_b32 v63, a19
v_mul_f32 v60, v60, v56
v_mul_f32 v61, v61, v56
v_mul_f32 v62, v62, v56
v_mul_f32 v63, v63, v56
v_mul_f32 v60, v60, v56
v_mul_f32 v61, v61, v56
v_mul_f32 v62, v62, v56
v_mul_f32 v63, v63, v56
v_accvgpr_write_b32 a16, v60
v_accvgpr_write_b32 a17, v61
v_accvgpr_write_b32 a18, v62
v_accvgpr_write_b32 a19, v63
v_accvgpr_read_b32 v60, a32
v_accvgpr_read_b32 v61, a33
v_accvgpr_read_b32 v62, a34
v_accvgpr_read_b32 v63, a35
v_mul_f32 v60, v60, v56
v_mul_f32 v61, v61, v56
v_mul_f32 v62, v62, v56
v_mul_f32 v63, v63, v56
v_mul_f32 v60, v60, v56
v_mul_f32 v61, v61, v56
v_mul_f32 v62, v62, v56
v_mul_f32 v63, v63, v56
v_accvgpr_write_b32 a32, v60
v_accvgpr_write_b32 a33, v61
v_accvgpr_write_b32 a34, v62
v_accvgpr_write_b32 a35, v63
v_accvgpr_read_b32 v60, a48
v_accvgpr_read_b32 v61, a49
v_accvgpr_read_b32 v62, a50
v_accvgpr_read_b32 v63, a51
v_mul_f32 v60, v60, v56
v_mul_f32 v61, v61, v56
v_mul_f32 v62, v62, v56
v_mul_f32 v63, v63, v56
v_mul_f32 v60, v60, v56
v_mul_f32 v61, v61, v56
v_mul_f32 v62, v62, v56
v_mul_f32 v63, v63, v56
v_accvgpr_write_b32 a48, v60
v_accvgpr_write_b32 a49, v61
v_accvgpr_write_b32 a50, v62
v_accvgpr_write_b32 a51, v63
v_accvgpr_read_b32 v60, a64
v_accvgpr_read_b32 v61, a65
v_accvgpr_read_b32 v62, a66
v_accvgpr_read_b32 v63, a67
v_mul_f32 v60, v60, v56
v_mul_f32 v61, v61, v56
v_mul_f32 v62, v62, v56
v_mul_f32 v63, v63, v56
v_mul_f32 v60, v60, v56
v_mul_f32 v61, v61, v56
v_mul_f32 v62, v62, v56
v_mul_f32 v63, v63, v56
v_accvgpr_write_b32 a64, v60
v_accvgpr_write_b32 a65, v61
v_accvgpr_write_b32 a66, v62
v_accvgpr_write_b32 a67, v63
v_accvgpr_read_b32 v60, a80
v_accvgpr_read_b32 v61, a81
v_accvgpr_read_b32 v62, a82
v_accvgpr_read_b32 v63, a83
v_mul_f32 v60, v60, v56
v_mul_f32 v61, v61, v56
v_mul_f32 v62, v62, v56
v_mul_f32 v63, v63, v56
v_mul_f32 v60, v60, v56
v_mul_f32 v61, v61, v56
v_mul_f32 v62, v62, v56
v_mul_f32 v63, v63, v56
v_accvgpr_write_b32 a80, v60
v_accvgpr_write_b32 a81, v61
v_accvgpr_write_b32 a82, v62
v_accvgpr_write_b32 a83, v63
v_accvgpr_read_b32 v60, a96
v_accvgpr_read_b32 v61, a97
v_accvgpr_read_b32 v62, a98
v_accvgpr_read_b32 v63, a99
v_mul_f32 v60, v60, v56
v_mul_f32 v61, v61, v56
v_mul_f32 v62, v62, v56
v_mul_f32 v63, v63, v56
v_mul_f32 v60, v60, v56
v_mul_f32 v61, v61, v56
v_mul_f32 v62, v62, v56
v_mul_f32 v63, v63, v56
v_accvgpr_write_b32 a96, v60
v_accvgpr_write_b32 a97, v61
v_accvgpr_write_b32 a98, v62
v_accvgpr_write_b32 a99, v63
v_accvgpr_read_b32 v60, a112
v_accvgpr_read_b32 v61, a113
v_accvgpr_read_b32 v62, a114
v_accvgpr_read_b32 v63, a115
v_mul_f32 v60, v60, v56
v_mul_f32 v61, v61, v56
v_mul_f32 v62, v62, v56
v_mul_f32 v63, v63, v56
v_mul_f32 v60, v60, v56
v_mul_f32 v61, v61, v56
v_mul_f32 v62, v62, v56
v_mul_f32 v63, v63, v56
v_accvgpr_write_b32 a112, v60
v_accvgpr_write_b32 a113, v61
v_accvgpr_write_b32 a114, v62
v_accvgpr_write_b32 a115, v63
v_accvgpr_read_b32 v60, a192
v_accvgpr_read_b32 v61, a193
v_accvgpr_read_b32 v62, a194
v_accvgpr_read_b32 v63, a195
v_mul_f32 v60, v60, v56
v_mul_f32 v61, v61, v56
v_mul_f32 v62, v62, v56
v_mul_f32 v63, v63, v56
v_mul_f32 v60, v60, v56
v_mul_f32 v61, v61, v56
v_mul_f32 v62, v62, v56
v_mul_f32 v63, v63, v56
v_accvgpr_write_b32 a192, v60
v_accvgpr_write_b32 a193, v61
v_accvgpr_write_b32 a194, v62
v_accvgpr_write_b32 a195, v63
v_accvgpr_read_b32 v60, a4
v_accvgpr_read_b32 v61, a5
v_accvgpr_read_b32 v62, a6
v_accvgpr_read_b32 v63, a7
v_mul_f32 v60, v60, v57
v_mul_f32 v61, v61, v57
v_mul_f32 v62, v62, v57
v_mul_f32 v63, v63, v57
v_mul_f32 v60, v60, v57
v_mul_f32 v61, v61, v57
v_mul_f32 v62, v62, v57
v_mul_f32 v63, v63, v57
v_accvgpr_write_b32 a4, v60
v_accvgpr_write_b32 a5, v61
v_accvgpr_write_b32 a6, v62
v_accvgpr_write_b32 a7, v63
v_accvgpr_read_b32 v60, a20
v_accvgpr_read_b32 v61, a21
v_accvgpr_read_b32 v62, a22
v_accvgpr_read_b32 v63, a23
v_mul_f32 v60, v60, v57
v_mul_f32 v61, v61, v57
v_mul_f32 v62, v62, v57
v_mul_f32 v63, v63, v57
v_mul_f32 v60, v60, v57
v_mul_f32 v61, v61, v57
v_mul_f32 v62, v62, v57
v_mul_f32 v63, v63, v57
v_accvgpr_write_b32 a20, v60
v_accvgpr_write_b32 a21, v61
v_accvgpr_write_b32 a22, v62
v_accvgpr_write_b32 a23, v63
v_accvgpr_read_b32 v60, a36
v_accvgpr_read_b32 v61, a37
v_accvgpr_read_b32 v62, a38
v_accvgpr_read_b32 v63, a39
v_mul_f32 v60, v60, v57
v_mul_f32 v61, v61, v57
v_mul_f32 v62, v62, v57
v_mul_f32 v63, v63, v57
v_mul_f32 v60, v60, v57
v_mul_f32 v61, v61, v57
v_mul_f32 v62, v62, v57
v_mul_f32 v63, v63, v57
v_accvgpr_write_b32 a36, v60
v_accvgpr_write_b32 a37, v61
v_accvgpr_write_b32 a38, v62
v_accvgpr_write_b32 a39, v63
v_accvgpr_read_b32 v60, a52
v_accvgpr_read_b32 v61, a53
v_accvgpr_read_b32 v62, a54
v_accvgpr_read_b32 v63, a55
v_mul_f32 v60, v60, v57
v_mul_f32 v61, v61, v57
v_mul_f32 v62, v62, v57
v_mul_f32 v63, v63, v57
v_mul_f32 v60, v60, v57
v_mul_f32 v61, v61, v57
v_mul_f32 v62, v62, v57
v_mul_f32 v63, v63, v57
v_accvgpr_write_b32 a52, v60
v_accvgpr_write_b32 a53, v61
v_accvgpr_write_b32 a54, v62
v_accvgpr_write_b32 a55, v63
v_accvgpr_read_b32 v60, a68
v_accvgpr_read_b32 v61, a69
v_accvgpr_read_b32 v62, a70
v_accvgpr_read_b32 v63, a71
v_mul_f32 v60, v60, v57
v_mul_f32 v61, v61, v57
v_mul_f32 v62, v62, v57
v_mul_f32 v63, v63, v57
v_mul_f32 v60, v60, v57
v_mul_f32 v61, v61, v57
v_mul_f32 v62, v62, v57
v_mul_f32 v63, v63, v57
v_accvgpr_write_b32 a68, v60
v_accvgpr_write_b32 a69, v61
v_accvgpr_write_b32 a70, v62
v_accvgpr_write_b32 a71, v63
v_accvgpr_read_b32 v60, a84
v_accvgpr_read_b32 v61, a85
v_accvgpr_read_b32 v62, a86
v_accvgpr_read_b32 v63, a87
v_mul_f32 v60, v60, v57
v_mul_f32 v61, v61, v57
v_mul_f32 v62, v62, v57
v_mul_f32 v63, v63, v57
v_mul_f32 v60, v60, v57
v_mul_f32 v61, v61, v57
v_mul_f32 v62, v62, v57
v_mul_f32 v63, v63, v57
v_accvgpr_write_b32 a84, v60
v_accvgpr_write_b32 a85, v61
v_accvgpr_write_b32 a86, v62
v_accvgpr_write_b32 a87, v63
v_accvgpr_read_b32 v60, a100
v_accvgpr_read_b32 v61, a101
v_accvgpr_read_b32 v62, a102
v_accvgpr_read_b32 v63, a103
v_mul_f32 v60, v60, v57
v_mul_f32 v61, v61, v57
v_mul_f32 v62, v62, v57
v_mul_f32 v63, v63, v57
v_mul_f32 v60, v60, v57
v_mul_f32 v61, v61, v57
v_mul_f32 v62, v62, v57
v_mul_f32 v63, v63, v57
v_accvgpr_write_b32 a100, v60
v_accvgpr_write_b32 a101, v61
v_accvgpr_write_b32 a102, v62
v_accvgpr_write_b32 a103, v63
v_accvgpr_read_b32 v60, a116
v_accvgpr_read_b32 v61, a117
v_accvgpr_read_b32 v62, a118
v_accvgpr_read_b32 v63, a119
v_mul_f32 v60, v60, v57
v_mul_f32 v61, v61, v57
v_mul_f32 v62, v62, v57
v_mul_f32 v63, v63, v57
v_mul_f32 v60, v60, v57
v_mul_f32 v61, v61, v57
v_mul_f32 v62, v62, v57
v_mul_f32 v63, v63, v57
v_accvgpr_write_b32 a116, v60
v_accvgpr_write_b32 a117, v61
v_accvgpr_write_b32 a118, v62
v_accvgpr_write_b32 a119, v63
v_accvgpr_read_b32 v60, a196
v_accvgpr_read_b32 v61, a197
v_accvgpr_read_b32 v62, a198
v_accvgpr_read_b32 v63, a199
v_mul_f32 v60, v60, v57
v_mul_f32 v61, v61, v57
v_mul_f32 v62, v62, v57
v_mul_f32 v63, v63, v57
v_mul_f32 v60, v60, v57
v_mul_f32 v61, v61, v57
v_mul_f32 v62, v62, v57
v_mul_f32 v63, v63, v57
v_accvgpr_write_b32 a196, v60
v_accvgpr_write_b32 a197, v61
v_accvgpr_write_b32 a198, v62
v_accvgpr_write_b32 a199, v63
v_accvgpr_read_b32 v60, a8
v_accvgpr_read_b32 v61, a9
v_accvgpr_read_b32 v62, a10
v_accvgpr_read_b32 v63, a11
v_mul_f32 v60, v60, v58
v_mul_f32 v61, v61, v58
v_mul_f32 v62, v62, v58
v_mul_f32 v63, v63, v58
v_mul_f32 v60, v60, v58
v_mul_f32 v61, v61, v58
v_mul_f32 v62, v62, v58
v_mul_f32 v63, v63, v58
v_accvgpr_write_b32 a8, v60
v_accvgpr_write_b32 a9, v61
v_accvgpr_write_b32 a10, v62
v_accvgpr_write_b32 a11, v63
v_accvgpr_read_b32 v60, a24
v_accvgpr_read_b32 v61, a25
v_accvgpr_read_b32 v62, a26
v_accvgpr_read_b32 v63, a27
v_mul_f32 v60, v60, v58
v_mul_f32 v61, v61, v58
v_mul_f32 v62, v62, v58
v_mul_f32 v63, v63, v58
v_mul_f32 v60, v60, v58
v_mul_f32 v61, v61, v58
v_mul_f32 v62, v62, v58
v_mul_f32 v63, v63, v58
v_accvgpr_write_b32 a24, v60
v_accvgpr_write_b32 a25, v61
v_accvgpr_write_b32 a26, v62
v_accvgpr_write_b32 a27, v63
v_accvgpr_read_b32 v60, a40
v_accvgpr_read_b32 v61, a41
v_accvgpr_read_b32 v62, a42
v_accvgpr_read_b32 v63, a43
v_mul_f32 v60, v60, v58
v_mul_f32 v61, v61, v58
v_mul_f32 v62, v62, v58
v_mul_f32 v63, v63, v58
v_mul_f32 v60, v60, v58
v_mul_f32 v61, v61, v58
v_mul_f32 v62, v62, v58
v_mul_f32 v63, v63, v58
v_accvgpr_write_b32 a40, v60
v_accvgpr_write_b32 a41, v61
v_accvgpr_write_b32 a42, v62
v_accvgpr_write_b32 a43, v63
v_accvgpr_read_b32 v60, a56
v_accvgpr_read_b32 v61, a57
v_accvgpr_read_b32 v62, a58
v_accvgpr_read_b32 v63, a59
v_mul_f32 v60, v60, v58
v_mul_f32 v61, v61, v58
v_mul_f32 v62, v62, v58
v_mul_f32 v63, v63, v58
v_mul_f32 v60, v60, v58
v_mul_f32 v61, v61, v58
v_mul_f32 v62, v62, v58
v_mul_f32 v63, v63, v58
v_accvgpr_write_b32 a56, v60
v_accvgpr_write_b32 a57, v61
v_accvgpr_write_b32 a58, v62
v_accvgpr_write_b32 a59, v63
v_accvgpr_read_b32 v60, a72
v_accvgpr_read_b32 v61, a73
v_accvgpr_read_b32 v62, a74
v_accvgpr_read_b32 v63, a75
v_mul_f32 v60, v60, v58
v_mul_f32 v61, v61, v58
v_mul_f32 v62, v62, v58
v_mul_f32 v63, v63, v58
v_mul_f32 v60, v60, v58
v_mul_f32 v61, v61, v58
v_mul_f32 v62, v62, v58
v_mul_f32 v63, v63, v58
v_accvgpr_write_b32 a72, v60
v_accvgpr_write_b32 a73, v61
v_accvgpr_write_b32 a74, v62
v_accvgpr_write_b32 a75, v63
v_accvgpr_read_b32 v60, a88
v_accvgpr_read_b32 v61, a89
v_accvgpr_read_b32 v62, a90
v_accvgpr_read_b32 v63, a91
v_mul_f32 v60, v60, v58
v_mul_f32 v61, v61, v58
v_mul_f32 v62, v62, v58
v_mul_f32 v63, v63, v58
v_mul_f32 v60, v60, v58
v_mul_f32 v61, v61, v58
v_mul_f32 v62, v62, v58
v_mul_f32 v63, v63, v58
v_accvgpr_write_b32 a88, v60
v_accvgpr_write_b32 a89, v61
v_accvgpr_write_b32 a90, v62
v_accvgpr_write_b32 a91, v63
v_accvgpr_read_b32 v60, a104
v_accvgpr_read_b32 v61, a105
v_accvgpr_read_b32 v62, a106
v_accvgpr_read_b32 v63, a107
v_mul_f32 v60, v60, v58
v_mul_f32 v61, v61, v58
v_mul_f32 v62, v62, v58
v_mul_f32 v63, v63, v58
v_mul_f32 v60, v60, v58
v_mul_f32 v61, v61, v58
v_mul_f32 v62, v62, v58
v_mul_f32 v63, v63, v58
v_accvgpr_write_b32 a104, v60
v_accvgpr_write_b32 a105, v61
v_accvgpr_write_b32 a106, v62
v_accvgpr_write_b32 a107, v63
v_accvgpr_read_b32 v60, a120
v_accvgpr_read_b32 v61, a121
v_accvgpr_read_b32 v62, a122
v_accvgpr_read_b32 v63, a123
v_mul_f32 v60, v60, v58
v_mul_f32 v61, v61, v58
v_mul_f32 v62, v62, v58
v_mul_f32 v63, v63, v58
v_mul_f32 v60, v60, v58
v_mul_f32 v61, v61, v58
v_mul_f32 v62, v62, v58
v_mul_f32 v63, v63, v58
v_accvgpr_write_b32 a120, v60
v_accvgpr_write_b32 a121, v61
v_accvgpr_write_b32 a122, v62
v_accvgpr_write_b32 a123, v63
v_accvgpr_read_b32 v60, a200
v_accvgpr_read_b32 v61, a201
v_accvgpr_read_b32 v62, a202
v_accvgpr_read_b32 v63, a203
v_mul_f32 v60, v60, v58
v_mul_f32 v61, v61, v58
v_mul_f32 v62, v62, v58
v_mul_f32 v63, v63, v58
v_mul_f32 v60, v60, v58
v_mul_f32 v61, v61, v58
v_mul_f32 v62, v62, v58
v_mul_f32 v63, v63, v58
v_accvgpr_write_b32 a200, v60
v_accvgpr_write_b32 a201, v61
v_accvgpr_write_b32 a202, v62
v_accvgpr_write_b32 a203, v63
v_accvgpr_read_b32 v60, a12
v_accvgpr_read_b32 v61, a13
v_accvgpr_read_b32 v62, a14
v_accvgpr_read_b32 v63, a15
v_mul_f32 v60, v60, v59
v_mul_f32 v61, v61, v59
v_mul_f32 v62, v62, v59
v_mul_f32 v63, v63, v59
v_mul_f32 v60, v60, v59
v_mul_f32 v61, v61, v59
v_mul_f32 v62, v62, v59
v_mul_f32 v63, v63, v59
v_accvgpr_write_b32 a12, v60
v_accvgpr_write_b32 a13, v61
v_accvgpr_write_b32 a14, v62
v_accvgpr_write_b32 a15, v63
v_accvgpr_read_b32 v60, a28
v_accvgpr_read_b32 v61, a29
v_accvgpr_read_b32 v62, a30
v_accvgpr_read_b32 v63, a31
v_mul_f32 v60, v60, v59
v_mul_f32 v61, v61, v59
v_mul_f32 v62, v62, v59
v_mul_f32 v63, v63, v59
v_mul_f32 v60, v60, v59
v_mul_f32 v61, v61, v59
v_mul_f32 v62, v62, v59
v_mul_f32 v63, v63, v59
v_accvgpr_write_b32 a28, v60
v_accvgpr_write_b32 a29, v61
v_accvgpr_write_b32 a30, v62
v_accvgpr_write_b32 a31, v63
v_accvgpr_read_b32 v60, a44
v_accvgpr_read_b32 v61, a45
v_accvgpr_read_b32 v62, a46
v_accvgpr_read_b32 v63, a47
v_mul_f32 v60, v60, v59
v_mul_f32 v61, v61, v59
v_mul_f32 v62, v62, v59
v_mul_f32 v63, v63, v59
v_mul_f32 v60, v60, v59
v_mul_f32 v61, v61, v59
v_mul_f32 v62, v62, v59
v_mul_f32 v63, v63, v59
v_accvgpr_write_b32 a44, v60
v_accvgpr_write_b32 a45, v61
v_accvgpr_write_b32 a46, v62
v_accvgpr_write_b32 a47, v63
v_accvgpr_read_b32 v60, a60
v_accvgpr_read_b32 v61, a61
v_accvgpr_read_b32 v62, a62
v_accvgpr_read_b32 v63, a63
v_mul_f32 v60, v60, v59
v_mul_f32 v61, v61, v59
v_mul_f32 v62, v62, v59
v_mul_f32 v63, v63, v59
v_mul_f32 v60, v60, v59
v_mul_f32 v61, v61, v59
v_mul_f32 v62, v62, v59
v_mul_f32 v63, v63, v59
v_accvgpr_write_b32 a60, v60
v_accvgpr_write_b32 a61, v61
v_accvgpr_write_b32 a62, v62
v_accvgpr_write_b32 a63, v63
v_accvgpr_read_b32 v60, a76
v_accvgpr_read_b32 v61, a77
v_accvgpr_read_b32 v62, a78
v_accvgpr_read_b32 v63, a79
v_mul_f32 v60, v60, v59
v_mul_f32 v61, v61, v59
v_mul_f32 v62, v62, v59
v_mul_f32 v63, v63, v59
v_mul_f32 v60, v60, v59
v_mul_f32 v61, v61, v59
v_mul_f32 v62, v62, v59
v_mul_f32 v63, v63, v59
v_accvgpr_write_b32 a76, v60
v_accvgpr_write_b32 a77, v61
v_accvgpr_write_b32 a78, v62
v_accvgpr_write_b32 a79, v63
v_accvgpr_read_b32 v60, a92
v_accvgpr_read_b32 v61, a93
v_accvgpr_read_b32 v62, a94
v_accvgpr_read_b32 v63, a95
v_mul_f32 v60, v60, v59
v_mul_f32 v61, v61, v59
v_mul_f32 v62, v62, v59
v_mul_f32 v63, v63, v59
v_mul_f32 v60, v60, v59
v_mul_f32 v61, v61, v59
v_mul_f32 v62, v62, v59
v_mul_f32 v63, v63, v59
v_accvgpr_write_b32 a92, v60
v_accvgpr_write_b32 a93, v61
v_accvgpr_write_b32 a94, v62
v_accvgpr_write_b32 a95, v63
v_accvgpr_read_b32 v60, a108
v_accvgpr_read_b32 v61, a109
v_accvgpr_read_b32 v62, a110
v_accvgpr_read_b32 v63, a111
v_mul_f32 v60, v60, v59
v_mul_f32 v61, v61, v59
v_mul_f32 v62, v62, v59
v_mul_f32 v63, v63, v59
v_mul_f32 v60, v60, v59
v_mul_f32 v61, v61, v59
v_mul_f32 v62, v62, v59
v_mul_f32 v63, v63, v59
v_accvgpr_write_b32 a108, v60
v_accvgpr_write_b32 a109, v61
v_accvgpr_write_b32 a110, v62
v_accvgpr_write_b32 a111, v63
v_accvgpr_read_b32 v60, a124
v_accvgpr_read_b32 v61, a125
v_accvgpr_read_b32 v62, a126
v_accvgpr_read_b32 v63, a127
v_mul_f32 v60, v60, v59
v_mul_f32 v61, v61, v59
v_mul_f32 v62, v62, v59
v_mul_f32 v63, v63, v59
v_mul_f32 v60, v60, v59
v_mul_f32 v61, v61, v59
v_mul_f32 v62, v62, v59
v_mul_f32 v63, v63, v59
v_accvgpr_write_b32 a124, v60
v_accvgpr_write_b32 a125, v61
v_accvgpr_write_b32 a126, v62
v_accvgpr_write_b32 a127, v63
v_accvgpr_read_b32 v60, a204
v_accvgpr_read_b32 v61, a205
v_accvgpr_read_b32 v62, a206
v_accvgpr_read_b32 v63, a207
v_mul_f32 v60, v60, v59
v_mul_f32 v61, v61, v59
v_mul_f32 v62, v62, v59
v_mul_f32 v63, v63, v59
v_mul_f32 v60, v60, v59
v_mul_f32 v61, v61, v59
v_mul_f32 v62, v62, v59
v_mul_f32 v63, v63, v59
v_accvgpr_write_b32 a204, v60
v_accvgpr_write_b32 a205, v61
v_accvgpr_write_b32 a206, v62
v_accvgpr_write_b32 a207, v63
s_mov_b32 s45, 0
s_nop 1
s_branch L_attn_kernel_rback_a_3
L_attn_kernel_resc_c_0:
s_nop 7
s_nop 7
v_accvgpr_read_b32 v60, a0
v_accvgpr_read_b32 v61, a1
v_accvgpr_read_b32 v62, a2
v_accvgpr_read_b32 v63, a3
v_mul_f32 v60, v60, v56
v_mul_f32 v61, v61, v56
v_mul_f32 v62, v62, v56
v_mul_f32 v63, v63, v56
v_mul_f32 v60, v60, v56
v_mul_f32 v61, v61, v56
v_mul_f32 v62, v62, v56
v_mul_f32 v63, v63, v56
v_accvgpr_write_b32 a0, v60
v_accvgpr_write_b32 a1, v61
v_accvgpr_write_b32 a2, v62
v_accvgpr_write_b32 a3, v63
v_accvgpr_read_b32 v60, a16
v_accvgpr_read_b32 v61, a17
v_accvgpr_read_b32 v62, a18
v_accvgpr_read_b32 v63, a19
v_mul_f32 v60, v60, v56
v_mul_f32 v61, v61, v56
v_mul_f32 v62, v62, v56
v_mul_f32 v63, v63, v56
v_mul_f32 v60, v60, v56
v_mul_f32 v61, v61, v56
v_mul_f32 v62, v62, v56
v_mul_f32 v63, v63, v56
v_accvgpr_write_b32 a16, v60
v_accvgpr_write_b32 a17, v61
v_accvgpr_write_b32 a18, v62
v_accvgpr_write_b32 a19, v63
v_accvgpr_read_b32 v60, a32
v_accvgpr_read_b32 v61, a33
v_accvgpr_read_b32 v62, a34
v_accvgpr_read_b32 v63, a35
v_mul_f32 v60, v60, v56
v_mul_f32 v61, v61, v56
v_mul_f32 v62, v62, v56
v_mul_f32 v63, v63, v56
v_mul_f32 v60, v60, v56
v_mul_f32 v61, v61, v56
v_mul_f32 v62, v62, v56
v_mul_f32 v63, v63, v56
v_accvgpr_write_b32 a32, v60
v_accvgpr_write_b32 a33, v61
v_accvgpr_write_b32 a34, v62
v_accvgpr_write_b32 a35, v63
v_accvgpr_read_b32 v60, a48
v_accvgpr_read_b32 v61, a49
v_accvgpr_read_b32 v62, a50
v_accvgpr_read_b32 v63, a51
v_mul_f32 v60, v60, v56
v_mul_f32 v61, v61, v56
v_mul_f32 v62, v62, v56
v_mul_f32 v63, v63, v56
v_mul_f32 v60, v60, v56
v_mul_f32 v61, v61, v56
v_mul_f32 v62, v62, v56
v_mul_f32 v63, v63, v56
v_accvgpr_write_b32 a48, v60
v_accvgpr_write_b32 a49, v61
v_accvgpr_write_b32 a50, v62
v_accvgpr_write_b32 a51, v63
v_accvgpr_read_b32 v60, a64
v_accvgpr_read_b32 v61, a65
v_accvgpr_read_b32 v62, a66
v_accvgpr_read_b32 v63, a67
v_mul_f32 v60, v60, v56
v_mul_f32 v61, v61, v56
v_mul_f32 v62, v62, v56
v_mul_f32 v63, v63, v56
v_mul_f32 v60, v60, v56
v_mul_f32 v61, v61, v56
v_mul_f32 v62, v62, v56
v_mul_f32 v63, v63, v56
v_accvgpr_write_b32 a64, v60
v_accvgpr_write_b32 a65, v61
v_accvgpr_write_b32 a66, v62
v_accvgpr_write_b32 a67, v63
v_accvgpr_read_b32 v60, a80
v_accvgpr_read_b32 v61, a81
v_accvgpr_read_b32 v62, a82
v_accvgpr_read_b32 v63, a83
v_mul_f32 v60, v60, v56
v_mul_f32 v61, v61, v56
v_mul_f32 v62, v62, v56
v_mul_f32 v63, v63, v56
v_mul_f32 v60, v60, v56
v_mul_f32 v61, v61, v56
v_mul_f32 v62, v62, v56
v_mul_f32 v63, v63, v56
v_accvgpr_write_b32 a80, v60
v_accvgpr_write_b32 a81, v61
v_accvgpr_write_b32 a82, v62
v_accvgpr_write_b32 a83, v63
v_accvgpr_read_b32 v60, a96
v_accvgpr_read_b32 v61, a97
v_accvgpr_read_b32 v62, a98
v_accvgpr_read_b32 v63, a99
v_mul_f32 v60, v60, v56
v_mul_f32 v61, v61, v56
v_mul_f32 v62, v62, v56
v_mul_f32 v63, v63, v56
v_mul_f32 v60, v60, v56
v_mul_f32 v61, v61, v56
v_mul_f32 v62, v62, v56
v_mul_f32 v63, v63, v56
v_accvgpr_write_b32 a96, v60
v_accvgpr_write_b32 a97, v61
v_accvgpr_write_b32 a98, v62
v_accvgpr_write_b32 a99, v63
v_accvgpr_read_b32 v60, a112
v_accvgpr_read_b32 v61, a113
v_accvgpr_read_b32 v62, a114
v_accvgpr_read_b32 v63, a115
v_mul_f32 v60, v60, v56
v_mul_f32 v61, v61, v56
v_mul_f32 v62, v62, v56
v_mul_f32 v63, v63, v56
v_mul_f32 v60, v60, v56
v_mul_f32 v61, v61, v56
v_mul_f32 v62, v62, v56
v_mul_f32 v63, v63, v56
v_accvgpr_write_b32 a112, v60
v_accvgpr_write_b32 a113, v61
v_accvgpr_write_b32 a114, v62
v_accvgpr_write_b32 a115, v63
v_accvgpr_read_b32 v60, a192
v_accvgpr_read_b32 v61, a193
v_accvgpr_read_b32 v62, a194
v_accvgpr_read_b32 v63, a195
v_mul_f32 v60, v60, v56
v_mul_f32 v61, v61, v56
v_mul_f32 v62, v62, v56
v_mul_f32 v63, v63, v56
v_mul_f32 v60, v60, v56
v_mul_f32 v61, v61, v56
v_mul_f32 v62, v62, v56
v_mul_f32 v63, v63, v56
v_accvgpr_write_b32 a192, v60
v_accvgpr_write_b32 a193, v61
v_accvgpr_write_b32 a194, v62
v_accvgpr_write_b32 a195, v63
v_accvgpr_read_b32 v60, a4
v_accvgpr_read_b32 v61, a5
v_accvgpr_read_b32 v62, a6
v_accvgpr_read_b32 v63, a7
v_mul_f32 v60, v60, v57
v_mul_f32 v61, v61, v57
v_mul_f32 v62, v62, v57
v_mul_f32 v63, v63, v57
v_mul_f32 v60, v60, v57
v_mul_f32 v61, v61, v57
v_mul_f32 v62, v62, v57
v_mul_f32 v63, v63, v57
v_accvgpr_write_b32 a4, v60
v_accvgpr_write_b32 a5, v61
v_accvgpr_write_b32 a6, v62
v_accvgpr_write_b32 a7, v63
v_accvgpr_read_b32 v60, a20
v_accvgpr_read_b32 v61, a21
v_accvgpr_read_b32 v62, a22
v_accvgpr_read_b32 v63, a23
v_mul_f32 v60, v60, v57
v_mul_f32 v61, v61, v57
v_mul_f32 v62, v62, v57
v_mul_f32 v63, v63, v57
v_mul_f32 v60, v60, v57
v_mul_f32 v61, v61, v57
v_mul_f32 v62, v62, v57
v_mul_f32 v63, v63, v57
v_accvgpr_write_b32 a20, v60
v_accvgpr_write_b32 a21, v61
v_accvgpr_write_b32 a22, v62
v_accvgpr_write_b32 a23, v63
v_accvgpr_read_b32 v60, a36
v_accvgpr_read_b32 v61, a37
v_accvgpr_read_b32 v62, a38
v_accvgpr_read_b32 v63, a39
v_mul_f32 v60, v60, v57
v_mul_f32 v61, v61, v57
v_mul_f32 v62, v62, v57
v_mul_f32 v63, v63, v57
v_mul_f32 v60, v60, v57
v_mul_f32 v61, v61, v57
v_mul_f32 v62, v62, v57
v_mul_f32 v63, v63, v57
v_accvgpr_write_b32 a36, v60
v_accvgpr_write_b32 a37, v61
v_accvgpr_write_b32 a38, v62
v_accvgpr_write_b32 a39, v63
v_accvgpr_read_b32 v60, a52
v_accvgpr_read_b32 v61, a53
v_accvgpr_read_b32 v62, a54
v_accvgpr_read_b32 v63, a55
v_mul_f32 v60, v60, v57
v_mul_f32 v61, v61, v57
v_mul_f32 v62, v62, v57
v_mul_f32 v63, v63, v57
v_mul_f32 v60, v60, v57
v_mul_f32 v61, v61, v57
v_mul_f32 v62, v62, v57
v_mul_f32 v63, v63, v57
v_accvgpr_write_b32 a52, v60
v_accvgpr_write_b32 a53, v61
v_accvgpr_write_b32 a54, v62
v_accvgpr_write_b32 a55, v63
v_accvgpr_read_b32 v60, a68
v_accvgpr_read_b32 v61, a69
v_accvgpr_read_b32 v62, a70
v_accvgpr_read_b32 v63, a71
v_mul_f32 v60, v60, v57
v_mul_f32 v61, v61, v57
v_mul_f32 v62, v62, v57
v_mul_f32 v63, v63, v57
v_mul_f32 v60, v60, v57
v_mul_f32 v61, v61, v57
v_mul_f32 v62, v62, v57
v_mul_f32 v63, v63, v57
v_accvgpr_write_b32 a68, v60
v_accvgpr_write_b32 a69, v61
v_accvgpr_write_b32 a70, v62
v_accvgpr_write_b32 a71, v63
v_accvgpr_read_b32 v60, a84
v_accvgpr_read_b32 v61, a85
v_accvgpr_read_b32 v62, a86
v_accvgpr_read_b32 v63, a87
v_mul_f32 v60, v60, v57
v_mul_f32 v61, v61, v57
v_mul_f32 v62, v62, v57
v_mul_f32 v63, v63, v57
v_mul_f32 v60, v60, v57
v_mul_f32 v61, v61, v57
v_mul_f32 v62, v62, v57
v_mul_f32 v63, v63, v57
v_accvgpr_write_b32 a84, v60
v_accvgpr_write_b32 a85, v61
v_accvgpr_write_b32 a86, v62
v_accvgpr_write_b32 a87, v63
v_accvgpr_read_b32 v60, a100
v_accvgpr_read_b32 v61, a101
v_accvgpr_read_b32 v62, a102
v_accvgpr_read_b32 v63, a103
v_mul_f32 v60, v60, v57
v_mul_f32 v61, v61, v57
v_mul_f32 v62, v62, v57
v_mul_f32 v63, v63, v57
v_mul_f32 v60, v60, v57
v_mul_f32 v61, v61, v57
v_mul_f32 v62, v62, v57
v_mul_f32 v63, v63, v57
v_accvgpr_write_b32 a100, v60
v_accvgpr_write_b32 a101, v61
v_accvgpr_write_b32 a102, v62
v_accvgpr_write_b32 a103, v63
v_accvgpr_read_b32 v60, a116
v_accvgpr_read_b32 v61, a117
v_accvgpr_read_b32 v62, a118
v_accvgpr_read_b32 v63, a119
v_mul_f32 v60, v60, v57
v_mul_f32 v61, v61, v57
v_mul_f32 v62, v62, v57
v_mul_f32 v63, v63, v57
v_mul_f32 v60, v60, v57
v_mul_f32 v61, v61, v57
v_mul_f32 v62, v62, v57
v_mul_f32 v63, v63, v57
v_accvgpr_write_b32 a116, v60
v_accvgpr_write_b32 a117, v61
v_accvgpr_write_b32 a118, v62
v_accvgpr_write_b32 a119, v63
v_accvgpr_read_b32 v60, a196
v_accvgpr_read_b32 v61, a197
v_accvgpr_read_b32 v62, a198
v_accvgpr_read_b32 v63, a199
v_mul_f32 v60, v60, v57
v_mul_f32 v61, v61, v57
v_mul_f32 v62, v62, v57
v_mul_f32 v63, v63, v57
v_mul_f32 v60, v60, v57
v_mul_f32 v61, v61, v57
v_mul_f32 v62, v62, v57
v_mul_f32 v63, v63, v57
v_accvgpr_write_b32 a196, v60
v_accvgpr_write_b32 a197, v61
v_accvgpr_write_b32 a198, v62
v_accvgpr_write_b32 a199, v63
v_accvgpr_read_b32 v60, a8
v_accvgpr_read_b32 v61, a9
v_accvgpr_read_b32 v62, a10
v_accvgpr_read_b32 v63, a11
v_mul_f32 v60, v60, v58
v_mul_f32 v61, v61, v58
v_mul_f32 v62, v62, v58
v_mul_f32 v63, v63, v58
v_mul_f32 v60, v60, v58
v_mul_f32 v61, v61, v58
v_mul_f32 v62, v62, v58
v_mul_f32 v63, v63, v58
v_accvgpr_write_b32 a8, v60
v_accvgpr_write_b32 a9, v61
v_accvgpr_write_b32 a10, v62
v_accvgpr_write_b32 a11, v63
v_accvgpr_read_b32 v60, a24
v_accvgpr_read_b32 v61, a25
v_accvgpr_read_b32 v62, a26
v_accvgpr_read_b32 v63, a27
v_mul_f32 v60, v60, v58
v_mul_f32 v61, v61, v58
v_mul_f32 v62, v62, v58
v_mul_f32 v63, v63, v58
v_mul_f32 v60, v60, v58
v_mul_f32 v61, v61, v58
v_mul_f32 v62, v62, v58
v_mul_f32 v63, v63, v58
v_accvgpr_write_b32 a24, v60
v_accvgpr_write_b32 a25, v61
v_accvgpr_write_b32 a26, v62
v_accvgpr_write_b32 a27, v63
v_accvgpr_read_b32 v60, a40
v_accvgpr_read_b32 v61, a41
v_accvgpr_read_b32 v62, a42
v_accvgpr_read_b32 v63, a43
v_mul_f32 v60, v60, v58
v_mul_f32 v61, v61, v58
v_mul_f32 v62, v62, v58
v_mul_f32 v63, v63, v58
v_mul_f32 v60, v60, v58
v_mul_f32 v61, v61, v58
v_mul_f32 v62, v62, v58
v_mul_f32 v63, v63, v58
v_accvgpr_write_b32 a40, v60
v_accvgpr_write_b32 a41, v61
v_accvgpr_write_b32 a42, v62
v_accvgpr_write_b32 a43, v63
v_accvgpr_read_b32 v60, a56
v_accvgpr_read_b32 v61, a57
v_accvgpr_read_b32 v62, a58
v_accvgpr_read_b32 v63, a59
v_mul_f32 v60, v60, v58
v_mul_f32 v61, v61, v58
v_mul_f32 v62, v62, v58
v_mul_f32 v63, v63, v58
v_mul_f32 v60, v60, v58
v_mul_f32 v61, v61, v58
v_mul_f32 v62, v62, v58
v_mul_f32 v63, v63, v58
v_accvgpr_write_b32 a56, v60
v_accvgpr_write_b32 a57, v61
v_accvgpr_write_b32 a58, v62
v_accvgpr_write_b32 a59, v63
v_accvgpr_read_b32 v60, a72
v_accvgpr_read_b32 v61, a73
v_accvgpr_read_b32 v62, a74
v_accvgpr_read_b32 v63, a75
v_mul_f32 v60, v60, v58
v_mul_f32 v61, v61, v58
v_mul_f32 v62, v62, v58
v_mul_f32 v63, v63, v58
v_mul_f32 v60, v60, v58
v_mul_f32 v61, v61, v58
v_mul_f32 v62, v62, v58
v_mul_f32 v63, v63, v58
v_accvgpr_write_b32 a72, v60
v_accvgpr_write_b32 a73, v61
v_accvgpr_write_b32 a74, v62
v_accvgpr_write_b32 a75, v63
v_accvgpr_read_b32 v60, a88
v_accvgpr_read_b32 v61, a89
v_accvgpr_read_b32 v62, a90
v_accvgpr_read_b32 v63, a91
v_mul_f32 v60, v60, v58
v_mul_f32 v61, v61, v58
v_mul_f32 v62, v62, v58
v_mul_f32 v63, v63, v58
v_mul_f32 v60, v60, v58
v_mul_f32 v61, v61, v58
v_mul_f32 v62, v62, v58
v_mul_f32 v63, v63, v58
v_accvgpr_write_b32 a88, v60
v_accvgpr_write_b32 a89, v61
v_accvgpr_write_b32 a90, v62
v_accvgpr_write_b32 a91, v63
v_accvgpr_read_b32 v60, a104
v_accvgpr_read_b32 v61, a105
v_accvgpr_read_b32 v62, a106
v_accvgpr_read_b32 v63, a107
v_mul_f32 v60, v60, v58
v_mul_f32 v61, v61, v58
v_mul_f32 v62, v62, v58
v_mul_f32 v63, v63, v58
v_mul_f32 v60, v60, v58
v_mul_f32 v61, v61, v58
v_mul_f32 v62, v62, v58
v_mul_f32 v63, v63, v58
v_accvgpr_write_b32 a104, v60
v_accvgpr_write_b32 a105, v61
v_accvgpr_write_b32 a106, v62
v_accvgpr_write_b32 a107, v63
v_accvgpr_read_b32 v60, a120
v_accvgpr_read_b32 v61, a121
v_accvgpr_read_b32 v62, a122
v_accvgpr_read_b32 v63, a123
v_mul_f32 v60, v60, v58
v_mul_f32 v61, v61, v58
v_mul_f32 v62, v62, v58
v_mul_f32 v63, v63, v58
v_mul_f32 v60, v60, v58
v_mul_f32 v61, v61, v58
v_mul_f32 v62, v62, v58
v_mul_f32 v63, v63, v58
v_accvgpr_write_b32 a120, v60
v_accvgpr_write_b32 a121, v61
v_accvgpr_write_b32 a122, v62
v_accvgpr_write_b32 a123, v63
v_accvgpr_read_b32 v60, a200
v_accvgpr_read_b32 v61, a201
v_accvgpr_read_b32 v62, a202
v_accvgpr_read_b32 v63, a203
v_mul_f32 v60, v60, v58
v_mul_f32 v61, v61, v58
v_mul_f32 v62, v62, v58
v_mul_f32 v63, v63, v58
v_mul_f32 v60, v60, v58
v_mul_f32 v61, v61, v58
v_mul_f32 v62, v62, v58
v_mul_f32 v63, v63, v58
v_accvgpr_write_b32 a200, v60
v_accvgpr_write_b32 a201, v61
v_accvgpr_write_b32 a202, v62
v_accvgpr_write_b32 a203, v63
v_accvgpr_read_b32 v60, a12
v_accvgpr_read_b32 v61, a13
v_accvgpr_read_b32 v62, a14
v_accvgpr_read_b32 v63, a15
v_mul_f32 v60, v60, v59
v_mul_f32 v61, v61, v59
v_mul_f32 v62, v62, v59
v_mul_f32 v63, v63, v59
v_mul_f32 v60, v60, v59
v_mul_f32 v61, v61, v59
v_mul_f32 v62, v62, v59
v_mul_f32 v63, v63, v59
v_accvgpr_write_b32 a12, v60
v_accvgpr_write_b32 a13, v61
v_accvgpr_write_b32 a14, v62
v_accvgpr_write_b32 a15, v63
v_accvgpr_read_b32 v60, a28
v_accvgpr_read_b32 v61, a29
v_accvgpr_read_b32 v62, a30
v_accvgpr_read_b32 v63, a31
v_mul_f32 v60, v60, v59
v_mul_f32 v61, v61, v59
v_mul_f32 v62, v62, v59
v_mul_f32 v63, v63, v59
v_mul_f32 v60, v60, v59
v_mul_f32 v61, v61, v59
v_mul_f32 v62, v62, v59
v_mul_f32 v63, v63, v59
v_accvgpr_write_b32 a28, v60
v_accvgpr_write_b32 a29, v61
v_accvgpr_write_b32 a30, v62
v_accvgpr_write_b32 a31, v63
v_accvgpr_read_b32 v60, a44
v_accvgpr_read_b32 v61, a45
v_accvgpr_read_b32 v62, a46
v_accvgpr_read_b32 v63, a47
v_mul_f32 v60, v60, v59
v_mul_f32 v61, v61, v59
v_mul_f32 v62, v62, v59
v_mul_f32 v63, v63, v59
v_mul_f32 v60, v60, v59
v_mul_f32 v61, v61, v59
v_mul_f32 v62, v62, v59
v_mul_f32 v63, v63, v59
v_accvgpr_write_b32 a44, v60
v_accvgpr_write_b32 a45, v61
v_accvgpr_write_b32 a46, v62
v_accvgpr_write_b32 a47, v63
v_accvgpr_read_b32 v60, a60
v_accvgpr_read_b32 v61, a61
v_accvgpr_read_b32 v62, a62
v_accvgpr_read_b32 v63, a63
v_mul_f32 v60, v60, v59
v_mul_f32 v61, v61, v59
v_mul_f32 v62, v62, v59
v_mul_f32 v63, v63, v59
v_mul_f32 v60, v60, v59
v_mul_f32 v61, v61, v59
v_mul_f32 v62, v62, v59
v_mul_f32 v63, v63, v59
v_accvgpr_write_b32 a60, v60
v_accvgpr_write_b32 a61, v61
v_accvgpr_write_b32 a62, v62
v_accvgpr_write_b32 a63, v63
v_accvgpr_read_b32 v60, a76
v_accvgpr_read_b32 v61, a77
v_accvgpr_read_b32 v62, a78
v_accvgpr_read_b32 v63, a79
v_mul_f32 v60, v60, v59
v_mul_f32 v61, v61, v59
v_mul_f32 v62, v62, v59
v_mul_f32 v63, v63, v59
v_mul_f32 v60, v60, v59
v_mul_f32 v61, v61, v59
v_mul_f32 v62, v62, v59
v_mul_f32 v63, v63, v59
v_accvgpr_write_b32 a76, v60
v_accvgpr_write_b32 a77, v61
v_accvgpr_write_b32 a78, v62
v_accvgpr_write_b32 a79, v63
v_accvgpr_read_b32 v60, a92
v_accvgpr_read_b32 v61, a93
v_accvgpr_read_b32 v62, a94
v_accvgpr_read_b32 v63, a95
v_mul_f32 v60, v60, v59
v_mul_f32 v61, v61, v59
v_mul_f32 v62, v62, v59
v_mul_f32 v63, v63, v59
v_mul_f32 v60, v60, v59
v_mul_f32 v61, v61, v59
v_mul_f32 v62, v62, v59
v_mul_f32 v63, v63, v59
v_accvgpr_write_b32 a92, v60
v_accvgpr_write_b32 a93, v61
v_accvgpr_write_b32 a94, v62
v_accvgpr_write_b32 a95, v63
v_accvgpr_read_b32 v60, a108
v_accvgpr_read_b32 v61, a109
v_accvgpr_read_b32 v62, a110
v_accvgpr_read_b32 v63, a111
v_mul_f32 v60, v60, v59
v_mul_f32 v61, v61, v59
v_mul_f32 v62, v62, v59
v_mul_f32 v63, v63, v59
v_mul_f32 v60, v60, v59
v_mul_f32 v61, v61, v59
v_mul_f32 v62, v62, v59
v_mul_f32 v63, v63, v59
v_accvgpr_write_b32 a108, v60
v_accvgpr_write_b32 a109, v61
v_accvgpr_write_b32 a110, v62
v_accvgpr_write_b32 a111, v63
v_accvgpr_read_b32 v60, a124
v_accvgpr_read_b32 v61, a125
v_accvgpr_read_b32 v62, a126
v_accvgpr_read_b32 v63, a127
v_mul_f32 v60, v60, v59
v_mul_f32 v61, v61, v59
v_mul_f32 v62, v62, v59
v_mul_f32 v63, v63, v59
v_mul_f32 v60, v60, v59
v_mul_f32 v61, v61, v59
v_mul_f32 v62, v62, v59
v_mul_f32 v63, v63, v59
v_accvgpr_write_b32 a124, v60
v_accvgpr_write_b32 a125, v61
v_accvgpr_write_b32 a126, v62
v_accvgpr_write_b32 a127, v63
v_accvgpr_read_b32 v60, a204
v_accvgpr_read_b32 v61, a205
v_accvgpr_read_b32 v62, a206
v_accvgpr_read_b32 v63, a207
v_mul_f32 v60, v60, v59
v_mul_f32 v61, v61, v59
v_mul_f32 v62, v62, v59
v_mul_f32 v63, v63, v59
v_mul_f32 v60, v60, v59
v_mul_f32 v61, v61, v59
v_mul_f32 v62, v62, v59
v_mul_f32 v63, v63, v59
v_accvgpr_write_b32 a204, v60
v_accvgpr_write_b32 a205, v61
v_accvgpr_write_b32 a206, v62
v_accvgpr_write_b32 a207, v63
s_mov_b32 s45, 0
s_nop 1
s_branch L_attn_kernel_rback_c_0
L_attn_kernel_resc_c_1:
s_nop 7
s_nop 7
v_accvgpr_read_b32 v60, a0
v_accvgpr_read_b32 v61, a1
v_accvgpr_read_b32 v62, a2
v_accvgpr_read_b32 v63, a3
v_mul_f32 v60, v60, v56
v_mul_f32 v61, v61, v56
v_mul_f32 v62, v62, v56
v_mul_f32 v63, v63, v56
v_mul_f32 v60, v60, v56
v_mul_f32 v61, v61, v56
v_mul_f32 v62, v62, v56
v_mul_f32 v63, v63, v56
v_accvgpr_write_b32 a0, v60
v_accvgpr_write_b32 a1, v61
v_accvgpr_write_b32 a2, v62
v_accvgpr_write_b32 a3, v63
v_accvgpr_read_b32 v60, a16
v_accvgpr_read_b32 v61, a17
v_accvgpr_read_b32 v62, a18
v_accvgpr_read_b32 v63, a19
v_mul_f32 v60, v60, v56
v_mul_f32 v61, v61, v56
v_mul_f32 v62, v62, v56
v_mul_f32 v63, v63, v56
v_mul_f32 v60, v60, v56
v_mul_f32 v61, v61, v56
v_mul_f32 v62, v62, v56
v_mul_f32 v63, v63, v56
v_accvgpr_write_b32 a16, v60
v_accvgpr_write_b32 a17, v61
v_accvgpr_write_b32 a18, v62
v_accvgpr_write_b32 a19, v63
v_accvgpr_read_b32 v60, a32
v_accvgpr_read_b32 v61, a33
v_accvgpr_read_b32 v62, a34
v_accvgpr_read_b32 v63, a35
v_mul_f32 v60, v60, v56
v_mul_f32 v61, v61, v56
v_mul_f32 v62, v62, v56
v_mul_f32 v63, v63, v56
v_mul_f32 v60, v60, v56
v_mul_f32 v61, v61, v56
v_mul_f32 v62, v62, v56
v_mul_f32 v63, v63, v56
v_accvgpr_write_b32 a32, v60
v_accvgpr_write_b32 a33, v61
v_accvgpr_write_b32 a34, v62
v_accvgpr_write_b32 a35, v63
v_accvgpr_read_b32 v60, a48
v_accvgpr_read_b32 v61, a49
v_accvgpr_read_b32 v62, a50
v_accvgpr_read_b32 v63, a51
v_mul_f32 v60, v60, v56
v_mul_f32 v61, v61, v56
v_mul_f32 v62, v62, v56
v_mul_f32 v63, v63, v56
v_mul_f32 v60, v60, v56
v_mul_f32 v61, v61, v56
v_mul_f32 v62, v62, v56
v_mul_f32 v63, v63, v56
v_accvgpr_write_b32 a48, v60
v_accvgpr_write_b32 a49, v61
v_accvgpr_write_b32 a50, v62
v_accvgpr_write_b32 a51, v63
v_accvgpr_read_b32 v60, a64
v_accvgpr_read_b32 v61, a65
v_accvgpr_read_b32 v62, a66
v_accvgpr_read_b32 v63, a67
v_mul_f32 v60, v60, v56
v_mul_f32 v61, v61, v56
v_mul_f32 v62, v62, v56
v_mul_f32 v63, v63, v56
v_mul_f32 v60, v60, v56
v_mul_f32 v61, v61, v56
v_mul_f32 v62, v62, v56
v_mul_f32 v63, v63, v56
v_accvgpr_write_b32 a64, v60
v_accvgpr_write_b32 a65, v61
v_accvgpr_write_b32 a66, v62
v_accvgpr_write_b32 a67, v63
v_accvgpr_read_b32 v60, a80
v_accvgpr_read_b32 v61, a81
v_accvgpr_read_b32 v62, a82
v_accvgpr_read_b32 v63, a83
v_mul_f32 v60, v60, v56
v_mul_f32 v61, v61, v56
v_mul_f32 v62, v62, v56
v_mul_f32 v63, v63, v56
v_mul_f32 v60, v60, v56
v_mul_f32 v61, v61, v56
v_mul_f32 v62, v62, v56
v_mul_f32 v63, v63, v56
v_accvgpr_write_b32 a80, v60
v_accvgpr_write_b32 a81, v61
v_accvgpr_write_b32 a82, v62
v_accvgpr_write_b32 a83, v63
v_accvgpr_read_b32 v60, a96
v_accvgpr_read_b32 v61, a97
v_accvgpr_read_b32 v62, a98
v_accvgpr_read_b32 v63, a99
v_mul_f32 v60, v60, v56
v_mul_f32 v61, v61, v56
v_mul_f32 v62, v62, v56
v_mul_f32 v63, v63, v56
v_mul_f32 v60, v60, v56
v_mul_f32 v61, v61, v56
v_mul_f32 v62, v62, v56
v_mul_f32 v63, v63, v56
v_accvgpr_write_b32 a96, v60
v_accvgpr_write_b32 a97, v61
v_accvgpr_write_b32 a98, v62
v_accvgpr_write_b32 a99, v63
v_accvgpr_read_b32 v60, a112
v_accvgpr_read_b32 v61, a113
v_accvgpr_read_b32 v62, a114
v_accvgpr_read_b32 v63, a115
v_mul_f32 v60, v60, v56
v_mul_f32 v61, v61, v56
v_mul_f32 v62, v62, v56
v_mul_f32 v63, v63, v56
v_mul_f32 v60, v60, v56
v_mul_f32 v61, v61, v56
v_mul_f32 v62, v62, v56
v_mul_f32 v63, v63, v56
v_accvgpr_write_b32 a112, v60
v_accvgpr_write_b32 a113, v61
v_accvgpr_write_b32 a114, v62
v_accvgpr_write_b32 a115, v63
v_accvgpr_read_b32 v60, a192
v_accvgpr_read_b32 v61, a193
v_accvgpr_read_b32 v62, a194
v_accvgpr_read_b32 v63, a195
v_mul_f32 v60, v60, v56
v_mul_f32 v61, v61, v56
v_mul_f32 v62, v62, v56
v_mul_f32 v63, v63, v56
v_mul_f32 v60, v60, v56
v_mul_f32 v61, v61, v56
v_mul_f32 v62, v62, v56
v_mul_f32 v63, v63, v56
v_accvgpr_write_b32 a192, v60
v_accvgpr_write_b32 a193, v61
v_accvgpr_write_b32 a194, v62
v_accvgpr_write_b32 a195, v63
v_accvgpr_read_b32 v60, a4
v_accvgpr_read_b32 v61, a5
v_accvgpr_read_b32 v62, a6
v_accvgpr_read_b32 v63, a7
v_mul_f32 v60, v60, v57
v_mul_f32 v61, v61, v57
v_mul_f32 v62, v62, v57
v_mul_f32 v63, v63, v57
v_mul_f32 v60, v60, v57
v_mul_f32 v61, v61, v57
v_mul_f32 v62, v62, v57
v_mul_f32 v63, v63, v57
v_accvgpr_write_b32 a4, v60
v_accvgpr_write_b32 a5, v61
v_accvgpr_write_b32 a6, v62
v_accvgpr_write_b32 a7, v63
v_accvgpr_read_b32 v60, a20
v_accvgpr_read_b32 v61, a21
v_accvgpr_read_b32 v62, a22
v_accvgpr_read_b32 v63, a23
v_mul_f32 v60, v60, v57
v_mul_f32 v61, v61, v57
v_mul_f32 v62, v62, v57
v_mul_f32 v63, v63, v57
v_mul_f32 v60, v60, v57
v_mul_f32 v61, v61, v57
v_mul_f32 v62, v62, v57
v_mul_f32 v63, v63, v57
v_accvgpr_write_b32 a20, v60
v_accvgpr_write_b32 a21, v61
v_accvgpr_write_b32 a22, v62
v_accvgpr_write_b32 a23, v63
v_accvgpr_read_b32 v60, a36
v_accvgpr_read_b32 v61, a37
v_accvgpr_read_b32 v62, a38
v_accvgpr_read_b32 v63, a39
v_mul_f32 v60, v60, v57
v_mul_f32 v61, v61, v57
v_mul_f32 v62, v62, v57
v_mul_f32 v63, v63, v57
v_mul_f32 v60, v60, v57
v_mul_f32 v61, v61, v57
v_mul_f32 v62, v62, v57
v_mul_f32 v63, v63, v57
v_accvgpr_write_b32 a36, v60
v_accvgpr_write_b32 a37, v61
v_accvgpr_write_b32 a38, v62
v_accvgpr_write_b32 a39, v63
v_accvgpr_read_b32 v60, a52
v_accvgpr_read_b32 v61, a53
v_accvgpr_read_b32 v62, a54
v_accvgpr_read_b32 v63, a55
v_mul_f32 v60, v60, v57
v_mul_f32 v61, v61, v57
v_mul_f32 v62, v62, v57
v_mul_f32 v63, v63, v57
v_mul_f32 v60, v60, v57
v_mul_f32 v61, v61, v57
v_mul_f32 v62, v62, v57
v_mul_f32 v63, v63, v57
v_accvgpr_write_b32 a52, v60
v_accvgpr_write_b32 a53, v61
v_accvgpr_write_b32 a54, v62
v_accvgpr_write_b32 a55, v63
v_accvgpr_read_b32 v60, a68
v_accvgpr_read_b32 v61, a69
v_accvgpr_read_b32 v62, a70
v_accvgpr_read_b32 v63, a71
v_mul_f32 v60, v60, v57
v_mul_f32 v61, v61, v57
v_mul_f32 v62, v62, v57
v_mul_f32 v63, v63, v57
v_mul_f32 v60, v60, v57
v_mul_f32 v61, v61, v57
v_mul_f32 v62, v62, v57
v_mul_f32 v63, v63, v57
v_accvgpr_write_b32 a68, v60
v_accvgpr_write_b32 a69, v61
v_accvgpr_write_b32 a70, v62
v_accvgpr_write_b32 a71, v63
v_accvgpr_read_b32 v60, a84
v_accvgpr_read_b32 v61, a85
v_accvgpr_read_b32 v62, a86
v_accvgpr_read_b32 v63, a87
v_mul_f32 v60, v60, v57
v_mul_f32 v61, v61, v57
v_mul_f32 v62, v62, v57
v_mul_f32 v63, v63, v57
v_mul_f32 v60, v60, v57
v_mul_f32 v61, v61, v57
v_mul_f32 v62, v62, v57
v_mul_f32 v63, v63, v57
v_accvgpr_write_b32 a84, v60
v_accvgpr_write_b32 a85, v61
v_accvgpr_write_b32 a86, v62
v_accvgpr_write_b32 a87, v63
v_accvgpr_read_b32 v60, a100
v_accvgpr_read_b32 v61, a101
v_accvgpr_read_b32 v62, a102
v_accvgpr_read_b32 v63, a103
v_mul_f32 v60, v60, v57
v_mul_f32 v61, v61, v57
v_mul_f32 v62, v62, v57
v_mul_f32 v63, v63, v57
v_mul_f32 v60, v60, v57
v_mul_f32 v61, v61, v57
v_mul_f32 v62, v62, v57
v_mul_f32 v63, v63, v57
v_accvgpr_write_b32 a100, v60
v_accvgpr_write_b32 a101, v61
v_accvgpr_write_b32 a102, v62
v_accvgpr_write_b32 a103, v63
v_accvgpr_read_b32 v60, a116
v_accvgpr_read_b32 v61, a117
v_accvgpr_read_b32 v62, a118
v_accvgpr_read_b32 v63, a119
v_mul_f32 v60, v60, v57
v_mul_f32 v61, v61, v57
v_mul_f32 v62, v62, v57
v_mul_f32 v63, v63, v57
v_mul_f32 v60, v60, v57
v_mul_f32 v61, v61, v57
v_mul_f32 v62, v62, v57
v_mul_f32 v63, v63, v57
v_accvgpr_write_b32 a116, v60
v_accvgpr_write_b32 a117, v61
v_accvgpr_write_b32 a118, v62
v_accvgpr_write_b32 a119, v63
v_accvgpr_read_b32 v60, a196
v_accvgpr_read_b32 v61, a197
v_accvgpr_read_b32 v62, a198
v_accvgpr_read_b32 v63, a199
v_mul_f32 v60, v60, v57
v_mul_f32 v61, v61, v57
v_mul_f32 v62, v62, v57
v_mul_f32 v63, v63, v57
v_mul_f32 v60, v60, v57
v_mul_f32 v61, v61, v57
v_mul_f32 v62, v62, v57
v_mul_f32 v63, v63, v57
v_accvgpr_write_b32 a196, v60
v_accvgpr_write_b32 a197, v61
v_accvgpr_write_b32 a198, v62
v_accvgpr_write_b32 a199, v63
v_accvgpr_read_b32 v60, a8
v_accvgpr_read_b32 v61, a9
v_accvgpr_read_b32 v62, a10
v_accvgpr_read_b32 v63, a11
v_mul_f32 v60, v60, v58
v_mul_f32 v61, v61, v58
v_mul_f32 v62, v62, v58
v_mul_f32 v63, v63, v58
v_mul_f32 v60, v60, v58
v_mul_f32 v61, v61, v58
v_mul_f32 v62, v62, v58
v_mul_f32 v63, v63, v58
v_accvgpr_write_b32 a8, v60
v_accvgpr_write_b32 a9, v61
v_accvgpr_write_b32 a10, v62
v_accvgpr_write_b32 a11, v63
v_accvgpr_read_b32 v60, a24
v_accvgpr_read_b32 v61, a25
v_accvgpr_read_b32 v62, a26
v_accvgpr_read_b32 v63, a27
v_mul_f32 v60, v60, v58
v_mul_f32 v61, v61, v58
v_mul_f32 v62, v62, v58
v_mul_f32 v63, v63, v58
v_mul_f32 v60, v60, v58
v_mul_f32 v61, v61, v58
v_mul_f32 v62, v62, v58
v_mul_f32 v63, v63, v58
v_accvgpr_write_b32 a24, v60
v_accvgpr_write_b32 a25, v61
v_accvgpr_write_b32 a26, v62
v_accvgpr_write_b32 a27, v63
v_accvgpr_read_b32 v60, a40
v_accvgpr_read_b32 v61, a41
v_accvgpr_read_b32 v62, a42
v_accvgpr_read_b32 v63, a43
v_mul_f32 v60, v60, v58
v_mul_f32 v61, v61, v58
v_mul_f32 v62, v62, v58
v_mul_f32 v63, v63, v58
v_mul_f32 v60, v60, v58
v_mul_f32 v61, v61, v58
v_mul_f32 v62, v62, v58
v_mul_f32 v63, v63, v58
v_accvgpr_write_b32 a40, v60
v_accvgpr_write_b32 a41, v61
v_accvgpr_write_b32 a42, v62
v_accvgpr_write_b32 a43, v63
v_accvgpr_read_b32 v60, a56
v_accvgpr_read_b32 v61, a57
v_accvgpr_read_b32 v62, a58
v_accvgpr_read_b32 v63, a59
v_mul_f32 v60, v60, v58
v_mul_f32 v61, v61, v58
v_mul_f32 v62, v62, v58
v_mul_f32 v63, v63, v58
v_mul_f32 v60, v60, v58
v_mul_f32 v61, v61, v58
v_mul_f32 v62, v62, v58
v_mul_f32 v63, v63, v58
v_accvgpr_write_b32 a56, v60
v_accvgpr_write_b32 a57, v61
v_accvgpr_write_b32 a58, v62
v_accvgpr_write_b32 a59, v63
v_accvgpr_read_b32 v60, a72
v_accvgpr_read_b32 v61, a73
v_accvgpr_read_b32 v62, a74
v_accvgpr_read_b32 v63, a75
v_mul_f32 v60, v60, v58
v_mul_f32 v61, v61, v58
v_mul_f32 v62, v62, v58
v_mul_f32 v63, v63, v58
v_mul_f32 v60, v60, v58
v_mul_f32 v61, v61, v58
v_mul_f32 v62, v62, v58
v_mul_f32 v63, v63, v58
v_accvgpr_write_b32 a72, v60
v_accvgpr_write_b32 a73, v61
v_accvgpr_write_b32 a74, v62
v_accvgpr_write_b32 a75, v63
v_accvgpr_read_b32 v60, a88
v_accvgpr_read_b32 v61, a89
v_accvgpr_read_b32 v62, a90
v_accvgpr_read_b32 v63, a91
v_mul_f32 v60, v60, v58
v_mul_f32 v61, v61, v58
v_mul_f32 v62, v62, v58
v_mul_f32 v63, v63, v58
v_mul_f32 v60, v60, v58
v_mul_f32 v61, v61, v58
v_mul_f32 v62, v62, v58
v_mul_f32 v63, v63, v58
v_accvgpr_write_b32 a88, v60
v_accvgpr_write_b32 a89, v61
v_accvgpr_write_b32 a90, v62
v_accvgpr_write_b32 a91, v63
v_accvgpr_read_b32 v60, a104
v_accvgpr_read_b32 v61, a105
v_accvgpr_read_b32 v62, a106
v_accvgpr_read_b32 v63, a107
v_mul_f32 v60, v60, v58
v_mul_f32 v61, v61, v58
v_mul_f32 v62, v62, v58
v_mul_f32 v63, v63, v58
v_mul_f32 v60, v60, v58
v_mul_f32 v61, v61, v58
v_mul_f32 v62, v62, v58
v_mul_f32 v63, v63, v58
v_accvgpr_write_b32 a104, v60
v_accvgpr_write_b32 a105, v61
v_accvgpr_write_b32 a106, v62
v_accvgpr_write_b32 a107, v63
v_accvgpr_read_b32 v60, a120
v_accvgpr_read_b32 v61, a121
v_accvgpr_read_b32 v62, a122
v_accvgpr_read_b32 v63, a123
v_mul_f32 v60, v60, v58
v_mul_f32 v61, v61, v58
v_mul_f32 v62, v62, v58
v_mul_f32 v63, v63, v58
v_mul_f32 v60, v60, v58
v_mul_f32 v61, v61, v58
v_mul_f32 v62, v62, v58
v_mul_f32 v63, v63, v58
v_accvgpr_write_b32 a120, v60
v_accvgpr_write_b32 a121, v61
v_accvgpr_write_b32 a122, v62
v_accvgpr_write_b32 a123, v63
v_accvgpr_read_b32 v60, a200
v_accvgpr_read_b32 v61, a201
v_accvgpr_read_b32 v62, a202
v_accvgpr_read_b32 v63, a203
v_mul_f32 v60, v60, v58
v_mul_f32 v61, v61, v58
v_mul_f32 v62, v62, v58
v_mul_f32 v63, v63, v58
v_mul_f32 v60, v60, v58
v_mul_f32 v61, v61, v58
v_mul_f32 v62, v62, v58
v_mul_f32 v63, v63, v58
v_accvgpr_write_b32 a200, v60
v_accvgpr_write_b32 a201, v61
v_accvgpr_write_b32 a202, v62
v_accvgpr_write_b32 a203, v63
v_accvgpr_read_b32 v60, a12
v_accvgpr_read_b32 v61, a13
v_accvgpr_read_b32 v62, a14
v_accvgpr_read_b32 v63, a15
v_mul_f32 v60, v60, v59
v_mul_f32 v61, v61, v59
v_mul_f32 v62, v62, v59
v_mul_f32 v63, v63, v59
v_mul_f32 v60, v60, v59
v_mul_f32 v61, v61, v59
v_mul_f32 v62, v62, v59
v_mul_f32 v63, v63, v59
v_accvgpr_write_b32 a12, v60
v_accvgpr_write_b32 a13, v61
v_accvgpr_write_b32 a14, v62
v_accvgpr_write_b32 a15, v63
v_accvgpr_read_b32 v60, a28
v_accvgpr_read_b32 v61, a29
v_accvgpr_read_b32 v62, a30
v_accvgpr_read_b32 v63, a31
v_mul_f32 v60, v60, v59
v_mul_f32 v61, v61, v59
v_mul_f32 v62, v62, v59
v_mul_f32 v63, v63, v59
v_mul_f32 v60, v60, v59
v_mul_f32 v61, v61, v59
v_mul_f32 v62, v62, v59
v_mul_f32 v63, v63, v59
v_accvgpr_write_b32 a28, v60
v_accvgpr_write_b32 a29, v61
v_accvgpr_write_b32 a30, v62
v_accvgpr_write_b32 a31, v63
v_accvgpr_read_b32 v60, a44
v_accvgpr_read_b32 v61, a45
v_accvgpr_read_b32 v62, a46
v_accvgpr_read_b32 v63, a47
v_mul_f32 v60, v60, v59
v_mul_f32 v61, v61, v59
v_mul_f32 v62, v62, v59
v_mul_f32 v63, v63, v59
v_mul_f32 v60, v60, v59
v_mul_f32 v61, v61, v59
v_mul_f32 v62, v62, v59
v_mul_f32 v63, v63, v59
v_accvgpr_write_b32 a44, v60
v_accvgpr_write_b32 a45, v61
v_accvgpr_write_b32 a46, v62
v_accvgpr_write_b32 a47, v63
v_accvgpr_read_b32 v60, a60
v_accvgpr_read_b32 v61, a61
v_accvgpr_read_b32 v62, a62
v_accvgpr_read_b32 v63, a63
v_mul_f32 v60, v60, v59
v_mul_f32 v61, v61, v59
v_mul_f32 v62, v62, v59
v_mul_f32 v63, v63, v59
v_mul_f32 v60, v60, v59
v_mul_f32 v61, v61, v59
v_mul_f32 v62, v62, v59
v_mul_f32 v63, v63, v59
v_accvgpr_write_b32 a60, v60
v_accvgpr_write_b32 a61, v61
v_accvgpr_write_b32 a62, v62
v_accvgpr_write_b32 a63, v63
v_accvgpr_read_b32 v60, a76
v_accvgpr_read_b32 v61, a77
v_accvgpr_read_b32 v62, a78
v_accvgpr_read_b32 v63, a79
v_mul_f32 v60, v60, v59
v_mul_f32 v61, v61, v59
v_mul_f32 v62, v62, v59
v_mul_f32 v63, v63, v59
v_mul_f32 v60, v60, v59
v_mul_f32 v61, v61, v59
v_mul_f32 v62, v62, v59
v_mul_f32 v63, v63, v59
v_accvgpr_write_b32 a76, v60
v_accvgpr_write_b32 a77, v61
v_accvgpr_write_b32 a78, v62
v_accvgpr_write_b32 a79, v63
v_accvgpr_read_b32 v60, a92
v_accvgpr_read_b32 v61, a93
v_accvgpr_read_b32 v62, a94
v_accvgpr_read_b32 v63, a95
v_mul_f32 v60, v60, v59
v_mul_f32 v61, v61, v59
v_mul_f32 v62, v62, v59
v_mul_f32 v63, v63, v59
v_mul_f32 v60, v60, v59
v_mul_f32 v61, v61, v59
v_mul_f32 v62, v62, v59
v_mul_f32 v63, v63, v59
v_accvgpr_write_b32 a92, v60
v_accvgpr_write_b32 a93, v61
v_accvgpr_write_b32 a94, v62
v_accvgpr_write_b32 a95, v63
v_accvgpr_read_b32 v60, a108
v_accvgpr_read_b32 v61, a109
v_accvgpr_read_b32 v62, a110
v_accvgpr_read_b32 v63, a111
v_mul_f32 v60, v60, v59
v_mul_f32 v61, v61, v59
v_mul_f32 v62, v62, v59
v_mul_f32 v63, v63, v59
v_mul_f32 v60, v60, v59
v_mul_f32 v61, v61, v59
v_mul_f32 v62, v62, v59
v_mul_f32 v63, v63, v59
v_accvgpr_write_b32 a108, v60
v_accvgpr_write_b32 a109, v61
v_accvgpr_write_b32 a110, v62
v_accvgpr_write_b32 a111, v63
v_accvgpr_read_b32 v60, a124
v_accvgpr_read_b32 v61, a125
v_accvgpr_read_b32 v62, a126
v_accvgpr_read_b32 v63, a127
v_mul_f32 v60, v60, v59
v_mul_f32 v61, v61, v59
v_mul_f32 v62, v62, v59
v_mul_f32 v63, v63, v59
v_mul_f32 v60, v60, v59
v_mul_f32 v61, v61, v59
v_mul_f32 v62, v62, v59
v_mul_f32 v63, v63, v59
v_accvgpr_write_b32 a124, v60
v_accvgpr_write_b32 a125, v61
v_accvgpr_write_b32 a126, v62
v_accvgpr_write_b32 a127, v63
v_accvgpr_read_b32 v60, a204
v_accvgpr_read_b32 v61, a205
v_accvgpr_read_b32 v62, a206
v_accvgpr_read_b32 v63, a207
v_mul_f32 v60, v60, v59
v_mul_f32 v61, v61, v59
v_mul_f32 v62, v62, v59
v_mul_f32 v63, v63, v59
v_mul_f32 v60, v60, v59
v_mul_f32 v61, v61, v59
v_mul_f32 v62, v62, v59
v_mul_f32 v63, v63, v59
v_accvgpr_write_b32 a204, v60
v_accvgpr_write_b32 a205, v61
v_accvgpr_write_b32 a206, v62
v_accvgpr_write_b32 a207, v63
s_mov_b32 s45, 0
s_nop 1
s_branch L_attn_kernel_rback_c_1
L_attn_kernel_resc_c_2:
s_nop 7
s_nop 7
v_accvgpr_read_b32 v60, a0
v_accvgpr_read_b32 v61, a1
v_accvgpr_read_b32 v62, a2
v_accvgpr_read_b32 v63, a3
v_mul_f32 v60, v60, v56
v_mul_f32 v61, v61, v56
v_mul_f32 v62, v62, v56
v_mul_f32 v63, v63, v56
v_mul_f32 v60, v60, v56
v_mul_f32 v61, v61, v56
v_mul_f32 v62, v62, v56
v_mul_f32 v63, v63, v56
v_accvgpr_write_b32 a0, v60
v_accvgpr_write_b32 a1, v61
v_accvgpr_write_b32 a2, v62
v_accvgpr_write_b32 a3, v63
v_accvgpr_read_b32 v60, a16
v_accvgpr_read_b32 v61, a17
v_accvgpr_read_b32 v62, a18
v_accvgpr_read_b32 v63, a19
v_mul_f32 v60, v60, v56
v_mul_f32 v61, v61, v56
v_mul_f32 v62, v62, v56
v_mul_f32 v63, v63, v56
v_mul_f32 v60, v60, v56
v_mul_f32 v61, v61, v56
v_mul_f32 v62, v62, v56
v_mul_f32 v63, v63, v56
v_accvgpr_write_b32 a16, v60
v_accvgpr_write_b32 a17, v61
v_accvgpr_write_b32 a18, v62
v_accvgpr_write_b32 a19, v63
v_accvgpr_read_b32 v60, a32
v_accvgpr_read_b32 v61, a33
v_accvgpr_read_b32 v62, a34
v_accvgpr_read_b32 v63, a35
v_mul_f32 v60, v60, v56
v_mul_f32 v61, v61, v56
v_mul_f32 v62, v62, v56
v_mul_f32 v63, v63, v56
v_mul_f32 v60, v60, v56
v_mul_f32 v61, v61, v56
v_mul_f32 v62, v62, v56
v_mul_f32 v63, v63, v56
v_accvgpr_write_b32 a32, v60
v_accvgpr_write_b32 a33, v61
v_accvgpr_write_b32 a34, v62
v_accvgpr_write_b32 a35, v63
v_accvgpr_read_b32 v60, a48
v_accvgpr_read_b32 v61, a49
v_accvgpr_read_b32 v62, a50
v_accvgpr_read_b32 v63, a51
v_mul_f32 v60, v60, v56
v_mul_f32 v61, v61, v56
v_mul_f32 v62, v62, v56
v_mul_f32 v63, v63, v56
v_mul_f32 v60, v60, v56
v_mul_f32 v61, v61, v56
v_mul_f32 v62, v62, v56
v_mul_f32 v63, v63, v56
v_accvgpr_write_b32 a48, v60
v_accvgpr_write_b32 a49, v61
v_accvgpr_write_b32 a50, v62
v_accvgpr_write_b32 a51, v63
v_accvgpr_read_b32 v60, a64
v_accvgpr_read_b32 v61, a65
v_accvgpr_read_b32 v62, a66
v_accvgpr_read_b32 v63, a67
v_mul_f32 v60, v60, v56
v_mul_f32 v61, v61, v56
v_mul_f32 v62, v62, v56
v_mul_f32 v63, v63, v56
v_mul_f32 v60, v60, v56
v_mul_f32 v61, v61, v56
v_mul_f32 v62, v62, v56
v_mul_f32 v63, v63, v56
v_accvgpr_write_b32 a64, v60
v_accvgpr_write_b32 a65, v61
v_accvgpr_write_b32 a66, v62
v_accvgpr_write_b32 a67, v63
v_accvgpr_read_b32 v60, a80
v_accvgpr_read_b32 v61, a81
v_accvgpr_read_b32 v62, a82
v_accvgpr_read_b32 v63, a83
v_mul_f32 v60, v60, v56
v_mul_f32 v61, v61, v56
v_mul_f32 v62, v62, v56
v_mul_f32 v63, v63, v56
v_mul_f32 v60, v60, v56
v_mul_f32 v61, v61, v56
v_mul_f32 v62, v62, v56
v_mul_f32 v63, v63, v56
v_accvgpr_write_b32 a80, v60
v_accvgpr_write_b32 a81, v61
v_accvgpr_write_b32 a82, v62
v_accvgpr_write_b32 a83, v63
v_accvgpr_read_b32 v60, a96
v_accvgpr_read_b32 v61, a97
v_accvgpr_read_b32 v62, a98
v_accvgpr_read_b32 v63, a99
v_mul_f32 v60, v60, v56
v_mul_f32 v61, v61, v56
v_mul_f32 v62, v62, v56
v_mul_f32 v63, v63, v56
v_mul_f32 v60, v60, v56
v_mul_f32 v61, v61, v56
v_mul_f32 v62, v62, v56
v_mul_f32 v63, v63, v56
v_accvgpr_write_b32 a96, v60
v_accvgpr_write_b32 a97, v61
v_accvgpr_write_b32 a98, v62
v_accvgpr_write_b32 a99, v63
v_accvgpr_read_b32 v60, a112
v_accvgpr_read_b32 v61, a113
v_accvgpr_read_b32 v62, a114
v_accvgpr_read_b32 v63, a115
v_mul_f32 v60, v60, v56
v_mul_f32 v61, v61, v56
v_mul_f32 v62, v62, v56
v_mul_f32 v63, v63, v56
v_mul_f32 v60, v60, v56
v_mul_f32 v61, v61, v56
v_mul_f32 v62, v62, v56
v_mul_f32 v63, v63, v56
v_accvgpr_write_b32 a112, v60
v_accvgpr_write_b32 a113, v61
v_accvgpr_write_b32 a114, v62
v_accvgpr_write_b32 a115, v63
v_accvgpr_read_b32 v60, a192
v_accvgpr_read_b32 v61, a193
v_accvgpr_read_b32 v62, a194
v_accvgpr_read_b32 v63, a195
v_mul_f32 v60, v60, v56
v_mul_f32 v61, v61, v56
v_mul_f32 v62, v62, v56
v_mul_f32 v63, v63, v56
v_mul_f32 v60, v60, v56
v_mul_f32 v61, v61, v56
v_mul_f32 v62, v62, v56
v_mul_f32 v63, v63, v56
v_accvgpr_write_b32 a192, v60
v_accvgpr_write_b32 a193, v61
v_accvgpr_write_b32 a194, v62
v_accvgpr_write_b32 a195, v63
v_accvgpr_read_b32 v60, a4
v_accvgpr_read_b32 v61, a5
v_accvgpr_read_b32 v62, a6
v_accvgpr_read_b32 v63, a7
v_mul_f32 v60, v60, v57
v_mul_f32 v61, v61, v57
v_mul_f32 v62, v62, v57
v_mul_f32 v63, v63, v57
v_mul_f32 v60, v60, v57
v_mul_f32 v61, v61, v57
v_mul_f32 v62, v62, v57
v_mul_f32 v63, v63, v57
v_accvgpr_write_b32 a4, v60
v_accvgpr_write_b32 a5, v61
v_accvgpr_write_b32 a6, v62
v_accvgpr_write_b32 a7, v63
v_accvgpr_read_b32 v60, a20
v_accvgpr_read_b32 v61, a21
v_accvgpr_read_b32 v62, a22
v_accvgpr_read_b32 v63, a23
v_mul_f32 v60, v60, v57
v_mul_f32 v61, v61, v57
v_mul_f32 v62, v62, v57
v_mul_f32 v63, v63, v57
v_mul_f32 v60, v60, v57
v_mul_f32 v61, v61, v57
v_mul_f32 v62, v62, v57
v_mul_f32 v63, v63, v57
v_accvgpr_write_b32 a20, v60
v_accvgpr_write_b32 a21, v61
v_accvgpr_write_b32 a22, v62
v_accvgpr_write_b32 a23, v63
v_accvgpr_read_b32 v60, a36
v_accvgpr_read_b32 v61, a37
v_accvgpr_read_b32 v62, a38
v_accvgpr_read_b32 v63, a39
v_mul_f32 v60, v60, v57
v_mul_f32 v61, v61, v57
v_mul_f32 v62, v62, v57
v_mul_f32 v63, v63, v57
v_mul_f32 v60, v60, v57
v_mul_f32 v61, v61, v57
v_mul_f32 v62, v62, v57
v_mul_f32 v63, v63, v57
v_accvgpr_write_b32 a36, v60
v_accvgpr_write_b32 a37, v61
v_accvgpr_write_b32 a38, v62
v_accvgpr_write_b32 a39, v63
v_accvgpr_read_b32 v60, a52
v_accvgpr_read_b32 v61, a53
v_accvgpr_read_b32 v62, a54
v_accvgpr_read_b32 v63, a55
v_mul_f32 v60, v60, v57
v_mul_f32 v61, v61, v57
v_mul_f32 v62, v62, v57
v_mul_f32 v63, v63, v57
v_mul_f32 v60, v60, v57
v_mul_f32 v61, v61, v57
v_mul_f32 v62, v62, v57
v_mul_f32 v63, v63, v57
v_accvgpr_write_b32 a52, v60
v_accvgpr_write_b32 a53, v61
v_accvgpr_write_b32 a54, v62
v_accvgpr_write_b32 a55, v63
v_accvgpr_read_b32 v60, a68
v_accvgpr_read_b32 v61, a69
v_accvgpr_read_b32 v62, a70
v_accvgpr_read_b32 v63, a71
v_mul_f32 v60, v60, v57
v_mul_f32 v61, v61, v57
v_mul_f32 v62, v62, v57
v_mul_f32 v63, v63, v57
v_mul_f32 v60, v60, v57
v_mul_f32 v61, v61, v57
v_mul_f32 v62, v62, v57
v_mul_f32 v63, v63, v57
v_accvgpr_write_b32 a68, v60
v_accvgpr_write_b32 a69, v61
v_accvgpr_write_b32 a70, v62
v_accvgpr_write_b32 a71, v63
v_accvgpr_read_b32 v60, a84
v_accvgpr_read_b32 v61, a85
v_accvgpr_read_b32 v62, a86
v_accvgpr_read_b32 v63, a87
v_mul_f32 v60, v60, v57
v_mul_f32 v61, v61, v57
v_mul_f32 v62, v62, v57
v_mul_f32 v63, v63, v57
v_mul_f32 v60, v60, v57
v_mul_f32 v61, v61, v57
v_mul_f32 v62, v62, v57
v_mul_f32 v63, v63, v57
v_accvgpr_write_b32 a84, v60
v_accvgpr_write_b32 a85, v61
v_accvgpr_write_b32 a86, v62
v_accvgpr_write_b32 a87, v63
v_accvgpr_read_b32 v60, a100
v_accvgpr_read_b32 v61, a101
v_accvgpr_read_b32 v62, a102
v_accvgpr_read_b32 v63, a103
v_mul_f32 v60, v60, v57
v_mul_f32 v61, v61, v57
v_mul_f32 v62, v62, v57
v_mul_f32 v63, v63, v57
v_mul_f32 v60, v60, v57
v_mul_f32 v61, v61, v57
v_mul_f32 v62, v62, v57
v_mul_f32 v63, v63, v57
v_accvgpr_write_b32 a100, v60
v_accvgpr_write_b32 a101, v61
v_accvgpr_write_b32 a102, v62
v_accvgpr_write_b32 a103, v63
v_accvgpr_read_b32 v60, a116
v_accvgpr_read_b32 v61, a117
v_accvgpr_read_b32 v62, a118
v_accvgpr_read_b32 v63, a119
v_mul_f32 v60, v60, v57
v_mul_f32 v61, v61, v57
v_mul_f32 v62, v62, v57
v_mul_f32 v63, v63, v57
v_mul_f32 v60, v60, v57
v_mul_f32 v61, v61, v57
v_mul_f32 v62, v62, v57
v_mul_f32 v63, v63, v57
v_accvgpr_write_b32 a116, v60
v_accvgpr_write_b32 a117, v61
v_accvgpr_write_b32 a118, v62
v_accvgpr_write_b32 a119, v63
v_accvgpr_read_b32 v60, a196
v_accvgpr_read_b32 v61, a197
v_accvgpr_read_b32 v62, a198
v_accvgpr_read_b32 v63, a199
v_mul_f32 v60, v60, v57
v_mul_f32 v61, v61, v57
v_mul_f32 v62, v62, v57
v_mul_f32 v63, v63, v57
v_mul_f32 v60, v60, v57
v_mul_f32 v61, v61, v57
v_mul_f32 v62, v62, v57
v_mul_f32 v63, v63, v57
v_accvgpr_write_b32 a196, v60
v_accvgpr_write_b32 a197, v61
v_accvgpr_write_b32 a198, v62
v_accvgpr_write_b32 a199, v63
v_accvgpr_read_b32 v60, a8
v_accvgpr_read_b32 v61, a9
v_accvgpr_read_b32 v62, a10
v_accvgpr_read_b32 v63, a11
v_mul_f32 v60, v60, v58
v_mul_f32 v61, v61, v58
v_mul_f32 v62, v62, v58
v_mul_f32 v63, v63, v58
v_mul_f32 v60, v60, v58
v_mul_f32 v61, v61, v58
v_mul_f32 v62, v62, v58
v_mul_f32 v63, v63, v58
v_accvgpr_write_b32 a8, v60
v_accvgpr_write_b32 a9, v61
v_accvgpr_write_b32 a10, v62
v_accvgpr_write_b32 a11, v63
v_accvgpr_read_b32 v60, a24
v_accvgpr_read_b32 v61, a25
v_accvgpr_read_b32 v62, a26
v_accvgpr_read_b32 v63, a27
v_mul_f32 v60, v60, v58
v_mul_f32 v61, v61, v58
v_mul_f32 v62, v62, v58
v_mul_f32 v63, v63, v58
v_mul_f32 v60, v60, v58
v_mul_f32 v61, v61, v58
v_mul_f32 v62, v62, v58
v_mul_f32 v63, v63, v58
v_accvgpr_write_b32 a24, v60
v_accvgpr_write_b32 a25, v61
v_accvgpr_write_b32 a26, v62
v_accvgpr_write_b32 a27, v63
v_accvgpr_read_b32 v60, a40
v_accvgpr_read_b32 v61, a41
v_accvgpr_read_b32 v62, a42
v_accvgpr_read_b32 v63, a43
v_mul_f32 v60, v60, v58
v_mul_f32 v61, v61, v58
v_mul_f32 v62, v62, v58
v_mul_f32 v63, v63, v58
v_mul_f32 v60, v60, v58
v_mul_f32 v61, v61, v58
v_mul_f32 v62, v62, v58
v_mul_f32 v63, v63, v58
v_accvgpr_write_b32 a40, v60
v_accvgpr_write_b32 a41, v61
v_accvgpr_write_b32 a42, v62
v_accvgpr_write_b32 a43, v63
v_accvgpr_read_b32 v60, a56
v_accvgpr_read_b32 v61, a57
v_accvgpr_read_b32 v62, a58
v_accvgpr_read_b32 v63, a59
v_mul_f32 v60, v60, v58
v_mul_f32 v61, v61, v58
v_mul_f32 v62, v62, v58
v_mul_f32 v63, v63, v58
v_mul_f32 v60, v60, v58
v_mul_f32 v61, v61, v58
v_mul_f32 v62, v62, v58
v_mul_f32 v63, v63, v58
v_accvgpr_write_b32 a56, v60
v_accvgpr_write_b32 a57, v61
v_accvgpr_write_b32 a58, v62
v_accvgpr_write_b32 a59, v63
v_accvgpr_read_b32 v60, a72
v_accvgpr_read_b32 v61, a73
v_accvgpr_read_b32 v62, a74
v_accvgpr_read_b32 v63, a75
v_mul_f32 v60, v60, v58
v_mul_f32 v61, v61, v58
v_mul_f32 v62, v62, v58
v_mul_f32 v63, v63, v58
v_mul_f32 v60, v60, v58
v_mul_f32 v61, v61, v58
v_mul_f32 v62, v62, v58
v_mul_f32 v63, v63, v58
v_accvgpr_write_b32 a72, v60
v_accvgpr_write_b32 a73, v61
v_accvgpr_write_b32 a74, v62
v_accvgpr_write_b32 a75, v63
v_accvgpr_read_b32 v60, a88
v_accvgpr_read_b32 v61, a89
v_accvgpr_read_b32 v62, a90
v_accvgpr_read_b32 v63, a91
v_mul_f32 v60, v60, v58
v_mul_f32 v61, v61, v58
v_mul_f32 v62, v62, v58
v_mul_f32 v63, v63, v58
v_mul_f32 v60, v60, v58
v_mul_f32 v61, v61, v58
v_mul_f32 v62, v62, v58
v_mul_f32 v63, v63, v58
v_accvgpr_write_b32 a88, v60
v_accvgpr_write_b32 a89, v61
v_accvgpr_write_b32 a90, v62
v_accvgpr_write_b32 a91, v63
v_accvgpr_read_b32 v60, a104
v_accvgpr_read_b32 v61, a105
v_accvgpr_read_b32 v62, a106
v_accvgpr_read_b32 v63, a107
v_mul_f32 v60, v60, v58
v_mul_f32 v61, v61, v58
v_mul_f32 v62, v62, v58
v_mul_f32 v63, v63, v58
v_mul_f32 v60, v60, v58
v_mul_f32 v61, v61, v58
v_mul_f32 v62, v62, v58
v_mul_f32 v63, v63, v58
v_accvgpr_write_b32 a104, v60
v_accvgpr_write_b32 a105, v61
v_accvgpr_write_b32 a106, v62
v_accvgpr_write_b32 a107, v63
v_accvgpr_read_b32 v60, a120
v_accvgpr_read_b32 v61, a121
v_accvgpr_read_b32 v62, a122
v_accvgpr_read_b32 v63, a123
v_mul_f32 v60, v60, v58
v_mul_f32 v61, v61, v58
v_mul_f32 v62, v62, v58
v_mul_f32 v63, v63, v58
v_mul_f32 v60, v60, v58
v_mul_f32 v61, v61, v58
v_mul_f32 v62, v62, v58
v_mul_f32 v63, v63, v58
v_accvgpr_write_b32 a120, v60
v_accvgpr_write_b32 a121, v61
v_accvgpr_write_b32 a122, v62
v_accvgpr_write_b32 a123, v63
v_accvgpr_read_b32 v60, a200
v_accvgpr_read_b32 v61, a201
v_accvgpr_read_b32 v62, a202
v_accvgpr_read_b32 v63, a203
v_mul_f32 v60, v60, v58
v_mul_f32 v61, v61, v58
v_mul_f32 v62, v62, v58
v_mul_f32 v63, v63, v58
v_mul_f32 v60, v60, v58
v_mul_f32 v61, v61, v58
v_mul_f32 v62, v62, v58
v_mul_f32 v63, v63, v58
v_accvgpr_write_b32 a200, v60
v_accvgpr_write_b32 a201, v61
v_accvgpr_write_b32 a202, v62
v_accvgpr_write_b32 a203, v63
v_accvgpr_read_b32 v60, a12
v_accvgpr_read_b32 v61, a13
v_accvgpr_read_b32 v62, a14
v_accvgpr_read_b32 v63, a15
v_mul_f32 v60, v60, v59
v_mul_f32 v61, v61, v59
v_mul_f32 v62, v62, v59
v_mul_f32 v63, v63, v59
v_mul_f32 v60, v60, v59
v_mul_f32 v61, v61, v59
v_mul_f32 v62, v62, v59
v_mul_f32 v63, v63, v59
v_accvgpr_write_b32 a12, v60
v_accvgpr_write_b32 a13, v61
v_accvgpr_write_b32 a14, v62
v_accvgpr_write_b32 a15, v63
v_accvgpr_read_b32 v60, a28
v_accvgpr_read_b32 v61, a29
v_accvgpr_read_b32 v62, a30
v_accvgpr_read_b32 v63, a31
v_mul_f32 v60, v60, v59
v_mul_f32 v61, v61, v59
v_mul_f32 v62, v62, v59
v_mul_f32 v63, v63, v59
v_mul_f32 v60, v60, v59
v_mul_f32 v61, v61, v59
v_mul_f32 v62, v62, v59
v_mul_f32 v63, v63, v59
v_accvgpr_write_b32 a28, v60
v_accvgpr_write_b32 a29, v61
v_accvgpr_write_b32 a30, v62
v_accvgpr_write_b32 a31, v63
v_accvgpr_read_b32 v60, a44
v_accvgpr_read_b32 v61, a45
v_accvgpr_read_b32 v62, a46
v_accvgpr_read_b32 v63, a47
v_mul_f32 v60, v60, v59
v_mul_f32 v61, v61, v59
v_mul_f32 v62, v62, v59
v_mul_f32 v63, v63, v59
v_mul_f32 v60, v60, v59
v_mul_f32 v61, v61, v59
v_mul_f32 v62, v62, v59
v_mul_f32 v63, v63, v59
v_accvgpr_write_b32 a44, v60
v_accvgpr_write_b32 a45, v61
v_accvgpr_write_b32 a46, v62
v_accvgpr_write_b32 a47, v63
v_accvgpr_read_b32 v60, a60
v_accvgpr_read_b32 v61, a61
v_accvgpr_read_b32 v62, a62
v_accvgpr_read_b32 v63, a63
v_mul_f32 v60, v60, v59
v_mul_f32 v61, v61, v59
v_mul_f32 v62, v62, v59
v_mul_f32 v63, v63, v59
v_mul_f32 v60, v60, v59
v_mul_f32 v61, v61, v59
v_mul_f32 v62, v62, v59
v_mul_f32 v63, v63, v59
v_accvgpr_write_b32 a60, v60
v_accvgpr_write_b32 a61, v61
v_accvgpr_write_b32 a62, v62
v_accvgpr_write_b32 a63, v63
v_accvgpr_read_b32 v60, a76
v_accvgpr_read_b32 v61, a77
v_accvgpr_read_b32 v62, a78
v_accvgpr_read_b32 v63, a79
v_mul_f32 v60, v60, v59
v_mul_f32 v61, v61, v59
v_mul_f32 v62, v62, v59
v_mul_f32 v63, v63, v59
v_mul_f32 v60, v60, v59
v_mul_f32 v61, v61, v59
v_mul_f32 v62, v62, v59
v_mul_f32 v63, v63, v59
v_accvgpr_write_b32 a76, v60
v_accvgpr_write_b32 a77, v61
v_accvgpr_write_b32 a78, v62
v_accvgpr_write_b32 a79, v63
v_accvgpr_read_b32 v60, a92
v_accvgpr_read_b32 v61, a93
v_accvgpr_read_b32 v62, a94
v_accvgpr_read_b32 v63, a95
v_mul_f32 v60, v60, v59
v_mul_f32 v61, v61, v59
v_mul_f32 v62, v62, v59
v_mul_f32 v63, v63, v59
v_mul_f32 v60, v60, v59
v_mul_f32 v61, v61, v59
v_mul_f32 v62, v62, v59
v_mul_f32 v63, v63, v59
v_accvgpr_write_b32 a92, v60
v_accvgpr_write_b32 a93, v61
v_accvgpr_write_b32 a94, v62
v_accvgpr_write_b32 a95, v63
v_accvgpr_read_b32 v60, a108
v_accvgpr_read_b32 v61, a109
v_accvgpr_read_b32 v62, a110
v_accvgpr_read_b32 v63, a111
v_mul_f32 v60, v60, v59
v_mul_f32 v61, v61, v59
v_mul_f32 v62, v62, v59
v_mul_f32 v63, v63, v59
v_mul_f32 v60, v60, v59
v_mul_f32 v61, v61, v59
v_mul_f32 v62, v62, v59
v_mul_f32 v63, v63, v59
v_accvgpr_write_b32 a108, v60
v_accvgpr_write_b32 a109, v61
v_accvgpr_write_b32 a110, v62
v_accvgpr_write_b32 a111, v63
v_accvgpr_read_b32 v60, a124
v_accvgpr_read_b32 v61, a125
v_accvgpr_read_b32 v62, a126
v_accvgpr_read_b32 v63, a127
v_mul_f32 v60, v60, v59
v_mul_f32 v61, v61, v59
v_mul_f32 v62, v62, v59
v_mul_f32 v63, v63, v59
v_mul_f32 v60, v60, v59
v_mul_f32 v61, v61, v59
v_mul_f32 v62, v62, v59
v_mul_f32 v63, v63, v59
v_accvgpr_write_b32 a124, v60
v_accvgpr_write_b32 a125, v61
v_accvgpr_write_b32 a126, v62
v_accvgpr_write_b32 a127, v63
v_accvgpr_read_b32 v60, a204
v_accvgpr_read_b32 v61, a205
v_accvgpr_read_b32 v62, a206
v_accvgpr_read_b32 v63, a207
v_mul_f32 v60, v60, v59
v_mul_f32 v61, v61, v59
v_mul_f32 v62, v62, v59
v_mul_f32 v63, v63, v59
v_mul_f32 v60, v60, v59
v_mul_f32 v61, v61, v59
v_mul_f32 v62, v62, v59
v_mul_f32 v63, v63, v59
v_accvgpr_write_b32 a204, v60
v_accvgpr_write_b32 a205, v61
v_accvgpr_write_b32 a206, v62
v_accvgpr_write_b32 a207, v63
s_mov_b32 s45, 0
s_nop 1
s_branch L_attn_kernel_rback_c_2
L_attn_kernel_resc_c_3:
s_nop 7
s_nop 7
v_accvgpr_read_b32 v60, a0
v_accvgpr_read_b32 v61, a1
v_accvgpr_read_b32 v62, a2
v_accvgpr_read_b32 v63, a3
v_mul_f32 v60, v60, v56
v_mul_f32 v61, v61, v56
v_mul_f32 v62, v62, v56
v_mul_f32 v63, v63, v56
v_mul_f32 v60, v60, v56
v_mul_f32 v61, v61, v56
v_mul_f32 v62, v62, v56
v_mul_f32 v63, v63, v56
v_accvgpr_write_b32 a0, v60
v_accvgpr_write_b32 a1, v61
v_accvgpr_write_b32 a2, v62
v_accvgpr_write_b32 a3, v63
v_accvgpr_read_b32 v60, a16
v_accvgpr_read_b32 v61, a17
v_accvgpr_read_b32 v62, a18
v_accvgpr_read_b32 v63, a19
v_mul_f32 v60, v60, v56
v_mul_f32 v61, v61, v56
v_mul_f32 v62, v62, v56
v_mul_f32 v63, v63, v56
v_mul_f32 v60, v60, v56
v_mul_f32 v61, v61, v56
v_mul_f32 v62, v62, v56
v_mul_f32 v63, v63, v56
v_accvgpr_write_b32 a16, v60
v_accvgpr_write_b32 a17, v61
v_accvgpr_write_b32 a18, v62
v_accvgpr_write_b32 a19, v63
v_accvgpr_read_b32 v60, a32
v_accvgpr_read_b32 v61, a33
v_accvgpr_read_b32 v62, a34
v_accvgpr_read_b32 v63, a35
v_mul_f32 v60, v60, v56
v_mul_f32 v61, v61, v56
v_mul_f32 v62, v62, v56
v_mul_f32 v63, v63, v56
v_mul_f32 v60, v60, v56
v_mul_f32 v61, v61, v56
v_mul_f32 v62, v62, v56
v_mul_f32 v63, v63, v56
v_accvgpr_write_b32 a32, v60
v_accvgpr_write_b32 a33, v61
v_accvgpr_write_b32 a34, v62
v_accvgpr_write_b32 a35, v63
v_accvgpr_read_b32 v60, a48
v_accvgpr_read_b32 v61, a49
v_accvgpr_read_b32 v62, a50
v_accvgpr_read_b32 v63, a51
v_mul_f32 v60, v60, v56
v_mul_f32 v61, v61, v56
v_mul_f32 v62, v62, v56
v_mul_f32 v63, v63, v56
v_mul_f32 v60, v60, v56
v_mul_f32 v61, v61, v56
v_mul_f32 v62, v62, v56
v_mul_f32 v63, v63, v56
v_accvgpr_write_b32 a48, v60
v_accvgpr_write_b32 a49, v61
v_accvgpr_write_b32 a50, v62
v_accvgpr_write_b32 a51, v63
v_accvgpr_read_b32 v60, a64
v_accvgpr_read_b32 v61, a65
v_accvgpr_read_b32 v62, a66
v_accvgpr_read_b32 v63, a67
v_mul_f32 v60, v60, v56
v_mul_f32 v61, v61, v56
v_mul_f32 v62, v62, v56
v_mul_f32 v63, v63, v56
v_mul_f32 v60, v60, v56
v_mul_f32 v61, v61, v56
v_mul_f32 v62, v62, v56
v_mul_f32 v63, v63, v56
v_accvgpr_write_b32 a64, v60
v_accvgpr_write_b32 a65, v61
v_accvgpr_write_b32 a66, v62
v_accvgpr_write_b32 a67, v63
v_accvgpr_read_b32 v60, a80
v_accvgpr_read_b32 v61, a81
v_accvgpr_read_b32 v62, a82
v_accvgpr_read_b32 v63, a83
v_mul_f32 v60, v60, v56
v_mul_f32 v61, v61, v56
v_mul_f32 v62, v62, v56
v_mul_f32 v63, v63, v56
v_mul_f32 v60, v60, v56
v_mul_f32 v61, v61, v56
v_mul_f32 v62, v62, v56
v_mul_f32 v63, v63, v56
v_accvgpr_write_b32 a80, v60
v_accvgpr_write_b32 a81, v61
v_accvgpr_write_b32 a82, v62
v_accvgpr_write_b32 a83, v63
v_accvgpr_read_b32 v60, a96
v_accvgpr_read_b32 v61, a97
v_accvgpr_read_b32 v62, a98
v_accvgpr_read_b32 v63, a99
v_mul_f32 v60, v60, v56
v_mul_f32 v61, v61, v56
v_mul_f32 v62, v62, v56
v_mul_f32 v63, v63, v56
v_mul_f32 v60, v60, v56
v_mul_f32 v61, v61, v56
v_mul_f32 v62, v62, v56
v_mul_f32 v63, v63, v56
v_accvgpr_write_b32 a96, v60
v_accvgpr_write_b32 a97, v61
v_accvgpr_write_b32 a98, v62
v_accvgpr_write_b32 a99, v63
v_accvgpr_read_b32 v60, a112
v_accvgpr_read_b32 v61, a113
v_accvgpr_read_b32 v62, a114
v_accvgpr_read_b32 v63, a115
v_mul_f32 v60, v60, v56
v_mul_f32 v61, v61, v56
v_mul_f32 v62, v62, v56
v_mul_f32 v63, v63, v56
v_mul_f32 v60, v60, v56
v_mul_f32 v61, v61, v56
v_mul_f32 v62, v62, v56
v_mul_f32 v63, v63, v56
v_accvgpr_write_b32 a112, v60
v_accvgpr_write_b32 a113, v61
v_accvgpr_write_b32 a114, v62
v_accvgpr_write_b32 a115, v63
v_accvgpr_read_b32 v60, a192
v_accvgpr_read_b32 v61, a193
v_accvgpr_read_b32 v62, a194
v_accvgpr_read_b32 v63, a195
v_mul_f32 v60, v60, v56
v_mul_f32 v61, v61, v56
v_mul_f32 v62, v62, v56
v_mul_f32 v63, v63, v56
v_mul_f32 v60, v60, v56
v_mul_f32 v61, v61, v56
v_mul_f32 v62, v62, v56
v_mul_f32 v63, v63, v56
v_accvgpr_write_b32 a192, v60
v_accvgpr_write_b32 a193, v61
v_accvgpr_write_b32 a194, v62
v_accvgpr_write_b32 a195, v63
v_accvgpr_read_b32 v60, a4
v_accvgpr_read_b32 v61, a5
v_accvgpr_read_b32 v62, a6
v_accvgpr_read_b32 v63, a7
v_mul_f32 v60, v60, v57
v_mul_f32 v61, v61, v57
v_mul_f32 v62, v62, v57
v_mul_f32 v63, v63, v57
v_mul_f32 v60, v60, v57
v_mul_f32 v61, v61, v57
v_mul_f32 v62, v62, v57
v_mul_f32 v63, v63, v57
v_accvgpr_write_b32 a4, v60
v_accvgpr_write_b32 a5, v61
v_accvgpr_write_b32 a6, v62
v_accvgpr_write_b32 a7, v63
v_accvgpr_read_b32 v60, a20
v_accvgpr_read_b32 v61, a21
v_accvgpr_read_b32 v62, a22
v_accvgpr_read_b32 v63, a23
v_mul_f32 v60, v60, v57
v_mul_f32 v61, v61, v57
v_mul_f32 v62, v62, v57
v_mul_f32 v63, v63, v57
v_mul_f32 v60, v60, v57
v_mul_f32 v61, v61, v57
v_mul_f32 v62, v62, v57
v_mul_f32 v63, v63, v57
v_accvgpr_write_b32 a20, v60
v_accvgpr_write_b32 a21, v61
v_accvgpr_write_b32 a22, v62
v_accvgpr_write_b32 a23, v63
v_accvgpr_read_b32 v60, a36
v_accvgpr_read_b32 v61, a37
v_accvgpr_read_b32 v62, a38
v_accvgpr_read_b32 v63, a39
v_mul_f32 v60, v60, v57
v_mul_f32 v61, v61, v57
v_mul_f32 v62, v62, v57
v_mul_f32 v63, v63, v57
v_mul_f32 v60, v60, v57
v_mul_f32 v61, v61, v57
v_mul_f32 v62, v62, v57
v_mul_f32 v63, v63, v57
v_accvgpr_write_b32 a36, v60
v_accvgpr_write_b32 a37, v61
v_accvgpr_write_b32 a38, v62
v_accvgpr_write_b32 a39, v63
v_accvgpr_read_b32 v60, a52
v_accvgpr_read_b32 v61, a53
v_accvgpr_read_b32 v62, a54
v_accvgpr_read_b32 v63, a55
v_mul_f32 v60, v60, v57
v_mul_f32 v61, v61, v57
v_mul_f32 v62, v62, v57
v_mul_f32 v63, v63, v57
v_mul_f32 v60, v60, v57
v_mul_f32 v61, v61, v57
v_mul_f32 v62, v62, v57
v_mul_f32 v63, v63, v57
v_accvgpr_write_b32 a52, v60
v_accvgpr_write_b32 a53, v61
v_accvgpr_write_b32 a54, v62
v_accvgpr_write_b32 a55, v63
v_accvgpr_read_b32 v60, a68
v_accvgpr_read_b32 v61, a69
v_accvgpr_read_b32 v62, a70
v_accvgpr_read_b32 v63, a71
v_mul_f32 v60, v60, v57
v_mul_f32 v61, v61, v57
v_mul_f32 v62, v62, v57
v_mul_f32 v63, v63, v57
v_mul_f32 v60, v60, v57
v_mul_f32 v61, v61, v57
v_mul_f32 v62, v62, v57
v_mul_f32 v63, v63, v57
v_accvgpr_write_b32 a68, v60
v_accvgpr_write_b32 a69, v61
v_accvgpr_write_b32 a70, v62
v_accvgpr_write_b32 a71, v63
v_accvgpr_read_b32 v60, a84
v_accvgpr_read_b32 v61, a85
v_accvgpr_read_b32 v62, a86
v_accvgpr_read_b32 v63, a87
v_mul_f32 v60, v60, v57
v_mul_f32 v61, v61, v57
v_mul_f32 v62, v62, v57
v_mul_f32 v63, v63, v57
v_mul_f32 v60, v60, v57
v_mul_f32 v61, v61, v57
v_mul_f32 v62, v62, v57
v_mul_f32 v63, v63, v57
v_accvgpr_write_b32 a84, v60
v_accvgpr_write_b32 a85, v61
v_accvgpr_write_b32 a86, v62
v_accvgpr_write_b32 a87, v63
v_accvgpr_read_b32 v60, a100
v_accvgpr_read_b32 v61, a101
v_accvgpr_read_b32 v62, a102
v_accvgpr_read_b32 v63, a103
v_mul_f32 v60, v60, v57
v_mul_f32 v61, v61, v57
v_mul_f32 v62, v62, v57
v_mul_f32 v63, v63, v57
v_mul_f32 v60, v60, v57
v_mul_f32 v61, v61, v57
v_mul_f32 v62, v62, v57
v_mul_f32 v63, v63, v57
v_accvgpr_write_b32 a100, v60
v_accvgpr_write_b32 a101, v61
v_accvgpr_write_b32 a102, v62
v_accvgpr_write_b32 a103, v63
v_accvgpr_read_b32 v60, a116
v_accvgpr_read_b32 v61, a117
v_accvgpr_read_b32 v62, a118
v_accvgpr_read_b32 v63, a119
v_mul_f32 v60, v60, v57
v_mul_f32 v61, v61, v57
v_mul_f32 v62, v62, v57
v_mul_f32 v63, v63, v57
v_mul_f32 v60, v60, v57
v_mul_f32 v61, v61, v57
v_mul_f32 v62, v62, v57
v_mul_f32 v63, v63, v57
v_accvgpr_write_b32 a116, v60
v_accvgpr_write_b32 a117, v61
v_accvgpr_write_b32 a118, v62
v_accvgpr_write_b32 a119, v63
v_accvgpr_read_b32 v60, a196
v_accvgpr_read_b32 v61, a197
v_accvgpr_read_b32 v62, a198
v_accvgpr_read_b32 v63, a199
v_mul_f32 v60, v60, v57
v_mul_f32 v61, v61, v57
v_mul_f32 v62, v62, v57
v_mul_f32 v63, v63, v57
v_mul_f32 v60, v60, v57
v_mul_f32 v61, v61, v57
v_mul_f32 v62, v62, v57
v_mul_f32 v63, v63, v57
v_accvgpr_write_b32 a196, v60
v_accvgpr_write_b32 a197, v61
v_accvgpr_write_b32 a198, v62
v_accvgpr_write_b32 a199, v63
v_accvgpr_read_b32 v60, a8
v_accvgpr_read_b32 v61, a9
v_accvgpr_read_b32 v62, a10
v_accvgpr_read_b32 v63, a11
v_mul_f32 v60, v60, v58
v_mul_f32 v61, v61, v58
v_mul_f32 v62, v62, v58
v_mul_f32 v63, v63, v58
v_mul_f32 v60, v60, v58
v_mul_f32 v61, v61, v58
v_mul_f32 v62, v62, v58
v_mul_f32 v63, v63, v58
v_accvgpr_write_b32 a8, v60
v_accvgpr_write_b32 a9, v61
v_accvgpr_write_b32 a10, v62
v_accvgpr_write_b32 a11, v63
v_accvgpr_read_b32 v60, a24
v_accvgpr_read_b32 v61, a25
v_accvgpr_read_b32 v62, a26
v_accvgpr_read_b32 v63, a27
v_mul_f32 v60, v60, v58
v_mul_f32 v61, v61, v58
v_mul_f32 v62, v62, v58
v_mul_f32 v63, v63, v58
v_mul_f32 v60, v60, v58
v_mul_f32 v61, v61, v58
v_mul_f32 v62, v62, v58
v_mul_f32 v63, v63, v58
v_accvgpr_write_b32 a24, v60
v_accvgpr_write_b32 a25, v61
v_accvgpr_write_b32 a26, v62
v_accvgpr_write_b32 a27, v63
v_accvgpr_read_b32 v60, a40
v_accvgpr_read_b32 v61, a41
v_accvgpr_read_b32 v62, a42
v_accvgpr_read_b32 v63, a43
v_mul_f32 v60, v60, v58
v_mul_f32 v61, v61, v58
v_mul_f32 v62, v62, v58
v_mul_f32 v63, v63, v58
v_mul_f32 v60, v60, v58
v_mul_f32 v61, v61, v58
v_mul_f32 v62, v62, v58
v_mul_f32 v63, v63, v58
v_accvgpr_write_b32 a40, v60
v_accvgpr_write_b32 a41, v61
v_accvgpr_write_b32 a42, v62
v_accvgpr_write_b32 a43, v63
v_accvgpr_read_b32 v60, a56
v_accvgpr_read_b32 v61, a57
v_accvgpr_read_b32 v62, a58
v_accvgpr_read_b32 v63, a59
v_mul_f32 v60, v60, v58
v_mul_f32 v61, v61, v58
v_mul_f32 v62, v62, v58
v_mul_f32 v63, v63, v58
v_mul_f32 v60, v60, v58
v_mul_f32 v61, v61, v58
v_mul_f32 v62, v62, v58
v_mul_f32 v63, v63, v58
v_accvgpr_write_b32 a56, v60
v_accvgpr_write_b32 a57, v61
v_accvgpr_write_b32 a58, v62
v_accvgpr_write_b32 a59, v63
v_accvgpr_read_b32 v60, a72
v_accvgpr_read_b32 v61, a73
v_accvgpr_read_b32 v62, a74
v_accvgpr_read_b32 v63, a75
v_mul_f32 v60, v60, v58
v_mul_f32 v61, v61, v58
v_mul_f32 v62, v62, v58
v_mul_f32 v63, v63, v58
v_mul_f32 v60, v60, v58
v_mul_f32 v61, v61, v58
v_mul_f32 v62, v62, v58
v_mul_f32 v63, v63, v58
v_accvgpr_write_b32 a72, v60
v_accvgpr_write_b32 a73, v61
v_accvgpr_write_b32 a74, v62
v_accvgpr_write_b32 a75, v63
v_accvgpr_read_b32 v60, a88
v_accvgpr_read_b32 v61, a89
v_accvgpr_read_b32 v62, a90
v_accvgpr_read_b32 v63, a91
v_mul_f32 v60, v60, v58
v_mul_f32 v61, v61, v58
v_mul_f32 v62, v62, v58
v_mul_f32 v63, v63, v58
v_mul_f32 v60, v60, v58
v_mul_f32 v61, v61, v58
v_mul_f32 v62, v62, v58
v_mul_f32 v63, v63, v58
v_accvgpr_write_b32 a88, v60
v_accvgpr_write_b32 a89, v61
v_accvgpr_write_b32 a90, v62
v_accvgpr_write_b32 a91, v63
v_accvgpr_read_b32 v60, a104
v_accvgpr_read_b32 v61, a105
v_accvgpr_read_b32 v62, a106
v_accvgpr_read_b32 v63, a107
v_mul_f32 v60, v60, v58
v_mul_f32 v61, v61, v58
v_mul_f32 v62, v62, v58
v_mul_f32 v63, v63, v58
v_mul_f32 v60, v60, v58
v_mul_f32 v61, v61, v58
v_mul_f32 v62, v62, v58
v_mul_f32 v63, v63, v58
v_accvgpr_write_b32 a104, v60
v_accvgpr_write_b32 a105, v61
v_accvgpr_write_b32 a106, v62
v_accvgpr_write_b32 a107, v63
v_accvgpr_read_b32 v60, a120
v_accvgpr_read_b32 v61, a121
v_accvgpr_read_b32 v62, a122
v_accvgpr_read_b32 v63, a123
v_mul_f32 v60, v60, v58
v_mul_f32 v61, v61, v58
v_mul_f32 v62, v62, v58
v_mul_f32 v63, v63, v58
v_mul_f32 v60, v60, v58
v_mul_f32 v61, v61, v58
v_mul_f32 v62, v62, v58
v_mul_f32 v63, v63, v58
v_accvgpr_write_b32 a120, v60
v_accvgpr_write_b32 a121, v61
v_accvgpr_write_b32 a122, v62
v_accvgpr_write_b32 a123, v63
v_accvgpr_read_b32 v60, a200
v_accvgpr_read_b32 v61, a201
v_accvgpr_read_b32 v62, a202
v_accvgpr_read_b32 v63, a203
v_mul_f32 v60, v60, v58
v_mul_f32 v61, v61, v58
v_mul_f32 v62, v62, v58
v_mul_f32 v63, v63, v58
v_mul_f32 v60, v60, v58
v_mul_f32 v61, v61, v58
v_mul_f32 v62, v62, v58
v_mul_f32 v63, v63, v58
v_accvgpr_write_b32 a200, v60
v_accvgpr_write_b32 a201, v61
v_accvgpr_write_b32 a202, v62
v_accvgpr_write_b32 a203, v63
v_accvgpr_read_b32 v60, a12
v_accvgpr_read_b32 v61, a13
v_accvgpr_read_b32 v62, a14
v_accvgpr_read_b32 v63, a15
v_mul_f32 v60, v60, v59
v_mul_f32 v61, v61, v59
v_mul_f32 v62, v62, v59
v_mul_f32 v63, v63, v59
v_mul_f32 v60, v60, v59
v_mul_f32 v61, v61, v59
v_mul_f32 v62, v62, v59
v_mul_f32 v63, v63, v59
v_accvgpr_write_b32 a12, v60
v_accvgpr_write_b32 a13, v61
v_accvgpr_write_b32 a14, v62
v_accvgpr_write_b32 a15, v63
v_accvgpr_read_b32 v60, a28
v_accvgpr_read_b32 v61, a29
v_accvgpr_read_b32 v62, a30
v_accvgpr_read_b32 v63, a31
v_mul_f32 v60, v60, v59
v_mul_f32 v61, v61, v59
v_mul_f32 v62, v62, v59
v_mul_f32 v63, v63, v59
v_mul_f32 v60, v60, v59
v_mul_f32 v61, v61, v59
v_mul_f32 v62, v62, v59
v_mul_f32 v63, v63, v59
v_accvgpr_write_b32 a28, v60
v_accvgpr_write_b32 a29, v61
v_accvgpr_write_b32 a30, v62
v_accvgpr_write_b32 a31, v63
v_accvgpr_read_b32 v60, a44
v_accvgpr_read_b32 v61, a45
v_accvgpr_read_b32 v62, a46
v_accvgpr_read_b32 v63, a47
v_mul_f32 v60, v60, v59
v_mul_f32 v61, v61, v59
v_mul_f32 v62, v62, v59
v_mul_f32 v63, v63, v59
v_mul_f32 v60, v60, v59
v_mul_f32 v61, v61, v59
v_mul_f32 v62, v62, v59
v_mul_f32 v63, v63, v59
v_accvgpr_write_b32 a44, v60
v_accvgpr_write_b32 a45, v61
v_accvgpr_write_b32 a46, v62
v_accvgpr_write_b32 a47, v63
v_accvgpr_read_b32 v60, a60
v_accvgpr_read_b32 v61, a61
v_accvgpr_read_b32 v62, a62
v_accvgpr_read_b32 v63, a63
v_mul_f32 v60, v60, v59
v_mul_f32 v61, v61, v59
v_mul_f32 v62, v62, v59
v_mul_f32 v63, v63, v59
v_mul_f32 v60, v60, v59
v_mul_f32 v61, v61, v59
v_mul_f32 v62, v62, v59
v_mul_f32 v63, v63, v59
v_accvgpr_write_b32 a60, v60
v_accvgpr_write_b32 a61, v61
v_accvgpr_write_b32 a62, v62
v_accvgpr_write_b32 a63, v63
v_accvgpr_read_b32 v60, a76
v_accvgpr_read_b32 v61, a77
v_accvgpr_read_b32 v62, a78
v_accvgpr_read_b32 v63, a79
v_mul_f32 v60, v60, v59
v_mul_f32 v61, v61, v59
v_mul_f32 v62, v62, v59
v_mul_f32 v63, v63, v59
v_mul_f32 v60, v60, v59
v_mul_f32 v61, v61, v59
v_mul_f32 v62, v62, v59
v_mul_f32 v63, v63, v59
v_accvgpr_write_b32 a76, v60
v_accvgpr_write_b32 a77, v61
v_accvgpr_write_b32 a78, v62
v_accvgpr_write_b32 a79, v63
v_accvgpr_read_b32 v60, a92
v_accvgpr_read_b32 v61, a93
v_accvgpr_read_b32 v62, a94
v_accvgpr_read_b32 v63, a95
v_mul_f32 v60, v60, v59
v_mul_f32 v61, v61, v59
v_mul_f32 v62, v62, v59
v_mul_f32 v63, v63, v59
v_mul_f32 v60, v60, v59
v_mul_f32 v61, v61, v59
v_mul_f32 v62, v62, v59
v_mul_f32 v63, v63, v59
v_accvgpr_write_b32 a92, v60
v_accvgpr_write_b32 a93, v61
v_accvgpr_write_b32 a94, v62
v_accvgpr_write_b32 a95, v63
v_accvgpr_read_b32 v60, a108
v_accvgpr_read_b32 v61, a109
v_accvgpr_read_b32 v62, a110
v_accvgpr_read_b32 v63, a111
v_mul_f32 v60, v60, v59
v_mul_f32 v61, v61, v59
v_mul_f32 v62, v62, v59
v_mul_f32 v63, v63, v59
v_mul_f32 v60, v60, v59
v_mul_f32 v61, v61, v59
v_mul_f32 v62, v62, v59
v_mul_f32 v63, v63, v59
v_accvgpr_write_b32 a108, v60
v_accvgpr_write_b32 a109, v61
v_accvgpr_write_b32 a110, v62
v_accvgpr_write_b32 a111, v63
v_accvgpr_read_b32 v60, a124
v_accvgpr_read_b32 v61, a125
v_accvgpr_read_b32 v62, a126
v_accvgpr_read_b32 v63, a127
v_mul_f32 v60, v60, v59
v_mul_f32 v61, v61, v59
v_mul_f32 v62, v62, v59
v_mul_f32 v63, v63, v59
v_mul_f32 v60, v60, v59
v_mul_f32 v61, v61, v59
v_mul_f32 v62, v62, v59
v_mul_f32 v63, v63, v59
v_accvgpr_write_b32 a124, v60
v_accvgpr_write_b32 a125, v61
v_accvgpr_write_b32 a126, v62
v_accvgpr_write_b32 a127, v63
v_accvgpr_read_b32 v60, a204
v_accvgpr_read_b32 v61, a205
v_accvgpr_read_b32 v62, a206
v_accvgpr_read_b32 v63, a207
v_mul_f32 v60, v60, v59
v_mul_f32 v61, v61, v59
v_mul_f32 v62, v62, v59
v_mul_f32 v63, v63, v59
v_mul_f32 v60, v60, v59
v_mul_f32 v61, v61, v59
v_mul_f32 v62, v62, v59
v_mul_f32 v63, v63, v59
v_accvgpr_write_b32 a204, v60
v_accvgpr_write_b32 a205, v61
v_accvgpr_write_b32 a206, v62
v_accvgpr_write_b32 a207, v63
s_mov_b32 s45, 0
s_nop 1
s_branch L_attn_kernel_rback_c_3
L_attn_kernel_afterrare:
s_lshl_b32 s61, s38, 1
s_lshr_b32 s40, s37, 4
s_add_u32 s61, s61, s40
s_lshl_b32 s61, s61, 7
s_add_u32 s61, s61, 77824
s_and_b32 s62, s37, 15
s_lshl_b32 s62, s62, 2
s_waitcnt vmcnt(0)
s_barrier
s_cmp_lg_u32 s32, 0
s_cbranch_scc1 L_attn_kernel_opub
s_add_u32 s52, s4, 0x80000
s_addc_u32 s53, s5, 0
s_mov_b32 s54, 0x20000
s_mov_b32 s55, 0x20000
v_mov_b32 v6, s62
v_mov_b32 v7, 1
s_mov_b64 s[46:47], exec
s_mov_b64 exec, 1
buffer_store_dword v7, v6, s[52:55], s61 offen sc1
s_mov_b64 exec, s[46:47]
L_attn_kernel_opub:
s_load_dwordx2 s[4:5], s[0:1], 104
s_load_dwordx2 s[6:7], s[0:1], 32
s_load_dwordx2 s[8:9], s[0:1], 0
s_load_dwordx2 s[10:11], s[0:1], 96
v_lshrrev_b32 v2, 6, v0
v_and_b32 v1, 63, v0
v_readfirstlane_b32 s32, v2
s_and_b32 s37, s2, 7
s_lshr_b32 s38, s2, 3
s_and_b32 s41, s37, 1
s_lshr_b32 s39, s37, 1
s_lshl_b32 s39, s39, 2
s_lshr_b32 s40, s38, 3
s_add_u32 s39, s39, s40
s_and_b32 s40, s38, 7
s_xor_b32 s58, s41, 1
s_lshl_b32 s44, s39, 3
s_add_u32 s44, s44, s40
s_lshl_b32 s35, s32, 12
v_lshrrev_b32 v4, 4, v1
v_and_b32 v5, 15, v1
v_lshlrev_b32 v3, 4, v1
v_mov_b32 v8, v3
v_add_u32 v9, 131072, v3
s_lshl_b32 s33, s39, 3
s_lshl_b32 s42, s32, 1
s_add_u32 s33, s33, s42
s_mul_i32 s33, s33, 131072
s_mul_i32 s42, s41, 65536
s_add_u32 s33, s33, s42
v_add_u32 v6, 0, v4
v_and_b32 v7, 7, v6
v_lshrrev_b32 v2, 1, v5
v_xor_b32 v7, v7, v2
v_lshlrev_b32 v7, 5, v7
v_and_b32 v2, 1, v5
v_lshl_add_u32 v7, v2, 4, v7
v_lshl_add_u32 v7, v6, 11, v7
v_subrev_u32 v10, 0, v7
v_add_u32 v6, 4, v4
v_and_b32 v7, 7, v6
v_lshrrev_b32 v2, 1, v5
v_xor_b32 v7, v7, v2
v_lshlrev_b32 v7, 5, v7
v_and_b32 v2, 1, v5
v_lshl_add_u32 v7, v2, 4, v7
v_lshl_add_u32 v7, v6, 11, v7
v_subrev_u32 v11, 1024, v7
v_add_u32 v6, 8, v4
v_and_b32 v7, 7, v6
v_lshrrev_b32 v2, 1, v5
v_xor_b32 v7, v7, v2
v_lshlrev_b32 v7, 5, v7
v_and_b32 v2, 1, v5
v_lshl_add_u32 v7, v2, 4, v7
v_lshl_add_u32 v7, v6, 11, v7
v_subrev_u32 v12, 2048, v7
v_add_u32 v6, 12, v4
v_and_b32 v7, 7, v6
v_lshrrev_b32 v2, 1, v5
v_xor_b32 v7, v7, v2
v_lshlrev_b32 v7, 5, v7
v_and_b32 v2, 1, v5
v_lshl_add_u32 v7, v2, 4, v7
v_lshl_add_u32 v7, v6, 11, v7
v_subrev_u32 v13, 3072, v7
s_mul_i32 s34, s41, 4194304
s_lshl_b32 s42, s32, 15
s_add_u32 s34, s34, s42
s_lshl_b32 s42, s40, 8
s_add_u32 s34, s34, s42
v_bfe_u32 v6, v1, 2, 2
v_lshl_add_u32 v6, v4, 2, v6
v_and_b32 v7, 7, v6
v_lshlrev_b32 v7, 5, v7
v_lshl_add_u32 v7, v6, 8, v7
v_and_b32 v6, 3, v1
v_lshl_add_u32 v7, v6, 3, v7
v_xor_b32 v16, 0, v7
v_xor_b32 v17, 32, v7
v_xor_b32 v18, 64, v7
v_xor_b32 v19, 96, v7
v_xor_b32 v20, 128, v7
v_xor_b32 v21, 160, v7
v_xor_b32 v22, 192, v7
v_xor_b32 v23, 224, v7
s_waitcnt lgkmcnt(0)
s_add_u32 s12, s4, 0x1000000
s_addc_u32 s13, s5, 0
s_mov_b32 s14, 0x1000000
s_mov_b32 s15, 0x20000
s_mov_b32 s16, s6
s_mov_b32 s17, s7
s_mov_b32 s18, 0x800000
s_mov_b32 s19, 0x20000
s_mov_b32 s20, s4
s_mov_b32 s21, s5
s_mov_b32 s22, 0x20000
s_mov_b32 s23, 0x20000
s_mov_b32 s24, s8
s_mov_b32 s25, s9
s_mov_b32 s26, 0x400000
s_mov_b32 s27, 0x20000
s_add_u32 s28, s4, 0x500000
s_addc_u32 s29, s5, 0
s_mov_b32 s30, 0x400000
s_mov_b32 s31, 0x20000
s_add_u32 s48, s4, 0x3000000
s_addc_u32 s49, s5, 0
s_mov_b32 s50, 0x800000
s_mov_b32 s51, 0x20000
s_add_u32 m0, s35, 0
s_nop 0
buffer_load_dwordx4 v10, s[16:19], s34 offen offset:0 lds
buffer_load_dwordx4 v11, s[16:19], s34 offen offset:1024 lds
buffer_load_dwordx4 v12, s[16:19], s34 offen offset:2048 lds
buffer_load_dwordx4 v13, s[16:19], s34 offen offset:3072 lds
s_add_u32 s34, s34, 131072
s_add_u32 m0, s35, 16384
s_nop 0
buffer_load_dwordx4 v10, s[16:19], s34 offen offset:0 lds
buffer_load_dwordx4 v11, s[16:19], s34 offen offset:1024 lds
buffer_load_dwordx4 v12, s[16:19], s34 offen offset:2048 lds
buffer_load_dwordx4 v13, s[16:19], s34 offen offset:3072 lds
s_add_u32 s34, s34, 131072
s_add_u32 s52, s4, 0x80000
s_addc_u32 s53, s5, 0
s_mov_b32 s54, 0x20000
s_mov_b32 s55, 0x20000
s_cmp_lg_u32 s32, 0
s_cbranch_scc1 L_attn_kernel_wo_dpolled
s_lshr_b32 s42, s39, 1
s_lshl_b32 s42, s42, 1
s_add_u32 s42, s42, s41
s_lshl_b32 s42, s42, 7
s_add_u32 s42, s42, 77824
v_lshlrev_b32 v6, 2, v1
s_mov_b32 s43, 0x40000
s_mov_b64 s[46:47], exec
s_mov_b32 exec_lo, 0xffff
s_mov_b32 exec_hi, 0
L_attn_kernel_wo_dpoll:
buffer_load_dword v7, v6, s[52:55], s42 offen sc1
s_waitcnt vmcnt(0)
v_cmp_ne_u32 vcc, 1, v7
s_sub_u32 s43, s43, 1
s_cmp_eq_u32 s43, 0
s_cbranch_scc1 L_attn_kernel_wo_dpdone
s_cbranch_vccnz L_attn_kernel_wo_dpoll
L_attn_kernel_wo_dpdone:
s_mov_b64 exec, s[46:47]
L_attn_kernel_wo_dpolled:
s_barrier
buffer_load_dwordx4 v[64:67], v8, s[12:15], s33 offen offset:0 sc1
buffer_load_dwordx4 v[68:71], v9, s[12:15], s33 offen offset:0 sc1
buffer_load_dwordx4 v[72:75], v8, s[12:15], s33 offen offset:1024 sc1
buffer_load_dwordx4 v[76:79], v9, s[12:15], s33 offen offset:1024 sc1
s_add_u32 s33, s33, 2048
buffer_load_dwordx4 v[80:83], v8, s[12:15], s33 offen offset:0 sc1
buffer_load_dwordx4 v[84:87], v9, s[12:15], s33 offen offset:0 sc1
buffer_load_dwordx4 v[88:91], v8, s[12:15], s33 offen offset:1024 sc1
buffer_load_dwordx4 v[92:95], v9, s[12:15], s33 offen offset:1024 sc1
s_add_u32 s33, s33, 2048
s_waitcnt vmcnt(12)
s_barrier
ds_read_b64_tr_b16 a[64:65], v16 offset:0
ds_read_b64_tr_b16 a[66:67], v16 offset:4096
ds_read_b64_tr_b16 a[68:69], v16 offset:8192
ds_read_b64_tr_b16 a[70:71], v16 offset:12288
ds_read_b64_tr_b16 a[72:73], v17 offset:0
ds_read_b64_tr_b16 a[74:75], v17 offset:4096
ds_read_b64_tr_b16 a[76:77], v17 offset:8192
ds_read_b64_tr_b16 a[78:79], v17 offset:12288
ds_read_b64_tr_b16 a[80:81], v18 offset:0
ds_read_b64_tr_b16 a[82:83], v18 offset:4096
ds_read_b64_tr_b16 a[84:85], v18 offset:8192
ds_read_b64_tr_b16 a[86:87], v18 offset:12288
ds_read_b64_tr_b16 a[88:89], v19 offset:0
ds_read_b64_tr_b16 a[90:91], v19 offset:4096
ds_read_b64_tr_b16 a[92:93], v19 offset:8192
ds_read_b64_tr_b16 a[94:95], v19 offset:12288
s_waitcnt vmcnt(4) lgkmcnt(8)
v_mfma_f32_16x16x32_bf16 a[0:3], a[64:67], v[64:67], 0
ds_read_b64_tr_b16 a[96:97], v20 offset:0
s_add_u32 m0, s35, 32768
v_mfma_f32_16x16x32_bf16 a[0:3], a[68:71], v[72:75], a[0:3]
buffer_load_dwordx4 v10, s[16:19], s34 offen offset:0 lds
v_mfma_f32_16x16x32_bf16 a[4:7], a[64:67], v[68:71], 0
ds_read_b64_tr_b16 a[98:99], v20 offset:4096
ds_read_b64_tr_b16 a[100:101], v20 offset:8192
v_mfma_f32_16x16x32_bf16 a[4:7], a[68:71], v[76:79], a[4:7]
buffer_load_dwordx4 v[96:99], v8, s[12:15], s33 offen offset:0 sc1
ds_read_b64_tr_b16 a[102:103], v20 offset:12288
v_mfma_f32_16x16x32_bf16 a[8:11], a[72:75], v[64:67], 0
buffer_load_dwordx4 v11, s[16:19], s34 offen offset:1024 lds
ds_read_b64_tr_b16 a[104:105], v21 offset:0
v_mfma_f32_16x16x32_bf16 a[8:11], a[76:79], v[72:75], a[8:11]
v_mfma_f32_16x16x32_bf16 a[12:15], a[72:75], v[68:71], 0
buffer_load_dwordx4 v12, s[16:19], s34 offen offset:2048 lds
buffer_load_dwordx4 v[100:103], v9, s[12:15], s33 offen offset:0 sc1
ds_read_b64_tr_b16 a[106:107], v21 offset:4096
ds_read_b64_tr_b16 a[108:109], v21 offset:8192
v_mfma_f32_16x16x32_bf16 a[12:15], a[76:79], v[76:79], a[12:15]
ds_read_b64_tr_b16 a[110:111], v21 offset:12288
s_waitcnt lgkmcnt(8)
v_mfma_f32_16x16x32_bf16 a[16:19], a[80:83], v[64:67], 0
buffer_load_dwordx4 v13, s[16:19], s34 offen offset:3072 lds
ds_read_b64_tr_b16 a[112:113], v22 offset:0
v_mfma_f32_16x16x32_bf16 a[16:19], a[84:87], v[72:75], a[16:19]
buffer_load_dwordx4 v[104:107], v8, s[12:15], s33 offen offset:1024 sc1
v_mfma_f32_16x16x32_bf16 a[20:23], a[80:83], v[68:71], 0
ds_read_b64_tr_b16 a[114:115], v22 offset:4096
ds_read_b64_tr_b16 a[116:117], v22 offset:8192
v_mfma_f32_16x16x32_bf16 a[20:23], a[84:87], v[76:79], a[20:23]
ds_read_b64_tr_b16 a[118:119], v22 offset:12288
s_add_u32 s34, s34, 131072
v_mfma_f32_16x16x32_bf16 a[24:27], a[88:91], v[64:67], 0
buffer_load_dwordx4 v[108:111], v9, s[12:15], s33 offen offset:1024 sc1
ds_read_b64_tr_b16 a[120:121], v23 offset:0
v_mfma_f32_16x16x32_bf16 a[24:27], a[92:95], v[72:75], a[24:27]
s_add_u32 s33, s33, 2048
v_mfma_f32_16x16x32_bf16 a[28:31], a[88:91], v[68:71], 0
buffer_load_dwordx4 v[112:115], v8, s[12:15], s33 offen offset:0 sc1
ds_read_b64_tr_b16 a[122:123], v23 offset:4096
ds_read_b64_tr_b16 a[124:125], v23 offset:8192
v_mfma_f32_16x16x32_bf16 a[28:31], a[92:95], v[76:79], a[28:31]
ds_read_b64_tr_b16 a[126:127], v23 offset:12288
s_waitcnt vmcnt(17) lgkmcnt(8)
s_barrier
v_mfma_f32_16x16x32_bf16 a[32:35], a[96:99], v[64:67], 0
ds_read_b64_tr_b16 a[64:65], v16 offset:16384
s_add_u32 m0, s35, 49152
v_mfma_f32_16x16x32_bf16 a[32:35], a[100:103], v[72:75], a[32:35]
buffer_load_dwordx4 v10, s[16:19], s34 offen offset:0 lds
buffer_load_dwordx4 v[116:119], v9, s[12:15], s33 offen offset:0 sc1
v_mfma_f32_16x16x32_bf16 a[36:39], a[96:99], v[68:71], 0
ds_read_b64_tr_b16 a[66:67], v16 offset:20480
ds_read_b64_tr_b16 a[68:69], v16 offset:24576
v_mfma_f32_16x16x32_bf16 a[36:39], a[100:103], v[76:79], a[36:39]
ds_read_b64_tr_b16 a[70:71], v16 offset:28672
v_mfma_f32_16x16x32_bf16 a[40:43], a[104:107], v[64:67], 0
ds_read_b64_tr_b16 a[72:73], v17 offset:16384
v_mfma_f32_16x16x32_bf16 a[40:43], a[108:111], v[72:75], a[40:43]
buffer_load_dwordx4 v11, s[16:19], s34 offen offset:1024 lds
buffer_load_dwordx4 v[120:123], v8, s[12:15], s33 offen offset:1024 sc1
v_mfma_f32_16x16x32_bf16 a[44:47], a[104:107], v[68:71], 0
ds_read_b64_tr_b16 a[74:75], v17 offset:20480
ds_read_b64_tr_b16 a[76:77], v17 offset:24576
v_mfma_f32_16x16x32_bf16 a[44:47], a[108:111], v[76:79], a[44:47]
ds_read_b64_tr_b16 a[78:79], v17 offset:28672
s_waitcnt lgkmcnt(8)
v_mfma_f32_16x16x32_bf16 a[48:51], a[112:115], v[64:67], 0
ds_read_b64_tr_b16 a[80:81], v18 offset:16384
v_mfma_f32_16x16x32_bf16 a[48:51], a[116:119], v[72:75], a[48:51]
buffer_load_dwordx4 v12, s[16:19], s34 offen offset:2048 lds
buffer_load_dwordx4 v[124:127], v9, s[12:15], s33 offen offset:1024 sc1
v_mfma_f32_16x16x32_bf16 a[52:55], a[112:115], v[68:71], 0
ds_read_b64_tr_b16 a[82:83], v18 offset:20480
ds_read_b64_tr_b16 a[84:85], v18 offset:24576
v_mfma_f32_16x16x32_bf16 a[52:55], a[116:119], v[76:79], a[52:55]
ds_read_b64_tr_b16 a[86:87], v18 offset:28672
s_add_u32 s33, s33, 2048
v_mfma_f32_16x16x32_bf16 a[56:59], a[120:123], v[64:67], 0
ds_read_b64_tr_b16 a[88:89], v19 offset:16384
v_mfma_f32_16x16x32_bf16 a[56:59], a[124:127], v[72:75], a[56:59]
buffer_load_dwordx4 v13, s[16:19], s34 offen offset:3072 lds
v_mfma_f32_16x16x32_bf16 a[60:63], a[120:123], v[68:71], 0
ds_read_b64_tr_b16 a[90:91], v19 offset:20480
ds_read_b64_tr_b16 a[92:93], v19 offset:24576
v_mfma_f32_16x16x32_bf16 a[60:63], a[124:127], v[76:79], a[60:63]
ds_read_b64_tr_b16 a[94:95], v19 offset:28672
s_waitcnt vmcnt(16) lgkmcnt(8)
v_mfma_f32_16x16x32_bf16 a[0:3], a[64:67], v[80:83], a[0:3]
ds_read_b64_tr_b16 a[96:97], v20 offset:16384
s_add_u32 s34, s34, 131072
v_mfma_f32_16x16x32_bf16 a[0:3], a[68:71], v[88:91], a[0:3]
buffer_load_dwordx4 v[64:67], v8, s[12:15], s33 offen offset:0 sc1
v_mfma_f32_16x16x32_bf16 a[4:7], a[64:67], v[84:87], a[4:7]
ds_read_b64_tr_b16 a[98:99], v20 offset:20480
ds_read_b64_tr_b16 a[100:101], v20 offset:24576
v_mfma_f32_16x16x32_bf16 a[4:7], a[68:71], v[92:95], a[4:7]
ds_read_b64_tr_b16 a[102:103], v20 offset:28672
v_mfma_f32_16x16x32_bf16 a[8:11], a[72:75], v[80:83], a[8:11]
ds_read_b64_tr_b16 a[104:105], v21 offset:16384
v_mfma_f32_16x16x32_bf16 a[8:11], a[76:79], v[88:91], a[8:11]
buffer_load_dwordx4 v[68:71], v9, s[12:15], s33 offen offset:0 sc1
v_mfma_f32_16x16x32_bf16 a[12:15], a[72:75], v[84:87], a[12:15]
ds_read_b64_tr_b16 a[106:107], v21 offset:20480
ds_read_b64_tr_b16 a[108:109], v21 offset:24576
v_mfma_f32_16x16x32_bf16 a[12:15], a[76:79], v[92:95], a[12:15]
ds_read_b64_tr_b16 a[110:111], v21 offset:28672
s_waitcnt lgkmcnt(8)
v_mfma_f32_16x16x32_bf16 a[16:19], a[80:83], v[80:83], a[16:19]
ds_read_b64_tr_b16 a[112:113], v22 offset:16384
v_mfma_f32_16x16x32_bf16 a[16:19], a[84:87], v[88:91], a[16:19]
buffer_load_dwordx4 v[72:75], v8, s[12:15], s33 offen offset:1024 sc1
v_mfma_f32_16x16x32_bf16 a[20:23], a[80:83], v[84:87], a[20:23]
ds_read_b64_tr_b16 a[114:115], v22 offset:20480
ds_read_b64_tr_b16 a[116:117], v22 offset:24576
v_mfma_f32_16x16x32_bf16 a[20:23], a[84:87], v[92:95], a[20:23]
ds_read_b64_tr_b16 a[118:119], v22 offset:28672
v_mfma_f32_16x16x32_bf16 a[24:27], a[88:91], v[80:83], a[24:27]
ds_read_b64_tr_b16 a[120:121], v23 offset:16384
v_mfma_f32_16x16x32_bf16 a[24:27], a[92:95], v[88:91], a[24:27]
buffer_load_dwordx4 v[76:79], v9, s[12:15], s33 offen offset:1024 sc1
v_mfma_f32_16x16x32_bf16 a[28:31], a[88:91], v[84:87], a[28:31]
ds_read_b64_tr_b16 a[122:123], v23 offset:20480
ds_read_b64_tr_b16 a[124:125], v23 offset:24576
v_mfma_f32_16x16x32_bf16 a[28:31], a[92:95], v[92:95], a[28:31]
ds_read_b64_tr_b16 a[126:127], v23 offset:28672
s_waitcnt vmcnt(14) lgkmcnt(8)
s_barrier
v_mfma_f32_16x16x32_bf16 a[32:35], a[96:99], v[80:83], a[32:35]
ds_read_b64_tr_b16 a[64:65], v16 offset:32768
s_add_u32 m0, s35, 0
v_mfma_f32_16x16x32_bf16 a[32:35], a[100:103], v[88:91], a[32:35]
buffer_load_dwordx4 v10, s[16:19], s34 offen offset:0 lds
v_mfma_f32_16x16x32_bf16 a[36:39], a[96:99], v[84:87], a[36:39]
ds_read_b64_tr_b16 a[66:67], v16 offset:36864
ds_read_b64_tr_b16 a[68:69], v16 offset:40960
v_mfma_f32_16x16x32_bf16 a[36:39], a[100:103], v[92:95], a[36:39]
ds_read_b64_tr_b16 a[70:71], v16 offset:45056
s_add_u32 s33, s33, 2048
v_mfma_f32_16x16x32_bf16 a[40:43], a[104:107], v[80:83], a[40:43]
ds_read_b64_tr_b16 a[72:73], v17 offset:32768
v_mfma_f32_16x16x32_bf16 a[40:43], a[108:111], v[88:91], a[40:43]
buffer_load_dwordx4 v11, s[16:19], s34 offen offset:1024 lds
v_mfma_f32_16x16x32_bf16 a[44:47], a[104:107], v[84:87], a[44:47]
ds_read_b64_tr_b16 a[74:75], v17 offset:36864
ds_read_b64_tr_b16 a[76:77], v17 offset:40960
v_mfma_f32_16x16x32_bf16 a[44:47], a[108:111], v[92:95], a[44:47]
ds_read_b64_tr_b16 a[78:79], v17 offset:45056
s_waitcnt lgkmcnt(8)
v_mfma_f32_16x16x32_bf16 a[48:51], a[112:115], v[80:83], a[48:51]
ds_read_b64_tr_b16 a[80:81], v18 offset:32768
v_mfma_f32_16x16x32_bf16 a[48:51], a[116:119], v[88:91], a[48:51]
buffer_load_dwordx4 v12, s[16:19], s34 offen offset:2048 lds
v_mfma_f32_16x16x32_bf16 a[52:55], a[112:115], v[84:87], a[52:55]
ds_read_b64_tr_b16 a[82:83], v18 offset:36864
ds_read_b64_tr_b16 a[84:85], v18 offset:40960
v_mfma_f32_16x16x32_bf16 a[52:55], a[116:119], v[92:95], a[52:55]
ds_read_b64_tr_b16 a[86:87], v18 offset:45056
v_mfma_f32_16x16x32_bf16 a[56:59], a[120:123], v[80:83], a[56:59]
ds_read_b64_tr_b16 a[88:89], v19 offset:32768
v_mfma_f32_16x16x32_bf16 a[56:59], a[124:127], v[88:91], a[56:59]
buffer_load_dwordx4 v13, s[16:19], s34 offen offset:3072 lds
v_mfma_f32_16x16x32_bf16 a[60:63], a[120:123], v[84:87], a[60:63]
ds_read_b64_tr_b16 a[90:91], v19 offset:36864
ds_read_b64_tr_b16 a[92:93], v19 offset:40960
v_mfma_f32_16x16x32_bf16 a[60:63], a[124:127], v[92:95], a[60:63]
ds_read_b64_tr_b16 a[94:95], v19 offset:45056
s_waitcnt vmcnt(16) lgkmcnt(8)
v_mfma_f32_16x16x32_bf16 a[0:3], a[64:67], v[96:99], a[0:3]
ds_read_b64_tr_b16 a[96:97], v20 offset:32768
s_add_u32 s34, s34, 131072
v_mfma_f32_16x16x32_bf16 a[0:3], a[68:71], v[104:107], a[0:3]
buffer_load_dwordx4 v[80:83], v8, s[12:15], s33 offen offset:0 sc1
v_mfma_f32_16x16x32_bf16 a[4:7], a[64:67], v[100:103], a[4:7]
ds_read_b64_tr_b16 a[98:99], v20 offset:36864
ds_read_b64_tr_b16 a[100:101], v20 offset:40960
v_mfma_f32_16x16x32_bf16 a[4:7], a[68:71], v[108:111], a[4:7]
ds_read_b64_tr_b16 a[102:103], v20 offset:45056
v_mfma_f32_16x16x32_bf16 a[8:11], a[72:75], v[96:99], a[8:11]
ds_read_b64_tr_b16 a[104:105], v21 offset:32768
v_mfma_f32_16x16x32_bf16 a[8:11], a[76:79], v[104:107], a[8:11]
buffer_load_dwordx4 v[84:87], v9, s[12:15], s33 offen offset:0 sc1
v_mfma_f32_16x16x32_bf16 a[12:15], a[72:75], v[100:103], a[12:15]
ds_read_b64_tr_b16 a[106:107], v21 offset:36864
ds_read_b64_tr_b16 a[108:109], v21 offset:40960
v_mfma_f32_16x16x32_bf16 a[12:15], a[76:79], v[108:111], a[12:15]
ds_read_b64_tr_b16 a[110:111], v21 offset:45056
s_waitcnt lgkmcnt(8)
v_mfma_f32_16x16x32_bf16 a[16:19], a[80:83], v[96:99], a[16:19]
ds_read_b64_tr_b16 a[112:113], v22 offset:32768
v_mfma_f32_16x16x32_bf16 a[16:19], a[84:87], v[104:107], a[16:19]
buffer_load_dwordx4 v[88:91], v8, s[12:15], s33 offen offset:1024 sc1
v_mfma_f32_16x16x32_bf16 a[20:23], a[80:83], v[100:103], a[20:23]
ds_read_b64_tr_b16 a[114:115], v22 offset:36864
ds_read_b64_tr_b16 a[116:117], v22 offset:40960
v_mfma_f32_16x16x32_bf16 a[20:23], a[84:87], v[108:111], a[20:23]
ds_read_b64_tr_b16 a[118:119], v22 offset:45056
v_mfma_f32_16x16x32_bf16 a[24:27], a[88:91], v[96:99], a[24:27]
ds_read_b64_tr_b16 a[120:121], v23 offset:32768
v_mfma_f32_16x16x32_bf16 a[24:27], a[92:95], v[104:107], a[24:27]
buffer_load_dwordx4 v[92:95], v9, s[12:15], s33 offen offset:1024 sc1
v_mfma_f32_16x16x32_bf16 a[28:31], a[88:91], v[100:103], a[28:31]
ds_read_b64_tr_b16 a[122:123], v23 offset:36864
ds_read_b64_tr_b16 a[124:125], v23 offset:40960
v_mfma_f32_16x16x32_bf16 a[28:31], a[92:95], v[108:111], a[28:31]
ds_read_b64_tr_b16 a[126:127], v23 offset:45056
s_waitcnt vmcnt(12) lgkmcnt(8)
s_barrier
v_mfma_f32_16x16x32_bf16 a[32:35], a[96:99], v[96:99], a[32:35]
ds_read_b64_tr_b16 a[64:65], v16 offset:49152
s_add_u32 m0, s35, 16384
v_mfma_f32_16x16x32_bf16 a[32:35], a[100:103], v[104:107], a[32:35]
buffer_load_dwordx4 v10, s[16:19], s34 offen offset:0 lds
v_mfma_f32_16x16x32_bf16 a[36:39], a[96:99], v[100:103], a[36:39]
ds_read_b64_tr_b16 a[66:67], v16 offset:53248
ds_read_b64_tr_b16 a[68:69], v16 offset:57344
v_mfma_f32_16x16x32_bf16 a[36:39], a[100:103], v[108:111], a[36:39]
ds_read_b64_tr_b16 a[70:71], v16 offset:61440
s_add_u32 s33, s33, 2048
v_mfma_f32_16x16x32_bf16 a[40:43], a[104:107], v[96:99], a[40:43]
ds_read_b64_tr_b16 a[72:73], v17 offset:49152
v_mfma_f32_16x16x32_bf16 a[40:43], a[108:111], v[104:107], a[40:43]
buffer_load_dwordx4 v11, s[16:19], s34 offen offset:1024 lds
v_mfma_f32_16x16x32_bf16 a[44:47], a[104:107], v[100:103], a[44:47]
ds_read_b64_tr_b16 a[74:75], v17 offset:53248
ds_read_b64_tr_b16 a[76:77], v17 offset:57344
v_mfma_f32_16x16x32_bf16 a[44:47], a[108:111], v[108:111], a[44:47]
ds_read_b64_tr_b16 a[78:79], v17 offset:61440
s_waitcnt lgkmcnt(8)
v_mfma_f32_16x16x32_bf16 a[48:51], a[112:115], v[96:99], a[48:51]
ds_read_b64_tr_b16 a[80:81], v18 offset:49152
v_mfma_f32_16x16x32_bf16 a[48:51], a[116:119], v[104:107], a[48:51]
buffer_load_dwordx4 v12, s[16:19], s34 offen offset:2048 lds
v_mfma_f32_16x16x32_bf16 a[52:55], a[112:115], v[100:103], a[52:55]
ds_read_b64_tr_b16 a[82:83], v18 offset:53248
ds_read_b64_tr_b16 a[84:85], v18 offset:57344
v_mfma_f32_16x16x32_bf16 a[52:55], a[116:119], v[108:111], a[52:55]
ds_read_b64_tr_b16 a[86:87], v18 offset:61440
v_mfma_f32_16x16x32_bf16 a[56:59], a[120:123], v[96:99], a[56:59]
ds_read_b64_tr_b16 a[88:89], v19 offset:49152
v_mfma_f32_16x16x32_bf16 a[56:59], a[124:127], v[104:107], a[56:59]
buffer_load_dwordx4 v13, s[16:19], s34 offen offset:3072 lds
v_mfma_f32_16x16x32_bf16 a[60:63], a[120:123], v[100:103], a[60:63]
ds_read_b64_tr_b16 a[90:91], v19 offset:53248
ds_read_b64_tr_b16 a[92:93], v19 offset:57344
v_mfma_f32_16x16x32_bf16 a[60:63], a[124:127], v[108:111], a[60:63]
ds_read_b64_tr_b16 a[94:95], v19 offset:61440
s_waitcnt vmcnt(17) lgkmcnt(8)
v_mfma_f32_16x16x32_bf16 a[0:3], a[64:67], v[112:115], a[0:3]
ds_read_b64_tr_b16 a[96:97], v20 offset:49152
s_add_u32 s34, s34, 131072
v_mfma_f32_16x16x32_bf16 a[0:3], a[68:71], v[120:123], a[0:3]
buffer_load_dwordx4 v[96:99], v8, s[12:15], s33 offen offset:0 sc1
v_mfma_f32_16x16x32_bf16 a[4:7], a[64:67], v[116:119], a[4:7]
ds_read_b64_tr_b16 a[98:99], v20 offset:53248
ds_read_b64_tr_b16 a[100:101], v20 offset:57344
v_mfma_f32_16x16x32_bf16 a[4:7], a[68:71], v[124:127], a[4:7]
ds_read_b64_tr_b16 a[102:103], v20 offset:61440
v_mfma_f32_16x16x32_bf16 a[8:11], a[72:75], v[112:115], a[8:11]
ds_read_b64_tr_b16 a[104:105], v21 offset:49152
v_mfma_f32_16x16x32_bf16 a[8:11], a[76:79], v[120:123], a[8:11]
buffer_load_dwordx4 v[100:103], v9, s[12:15], s33 offen offset:0 sc1
v_mfma_f32_16x16x32_bf16 a[12:15], a[72:75], v[116:119], a[12:15]
ds_read_b64_tr_b16 a[106:107], v21 offset:53248
ds_read_b64_tr_b16 a[108:109], v21 offset:57344
v_mfma_f32_16x16x32_bf16 a[12:15], a[76:79], v[124:127], a[12:15]
ds_read_b64_tr_b16 a[110:111], v21 offset:61440
s_waitcnt lgkmcnt(8)
v_mfma_f32_16x16x32_bf16 a[16:19], a[80:83], v[112:115], a[16:19]
ds_read_b64_tr_b16 a[112:113], v22 offset:49152
v_mfma_f32_16x16x32_bf16 a[16:19], a[84:87], v[120:123], a[16:19]
buffer_load_dwordx4 v[104:107], v8, s[12:15], s33 offen offset:1024 sc1
v_mfma_f32_16x16x32_bf16 a[20:23], a[80:83], v[116:119], a[20:23]
ds_read_b64_tr_b16 a[114:115], v22 offset:53248
ds_read_b64_tr_b16 a[116:117], v22 offset:57344
v_mfma_f32_16x16x32_bf16 a[20:23], a[84:87], v[124:127], a[20:23]
ds_read_b64_tr_b16 a[118:119], v22 offset:61440
v_mfma_f32_16x16x32_bf16 a[24:27], a[88:91], v[112:115], a[24:27]
ds_read_b64_tr_b16 a[120:121], v23 offset:49152
v_mfma_f32_16x16x32_bf16 a[24:27], a[92:95], v[120:123], a[24:27]
buffer_load_dwordx4 v[108:111], v9, s[12:15], s33 offen offset:1024 sc1
v_mfma_f32_16x16x32_bf16 a[28:31], a[88:91], v[116:119], a[28:31]
ds_read_b64_tr_b16 a[122:123], v23 offset:53248
ds_read_b64_tr_b16 a[124:125], v23 offset:57344
v_mfma_f32_16x16x32_bf16 a[28:31], a[92:95], v[124:127], a[28:31]
ds_read_b64_tr_b16 a[126:127], v23 offset:61440
s_waitcnt vmcnt(12) lgkmcnt(8)
s_barrier
v_mfma_f32_16x16x32_bf16 a[32:35], a[96:99], v[112:115], a[32:35]
ds_read_b64_tr_b16 a[64:65], v16 offset:0
s_add_u32 m0, s35, 32768
v_mfma_f32_16x16x32_bf16 a[32:35], a[100:103], v[120:123], a[32:35]
buffer_load_dwordx4 v10, s[16:19], s34 offen offset:0 lds
v_mfma_f32_16x16x32_bf16 a[36:39], a[96:99], v[116:119], a[36:39]
ds_read_b64_tr_b16 a[66:67], v16 offset:4096
ds_read_b64_tr_b16 a[68:69], v16 offset:8192
v_mfma_f32_16x16x32_bf16 a[36:39], a[100:103], v[124:127], a[36:39]
ds_read_b64_tr_b16 a[70:71], v16 offset:12288
s_add_u32 s33, s33, 2048
v_mfma_f32_16x16x32_bf16 a[40:43], a[104:107], v[112:115], a[40:43]
ds_read_b64_tr_b16 a[72:73], v17 offset:0
v_mfma_f32_16x16x32_bf16 a[40:43], a[108:111], v[120:123], a[40:43]
buffer_load_dwordx4 v11, s[16:19], s34 offen offset:1024 lds
v_mfma_f32_16x16x32_bf16 a[44:47], a[104:107], v[116:119], a[44:47]
ds_read_b64_tr_b16 a[74:75], v17 offset:4096
ds_read_b64_tr_b16 a[76:77], v17 offset:8192
v_mfma_f32_16x16x32_bf16 a[44:47], a[108:111], v[124:127], a[44:47]
ds_read_b64_tr_b16 a[78:79], v17 offset:12288
s_waitcnt lgkmcnt(8)
v_mfma_f32_16x16x32_bf16 a[48:51], a[112:115], v[112:115], a[48:51]
ds_read_b64_tr_b16 a[80:81], v18 offset:0
v_mfma_f32_16x16x32_bf16 a[48:51], a[116:119], v[120:123], a[48:51]
buffer_load_dwordx4 v12, s[16:19], s34 offen offset:2048 lds
v_mfma_f32_16x16x32_bf16 a[52:55], a[112:115], v[116:119], a[52:55]
ds_read_b64_tr_b16 a[82:83], v18 offset:4096
ds_read_b64_tr_b16 a[84:85], v18 offset:8192
v_mfma_f32_16x16x32_bf16 a[52:55], a[116:119], v[124:127], a[52:55]
ds_read_b64_tr_b16 a[86:87], v18 offset:12288
v_mfma_f32_16x16x32_bf16 a[56:59], a[120:123], v[112:115], a[56:59]
ds_read_b64_tr_b16 a[88:89], v19 offset:0
v_mfma_f32_16x16x32_bf16 a[56:59], a[124:127], v[120:123], a[56:59]
buffer_load_dwordx4 v13, s[16:19], s34 offen offset:3072 lds
v_mfma_f32_16x16x32_bf16 a[60:63], a[120:123], v[116:119], a[60:63]
ds_read_b64_tr_b16 a[90:91], v19 offset:4096
ds_read_b64_tr_b16 a[92:93], v19 offset:8192
v_mfma_f32_16x16x32_bf16 a[60:63], a[124:127], v[124:127], a[60:63]
ds_read_b64_tr_b16 a[94:95], v19 offset:12288
s_add_u32 s34, s34, 131072
s_mov_b32 s36, 6
L_attn_kernel_wo_loop:
s_waitcnt vmcnt(20) lgkmcnt(8)
v_mfma_f32_16x16x32_bf16 a[0:3], a[64:67], v[64:67], a[0:3]
ds_read_b64_tr_b16 a[96:97], v20 offset:0
v_mfma_f32_16x16x32_bf16 a[0:3], a[68:71], v[72:75], a[0:3]
buffer_load_dwordx4 v[112:115], v8, s[12:15], s33 offen offset:0 sc1
v_mfma_f32_16x16x32_bf16 a[4:7], a[64:67], v[68:71], a[4:7]
ds_read_b64_tr_b16 a[98:99], v20 offset:4096
ds_read_b64_tr_b16 a[100:101], v20 offset:8192
v_mfma_f32_16x16x32_bf16 a[4:7], a[68:71], v[76:79], a[4:7]
ds_read_b64_tr_b16 a[102:103], v20 offset:12288
v_mfma_f32_16x16x32_bf16 a[8:11], a[72:75], v[64:67], a[8:11]
ds_read_b64_tr_b16 a[104:105], v21 offset:0
v_mfma_f32_16x16x32_bf16 a[8:11], a[76:79], v[72:75], a[8:11]
buffer_load_dwordx4 v[116:119], v9, s[12:15], s33 offen offset:0 sc1
v_mfma_f32_16x16x32_bf16 a[12:15], a[72:75], v[68:71], a[12:15]
ds_read_b64_tr_b16 a[106:107], v21 offset:4096
ds_read_b64_tr_b16 a[108:109], v21 offset:8192
v_mfma_f32_16x16x32_bf16 a[12:15], a[76:79], v[76:79], a[12:15]
ds_read_b64_tr_b16 a[110:111], v21 offset:12288
s_waitcnt lgkmcnt(8)
v_mfma_f32_16x16x32_bf16 a[16:19], a[80:83], v[64:67], a[16:19]
ds_read_b64_tr_b16 a[112:113], v22 offset:0
v_mfma_f32_16x16x32_bf16 a[16:19], a[84:87], v[72:75], a[16:19]
buffer_load_dwordx4 v[120:123], v8, s[12:15], s33 offen offset:1024 sc1
v_mfma_f32_16x16x32_bf16 a[20:23], a[80:83], v[68:71], a[20:23]
ds_read_b64_tr_b16 a[114:115], v22 offset:4096
ds_read_b64_tr_b16 a[116:117], v22 offset:8192
v_mfma_f32_16x16x32_bf16 a[20:23], a[84:87], v[76:79], a[20:23]
ds_read_b64_tr_b16 a[118:119], v22 offset:12288
v_mfma_f32_16x16x32_bf16 a[24:27], a[88:91], v[64:67], a[24:27]
ds_read_b64_tr_b16 a[120:121], v23 offset:0
v_mfma_f32_16x16x32_bf16 a[24:27], a[92:95], v[72:75], a[24:27]
buffer_load_dwordx4 v[124:127], v9, s[12:15], s33 offen offset:1024 sc1
v_mfma_f32_16x16x32_bf16 a[28:31], a[88:91], v[68:71], a[28:31]
ds_read_b64_tr_b16 a[122:123], v23 offset:4096
ds_read_b64_tr_b16 a[124:125], v23 offset:8192
v_mfma_f32_16x16x32_bf16 a[28:31], a[92:95], v[76:79], a[28:31]
ds_read_b64_tr_b16 a[126:127], v23 offset:12288
s_waitcnt vmcnt(12) lgkmcnt(8)
s_barrier
v_mfma_f32_16x16x32_bf16 a[32:35], a[96:99], v[64:67], a[32:35]
ds_read_b64_tr_b16 a[64:65], v16 offset:16384
s_add_u32 m0, s35, 49152
v_mfma_f32_16x16x32_bf16 a[32:35], a[100:103], v[72:75], a[32:35]
buffer_load_dwordx4 v10, s[16:19], s34 offen offset:0 lds
v_mfma_f32_16x16x32_bf16 a[36:39], a[96:99], v[68:71], a[36:39]
ds_read_b64_tr_b16 a[66:67], v16 offset:20480
ds_read_b64_tr_b16 a[68:69], v16 offset:24576
v_mfma_f32_16x16x32_bf16 a[36:39], a[100:103], v[76:79], a[36:39]
ds_read_b64_tr_b16 a[70:71], v16 offset:28672
s_add_u32 s33, s33, 2048
v_mfma_f32_16x16x32_bf16 a[40:43], a[104:107], v[64:67], a[40:43]
ds_read_b64_tr_b16 a[72:73], v17 offset:16384
v_mfma_f32_16x16x32_bf16 a[40:43], a[108:111], v[72:75], a[40:43]
buffer_load_dwordx4 v11, s[16:19], s34 offen offset:1024 lds
v_mfma_f32_16x16x32_bf16 a[44:47], a[104:107], v[68:71], a[44:47]
ds_read_b64_tr_b16 a[74:75], v17 offset:20480
ds_read_b64_tr_b16 a[76:77], v17 offset:24576
v_mfma_f32_16x16x32_bf16 a[44:47], a[108:111], v[76:79], a[44:47]
ds_read_b64_tr_b16 a[78:79], v17 offset:28672
s_waitcnt lgkmcnt(8)
v_mfma_f32_16x16x32_bf16 a[48:51], a[112:115], v[64:67], a[48:51]
ds_read_b64_tr_b16 a[80:81], v18 offset:16384
v_mfma_f32_16x16x32_bf16 a[48:51], a[116:119], v[72:75], a[48:51]
buffer_load_dwordx4 v12, s[16:19], s34 offen offset:2048 lds
v_mfma_f32_16x16x32_bf16 a[52:55], a[112:115], v[68:71], a[52:55]
ds_read_b64_tr_b16 a[82:83], v18 offset:20480
ds_read_b64_tr_b16 a[84:85], v18 offset:24576
v_mfma_f32_16x16x32_bf16 a[52:55], a[116:119], v[76:79], a[52:55]
ds_read_b64_tr_b16 a[86:87], v18 offset:28672
v_mfma_f32_16x16x32_bf16 a[56:59], a[120:123], v[64:67], a[56:59]
ds_read_b64_tr_b16 a[88:89], v19 offset:16384
v_mfma_f32_16x16x32_bf16 a[56:59], a[124:127], v[72:75], a[56:59]
buffer_load_dwordx4 v13, s[16:19], s34 offen offset:3072 lds
v_mfma_f32_16x16x32_bf16 a[60:63], a[120:123], v[68:71], a[60:63]
ds_read_b64_tr_b16 a[90:91], v19 offset:20480
ds_read_b64_tr_b16 a[92:93], v19 offset:24576
v_mfma_f32_16x16x32_bf16 a[60:63], a[124:127], v[76:79], a[60:63]
ds_read_b64_tr_b16 a[94:95], v19 offset:28672
s_waitcnt vmcnt(20) lgkmcnt(8)
v_mfma_f32_16x16x32_bf16 a[0:3], a[64:67], v[80:83], a[0:3]
ds_read_b64_tr_b16 a[96:97], v20 offset:16384
s_add_u32 s34, s34, 131072
v_mfma_f32_16x16x32_bf16 a[0:3], a[68:71], v[88:91], a[0:3]
buffer_load_dwordx4 v[64:67], v8, s[12:15], s33 offen offset:0 sc1
v_mfma_f32_16x16x32_bf16 a[4:7], a[64:67], v[84:87], a[4:7]
ds_read_b64_tr_b16 a[98:99], v20 offset:20480
ds_read_b64_tr_b16 a[100:101], v20 offset:24576
v_mfma_f32_16x16x32_bf16 a[4:7], a[68:71], v[92:95], a[4:7]
ds_read_b64_tr_b16 a[102:103], v20 offset:28672
v_mfma_f32_16x16x32_bf16 a[8:11], a[72:75], v[80:83], a[8:11]
ds_read_b64_tr_b16 a[104:105], v21 offset:16384
v_mfma_f32_16x16x32_bf16 a[8:11], a[76:79], v[88:91], a[8:11]
buffer_load_dwordx4 v[68:71], v9, s[12:15], s33 offen offset:0 sc1
v_mfma_f32_16x16x32_bf16 a[12:15], a[72:75], v[84:87], a[12:15]
ds_read_b64_tr_b16 a[106:107], v21 offset:20480
ds_read_b64_tr_b16 a[108:109], v21 offset:24576
v_mfma_f32_16x16x32_bf16 a[12:15], a[76:79], v[92:95], a[12:15]
ds_read_b64_tr_b16 a[110:111], v21 offset:28672
s_waitcnt lgkmcnt(8)
v_mfma_f32_16x16x32_bf16 a[16:19], a[80:83], v[80:83], a[16:19]
ds_read_b64_tr_b16 a[112:113], v22 offset:16384
v_mfma_f32_16x16x32_bf16 a[16:19], a[84:87], v[88:91], a[16:19]
buffer_load_dwordx4 v[72:75], v8, s[12:15], s33 offen offset:1024 sc1
v_mfma_f32_16x16x32_bf16 a[20:23], a[80:83], v[84:87], a[20:23]
ds_read_b64_tr_b16 a[114:115], v22 offset:20480
ds_read_b64_tr_b16 a[116:117], v22 offset:24576
v_mfma_f32_16x16x32_bf16 a[20:23], a[84:87], v[92:95], a[20:23]
ds_read_b64_tr_b16 a[118:119], v22 offset:28672
v_mfma_f32_16x16x32_bf16 a[24:27], a[88:91], v[80:83], a[24:27]
ds_read_b64_tr_b16 a[120:121], v23 offset:16384
v_mfma_f32_16x16x32_bf16 a[24:27], a[92:95], v[88:91], a[24:27]
buffer_load_dwordx4 v[76:79], v9, s[12:15], s33 offen offset:1024 sc1
v_mfma_f32_16x16x32_bf16 a[28:31], a[88:91], v[84:87], a[28:31]
ds_read_b64_tr_b16 a[122:123], v23 offset:20480
ds_read_b64_tr_b16 a[124:125], v23 offset:24576
v_mfma_f32_16x16x32_bf16 a[28:31], a[92:95], v[92:95], a[28:31]
ds_read_b64_tr_b16 a[126:127], v23 offset:28672
s_waitcnt vmcnt(12) lgkmcnt(8)
s_barrier
v_mfma_f32_16x16x32_bf16 a[32:35], a[96:99], v[80:83], a[32:35]
ds_read_b64_tr_b16 a[64:65], v16 offset:32768
s_add_u32 m0, s35, 0
v_mfma_f32_16x16x32_bf16 a[32:35], a[100:103], v[88:91], a[32:35]
buffer_load_dwordx4 v10, s[16:19], s34 offen offset:0 lds
v_mfma_f32_16x16x32_bf16 a[36:39], a[96:99], v[84:87], a[36:39]
ds_read_b64_tr_b16 a[66:67], v16 offset:36864
ds_read_b64_tr_b16 a[68:69], v16 offset:40960
v_mfma_f32_16x16x32_bf16 a[36:39], a[100:103], v[92:95], a[36:39]
ds_read_b64_tr_b16 a[70:71], v16 offset:45056
s_add_u32 s33, s33, 2048
v_mfma_f32_16x16x32_bf16 a[40:43], a[104:107], v[80:83], a[40:43]
ds_read_b64_tr_b16 a[72:73], v17 offset:32768
v_mfma_f32_16x16x32_bf16 a[40:43], a[108:111], v[88:91], a[40:43]
buffer_load_dwordx4 v11, s[16:19], s34 offen offset:1024 lds
v_mfma_f32_16x16x32_bf16 a[44:47], a[104:107], v[84:87], a[44:47]
ds_read_b64_tr_b16 a[74:75], v17 offset:36864
ds_read_b64_tr_b16 a[76:77], v17 offset:40960
v_mfma_f32_16x16x32_bf16 a[44:47], a[108:111], v[92:95], a[44:47]
ds_read_b64_tr_b16 a[78:79], v17 offset:45056
s_waitcnt lgkmcnt(8)
v_mfma_f32_16x16x32_bf16 a[48:51], a[112:115], v[80:83], a[48:51]
ds_read_b64_tr_b16 a[80:81], v18 offset:32768
v_mfma_f32_16x16x32_bf16 a[48:51], a[116:119], v[88:91], a[48:51]
buffer_load_dwordx4 v12, s[16:19], s34 offen offset:2048 lds
v_mfma_f32_16x16x32_bf16 a[52:55], a[112:115], v[84:87], a[52:55]
ds_read_b64_tr_b16 a[82:83], v18 offset:36864
ds_read_b64_tr_b16 a[84:85], v18 offset:40960
v_mfma_f32_16x16x32_bf16 a[52:55], a[116:119], v[92:95], a[52:55]
ds_read_b64_tr_b16 a[86:87], v18 offset:45056
v_mfma_f32_16x16x32_bf16 a[56:59], a[120:123], v[80:83], a[56:59]
ds_read_b64_tr_b16 a[88:89], v19 offset:32768
v_mfma_f32_16x16x32_bf16 a[56:59], a[124:127], v[88:91], a[56:59]
buffer_load_dwordx4 v13, s[16:19], s34 offen offset:3072 lds
v_mfma_f32_16x16x32_bf16 a[60:63], a[120:123], v[84:87], a[60:63]
ds_read_b64_tr_b16 a[90:91], v19 offset:36864
ds_read_b64_tr_b16 a[92:93], v19 offset:40960
v_mfma_f32_16x16x32_bf16 a[60:63], a[124:127], v[92:95], a[60:63]
ds_read_b64_tr_b16 a[94:95], v19 offset:45056
s_waitcnt vmcnt(20) lgkmcnt(8)
v_mfma_f32_16x16x32_bf16 a[0:3], a[64:67], v[96:99], a[0:3]
ds_read_b64_tr_b16 a[96:97], v20 offset:32768
s_add_u32 s34, s34, 131072
v_mfma_f32_16x16x32_bf16 a[0:3], a[68:71], v[104:107], a[0:3]
buffer_load_dwordx4 v[80:83], v8, s[12:15], s33 offen offset:0 sc1
v_mfma_f32_16x16x32_bf16 a[4:7], a[64:67], v[100:103], a[4:7]
ds_read_b64_tr_b16 a[98:99], v20 offset:36864
ds_read_b64_tr_b16 a[100:101], v20 offset:40960
v_mfma_f32_16x16x32_bf16 a[4:7], a[68:71], v[108:111], a[4:7]
ds_read_b64_tr_b16 a[102:103], v20 offset:45056
v_mfma_f32_16x16x32_bf16 a[8:11], a[72:75], v[96:99], a[8:11]
ds_read_b64_tr_b16 a[104:105], v21 offset:32768
v_mfma_f32_16x16x32_bf16 a[8:11], a[76:79], v[104:107], a[8:11]
buffer_load_dwordx4 v[84:87], v9, s[12:15], s33 offen offset:0 sc1
v_mfma_f32_16x16x32_bf16 a[12:15], a[72:75], v[100:103], a[12:15]
ds_read_b64_tr_b16 a[106:107], v21 offset:36864
ds_read_b64_tr_b16 a[108:109], v21 offset:40960
v_mfma_f32_16x16x32_bf16 a[12:15], a[76:79], v[108:111], a[12:15]
ds_read_b64_tr_b16 a[110:111], v21 offset:45056
s_waitcnt lgkmcnt(8)
v_mfma_f32_16x16x32_bf16 a[16:19], a[80:83], v[96:99], a[16:19]
ds_read_b64_tr_b16 a[112:113], v22 offset:32768
v_mfma_f32_16x16x32_bf16 a[16:19], a[84:87], v[104:107], a[16:19]
buffer_load_dwordx4 v[88:91], v8, s[12:15], s33 offen offset:1024 sc1
v_mfma_f32_16x16x32_bf16 a[20:23], a[80:83], v[100:103], a[20:23]
ds_read_b64_tr_b16 a[114:115], v22 offset:36864
ds_read_b64_tr_b16 a[116:117], v22 offset:40960
v_mfma_f32_16x16x32_bf16 a[20:23], a[84:87], v[108:111], a[20:23]
ds_read_b64_tr_b16 a[118:119], v22 offset:45056
v_mfma_f32_16x16x32_bf16 a[24:27], a[88:91], v[96:99], a[24:27]
ds_read_b64_tr_b16 a[120:121], v23 offset:32768
v_mfma_f32_16x16x32_bf16 a[24:27], a[92:95], v[104:107], a[24:27]
buffer_load_dwordx4 v[92:95], v9, s[12:15], s33 offen offset:1024 sc1
v_mfma_f32_16x16x32_bf16 a[28:31], a[88:91], v[100:103], a[28:31]
ds_read_b64_tr_b16 a[122:123], v23 offset:36864
ds_read_b64_tr_b16 a[124:125], v23 offset:40960
v_mfma_f32_16x16x32_bf16 a[28:31], a[92:95], v[108:111], a[28:31]
ds_read_b64_tr_b16 a[126:127], v23 offset:45056
s_waitcnt vmcnt(12) lgkmcnt(8)
s_barrier
v_mfma_f32_16x16x32_bf16 a[32:35], a[96:99], v[96:99], a[32:35]
ds_read_b64_tr_b16 a[64:65], v16 offset:49152
s_add_u32 m0, s35, 16384
v_mfma_f32_16x16x32_bf16 a[32:35], a[100:103], v[104:107], a[32:35]
buffer_load_dwordx4 v10, s[16:19], s34 offen offset:0 lds
v_mfma_f32_16x16x32_bf16 a[36:39], a[96:99], v[100:103], a[36:39]
ds_read_b64_tr_b16 a[66:67], v16 offset:53248
ds_read_b64_tr_b16 a[68:69], v16 offset:57344
v_mfma_f32_16x16x32_bf16 a[36:39], a[100:103], v[108:111], a[36:39]
ds_read_b64_tr_b16 a[70:71], v16 offset:61440
s_add_u32 s33, s33, 2048
v_mfma_f32_16x16x32_bf16 a[40:43], a[104:107], v[96:99], a[40:43]
ds_read_b64_tr_b16 a[72:73], v17 offset:49152
v_mfma_f32_16x16x32_bf16 a[40:43], a[108:111], v[104:107], a[40:43]
buffer_load_dwordx4 v11, s[16:19], s34 offen offset:1024 lds
v_mfma_f32_16x16x32_bf16 a[44:47], a[104:107], v[100:103], a[44:47]
ds_read_b64_tr_b16 a[74:75], v17 offset:53248
ds_read_b64_tr_b16 a[76:77], v17 offset:57344
v_mfma_f32_16x16x32_bf16 a[44:47], a[108:111], v[108:111], a[44:47]
ds_read_b64_tr_b16 a[78:79], v17 offset:61440
s_waitcnt lgkmcnt(8)
v_mfma_f32_16x16x32_bf16 a[48:51], a[112:115], v[96:99], a[48:51]
ds_read_b64_tr_b16 a[80:81], v18 offset:49152
v_mfma_f32_16x16x32_bf16 a[48:51], a[116:119], v[104:107], a[48:51]
buffer_load_dwordx4 v12, s[16:19], s34 offen offset:2048 lds
v_mfma_f32_16x16x32_bf16 a[52:55], a[112:115], v[100:103], a[52:55]
ds_read_b64_tr_b16 a[82:83], v18 offset:53248
ds_read_b64_tr_b16 a[84:85], v18 offset:57344
v_mfma_f32_16x16x32_bf16 a[52:55], a[116:119], v[108:111], a[52:55]
ds_read_b64_tr_b16 a[86:87], v18 offset:61440
v_mfma_f32_16x16x32_bf16 a[56:59], a[120:123], v[96:99], a[56:59]
ds_read_b64_tr_b16 a[88:89], v19 offset:49152
v_mfma_f32_16x16x32_bf16 a[56:59], a[124:127], v[104:107], a[56:59]
buffer_load_dwordx4 v13, s[16:19], s34 offen offset:3072 lds
v_mfma_f32_16x16x32_bf16 a[60:63], a[120:123], v[100:103], a[60:63]
ds_read_b64_tr_b16 a[90:91], v19 offset:53248
ds_read_b64_tr_b16 a[92:93], v19 offset:57344
v_mfma_f32_16x16x32_bf16 a[60:63], a[124:127], v[108:111], a[60:63]
ds_read_b64_tr_b16 a[94:95], v19 offset:61440
s_waitcnt vmcnt(20) lgkmcnt(8)
v_mfma_f32_16x16x32_bf16 a[0:3], a[64:67], v[112:115], a[0:3]
ds_read_b64_tr_b16 a[96:97], v20 offset:49152
s_add_u32 s34, s34, 131072
v_mfma_f32_16x16x32_bf16 a[0:3], a[68:71], v[120:123], a[0:3]
buffer_load_dwordx4 v[96:99], v8, s[12:15], s33 offen offset:0 sc1
v_mfma_f32_16x16x32_bf16 a[4:7], a[64:67], v[116:119], a[4:7]
ds_read_b64_tr_b16 a[98:99], v20 offset:53248
ds_read_b64_tr_b16 a[100:101], v20 offset:57344
v_mfma_f32_16x16x32_bf16 a[4:7], a[68:71], v[124:127], a[4:7]
ds_read_b64_tr_b16 a[102:103], v20 offset:61440
v_mfma_f32_16x16x32_bf16 a[8:11], a[72:75], v[112:115], a[8:11]
ds_read_b64_tr_b16 a[104:105], v21 offset:49152
v_mfma_f32_16x16x32_bf16 a[8:11], a[76:79], v[120:123], a[8:11]
buffer_load_dwordx4 v[100:103], v9, s[12:15], s33 offen offset:0 sc1
v_mfma_f32_16x16x32_bf16 a[12:15], a[72:75], v[116:119], a[12:15]
ds_read_b64_tr_b16 a[106:107], v21 offset:53248
ds_read_b64_tr_b16 a[108:109], v21 offset:57344
v_mfma_f32_16x16x32_bf16 a[12:15], a[76:79], v[124:127], a[12:15]
ds_read_b64_tr_b16 a[110:111], v21 offset:61440
s_waitcnt lgkmcnt(8)
v_mfma_f32_16x16x32_bf16 a[16:19], a[80:83], v[112:115], a[16:19]
ds_read_b64_tr_b16 a[112:113], v22 offset:49152
v_mfma_f32_16x16x32_bf16 a[16:19], a[84:87], v[120:123], a[16:19]
buffer_load_dwordx4 v[104:107], v8, s[12:15], s33 offen offset:1024 sc1
v_mfma_f32_16x16x32_bf16 a[20:23], a[80:83], v[116:119], a[20:23]
ds_read_b64_tr_b16 a[114:115], v22 offset:53248
ds_read_b64_tr_b16 a[116:117], v22 offset:57344
v_mfma_f32_16x16x32_bf16 a[20:23], a[84:87], v[124:127], a[20:23]
ds_read_b64_tr_b16 a[118:119], v22 offset:61440
v_mfma_f32_16x16x32_bf16 a[24:27], a[88:91], v[112:115], a[24:27]
ds_read_b64_tr_b16 a[120:121], v23 offset:49152
v_mfma_f32_16x16x32_bf16 a[24:27], a[92:95], v[120:123], a[24:27]
buffer_load_dwordx4 v[108:111], v9, s[12:15], s33 offen offset:1024 sc1
v_mfma_f32_16x16x32_bf16 a[28:31], a[88:91], v[116:119], a[28:31]
ds_read_b64_tr_b16 a[122:123], v23 offset:53248
ds_read_b64_tr_b16 a[124:125], v23 offset:57344
v_mfma_f32_16x16x32_bf16 a[28:31], a[92:95], v[124:127], a[28:31]
ds_read_b64_tr_b16 a[126:127], v23 offset:61440
s_waitcnt vmcnt(12) lgkmcnt(8)
s_barrier
v_mfma_f32_16x16x32_bf16 a[32:35], a[96:99], v[112:115], a[32:35]
ds_read_b64_tr_b16 a[64:65], v16 offset:0
s_add_u32 m0, s35, 32768
v_mfma_f32_16x16x32_bf16 a[32:35], a[100:103], v[120:123], a[32:35]
buffer_load_dwordx4 v10, s[16:19], s34 offen offset:0 lds
v_mfma_f32_16x16x32_bf16 a[36:39], a[96:99], v[116:119], a[36:39]
ds_read_b64_tr_b16 a[66:67], v16 offset:4096
ds_read_b64_tr_b16 a[68:69], v16 offset:8192
v_mfma_f32_16x16x32_bf16 a[36:39], a[100:103], v[124:127], a[36:39]
ds_read_b64_tr_b16 a[70:71], v16 offset:12288
s_add_u32 s33, s33, 2048
v_mfma_f32_16x16x32_bf16 a[40:43], a[104:107], v[112:115], a[40:43]
ds_read_b64_tr_b16 a[72:73], v17 offset:0
v_mfma_f32_16x16x32_bf16 a[40:43], a[108:111], v[120:123], a[40:43]
buffer_load_dwordx4 v11, s[16:19], s34 offen offset:1024 lds
v_mfma_f32_16x16x32_bf16 a[44:47], a[104:107], v[116:119], a[44:47]
ds_read_b64_tr_b16 a[74:75], v17 offset:4096
ds_read_b64_tr_b16 a[76:77], v17 offset:8192
v_mfma_f32_16x16x32_bf16 a[44:47], a[108:111], v[124:127], a[44:47]
ds_read_b64_tr_b16 a[78:79], v17 offset:12288
s_waitcnt lgkmcnt(8)
v_mfma_f32_16x16x32_bf16 a[48:51], a[112:115], v[112:115], a[48:51]
ds_read_b64_tr_b16 a[80:81], v18 offset:0
v_mfma_f32_16x16x32_bf16 a[48:51], a[116:119], v[120:123], a[48:51]
buffer_load_dwordx4 v12, s[16:19], s34 offen offset:2048 lds
v_mfma_f32_16x16x32_bf16 a[52:55], a[112:115], v[116:119], a[52:55]
ds_read_b64_tr_b16 a[82:83], v18 offset:4096
ds_read_b64_tr_b16 a[84:85], v18 offset:8192
v_mfma_f32_16x16x32_bf16 a[52:55], a[116:119], v[124:127], a[52:55]
ds_read_b64_tr_b16 a[86:87], v18 offset:12288
v_mfma_f32_16x16x32_bf16 a[56:59], a[120:123], v[112:115], a[56:59]
ds_read_b64_tr_b16 a[88:89], v19 offset:0
v_mfma_f32_16x16x32_bf16 a[56:59], a[124:127], v[120:123], a[56:59]
buffer_load_dwordx4 v13, s[16:19], s34 offen offset:3072 lds
v_mfma_f32_16x16x32_bf16 a[60:63], a[120:123], v[116:119], a[60:63]
ds_read_b64_tr_b16 a[90:91], v19 offset:4096
ds_read_b64_tr_b16 a[92:93], v19 offset:8192
v_mfma_f32_16x16x32_bf16 a[60:63], a[124:127], v[124:127], a[60:63]
ds_read_b64_tr_b16 a[94:95], v19 offset:12288
s_add_u32 s34, s34, 131072
s_sub_u32 s36, s36, 1
s_cmp_lg_u32 s36, 0
s_cbranch_scc1 L_attn_kernel_wo_loop
s_waitcnt vmcnt(20) lgkmcnt(8)
v_mfma_f32_16x16x32_bf16 a[0:3], a[64:67], v[64:67], a[0:3]
ds_read_b64_tr_b16 a[96:97], v20 offset:0
v_mfma_f32_16x16x32_bf16 a[0:3], a[68:71], v[72:75], a[0:3]
buffer_load_dwordx4 v[112:115], v8, s[12:15], s33 offen offset:0 sc1
v_mfma_f32_16x16x32_bf16 a[4:7], a[64:67], v[68:71], a[4:7]
ds_read_b64_tr_b16 a[98:99], v20 offset:4096
ds_read_b64_tr_b16 a[100:101], v20 offset:8192
v_mfma_f32_16x16x32_bf16 a[4:7], a[68:71], v[76:79], a[4:7]
ds_read_b64_tr_b16 a[102:103], v20 offset:12288
v_mfma_f32_16x16x32_bf16 a[8:11], a[72:75], v[64:67], a[8:11]
ds_read_b64_tr_b16 a[104:105], v21 offset:0
v_mfma_f32_16x16x32_bf16 a[8:11], a[76:79], v[72:75], a[8:11]
buffer_load_dwordx4 v[116:119], v9, s[12:15], s33 offen offset:0 sc1
v_mfma_f32_16x16x32_bf16 a[12:15], a[72:75], v[68:71], a[12:15]
ds_read_b64_tr_b16 a[106:107], v21 offset:4096
ds_read_b64_tr_b16 a[108:109], v21 offset:8192
v_mfma_f32_16x16x32_bf16 a[12:15], a[76:79], v[76:79], a[12:15]
ds_read_b64_tr_b16 a[110:111], v21 offset:12288
s_waitcnt lgkmcnt(8)
v_mfma_f32_16x16x32_bf16 a[16:19], a[80:83], v[64:67], a[16:19]
ds_read_b64_tr_b16 a[112:113], v22 offset:0
v_mfma_f32_16x16x32_bf16 a[16:19], a[84:87], v[72:75], a[16:19]
buffer_load_dwordx4 v[120:123], v8, s[12:15], s33 offen offset:1024 sc1
v_mfma_f32_16x16x32_bf16 a[20:23], a[80:83], v[68:71], a[20:23]
ds_read_b64_tr_b16 a[114:115], v22 offset:4096
ds_read_b64_tr_b16 a[116:117], v22 offset:8192
v_mfma_f32_16x16x32_bf16 a[20:23], a[84:87], v[76:79], a[20:23]
ds_read_b64_tr_b16 a[118:119], v22 offset:12288
v_mfma_f32_16x16x32_bf16 a[24:27], a[88:91], v[64:67], a[24:27]
ds_read_b64_tr_b16 a[120:121], v23 offset:0
v_mfma_f32_16x16x32_bf16 a[24:27], a[92:95], v[72:75], a[24:27]
buffer_load_dwordx4 v[124:127], v9, s[12:15], s33 offen offset:1024 sc1
v_mfma_f32_16x16x32_bf16 a[28:31], a[88:91], v[68:71], a[28:31]
ds_read_b64_tr_b16 a[122:123], v23 offset:4096
ds_read_b64_tr_b16 a[124:125], v23 offset:8192
v_mfma_f32_16x16x32_bf16 a[28:31], a[92:95], v[76:79], a[28:31]
ds_read_b64_tr_b16 a[126:127], v23 offset:12288
s_waitcnt vmcnt(12) lgkmcnt(8)
s_barrier
v_mfma_f32_16x16x32_bf16 a[32:35], a[96:99], v[64:67], a[32:35]
ds_read_b64_tr_b16 a[64:65], v16 offset:16384
s_add_u32 m0, s35, 49152
v_mfma_f32_16x16x32_bf16 a[32:35], a[100:103], v[72:75], a[32:35]
buffer_load_dwordx4 v10, s[16:19], s34 offen offset:0 lds
v_mfma_f32_16x16x32_bf16 a[36:39], a[96:99], v[68:71], a[36:39]
ds_read_b64_tr_b16 a[66:67], v16 offset:20480
ds_read_b64_tr_b16 a[68:69], v16 offset:24576
v_mfma_f32_16x16x32_bf16 a[36:39], a[100:103], v[76:79], a[36:39]
ds_read_b64_tr_b16 a[70:71], v16 offset:28672
s_add_u32 s33, s33, 2048
v_mfma_f32_16x16x32_bf16 a[40:43], a[104:107], v[64:67], a[40:43]
ds_read_b64_tr_b16 a[72:73], v17 offset:16384
v_mfma_f32_16x16x32_bf16 a[40:43], a[108:111], v[72:75], a[40:43]
buffer_load_dwordx4 v11, s[16:19], s34 offen offset:1024 lds
v_mfma_f32_16x16x32_bf16 a[44:47], a[104:107], v[68:71], a[44:47]
ds_read_b64_tr_b16 a[74:75], v17 offset:20480
ds_read_b64_tr_b16 a[76:77], v17 offset:24576
v_mfma_f32_16x16x32_bf16 a[44:47], a[108:111], v[76:79], a[44:47]
ds_read_b64_tr_b16 a[78:79], v17 offset:28672
s_waitcnt lgkmcnt(8)
v_mfma_f32_16x16x32_bf16 a[48:51], a[112:115], v[64:67], a[48:51]
ds_read_b64_tr_b16 a[80:81], v18 offset:16384
v_mfma_f32_16x16x32_bf16 a[48:51], a[116:119], v[72:75], a[48:51]
buffer_load_dwordx4 v12, s[16:19], s34 offen offset:2048 lds
v_mfma_f32_16x16x32_bf16 a[52:55], a[112:115], v[68:71], a[52:55]
ds_read_b64_tr_b16 a[82:83], v18 offset:20480
ds_read_b64_tr_b16 a[84:85], v18 offset:24576
v_mfma_f32_16x16x32_bf16 a[52:55], a[116:119], v[76:79], a[52:55]
ds_read_b64_tr_b16 a[86:87], v18 offset:28672
v_mfma_f32_16x16x32_bf16 a[56:59], a[120:123], v[64:67], a[56:59]
ds_read_b64_tr_b16 a[88:89], v19 offset:16384
v_mfma_f32_16x16x32_bf16 a[56:59], a[124:127], v[72:75], a[56:59]
buffer_load_dwordx4 v13, s[16:19], s34 offen offset:3072 lds
v_mfma_f32_16x16x32_bf16 a[60:63], a[120:123], v[68:71], a[60:63]
ds_read_b64_tr_b16 a[90:91], v19 offset:20480
ds_read_b64_tr_b16 a[92:93], v19 offset:24576
v_mfma_f32_16x16x32_bf16 a[60:63], a[124:127], v[76:79], a[60:63]
ds_read_b64_tr_b16 a[94:95], v19 offset:28672
s_waitcnt vmcnt(20) lgkmcnt(8)
v_mfma_f32_16x16x32_bf16 a[0:3], a[64:67], v[80:83], a[0:3]
ds_read_b64_tr_b16 a[96:97], v20 offset:16384
s_add_u32 s34, s34, 131072
v_mfma_f32_16x16x32_bf16 a[0:3], a[68:71], v[88:91], a[0:3]
v_mfma_f32_16x16x32_bf16 a[4:7], a[64:67], v[84:87], a[4:7]
ds_read_b64_tr_b16 a[98:99], v20 offset:20480
ds_read_b64_tr_b16 a[100:101], v20 offset:24576
v_mfma_f32_16x16x32_bf16 a[4:7], a[68:71], v[92:95], a[4:7]
ds_read_b64_tr_b16 a[102:103], v20 offset:28672
v_mfma_f32_16x16x32_bf16 a[8:11], a[72:75], v[80:83], a[8:11]
ds_read_b64_tr_b16 a[104:105], v21 offset:16384
v_mfma_f32_16x16x32_bf16 a[8:11], a[76:79], v[88:91], a[8:11]
v_mfma_f32_16x16x32_bf16 a[12:15], a[72:75], v[84:87], a[12:15]
ds_read_b64_tr_b16 a[106:107], v21 offset:20480
ds_read_b64_tr_b16 a[108:109], v21 offset:24576
v_mfma_f32_16x16x32_bf16 a[12:15], a[76:79], v[92:95], a[12:15]
ds_read_b64_tr_b16 a[110:111], v21 offset:28672
s_waitcnt lgkmcnt(8)
v_mfma_f32_16x16x32_bf16 a[16:19], a[80:83], v[80:83], a[16:19]
ds_read_b64_tr_b16 a[112:113], v22 offset:16384
v_mfma_f32_16x16x32_bf16 a[16:19], a[84:87], v[88:91], a[16:19]
v_mfma_f32_16x16x32_bf16 a[20:23], a[80:83], v[84:87], a[20:23]
ds_read_b64_tr_b16 a[114:115], v22 offset:20480
ds_read_b64_tr_b16 a[116:117], v22 offset:24576
v_mfma_f32_16x16x32_bf16 a[20:23], a[84:87], v[92:95], a[20:23]
ds_read_b64_tr_b16 a[118:119], v22 offset:28672
v_mfma_f32_16x16x32_bf16 a[24:27], a[88:91], v[80:83], a[24:27]
ds_read_b64_tr_b16 a[120:121], v23 offset:16384
v_mfma_f32_16x16x32_bf16 a[24:27], a[92:95], v[88:91], a[24:27]
v_mfma_f32_16x16x32_bf16 a[28:31], a[88:91], v[84:87], a[28:31]
ds_read_b64_tr_b16 a[122:123], v23 offset:20480
ds_read_b64_tr_b16 a[124:125], v23 offset:24576
v_mfma_f32_16x16x32_bf16 a[28:31], a[92:95], v[92:95], a[28:31]
ds_read_b64_tr_b16 a[126:127], v23 offset:28672
s_waitcnt vmcnt(8) lgkmcnt(8)
s_barrier
v_mfma_f32_16x16x32_bf16 a[32:35], a[96:99], v[80:83], a[32:35]
ds_read_b64_tr_b16 a[64:65], v16 offset:32768
v_mfma_f32_16x16x32_bf16 a[32:35], a[100:103], v[88:91], a[32:35]
v_mfma_f32_16x16x32_bf16 a[36:39], a[96:99], v[84:87], a[36:39]
ds_read_b64_tr_b16 a[66:67], v16 offset:36864
ds_read_b64_tr_b16 a[68:69], v16 offset:40960
v_mfma_f32_16x16x32_bf16 a[36:39], a[100:103], v[92:95], a[36:39]
ds_read_b64_tr_b16 a[70:71], v16 offset:45056
v_mfma_f32_16x16x32_bf16 a[40:43], a[104:107], v[80:83], a[40:43]
ds_read_b64_tr_b16 a[72:73], v17 offset:32768
v_mfma_f32_16x16x32_bf16 a[40:43], a[108:111], v[88:91], a[40:43]
v_mfma_f32_16x16x32_bf16 a[44:47], a[104:107], v[84:87], a[44:47]
ds_read_b64_tr_b16 a[74:75], v17 offset:36864
ds_read_b64_tr_b16 a[76:77], v17 offset:40960
v_mfma_f32_16x16x32_bf16 a[44:47], a[108:111], v[92:95], a[44:47]
ds_read_b64_tr_b16 a[78:79], v17 offset:45056
s_waitcnt lgkmcnt(8)
v_mfma_f32_16x16x32_bf16 a[48:51], a[112:115], v[80:83], a[48:51]
ds_read_b64_tr_b16 a[80:81], v18 offset:32768
v_mfma_f32_16x16x32_bf16 a[48:51], a[116:119], v[88:91], a[48:51]
v_mfma_f32_16x16x32_bf16 a[52:55], a[112:115], v[84:87], a[52:55]
ds_read_b64_tr_b16 a[82:83], v18 offset:36864
ds_read_b64_tr_b16 a[84:85], v18 offset:40960
v_mfma_f32_16x16x32_bf16 a[52:55], a[116:119], v[92:95], a[52:55]
ds_read_b64_tr_b16 a[86:87], v18 offset:45056
v_mfma_f32_16x16x32_bf16 a[56:59], a[120:123], v[80:83], a[56:59]
ds_read_b64_tr_b16 a[88:89], v19 offset:32768
v_mfma_f32_16x16x32_bf16 a[56:59], a[124:127], v[88:91], a[56:59]
v_mfma_f32_16x16x32_bf16 a[60:63], a[120:123], v[84:87], a[60:63]
ds_read_b64_tr_b16 a[90:91], v19 offset:36864
ds_read_b64_tr_b16 a[92:93], v19 offset:40960
v_mfma_f32_16x16x32_bf16 a[60:63], a[124:127], v[92:95], a[60:63]
ds_read_b64_tr_b16 a[94:95], v19 offset:45056
s_waitcnt vmcnt(12) lgkmcnt(8)
v_mfma_f32_16x16x32_bf16 a[0:3], a[64:67], v[96:99], a[0:3]
ds_read_b64_tr_b16 a[96:97], v20 offset:32768
v_mfma_f32_16x16x32_bf16 a[0:3], a[68:71], v[104:107], a[0:3]
v_mfma_f32_16x16x32_bf16 a[4:7], a[64:67], v[100:103], a[4:7]
ds_read_b64_tr_b16 a[98:99], v20 offset:36864
ds_read_b64_tr_b16 a[100:101], v20 offset:40960
v_mfma_f32_16x16x32_bf16 a[4:7], a[68:71], v[108:111], a[4:7]
ds_read_b64_tr_b16 a[102:103], v20 offset:45056
v_mfma_f32_16x16x32_bf16 a[8:11], a[72:75], v[96:99], a[8:11]
ds_read_b64_tr_b16 a[104:105], v21 offset:32768
v_mfma_f32_16x16x32_bf16 a[8:11], a[76:79], v[104:107], a[8:11]
v_mfma_f32_16x16x32_bf16 a[12:15], a[72:75], v[100:103], a[12:15]
ds_read_b64_tr_b16 a[106:107], v21 offset:36864
ds_read_b64_tr_b16 a[108:109], v21 offset:40960
v_mfma_f32_16x16x32_bf16 a[12:15], a[76:79], v[108:111], a[12:15]
ds_read_b64_tr_b16 a[110:111], v21 offset:45056
s_waitcnt lgkmcnt(8)
v_mfma_f32_16x16x32_bf16 a[16:19], a[80:83], v[96:99], a[16:19]
ds_read_b64_tr_b16 a[112:113], v22 offset:32768
v_mfma_f32_16x16x32_bf16 a[16:19], a[84:87], v[104:107], a[16:19]
v_mfma_f32_16x16x32_bf16 a[20:23], a[80:83], v[100:103], a[20:23]
ds_read_b64_tr_b16 a[114:115], v22 offset:36864
ds_read_b64_tr_b16 a[116:117], v22 offset:40960
v_mfma_f32_16x16x32_bf16 a[20:23], a[84:87], v[108:111], a[20:23]
ds_read_b64_tr_b16 a[118:119], v22 offset:45056
v_mfma_f32_16x16x32_bf16 a[24:27], a[88:91], v[96:99], a[24:27]
ds_read_b64_tr_b16 a[120:121], v23 offset:32768
v_mfma_f32_16x16x32_bf16 a[24:27], a[92:95], v[104:107], a[24:27]
v_mfma_f32_16x16x32_bf16 a[28:31], a[88:91], v[100:103], a[28:31]
ds_read_b64_tr_b16 a[122:123], v23 offset:36864
ds_read_b64_tr_b16 a[124:125], v23 offset:40960
v_mfma_f32_16x16x32_bf16 a[28:31], a[92:95], v[108:111], a[28:31]
ds_read_b64_tr_b16 a[126:127], v23 offset:45056
s_waitcnt vmcnt(0) lgkmcnt(8)
s_barrier
v_mfma_f32_16x16x32_bf16 a[32:35], a[96:99], v[96:99], a[32:35]
ds_read_b64_tr_b16 a[64:65], v16 offset:49152
v_mfma_f32_16x16x32_bf16 a[32:35], a[100:103], v[104:107], a[32:35]
v_mfma_f32_16x16x32_bf16 a[36:39], a[96:99], v[100:103], a[36:39]
ds_read_b64_tr_b16 a[66:67], v16 offset:53248
ds_read_b64_tr_b16 a[68:69], v16 offset:57344
v_mfma_f32_16x16x32_bf16 a[36:39], a[100:103], v[108:111], a[36:39]
ds_read_b64_tr_b16 a[70:71], v16 offset:61440
v_mfma_f32_16x16x32_bf16 a[40:43], a[104:107], v[96:99], a[40:43]
ds_read_b64_tr_b16 a[72:73], v17 offset:49152
v_mfma_f32_16x16x32_bf16 a[40:43], a[108:111], v[104:107], a[40:43]
v_mfma_f32_16x16x32_bf16 a[44:47], a[104:107], v[100:103], a[44:47]
ds_read_b64_tr_b16 a[74:75], v17 offset:53248
ds_read_b64_tr_b16 a[76:77], v17 offset:57344
v_mfma_f32_16x16x32_bf16 a[44:47], a[108:111], v[108:111], a[44:47]
ds_read_b64_tr_b16 a[78:79], v17 offset:61440
s_waitcnt lgkmcnt(8)
v_mfma_f32_16x16x32_bf16 a[48:51], a[112:115], v[96:99], a[48:51]
ds_read_b64_tr_b16 a[80:81], v18 offset:49152
v_mfma_f32_16x16x32_bf16 a[48:51], a[116:119], v[104:107], a[48:51]
v_mfma_f32_16x16x32_bf16 a[52:55], a[112:115], v[100:103], a[52:55]
ds_read_b64_tr_b16 a[82:83], v18 offset:53248
ds_read_b64_tr_b16 a[84:85], v18 offset:57344
v_mfma_f32_16x16x32_bf16 a[52:55], a[116:119], v[108:111], a[52:55]
ds_read_b64_tr_b16 a[86:87], v18 offset:61440
v_mfma_f32_16x16x32_bf16 a[56:59], a[120:123], v[96:99], a[56:59]
ds_read_b64_tr_b16 a[88:89], v19 offset:49152
v_mfma_f32_16x16x32_bf16 a[56:59], a[124:127], v[104:107], a[56:59]
v_mfma_f32_16x16x32_bf16 a[60:63], a[120:123], v[100:103], a[60:63]
ds_read_b64_tr_b16 a[90:91], v19 offset:53248
ds_read_b64_tr_b16 a[92:93], v19 offset:57344
v_mfma_f32_16x16x32_bf16 a[60:63], a[124:127], v[108:111], a[60:63]
ds_read_b64_tr_b16 a[94:95], v19 offset:61440
s_waitcnt vmcnt(4) lgkmcnt(8)
v_mfma_f32_16x16x32_bf16 a[0:3], a[64:67], v[112:115], a[0:3]
ds_read_b64_tr_b16 a[96:97], v20 offset:49152
v_mfma_f32_16x16x32_bf16 a[0:3], a[68:71], v[120:123], a[0:3]
v_mfma_f32_16x16x32_bf16 a[4:7], a[64:67], v[116:119], a[4:7]
ds_read_b64_tr_b16 a[98:99], v20 offset:53248
ds_read_b64_tr_b16 a[100:101], v20 offset:57344
v_mfma_f32_16x16x32_bf16 a[4:7], a[68:71], v[124:127], a[4:7]
ds_read_b64_tr_b16 a[102:103], v20 offset:61440
v_mfma_f32_16x16x32_bf16 a[8:11], a[72:75], v[112:115], a[8:11]
ds_read_b64_tr_b16 a[104:105], v21 offset:49152
v_mfma_f32_16x16x32_bf16 a[8:11], a[76:79], v[120:123], a[8:11]
v_mfma_f32_16x16x32_bf16 a[12:15], a[72:75], v[116:119], a[12:15]
ds_read_b64_tr_b16 a[106:107], v21 offset:53248
ds_read_b64_tr_b16 a[108:109], v21 offset:57344
v_mfma_f32_16x16x32_bf16 a[12:15], a[76:79], v[124:127], a[12:15]
ds_read_b64_tr_b16 a[110:111], v21 offset:61440
s_waitcnt lgkmcnt(8)
v_mfma_f32_16x16x32_bf16 a[16:19], a[80:83], v[112:115], a[16:19]
ds_read_b64_tr_b16 a[112:113], v22 offset:49152
v_mfma_f32_16x16x32_bf16 a[16:19], a[84:87], v[120:123], a[16:19]
v_mfma_f32_16x16x32_bf16 a[20:23], a[80:83], v[116:119], a[20:23]
ds_read_b64_tr_b16 a[114:115], v22 offset:53248
ds_read_b64_tr_b16 a[116:117], v22 offset:57344
v_mfma_f32_16x16x32_bf16 a[20:23], a[84:87], v[124:127], a[20:23]
ds_read_b64_tr_b16 a[118:119], v22 offset:61440
v_mfma_f32_16x16x32_bf16 a[24:27], a[88:91], v[112:115], a[24:27]
ds_read_b64_tr_b16 a[120:121], v23 offset:49152
v_mfma_f32_16x16x32_bf16 a[24:27], a[92:95], v[120:123], a[24:27]
v_mfma_f32_16x16x32_bf16 a[28:31], a[88:91], v[116:119], a[28:31]
ds_read_b64_tr_b16 a[122:123], v23 offset:53248
ds_read_b64_tr_b16 a[124:125], v23 offset:57344
v_mfma_f32_16x16x32_bf16 a[28:31], a[92:95], v[124:127], a[28:31]
ds_read_b64_tr_b16 a[126:127], v23 offset:61440
s_waitcnt lgkmcnt(8)
v_mfma_f32_16x16x32_bf16 a[32:35], a[96:99], v[112:115], a[32:35]
v_mfma_f32_16x16x32_bf16 a[32:35], a[100:103], v[120:123], a[32:35]
v_mfma_f32_16x16x32_bf16 a[36:39], a[96:99], v[116:119], a[36:39]
v_mfma_f32_16x16x32_bf16 a[36:39], a[100:103], v[124:127], a[36:39]
v_mfma_f32_16x16x32_bf16 a[40:43], a[104:107], v[112:115], a[40:43]
v_mfma_f32_16x16x32_bf16 a[40:43], a[108:111], v[120:123], a[40:43]
v_mfma_f32_16x16x32_bf16 a[44:47], a[104:107], v[116:119], a[44:47]
v_mfma_f32_16x16x32_bf16 a[44:47], a[108:111], v[124:127], a[44:47]
s_waitcnt lgkmcnt(0)
v_mfma_f32_16x16x32_bf16 a[48:51], a[112:115], v[112:115], a[48:51]
v_mfma_f32_16x16x32_bf16 a[48:51], a[116:119], v[120:123], a[48:51]
v_mfma_f32_16x16x32_bf16 a[52:55], a[112:115], v[116:119], a[52:55]
v_mfma_f32_16x16x32_bf16 a[52:55], a[116:119], v[124:127], a[52:55]
v_mfma_f32_16x16x32_bf16 a[56:59], a[120:123], v[112:115], a[56:59]
v_mfma_f32_16x16x32_bf16 a[56:59], a[124:127], v[120:123], a[56:59]
v_mfma_f32_16x16x32_bf16 a[60:63], a[120:123], v[116:119], a[60:63]
v_mfma_f32_16x16x32_bf16 a[60:63], a[124:127], v[124:127], a[60:63]
s_add_u32 s16, s4, 0x80000
s_addc_u32 s17, s5, 0
s_mov_b32 s18, 0x20000
s_mov_b32 s19, 0x20000
s_lshl_b32 s42, s39, 18
s_lshl_b32 s43, s32, 16
s_add_u32 s42, s42, s43
s_lshl_b32 s43, s40, 12
s_add_u32 s42, s42, s43
s_lshl_b32 s43, s41, 22
s_add_u32 s42, s42, s43
v_accvgpr_read_b32 v64, a0
v_accvgpr_read_b32 v65, a1
v_accvgpr_read_b32 v66, a2
v_accvgpr_read_b32 v67, a3
v_accvgpr_read_b32 v68, a8
v_accvgpr_read_b32 v69, a9
v_accvgpr_read_b32 v70, a10
v_accvgpr_read_b32 v71, a11
v_cvt_pk_bf16_f32 v72, v64, v65
v_cvt_pk_bf16_f32 v73, v66, v67
v_cvt_pk_bf16_f32 v74, v68, v69
v_cvt_pk_bf16_f32 v75, v70, v71
buffer_store_dwordx4 v[72:75], v3, s[48:51], s42 offen offset:0 sc1
v_accvgpr_read_b32 v80, a16
v_accvgpr_read_b32 v81, a17
v_accvgpr_read_b32 v82, a18
v_accvgpr_read_b32 v83, a19
v_accvgpr_read_b32 v84, a24
v_accvgpr_read_b32 v85, a25
v_accvgpr_read_b32 v86, a26
v_accvgpr_read_b32 v87, a27
v_cvt_pk_bf16_f32 v88, v80, v81
v_cvt_pk_bf16_f32 v89, v82, v83
v_cvt_pk_bf16_f32 v90, v84, v85
v_cvt_pk_bf16_f32 v91, v86, v87
buffer_store_dwordx4 v[88:91], v3, s[48:51], s42 offen offset:1024 sc1
v_accvgpr_read_b32 v96, a32
v_accvgpr_read_b32 v97, a33
v_accvgpr_read_b32 v98, a34
v_accvgpr_read_b32 v99, a35
v_accvgpr_read_b32 v100, a40
v_accvgpr_read_b32 v101, a41
v_accvgpr_read_b32 v102, a42
v_accvgpr_read_b32 v103, a43
v_cvt_pk_bf16_f32 v104, v96, v97
v_cvt_pk_bf16_f32 v105, v98, v99
v_cvt_pk_bf16_f32 v106, v100, v101
v_cvt_pk_bf16_f32 v107, v102, v103
buffer_store_dwordx4 v[104:107], v3, s[48:51], s42 offen offset:2048 sc1
v_accvgpr_read_b32 v112, a48
v_accvgpr_read_b32 v113, a49
v_accvgpr_read_b32 v114, a50
v_accvgpr_read_b32 v115, a51
v_accvgpr_read_b32 v116, a56
v_accvgpr_read_b32 v117, a57
v_accvgpr_read_b32 v118, a58
v_accvgpr_read_b32 v119, a59
v_cvt_pk_bf16_f32 v120, v112, v113
v_cvt_pk_bf16_f32 v121, v114, v115
v_cvt_pk_bf16_f32 v122, v116, v117
v_cvt_pk_bf16_f32 v123, v118, v119
buffer_store_dwordx4 v[120:123], v3, s[48:51], s42 offen offset:3072 sc1
s_add_u32 s42, s42, 0x8000
v_accvgpr_read_b32 v64, a4
v_accvgpr_read_b32 v65, a5
v_accvgpr_read_b32 v66, a6
v_accvgpr_read_b32 v67, a7
v_accvgpr_read_b32 v68, a12
v_accvgpr_read_b32 v69, a13
v_accvgpr_read_b32 v70, a14
v_accvgpr_read_b32 v71, a15
v_cvt_pk_bf16_f32 v72, v64, v65
v_cvt_pk_bf16_f32 v73, v66, v67
v_cvt_pk_bf16_f32 v74, v68, v69
v_cvt_pk_bf16_f32 v75, v70, v71
buffer_store_dwordx4 v[72:75], v3, s[48:51], s42 offen offset:0 sc1
v_accvgpr_read_b32 v80, a20
v_accvgpr_read_b32 v81, a21
v_accvgpr_read_b32 v82, a22
v_accvgpr_read_b32 v83, a23
v_accvgpr_read_b32 v84, a28
v_accvgpr_read_b32 v85, a29
v_accvgpr_read_b32 v86, a30
v_accvgpr_read_b32 v87, a31
v_cvt_pk_bf16_f32 v88, v80, v81
v_cvt_pk_bf16_f32 v89, v82, v83
v_cvt_pk_bf16_f32 v90, v84, v85
v_cvt_pk_bf16_f32 v91, v86, v87
buffer_store_dwordx4 v[88:91], v3, s[48:51], s42 offen offset:1024 sc1
v_accvgpr_read_b32 v96, a36
v_accvgpr_read_b32 v97, a37
v_accvgpr_read_b32 v98, a38
v_accvgpr_read_b32 v99, a39
v_accvgpr_read_b32 v100, a44
v_accvgpr_read_b32 v101, a45
v_accvgpr_read_b32 v102, a46
v_accvgpr_read_b32 v103, a47
v_cvt_pk_bf16_f32 v104, v96, v97
v_cvt_pk_bf16_f32 v105, v98, v99
v_cvt_pk_bf16_f32 v106, v100, v101
v_cvt_pk_bf16_f32 v107, v102, v103
buffer_store_dwordx4 v[104:107], v3, s[48:51], s42 offen offset:2048 sc1
v_accvgpr_read_b32 v112, a52
v_accvgpr_read_b32 v113, a53
v_accvgpr_read_b32 v114, a54
v_accvgpr_read_b32 v115, a55
v_accvgpr_read_b32 v116, a60
v_accvgpr_read_b32 v117, a61
v_accvgpr_read_b32 v118, a62
v_accvgpr_read_b32 v119, a63
v_cvt_pk_bf16_f32 v120, v112, v113
v_cvt_pk_bf16_f32 v121, v114, v115
v_cvt_pk_bf16_f32 v122, v116, v117
v_cvt_pk_bf16_f32 v123, v118, v119
buffer_store_dwordx4 v[120:123], v3, s[48:51], s42 offen offset:3072 sc1
s_waitcnt vmcnt(0)
s_barrier
s_cmp_lg_u32 s32, 0
s_cbranch_scc1 L_attn_kernel_wo_xpub
s_lshl_b32 s42, s39, 7
s_add_u32 s42, s42, 81920
s_lshl_b32 s43, s40, 1
s_add_u32 s43, s43, s41
s_lshl_b32 s43, s43, 2
v_mov_b32 v6, s43
v_mov_b32 v7, 1
s_mov_b64 s[52:53], exec
s_mov_b64 exec, 1
buffer_store_dword v7, v6, s[16:19], s42 offen sc1
s_mov_b64 exec, s[52:53]
L_attn_kernel_wo_xpub:
s_load_dwordx2 s[8:9], s[0:1], 104
v_and_b32 v1, 7, v0
v_bfe_u32 v2, v0, 3, 2
v_bfe_u32 v3, v0, 5, 1
v_lshrrev_b32 v4, 6, v0
v_lshl_add_u32 v5, v4, 3, v3
s_lshr_b32 s10, s2, 1
s_lshl_b32 s10, s10, 15
s_and_b32 s11, s2, 1
s_lshl_b32 s11, s11, 7
s_add_u32 s10, s10, s11
v_lshlrev_b32 v6, 10, v5
v_lshl_add_u32 v6, v2, 8, v6
v_lshl_add_u32 v6, v1, 4, v6
v_add_u32 v6, s10, v6
v_lshlrev_b32 v8, 7, v5
v_lshl_add_u32 v8, v2, 4, v8
s_waitcnt lgkmcnt(0)
s_mov_b32 s12, s8
s_mov_b32 s13, s9
s_mov_b32 s14, 0x20000
s_mov_b32 s15, 0x20000
s_add_u32 s16, s8, 0x500000
s_addc_u32 s17, s9, 0
s_mov_b32 s18, 0x400000
s_mov_b32 s19, 0x20000
s_add_u32 s20, s8, 0x900000
s_addc_u32 s21, s9, 0
s_mov_b32 s22, 0x400000
s_mov_b32 s23, 0x20000
v_lshlrev_b32 v144, 4, v0
s_mov_b32 s24, 12288
buffer_load_dwordx4 v[128:131], v144, s[12:15], s24 offen
s_mov_b32 s24, 45056
buffer_load_dwordx4 v[132:135], v144, s[12:15], s24 offen
s_mov_b32 s24, 16384
buffer_load_dwordx4 v[136:139], v144, s[12:15], s24 offen
s_mov_b32 s24, 49152
buffer_load_dwordx4 v[140:143], v144, s[12:15], s24 offen
s_load_dwordx2 s[4:5], s[0:1], 0
s_mov_b32 s24, 8192
buffer_load_dwordx4 v[164:167], v144, s[12:15], s24 offen
s_mov_b32 s24, 40960
buffer_load_dwordx4 v[168:171], v144, s[12:15], s24 offen
s_lshl_b32 s11, s2, 14
v_lshlrev_b32 v7, 11, v1
v_lshl_add_u32 v7, v5, 6, v7
v_lshl_add_u32 v7, v2, 3, v7
v_add_u32 v7, s11, v7
s_waitcnt lgkmcnt(0)
s_mov_b32 s40, s4
s_mov_b32 s41, s5
s_mov_b32 s42, 0x400000
s_mov_b32 s43, 0x20000
buffer_load_dwordx2 v[200:201], v7, s[40:43], 0 offen offset:0
buffer_load_dwordx2 v[202:203], v7, s[40:43], 0 offen offset:32
buffer_load_dwordx2 v[204:205], v7, s[40:43], 0 offen offset:128
buffer_load_dwordx2 v[206:207], v7, s[40:43], 0 offen offset:160
buffer_load_dwordx2 v[208:209], v7, s[40:43], 0 offen offset:256
buffer_load_dwordx2 v[210:211], v7, s[40:43], 0 offen offset:288
buffer_load_dwordx2 v[212:213], v7, s[40:43], 0 offen offset:384
buffer_load_dwordx2 v[214:215], v7, s[40:43], 0 offen offset:416
s_waitcnt vmcnt(0)
v_add_f32 v128, v128, v132
v_add_f32 v136, v136, v140
v_add_f32 v129, v129, v133
v_add_f32 v137, v137, v141
v_add_f32 v130, v130, v134
v_add_f32 v138, v138, v142
v_add_f32 v131, v131, v135
v_add_f32 v139, v139, v143
v_cvt_pk_bf16_f32 v132, v128, v129
v_lshlrev_b32 v128, 16, v132
v_and_b32 v129, 0xffff0000, v132
v_cvt_pk_bf16_f32 v132, v136, v137
v_lshlrev_b32 v136, 16, v132
v_and_b32 v137, 0xffff0000, v132
v_cvt_pk_bf16_f32 v132, v130, v131
v_lshlrev_b32 v130, 16, v132
v_and_b32 v131, 0xffff0000, v132
v_cvt_pk_bf16_f32 v132, v138, v139
v_lshlrev_b32 v138, 16, v132
v_and_b32 v139, 0xffff0000, v132
v_add_f32 v136, 1.0, v136
v_add_f32 v137, 1.0, v137
v_add_f32 v138, 1.0, v138
v_add_f32 v139, 1.0, v139
v_cvt_pk_bf16_f32 v132, v136, v137
v_lshlrev_b32 v136, 16, v132
v_and_b32 v137, 0xffff0000, v132
v_cvt_pk_bf16_f32 v132, v138, v139
v_lshlrev_b32 v138, 16, v132
v_and_b32 v139, 0xffff0000, v132
ds_write_b128 v144, v[128:131] offset:8192
ds_write_b128 v144, v[136:139] offset:4096
v_add_f32 v164, v164, v168
v_add_f32 v165, v165, v169
v_add_f32 v166, v166, v170
v_add_f32 v167, v167, v171
v_cvt_pk_bf16_f32 v168, v164, v165
v_lshlrev_b32 v164, 16, v168
v_and_b32 v165, 0xffff0000, v168
v_cvt_pk_bf16_f32 v168, v166, v167
v_lshlrev_b32 v166, 16, v168
v_and_b32 v167, 0xffff0000, v168
ds_write_b128 v144, v[164:167] offset:12288
s_waitcnt lgkmcnt(0)
s_add_u32 s44, s8, 0x3000000
s_addc_u32 s45, s9, 0
s_mov_b32 s46, 0x800000
s_mov_b32 s47, 0x20000
s_add_u32 s52, s8, 0x80000
s_addc_u32 s53, s9, 0
s_mov_b32 s54, 0x20000
s_mov_b32 s55, 0x20000
v_readfirstlane_b32 s48, v4
s_nop 0
s_cmp_lg_u32 s48, 0
s_cbranch_scc1 L_attn_kernel_ln_xpolled
s_lshr_b32 s49, s2, 4
s_lshl_b32 s49, s49, 7
s_add_u32 s49, s49, 81920
v_and_b32 v9, 63, v0
v_lshlrev_b32 v9, 2, v9
s_mov_b32 s48, 0x40000
s_mov_b64 s[50:51], exec
s_mov_b32 exec_lo, 0xffff
s_mov_b32 exec_hi, 0
L_attn_kernel_ln_xpoll:
buffer_load_dword v10, v9, s[52:55], s49 offen sc1
s_waitcnt vmcnt(0)
v_cmp_ne_u32 vcc, 1, v10
s_sub_u32 s48, s48, 1
s_cmp_eq_u32 s48, 0
s_cbranch_scc1 L_attn_kernel_ln_xpdone
s_cbranch_vccnz L_attn_kernel_ln_xpoll
L_attn_kernel_ln_xpdone:
s_mov_b64 exec, s[50:51]
L_attn_kernel_ln_xpolled:
s_barrier
s_mov_b32 s24, 0
buffer_load_dwordx4 v[16:19], v6, s[44:47], s24 offen sc1
s_mov_b32 s24, 4194304
buffer_load_dwordx4 v[176:179], v6, s[44:47], s24 offen sc1
s_mov_b32 s24, 2048
buffer_load_dwordx4 v[20:23], v6, s[44:47], s24 offen sc1
s_mov_b32 s24, 4196352
buffer_load_dwordx4 v[180:183], v6, s[44:47], s24 offen sc1
s_mov_b32 s24, 4096
buffer_load_dwordx4 v[24:27], v6, s[44:47], s24 offen sc1
s_mov_b32 s24, 4198400
buffer_load_dwordx4 v[184:187], v6, s[44:47], s24 offen sc1
s_mov_b32 s24, 6144
buffer_load_dwordx4 v[28:31], v6, s[44:47], s24 offen sc1
s_mov_b32 s24, 4200448
buffer_load_dwordx4 v[188:191], v6, s[44:47], s24 offen sc1
s_waitcnt vmcnt(0)
ds_read_b128 v[216:219], v8 offset:12288
ds_read_b128 v[220:223], v8 offset:12352
ds_read_b128 v[224:227], v8 offset:12544
ds_read_b128 v[228:231], v8 offset:12608
ds_read_b128 v[232:235], v8 offset:12800
ds_read_b128 v[236:239], v8 offset:12864
ds_read_b128 v[240:243], v8 offset:13056
ds_read_b128 v[244:247], v8 offset:13120
v_lshlrev_b32 v32, 16, v16
v_and_b32 v33, 0xffff0000, v16
v_lshlrev_b32 v9, 16, v176
v_and_b32 v10, 0xffff0000, v176
v_add_f32 v32, v32, v9
v_add_f32 v33, v33, v10
v_lshlrev_b32 v34, 16, v17
v_and_b32 v35, 0xffff0000, v17
v_lshlrev_b32 v9, 16, v177
v_and_b32 v10, 0xffff0000, v177
v_add_f32 v34, v34, v9
v_add_f32 v35, v35, v10
v_lshlrev_b32 v36, 16, v18
v_and_b32 v37, 0xffff0000, v18
v_lshlrev_b32 v9, 16, v178
v_and_b32 v10, 0xffff0000, v178
v_add_f32 v36, v36, v9
v_add_f32 v37, v37, v10
v_lshlrev_b32 v38, 16, v19
v_and_b32 v39, 0xffff0000, v19
v_lshlrev_b32 v9, 16, v179
v_and_b32 v10, 0xffff0000, v179
v_add_f32 v38, v38, v9
v_add_f32 v39, v39, v10
v_lshlrev_b32 v40, 16, v20
v_and_b32 v41, 0xffff0000, v20
v_lshlrev_b32 v9, 16, v180
v_and_b32 v10, 0xffff0000, v180
v_add_f32 v40, v40, v9
v_add_f32 v41, v41, v10
v_lshlrev_b32 v42, 16, v21
v_and_b32 v43, 0xffff0000, v21
v_lshlrev_b32 v9, 16, v181
v_and_b32 v10, 0xffff0000, v181
v_add_f32 v42, v42, v9
v_add_f32 v43, v43, v10
v_lshlrev_b32 v44, 16, v22
v_and_b32 v45, 0xffff0000, v22
v_lshlrev_b32 v9, 16, v182
v_and_b32 v10, 0xffff0000, v182
v_add_f32 v44, v44, v9
v_add_f32 v45, v45, v10
v_lshlrev_b32 v46, 16, v23
v_and_b32 v47, 0xffff0000, v23
v_lshlrev_b32 v9, 16, v183
v_and_b32 v10, 0xffff0000, v183
v_add_f32 v46, v46, v9
v_add_f32 v47, v47, v10
v_lshlrev_b32 v48, 16, v24
v_and_b32 v49, 0xffff0000, v24
v_lshlrev_b32 v9, 16, v184
v_and_b32 v10, 0xffff0000, v184
v_add_f32 v48, v48, v9
v_add_f32 v49, v49, v10
v_lshlrev_b32 v50, 16, v25
v_and_b32 v51, 0xffff0000, v25
v_lshlrev_b32 v9, 16, v185
v_and_b32 v10, 0xffff0000, v185
v_add_f32 v50, v50, v9
v_add_f32 v51, v51, v10
v_lshlrev_b32 v52, 16, v26
v_and_b32 v53, 0xffff0000, v26
v_lshlrev_b32 v9, 16, v186
v_and_b32 v10, 0xffff0000, v186
v_add_f32 v52, v52, v9
v_add_f32 v53, v53, v10
v_lshlrev_b32 v54, 16, v27
v_and_b32 v55, 0xffff0000, v27
v_lshlrev_b32 v9, 16, v187
v_and_b32 v10, 0xffff0000, v187
v_add_f32 v54, v54, v9
v_add_f32 v55, v55, v10
v_lshlrev_b32 v56, 16, v28
v_and_b32 v57, 0xffff0000, v28
v_lshlrev_b32 v9, 16, v188
v_and_b32 v10, 0xffff0000, v188
v_add_f32 v56, v56, v9
v_add_f32 v57, v57, v10
v_lshlrev_b32 v58, 16, v29
v_and_b32 v59, 0xffff0000, v29
v_lshlrev_b32 v9, 16, v189
v_and_b32 v10, 0xffff0000, v189
v_add_f32 v58, v58, v9
v_add_f32 v59, v59, v10
v_lshlrev_b32 v60, 16, v30
v_and_b32 v61, 0xffff0000, v30
v_lshlrev_b32 v9, 16, v190
v_and_b32 v10, 0xffff0000, v190
v_add_f32 v60, v60, v9
v_add_f32 v61, v61, v10
v_lshlrev_b32 v62, 16, v31
v_and_b32 v63, 0xffff0000, v31
v_lshlrev_b32 v9, 16, v191
v_and_b32 v10, 0xffff0000, v191
v_add_f32 v62, v62, v9
v_add_f32 v63, v63, v10
s_waitcnt lgkmcnt(0)
v_lshlrev_b32 v9, 16, v200
v_and_b32 v10, 0xffff0000, v200
v_fma_f32 v32, v32, v216, v9
v_fma_f32 v33, v33, v217, v10
v_cvt_pk_bf16_f32 v16, v32, v33
v_lshlrev_b32 v9, 16, v201
v_and_b32 v10, 0xffff0000, v201
v_fma_f32 v34, v34, v218, v9
v_fma_f32 v35, v35, v219, v10
v_cvt_pk_bf16_f32 v17, v34, v35
v_lshlrev_b32 v9, 16, v202
v_and_b32 v10, 0xffff0000, v202
v_fma_f32 v36, v36, v220, v9
v_fma_f32 v37, v37, v221, v10
v_cvt_pk_bf16_f32 v18, v36, v37
v_lshlrev_b32 v9, 16, v203
v_and_b32 v10, 0xffff0000, v203
v_fma_f32 v38, v38, v222, v9
v_fma_f32 v39, v39, v223, v10
v_cvt_pk_bf16_f32 v19, v38, v39
v_lshlrev_b32 v9, 16, v204
v_and_b32 v10, 0xffff0000, v204
v_fma_f32 v40, v40, v224, v9
v_fma_f32 v41, v41, v225, v10
v_cvt_pk_bf16_f32 v20, v40, v41
v_lshlrev_b32 v9, 16, v205
v_and_b32 v10, 0xffff0000, v205
v_fma_f32 v42, v42, v226, v9
v_fma_f32 v43, v43, v227, v10
v_cvt_pk_bf16_f32 v21, v42, v43
v_lshlrev_b32 v9, 16, v206
v_and_b32 v10, 0xffff0000, v206
v_fma_f32 v44, v44, v228, v9
v_fma_f32 v45, v45, v229, v10
v_cvt_pk_bf16_f32 v22, v44, v45
v_lshlrev_b32 v9, 16, v207
v_and_b32 v10, 0xffff0000, v207
v_fma_f32 v46, v46, v230, v9
v_fma_f32 v47, v47, v231, v10
v_cvt_pk_bf16_f32 v23, v46, v47
v_lshlrev_b32 v9, 16, v208
v_and_b32 v10, 0xffff0000, v208
v_fma_f32 v48, v48, v232, v9
v_fma_f32 v49, v49, v233, v10
v_cvt_pk_bf16_f32 v24, v48, v49
v_lshlrev_b32 v9, 16, v209
v_and_b32 v10, 0xffff0000, v209
v_fma_f32 v50, v50, v234, v9
v_fma_f32 v51, v51, v235, v10
v_cvt_pk_bf16_f32 v25, v50, v51
v_lshlrev_b32 v9, 16, v210
v_and_b32 v10, 0xffff0000, v210
v_fma_f32 v52, v52, v236, v9
v_fma_f32 v53, v53, v237, v10
v_cvt_pk_bf16_f32 v26, v52, v53
v_lshlrev_b32 v9, 16, v211
v_and_b32 v10, 0xffff0000, v211
v_fma_f32 v54, v54, v238, v9
v_fma_f32 v55, v55, v239, v10
v_cvt_pk_bf16_f32 v27, v54, v55
v_lshlrev_b32 v9, 16, v212
v_and_b32 v10, 0xffff0000, v212
v_fma_f32 v56, v56, v240, v9
v_fma_f32 v57, v57, v241, v10
v_cvt_pk_bf16_f32 v28, v56, v57
v_lshlrev_b32 v9, 16, v213
v_and_b32 v10, 0xffff0000, v213
v_fma_f32 v58, v58, v242, v9
v_fma_f32 v59, v59, v243, v10
v_cvt_pk_bf16_f32 v29, v58, v59
v_lshlrev_b32 v9, 16, v214
v_and_b32 v10, 0xffff0000, v214
v_fma_f32 v60, v60, v244, v9
v_fma_f32 v61, v61, v245, v10
v_cvt_pk_bf16_f32 v30, v60, v61
v_lshlrev_b32 v9, 16, v215
v_and_b32 v10, 0xffff0000, v215
v_fma_f32 v62, v62, v246, v9
v_fma_f32 v63, v63, v247, v10
v_cvt_pk_bf16_f32 v31, v62, v63
s_mov_b32 s24, 0
buffer_store_dwordx4 v[16:19], v6, s[16:19], s24 offen sc1
s_mov_b32 s24, 2048
buffer_store_dwordx4 v[20:23], v6, s[16:19], s24 offen sc1
s_mov_b32 s24, 4096
buffer_store_dwordx4 v[24:27], v6, s[16:19], s24 offen sc1
s_mov_b32 s24, 6144
buffer_store_dwordx4 v[28:31], v6, s[16:19], s24 offen sc1
v_lshlrev_b32 v32, 16, v16
v_and_b32 v33, 0xffff0000, v16
v_lshlrev_b32 v34, 16, v17
v_and_b32 v35, 0xffff0000, v17
v_lshlrev_b32 v36, 16, v18
v_and_b32 v37, 0xffff0000, v18
v_lshlrev_b32 v38, 16, v19
v_and_b32 v39, 0xffff0000, v19
v_lshlrev_b32 v40, 16, v20
v_and_b32 v41, 0xffff0000, v20
v_lshlrev_b32 v42, 16, v21
v_and_b32 v43, 0xffff0000, v21
v_lshlrev_b32 v44, 16, v22
v_and_b32 v45, 0xffff0000, v22
v_lshlrev_b32 v46, 16, v23
v_and_b32 v47, 0xffff0000, v23
v_lshlrev_b32 v48, 16, v24
v_and_b32 v49, 0xffff0000, v24
v_lshlrev_b32 v50, 16, v25
v_and_b32 v51, 0xffff0000, v25
v_lshlrev_b32 v52, 16, v26
v_and_b32 v53, 0xffff0000, v26
v_lshlrev_b32 v54, 16, v27
v_and_b32 v55, 0xffff0000, v27
v_lshlrev_b32 v56, 16, v28
v_and_b32 v57, 0xffff0000, v28
v_lshlrev_b32 v58, 16, v29
v_and_b32 v59, 0xffff0000, v29
v_lshlrev_b32 v60, 16, v30
v_and_b32 v61, 0xffff0000, v30
v_lshlrev_b32 v62, 16, v31
v_and_b32 v63, 0xffff0000, v31
v_add_f32 v10, v32, v33
v_add_f32 v11, v34, v35
v_add_f32 v10, v10, v36
v_add_f32 v10, v10, v37
v_add_f32 v11, v11, v38
v_add_f32 v11, v11, v39
v_add_f32 v10, v10, v40
v_add_f32 v10, v10, v41
v_add_f32 v11, v11, v42
v_add_f32 v11, v11, v43
v_add_f32 v10, v10, v44
v_add_f32 v10, v10, v45
v_add_f32 v11, v11, v46
v_add_f32 v11, v11, v47
v_add_f32 v10, v10, v48
v_add_f32 v10, v10, v49
v_add_f32 v11, v11, v50
v_add_f32 v11, v11, v51
v_add_f32 v10, v10, v52
v_add_f32 v10, v10, v53
v_add_f32 v11, v11, v54
v_add_f32 v11, v11, v55
v_add_f32 v10, v10, v56
v_add_f32 v10, v10, v57
v_add_f32 v11, v11, v58
v_add_f32 v11, v11, v59
v_add_f32 v10, v10, v60
v_add_f32 v10, v10, v61
v_add_f32 v11, v11, v62
v_add_f32 v11, v11, v63
v_add_f32 v10, v10, v11
s_nop 1
v_add_f32_dpp v10, v10, v10 row_ror:8 row_mask:0xf bank_mask:0xf
v_mov_b32 v11, v10
s_nop 1
v_permlane16_swap_b32 v10, v11
v_add_f32 v10, v10, v11
v_mov_b32 v11, v10
s_nop 1
v_permlane32_swap_b32 v10, v11
v_add_f32 v10, v10, v11
v_lshlrev_b32 v12, 5, v4
v_lshl_add_u32 v12, v1, 2, v12
ds_write_b32 v12, v10 offset:3072
s_waitcnt lgkmcnt(0)
s_barrier
v_lshlrev_b32 v12, 2, v1
ds_read_b32 v13, v12 offset:3072
ds_read_b32 v14, v12 offset:3104
ds_read_b32 v15, v12 offset:3136
ds_read_b32 v16, v12 offset:3168
s_waitcnt lgkmcnt(0)
v_add_f32 v13, v13, v14
v_add_f32 v15, v15, v16
v_add_f32 v10, v13, v15
v_mul_f32 v10, 0x3a800000, v10
v_sub_f32 v32, v32, v10
v_sub_f32 v33, v33, v10
v_sub_f32 v34, v34, v10
v_sub_f32 v35, v35, v10
v_sub_f32 v36, v36, v10
v_sub_f32 v37, v37, v10
v_sub_f32 v38, v38, v10
v_sub_f32 v39, v39, v10
v_sub_f32 v40, v40, v10
v_sub_f32 v41, v41, v10
v_sub_f32 v42, v42, v10
v_sub_f32 v43, v43, v10
v_sub_f32 v44, v44, v10
v_sub_f32 v45, v45, v10
v_sub_f32 v46, v46, v10
v_sub_f32 v47, v47, v10
v_sub_f32 v48, v48, v10
v_sub_f32 v49, v49, v10
v_sub_f32 v50, v50, v10
v_sub_f32 v51, v51, v10
v_sub_f32 v52, v52, v10
v_sub_f32 v53, v53, v10
v_sub_f32 v54, v54, v10
v_sub_f32 v55, v55, v10
v_sub_f32 v56, v56, v10
v_sub_f32 v57, v57, v10
v_sub_f32 v58, v58, v10
v_sub_f32 v59, v59, v10
v_sub_f32 v60, v60, v10
v_sub_f32 v61, v61, v10
v_sub_f32 v62, v62, v10
v_sub_f32 v63, v63, v10
v_mul_f32 v10, v32, v32
v_mul_f32 v11, v33, v33
v_fmac_f32 v10, v34, v34
v_fmac_f32 v11, v35, v35
v_fmac_f32 v10, v36, v36
v_fmac_f32 v11, v37, v37
v_fmac_f32 v10, v38, v38
v_fmac_f32 v11, v39, v39
v_fmac_f32 v10, v40, v40
v_fmac_f32 v11, v41, v41
v_fmac_f32 v10, v42, v42
v_fmac_f32 v11, v43, v43
v_fmac_f32 v10, v44, v44
v_fmac_f32 v11, v45, v45
v_fmac_f32 v10, v46, v46
v_fmac_f32 v11, v47, v47
v_fmac_f32 v10, v48, v48
v_fmac_f32 v11, v49, v49
v_fmac_f32 v10, v50, v50
v_fmac_f32 v11, v51, v51
v_fmac_f32 v10, v52, v52
v_fmac_f32 v11, v53, v53
v_fmac_f32 v10, v54, v54
v_fmac_f32 v11, v55, v55
v_fmac_f32 v10, v56, v56
v_fmac_f32 v11, v57, v57
v_fmac_f32 v10, v58, v58
v_fmac_f32 v11, v59, v59
v_fmac_f32 v10, v60, v60
v_fmac_f32 v11, v61, v61
v_fmac_f32 v10, v62, v62
v_fmac_f32 v11, v63, v63
v_add_f32 v10, v10, v11
s_nop 1
v_add_f32_dpp v10, v10, v10 row_ror:8 row_mask:0xf bank_mask:0xf
v_mov_b32 v11, v10
s_nop 1
v_permlane16_swap_b32 v10, v11
v_add_f32 v10, v10, v11
v_mov_b32 v11, v10
s_nop 1
v_permlane32_swap_b32 v10, v11
v_add_f32 v10, v10, v11
v_lshlrev_b32 v12, 5, v4
v_lshl_add_u32 v12, v1, 2, v12
ds_write_b32 v12, v10 offset:3200
s_waitcnt lgkmcnt(0)
s_barrier
v_lshlrev_b32 v12, 2, v1
ds_read_b32 v13, v12 offset:3200
ds_read_b32 v14, v12 offset:3232
ds_read_b32 v15, v12 offset:3264
ds_read_b32 v16, v12 offset:3296
s_waitcnt lgkmcnt(0)
v_add_f32 v13, v13, v14
v_add_f32 v15, v15, v16
v_add_f32 v10, v13, v15
v_mul_f32 v10, 0x3a800000, v10
v_add_f32 v10, 0x3727c5ac, v10
v_rsq_f32 v10, v10
s_nop 0
v_mul_f32 v32, v32, v10
v_mul_f32 v33, v33, v10
v_mul_f32 v34, v34, v10
v_mul_f32 v35, v35, v10
v_mul_f32 v36, v36, v10
v_mul_f32 v37, v37, v10
v_mul_f32 v38, v38, v10
v_mul_f32 v39, v39, v10
v_mul_f32 v40, v40, v10
v_mul_f32 v41, v41, v10
v_mul_f32 v42, v42, v10
v_mul_f32 v43, v43, v10
v_mul_f32 v44, v44, v10
v_mul_f32 v45, v45, v10
v_mul_f32 v46, v46, v10
v_mul_f32 v47, v47, v10
v_mul_f32 v48, v48, v10
v_mul_f32 v49, v49, v10
v_mul_f32 v50, v50, v10
v_mul_f32 v51, v51, v10
v_mul_f32 v52, v52, v10
v_mul_f32 v53, v53, v10
v_mul_f32 v54, v54, v10
v_mul_f32 v55, v55, v10
v_mul_f32 v56, v56, v10
v_mul_f32 v57, v57, v10
v_mul_f32 v58, v58, v10
v_mul_f32 v59, v59, v10
v_mul_f32 v60, v60, v10
v_mul_f32 v61, v61, v10
v_mul_f32 v62, v62, v10
v_mul_f32 v63, v63, v10
ds_read_b128 v[64:67], v8 offset:4096
ds_read_b128 v[96:99], v8 offset:8192
ds_read_b128 v[68:71], v8 offset:4160
ds_read_b128 v[100:103], v8 offset:8256
ds_read_b128 v[72:75], v8 offset:4352
ds_read_b128 v[104:107], v8 offset:8448
ds_read_b128 v[76:79], v8 offset:4416
ds_read_b128 v[108:111], v8 offset:8512
ds_read_b128 v[80:83], v8 offset:4608
ds_read_b128 v[112:115], v8 offset:8704
ds_read_b128 v[84:87], v8 offset:4672
ds_read_b128 v[116:119], v8 offset:8768
ds_read_b128 v[88:91], v8 offset:4864
ds_read_b128 v[120:123], v8 offset:8960
ds_read_b128 v[92:95], v8 offset:4928
ds_read_b128 v[124:127], v8 offset:9024
s_waitcnt lgkmcnt(12)
v_fma_f32 v32, v32, v64, v96
v_fma_f32 v33, v33, v65, v97
v_fma_f32 v34, v34, v66, v98
v_fma_f32 v35, v35, v67, v99
v_fma_f32 v36, v36, v68, v100
v_fma_f32 v37, v37, v69, v101
v_fma_f32 v38, v38, v70, v102
v_fma_f32 v39, v39, v71, v103
v_cvt_pk_bf16_f32 v16, v32, v33
v_cvt_pk_bf16_f32 v17, v34, v35
v_cvt_pk_bf16_f32 v18, v36, v37
v_cvt_pk_bf16_f32 v19, v38, v39
s_mov_b32 s24, 0
buffer_store_dwordx4 v[16:19], v6, s[20:23], s24 offen sc1
s_waitcnt lgkmcnt(8)
v_fma_f32 v40, v40, v72, v104
v_fma_f32 v41, v41, v73, v105
v_fma_f32 v42, v42, v74, v106
v_fma_f32 v43, v43, v75, v107
v_fma_f32 v44, v44, v76, v108
v_fma_f32 v45, v45, v77, v109
v_fma_f32 v46, v46, v78, v110
v_fma_f32 v47, v47, v79, v111
v_cvt_pk_bf16_f32 v20, v40, v41
v_cvt_pk_bf16_f32 v21, v42, v43
v_cvt_pk_bf16_f32 v22, v44, v45
v_cvt_pk_bf16_f32 v23, v46, v47
s_mov_b32 s24, 2048
buffer_store_dwordx4 v[20:23], v6, s[20:23], s24 offen sc1
s_waitcnt lgkmcnt(4)
v_fma_f32 v48, v48, v80, v112
v_fma_f32 v49, v49, v81, v113
v_fma_f32 v50, v50, v82, v114
v_fma_f32 v51, v51, v83, v115
v_fma_f32 v52, v52, v84, v116
v_fma_f32 v53, v53, v85, v117
v_fma_f32 v54, v54, v86, v118
v_fma_f32 v55, v55, v87, v119
v_cvt_pk_bf16_f32 v24, v48, v49
v_cvt_pk_bf16_f32 v25, v50, v51
v_cvt_pk_bf16_f32 v26, v52, v53
v_cvt_pk_bf16_f32 v27, v54, v55
s_mov_b32 s24, 4096
buffer_store_dwordx4 v[24:27], v6, s[20:23], s24 offen sc1
s_waitcnt lgkmcnt(0)
v_fma_f32 v56, v56, v88, v120
v_fma_f32 v57, v57, v89, v121
v_fma_f32 v58, v58, v90, v122
v_fma_f32 v59, v59, v91, v123
v_fma_f32 v60, v60, v92, v124
v_fma_f32 v61, v61, v93, v125
v_fma_f32 v62, v62, v94, v126
v_fma_f32 v63, v63, v95, v127
v_cvt_pk_bf16_f32 v28, v56, v57
v_cvt_pk_bf16_f32 v29, v58, v59
v_cvt_pk_bf16_f32 v30, v60, v61
v_cvt_pk_bf16_f32 v31, v62, v63
s_mov_b32 s24, 6144
buffer_store_dwordx4 v[28:31], v6, s[20:23], s24 offen sc1
s_waitcnt vmcnt(0)
s_barrier
v_readfirstlane_b32 s48, v4
s_nop 0
s_cmp_lg_u32 s48, 0
s_cbranch_scc1 L_attn_kernel_ln_sig
s_mov_b64 s[50:51], exec
s_mov_b64 exec, 1
s_add_u32 s52, s8, 0x80000
s_addc_u32 s53, s9, 0
s_mov_b32 s54, 0x20000
s_mov_b32 s55, 0x20000
s_lshr_b32 s49, s2, 5
s_lshl_b32 s49, s49, 7
s_add_u32 s49, s49, 69632
s_and_b32 s48, s2, 31
s_lshl_b32 s48, s48, 2
v_mov_b32 v9, s48
v_mov_b32 v10, 1
buffer_store_dword v10, v9, s[52:55], s49 offen sc1
s_mov_b64 exec, s[50:51]
L_attn_kernel_ln_sig:
s_load_dwordx2 s[4:5], s[0:1], 104
s_load_dwordx2 s[6:7], s[0:1], 48
s_load_dwordx2 s[8:9], s[0:1], 56
v_lshrrev_b32 v2, 6, v0
v_and_b32 v1, 63, v0
v_readfirstlane_b32 s32, v2
s_and_b32 s37, s2, 7
s_lshr_b32 s38, s2, 3
s_lshl_b32 s40, s37, 2
s_and_b32 s41, s38, 3
s_add_u32 s40, s40, s41
s_lshr_b32 s39, s38, 2
v_lshlrev_b32 v3, 4, v1
v_mov_b32 v8, v3
v_add_u32 v9, 32768, v3
v_add_u32 v10, 65536, v3
v_add_u32 v11, 98304, v3
s_lshl_b32 s33, s39, 4
s_lshl_b32 s42, s32, 2
s_add_u32 s33, s33, s42
s_lshl_b32 s33, s33, 15
v_add_u32 v4, 0, v1
v_mul_u32_u24 v5, 4682, v4
v_lshrrev_b32 v5, 16, v5
v_mul_u32_u24 v6, 14, v5
v_sub_u32 v6, v4, v6
v_mul_u32_u24 v5, 7168, v5
v_lshl_add_u32 v5, v6, 4, v5
v_subrev_u32 v12, 0, v5
v_add_u32 v4, 64, v1
v_mul_u32_u24 v5, 4682, v4
v_lshrrev_b32 v5, 16, v5
v_mul_u32_u24 v6, 14, v5
v_sub_u32 v6, v4, v6
v_mul_u32_u24 v5, 7168, v5
v_lshl_add_u32 v5, v6, 4, v5
v_subrev_u32 v13, 1024, v5
v_add_u32 v4, 128, v1
v_mul_u32_u24 v5, 4682, v4
v_lshrrev_b32 v5, 16, v5
v_mul_u32_u24 v6, 14, v5
v_sub_u32 v6, v4, v6
v_mul_u32_u24 v5, 7168, v5
v_lshl_add_u32 v5, v6, 4, v5
v_subrev_u32 v14, 2048, v5
v_add_u32 v4, 192, v1
v_mul_u32_u24 v5, 4682, v4
v_lshrrev_b32 v5, 16, v5
v_mul_u32_u24 v6, 14, v5
v_sub_u32 v6, v4, v6
v_mul_u32_u24 v5, 7168, v5
v_lshl_add_u32 v5, v6, 4, v5
v_subrev_u32 v15, 3072, v5
v_add_u32 v4, 256, v1
v_mul_u32_u24 v5, 4682, v4
v_lshrrev_b32 v5, 16, v5
v_mul_u32_u24 v6, 14, v5
v_sub_u32 v6, v4, v6
v_mul_u32_u24 v5, 7168, v5
v_lshl_add_u32 v5, v6, 4, v5
v_subrev_u32 v16, 0, v5
v_add_u32 v4, 320, v1
v_mul_u32_u24 v5, 4682, v4
v_lshrrev_b32 v5, 16, v5
v_mul_u32_u24 v6, 14, v5
v_sub_u32 v6, v4, v6
v_mul_u32_u24 v5, 7168, v5
v_lshl_add_u32 v5, v6, 4, v5
v_subrev_u32 v17, 1024, v5
v_add_u32 v4, 384, v1
v_mul_u32_u24 v5, 4682, v4
v_lshrrev_b32 v5, 16, v5
v_mul_u32_u24 v6, 14, v5
v_sub_u32 v6, v4, v6
v_mul_u32_u24 v5, 7168, v5
v_lshl_add_u32 v5, v6, 4, v5
v_subrev_u32 v18, 2048, v5
s_and_b32 s42, s32, 1
s_mul_i32 s34, s42, 229376
s_mul_i32 s43, s40, 224
s_add_u32 s34, s34, s43
s_lshr_b32 s43, s32, 1
s_mul_i32 s35, s43, 14336
s_mul_i32 s42, s42, 7168
s_add_u32 s35, s35, s42
v_lshrrev_b32 v4, 4, v1
v_bfe_u32 v5, v1, 2, 2
v_lshl_add_u32 v5, v4, 2, v5
v_mul_u32_u24 v5, 224, v5
v_and_b32 v6, 3, v1
v_lshl_add_u32 v20, v6, 3, v5
v_add_u32 v21, 57344, v20
s_waitcnt lgkmcnt(0)
s_add_u32 s12, s4, 0x900000
s_addc_u32 s13, s5, 0
s_mov_b32 s14, 0x400000
s_mov_b32 s15, 0x20000
s_cmp_lt_u32 s32, 2
s_cselect_b32 s16, s6, s8
s_cselect_b32 s17, s7, s9
s_mov_b32 s18, 7340032
s_mov_b32 s19, 0x20000
s_add_u32 s20, s4, 0x2000000
s_addc_u32 s21, s5, 0
s_mov_b32 s22, 0xe00000
s_mov_b32 s23, 0x20000
s_add_u32 m0, s35, 0
s_nop 0
buffer_load_dwordx4 v12, s[16:19], s34 offen offset:0 lds
buffer_load_dwordx4 v13, s[16:19], s34 offen offset:1024 lds
buffer_load_dwordx4 v14, s[16:19], s34 offen offset:2048 lds
buffer_load_dwordx4 v15, s[16:19], s34 offen offset:3072 lds
s_add_u32 m0, s35, 4096
s_nop 0
buffer_load_dwordx4 v16, s[16:19], s34 offen offset:0 lds
buffer_load_dwordx4 v17, s[16:19], s34 offen offset:1024 lds
buffer_load_dwordx4 v18, s[16:19], s34 offen offset:2048 lds
s_add_u32 s34, s34, 458752
s_add_u32 s24, s4, 0x80000
s_addc_u32 s25, s5, 0
s_mov_b32 s26, 0x20000
s_mov_b32 s27, 0x20000
s_cmp_lg_u32 s32, 0
s_cbranch_scc1 L_attn_kernel_gu_hpolled
s_lshl_b32 s42, s39, 7
s_add_u32 s42, s42, 69632
v_lshlrev_b32 v6, 2, v1
s_mov_b32 s43, 0x40000
s_mov_b64 s[44:45], exec
s_mov_b32 exec_lo, -1
s_mov_b32 exec_hi, 0
L_attn_kernel_gu_hpoll:
buffer_load_dword v7, v6, s[24:27], s42 offen sc1
s_waitcnt vmcnt(0)
v_cmp_ne_u32 vcc, 1, v7
s_sub_u32 s43, s43, 1
s_cmp_eq_u32 s43, 0
s_cbranch_scc1 L_attn_kernel_gu_hpdone
s_cbranch_vccnz L_attn_kernel_gu_hpoll
L_attn_kernel_gu_hpdone:
s_mov_b64 exec, s[44:45]
L_attn_kernel_gu_hpolled:
s_barrier
buffer_load_dwordx4 v[40:43], v8, s[12:15], s33 offen offset:0 sc1
buffer_load_dwordx4 v[44:47], v9, s[12:15], s33 offen offset:0 sc1
buffer_load_dwordx4 v[48:51], v10, s[12:15], s33 offen offset:0 sc1
buffer_load_dwordx4 v[52:55], v11, s[12:15], s33 offen offset:0 sc1
buffer_load_dwordx4 v[56:59], v8, s[12:15], s33 offen offset:1024 sc1
buffer_load_dwordx4 v[60:63], v9, s[12:15], s33 offen offset:1024 sc1
buffer_load_dwordx4 v[64:67], v10, s[12:15], s33 offen offset:1024 sc1
buffer_load_dwordx4 v[68:71], v11, s[12:15], s33 offen offset:1024 sc1
s_add_u32 s33, s33, 2048
s_add_u32 m0, s35, 28672
s_nop 0
buffer_load_dwordx4 v12, s[16:19], s34 offen offset:0 lds
buffer_load_dwordx4 v13, s[16:19], s34 offen offset:1024 lds
buffer_load_dwordx4 v14, s[16:19], s34 offen offset:2048 lds
buffer_load_dwordx4 v15, s[16:19], s34 offen offset:3072 lds
s_add_u32 m0, s35, 32768
s_nop 0
buffer_load_dwordx4 v16, s[16:19], s34 offen offset:0 lds
buffer_load_dwordx4 v17, s[16:19], s34 offen offset:1024 lds
buffer_load_dwordx4 v18, s[16:19], s34 offen offset:2048 lds
s_add_u32 s34, s34, 458752
s_waitcnt vmcnt(15)
s_barrier
ds_read_b64_tr_b16 v[168:169], v20 offset:0
ds_read_b64_tr_b16 v[170:171], v20 offset:3584
ds_read_b64_tr_b16 v[172:173], v20 offset:7168
ds_read_b64_tr_b16 v[174:175], v20 offset:10752
ds_read_b64_tr_b16 v[176:177], v20 offset:14336
ds_read_b64_tr_b16 v[178:179], v20 offset:17920
ds_read_b64_tr_b16 v[180:181], v20 offset:21504
ds_read_b64_tr_b16 v[182:183], v20 offset:25088
s_waitcnt vmcnt(7) lgkmcnt(4)
v_mfma_f32_16x16x32_bf16 a[0:3], v[168:171], v[40:43], 0
ds_read_b64_tr_b16 v[184:185], v20 offset:32
v_mfma_f32_16x16x32_bf16 a[0:3], v[172:175], v[56:59], a[0:3]
buffer_load_dwordx4 v[72:75], v8, s[12:15], s33 offen offset:0 sc1
v_mfma_f32_16x16x32_bf16 a[4:7], v[168:171], v[44:47], 0
ds_read_b64_tr_b16 v[186:187], v20 offset:3616
v_mfma_f32_16x16x32_bf16 a[4:7], v[172:175], v[60:63], a[4:7]
ds_read_b64_tr_b16 v[188:189], v20 offset:7200
v_mfma_f32_16x16x32_bf16 a[8:11], v[168:171], v[48:51], 0
buffer_load_dwordx4 v[76:79], v9, s[12:15], s33 offen offset:0 sc1
v_mfma_f32_16x16x32_bf16 a[8:11], v[172:175], v[64:67], a[8:11]
ds_read_b64_tr_b16 v[190:191], v20 offset:10784
v_mfma_f32_16x16x32_bf16 a[12:15], v[168:171], v[52:55], 0
v_mfma_f32_16x16x32_bf16 a[12:15], v[172:175], v[68:71], a[12:15]
s_waitcnt lgkmcnt(4)
v_mfma_f32_16x16x32_bf16 a[112:115], v[176:179], v[40:43], 0
buffer_load_dwordx4 v[80:83], v10, s[12:15], s33 offen offset:0 sc1
v_mfma_f32_16x16x32_bf16 a[112:115], v[180:183], v[56:59], a[112:115]
ds_read_b64_tr_b16 v[192:193], v20 offset:14368
v_mfma_f32_16x16x32_bf16 a[116:119], v[176:179], v[44:47], 0
ds_read_b64_tr_b16 v[194:195], v20 offset:17952
v_mfma_f32_16x16x32_bf16 a[116:119], v[180:183], v[60:63], a[116:119]
buffer_load_dwordx4 v[84:87], v11, s[12:15], s33 offen offset:0 sc1
v_mfma_f32_16x16x32_bf16 a[120:123], v[176:179], v[48:51], 0
ds_read_b64_tr_b16 v[196:197], v20 offset:21536
v_mfma_f32_16x16x32_bf16 a[120:123], v[180:183], v[64:67], a[120:123]
ds_read_b64_tr_b16 v[198:199], v20 offset:25120
v_mfma_f32_16x16x32_bf16 a[124:127], v[176:179], v[52:55], 0
buffer_load_dwordx4 v[88:91], v8, s[12:15], s33 offen offset:1024 sc1
v_mfma_f32_16x16x32_bf16 a[124:127], v[180:183], v[68:71], a[124:127]
s_waitcnt lgkmcnt(4)
v_mfma_f32_16x16x32_bf16 a[16:19], v[184:187], v[40:43], 0
ds_read_b64_tr_b16 v[168:169], v20 offset:64
v_mfma_f32_16x16x32_bf16 a[16:19], v[188:191], v[56:59], a[16:19]
buffer_load_dwordx4 v[92:95], v9, s[12:15], s33 offen offset:1024 sc1
v_mfma_f32_16x16x32_bf16 a[20:23], v[184:187], v[44:47], 0
ds_read_b64_tr_b16 v[170:171], v20 offset:3648
v_mfma_f32_16x16x32_bf16 a[20:23], v[188:191], v[60:63], a[20:23]
ds_read_b64_tr_b16 v[172:173], v20 offset:7232
v_mfma_f32_16x16x32_bf16 a[24:27], v[184:187], v[48:51], 0
buffer_load_dwordx4 v[96:99], v10, s[12:15], s33 offen offset:1024 sc1
v_mfma_f32_16x16x32_bf16 a[24:27], v[188:191], v[64:67], a[24:27]
ds_read_b64_tr_b16 v[174:175], v20 offset:10816
v_mfma_f32_16x16x32_bf16 a[28:31], v[184:187], v[52:55], 0
v_mfma_f32_16x16x32_bf16 a[28:31], v[188:191], v[68:71], a[28:31]
buffer_load_dwordx4 v[100:103], v11, s[12:15], s33 offen offset:1024 sc1
s_waitcnt lgkmcnt(4)
v_mfma_f32_16x16x32_bf16 a[128:131], v[192:195], v[40:43], 0
ds_read_b64_tr_b16 v[176:177], v20 offset:14400
s_add_u32 m0, s35, 57344
v_mfma_f32_16x16x32_bf16 a[128:131], v[196:199], v[56:59], a[128:131]
ds_read_b64_tr_b16 v[178:179], v20 offset:17984
s_add_u32 s33, s33, 2048
v_mfma_f32_16x16x32_bf16 a[132:135], v[192:195], v[44:47], 0
buffer_load_dwordx4 v12, s[16:19], s34 offen offset:0 lds
v_mfma_f32_16x16x32_bf16 a[132:135], v[196:199], v[60:63], a[132:135]
ds_read_b64_tr_b16 v[180:181], v20 offset:21568
v_mfma_f32_16x16x32_bf16 a[136:139], v[192:195], v[48:51], 0
ds_read_b64_tr_b16 v[182:183], v20 offset:25152
v_mfma_f32_16x16x32_bf16 a[136:139], v[196:199], v[64:67], a[136:139]
buffer_load_dwordx4 v13, s[16:19], s34 offen offset:1024 lds
v_mfma_f32_16x16x32_bf16 a[140:143], v[192:195], v[52:55], 0
v_mfma_f32_16x16x32_bf16 a[140:143], v[196:199], v[68:71], a[140:143]
s_waitcnt lgkmcnt(4)
v_mfma_f32_16x16x32_bf16 a[32:35], v[168:171], v[40:43], 0
buffer_load_dwordx4 v14, s[16:19], s34 offen offset:2048 lds
v_mfma_f32_16x16x32_bf16 a[32:35], v[172:175], v[56:59], a[32:35]
ds_read_b64_tr_b16 v[184:185], v20 offset:96
v_mfma_f32_16x16x32_bf16 a[36:39], v[168:171], v[44:47], 0
ds_read_b64_tr_b16 v[186:187], v20 offset:3680
v_mfma_f32_16x16x32_bf16 a[36:39], v[172:175], v[60:63], a[36:39]
buffer_load_dwordx4 v15, s[16:19], s34 offen offset:3072 lds
v_mfma_f32_16x16x32_bf16 a[40:43], v[168:171], v[48:51], 0
ds_read_b64_tr_b16 v[188:189], v20 offset:7264
s_add_u32 m0, s35, 61440
v_mfma_f32_16x16x32_bf16 a[40:43], v[172:175], v[64:67], a[40:43]
ds_read_b64_tr_b16 v[190:191], v20 offset:10848
v_mfma_f32_16x16x32_bf16 a[44:47], v[168:171], v[52:55], 0
buffer_load_dwordx4 v16, s[16:19], s34 offen offset:0 lds
v_mfma_f32_16x16x32_bf16 a[44:47], v[172:175], v[68:71], a[44:47]
s_waitcnt lgkmcnt(4)
v_mfma_f32_16x16x32_bf16 a[144:147], v[176:179], v[40:43], 0
ds_read_b64_tr_b16 v[192:193], v20 offset:14432
v_mfma_f32_16x16x32_bf16 a[144:147], v[180:183], v[56:59], a[144:147]
buffer_load_dwordx4 v17, s[16:19], s34 offen offset:1024 lds
v_mfma_f32_16x16x32_bf16 a[148:151], v[176:179], v[44:47], 0
ds_read_b64_tr_b16 v[194:195], v20 offset:18016
v_mfma_f32_16x16x32_bf16 a[148:151], v[180:183], v[60:63], a[148:151]
ds_read_b64_tr_b16 v[196:197], v20 offset:21600
v_mfma_f32_16x16x32_bf16 a[152:155], v[176:179], v[48:51], 0
buffer_load_dwordx4 v18, s[16:19], s34 offen offset:2048 lds
v_mfma_f32_16x16x32_bf16 a[152:155], v[180:183], v[64:67], a[152:155]
ds_read_b64_tr_b16 v[198:199], v20 offset:25184
s_add_u32 s34, s34, 458752
v_mfma_f32_16x16x32_bf16 a[156:159], v[176:179], v[52:55], 0
v_mfma_f32_16x16x32_bf16 a[156:159], v[180:183], v[68:71], a[156:159]
s_waitcnt lgkmcnt(4)
v_mfma_f32_16x16x32_bf16 a[48:51], v[184:187], v[40:43], 0
ds_read_b64_tr_b16 v[168:169], v20 offset:128
v_mfma_f32_16x16x32_bf16 a[48:51], v[188:191], v[56:59], a[48:51]
ds_read_b64_tr_b16 v[170:171], v20 offset:3712
v_mfma_f32_16x16x32_bf16 a[52:55], v[184:187], v[44:47], 0
buffer_load_dwordx4 v[104:107], v8, s[12:15], s33 offen offset:0 sc1
v_mfma_f32_16x16x32_bf16 a[52:55], v[188:191], v[60:63], a[52:55]
ds_read_b64_tr_b16 v[172:173], v20 offset:7296
v_mfma_f32_16x16x32_bf16 a[56:59], v[184:187], v[48:51], 0
ds_read_b64_tr_b16 v[174:175], v20 offset:10880
v_mfma_f32_16x16x32_bf16 a[56:59], v[188:191], v[64:67], a[56:59]
v_mfma_f32_16x16x32_bf16 a[60:63], v[184:187], v[52:55], 0
v_mfma_f32_16x16x32_bf16 a[60:63], v[188:191], v[68:71], a[60:63]
s_waitcnt lgkmcnt(4)
v_mfma_f32_16x16x32_bf16 a[160:163], v[192:195], v[40:43], 0
buffer_load_dwordx4 v[108:111], v9, s[12:15], s33 offen offset:0 sc1
v_mfma_f32_16x16x32_bf16 a[160:163], v[196:199], v[56:59], a[160:163]
ds_read_b64_tr_b16 v[176:177], v20 offset:14464
s_add_u32 m0, s35, 86016
v_mfma_f32_16x16x32_bf16 a[164:167], v[192:195], v[44:47], 0
ds_read_b64_tr_b16 v[178:179], v20 offset:18048
v_mfma_f32_16x16x32_bf16 a[164:167], v[196:199], v[60:63], a[164:167]
ds_read_b64_tr_b16 v[180:181], v20 offset:21632
v_mfma_f32_16x16x32_bf16 a[168:171], v[192:195], v[48:51], 0
ds_read_b64_tr_b16 v[182:183], v20 offset:25216
v_mfma_f32_16x16x32_bf16 a[168:171], v[196:199], v[64:67], a[168:171]
buffer_load_dwordx4 v[112:115], v10, s[12:15], s33 offen offset:0 sc1
v_mfma_f32_16x16x32_bf16 a[172:175], v[192:195], v[52:55], 0
v_mfma_f32_16x16x32_bf16 a[172:175], v[196:199], v[68:71], a[172:175]
s_waitcnt lgkmcnt(4)
v_mfma_f32_16x16x32_bf16 a[64:67], v[168:171], v[40:43], 0
buffer_load_dwordx4 v12, s[16:19], s34 offen offset:0 lds
v_mfma_f32_16x16x32_bf16 a[64:67], v[172:175], v[56:59], a[64:67]
ds_read_b64_tr_b16 v[184:185], v20 offset:160
v_mfma_f32_16x16x32_bf16 a[68:71], v[168:171], v[44:47], 0
ds_read_b64_tr_b16 v[186:187], v20 offset:3744
v_mfma_f32_16x16x32_bf16 a[68:71], v[172:175], v[60:63], a[68:71]
buffer_load_dwordx4 v[116:119], v11, s[12:15], s33 offen offset:0 sc1
v_mfma_f32_16x16x32_bf16 a[72:75], v[168:171], v[48:51], 0
ds_read_b64_tr_b16 v[188:189], v20 offset:7328
v_mfma_f32_16x16x32_bf16 a[72:75], v[172:175], v[64:67], a[72:75]
ds_read_b64_tr_b16 v[190:191], v20 offset:10912
v_mfma_f32_16x16x32_bf16 a[76:79], v[168:171], v[52:55], 0
buffer_load_dwordx4 v13, s[16:19], s34 offen offset:1024 lds
v_mfma_f32_16x16x32_bf16 a[76:79], v[172:175], v[68:71], a[76:79]
s_waitcnt lgkmcnt(4)
v_mfma_f32_16x16x32_bf16 a[176:179], v[176:179], v[40:43], 0
ds_read_b64_tr_b16 v[192:193], v20 offset:14496
v_mfma_f32_16x16x32_bf16 a[176:179], v[180:183], v[56:59], a[176:179]
buffer_load_dwordx4 v[120:123], v8, s[12:15], s33 offen offset:1024 sc1
v_mfma_f32_16x16x32_bf16 a[180:183], v[176:179], v[44:47], 0
ds_read_b64_tr_b16 v[194:195], v20 offset:18080
v_mfma_f32_16x16x32_bf16 a[180:183], v[180:183], v[60:63], a[180:183]
ds_read_b64_tr_b16 v[196:197], v20 offset:21664
v_mfma_f32_16x16x32_bf16 a[184:187], v[176:179], v[48:51], 0
buffer_load_dwordx4 v[124:127], v9, s[12:15], s33 offen offset:1024 sc1
v_mfma_f32_16x16x32_bf16 a[184:187], v[180:183], v[64:67], a[184:187]
ds_read_b64_tr_b16 v[198:199], v20 offset:25248
v_mfma_f32_16x16x32_bf16 a[188:191], v[176:179], v[52:55], 0
v_mfma_f32_16x16x32_bf16 a[188:191], v[180:183], v[68:71], a[188:191]
s_waitcnt lgkmcnt(4)
v_mfma_f32_16x16x32_bf16 a[80:83], v[184:187], v[40:43], 0
buffer_load_dwordx4 v14, s[16:19], s34 offen offset:2048 lds
v_mfma_f32_16x16x32_bf16 a[80:83], v[188:191], v[56:59], a[80:83]
ds_read_b64_tr_b16 v[168:169], v20 offset:192
v_mfma_f32_16x16x32_bf16 a[84:87], v[184:187], v[44:47], 0
ds_read_b64_tr_b16 v[170:171], v20 offset:3776
v_mfma_f32_16x16x32_bf16 a[84:87], v[188:191], v[60:63], a[84:87]
buffer_load_dwordx4 v[128:131], v10, s[12:15], s33 offen offset:1024 sc1
v_mfma_f32_16x16x32_bf16 a[88:91], v[184:187], v[48:51], 0
ds_read_b64_tr_b16 v[172:173], v20 offset:7360
v_mfma_f32_16x16x32_bf16 a[88:91], v[188:191], v[64:67], a[88:91]
ds_read_b64_tr_b16 v[174:175], v20 offset:10944
v_mfma_f32_16x16x32_bf16 a[92:95], v[184:187], v[52:55], 0
buffer_load_dwordx4 v15, s[16:19], s34 offen offset:3072 lds
v_mfma_f32_16x16x32_bf16 a[92:95], v[188:191], v[68:71], a[92:95]
s_add_u32 m0, s35, 90112
s_waitcnt lgkmcnt(4)
v_mfma_f32_16x16x32_bf16 a[192:195], v[192:195], v[40:43], 0
ds_read_b64_tr_b16 v[176:177], v20 offset:14528
v_mfma_f32_16x16x32_bf16 a[192:195], v[196:199], v[56:59], a[192:195]
buffer_load_dwordx4 v[132:135], v11, s[12:15], s33 offen offset:1024 sc1
v_mfma_f32_16x16x32_bf16 a[196:199], v[192:195], v[44:47], 0
ds_read_b64_tr_b16 v[178:179], v20 offset:18112
s_add_u32 s33, s33, 2048
v_mfma_f32_16x16x32_bf16 a[196:199], v[196:199], v[60:63], a[196:199]
ds_read_b64_tr_b16 v[180:181], v20 offset:21696
v_mfma_f32_16x16x32_bf16 a[200:203], v[192:195], v[48:51], 0
buffer_load_dwordx4 v16, s[16:19], s34 offen offset:0 lds
v_mfma_f32_16x16x32_bf16 a[200:203], v[196:199], v[64:67], a[200:203]
ds_read_b64_tr_b16 v[182:183], v20 offset:25280
v_mfma_f32_16x16x32_bf16 a[204:207], v[192:195], v[52:55], 0
v_mfma_f32_16x16x32_bf16 a[204:207], v[196:199], v[68:71], a[204:207]
s_waitcnt vmcnt(28) lgkmcnt(4)
s_barrier
v_mfma_f32_16x16x32_bf16 a[96:99], v[168:171], v[40:43], 0
buffer_load_dwordx4 v17, s[16:19], s34 offen offset:1024 lds
v_mfma_f32_16x16x32_bf16 a[96:99], v[172:175], v[56:59], a[96:99]
ds_read_b64_tr_b16 v[184:185], v20 offset:28672
v_mfma_f32_16x16x32_bf16 a[100:103], v[168:171], v[44:47], 0
ds_read_b64_tr_b16 v[186:187], v20 offset:32256
v_mfma_f32_16x16x32_bf16 a[100:103], v[172:175], v[60:63], a[100:103]
ds_read_b64_tr_b16 v[188:189], v20 offset:35840
v_mfma_f32_16x16x32_bf16 a[104:107], v[168:171], v[48:51], 0
ds_read_b64_tr_b16 v[190:191], v20 offset:39424
v_mfma_f32_16x16x32_bf16 a[104:107], v[172:175], v[64:67], a[104:107]
v_mfma_f32_16x16x32_bf16 a[108:111], v[168:171], v[52:55], 0
buffer_load_dwordx4 v18, s[16:19], s34 offen offset:2048 lds
v_mfma_f32_16x16x32_bf16 a[108:111], v[172:175], v[68:71], a[108:111]
s_add_u32 s34, s34, 458752
s_waitcnt lgkmcnt(4)
v_mfma_f32_16x16x32_bf16 a[208:211], v[176:179], v[40:43], 0
ds_read_b64_tr_b16 v[192:193], v20 offset:43008
v_mfma_f32_16x16x32_bf16 a[208:211], v[180:183], v[56:59], a[208:211]
ds_read_b64_tr_b16 v[194:195], v20 offset:46592
v_mfma_f32_16x16x32_bf16 a[212:215], v[176:179], v[44:47], 0
ds_read_b64_tr_b16 v[196:197], v20 offset:50176
v_mfma_f32_16x16x32_bf16 a[212:215], v[180:183], v[60:63], a[212:215]
ds_read_b64_tr_b16 v[198:199], v20 offset:53760
v_mfma_f32_16x16x32_bf16 a[216:219], v[176:179], v[48:51], 0
v_mfma_f32_16x16x32_bf16 a[216:219], v[180:183], v[64:67], a[216:219]
v_mfma_f32_16x16x32_bf16 a[220:223], v[176:179], v[52:55], 0
v_mfma_f32_16x16x32_bf16 a[220:223], v[180:183], v[68:71], a[220:223]
s_waitcnt vmcnt(22) lgkmcnt(4)
v_mfma_f32_16x16x32_bf16 a[0:3], v[184:187], v[72:75], a[0:3]
ds_read_b64_tr_b16 v[168:169], v20 offset:28704
v_mfma_f32_16x16x32_bf16 a[0:3], v[188:191], v[88:91], a[0:3]
ds_read_b64_tr_b16 v[170:171], v20 offset:32288
v_mfma_f32_16x16x32_bf16 a[4:7], v[184:187], v[76:79], a[4:7]
ds_read_b64_tr_b16 v[172:173], v20 offset:35872
v_mfma_f32_16x16x32_bf16 a[4:7], v[188:191], v[92:95], a[4:7]
ds_read_b64_tr_b16 v[174:175], v20 offset:39456
v_mfma_f32_16x16x32_bf16 a[8:11], v[184:187], v[80:83], a[8:11]
buffer_load_dwordx4 v[136:139], v8, s[12:15], s33 offen offset:0 sc1
v_mfma_f32_16x16x32_bf16 a[8:11], v[188:191], v[96:99], a[8:11]
v_mfma_f32_16x16x32_bf16 a[12:15], v[184:187], v[84:87], a[12:15]
v_mfma_f32_16x16x32_bf16 a[12:15], v[188:191], v[100:103], a[12:15]
s_waitcnt lgkmcnt(4)
v_mfma_f32_16x16x32_bf16 a[112:115], v[192:195], v[72:75], a[112:115]
ds_read_b64_tr_b16 v[176:177], v20 offset:43040
v_mfma_f32_16x16x32_bf16 a[112:115], v[196:199], v[88:91], a[112:115]
buffer_load_dwordx4 v[140:143], v9, s[12:15], s33 offen offset:0 sc1
v_mfma_f32_16x16x32_bf16 a[116:119], v[192:195], v[76:79], a[116:119]
ds_read_b64_tr_b16 v[178:179], v20 offset:46624
v_mfma_f32_16x16x32_bf16 a[116:119], v[196:199], v[92:95], a[116:119]
ds_read_b64_tr_b16 v[180:181], v20 offset:50208
v_mfma_f32_16x16x32_bf16 a[120:123], v[192:195], v[80:83], a[120:123]
ds_read_b64_tr_b16 v[182:183], v20 offset:53792
v_mfma_f32_16x16x32_bf16 a[120:123], v[196:199], v[96:99], a[120:123]
v_mfma_f32_16x16x32_bf16 a[124:127], v[192:195], v[84:87], a[124:127]
v_mfma_f32_16x16x32_bf16 a[124:127], v[196:199], v[100:103], a[124:127]
s_waitcnt lgkmcnt(4)
v_mfma_f32_16x16x32_bf16 a[16:19], v[168:171], v[72:75], a[16:19]
buffer_load_dwordx4 v[144:147], v10, s[12:15], s33 offen offset:0 sc1
v_mfma_f32_16x16x32_bf16 a[16:19], v[172:175], v[88:91], a[16:19]
ds_read_b64_tr_b16 v[184:185], v20 offset:28736
v_mfma_f32_16x16x32_bf16 a[20:23], v[168:171], v[76:79], a[20:23]
ds_read_b64_tr_b16 v[186:187], v20 offset:32320
v_mfma_f32_16x16x32_bf16 a[20:23], v[172:175], v[92:95], a[20:23]
ds_read_b64_tr_b16 v[188:189], v20 offset:35904
v_mfma_f32_16x16x32_bf16 a[24:27], v[168:171], v[80:83], a[24:27]
ds_read_b64_tr_b16 v[190:191], v20 offset:39488
v_mfma_f32_16x16x32_bf16 a[24:27], v[172:175], v[96:99], a[24:27]
v_mfma_f32_16x16x32_bf16 a[28:31], v[168:171], v[84:87], a[28:31]
v_mfma_f32_16x16x32_bf16 a[28:31], v[172:175], v[100:103], a[28:31]
s_waitcnt lgkmcnt(4)
v_mfma_f32_16x16x32_bf16 a[128:131], v[176:179], v[72:75], a[128:131]
buffer_load_dwordx4 v[148:151], v11, s[12:15], s33 offen offset:0 sc1
v_mfma_f32_16x16x32_bf16 a[128:131], v[180:183], v[88:91], a[128:131]
ds_read_b64_tr_b16 v[192:193], v20 offset:43072
v_mfma_f32_16x16x32_bf16 a[132:135], v[176:179], v[76:79], a[132:135]
ds_read_b64_tr_b16 v[194:195], v20 offset:46656
v_mfma_f32_16x16x32_bf16 a[132:135], v[180:183], v[92:95], a[132:135]
ds_read_b64_tr_b16 v[196:197], v20 offset:50240
v_mfma_f32_16x16x32_bf16 a[136:139], v[176:179], v[80:83], a[136:139]
ds_read_b64_tr_b16 v[198:199], v20 offset:53824
v_mfma_f32_16x16x32_bf16 a[136:139], v[180:183], v[96:99], a[136:139]
v_mfma_f32_16x16x32_bf16 a[140:143], v[176:179], v[84:87], a[140:143]
buffer_load_dwordx4 v[152:155], v8, s[12:15], s33 offen offset:1024 sc1
v_mfma_f32_16x16x32_bf16 a[140:143], v[180:183], v[100:103], a[140:143]
s_waitcnt lgkmcnt(4)
v_mfma_f32_16x16x32_bf16 a[32:35], v[184:187], v[72:75], a[32:35]
ds_read_b64_tr_b16 v[168:169], v20 offset:28768
v_mfma_f32_16x16x32_bf16 a[32:35], v[188:191], v[88:91], a[32:35]
ds_read_b64_tr_b16 v[170:171], v20 offset:32352
v_mfma_f32_16x16x32_bf16 a[36:39], v[184:187], v[76:79], a[36:39]
ds_read_b64_tr_b16 v[172:173], v20 offset:35936
v_mfma_f32_16x16x32_bf16 a[36:39], v[188:191], v[92:95], a[36:39]
ds_read_b64_tr_b16 v[174:175], v20 offset:39520
v_mfma_f32_16x16x32_bf16 a[40:43], v[184:187], v[80:83], a[40:43]
v_mfma_f32_16x16x32_bf16 a[40:43], v[188:191], v[96:99], a[40:43]
buffer_load_dwordx4 v[156:159], v9, s[12:15], s33 offen offset:1024 sc1
v_mfma_f32_16x16x32_bf16 a[44:47], v[184:187], v[84:87], a[44:47]
v_mfma_f32_16x16x32_bf16 a[44:47], v[188:191], v[100:103], a[44:47]
s_waitcnt lgkmcnt(4)
v_mfma_f32_16x16x32_bf16 a[144:147], v[192:195], v[72:75], a[144:147]
ds_read_b64_tr_b16 v[176:177], v20 offset:43104
v_mfma_f32_16x16x32_bf16 a[144:147], v[196:199], v[88:91], a[144:147]
ds_read_b64_tr_b16 v[178:179], v20 offset:46688
v_mfma_f32_16x16x32_bf16 a[148:151], v[192:195], v[76:79], a[148:151]
ds_read_b64_tr_b16 v[180:181], v20 offset:50272
v_mfma_f32_16x16x32_bf16 a[148:151], v[196:199], v[92:95], a[148:151]
ds_read_b64_tr_b16 v[182:183], v20 offset:53856
v_mfma_f32_16x16x32_bf16 a[152:155], v[192:195], v[80:83], a[152:155]
buffer_load_dwordx4 v[160:163], v10, s[12:15], s33 offen offset:1024 sc1
v_mfma_f32_16x16x32_bf16 a[152:155], v[196:199], v[96:99], a[152:155]
v_mfma_f32_16x16x32_bf16 a[156:159], v[192:195], v[84:87], a[156:159]
v_mfma_f32_16x16x32_bf16 a[156:159], v[196:199], v[100:103], a[156:159]
s_waitcnt lgkmcnt(4)
v_mfma_f32_16x16x32_bf16 a[48:51], v[168:171], v[72:75], a[48:51]
ds_read_b64_tr_b16 v[184:185], v20 offset:28800
v_mfma_f32_16x16x32_bf16 a[48:51], v[172:175], v[88:91], a[48:51]
ds_read_b64_tr_b16 v[186:187], v20 offset:32384
v_mfma_f32_16x16x32_bf16 a[52:55], v[168:171], v[76:79], a[52:55]
ds_read_b64_tr_b16 v[188:189], v20 offset:35968
v_mfma_f32_16x16x32_bf16 a[52:55], v[172:175], v[92:95], a[52:55]
ds_read_b64_tr_b16 v[190:191], v20 offset:39552
v_mfma_f32_16x16x32_bf16 a[56:59], v[168:171], v[80:83], a[56:59]
buffer_load_dwordx4 v[164:167], v11, s[12:15], s33 offen offset:1024 sc1
v_mfma_f32_16x16x32_bf16 a[56:59], v[172:175], v[96:99], a[56:59]
s_add_u32 s33, s33, 2048
v_mfma_f32_16x16x32_bf16 a[60:63], v[168:171], v[84:87], a[60:63]
v_mfma_f32_16x16x32_bf16 a[60:63], v[172:175], v[100:103], a[60:63]
s_waitcnt lgkmcnt(4)
v_mfma_f32_16x16x32_bf16 a[160:163], v[176:179], v[72:75], a[160:163]
ds_read_b64_tr_b16 v[192:193], v20 offset:43136
v_mfma_f32_16x16x32_bf16 a[160:163], v[180:183], v[88:91], a[160:163]
ds_read_b64_tr_b16 v[194:195], v20 offset:46720
s_add_u32 m0, s35, 0
v_mfma_f32_16x16x32_bf16 a[164:167], v[176:179], v[76:79], a[164:167]
ds_read_b64_tr_b16 v[196:197], v20 offset:50304
v_mfma_f32_16x16x32_bf16 a[164:167], v[180:183], v[92:95], a[164:167]
ds_read_b64_tr_b16 v[198:199], v20 offset:53888
v_mfma_f32_16x16x32_bf16 a[168:171], v[176:179], v[80:83], a[168:171]
buffer_load_dwordx4 v12, s[16:19], s34 offen offset:0 lds
v_mfma_f32_16x16x32_bf16 a[168:171], v[180:183], v[96:99], a[168:171]
v_mfma_f32_16x16x32_bf16 a[172:175], v[176:179], v[84:87], a[172:175]
v_mfma_f32_16x16x32_bf16 a[172:175], v[180:183], v[100:103], a[172:175]
s_waitcnt lgkmcnt(4)
v_mfma_f32_16x16x32_bf16 a[64:67], v[184:187], v[72:75], a[64:67]
ds_read_b64_tr_b16 v[168:169], v20 offset:28832
v_mfma_f32_16x16x32_bf16 a[64:67], v[188:191], v[88:91], a[64:67]
ds_read_b64_tr_b16 v[170:171], v20 offset:32416
v_mfma_f32_16x16x32_bf16 a[68:71], v[184:187], v[76:79], a[68:71]
ds_read_b64_tr_b16 v[172:173], v20 offset:36000
v_mfma_f32_16x16x32_bf16 a[68:71], v[188:191], v[92:95], a[68:71]
ds_read_b64_tr_b16 v[174:175], v20 offset:39584
v_mfma_f32_16x16x32_bf16 a[72:75], v[184:187], v[80:83], a[72:75]
buffer_load_dwordx4 v13, s[16:19], s34 offen offset:1024 lds
v_mfma_f32_16x16x32_bf16 a[72:75], v[188:191], v[96:99], a[72:75]
v_mfma_f32_16x16x32_bf16 a[76:79], v[184:187], v[84:87], a[76:79]
v_mfma_f32_16x16x32_bf16 a[76:79], v[188:191], v[100:103], a[76:79]
s_waitcnt lgkmcnt(4)
v_mfma_f32_16x16x32_bf16 a[176:179], v[192:195], v[72:75], a[176:179]
ds_read_b64_tr_b16 v[176:177], v20 offset:43168
v_mfma_f32_16x16x32_bf16 a[176:179], v[196:199], v[88:91], a[176:179]
ds_read_b64_tr_b16 v[178:179], v20 offset:46752
v_mfma_f32_16x16x32_bf16 a[180:183], v[192:195], v[76:79], a[180:183]
ds_read_b64_tr_b16 v[180:181], v20 offset:50336
v_mfma_f32_16x16x32_bf16 a[180:183], v[196:199], v[92:95], a[180:183]
ds_read_b64_tr_b16 v[182:183], v20 offset:53920
v_mfma_f32_16x16x32_bf16 a[184:187], v[192:195], v[80:83], a[184:187]
buffer_load_dwordx4 v14, s[16:19], s34 offen offset:2048 lds
v_mfma_f32_16x16x32_bf16 a[184:187], v[196:199], v[96:99], a[184:187]
v_mfma_f32_16x16x32_bf16 a[188:191], v[192:195], v[84:87], a[188:191]
v_mfma_f32_16x16x32_bf16 a[188:191], v[196:199], v[100:103], a[188:191]
s_waitcnt lgkmcnt(4)
v_mfma_f32_16x16x32_bf16 a[80:83], v[168:171], v[72:75], a[80:83]
ds_read_b64_tr_b16 v[184:185], v20 offset:28864
v_mfma_f32_16x16x32_bf16 a[80:83], v[172:175], v[88:91], a[80:83]
buffer_load_dwordx4 v15, s[16:19], s34 offen offset:3072 lds
v_mfma_f32_16x16x32_bf16 a[84:87], v[168:171], v[76:79], a[84:87]
ds_read_b64_tr_b16 v[186:187], v20 offset:32448
v_mfma_f32_16x16x32_bf16 a[84:87], v[172:175], v[92:95], a[84:87]
ds_read_b64_tr_b16 v[188:189], v20 offset:36032
v_mfma_f32_16x16x32_bf16 a[88:91], v[168:171], v[80:83], a[88:91]
ds_read_b64_tr_b16 v[190:191], v20 offset:39616
v_mfma_f32_16x16x32_bf16 a[88:91], v[172:175], v[96:99], a[88:91]
s_add_u32 m0, s35, 4096
v_mfma_f32_16x16x32_bf16 a[92:95], v[168:171], v[84:87], a[92:95]
v_mfma_f32_16x16x32_bf16 a[92:95], v[172:175], v[100:103], a[92:95]
s_waitcnt lgkmcnt(4)
v_mfma_f32_16x16x32_bf16 a[192:195], v[176:179], v[72:75], a[192:195]
buffer_load_dwordx4 v16, s[16:19], s34 offen offset:0 lds
v_mfma_f32_16x16x32_bf16 a[192:195], v[180:183], v[88:91], a[192:195]
ds_read_b64_tr_b16 v[192:193], v20 offset:43200
v_mfma_f32_16x16x32_bf16 a[196:199], v[176:179], v[76:79], a[196:199]
ds_read_b64_tr_b16 v[194:195], v20 offset:46784
v_mfma_f32_16x16x32_bf16 a[196:199], v[180:183], v[92:95], a[196:199]
ds_read_b64_tr_b16 v[196:197], v20 offset:50368
v_mfma_f32_16x16x32_bf16 a[200:203], v[176:179], v[80:83], a[200:203]
ds_read_b64_tr_b16 v[198:199], v20 offset:53952
v_mfma_f32_16x16x32_bf16 a[200:203], v[180:183], v[96:99], a[200:203]
v_mfma_f32_16x16x32_bf16 a[204:207], v[176:179], v[84:87], a[204:207]
v_mfma_f32_16x16x32_bf16 a[204:207], v[180:183], v[100:103], a[204:207]
s_waitcnt vmcnt(28) lgkmcnt(4)
s_barrier
v_mfma_f32_16x16x32_bf16 a[96:99], v[184:187], v[72:75], a[96:99]
buffer_load_dwordx4 v17, s[16:19], s34 offen offset:1024 lds
v_mfma_f32_16x16x32_bf16 a[96:99], v[188:191], v[88:91], a[96:99]
ds_read_b64_tr_b16 v[168:169], v21 offset:0
v_mfma_f32_16x16x32_bf16 a[100:103], v[184:187], v[76:79], a[100:103]
ds_read_b64_tr_b16 v[170:171], v21 offset:3584
v_mfma_f32_16x16x32_bf16 a[100:103], v[188:191], v[92:95], a[100:103]
ds_read_b64_tr_b16 v[172:173], v21 offset:7168
v_mfma_f32_16x16x32_bf16 a[104:107], v[184:187], v[80:83], a[104:107]
ds_read_b64_tr_b16 v[174:175], v21 offset:10752
v_mfma_f32_16x16x32_bf16 a[104:107], v[188:191], v[96:99], a[104:107]
v_mfma_f32_16x16x32_bf16 a[108:111], v[184:187], v[84:87], a[108:111]
buffer_load_dwordx4 v18, s[16:19], s34 offen offset:2048 lds
v_mfma_f32_16x16x32_bf16 a[108:111], v[188:191], v[100:103], a[108:111]
s_add_u32 s34, s34, 458752
s_waitcnt lgkmcnt(4)
v_mfma_f32_16x16x32_bf16 a[208:211], v[192:195], v[72:75], a[208:211]
ds_read_b64_tr_b16 v[176:177], v21 offset:14336
v_mfma_f32_16x16x32_bf16 a[208:211], v[196:199], v[88:91], a[208:211]
ds_read_b64_tr_b16 v[178:179], v21 offset:17920
v_mfma_f32_16x16x32_bf16 a[212:215], v[192:195], v[76:79], a[212:215]
ds_read_b64_tr_b16 v[180:181], v21 offset:21504
v_mfma_f32_16x16x32_bf16 a[212:215], v[196:199], v[92:95], a[212:215]
ds_read_b64_tr_b16 v[182:183], v21 offset:25088
v_mfma_f32_16x16x32_bf16 a[216:219], v[192:195], v[80:83], a[216:219]
v_mfma_f32_16x16x32_bf16 a[216:219], v[196:199], v[96:99], a[216:219]
v_mfma_f32_16x16x32_bf16 a[220:223], v[192:195], v[84:87], a[220:223]
v_mfma_f32_16x16x32_bf16 a[220:223], v[196:199], v[100:103], a[220:223]
s_waitcnt vmcnt(18) lgkmcnt(4)
v_mfma_f32_16x16x32_bf16 a[0:3], v[168:171], v[104:107], a[0:3]
ds_read_b64_tr_b16 v[184:185], v21 offset:32
v_mfma_f32_16x16x32_bf16 a[0:3], v[172:175], v[120:123], a[0:3]
ds_read_b64_tr_b16 v[186:187], v21 offset:3616
v_mfma_f32_16x16x32_bf16 a[4:7], v[168:171], v[108:111], a[4:7]
ds_read_b64_tr_b16 v[188:189], v21 offset:7200
v_mfma_f32_16x16x32_bf16 a[4:7], v[172:175], v[124:127], a[4:7]
ds_read_b64_tr_b16 v[190:191], v21 offset:10784
v_mfma_f32_16x16x32_bf16 a[8:11], v[168:171], v[112:115], a[8:11]
buffer_load_dwordx4 v[40:43], v8, s[12:15], s33 offen offset:0 sc1
v_mfma_f32_16x16x32_bf16 a[8:11], v[172:175], v[128:131], a[8:11]
v_mfma_f32_16x16x32_bf16 a[12:15], v[168:171], v[116:119], a[12:15]
v_mfma_f32_16x16x32_bf16 a[12:15], v[172:175], v[132:135], a[12:15]
s_waitcnt lgkmcnt(4)
v_mfma_f32_16x16x32_bf16 a[112:115], v[176:179], v[104:107], a[112:115]
ds_read_b64_tr_b16 v[192:193], v21 offset:14368
v_mfma_f32_16x16x32_bf16 a[112:115], v[180:183], v[120:123], a[112:115]
buffer_load_dwordx4 v[44:47], v9, s[12:15], s33 offen offset:0 sc1
v_mfma_f32_16x16x32_bf16 a[116:119], v[176:179], v[108:111], a[116:119]
ds_read_b64_tr_b16 v[194:195], v21 offset:17952
v_mfma_f32_16x16x32_bf16 a[116:119], v[180:183], v[124:127], a[116:119]
ds_read_b64_tr_b16 v[196:197], v21 offset:21536
v_mfma_f32_16x16x32_bf16 a[120:123], v[176:179], v[112:115], a[120:123]
ds_read_b64_tr_b16 v[198:199], v21 offset:25120
v_mfma_f32_16x16x32_bf16 a[120:123], v[180:183], v[128:131], a[120:123]
v_mfma_f32_16x16x32_bf16 a[124:127], v[176:179], v[116:119], a[124:127]
v_mfma_f32_16x16x32_bf16 a[124:127], v[180:183], v[132:135], a[124:127]
s_waitcnt lgkmcnt(4)
v_mfma_f32_16x16x32_bf16 a[16:19], v[184:187], v[104:107], a[16:19]
buffer_load_dwordx4 v[48:51], v10, s[12:15], s33 offen offset:0 sc1
v_mfma_f32_16x16x32_bf16 a[16:19], v[188:191], v[120:123], a[16:19]
ds_read_b64_tr_b16 v[168:169], v21 offset:64
v_mfma_f32_16x16x32_bf16 a[20:23], v[184:187], v[108:111], a[20:23]
ds_read_b64_tr_b16 v[170:171], v21 offset:3648
v_mfma_f32_16x16x32_bf16 a[20:23], v[188:191], v[124:127], a[20:23]
ds_read_b64_tr_b16 v[172:173], v21 offset:7232
v_mfma_f32_16x16x32_bf16 a[24:27], v[184:187], v[112:115], a[24:27]
ds_read_b64_tr_b16 v[174:175], v21 offset:10816
v_mfma_f32_16x16x32_bf16 a[24:27], v[188:191], v[128:131], a[24:27]
v_mfma_f32_16x16x32_bf16 a[28:31], v[184:187], v[116:119], a[28:31]
v_mfma_f32_16x16x32_bf16 a[28:31], v[188:191], v[132:135], a[28:31]
s_waitcnt lgkmcnt(4)
v_mfma_f32_16x16x32_bf16 a[128:131], v[192:195], v[104:107], a[128:131]
buffer_load_dwordx4 v[52:55], v11, s[12:15], s33 offen offset:0 sc1
v_mfma_f32_16x16x32_bf16 a[128:131], v[196:199], v[120:123], a[128:131]
ds_read_b64_tr_b16 v[176:177], v21 offset:14400
v_mfma_f32_16x16x32_bf16 a[132:135], v[192:195], v[108:111], a[132:135]
ds_read_b64_tr_b16 v[178:179], v21 offset:17984
v_mfma_f32_16x16x32_bf16 a[132:135], v[196:199], v[124:127], a[132:135]
ds_read_b64_tr_b16 v[180:181], v21 offset:21568
v_mfma_f32_16x16x32_bf16 a[136:139], v[192:195], v[112:115], a[136:139]
ds_read_b64_tr_b16 v[182:183], v21 offset:25152
v_mfma_f32_16x16x32_bf16 a[136:139], v[196:199], v[128:131], a[136:139]
v_mfma_f32_16x16x32_bf16 a[140:143], v[192:195], v[116:119], a[140:143]
buffer_load_dwordx4 v[56:59], v8, s[12:15], s33 offen offset:1024 sc1
v_mfma_f32_16x16x32_bf16 a[140:143], v[196:199], v[132:135], a[140:143]
s_waitcnt lgkmcnt(4)
v_mfma_f32_16x16x32_bf16 a[32:35], v[168:171], v[104:107], a[32:35]
ds_read_b64_tr_b16 v[184:185], v21 offset:96
v_mfma_f32_16x16x32_bf16 a[32:35], v[172:175], v[120:123], a[32:35]
ds_read_b64_tr_b16 v[186:187], v21 offset:3680
v_mfma_f32_16x16x32_bf16 a[36:39], v[168:171], v[108:111], a[36:39]
ds_read_b64_tr_b16 v[188:189], v21 offset:7264
v_mfma_f32_16x16x32_bf16 a[36:39], v[172:175], v[124:127], a[36:39]
ds_read_b64_tr_b16 v[190:191], v21 offset:10848
v_mfma_f32_16x16x32_bf16 a[40:43], v[168:171], v[112:115], a[40:43]
v_mfma_f32_16x16x32_bf16 a[40:43], v[172:175], v[128:131], a[40:43]
buffer_load_dwordx4 v[60:63], v9, s[12:15], s33 offen offset:1024 sc1
v_mfma_f32_16x16x32_bf16 a[44:47], v[168:171], v[116:119], a[44:47]
v_mfma_f32_16x16x32_bf16 a[44:47], v[172:175], v[132:135], a[44:47]
s_waitcnt lgkmcnt(4)
v_mfma_f32_16x16x32_bf16 a[144:147], v[176:179], v[104:107], a[144:147]
ds_read_b64_tr_b16 v[192:193], v21 offset:14432
v_mfma_f32_16x16x32_bf16 a[144:147], v[180:183], v[120:123], a[144:147]
ds_read_b64_tr_b16 v[194:195], v21 offset:18016
v_mfma_f32_16x16x32_bf16 a[148:151], v[176:179], v[108:111], a[148:151]
ds_read_b64_tr_b16 v[196:197], v21 offset:21600
v_mfma_f32_16x16x32_bf16 a[148:151], v[180:183], v[124:127], a[148:151]
ds_read_b64_tr_b16 v[198:199], v21 offset:25184
v_mfma_f32_16x16x32_bf16 a[152:155], v[176:179], v[112:115], a[152:155]
buffer_load_dwordx4 v[64:67], v10, s[12:15], s33 offen offset:1024 sc1
v_mfma_f32_16x16x32_bf16 a[152:155], v[180:183], v[128:131], a[152:155]
v_mfma_f32_16x16x32_bf16 a[156:159], v[176:179], v[116:119], a[156:159]
v_mfma_f32_16x16x32_bf16 a[156:159], v[180:183], v[132:135], a[156:159]
s_waitcnt lgkmcnt(4)
v_mfma_f32_16x16x32_bf16 a[48:51], v[184:187], v[104:107], a[48:51]
ds_read_b64_tr_b16 v[168:169], v21 offset:128
v_mfma_f32_16x16x32_bf16 a[48:51], v[188:191], v[120:123], a[48:51]
ds_read_b64_tr_b16 v[170:171], v21 offset:3712
v_mfma_f32_16x16x32_bf16 a[52:55], v[184:187], v[108:111], a[52:55]
ds_read_b64_tr_b16 v[172:173], v21 offset:7296
v_mfma_f32_16x16x32_bf16 a[52:55], v[188:191], v[124:127], a[52:55]
ds_read_b64_tr_b16 v[174:175], v21 offset:10880
v_mfma_f32_16x16x32_bf16 a[56:59], v[184:187], v[112:115], a[56:59]
buffer_load_dwordx4 v[68:71], v11, s[12:15], s33 offen offset:1024 sc1
v_mfma_f32_16x16x32_bf16 a[56:59], v[188:191], v[128:131], a[56:59]
s_add_u32 s33, s33, 2048
v_mfma_f32_16x16x32_bf16 a[60:63], v[184:187], v[116:119], a[60:63]
v_mfma_f32_16x16x32_bf16 a[60:63], v[188:191], v[132:135], a[60:63]
s_waitcnt lgkmcnt(4)
v_mfma_f32_16x16x32_bf16 a[160:163], v[192:195], v[104:107], a[160:163]
ds_read_b64_tr_b16 v[176:177], v21 offset:14464
v_mfma_f32_16x16x32_bf16 a[160:163], v[196:199], v[120:123], a[160:163]
ds_read_b64_tr_b16 v[178:179], v21 offset:18048
s_add_u32 m0, s35, 28672
v_mfma_f32_16x16x32_bf16 a[164:167], v[192:195], v[108:111], a[164:167]
ds_read_b64_tr_b16 v[180:181], v21 offset:21632
v_mfma_f32_16x16x32_bf16 a[164:167], v[196:199], v[124:127], a[164:167]
ds_read_b64_tr_b16 v[182:183], v21 offset:25216
v_mfma_f32_16x16x32_bf16 a[168:171], v[192:195], v[112:115], a[168:171]
buffer_load_dwordx4 v12, s[16:19], s34 offen offset:0 lds
v_mfma_f32_16x16x32_bf16 a[168:171], v[196:199], v[128:131], a[168:171]
v_mfma_f32_16x16x32_bf16 a[172:175], v[192:195], v[116:119], a[172:175]
v_mfma_f32_16x16x32_bf16 a[172:175], v[196:199], v[132:135], a[172:175]
s_waitcnt lgkmcnt(4)
v_mfma_f32_16x16x32_bf16 a[64:67], v[168:171], v[104:107], a[64:67]
ds_read_b64_tr_b16 v[184:185], v21 offset:160
v_mfma_f32_16x16x32_bf16 a[64:67], v[172:175], v[120:123], a[64:67]
ds_read_b64_tr_b16 v[186:187], v21 offset:3744
v_mfma_f32_16x16x32_bf16 a[68:71], v[168:171], v[108:111], a[68:71]
ds_read_b64_tr_b16 v[188:189], v21 offset:7328
v_mfma_f32_16x16x32_bf16 a[68:71], v[172:175], v[124:127], a[68:71]
ds_read_b64_tr_b16 v[190:191], v21 offset:10912
v_mfma_f32_16x16x32_bf16 a[72:75], v[168:171], v[112:115], a[72:75]
buffer_load_dwordx4 v13, s[16:19], s34 offen offset:1024 lds
v_mfma_f32_16x16x32_bf16 a[72:75], v[172:175], v[128:131], a[72:75]
v_mfma_f32_16x16x32_bf16 a[76:79], v[168:171], v[116:119], a[76:79]
v_mfma_f32_16x16x32_bf16 a[76:79], v[172:175], v[132:135], a[76:79]
s_waitcnt lgkmcnt(4)
v_mfma_f32_16x16x32_bf16 a[176:179], v[176:179], v[104:107], a[176:179]
ds_read_b64_tr_b16 v[192:193], v21 offset:14496
v_mfma_f32_16x16x32_bf16 a[176:179], v[180:183], v[120:123], a[176:179]
ds_read_b64_tr_b16 v[194:195], v21 offset:18080
v_mfma_f32_16x16x32_bf16 a[180:183], v[176:179], v[108:111], a[180:183]
ds_read_b64_tr_b16 v[196:197], v21 offset:21664
v_mfma_f32_16x16x32_bf16 a[180:183], v[180:183], v[124:127], a[180:183]
ds_read_b64_tr_b16 v[198:199], v21 offset:25248
v_mfma_f32_16x16x32_bf16 a[184:187], v[176:179], v[112:115], a[184:187]
buffer_load_dwordx4 v14, s[16:19], s34 offen offset:2048 lds
v_mfma_f32_16x16x32_bf16 a[184:187], v[180:183], v[128:131], a[184:187]
v_mfma_f32_16x16x32_bf16 a[188:191], v[176:179], v[116:119], a[188:191]
v_mfma_f32_16x16x32_bf16 a[188:191], v[180:183], v[132:135], a[188:191]
s_waitcnt lgkmcnt(4)
v_mfma_f32_16x16x32_bf16 a[80:83], v[184:187], v[104:107], a[80:83]
ds_read_b64_tr_b16 v[168:169], v21 offset:192
v_mfma_f32_16x16x32_bf16 a[80:83], v[188:191], v[120:123], a[80:83]
buffer_load_dwordx4 v15, s[16:19], s34 offen offset:3072 lds
v_mfma_f32_16x16x32_bf16 a[84:87], v[184:187], v[108:111], a[84:87]
ds_read_b64_tr_b16 v[170:171], v21 offset:3776
v_mfma_f32_16x16x32_bf16 a[84:87], v[188:191], v[124:127], a[84:87]
ds_read_b64_tr_b16 v[172:173], v21 offset:7360
v_mfma_f32_16x16x32_bf16 a[88:91], v[184:187], v[112:115], a[88:91]
ds_read_b64_tr_b16 v[174:175], v21 offset:10944
v_mfma_f32_16x16x32_bf16 a[88:91], v[188:191], v[128:131], a[88:91]
s_add_u32 m0, s35, 32768
v_mfma_f32_16x16x32_bf16 a[92:95], v[184:187], v[116:119], a[92:95]
v_mfma_f32_16x16x32_bf16 a[92:95], v[188:191], v[132:135], a[92:95]
s_waitcnt lgkmcnt(4)
v_mfma_f32_16x16x32_bf16 a[192:195], v[192:195], v[104:107], a[192:195]
buffer_load_dwordx4 v16, s[16:19], s34 offen offset:0 lds
v_mfma_f32_16x16x32_bf16 a[192:195], v[196:199], v[120:123], a[192:195]
ds_read_b64_tr_b16 v[176:177], v21 offset:14528
v_mfma_f32_16x16x32_bf16 a[196:199], v[192:195], v[108:111], a[196:199]
ds_read_b64_tr_b16 v[178:179], v21 offset:18112
v_mfma_f32_16x16x32_bf16 a[196:199], v[196:199], v[124:127], a[196:199]
ds_read_b64_tr_b16 v[180:181], v21 offset:21696
v_mfma_f32_16x16x32_bf16 a[200:203], v[192:195], v[112:115], a[200:203]
ds_read_b64_tr_b16 v[182:183], v21 offset:25280
v_mfma_f32_16x16x32_bf16 a[200:203], v[196:199], v[128:131], a[200:203]
v_mfma_f32_16x16x32_bf16 a[204:207], v[192:195], v[116:119], a[204:207]
v_mfma_f32_16x16x32_bf16 a[204:207], v[196:199], v[132:135], a[204:207]
s_waitcnt vmcnt(28) lgkmcnt(4)
s_barrier
v_mfma_f32_16x16x32_bf16 a[96:99], v[168:171], v[104:107], a[96:99]
buffer_load_dwordx4 v17, s[16:19], s34 offen offset:1024 lds
v_mfma_f32_16x16x32_bf16 a[96:99], v[172:175], v[120:123], a[96:99]
ds_read_b64_tr_b16 v[184:185], v21 offset:28672
v_mfma_f32_16x16x32_bf16 a[100:103], v[168:171], v[108:111], a[100:103]
ds_read_b64_tr_b16 v[186:187], v21 offset:32256
v_mfma_f32_16x16x32_bf16 a[100:103], v[172:175], v[124:127], a[100:103]
ds_read_b64_tr_b16 v[188:189], v21 offset:35840
v_mfma_f32_16x16x32_bf16 a[104:107], v[168:171], v[112:115], a[104:107]
ds_read_b64_tr_b16 v[190:191], v21 offset:39424
v_mfma_f32_16x16x32_bf16 a[104:107], v[172:175], v[128:131], a[104:107]
v_mfma_f32_16x16x32_bf16 a[108:111], v[168:171], v[116:119], a[108:111]
buffer_load_dwordx4 v18, s[16:19], s34 offen offset:2048 lds
v_mfma_f32_16x16x32_bf16 a[108:111], v[172:175], v[132:135], a[108:111]
s_add_u32 s34, s34, 458752
s_waitcnt lgkmcnt(4)
v_mfma_f32_16x16x32_bf16 a[208:211], v[176:179], v[104:107], a[208:211]
ds_read_b64_tr_b16 v[192:193], v21 offset:43008
v_mfma_f32_16x16x32_bf16 a[208:211], v[180:183], v[120:123], a[208:211]
ds_read_b64_tr_b16 v[194:195], v21 offset:46592
v_mfma_f32_16x16x32_bf16 a[212:215], v[176:179], v[108:111], a[212:215]
ds_read_b64_tr_b16 v[196:197], v21 offset:50176
v_mfma_f32_16x16x32_bf16 a[212:215], v[180:183], v[124:127], a[212:215]
ds_read_b64_tr_b16 v[198:199], v21 offset:53760
v_mfma_f32_16x16x32_bf16 a[216:219], v[176:179], v[112:115], a[216:219]
v_mfma_f32_16x16x32_bf16 a[216:219], v[180:183], v[128:131], a[216:219]
v_mfma_f32_16x16x32_bf16 a[220:223], v[176:179], v[116:119], a[220:223]
v_mfma_f32_16x16x32_bf16 a[220:223], v[180:183], v[132:135], a[220:223]
s_waitcnt vmcnt(22) lgkmcnt(4)
v_mfma_f32_16x16x32_bf16 a[0:3], v[184:187], v[136:139], a[0:3]
ds_read_b64_tr_b16 v[168:169], v21 offset:28704
v_mfma_f32_16x16x32_bf16 a[0:3], v[188:191], v[152:155], a[0:3]
ds_read_b64_tr_b16 v[170:171], v21 offset:32288
v_mfma_f32_16x16x32_bf16 a[4:7], v[184:187], v[140:143], a[4:7]
ds_read_b64_tr_b16 v[172:173], v21 offset:35872
v_mfma_f32_16x16x32_bf16 a[4:7], v[188:191], v[156:159], a[4:7]
ds_read_b64_tr_b16 v[174:175], v21 offset:39456
v_mfma_f32_16x16x32_bf16 a[8:11], v[184:187], v[144:147], a[8:11]
buffer_load_dwordx4 v[72:75], v8, s[12:15], s33 offen offset:0 sc1
v_mfma_f32_16x16x32_bf16 a[8:11], v[188:191], v[160:163], a[8:11]
v_mfma_f32_16x16x32_bf16 a[12:15], v[184:187], v[148:151], a[12:15]
v_mfma_f32_16x16x32_bf16 a[12:15], v[188:191], v[164:167], a[12:15]
s_waitcnt lgkmcnt(4)
v_mfma_f32_16x16x32_bf16 a[112:115], v[192:195], v[136:139], a[112:115]
ds_read_b64_tr_b16 v[176:177], v21 offset:43040
v_mfma_f32_16x16x32_bf16 a[112:115], v[196:199], v[152:155], a[112:115]
buffer_load_dwordx4 v[76:79], v9, s[12:15], s33 offen offset:0 sc1
v_mfma_f32_16x16x32_bf16 a[116:119], v[192:195], v[140:143], a[116:119]
ds_read_b64_tr_b16 v[178:179], v21 offset:46624
v_mfma_f32_16x16x32_bf16 a[116:119], v[196:199], v[156:159], a[116:119]
ds_read_b64_tr_b16 v[180:181], v21 offset:50208
v_mfma_f32_16x16x32_bf16 a[120:123], v[192:195], v[144:147], a[120:123]
ds_read_b64_tr_b16 v[182:183], v21 offset:53792
v_mfma_f32_16x16x32_bf16 a[120:123], v[196:199], v[160:163], a[120:123]
v_mfma_f32_16x16x32_bf16 a[124:127], v[192:195], v[148:151], a[124:127]
v_mfma_f32_16x16x32_bf16 a[124:127], v[196:199], v[164:167], a[124:127]
s_waitcnt lgkmcnt(4)
v_mfma_f32_16x16x32_bf16 a[16:19], v[168:171], v[136:139], a[16:19]
buffer_load_dwordx4 v[80:83], v10, s[12:15], s33 offen offset:0 sc1
v_mfma_f32_16x16x32_bf16 a[16:19], v[172:175], v[152:155], a[16:19]
ds_read_b64_tr_b16 v[184:185], v21 offset:28736
v_mfma_f32_16x16x32_bf16 a[20:23], v[168:171], v[140:143], a[20:23]
ds_read_b64_tr_b16 v[186:187], v21 offset:32320
v_mfma_f32_16x16x32_bf16 a[20:23], v[172:175], v[156:159], a[20:23]
ds_read_b64_tr_b16 v[188:189], v21 offset:35904
v_mfma_f32_16x16x32_bf16 a[24:27], v[168:171], v[144:147], a[24:27]
ds_read_b64_tr_b16 v[190:191], v21 offset:39488
v_mfma_f32_16x16x32_bf16 a[24:27], v[172:175], v[160:163], a[24:27]
v_mfma_f32_16x16x32_bf16 a[28:31], v[168:171], v[148:151], a[28:31]
v_mfma_f32_16x16x32_bf16 a[28:31], v[172:175], v[164:167], a[28:31]
s_waitcnt lgkmcnt(4)
v_mfma_f32_16x16x32_bf16 a[128:131], v[176:179], v[136:139], a[128:131]
buffer_load_dwordx4 v[84:87], v11, s[12:15], s33 offen offset:0 sc1
v_mfma_f32_16x16x32_bf16 a[128:131], v[180:183], v[152:155], a[128:131]
ds_read_b64_tr_b16 v[192:193], v21 offset:43072
v_mfma_f32_16x16x32_bf16 a[132:135], v[176:179], v[140:143], a[132:135]
ds_read_b64_tr_b16 v[194:195], v21 offset:46656
v_mfma_f32_16x16x32_bf16 a[132:135], v[180:183], v[156:159], a[132:135]
ds_read_b64_tr_b16 v[196:197], v21 offset:50240
v_mfma_f32_16x16x32_bf16 a[136:139], v[176:179], v[144:147], a[136:139]
ds_read_b64_tr_b16 v[198:199], v21 offset:53824
v_mfma_f32_16x16x32_bf16 a[136:139], v[180:183], v[160:163], a[136:139]
v_mfma_f32_16x16x32_bf16 a[140:143], v[176:179], v[148:151], a[140:143]
buffer_load_dwordx4 v[88:91], v8, s[12:15], s33 offen offset:1024 sc1
v_mfma_f32_16x16x32_bf16 a[140:143], v[180:183], v[164:167], a[140:143]
s_waitcnt lgkmcnt(4)
v_mfma_f32_16x16x32_bf16 a[32:35], v[184:187], v[136:139], a[32:35]
ds_read_b64_tr_b16 v[168:169], v21 offset:28768
v_mfma_f32_16x16x32_bf16 a[32:35], v[188:191], v[152:155], a[32:35]
ds_read_b64_tr_b16 v[170:171], v21 offset:32352
v_mfma_f32_16x16x32_bf16 a[36:39], v[184:187], v[140:143], a[36:39]
ds_read_b64_tr_b16 v[172:173], v21 offset:35936
v_mfma_f32_16x16x32_bf16 a[36:39], v[188:191], v[156:159], a[36:39]
ds_read_b64_tr_b16 v[174:175], v21 offset:39520
v_mfma_f32_16x16x32_bf16 a[40:43], v[184:187], v[144:147], a[40:43]
v_mfma_f32_16x16x32_bf16 a[40:43], v[188:191], v[160:163], a[40:43]
buffer_load_dwordx4 v[92:95], v9, s[12:15], s33 offen offset:1024 sc1
v_mfma_f32_16x16x32_bf16 a[44:47], v[184:187], v[148:151], a[44:47]
v_mfma_f32_16x16x32_bf16 a[44:47], v[188:191], v[164:167], a[44:47]
s_waitcnt lgkmcnt(4)
v_mfma_f32_16x16x32_bf16 a[144:147], v[192:195], v[136:139], a[144:147]
ds_read_b64_tr_b16 v[176:177], v21 offset:43104
v_mfma_f32_16x16x32_bf16 a[144:147], v[196:199], v[152:155], a[144:147]
ds_read_b64_tr_b16 v[178:179], v21 offset:46688
v_mfma_f32_16x16x32_bf16 a[148:151], v[192:195], v[140:143], a[148:151]
ds_read_b64_tr_b16 v[180:181], v21 offset:50272
v_mfma_f32_16x16x32_bf16 a[148:151], v[196:199], v[156:159], a[148:151]
ds_read_b64_tr_b16 v[182:183], v21 offset:53856
v_mfma_f32_16x16x32_bf16 a[152:155], v[192:195], v[144:147], a[152:155]
buffer_load_dwordx4 v[96:99], v10, s[12:15], s33 offen offset:1024 sc1
v_mfma_f32_16x16x32_bf16 a[152:155], v[196:199], v[160:163], a[152:155]
v_mfma_f32_16x16x32_bf16 a[156:159], v[192:195], v[148:151], a[156:159]
v_mfma_f32_16x16x32_bf16 a[156:159], v[196:199], v[164:167], a[156:159]
s_waitcnt lgkmcnt(4)
v_mfma_f32_16x16x32_bf16 a[48:51], v[168:171], v[136:139], a[48:51]
ds_read_b64_tr_b16 v[184:185], v21 offset:28800
v_mfma_f32_16x16x32_bf16 a[48:51], v[172:175], v[152:155], a[48:51]
ds_read_b64_tr_b16 v[186:187], v21 offset:32384
v_mfma_f32_16x16x32_bf16 a[52:55], v[168:171], v[140:143], a[52:55]
ds_read_b64_tr_b16 v[188:189], v21 offset:35968
v_mfma_f32_16x16x32_bf16 a[52:55], v[172:175], v[156:159], a[52:55]
ds_read_b64_tr_b16 v[190:191], v21 offset:39552
v_mfma_f32_16x16x32_bf16 a[56:59], v[168:171], v[144:147], a[56:59]
buffer_load_dwordx4 v[100:103], v11, s[12:15], s33 offen offset:1024 sc1
v_mfma_f32_16x16x32_bf16 a[56:59], v[172:175], v[160:163], a[56:59]
s_add_u32 s33, s33, 2048
v_mfma_f32_16x16x32_bf16 a[60:63], v[168:171], v[148:151], a[60:63]
v_mfma_f32_16x16x32_bf16 a[60:63], v[172:175], v[164:167], a[60:63]
s_waitcnt lgkmcnt(4)
v_mfma_f32_16x16x32_bf16 a[160:163], v[176:179], v[136:139], a[160:163]
ds_read_b64_tr_b16 v[192:193], v21 offset:43136
v_mfma_f32_16x16x32_bf16 a[160:163], v[180:183], v[152:155], a[160:163]
ds_read_b64_tr_b16 v[194:195], v21 offset:46720
s_add_u32 m0, s35, 57344
v_mfma_f32_16x16x32_bf16 a[164:167], v[176:179], v[140:143], a[164:167]
ds_read_b64_tr_b16 v[196:197], v21 offset:50304
v_mfma_f32_16x16x32_bf16 a[164:167], v[180:183], v[156:159], a[164:167]
ds_read_b64_tr_b16 v[198:199], v21 offset:53888
v_mfma_f32_16x16x32_bf16 a[168:171], v[176:179], v[144:147], a[168:171]
buffer_load_dwordx4 v12, s[16:19], s34 offen offset:0 lds
v_mfma_f32_16x16x32_bf16 a[168:171], v[180:183], v[160:163], a[168:171]
v_mfma_f32_16x16x32_bf16 a[172:175], v[176:179], v[148:151], a[172:175]
v_mfma_f32_16x16x32_bf16 a[172:175], v[180:183], v[164:167], a[172:175]
s_waitcnt lgkmcnt(4)
v_mfma_f32_16x16x32_bf16 a[64:67], v[184:187], v[136:139], a[64:67]
ds_read_b64_tr_b16 v[168:169], v21 offset:28832
v_mfma_f32_16x16x32_bf16 a[64:67], v[188:191], v[152:155], a[64:67]
ds_read_b64_tr_b16 v[170:171], v21 offset:32416
v_mfma_f32_16x16x32_bf16 a[68:71], v[184:187], v[140:143], a[68:71]
ds_read_b64_tr_b16 v[172:173], v21 offset:36000
v_mfma_f32_16x16x32_bf16 a[68:71], v[188:191], v[156:159], a[68:71]
ds_read_b64_tr_b16 v[174:175], v21 offset:39584
v_mfma_f32_16x16x32_bf16 a[72:75], v[184:187], v[144:147], a[72:75]
buffer_load_dwordx4 v13, s[16:19], s34 offen offset:1024 lds
v_mfma_f32_16x16x32_bf16 a[72:75], v[188:191], v[160:163], a[72:75]
v_mfma_f32_16x16x32_bf16 a[76:79], v[184:187], v[148:151], a[76:79]
v_mfma_f32_16x16x32_bf16 a[76:79], v[188:191], v[164:167], a[76:79]
s_waitcnt lgkmcnt(4)
v_mfma_f32_16x16x32_bf16 a[176:179], v[192:195], v[136:139], a[176:179]
ds_read_b64_tr_b16 v[176:177], v21 offset:43168
v_mfma_f32_16x16x32_bf16 a[176:179], v[196:199], v[152:155], a[176:179]
ds_read_b64_tr_b16 v[178:179], v21 offset:46752
v_mfma_f32_16x16x32_bf16 a[180:183], v[192:195], v[140:143], a[180:183]
ds_read_b64_tr_b16 v[180:181], v21 offset:50336
v_mfma_f32_16x16x32_bf16 a[180:183], v[196:199], v[156:159], a[180:183]
ds_read_b64_tr_b16 v[182:183], v21 offset:53920
v_mfma_f32_16x16x32_bf16 a[184:187], v[192:195], v[144:147], a[184:187]
buffer_load_dwordx4 v14, s[16:19], s34 offen offset:2048 lds
v_mfma_f32_16x16x32_bf16 a[184:187], v[196:199], v[160:163], a[184:187]
v_mfma_f32_16x16x32_bf16 a[188:191], v[192:195], v[148:151], a[188:191]
v_mfma_f32_16x16x32_bf16 a[188:191], v[196:199], v[164:167], a[188:191]
s_waitcnt lgkmcnt(4)
v_mfma_f32_16x16x32_bf16 a[80:83], v[168:171], v[136:139], a[80:83]
ds_read_b64_tr_b16 v[184:185], v21 offset:28864
v_mfma_f32_16x16x32_bf16 a[80:83], v[172:175], v[152:155], a[80:83]
buffer_load_dwordx4 v15, s[16:19], s34 offen offset:3072 lds
v_mfma_f32_16x16x32_bf16 a[84:87], v[168:171], v[140:143], a[84:87]
ds_read_b64_tr_b16 v[186:187], v21 offset:32448
v_mfma_f32_16x16x32_bf16 a[84:87], v[172:175], v[156:159], a[84:87]
ds_read_b64_tr_b16 v[188:189], v21 offset:36032
v_mfma_f32_16x16x32_bf16 a[88:91], v[168:171], v[144:147], a[88:91]
ds_read_b64_tr_b16 v[190:191], v21 offset:39616
v_mfma_f32_16x16x32_bf16 a[88:91], v[172:175], v[160:163], a[88:91]
s_add_u32 m0, s35, 61440
v_mfma_f32_16x16x32_bf16 a[92:95], v[168:171], v[148:151], a[92:95]
v_mfma_f32_16x16x32_bf16 a[92:95], v[172:175], v[164:167], a[92:95]
s_waitcnt lgkmcnt(4)
v_mfma_f32_16x16x32_bf16 a[192:195], v[176:179], v[136:139], a[192:195]
buffer_load_dwordx4 v16, s[16:19], s34 offen offset:0 lds
v_mfma_f32_16x16x32_bf16 a[192:195], v[180:183], v[152:155], a[192:195]
ds_read_b64_tr_b16 v[192:193], v21 offset:43200
v_mfma_f32_16x16x32_bf16 a[196:199], v[176:179], v[140:143], a[196:199]
ds_read_b64_tr_b16 v[194:195], v21 offset:46784
v_mfma_f32_16x16x32_bf16 a[196:199], v[180:183], v[156:159], a[196:199]
ds_read_b64_tr_b16 v[196:197], v21 offset:50368
v_mfma_f32_16x16x32_bf16 a[200:203], v[176:179], v[144:147], a[200:203]
ds_read_b64_tr_b16 v[198:199], v21 offset:53952
v_mfma_f32_16x16x32_bf16 a[200:203], v[180:183], v[160:163], a[200:203]
v_mfma_f32_16x16x32_bf16 a[204:207], v[176:179], v[148:151], a[204:207]
v_mfma_f32_16x16x32_bf16 a[204:207], v[180:183], v[164:167], a[204:207]
s_waitcnt vmcnt(28) lgkmcnt(4)
s_barrier
v_mfma_f32_16x16x32_bf16 a[96:99], v[184:187], v[136:139], a[96:99]
buffer_load_dwordx4 v17, s[16:19], s34 offen offset:1024 lds
v_mfma_f32_16x16x32_bf16 a[96:99], v[188:191], v[152:155], a[96:99]
ds_read_b64_tr_b16 v[168:169], v20 offset:0
v_mfma_f32_16x16x32_bf16 a[100:103], v[184:187], v[140:143], a[100:103]
ds_read_b64_tr_b16 v[170:171], v20 offset:3584
v_mfma_f32_16x16x32_bf16 a[100:103], v[188:191], v[156:159], a[100:103]
ds_read_b64_tr_b16 v[172:173], v20 offset:7168
v_mfma_f32_16x16x32_bf16 a[104:107], v[184:187], v[144:147], a[104:107]
ds_read_b64_tr_b16 v[174:175], v20 offset:10752
v_mfma_f32_16x16x32_bf16 a[104:107], v[188:191], v[160:163], a[104:107]
v_mfma_f32_16x16x32_bf16 a[108:111], v[184:187], v[148:151], a[108:111]
buffer_load_dwordx4 v18, s[16:19], s34 offen offset:2048 lds
v_mfma_f32_16x16x32_bf16 a[108:111], v[188:191], v[164:167], a[108:111]
s_add_u32 s34, s34, 458752
s_waitcnt lgkmcnt(4)
v_mfma_f32_16x16x32_bf16 a[208:211], v[192:195], v[136:139], a[208:211]
ds_read_b64_tr_b16 v[176:177], v20 offset:14336
v_mfma_f32_16x16x32_bf16 a[208:211], v[196:199], v[152:155], a[208:211]
ds_read_b64_tr_b16 v[178:179], v20 offset:17920
v_mfma_f32_16x16x32_bf16 a[212:215], v[192:195], v[140:143], a[212:215]
ds_read_b64_tr_b16 v[180:181], v20 offset:21504
v_mfma_f32_16x16x32_bf16 a[212:215], v[196:199], v[156:159], a[212:215]
ds_read_b64_tr_b16 v[182:183], v20 offset:25088
v_mfma_f32_16x16x32_bf16 a[216:219], v[192:195], v[144:147], a[216:219]
v_mfma_f32_16x16x32_bf16 a[216:219], v[196:199], v[160:163], a[216:219]
v_mfma_f32_16x16x32_bf16 a[220:223], v[192:195], v[148:151], a[220:223]
v_mfma_f32_16x16x32_bf16 a[220:223], v[196:199], v[164:167], a[220:223]
s_mov_b32 s36, 2
L_attn_kernel_gu_loop:
s_waitcnt vmcnt(22) lgkmcnt(4)
v_mfma_f32_16x16x32_bf16 a[0:3], v[168:171], v[40:43], a[0:3]
ds_read_b64_tr_b16 v[184:185], v20 offset:32
v_mfma_f32_16x16x32_bf16 a[0:3], v[172:175], v[56:59], a[0:3]
ds_read_b64_tr_b16 v[186:187], v20 offset:3616
v_mfma_f32_16x16x32_bf16 a[4:7], v[168:171], v[44:47], a[4:7]
ds_read_b64_tr_b16 v[188:189], v20 offset:7200
v_mfma_f32_16x16x32_bf16 a[4:7], v[172:175], v[60:63], a[4:7]
ds_read_b64_tr_b16 v[190:191], v20 offset:10784
v_mfma_f32_16x16x32_bf16 a[8:11], v[168:171], v[48:51], a[8:11]
buffer_load_dwordx4 v[104:107], v8, s[12:15], s33 offen offset:0 sc1
v_mfma_f32_16x16x32_bf16 a[8:11], v[172:175], v[64:67], a[8:11]
v_mfma_f32_16x16x32_bf16 a[12:15], v[168:171], v[52:55], a[12:15]
v_mfma_f32_16x16x32_bf16 a[12:15], v[172:175], v[68:71], a[12:15]
s_waitcnt lgkmcnt(4)
v_mfma_f32_16x16x32_bf16 a[112:115], v[176:179], v[40:43], a[112:115]
ds_read_b64_tr_b16 v[192:193], v20 offset:14368
v_mfma_f32_16x16x32_bf16 a[112:115], v[180:183], v[56:59], a[112:115]
buffer_load_dwordx4 v[108:111], v9, s[12:15], s33 offen offset:0 sc1
v_mfma_f32_16x16x32_bf16 a[116:119], v[176:179], v[44:47], a[116:119]
ds_read_b64_tr_b16 v[194:195], v20 offset:17952
v_mfma_f32_16x16x32_bf16 a[116:119], v[180:183], v[60:63], a[116:119]
ds_read_b64_tr_b16 v[196:197], v20 offset:21536
v_mfma_f32_16x16x32_bf16 a[120:123], v[176:179], v[48:51], a[120:123]
ds_read_b64_tr_b16 v[198:199], v20 offset:25120
v_mfma_f32_16x16x32_bf16 a[120:123], v[180:183], v[64:67], a[120:123]
v_mfma_f32_16x16x32_bf16 a[124:127], v[176:179], v[52:55], a[124:127]
v_mfma_f32_16x16x32_bf16 a[124:127], v[180:183], v[68:71], a[124:127]
s_waitcnt lgkmcnt(4)
v_mfma_f32_16x16x32_bf16 a[16:19], v[184:187], v[40:43], a[16:19]
buffer_load_dwordx4 v[112:115], v10, s[12:15], s33 offen offset:0 sc1
v_mfma_f32_16x16x32_bf16 a[16:19], v[188:191], v[56:59], a[16:19]
ds_read_b64_tr_b16 v[168:169], v20 offset:64
v_mfma_f32_16x16x32_bf16 a[20:23], v[184:187], v[44:47], a[20:23]
ds_read_b64_tr_b16 v[170:171], v20 offset:3648
v_mfma_f32_16x16x32_bf16 a[20:23], v[188:191], v[60:63], a[20:23]
ds_read_b64_tr_b16 v[172:173], v20 offset:7232
v_mfma_f32_16x16x32_bf16 a[24:27], v[184:187], v[48:51], a[24:27]
ds_read_b64_tr_b16 v[174:175], v20 offset:10816
v_mfma_f32_16x16x32_bf16 a[24:27], v[188:191], v[64:67], a[24:27]
v_mfma_f32_16x16x32_bf16 a[28:31], v[184:187], v[52:55], a[28:31]
v_mfma_f32_16x16x32_bf16 a[28:31], v[188:191], v[68:71], a[28:31]
s_waitcnt lgkmcnt(4)
v_mfma_f32_16x16x32_bf16 a[128:131], v[192:195], v[40:43], a[128:131]
buffer_load_dwordx4 v[116:119], v11, s[12:15], s33 offen offset:0 sc1
v_mfma_f32_16x16x32_bf16 a[128:131], v[196:199], v[56:59], a[128:131]
ds_read_b64_tr_b16 v[176:177], v20 offset:14400
v_mfma_f32_16x16x32_bf16 a[132:135], v[192:195], v[44:47], a[132:135]
ds_read_b64_tr_b16 v[178:179], v20 offset:17984
v_mfma_f32_16x16x32_bf16 a[132:135], v[196:199], v[60:63], a[132:135]
ds_read_b64_tr_b16 v[180:181], v20 offset:21568
v_mfma_f32_16x16x32_bf16 a[136:139], v[192:195], v[48:51], a[136:139]
ds_read_b64_tr_b16 v[182:183], v20 offset:25152
v_mfma_f32_16x16x32_bf16 a[136:139], v[196:199], v[64:67], a[136:139]
v_mfma_f32_16x16x32_bf16 a[140:143], v[192:195], v[52:55], a[140:143]
buffer_load_dwordx4 v[120:123], v8, s[12:15], s33 offen offset:1024 sc1
v_mfma_f32_16x16x32_bf16 a[140:143], v[196:199], v[68:71], a[140:143]
s_waitcnt lgkmcnt(4)
v_mfma_f32_16x16x32_bf16 a[32:35], v[168:171], v[40:43], a[32:35]
ds_read_b64_tr_b16 v[184:185], v20 offset:96
v_mfma_f32_16x16x32_bf16 a[32:35], v[172:175], v[56:59], a[32:35]
ds_read_b64_tr_b16 v[186:187], v20 offset:3680
v_mfma_f32_16x16x32_bf16 a[36:39], v[168:171], v[44:47], a[36:39]
ds_read_b64_tr_b16 v[188:189], v20 offset:7264
v_mfma_f32_16x16x32_bf16 a[36:39], v[172:175], v[60:63], a[36:39]
ds_read_b64_tr_b16 v[190:191], v20 offset:10848
v_mfma_f32_16x16x32_bf16 a[40:43], v[168:171], v[48:51], a[40:43]
v_mfma_f32_16x16x32_bf16 a[40:43], v[172:175], v[64:67], a[40:43]
buffer_load_dwordx4 v[124:127], v9, s[12:15], s33 offen offset:1024 sc1
v_mfma_f32_16x16x32_bf16 a[44:47], v[168:171], v[52:55], a[44:47]
v_mfma_f32_16x16x32_bf16 a[44:47], v[172:175], v[68:71], a[44:47]
s_waitcnt lgkmcnt(4)
v_mfma_f32_16x16x32_bf16 a[144:147], v[176:179], v[40:43], a[144:147]
ds_read_b64_tr_b16 v[192:193], v20 offset:14432
v_mfma_f32_16x16x32_bf16 a[144:147], v[180:183], v[56:59], a[144:147]
ds_read_b64_tr_b16 v[194:195], v20 offset:18016
v_mfma_f32_16x16x32_bf16 a[148:151], v[176:179], v[44:47], a[148:151]
ds_read_b64_tr_b16 v[196:197], v20 offset:21600
v_mfma_f32_16x16x32_bf16 a[148:151], v[180:183], v[60:63], a[148:151]
ds_read_b64_tr_b16 v[198:199], v20 offset:25184
v_mfma_f32_16x16x32_bf16 a[152:155], v[176:179], v[48:51], a[152:155]
buffer_load_dwordx4 v[128:131], v10, s[12:15], s33 offen offset:1024 sc1
v_mfma_f32_16x16x32_bf16 a[152:155], v[180:183], v[64:67], a[152:155]
v_mfma_f32_16x16x32_bf16 a[156:159], v[176:179], v[52:55], a[156:159]
v_mfma_f32_16x16x32_bf16 a[156:159], v[180:183], v[68:71], a[156:159]
s_waitcnt lgkmcnt(4)
v_mfma_f32_16x16x32_bf16 a[48:51], v[184:187], v[40:43], a[48:51]
ds_read_b64_tr_b16 v[168:169], v20 offset:128
v_mfma_f32_16x16x32_bf16 a[48:51], v[188:191], v[56:59], a[48:51]
ds_read_b64_tr_b16 v[170:171], v20 offset:3712
v_mfma_f32_16x16x32_bf16 a[52:55], v[184:187], v[44:47], a[52:55]
ds_read_b64_tr_b16 v[172:173], v20 offset:7296
v_mfma_f32_16x16x32_bf16 a[52:55], v[188:191], v[60:63], a[52:55]
ds_read_b64_tr_b16 v[174:175], v20 offset:10880
v_mfma_f32_16x16x32_bf16 a[56:59], v[184:187], v[48:51], a[56:59]
buffer_load_dwordx4 v[132:135], v11, s[12:15], s33 offen offset:1024 sc1
v_mfma_f32_16x16x32_bf16 a[56:59], v[188:191], v[64:67], a[56:59]
s_add_u32 s33, s33, 2048
v_mfma_f32_16x16x32_bf16 a[60:63], v[184:187], v[52:55], a[60:63]
v_mfma_f32_16x16x32_bf16 a[60:63], v[188:191], v[68:71], a[60:63]
s_waitcnt lgkmcnt(4)
v_mfma_f32_16x16x32_bf16 a[160:163], v[192:195], v[40:43], a[160:163]
ds_read_b64_tr_b16 v[176:177], v20 offset:14464
v_mfma_f32_16x16x32_bf16 a[160:163], v[196:199], v[56:59], a[160:163]
ds_read_b64_tr_b16 v[178:179], v20 offset:18048
s_add_u32 m0, s35, 86016
v_mfma_f32_16x16x32_bf16 a[164:167], v[192:195], v[44:47], a[164:167]
ds_read_b64_tr_b16 v[180:181], v20 offset:21632
v_mfma_f32_16x16x32_bf16 a[164:167], v[196:199], v[60:63], a[164:167]
ds_read_b64_tr_b16 v[182:183], v20 offset:25216
v_mfma_f32_16x16x32_bf16 a[168:171], v[192:195], v[48:51], a[168:171]
buffer_load_dwordx4 v12, s[16:19], s34 offen offset:0 lds
v_mfma_f32_16x16x32_bf16 a[168:171], v[196:199], v[64:67], a[168:171]
v_mfma_f32_16x16x32_bf16 a[172:175], v[192:195], v[52:55], a[172:175]
v_mfma_f32_16x16x32_bf16 a[172:175], v[196:199], v[68:71], a[172:175]
s_waitcnt lgkmcnt(4)
v_mfma_f32_16x16x32_bf16 a[64:67], v[168:171], v[40:43], a[64:67]
ds_read_b64_tr_b16 v[184:185], v20 offset:160
v_mfma_f32_16x16x32_bf16 a[64:67], v[172:175], v[56:59], a[64:67]
ds_read_b64_tr_b16 v[186:187], v20 offset:3744
v_mfma_f32_16x16x32_bf16 a[68:71], v[168:171], v[44:47], a[68:71]
ds_read_b64_tr_b16 v[188:189], v20 offset:7328
v_mfma_f32_16x16x32_bf16 a[68:71], v[172:175], v[60:63], a[68:71]
ds_read_b64_tr_b16 v[190:191], v20 offset:10912
v_mfma_f32_16x16x32_bf16 a[72:75], v[168:171], v[48:51], a[72:75]
buffer_load_dwordx4 v13, s[16:19], s34 offen offset:1024 lds
v_mfma_f32_16x16x32_bf16 a[72:75], v[172:175], v[64:67], a[72:75]
v_mfma_f32_16x16x32_bf16 a[76:79], v[168:171], v[52:55], a[76:79]
v_mfma_f32_16x16x32_bf16 a[76:79], v[172:175], v[68:71], a[76:79]
s_waitcnt lgkmcnt(4)
v_mfma_f32_16x16x32_bf16 a[176:179], v[176:179], v[40:43], a[176:179]
ds_read_b64_tr_b16 v[192:193], v20 offset:14496
v_mfma_f32_16x16x32_bf16 a[176:179], v[180:183], v[56:59], a[176:179]
ds_read_b64_tr_b16 v[194:195], v20 offset:18080
v_mfma_f32_16x16x32_bf16 a[180:183], v[176:179], v[44:47], a[180:183]
ds_read_b64_tr_b16 v[196:197], v20 offset:21664
v_mfma_f32_16x16x32_bf16 a[180:183], v[180:183], v[60:63], a[180:183]
ds_read_b64_tr_b16 v[198:199], v20 offset:25248
v_mfma_f32_16x16x32_bf16 a[184:187], v[176:179], v[48:51], a[184:187]
buffer_load_dwordx4 v14, s[16:19], s34 offen offset:2048 lds
v_mfma_f32_16x16x32_bf16 a[184:187], v[180:183], v[64:67], a[184:187]
v_mfma_f32_16x16x32_bf16 a[188:191], v[176:179], v[52:55], a[188:191]
v_mfma_f32_16x16x32_bf16 a[188:191], v[180:183], v[68:71], a[188:191]
s_waitcnt lgkmcnt(4)
v_mfma_f32_16x16x32_bf16 a[80:83], v[184:187], v[40:43], a[80:83]
ds_read_b64_tr_b16 v[168:169], v20 offset:192
v_mfma_f32_16x16x32_bf16 a[80:83], v[188:191], v[56:59], a[80:83]
buffer_load_dwordx4 v15, s[16:19], s34 offen offset:3072 lds
v_mfma_f32_16x16x32_bf16 a[84:87], v[184:187], v[44:47], a[84:87]
ds_read_b64_tr_b16 v[170:171], v20 offset:3776
v_mfma_f32_16x16x32_bf16 a[84:87], v[188:191], v[60:63], a[84:87]
ds_read_b64_tr_b16 v[172:173], v20 offset:7360
v_mfma_f32_16x16x32_bf16 a[88:91], v[184:187], v[48:51], a[88:91]
ds_read_b64_tr_b16 v[174:175], v20 offset:10944
v_mfma_f32_16x16x32_bf16 a[88:91], v[188:191], v[64:67], a[88:91]
s_add_u32 m0, s35, 90112
v_mfma_f32_16x16x32_bf16 a[92:95], v[184:187], v[52:55], a[92:95]
v_mfma_f32_16x16x32_bf16 a[92:95], v[188:191], v[68:71], a[92:95]
s_waitcnt lgkmcnt(4)
v_mfma_f32_16x16x32_bf16 a[192:195], v[192:195], v[40:43], a[192:195]
buffer_load_dwordx4 v16, s[16:19], s34 offen offset:0 lds
v_mfma_f32_16x16x32_bf16 a[192:195], v[196:199], v[56:59], a[192:195]
ds_read_b64_tr_b16 v[176:177], v20 offset:14528
v_mfma_f32_16x16x32_bf16 a[196:199], v[192:195], v[44:47], a[196:199]
ds_read_b64_tr_b16 v[178:179], v20 offset:18112
v_mfma_f32_16x16x32_bf16 a[196:199], v[196:199], v[60:63], a[196:199]
ds_read_b64_tr_b16 v[180:181], v20 offset:21696
v_mfma_f32_16x16x32_bf16 a[200:203], v[192:195], v[48:51], a[200:203]
ds_read_b64_tr_b16 v[182:183], v20 offset:25280
v_mfma_f32_16x16x32_bf16 a[200:203], v[196:199], v[64:67], a[200:203]
v_mfma_f32_16x16x32_bf16 a[204:207], v[192:195], v[52:55], a[204:207]
v_mfma_f32_16x16x32_bf16 a[204:207], v[196:199], v[68:71], a[204:207]
s_waitcnt vmcnt(28) lgkmcnt(4)
s_barrier
v_mfma_f32_16x16x32_bf16 a[96:99], v[168:171], v[40:43], a[96:99]
buffer_load_dwordx4 v17, s[16:19], s34 offen offset:1024 lds
v_mfma_f32_16x16x32_bf16 a[96:99], v[172:175], v[56:59], a[96:99]
ds_read_b64_tr_b16 v[184:185], v20 offset:28672
v_mfma_f32_16x16x32_bf16 a[100:103], v[168:171], v[44:47], a[100:103]
ds_read_b64_tr_b16 v[186:187], v20 offset:32256
v_mfma_f32_16x16x32_bf16 a[100:103], v[172:175], v[60:63], a[100:103]
ds_read_b64_tr_b16 v[188:189], v20 offset:35840
v_mfma_f32_16x16x32_bf16 a[104:107], v[168:171], v[48:51], a[104:107]
ds_read_b64_tr_b16 v[190:191], v20 offset:39424
v_mfma_f32_16x16x32_bf16 a[104:107], v[172:175], v[64:67], a[104:107]
v_mfma_f32_16x16x32_bf16 a[108:111], v[168:171], v[52:55], a[108:111]
buffer_load_dwordx4 v18, s[16:19], s34 offen offset:2048 lds
v_mfma_f32_16x16x32_bf16 a[108:111], v[172:175], v[68:71], a[108:111]
s_add_u32 s34, s34, 458752
s_waitcnt lgkmcnt(4)
v_mfma_f32_16x16x32_bf16 a[208:211], v[176:179], v[40:43], a[208:211]
ds_read_b64_tr_b16 v[192:193], v20 offset:43008
v_mfma_f32_16x16x32_bf16 a[208:211], v[180:183], v[56:59], a[208:211]
ds_read_b64_tr_b16 v[194:195], v20 offset:46592
v_mfma_f32_16x16x32_bf16 a[212:215], v[176:179], v[44:47], a[212:215]
ds_read_b64_tr_b16 v[196:197], v20 offset:50176
v_mfma_f32_16x16x32_bf16 a[212:215], v[180:183], v[60:63], a[212:215]
ds_read_b64_tr_b16 v[198:199], v20 offset:53760
v_mfma_f32_16x16x32_bf16 a[216:219], v[176:179], v[48:51], a[216:219]
v_mfma_f32_16x16x32_bf16 a[216:219], v[180:183], v[64:67], a[216:219]
v_mfma_f32_16x16x32_bf16 a[220:223], v[176:179], v[52:55], a[220:223]
v_mfma_f32_16x16x32_bf16 a[220:223], v[180:183], v[68:71], a[220:223]
s_waitcnt vmcnt(22) lgkmcnt(4)
v_mfma_f32_16x16x32_bf16 a[0:3], v[184:187], v[72:75], a[0:3]
ds_read_b64_tr_b16 v[168:169], v20 offset:28704
v_mfma_f32_16x16x32_bf16 a[0:3], v[188:191], v[88:91], a[0:3]
ds_read_b64_tr_b16 v[170:171], v20 offset:32288
v_mfma_f32_16x16x32_bf16 a[4:7], v[184:187], v[76:79], a[4:7]
ds_read_b64_tr_b16 v[172:173], v20 offset:35872
v_mfma_f32_16x16x32_bf16 a[4:7], v[188:191], v[92:95], a[4:7]
ds_read_b64_tr_b16 v[174:175], v20 offset:39456
v_mfma_f32_16x16x32_bf16 a[8:11], v[184:187], v[80:83], a[8:11]
buffer_load_dwordx4 v[136:139], v8, s[12:15], s33 offen offset:0 sc1
v_mfma_f32_16x16x32_bf16 a[8:11], v[188:191], v[96:99], a[8:11]
v_mfma_f32_16x16x32_bf16 a[12:15], v[184:187], v[84:87], a[12:15]
v_mfma_f32_16x16x32_bf16 a[12:15], v[188:191], v[100:103], a[12:15]
s_waitcnt lgkmcnt(4)
v_mfma_f32_16x16x32_bf16 a[112:115], v[192:195], v[72:75], a[112:115]
ds_read_b64_tr_b16 v[176:177], v20 offset:43040
v_mfma_f32_16x16x32_bf16 a[112:115], v[196:199], v[88:91], a[112:115]
buffer_load_dwordx4 v[140:143], v9, s[12:15], s33 offen offset:0 sc1
v_mfma_f32_16x16x32_bf16 a[116:119], v[192:195], v[76:79], a[116:119]
ds_read_b64_tr_b16 v[178:179], v20 offset:46624
v_mfma_f32_16x16x32_bf16 a[116:119], v[196:199], v[92:95], a[116:119]
ds_read_b64_tr_b16 v[180:181], v20 offset:50208
v_mfma_f32_16x16x32_bf16 a[120:123], v[192:195], v[80:83], a[120:123]
ds_read_b64_tr_b16 v[182:183], v20 offset:53792
v_mfma_f32_16x16x32_bf16 a[120:123], v[196:199], v[96:99], a[120:123]
v_mfma_f32_16x16x32_bf16 a[124:127], v[192:195], v[84:87], a[124:127]
v_mfma_f32_16x16x32_bf16 a[124:127], v[196:199], v[100:103], a[124:127]
s_waitcnt lgkmcnt(4)
v_mfma_f32_16x16x32_bf16 a[16:19], v[168:171], v[72:75], a[16:19]
buffer_load_dwordx4 v[144:147], v10, s[12:15], s33 offen offset:0 sc1
v_mfma_f32_16x16x32_bf16 a[16:19], v[172:175], v[88:91], a[16:19]
ds_read_b64_tr_b16 v[184:185], v20 offset:28736
v_mfma_f32_16x16x32_bf16 a[20:23], v[168:171], v[76:79], a[20:23]
ds_read_b64_tr_b16 v[186:187], v20 offset:32320
v_mfma_f32_16x16x32_bf16 a[20:23], v[172:175], v[92:95], a[20:23]
ds_read_b64_tr_b16 v[188:189], v20 offset:35904
v_mfma_f32_16x16x32_bf16 a[24:27], v[168:171], v[80:83], a[24:27]
ds_read_b64_tr_b16 v[190:191], v20 offset:39488
v_mfma_f32_16x16x32_bf16 a[24:27], v[172:175], v[96:99], a[24:27]
v_mfma_f32_16x16x32_bf16 a[28:31], v[168:171], v[84:87], a[28:31]
v_mfma_f32_16x16x32_bf16 a[28:31], v[172:175], v[100:103], a[28:31]
s_waitcnt lgkmcnt(4)
v_mfma_f32_16x16x32_bf16 a[128:131], v[176:179], v[72:75], a[128:131]
buffer_load_dwordx4 v[148:151], v11, s[12:15], s33 offen offset:0 sc1
v_mfma_f32_16x16x32_bf16 a[128:131], v[180:183], v[88:91], a[128:131]
ds_read_b64_tr_b16 v[192:193], v20 offset:43072
v_mfma_f32_16x16x32_bf16 a[132:135], v[176:179], v[76:79], a[132:135]
ds_read_b64_tr_b16 v[194:195], v20 offset:46656
v_mfma_f32_16x16x32_bf16 a[132:135], v[180:183], v[92:95], a[132:135]
ds_read_b64_tr_b16 v[196:197], v20 offset:50240
v_mfma_f32_16x16x32_bf16 a[136:139], v[176:179], v[80:83], a[136:139]
ds_read_b64_tr_b16 v[198:199], v20 offset:53824
v_mfma_f32_16x16x32_bf16 a[136:139], v[180:183], v[96:99], a[136:139]
v_mfma_f32_16x16x32_bf16 a[140:143], v[176:179], v[84:87], a[140:143]
buffer_load_dwordx4 v[152:155], v8, s[12:15], s33 offen offset:1024 sc1
v_mfma_f32_16x16x32_bf16 a[140:143], v[180:183], v[100:103], a[140:143]
s_waitcnt lgkmcnt(4)
v_mfma_f32_16x16x32_bf16 a[32:35], v[184:187], v[72:75], a[32:35]
ds_read_b64_tr_b16 v[168:169], v20 offset:28768
v_mfma_f32_16x16x32_bf16 a[32:35], v[188:191], v[88:91], a[32:35]
ds_read_b64_tr_b16 v[170:171], v20 offset:32352
v_mfma_f32_16x16x32_bf16 a[36:39], v[184:187], v[76:79], a[36:39]
ds_read_b64_tr_b16 v[172:173], v20 offset:35936
v_mfma_f32_16x16x32_bf16 a[36:39], v[188:191], v[92:95], a[36:39]
ds_read_b64_tr_b16 v[174:175], v20 offset:39520
v_mfma_f32_16x16x32_bf16 a[40:43], v[184:187], v[80:83], a[40:43]
v_mfma_f32_16x16x32_bf16 a[40:43], v[188:191], v[96:99], a[40:43]
buffer_load_dwordx4 v[156:159], v9, s[12:15], s33 offen offset:1024 sc1
v_mfma_f32_16x16x32_bf16 a[44:47], v[184:187], v[84:87], a[44:47]
v_mfma_f32_16x16x32_bf16 a[44:47], v[188:191], v[100:103], a[44:47]
s_waitcnt lgkmcnt(4)
v_mfma_f32_16x16x32_bf16 a[144:147], v[192:195], v[72:75], a[144:147]
ds_read_b64_tr_b16 v[176:177], v20 offset:43104
v_mfma_f32_16x16x32_bf16 a[144:147], v[196:199], v[88:91], a[144:147]
ds_read_b64_tr_b16 v[178:179], v20 offset:46688
v_mfma_f32_16x16x32_bf16 a[148:151], v[192:195], v[76:79], a[148:151]
ds_read_b64_tr_b16 v[180:181], v20 offset:50272
v_mfma_f32_16x16x32_bf16 a[148:151], v[196:199], v[92:95], a[148:151]
ds_read_b64_tr_b16 v[182:183], v20 offset:53856
v_mfma_f32_16x16x32_bf16 a[152:155], v[192:195], v[80:83], a[152:155]
buffer_load_dwordx4 v[160:163], v10, s[12:15], s33 offen offset:1024 sc1
v_mfma_f32_16x16x32_bf16 a[152:155], v[196:199], v[96:99], a[152:155]
v_mfma_f32_16x16x32_bf16 a[156:159], v[192:195], v[84:87], a[156:159]
v_mfma_f32_16x16x32_bf16 a[156:159], v[196:199], v[100:103], a[156:159]
s_waitcnt lgkmcnt(4)
v_mfma_f32_16x16x32_bf16 a[48:51], v[168:171], v[72:75], a[48:51]
ds_read_b64_tr_b16 v[184:185], v20 offset:28800
v_mfma_f32_16x16x32_bf16 a[48:51], v[172:175], v[88:91], a[48:51]
ds_read_b64_tr_b16 v[186:187], v20 offset:32384
v_mfma_f32_16x16x32_bf16 a[52:55], v[168:171], v[76:79], a[52:55]
ds_read_b64_tr_b16 v[188:189], v20 offset:35968
v_mfma_f32_16x16x32_bf16 a[52:55], v[172:175], v[92:95], a[52:55]
ds_read_b64_tr_b16 v[190:191], v20 offset:39552
v_mfma_f32_16x16x32_bf16 a[56:59], v[168:171], v[80:83], a[56:59]
buffer_load_dwordx4 v[164:167], v11, s[12:15], s33 offen offset:1024 sc1
v_mfma_f32_16x16x32_bf16 a[56:59], v[172:175], v[96:99], a[56:59]
s_add_u32 s33, s33, 2048
v_mfma_f32_16x16x32_bf16 a[60:63], v[168:171], v[84:87], a[60:63]
v_mfma_f32_16x16x32_bf16 a[60:63], v[172:175], v[100:103], a[60:63]
s_waitcnt lgkmcnt(4)
v_mfma_f32_16x16x32_bf16 a[160:163], v[176:179], v[72:75], a[160:163]
ds_read_b64_tr_b16 v[192:193], v20 offset:43136
v_mfma_f32_16x16x32_bf16 a[160:163], v[180:183], v[88:91], a[160:163]
ds_read_b64_tr_b16 v[194:195], v20 offset:46720
s_add_u32 m0, s35, 0
v_mfma_f32_16x16x32_bf16 a[164:167], v[176:179], v[76:79], a[164:167]
ds_read_b64_tr_b16 v[196:197], v20 offset:50304
v_mfma_f32_16x16x32_bf16 a[164:167], v[180:183], v[92:95], a[164:167]
ds_read_b64_tr_b16 v[198:199], v20 offset:53888
v_mfma_f32_16x16x32_bf16 a[168:171], v[176:179], v[80:83], a[168:171]
buffer_load_dwordx4 v12, s[16:19], s34 offen offset:0 lds
v_mfma_f32_16x16x32_bf16 a[168:171], v[180:183], v[96:99], a[168:171]
v_mfma_f32_16x16x32_bf16 a[172:175], v[176:179], v[84:87], a[172:175]
v_mfma_f32_16x16x32_bf16 a[172:175], v[180:183], v[100:103], a[172:175]
s_waitcnt lgkmcnt(4)
v_mfma_f32_16x16x32_bf16 a[64:67], v[184:187], v[72:75], a[64:67]
ds_read_b64_tr_b16 v[168:169], v20 offset:28832
v_mfma_f32_16x16x32_bf16 a[64:67], v[188:191], v[88:91], a[64:67]
ds_read_b64_tr_b16 v[170:171], v20 offset:32416
v_mfma_f32_16x16x32_bf16 a[68:71], v[184:187], v[76:79], a[68:71]
ds_read_b64_tr_b16 v[172:173], v20 offset:36000
v_mfma_f32_16x16x32_bf16 a[68:71], v[188:191], v[92:95], a[68:71]
ds_read_b64_tr_b16 v[174:175], v20 offset:39584
v_mfma_f32_16x16x32_bf16 a[72:75], v[184:187], v[80:83], a[72:75]
buffer_load_dwordx4 v13, s[16:19], s34 offen offset:1024 lds
v_mfma_f32_16x16x32_bf16 a[72:75], v[188:191], v[96:99], a[72:75]
v_mfma_f32_16x16x32_bf16 a[76:79], v[184:187], v[84:87], a[76:79]
v_mfma_f32_16x16x32_bf16 a[76:79], v[188:191], v[100:103], a[76:79]
s_waitcnt lgkmcnt(4)
v_mfma_f32_16x16x32_bf16 a[176:179], v[192:195], v[72:75], a[176:179]
ds_read_b64_tr_b16 v[176:177], v20 offset:43168
v_mfma_f32_16x16x32_bf16 a[176:179], v[196:199], v[88:91], a[176:179]
ds_read_b64_tr_b16 v[178:179], v20 offset:46752
v_mfma_f32_16x16x32_bf16 a[180:183], v[192:195], v[76:79], a[180:183]
ds_read_b64_tr_b16 v[180:181], v20 offset:50336
v_mfma_f32_16x16x32_bf16 a[180:183], v[196:199], v[92:95], a[180:183]
ds_read_b64_tr_b16 v[182:183], v20 offset:53920
v_mfma_f32_16x16x32_bf16 a[184:187], v[192:195], v[80:83], a[184:187]
buffer_load_dwordx4 v14, s[16:19], s34 offen offset:2048 lds
v_mfma_f32_16x16x32_bf16 a[184:187], v[196:199], v[96:99], a[184:187]
v_mfma_f32_16x16x32_bf16 a[188:191], v[192:195], v[84:87], a[188:191]
v_mfma_f32_16x16x32_bf16 a[188:191], v[196:199], v[100:103], a[188:191]
s_waitcnt lgkmcnt(4)
v_mfma_f32_16x16x32_bf16 a[80:83], v[168:171], v[72:75], a[80:83]
ds_read_b64_tr_b16 v[184:185], v20 offset:28864
v_mfma_f32_16x16x32_bf16 a[80:83], v[172:175], v[88:91], a[80:83]
buffer_load_dwordx4 v15, s[16:19], s34 offen offset:3072 lds
v_mfma_f32_16x16x32_bf16 a[84:87], v[168:171], v[76:79], a[84:87]
ds_read_b64_tr_b16 v[186:187], v20 offset:32448
v_mfma_f32_16x16x32_bf16 a[84:87], v[172:175], v[92:95], a[84:87]
ds_read_b64_tr_b16 v[188:189], v20 offset:36032
v_mfma_f32_16x16x32_bf16 a[88:91], v[168:171], v[80:83], a[88:91]
ds_read_b64_tr_b16 v[190:191], v20 offset:39616
v_mfma_f32_16x16x32_bf16 a[88:91], v[172:175], v[96:99], a[88:91]
s_add_u32 m0, s35, 4096
v_mfma_f32_16x16x32_bf16 a[92:95], v[168:171], v[84:87], a[92:95]
v_mfma_f32_16x16x32_bf16 a[92:95], v[172:175], v[100:103], a[92:95]
s_waitcnt lgkmcnt(4)
v_mfma_f32_16x16x32_bf16 a[192:195], v[176:179], v[72:75], a[192:195]
buffer_load_dwordx4 v16, s[16:19], s34 offen offset:0 lds
v_mfma_f32_16x16x32_bf16 a[192:195], v[180:183], v[88:91], a[192:195]
ds_read_b64_tr_b16 v[192:193], v20 offset:43200
v_mfma_f32_16x16x32_bf16 a[196:199], v[176:179], v[76:79], a[196:199]
ds_read_b64_tr_b16 v[194:195], v20 offset:46784
v_mfma_f32_16x16x32_bf16 a[196:199], v[180:183], v[92:95], a[196:199]
ds_read_b64_tr_b16 v[196:197], v20 offset:50368
v_mfma_f32_16x16x32_bf16 a[200:203], v[176:179], v[80:83], a[200:203]
ds_read_b64_tr_b16 v[198:199], v20 offset:53952
v_mfma_f32_16x16x32_bf16 a[200:203], v[180:183], v[96:99], a[200:203]
v_mfma_f32_16x16x32_bf16 a[204:207], v[176:179], v[84:87], a[204:207]
v_mfma_f32_16x16x32_bf16 a[204:207], v[180:183], v[100:103], a[204:207]
s_waitcnt vmcnt(28) lgkmcnt(4)
s_barrier
v_mfma_f32_16x16x32_bf16 a[96:99], v[184:187], v[72:75], a[96:99]
buffer_load_dwordx4 v17, s[16:19], s34 offen offset:1024 lds
v_mfma_f32_16x16x32_bf16 a[96:99], v[188:191], v[88:91], a[96:99]
ds_read_b64_tr_b16 v[168:169], v21 offset:0
v_mfma_f32_16x16x32_bf16 a[100:103], v[184:187], v[76:79], a[100:103]
ds_read_b64_tr_b16 v[170:171], v21 offset:3584
v_mfma_f32_16x16x32_bf16 a[100:103], v[188:191], v[92:95], a[100:103]
ds_read_b64_tr_b16 v[172:173], v21 offset:7168
v_mfma_f32_16x16x32_bf16 a[104:107], v[184:187], v[80:83], a[104:107]
ds_read_b64_tr_b16 v[174:175], v21 offset:10752
v_mfma_f32_16x16x32_bf16 a[104:107], v[188:191], v[96:99], a[104:107]
v_mfma_f32_16x16x32_bf16 a[108:111], v[184:187], v[84:87], a[108:111]
buffer_load_dwordx4 v18, s[16:19], s34 offen offset:2048 lds
v_mfma_f32_16x16x32_bf16 a[108:111], v[188:191], v[100:103], a[108:111]
s_add_u32 s34, s34, 458752
s_waitcnt lgkmcnt(4)
v_mfma_f32_16x16x32_bf16 a[208:211], v[192:195], v[72:75], a[208:211]
ds_read_b64_tr_b16 v[176:177], v21 offset:14336
v_mfma_f32_16x16x32_bf16 a[208:211], v[196:199], v[88:91], a[208:211]
ds_read_b64_tr_b16 v[178:179], v21 offset:17920
v_mfma_f32_16x16x32_bf16 a[212:215], v[192:195], v[76:79], a[212:215]
ds_read_b64_tr_b16 v[180:181], v21 offset:21504
v_mfma_f32_16x16x32_bf16 a[212:215], v[196:199], v[92:95], a[212:215]
ds_read_b64_tr_b16 v[182:183], v21 offset:25088
v_mfma_f32_16x16x32_bf16 a[216:219], v[192:195], v[80:83], a[216:219]
v_mfma_f32_16x16x32_bf16 a[216:219], v[196:199], v[96:99], a[216:219]
v_mfma_f32_16x16x32_bf16 a[220:223], v[192:195], v[84:87], a[220:223]
v_mfma_f32_16x16x32_bf16 a[220:223], v[196:199], v[100:103], a[220:223]
s_waitcnt vmcnt(22) lgkmcnt(4)
v_mfma_f32_16x16x32_bf16 a[0:3], v[168:171], v[104:107], a[0:3]
ds_read_b64_tr_b16 v[184:185], v21 offset:32
v_mfma_f32_16x16x32_bf16 a[0:3], v[172:175], v[120:123], a[0:3]
ds_read_b64_tr_b16 v[186:187], v21 offset:3616
v_mfma_f32_16x16x32_bf16 a[4:7], v[168:171], v[108:111], a[4:7]
ds_read_b64_tr_b16 v[188:189], v21 offset:7200
v_mfma_f32_16x16x32_bf16 a[4:7], v[172:175], v[124:127], a[4:7]
ds_read_b64_tr_b16 v[190:191], v21 offset:10784
v_mfma_f32_16x16x32_bf16 a[8:11], v[168:171], v[112:115], a[8:11]
buffer_load_dwordx4 v[40:43], v8, s[12:15], s33 offen offset:0 sc1
v_mfma_f32_16x16x32_bf16 a[8:11], v[172:175], v[128:131], a[8:11]
v_mfma_f32_16x16x32_bf16 a[12:15], v[168:171], v[116:119], a[12:15]
v_mfma_f32_16x16x32_bf16 a[12:15], v[172:175], v[132:135], a[12:15]
s_waitcnt lgkmcnt(4)
v_mfma_f32_16x16x32_bf16 a[112:115], v[176:179], v[104:107], a[112:115]
ds_read_b64_tr_b16 v[192:193], v21 offset:14368
v_mfma_f32_16x16x32_bf16 a[112:115], v[180:183], v[120:123], a[112:115]
buffer_load_dwordx4 v[44:47], v9, s[12:15], s33 offen offset:0 sc1
v_mfma_f32_16x16x32_bf16 a[116:119], v[176:179], v[108:111], a[116:119]
ds_read_b64_tr_b16 v[194:195], v21 offset:17952
v_mfma_f32_16x16x32_bf16 a[116:119], v[180:183], v[124:127], a[116:119]
ds_read_b64_tr_b16 v[196:197], v21 offset:21536
v_mfma_f32_16x16x32_bf16 a[120:123], v[176:179], v[112:115], a[120:123]
ds_read_b64_tr_b16 v[198:199], v21 offset:25120
v_mfma_f32_16x16x32_bf16 a[120:123], v[180:183], v[128:131], a[120:123]
v_mfma_f32_16x16x32_bf16 a[124:127], v[176:179], v[116:119], a[124:127]
v_mfma_f32_16x16x32_bf16 a[124:127], v[180:183], v[132:135], a[124:127]
s_waitcnt lgkmcnt(4)
v_mfma_f32_16x16x32_bf16 a[16:19], v[184:187], v[104:107], a[16:19]
buffer_load_dwordx4 v[48:51], v10, s[12:15], s33 offen offset:0 sc1
v_mfma_f32_16x16x32_bf16 a[16:19], v[188:191], v[120:123], a[16:19]
ds_read_b64_tr_b16 v[168:169], v21 offset:64
v_mfma_f32_16x16x32_bf16 a[20:23], v[184:187], v[108:111], a[20:23]
ds_read_b64_tr_b16 v[170:171], v21 offset:3648
v_mfma_f32_16x16x32_bf16 a[20:23], v[188:191], v[124:127], a[20:23]
ds_read_b64_tr_b16 v[172:173], v21 offset:7232
v_mfma_f32_16x16x32_bf16 a[24:27], v[184:187], v[112:115], a[24:27]
ds_read_b64_tr_b16 v[174:175], v21 offset:10816
v_mfma_f32_16x16x32_bf16 a[24:27], v[188:191], v[128:131], a[24:27]
v_mfma_f32_16x16x32_bf16 a[28:31], v[184:187], v[116:119], a[28:31]
v_mfma_f32_16x16x32_bf16 a[28:31], v[188:191], v[132:135], a[28:31]
s_waitcnt lgkmcnt(4)
v_mfma_f32_16x16x32_bf16 a[128:131], v[192:195], v[104:107], a[128:131]
buffer_load_dwordx4 v[52:55], v11, s[12:15], s33 offen offset:0 sc1
v_mfma_f32_16x16x32_bf16 a[128:131], v[196:199], v[120:123], a[128:131]
ds_read_b64_tr_b16 v[176:177], v21 offset:14400
v_mfma_f32_16x16x32_bf16 a[132:135], v[192:195], v[108:111], a[132:135]
ds_read_b64_tr_b16 v[178:179], v21 offset:17984
v_mfma_f32_16x16x32_bf16 a[132:135], v[196:199], v[124:127], a[132:135]
ds_read_b64_tr_b16 v[180:181], v21 offset:21568
v_mfma_f32_16x16x32_bf16 a[136:139], v[192:195], v[112:115], a[136:139]
ds_read_b64_tr_b16 v[182:183], v21 offset:25152
v_mfma_f32_16x16x32_bf16 a[136:139], v[196:199], v[128:131], a[136:139]
v_mfma_f32_16x16x32_bf16 a[140:143], v[192:195], v[116:119], a[140:143]
buffer_load_dwordx4 v[56:59], v8, s[12:15], s33 offen offset:1024 sc1
v_mfma_f32_16x16x32_bf16 a[140:143], v[196:199], v[132:135], a[140:143]
s_waitcnt lgkmcnt(4)
v_mfma_f32_16x16x32_bf16 a[32:35], v[168:171], v[104:107], a[32:35]
ds_read_b64_tr_b16 v[184:185], v21 offset:96
v_mfma_f32_16x16x32_bf16 a[32:35], v[172:175], v[120:123], a[32:35]
ds_read_b64_tr_b16 v[186:187], v21 offset:3680
v_mfma_f32_16x16x32_bf16 a[36:39], v[168:171], v[108:111], a[36:39]
ds_read_b64_tr_b16 v[188:189], v21 offset:7264
v_mfma_f32_16x16x32_bf16 a[36:39], v[172:175], v[124:127], a[36:39]
ds_read_b64_tr_b16 v[190:191], v21 offset:10848
v_mfma_f32_16x16x32_bf16 a[40:43], v[168:171], v[112:115], a[40:43]
v_mfma_f32_16x16x32_bf16 a[40:43], v[172:175], v[128:131], a[40:43]
buffer_load_dwordx4 v[60:63], v9, s[12:15], s33 offen offset:1024 sc1
v_mfma_f32_16x16x32_bf16 a[44:47], v[168:171], v[116:119], a[44:47]
v_mfma_f32_16x16x32_bf16 a[44:47], v[172:175], v[132:135], a[44:47]
s_waitcnt lgkmcnt(4)
v_mfma_f32_16x16x32_bf16 a[144:147], v[176:179], v[104:107], a[144:147]
ds_read_b64_tr_b16 v[192:193], v21 offset:14432
v_mfma_f32_16x16x32_bf16 a[144:147], v[180:183], v[120:123], a[144:147]
ds_read_b64_tr_b16 v[194:195], v21 offset:18016
v_mfma_f32_16x16x32_bf16 a[148:151], v[176:179], v[108:111], a[148:151]
ds_read_b64_tr_b16 v[196:197], v21 offset:21600
v_mfma_f32_16x16x32_bf16 a[148:151], v[180:183], v[124:127], a[148:151]
ds_read_b64_tr_b16 v[198:199], v21 offset:25184
v_mfma_f32_16x16x32_bf16 a[152:155], v[176:179], v[112:115], a[152:155]
buffer_load_dwordx4 v[64:67], v10, s[12:15], s33 offen offset:1024 sc1
v_mfma_f32_16x16x32_bf16 a[152:155], v[180:183], v[128:131], a[152:155]
v_mfma_f32_16x16x32_bf16 a[156:159], v[176:179], v[116:119], a[156:159]
v_mfma_f32_16x16x32_bf16 a[156:159], v[180:183], v[132:135], a[156:159]
s_waitcnt lgkmcnt(4)
v_mfma_f32_16x16x32_bf16 a[48:51], v[184:187], v[104:107], a[48:51]
ds_read_b64_tr_b16 v[168:169], v21 offset:128
v_mfma_f32_16x16x32_bf16 a[48:51], v[188:191], v[120:123], a[48:51]
ds_read_b64_tr_b16 v[170:171], v21 offset:3712
v_mfma_f32_16x16x32_bf16 a[52:55], v[184:187], v[108:111], a[52:55]
ds_read_b64_tr_b16 v[172:173], v21 offset:7296
v_mfma_f32_16x16x32_bf16 a[52:55], v[188:191], v[124:127], a[52:55]
ds_read_b64_tr_b16 v[174:175], v21 offset:10880
v_mfma_f32_16x16x32_bf16 a[56:59], v[184:187], v[112:115], a[56:59]
buffer_load_dwordx4 v[68:71], v11, s[12:15], s33 offen offset:1024 sc1
v_mfma_f32_16x16x32_bf16 a[56:59], v[188:191], v[128:131], a[56:59]
s_add_u32 s33, s33, 2048
v_mfma_f32_16x16x32_bf16 a[60:63], v[184:187], v[116:119], a[60:63]
v_mfma_f32_16x16x32_bf16 a[60:63], v[188:191], v[132:135], a[60:63]
s_waitcnt lgkmcnt(4)
v_mfma_f32_16x16x32_bf16 a[160:163], v[192:195], v[104:107], a[160:163]
ds_read_b64_tr_b16 v[176:177], v21 offset:14464
v_mfma_f32_16x16x32_bf16 a[160:163], v[196:199], v[120:123], a[160:163]
ds_read_b64_tr_b16 v[178:179], v21 offset:18048
s_add_u32 m0, s35, 28672
v_mfma_f32_16x16x32_bf16 a[164:167], v[192:195], v[108:111], a[164:167]
ds_read_b64_tr_b16 v[180:181], v21 offset:21632
v_mfma_f32_16x16x32_bf16 a[164:167], v[196:199], v[124:127], a[164:167]
ds_read_b64_tr_b16 v[182:183], v21 offset:25216
v_mfma_f32_16x16x32_bf16 a[168:171], v[192:195], v[112:115], a[168:171]
buffer_load_dwordx4 v12, s[16:19], s34 offen offset:0 lds
v_mfma_f32_16x16x32_bf16 a[168:171], v[196:199], v[128:131], a[168:171]
v_mfma_f32_16x16x32_bf16 a[172:175], v[192:195], v[116:119], a[172:175]
v_mfma_f32_16x16x32_bf16 a[172:175], v[196:199], v[132:135], a[172:175]
s_waitcnt lgkmcnt(4)
v_mfma_f32_16x16x32_bf16 a[64:67], v[168:171], v[104:107], a[64:67]
ds_read_b64_tr_b16 v[184:185], v21 offset:160
v_mfma_f32_16x16x32_bf16 a[64:67], v[172:175], v[120:123], a[64:67]
ds_read_b64_tr_b16 v[186:187], v21 offset:3744
v_mfma_f32_16x16x32_bf16 a[68:71], v[168:171], v[108:111], a[68:71]
ds_read_b64_tr_b16 v[188:189], v21 offset:7328
v_mfma_f32_16x16x32_bf16 a[68:71], v[172:175], v[124:127], a[68:71]
ds_read_b64_tr_b16 v[190:191], v21 offset:10912
v_mfma_f32_16x16x32_bf16 a[72:75], v[168:171], v[112:115], a[72:75]
buffer_load_dwordx4 v13, s[16:19], s34 offen offset:1024 lds
v_mfma_f32_16x16x32_bf16 a[72:75], v[172:175], v[128:131], a[72:75]
v_mfma_f32_16x16x32_bf16 a[76:79], v[168:171], v[116:119], a[76:79]
v_mfma_f32_16x16x32_bf16 a[76:79], v[172:175], v[132:135], a[76:79]
s_waitcnt lgkmcnt(4)
v_mfma_f32_16x16x32_bf16 a[176:179], v[176:179], v[104:107], a[176:179]
ds_read_b64_tr_b16 v[192:193], v21 offset:14496
v_mfma_f32_16x16x32_bf16 a[176:179], v[180:183], v[120:123], a[176:179]
ds_read_b64_tr_b16 v[194:195], v21 offset:18080
v_mfma_f32_16x16x32_bf16 a[180:183], v[176:179], v[108:111], a[180:183]
ds_read_b64_tr_b16 v[196:197], v21 offset:21664
v_mfma_f32_16x16x32_bf16 a[180:183], v[180:183], v[124:127], a[180:183]
ds_read_b64_tr_b16 v[198:199], v21 offset:25248
v_mfma_f32_16x16x32_bf16 a[184:187], v[176:179], v[112:115], a[184:187]
buffer_load_dwordx4 v14, s[16:19], s34 offen offset:2048 lds
v_mfma_f32_16x16x32_bf16 a[184:187], v[180:183], v[128:131], a[184:187]
v_mfma_f32_16x16x32_bf16 a[188:191], v[176:179], v[116:119], a[188:191]
v_mfma_f32_16x16x32_bf16 a[188:191], v[180:183], v[132:135], a[188:191]
s_waitcnt lgkmcnt(4)
v_mfma_f32_16x16x32_bf16 a[80:83], v[184:187], v[104:107], a[80:83]
ds_read_b64_tr_b16 v[168:169], v21 offset:192
v_mfma_f32_16x16x32_bf16 a[80:83], v[188:191], v[120:123], a[80:83]
buffer_load_dwordx4 v15, s[16:19], s34 offen offset:3072 lds
v_mfma_f32_16x16x32_bf16 a[84:87], v[184:187], v[108:111], a[84:87]
ds_read_b64_tr_b16 v[170:171], v21 offset:3776
v_mfma_f32_16x16x32_bf16 a[84:87], v[188:191], v[124:127], a[84:87]
ds_read_b64_tr_b16 v[172:173], v21 offset:7360
v_mfma_f32_16x16x32_bf16 a[88:91], v[184:187], v[112:115], a[88:91]
ds_read_b64_tr_b16 v[174:175], v21 offset:10944
v_mfma_f32_16x16x32_bf16 a[88:91], v[188:191], v[128:131], a[88:91]
s_add_u32 m0, s35, 32768
v_mfma_f32_16x16x32_bf16 a[92:95], v[184:187], v[116:119], a[92:95]
v_mfma_f32_16x16x32_bf16 a[92:95], v[188:191], v[132:135], a[92:95]
s_waitcnt lgkmcnt(4)
v_mfma_f32_16x16x32_bf16 a[192:195], v[192:195], v[104:107], a[192:195]
buffer_load_dwordx4 v16, s[16:19], s34 offen offset:0 lds
v_mfma_f32_16x16x32_bf16 a[192:195], v[196:199], v[120:123], a[192:195]
ds_read_b64_tr_b16 v[176:177], v21 offset:14528
v_mfma_f32_16x16x32_bf16 a[196:199], v[192:195], v[108:111], a[196:199]
ds_read_b64_tr_b16 v[178:179], v21 offset:18112
v_mfma_f32_16x16x32_bf16 a[196:199], v[196:199], v[124:127], a[196:199]
ds_read_b64_tr_b16 v[180:181], v21 offset:21696
v_mfma_f32_16x16x32_bf16 a[200:203], v[192:195], v[112:115], a[200:203]
ds_read_b64_tr_b16 v[182:183], v21 offset:25280
v_mfma_f32_16x16x32_bf16 a[200:203], v[196:199], v[128:131], a[200:203]
v_mfma_f32_16x16x32_bf16 a[204:207], v[192:195], v[116:119], a[204:207]
v_mfma_f32_16x16x32_bf16 a[204:207], v[196:199], v[132:135], a[204:207]
s_waitcnt vmcnt(28) lgkmcnt(4)
s_barrier
v_mfma_f32_16x16x32_bf16 a[96:99], v[168:171], v[104:107], a[96:99]
buffer_load_dwordx4 v17, s[16:19], s34 offen offset:1024 lds
v_mfma_f32_16x16x32_bf16 a[96:99], v[172:175], v[120:123], a[96:99]
ds_read_b64_tr_b16 v[184:185], v21 offset:28672
v_mfma_f32_16x16x32_bf16 a[100:103], v[168:171], v[108:111], a[100:103]
ds_read_b64_tr_b16 v[186:187], v21 offset:32256
v_mfma_f32_16x16x32_bf16 a[100:103], v[172:175], v[124:127], a[100:103]
ds_read_b64_tr_b16 v[188:189], v21 offset:35840
v_mfma_f32_16x16x32_bf16 a[104:107], v[168:171], v[112:115], a[104:107]
ds_read_b64_tr_b16 v[190:191], v21 offset:39424
v_mfma_f32_16x16x32_bf16 a[104:107], v[172:175], v[128:131], a[104:107]
v_mfma_f32_16x16x32_bf16 a[108:111], v[168:171], v[116:119], a[108:111]
buffer_load_dwordx4 v18, s[16:19], s34 offen offset:2048 lds
v_mfma_f32_16x16x32_bf16 a[108:111], v[172:175], v[132:135], a[108:111]
s_add_u32 s34, s34, 458752
s_waitcnt lgkmcnt(4)
v_mfma_f32_16x16x32_bf16 a[208:211], v[176:179], v[104:107], a[208:211]
ds_read_b64_tr_b16 v[192:193], v21 offset:43008
v_mfma_f32_16x16x32_bf16 a[208:211], v[180:183], v[120:123], a[208:211]
ds_read_b64_tr_b16 v[194:195], v21 offset:46592
v_mfma_f32_16x16x32_bf16 a[212:215], v[176:179], v[108:111], a[212:215]
ds_read_b64_tr_b16 v[196:197], v21 offset:50176
v_mfma_f32_16x16x32_bf16 a[212:215], v[180:183], v[124:127], a[212:215]
ds_read_b64_tr_b16 v[198:199], v21 offset:53760
v_mfma_f32_16x16x32_bf16 a[216:219], v[176:179], v[112:115], a[216:219]
v_mfma_f32_16x16x32_bf16 a[216:219], v[180:183], v[128:131], a[216:219]
v_mfma_f32_16x16x32_bf16 a[220:223], v[176:179], v[116:119], a[220:223]
v_mfma_f32_16x16x32_bf16 a[220:223], v[180:183], v[132:135], a[220:223]
s_waitcnt vmcnt(22) lgkmcnt(4)
v_mfma_f32_16x16x32_bf16 a[0:3], v[184:187], v[136:139], a[0:3]
ds_read_b64_tr_b16 v[168:169], v21 offset:28704
v_mfma_f32_16x16x32_bf16 a[0:3], v[188:191], v[152:155], a[0:3]
ds_read_b64_tr_b16 v[170:171], v21 offset:32288
v_mfma_f32_16x16x32_bf16 a[4:7], v[184:187], v[140:143], a[4:7]
ds_read_b64_tr_b16 v[172:173], v21 offset:35872
v_mfma_f32_16x16x32_bf16 a[4:7], v[188:191], v[156:159], a[4:7]
ds_read_b64_tr_b16 v[174:175], v21 offset:39456
v_mfma_f32_16x16x32_bf16 a[8:11], v[184:187], v[144:147], a[8:11]
buffer_load_dwordx4 v[72:75], v8, s[12:15], s33 offen offset:0 sc1
v_mfma_f32_16x16x32_bf16 a[8:11], v[188:191], v[160:163], a[8:11]
v_mfma_f32_16x16x32_bf16 a[12:15], v[184:187], v[148:151], a[12:15]
v_mfma_f32_16x16x32_bf16 a[12:15], v[188:191], v[164:167], a[12:15]
s_waitcnt lgkmcnt(4)
v_mfma_f32_16x16x32_bf16 a[112:115], v[192:195], v[136:139], a[112:115]
ds_read_b64_tr_b16 v[176:177], v21 offset:43040
v_mfma_f32_16x16x32_bf16 a[112:115], v[196:199], v[152:155], a[112:115]
buffer_load_dwordx4 v[76:79], v9, s[12:15], s33 offen offset:0 sc1
v_mfma_f32_16x16x32_bf16 a[116:119], v[192:195], v[140:143], a[116:119]
ds_read_b64_tr_b16 v[178:179], v21 offset:46624
v_mfma_f32_16x16x32_bf16 a[116:119], v[196:199], v[156:159], a[116:119]
ds_read_b64_tr_b16 v[180:181], v21 offset:50208
v_mfma_f32_16x16x32_bf16 a[120:123], v[192:195], v[144:147], a[120:123]
ds_read_b64_tr_b16 v[182:183], v21 offset:53792
v_mfma_f32_16x16x32_bf16 a[120:123], v[196:199], v[160:163], a[120:123]
v_mfma_f32_16x16x32_bf16 a[124:127], v[192:195], v[148:151], a[124:127]
v_mfma_f32_16x16x32_bf16 a[124:127], v[196:199], v[164:167], a[124:127]
s_waitcnt lgkmcnt(4)
v_mfma_f32_16x16x32_bf16 a[16:19], v[168:171], v[136:139], a[16:19]
buffer_load_dwordx4 v[80:83], v10, s[12:15], s33 offen offset:0 sc1
v_mfma_f32_16x16x32_bf16 a[16:19], v[172:175], v[152:155], a[16:19]
ds_read_b64_tr_b16 v[184:185], v21 offset:28736
v_mfma_f32_16x16x32_bf16 a[20:23], v[168:171], v[140:143], a[20:23]
ds_read_b64_tr_b16 v[186:187], v21 offset:32320
v_mfma_f32_16x16x32_bf16 a[20:23], v[172:175], v[156:159], a[20:23]
ds_read_b64_tr_b16 v[188:189], v21 offset:35904
v_mfma_f32_16x16x32_bf16 a[24:27], v[168:171], v[144:147], a[24:27]
ds_read_b64_tr_b16 v[190:191], v21 offset:39488
v_mfma_f32_16x16x32_bf16 a[24:27], v[172:175], v[160:163], a[24:27]
v_mfma_f32_16x16x32_bf16 a[28:31], v[168:171], v[148:151], a[28:31]
v_mfma_f32_16x16x32_bf16 a[28:31], v[172:175], v[164:167], a[28:31]
s_waitcnt lgkmcnt(4)
v_mfma_f32_16x16x32_bf16 a[128:131], v[176:179], v[136:139], a[128:131]
buffer_load_dwordx4 v[84:87], v11, s[12:15], s33 offen offset:0 sc1
v_mfma_f32_16x16x32_bf16 a[128:131], v[180:183], v[152:155], a[128:131]
ds_read_b64_tr_b16 v[192:193], v21 offset:43072
v_mfma_f32_16x16x32_bf16 a[132:135], v[176:179], v[140:143], a[132:135]
ds_read_b64_tr_b16 v[194:195], v21 offset:46656
v_mfma_f32_16x16x32_bf16 a[132:135], v[180:183], v[156:159], a[132:135]
ds_read_b64_tr_b16 v[196:197], v21 offset:50240
v_mfma_f32_16x16x32_bf16 a[136:139], v[176:179], v[144:147], a[136:139]
ds_read_b64_tr_b16 v[198:199], v21 offset:53824
v_mfma_f32_16x16x32_bf16 a[136:139], v[180:183], v[160:163], a[136:139]
v_mfma_f32_16x16x32_bf16 a[140:143], v[176:179], v[148:151], a[140:143]
buffer_load_dwordx4 v[88:91], v8, s[12:15], s33 offen offset:1024 sc1
v_mfma_f32_16x16x32_bf16 a[140:143], v[180:183], v[164:167], a[140:143]
s_waitcnt lgkmcnt(4)
v_mfma_f32_16x16x32_bf16 a[32:35], v[184:187], v[136:139], a[32:35]
ds_read_b64_tr_b16 v[168:169], v21 offset:28768
v_mfma_f32_16x16x32_bf16 a[32:35], v[188:191], v[152:155], a[32:35]
ds_read_b64_tr_b16 v[170:171], v21 offset:32352
v_mfma_f32_16x16x32_bf16 a[36:39], v[184:187], v[140:143], a[36:39]
ds_read_b64_tr_b16 v[172:173], v21 offset:35936
v_mfma_f32_16x16x32_bf16 a[36:39], v[188:191], v[156:159], a[36:39]
ds_read_b64_tr_b16 v[174:175], v21 offset:39520
v_mfma_f32_16x16x32_bf16 a[40:43], v[184:187], v[144:147], a[40:43]
v_mfma_f32_16x16x32_bf16 a[40:43], v[188:191], v[160:163], a[40:43]
buffer_load_dwordx4 v[92:95], v9, s[12:15], s33 offen offset:1024 sc1
v_mfma_f32_16x16x32_bf16 a[44:47], v[184:187], v[148:151], a[44:47]
v_mfma_f32_16x16x32_bf16 a[44:47], v[188:191], v[164:167], a[44:47]
s_waitcnt lgkmcnt(4)
v_mfma_f32_16x16x32_bf16 a[144:147], v[192:195], v[136:139], a[144:147]
ds_read_b64_tr_b16 v[176:177], v21 offset:43104
v_mfma_f32_16x16x32_bf16 a[144:147], v[196:199], v[152:155], a[144:147]
ds_read_b64_tr_b16 v[178:179], v21 offset:46688
v_mfma_f32_16x16x32_bf16 a[148:151], v[192:195], v[140:143], a[148:151]
ds_read_b64_tr_b16 v[180:181], v21 offset:50272
v_mfma_f32_16x16x32_bf16 a[148:151], v[196:199], v[156:159], a[148:151]
ds_read_b64_tr_b16 v[182:183], v21 offset:53856
v_mfma_f32_16x16x32_bf16 a[152:155], v[192:195], v[144:147], a[152:155]
buffer_load_dwordx4 v[96:99], v10, s[12:15], s33 offen offset:1024 sc1
v_mfma_f32_16x16x32_bf16 a[152:155], v[196:199], v[160:163], a[152:155]
v_mfma_f32_16x16x32_bf16 a[156:159], v[192:195], v[148:151], a[156:159]
v_mfma_f32_16x16x32_bf16 a[156:159], v[196:199], v[164:167], a[156:159]
s_waitcnt lgkmcnt(4)
v_mfma_f32_16x16x32_bf16 a[48:51], v[168:171], v[136:139], a[48:51]
ds_read_b64_tr_b16 v[184:185], v21 offset:28800
v_mfma_f32_16x16x32_bf16 a[48:51], v[172:175], v[152:155], a[48:51]
ds_read_b64_tr_b16 v[186:187], v21 offset:32384
v_mfma_f32_16x16x32_bf16 a[52:55], v[168:171], v[140:143], a[52:55]
ds_read_b64_tr_b16 v[188:189], v21 offset:35968
v_mfma_f32_16x16x32_bf16 a[52:55], v[172:175], v[156:159], a[52:55]
ds_read_b64_tr_b16 v[190:191], v21 offset:39552
v_mfma_f32_16x16x32_bf16 a[56:59], v[168:171], v[144:147], a[56:59]
buffer_load_dwordx4 v[100:103], v11, s[12:15], s33 offen offset:1024 sc1
v_mfma_f32_16x16x32_bf16 a[56:59], v[172:175], v[160:163], a[56:59]
s_add_u32 s33, s33, 2048
v_mfma_f32_16x16x32_bf16 a[60:63], v[168:171], v[148:151], a[60:63]
v_mfma_f32_16x16x32_bf16 a[60:63], v[172:175], v[164:167], a[60:63]
s_waitcnt lgkmcnt(4)
v_mfma_f32_16x16x32_bf16 a[160:163], v[176:179], v[136:139], a[160:163]
ds_read_b64_tr_b16 v[192:193], v21 offset:43136
v_mfma_f32_16x16x32_bf16 a[160:163], v[180:183], v[152:155], a[160:163]
ds_read_b64_tr_b16 v[194:195], v21 offset:46720
s_add_u32 m0, s35, 57344
v_mfma_f32_16x16x32_bf16 a[164:167], v[176:179], v[140:143], a[164:167]
ds_read_b64_tr_b16 v[196:197], v21 offset:50304
v_mfma_f32_16x16x32_bf16 a[164:167], v[180:183], v[156:159], a[164:167]
ds_read_b64_tr_b16 v[198:199], v21 offset:53888
v_mfma_f32_16x16x32_bf16 a[168:171], v[176:179], v[144:147], a[168:171]
buffer_load_dwordx4 v12, s[16:19], s34 offen offset:0 lds
v_mfma_f32_16x16x32_bf16 a[168:171], v[180:183], v[160:163], a[168:171]
v_mfma_f32_16x16x32_bf16 a[172:175], v[176:179], v[148:151], a[172:175]
v_mfma_f32_16x16x32_bf16 a[172:175], v[180:183], v[164:167], a[172:175]
s_waitcnt lgkmcnt(4)
v_mfma_f32_16x16x32_bf16 a[64:67], v[184:187], v[136:139], a[64:67]
ds_read_b64_tr_b16 v[168:169], v21 offset:28832
v_mfma_f32_16x16x32_bf16 a[64:67], v[188:191], v[152:155], a[64:67]
ds_read_b64_tr_b16 v[170:171], v21 offset:32416
v_mfma_f32_16x16x32_bf16 a[68:71], v[184:187], v[140:143], a[68:71]
ds_read_b64_tr_b16 v[172:173], v21 offset:36000
v_mfma_f32_16x16x32_bf16 a[68:71], v[188:191], v[156:159], a[68:71]
ds_read_b64_tr_b16 v[174:175], v21 offset:39584
v_mfma_f32_16x16x32_bf16 a[72:75], v[184:187], v[144:147], a[72:75]
buffer_load_dwordx4 v13, s[16:19], s34 offen offset:1024 lds
v_mfma_f32_16x16x32_bf16 a[72:75], v[188:191], v[160:163], a[72:75]
v_mfma_f32_16x16x32_bf16 a[76:79], v[184:187], v[148:151], a[76:79]
v_mfma_f32_16x16x32_bf16 a[76:79], v[188:191], v[164:167], a[76:79]
s_waitcnt lgkmcnt(4)
v_mfma_f32_16x16x32_bf16 a[176:179], v[192:195], v[136:139], a[176:179]
ds_read_b64_tr_b16 v[176:177], v21 offset:43168
v_mfma_f32_16x16x32_bf16 a[176:179], v[196:199], v[152:155], a[176:179]
ds_read_b64_tr_b16 v[178:179], v21 offset:46752
v_mfma_f32_16x16x32_bf16 a[180:183], v[192:195], v[140:143], a[180:183]
ds_read_b64_tr_b16 v[180:181], v21 offset:50336
v_mfma_f32_16x16x32_bf16 a[180:183], v[196:199], v[156:159], a[180:183]
ds_read_b64_tr_b16 v[182:183], v21 offset:53920
v_mfma_f32_16x16x32_bf16 a[184:187], v[192:195], v[144:147], a[184:187]
buffer_load_dwordx4 v14, s[16:19], s34 offen offset:2048 lds
v_mfma_f32_16x16x32_bf16 a[184:187], v[196:199], v[160:163], a[184:187]
v_mfma_f32_16x16x32_bf16 a[188:191], v[192:195], v[148:151], a[188:191]
v_mfma_f32_16x16x32_bf16 a[188:191], v[196:199], v[164:167], a[188:191]
s_waitcnt lgkmcnt(4)
v_mfma_f32_16x16x32_bf16 a[80:83], v[168:171], v[136:139], a[80:83]
ds_read_b64_tr_b16 v[184:185], v21 offset:28864
v_mfma_f32_16x16x32_bf16 a[80:83], v[172:175], v[152:155], a[80:83]
buffer_load_dwordx4 v15, s[16:19], s34 offen offset:3072 lds
v_mfma_f32_16x16x32_bf16 a[84:87], v[168:171], v[140:143], a[84:87]
ds_read_b64_tr_b16 v[186:187], v21 offset:32448
v_mfma_f32_16x16x32_bf16 a[84:87], v[172:175], v[156:159], a[84:87]
ds_read_b64_tr_b16 v[188:189], v21 offset:36032
v_mfma_f32_16x16x32_bf16 a[88:91], v[168:171], v[144:147], a[88:91]
ds_read_b64_tr_b16 v[190:191], v21 offset:39616
v_mfma_f32_16x16x32_bf16 a[88:91], v[172:175], v[160:163], a[88:91]
s_add_u32 m0, s35, 61440
v_mfma_f32_16x16x32_bf16 a[92:95], v[168:171], v[148:151], a[92:95]
v_mfma_f32_16x16x32_bf16 a[92:95], v[172:175], v[164:167], a[92:95]
s_waitcnt lgkmcnt(4)
v_mfma_f32_16x16x32_bf16 a[192:195], v[176:179], v[136:139], a[192:195]
buffer_load_dwordx4 v16, s[16:19], s34 offen offset:0 lds
v_mfma_f32_16x16x32_bf16 a[192:195], v[180:183], v[152:155], a[192:195]
ds_read_b64_tr_b16 v[192:193], v21 offset:43200
v_mfma_f32_16x16x32_bf16 a[196:199], v[176:179], v[140:143], a[196:199]
ds_read_b64_tr_b16 v[194:195], v21 offset:46784
v_mfma_f32_16x16x32_bf16 a[196:199], v[180:183], v[156:159], a[196:199]
ds_read_b64_tr_b16 v[196:197], v21 offset:50368
v_mfma_f32_16x16x32_bf16 a[200:203], v[176:179], v[144:147], a[200:203]
ds_read_b64_tr_b16 v[198:199], v21 offset:53952
v_mfma_f32_16x16x32_bf16 a[200:203], v[180:183], v[160:163], a[200:203]
v_mfma_f32_16x16x32_bf16 a[204:207], v[176:179], v[148:151], a[204:207]
v_mfma_f32_16x16x32_bf16 a[204:207], v[180:183], v[164:167], a[204:207]
s_waitcnt vmcnt(28) lgkmcnt(4)
s_barrier
v_mfma_f32_16x16x32_bf16 a[96:99], v[184:187], v[136:139], a[96:99]
buffer_load_dwordx4 v17, s[16:19], s34 offen offset:1024 lds
v_mfma_f32_16x16x32_bf16 a[96:99], v[188:191], v[152:155], a[96:99]
ds_read_b64_tr_b16 v[168:169], v20 offset:0
v_mfma_f32_16x16x32_bf16 a[100:103], v[184:187], v[140:143], a[100:103]
ds_read_b64_tr_b16 v[170:171], v20 offset:3584
v_mfma_f32_16x16x32_bf16 a[100:103], v[188:191], v[156:159], a[100:103]
ds_read_b64_tr_b16 v[172:173], v20 offset:7168
v_mfma_f32_16x16x32_bf16 a[104:107], v[184:187], v[144:147], a[104:107]
ds_read_b64_tr_b16 v[174:175], v20 offset:10752
v_mfma_f32_16x16x32_bf16 a[104:107], v[188:191], v[160:163], a[104:107]
v_mfma_f32_16x16x32_bf16 a[108:111], v[184:187], v[148:151], a[108:111]
buffer_load_dwordx4 v18, s[16:19], s34 offen offset:2048 lds
v_mfma_f32_16x16x32_bf16 a[108:111], v[188:191], v[164:167], a[108:111]
s_add_u32 s34, s34, 458752
s_waitcnt lgkmcnt(4)
v_mfma_f32_16x16x32_bf16 a[208:211], v[192:195], v[136:139], a[208:211]
ds_read_b64_tr_b16 v[176:177], v20 offset:14336
v_mfma_f32_16x16x32_bf16 a[208:211], v[196:199], v[152:155], a[208:211]
ds_read_b64_tr_b16 v[178:179], v20 offset:17920
v_mfma_f32_16x16x32_bf16 a[212:215], v[192:195], v[140:143], a[212:215]
ds_read_b64_tr_b16 v[180:181], v20 offset:21504
v_mfma_f32_16x16x32_bf16 a[212:215], v[196:199], v[156:159], a[212:215]
ds_read_b64_tr_b16 v[182:183], v20 offset:25088
v_mfma_f32_16x16x32_bf16 a[216:219], v[192:195], v[144:147], a[216:219]
v_mfma_f32_16x16x32_bf16 a[216:219], v[196:199], v[160:163], a[216:219]
v_mfma_f32_16x16x32_bf16 a[220:223], v[192:195], v[148:151], a[220:223]
v_mfma_f32_16x16x32_bf16 a[220:223], v[196:199], v[164:167], a[220:223]
s_sub_u32 s36, s36, 1
s_cmp_lg_u32 s36, 0
s_cbranch_scc1 L_attn_kernel_gu_loop
s_waitcnt vmcnt(22) lgkmcnt(4)
v_mfma_f32_16x16x32_bf16 a[0:3], v[168:171], v[40:43], a[0:3]
ds_read_b64_tr_b16 v[184:185], v20 offset:32
v_mfma_f32_16x16x32_bf16 a[0:3], v[172:175], v[56:59], a[0:3]
ds_read_b64_tr_b16 v[186:187], v20 offset:3616
v_mfma_f32_16x16x32_bf16 a[4:7], v[168:171], v[44:47], a[4:7]
ds_read_b64_tr_b16 v[188:189], v20 offset:7200
v_mfma_f32_16x16x32_bf16 a[4:7], v[172:175], v[60:63], a[4:7]
ds_read_b64_tr_b16 v[190:191], v20 offset:10784
v_mfma_f32_16x16x32_bf16 a[8:11], v[168:171], v[48:51], a[8:11]
buffer_load_dwordx4 v[104:107], v8, s[12:15], s33 offen offset:0 sc1
v_mfma_f32_16x16x32_bf16 a[8:11], v[172:175], v[64:67], a[8:11]
v_mfma_f32_16x16x32_bf16 a[12:15], v[168:171], v[52:55], a[12:15]
v_mfma_f32_16x16x32_bf16 a[12:15], v[172:175], v[68:71], a[12:15]
s_waitcnt lgkmcnt(4)
v_mfma_f32_16x16x32_bf16 a[112:115], v[176:179], v[40:43], a[112:115]
ds_read_b64_tr_b16 v[192:193], v20 offset:14368
v_mfma_f32_16x16x32_bf16 a[112:115], v[180:183], v[56:59], a[112:115]
buffer_load_dwordx4 v[108:111], v9, s[12:15], s33 offen offset:0 sc1
v_mfma_f32_16x16x32_bf16 a[116:119], v[176:179], v[44:47], a[116:119]
ds_read_b64_tr_b16 v[194:195], v20 offset:17952
v_mfma_f32_16x16x32_bf16 a[116:119], v[180:183], v[60:63], a[116:119]
ds_read_b64_tr_b16 v[196:197], v20 offset:21536
v_mfma_f32_16x16x32_bf16 a[120:123], v[176:179], v[48:51], a[120:123]
ds_read_b64_tr_b16 v[198:199], v20 offset:25120
v_mfma_f32_16x16x32_bf16 a[120:123], v[180:183], v[64:67], a[120:123]
v_mfma_f32_16x16x32_bf16 a[124:127], v[176:179], v[52:55], a[124:127]
v_mfma_f32_16x16x32_bf16 a[124:127], v[180:183], v[68:71], a[124:127]
s_waitcnt lgkmcnt(4)
v_mfma_f32_16x16x32_bf16 a[16:19], v[184:187], v[40:43], a[16:19]
buffer_load_dwordx4 v[112:115], v10, s[12:15], s33 offen offset:0 sc1
v_mfma_f32_16x16x32_bf16 a[16:19], v[188:191], v[56:59], a[16:19]
ds_read_b64_tr_b16 v[168:169], v20 offset:64
v_mfma_f32_16x16x32_bf16 a[20:23], v[184:187], v[44:47], a[20:23]
ds_read_b64_tr_b16 v[170:171], v20 offset:3648
v_mfma_f32_16x16x32_bf16 a[20:23], v[188:191], v[60:63], a[20:23]
ds_read_b64_tr_b16 v[172:173], v20 offset:7232
v_mfma_f32_16x16x32_bf16 a[24:27], v[184:187], v[48:51], a[24:27]
ds_read_b64_tr_b16 v[174:175], v20 offset:10816
v_mfma_f32_16x16x32_bf16 a[24:27], v[188:191], v[64:67], a[24:27]
v_mfma_f32_16x16x32_bf16 a[28:31], v[184:187], v[52:55], a[28:31]
v_mfma_f32_16x16x32_bf16 a[28:31], v[188:191], v[68:71], a[28:31]
s_waitcnt lgkmcnt(4)
v_mfma_f32_16x16x32_bf16 a[128:131], v[192:195], v[40:43], a[128:131]
buffer_load_dwordx4 v[116:119], v11, s[12:15], s33 offen offset:0 sc1
v_mfma_f32_16x16x32_bf16 a[128:131], v[196:199], v[56:59], a[128:131]
ds_read_b64_tr_b16 v[176:177], v20 offset:14400
v_mfma_f32_16x16x32_bf16 a[132:135], v[192:195], v[44:47], a[132:135]
ds_read_b64_tr_b16 v[178:179], v20 offset:17984
v_mfma_f32_16x16x32_bf16 a[132:135], v[196:199], v[60:63], a[132:135]
ds_read_b64_tr_b16 v[180:181], v20 offset:21568
v_mfma_f32_16x16x32_bf16 a[136:139], v[192:195], v[48:51], a[136:139]
ds_read_b64_tr_b16 v[182:183], v20 offset:25152
v_mfma_f32_16x16x32_bf16 a[136:139], v[196:199], v[64:67], a[136:139]
v_mfma_f32_16x16x32_bf16 a[140:143], v[192:195], v[52:55], a[140:143]
buffer_load_dwordx4 v[120:123], v8, s[12:15], s33 offen offset:1024 sc1
v_mfma_f32_16x16x32_bf16 a[140:143], v[196:199], v[68:71], a[140:143]
s_waitcnt lgkmcnt(4)
v_mfma_f32_16x16x32_bf16 a[32:35], v[168:171], v[40:43], a[32:35]
ds_read_b64_tr_b16 v[184:185], v20 offset:96
v_mfma_f32_16x16x32_bf16 a[32:35], v[172:175], v[56:59], a[32:35]
ds_read_b64_tr_b16 v[186:187], v20 offset:3680
v_mfma_f32_16x16x32_bf16 a[36:39], v[168:171], v[44:47], a[36:39]
ds_read_b64_tr_b16 v[188:189], v20 offset:7264
v_mfma_f32_16x16x32_bf16 a[36:39], v[172:175], v[60:63], a[36:39]
ds_read_b64_tr_b16 v[190:191], v20 offset:10848
v_mfma_f32_16x16x32_bf16 a[40:43], v[168:171], v[48:51], a[40:43]
v_mfma_f32_16x16x32_bf16 a[40:43], v[172:175], v[64:67], a[40:43]
buffer_load_dwordx4 v[124:127], v9, s[12:15], s33 offen offset:1024 sc1
v_mfma_f32_16x16x32_bf16 a[44:47], v[168:171], v[52:55], a[44:47]
v_mfma_f32_16x16x32_bf16 a[44:47], v[172:175], v[68:71], a[44:47]
s_waitcnt lgkmcnt(4)
v_mfma_f32_16x16x32_bf16 a[144:147], v[176:179], v[40:43], a[144:147]
ds_read_b64_tr_b16 v[192:193], v20 offset:14432
v_mfma_f32_16x16x32_bf16 a[144:147], v[180:183], v[56:59], a[144:147]
ds_read_b64_tr_b16 v[194:195], v20 offset:18016
v_mfma_f32_16x16x32_bf16 a[148:151], v[176:179], v[44:47], a[148:151]
ds_read_b64_tr_b16 v[196:197], v20 offset:21600
v_mfma_f32_16x16x32_bf16 a[148:151], v[180:183], v[60:63], a[148:151]
ds_read_b64_tr_b16 v[198:199], v20 offset:25184
v_mfma_f32_16x16x32_bf16 a[152:155], v[176:179], v[48:51], a[152:155]
buffer_load_dwordx4 v[128:131], v10, s[12:15], s33 offen offset:1024 sc1
v_mfma_f32_16x16x32_bf16 a[152:155], v[180:183], v[64:67], a[152:155]
v_mfma_f32_16x16x32_bf16 a[156:159], v[176:179], v[52:55], a[156:159]
v_mfma_f32_16x16x32_bf16 a[156:159], v[180:183], v[68:71], a[156:159]
s_waitcnt lgkmcnt(4)
v_mfma_f32_16x16x32_bf16 a[48:51], v[184:187], v[40:43], a[48:51]
ds_read_b64_tr_b16 v[168:169], v20 offset:128
v_mfma_f32_16x16x32_bf16 a[48:51], v[188:191], v[56:59], a[48:51]
ds_read_b64_tr_b16 v[170:171], v20 offset:3712
v_mfma_f32_16x16x32_bf16 a[52:55], v[184:187], v[44:47], a[52:55]
ds_read_b64_tr_b16 v[172:173], v20 offset:7296
v_mfma_f32_16x16x32_bf16 a[52:55], v[188:191], v[60:63], a[52:55]
ds_read_b64_tr_b16 v[174:175], v20 offset:10880
v_mfma_f32_16x16x32_bf16 a[56:59], v[184:187], v[48:51], a[56:59]
buffer_load_dwordx4 v[132:135], v11, s[12:15], s33 offen offset:1024 sc1
v_mfma_f32_16x16x32_bf16 a[56:59], v[188:191], v[64:67], a[56:59]
s_add_u32 s33, s33, 2048
v_mfma_f32_16x16x32_bf16 a[60:63], v[184:187], v[52:55], a[60:63]
v_mfma_f32_16x16x32_bf16 a[60:63], v[188:191], v[68:71], a[60:63]
s_waitcnt lgkmcnt(4)
v_mfma_f32_16x16x32_bf16 a[160:163], v[192:195], v[40:43], a[160:163]
ds_read_b64_tr_b16 v[176:177], v20 offset:14464
v_mfma_f32_16x16x32_bf16 a[160:163], v[196:199], v[56:59], a[160:163]
ds_read_b64_tr_b16 v[178:179], v20 offset:18048
s_add_u32 m0, s35, 86016
v_mfma_f32_16x16x32_bf16 a[164:167], v[192:195], v[44:47], a[164:167]
ds_read_b64_tr_b16 v[180:181], v20 offset:21632
v_mfma_f32_16x16x32_bf16 a[164:167], v[196:199], v[60:63], a[164:167]
ds_read_b64_tr_b16 v[182:183], v20 offset:25216
v_mfma_f32_16x16x32_bf16 a[168:171], v[192:195], v[48:51], a[168:171]
buffer_load_dwordx4 v12, s[16:19], s34 offen offset:0 lds
v_mfma_f32_16x16x32_bf16 a[168:171], v[196:199], v[64:67], a[168:171]
v_mfma_f32_16x16x32_bf16 a[172:175], v[192:195], v[52:55], a[172:175]
v_mfma_f32_16x16x32_bf16 a[172:175], v[196:199], v[68:71], a[172:175]
s_waitcnt lgkmcnt(4)
v_mfma_f32_16x16x32_bf16 a[64:67], v[168:171], v[40:43], a[64:67]
ds_read_b64_tr_b16 v[184:185], v20 offset:160
v_mfma_f32_16x16x32_bf16 a[64:67], v[172:175], v[56:59], a[64:67]
ds_read_b64_tr_b16 v[186:187], v20 offset:3744
v_mfma_f32_16x16x32_bf16 a[68:71], v[168:171], v[44:47], a[68:71]
ds_read_b64_tr_b16 v[188:189], v20 offset:7328
v_mfma_f32_16x16x32_bf16 a[68:71], v[172:175], v[60:63], a[68:71]
ds_read_b64_tr_b16 v[190:191], v20 offset:10912
v_mfma_f32_16x16x32_bf16 a[72:75], v[168:171], v[48:51], a[72:75]
buffer_load_dwordx4 v13, s[16:19], s34 offen offset:1024 lds
v_mfma_f32_16x16x32_bf16 a[72:75], v[172:175], v[64:67], a[72:75]
v_mfma_f32_16x16x32_bf16 a[76:79], v[168:171], v[52:55], a[76:79]
v_mfma_f32_16x16x32_bf16 a[76:79], v[172:175], v[68:71], a[76:79]
s_waitcnt lgkmcnt(4)
v_mfma_f32_16x16x32_bf16 a[176:179], v[176:179], v[40:43], a[176:179]
ds_read_b64_tr_b16 v[192:193], v20 offset:14496
v_mfma_f32_16x16x32_bf16 a[176:179], v[180:183], v[56:59], a[176:179]
ds_read_b64_tr_b16 v[194:195], v20 offset:18080
v_mfma_f32_16x16x32_bf16 a[180:183], v[176:179], v[44:47], a[180:183]
ds_read_b64_tr_b16 v[196:197], v20 offset:21664
v_mfma_f32_16x16x32_bf16 a[180:183], v[180:183], v[60:63], a[180:183]
ds_read_b64_tr_b16 v[198:199], v20 offset:25248
v_mfma_f32_16x16x32_bf16 a[184:187], v[176:179], v[48:51], a[184:187]
buffer_load_dwordx4 v14, s[16:19], s34 offen offset:2048 lds
v_mfma_f32_16x16x32_bf16 a[184:187], v[180:183], v[64:67], a[184:187]
v_mfma_f32_16x16x32_bf16 a[188:191], v[176:179], v[52:55], a[188:191]
v_mfma_f32_16x16x32_bf16 a[188:191], v[180:183], v[68:71], a[188:191]
s_waitcnt lgkmcnt(4)
v_mfma_f32_16x16x32_bf16 a[80:83], v[184:187], v[40:43], a[80:83]
ds_read_b64_tr_b16 v[168:169], v20 offset:192
v_mfma_f32_16x16x32_bf16 a[80:83], v[188:191], v[56:59], a[80:83]
buffer_load_dwordx4 v15, s[16:19], s34 offen offset:3072 lds
v_mfma_f32_16x16x32_bf16 a[84:87], v[184:187], v[44:47], a[84:87]
ds_read_b64_tr_b16 v[170:171], v20 offset:3776
v_mfma_f32_16x16x32_bf16 a[84:87], v[188:191], v[60:63], a[84:87]
ds_read_b64_tr_b16 v[172:173], v20 offset:7360
v_mfma_f32_16x16x32_bf16 a[88:91], v[184:187], v[48:51], a[88:91]
ds_read_b64_tr_b16 v[174:175], v20 offset:10944
v_mfma_f32_16x16x32_bf16 a[88:91], v[188:191], v[64:67], a[88:91]
s_add_u32 m0, s35, 90112
v_mfma_f32_16x16x32_bf16 a[92:95], v[184:187], v[52:55], a[92:95]
v_mfma_f32_16x16x32_bf16 a[92:95], v[188:191], v[68:71], a[92:95]
s_waitcnt lgkmcnt(4)
v_mfma_f32_16x16x32_bf16 a[192:195], v[192:195], v[40:43], a[192:195]
buffer_load_dwordx4 v16, s[16:19], s34 offen offset:0 lds
v_mfma_f32_16x16x32_bf16 a[192:195], v[196:199], v[56:59], a[192:195]
ds_read_b64_tr_b16 v[176:177], v20 offset:14528
v_mfma_f32_16x16x32_bf16 a[196:199], v[192:195], v[44:47], a[196:199]
ds_read_b64_tr_b16 v[178:179], v20 offset:18112
v_mfma_f32_16x16x32_bf16 a[196:199], v[196:199], v[60:63], a[196:199]
ds_read_b64_tr_b16 v[180:181], v20 offset:21696
v_mfma_f32_16x16x32_bf16 a[200:203], v[192:195], v[48:51], a[200:203]
ds_read_b64_tr_b16 v[182:183], v20 offset:25280
v_mfma_f32_16x16x32_bf16 a[200:203], v[196:199], v[64:67], a[200:203]
v_mfma_f32_16x16x32_bf16 a[204:207], v[192:195], v[52:55], a[204:207]
v_mfma_f32_16x16x32_bf16 a[204:207], v[196:199], v[68:71], a[204:207]
s_waitcnt vmcnt(28) lgkmcnt(4)
s_barrier
v_mfma_f32_16x16x32_bf16 a[96:99], v[168:171], v[40:43], a[96:99]
buffer_load_dwordx4 v17, s[16:19], s34 offen offset:1024 lds
v_mfma_f32_16x16x32_bf16 a[96:99], v[172:175], v[56:59], a[96:99]
ds_read_b64_tr_b16 v[184:185], v20 offset:28672
v_mfma_f32_16x16x32_bf16 a[100:103], v[168:171], v[44:47], a[100:103]
ds_read_b64_tr_b16 v[186:187], v20 offset:32256
v_mfma_f32_16x16x32_bf16 a[100:103], v[172:175], v[60:63], a[100:103]
ds_read_b64_tr_b16 v[188:189], v20 offset:35840
v_mfma_f32_16x16x32_bf16 a[104:107], v[168:171], v[48:51], a[104:107]
ds_read_b64_tr_b16 v[190:191], v20 offset:39424
v_mfma_f32_16x16x32_bf16 a[104:107], v[172:175], v[64:67], a[104:107]
v_mfma_f32_16x16x32_bf16 a[108:111], v[168:171], v[52:55], a[108:111]
buffer_load_dwordx4 v18, s[16:19], s34 offen offset:2048 lds
v_mfma_f32_16x16x32_bf16 a[108:111], v[172:175], v[68:71], a[108:111]
s_add_u32 s34, s34, 458752
s_waitcnt lgkmcnt(4)
v_mfma_f32_16x16x32_bf16 a[208:211], v[176:179], v[40:43], a[208:211]
ds_read_b64_tr_b16 v[192:193], v20 offset:43008
v_mfma_f32_16x16x32_bf16 a[208:211], v[180:183], v[56:59], a[208:211]
ds_read_b64_tr_b16 v[194:195], v20 offset:46592
v_mfma_f32_16x16x32_bf16 a[212:215], v[176:179], v[44:47], a[212:215]
ds_read_b64_tr_b16 v[196:197], v20 offset:50176
v_mfma_f32_16x16x32_bf16 a[212:215], v[180:183], v[60:63], a[212:215]
ds_read_b64_tr_b16 v[198:199], v20 offset:53760
v_mfma_f32_16x16x32_bf16 a[216:219], v[176:179], v[48:51], a[216:219]
v_mfma_f32_16x16x32_bf16 a[216:219], v[180:183], v[64:67], a[216:219]
v_mfma_f32_16x16x32_bf16 a[220:223], v[176:179], v[52:55], a[220:223]
v_mfma_f32_16x16x32_bf16 a[220:223], v[180:183], v[68:71], a[220:223]
s_waitcnt vmcnt(22) lgkmcnt(4)
v_mfma_f32_16x16x32_bf16 a[0:3], v[184:187], v[72:75], a[0:3]
ds_read_b64_tr_b16 v[168:169], v20 offset:28704
v_mfma_f32_16x16x32_bf16 a[0:3], v[188:191], v[88:91], a[0:3]
ds_read_b64_tr_b16 v[170:171], v20 offset:32288
v_mfma_f32_16x16x32_bf16 a[4:7], v[184:187], v[76:79], a[4:7]
ds_read_b64_tr_b16 v[172:173], v20 offset:35872
v_mfma_f32_16x16x32_bf16 a[4:7], v[188:191], v[92:95], a[4:7]
ds_read_b64_tr_b16 v[174:175], v20 offset:39456
v_mfma_f32_16x16x32_bf16 a[8:11], v[184:187], v[80:83], a[8:11]
buffer_load_dwordx4 v[136:139], v8, s[12:15], s33 offen offset:0 sc1
v_mfma_f32_16x16x32_bf16 a[8:11], v[188:191], v[96:99], a[8:11]
v_mfma_f32_16x16x32_bf16 a[12:15], v[184:187], v[84:87], a[12:15]
v_mfma_f32_16x16x32_bf16 a[12:15], v[188:191], v[100:103], a[12:15]
s_waitcnt lgkmcnt(4)
v_mfma_f32_16x16x32_bf16 a[112:115], v[192:195], v[72:75], a[112:115]
ds_read_b64_tr_b16 v[176:177], v20 offset:43040
v_mfma_f32_16x16x32_bf16 a[112:115], v[196:199], v[88:91], a[112:115]
buffer_load_dwordx4 v[140:143], v9, s[12:15], s33 offen offset:0 sc1
v_mfma_f32_16x16x32_bf16 a[116:119], v[192:195], v[76:79], a[116:119]
ds_read_b64_tr_b16 v[178:179], v20 offset:46624
v_mfma_f32_16x16x32_bf16 a[116:119], v[196:199], v[92:95], a[116:119]
ds_read_b64_tr_b16 v[180:181], v20 offset:50208
v_mfma_f32_16x16x32_bf16 a[120:123], v[192:195], v[80:83], a[120:123]
ds_read_b64_tr_b16 v[182:183], v20 offset:53792
v_mfma_f32_16x16x32_bf16 a[120:123], v[196:199], v[96:99], a[120:123]
v_mfma_f32_16x16x32_bf16 a[124:127], v[192:195], v[84:87], a[124:127]
v_mfma_f32_16x16x32_bf16 a[124:127], v[196:199], v[100:103], a[124:127]
s_waitcnt lgkmcnt(4)
v_mfma_f32_16x16x32_bf16 a[16:19], v[168:171], v[72:75], a[16:19]
buffer_load_dwordx4 v[144:147], v10, s[12:15], s33 offen offset:0 sc1
v_mfma_f32_16x16x32_bf16 a[16:19], v[172:175], v[88:91], a[16:19]
ds_read_b64_tr_b16 v[184:185], v20 offset:28736
v_mfma_f32_16x16x32_bf16 a[20:23], v[168:171], v[76:79], a[20:23]
ds_read_b64_tr_b16 v[186:187], v20 offset:32320
v_mfma_f32_16x16x32_bf16 a[20:23], v[172:175], v[92:95], a[20:23]
ds_read_b64_tr_b16 v[188:189], v20 offset:35904
v_mfma_f32_16x16x32_bf16 a[24:27], v[168:171], v[80:83], a[24:27]
ds_read_b64_tr_b16 v[190:191], v20 offset:39488
v_mfma_f32_16x16x32_bf16 a[24:27], v[172:175], v[96:99], a[24:27]
v_mfma_f32_16x16x32_bf16 a[28:31], v[168:171], v[84:87], a[28:31]
v_mfma_f32_16x16x32_bf16 a[28:31], v[172:175], v[100:103], a[28:31]
s_waitcnt lgkmcnt(4)
v_mfma_f32_16x16x32_bf16 a[128:131], v[176:179], v[72:75], a[128:131]
buffer_load_dwordx4 v[148:151], v11, s[12:15], s33 offen offset:0 sc1
v_mfma_f32_16x16x32_bf16 a[128:131], v[180:183], v[88:91], a[128:131]
ds_read_b64_tr_b16 v[192:193], v20 offset:43072
v_mfma_f32_16x16x32_bf16 a[132:135], v[176:179], v[76:79], a[132:135]
ds_read_b64_tr_b16 v[194:195], v20 offset:46656
v_mfma_f32_16x16x32_bf16 a[132:135], v[180:183], v[92:95], a[132:135]
ds_read_b64_tr_b16 v[196:197], v20 offset:50240
v_mfma_f32_16x16x32_bf16 a[136:139], v[176:179], v[80:83], a[136:139]
ds_read_b64_tr_b16 v[198:199], v20 offset:53824
v_mfma_f32_16x16x32_bf16 a[136:139], v[180:183], v[96:99], a[136:139]
v_mfma_f32_16x16x32_bf16 a[140:143], v[176:179], v[84:87], a[140:143]
buffer_load_dwordx4 v[152:155], v8, s[12:15], s33 offen offset:1024 sc1
v_mfma_f32_16x16x32_bf16 a[140:143], v[180:183], v[100:103], a[140:143]
s_waitcnt lgkmcnt(4)
v_mfma_f32_16x16x32_bf16 a[32:35], v[184:187], v[72:75], a[32:35]
ds_read_b64_tr_b16 v[168:169], v20 offset:28768
v_mfma_f32_16x16x32_bf16 a[32:35], v[188:191], v[88:91], a[32:35]
ds_read_b64_tr_b16 v[170:171], v20 offset:32352
v_mfma_f32_16x16x32_bf16 a[36:39], v[184:187], v[76:79], a[36:39]
ds_read_b64_tr_b16 v[172:173], v20 offset:35936
v_mfma_f32_16x16x32_bf16 a[36:39], v[188:191], v[92:95], a[36:39]
ds_read_b64_tr_b16 v[174:175], v20 offset:39520
v_mfma_f32_16x16x32_bf16 a[40:43], v[184:187], v[80:83], a[40:43]
v_mfma_f32_16x16x32_bf16 a[40:43], v[188:191], v[96:99], a[40:43]
buffer_load_dwordx4 v[156:159], v9, s[12:15], s33 offen offset:1024 sc1
v_mfma_f32_16x16x32_bf16 a[44:47], v[184:187], v[84:87], a[44:47]
v_mfma_f32_16x16x32_bf16 a[44:47], v[188:191], v[100:103], a[44:47]
s_waitcnt lgkmcnt(4)
v_mfma_f32_16x16x32_bf16 a[144:147], v[192:195], v[72:75], a[144:147]
ds_read_b64_tr_b16 v[176:177], v20 offset:43104
v_mfma_f32_16x16x32_bf16 a[144:147], v[196:199], v[88:91], a[144:147]
ds_read_b64_tr_b16 v[178:179], v20 offset:46688
v_mfma_f32_16x16x32_bf16 a[148:151], v[192:195], v[76:79], a[148:151]
ds_read_b64_tr_b16 v[180:181], v20 offset:50272
v_mfma_f32_16x16x32_bf16 a[148:151], v[196:199], v[92:95], a[148:151]
ds_read_b64_tr_b16 v[182:183], v20 offset:53856
v_mfma_f32_16x16x32_bf16 a[152:155], v[192:195], v[80:83], a[152:155]
buffer_load_dwordx4 v[160:163], v10, s[12:15], s33 offen offset:1024 sc1
v_mfma_f32_16x16x32_bf16 a[152:155], v[196:199], v[96:99], a[152:155]
v_mfma_f32_16x16x32_bf16 a[156:159], v[192:195], v[84:87], a[156:159]
v_mfma_f32_16x16x32_bf16 a[156:159], v[196:199], v[100:103], a[156:159]
s_waitcnt lgkmcnt(4)
v_mfma_f32_16x16x32_bf16 a[48:51], v[168:171], v[72:75], a[48:51]
ds_read_b64_tr_b16 v[184:185], v20 offset:28800
v_mfma_f32_16x16x32_bf16 a[48:51], v[172:175], v[88:91], a[48:51]
ds_read_b64_tr_b16 v[186:187], v20 offset:32384
v_mfma_f32_16x16x32_bf16 a[52:55], v[168:171], v[76:79], a[52:55]
ds_read_b64_tr_b16 v[188:189], v20 offset:35968
v_mfma_f32_16x16x32_bf16 a[52:55], v[172:175], v[92:95], a[52:55]
ds_read_b64_tr_b16 v[190:191], v20 offset:39552
v_mfma_f32_16x16x32_bf16 a[56:59], v[168:171], v[80:83], a[56:59]
buffer_load_dwordx4 v[164:167], v11, s[12:15], s33 offen offset:1024 sc1
v_mfma_f32_16x16x32_bf16 a[56:59], v[172:175], v[96:99], a[56:59]
s_add_u32 s33, s33, 2048
v_mfma_f32_16x16x32_bf16 a[60:63], v[168:171], v[84:87], a[60:63]
v_mfma_f32_16x16x32_bf16 a[60:63], v[172:175], v[100:103], a[60:63]
s_waitcnt lgkmcnt(4)
v_mfma_f32_16x16x32_bf16 a[160:163], v[176:179], v[72:75], a[160:163]
ds_read_b64_tr_b16 v[192:193], v20 offset:43136
v_mfma_f32_16x16x32_bf16 a[160:163], v[180:183], v[88:91], a[160:163]
ds_read_b64_tr_b16 v[194:195], v20 offset:46720
v_mfma_f32_16x16x32_bf16 a[164:167], v[176:179], v[76:79], a[164:167]
ds_read_b64_tr_b16 v[196:197], v20 offset:50304
v_mfma_f32_16x16x32_bf16 a[164:167], v[180:183], v[92:95], a[164:167]
ds_read_b64_tr_b16 v[198:199], v20 offset:53888
v_mfma_f32_16x16x32_bf16 a[168:171], v[176:179], v[80:83], a[168:171]
v_mfma_f32_16x16x32_bf16 a[168:171], v[180:183], v[96:99], a[168:171]
v_mfma_f32_16x16x32_bf16 a[172:175], v[176:179], v[84:87], a[172:175]
v_mfma_f32_16x16x32_bf16 a[172:175], v[180:183], v[100:103], a[172:175]
s_waitcnt lgkmcnt(4)
v_mfma_f32_16x16x32_bf16 a[64:67], v[184:187], v[72:75], a[64:67]
ds_read_b64_tr_b16 v[168:169], v20 offset:28832
v_mfma_f32_16x16x32_bf16 a[64:67], v[188:191], v[88:91], a[64:67]
ds_read_b64_tr_b16 v[170:171], v20 offset:32416
v_mfma_f32_16x16x32_bf16 a[68:71], v[184:187], v[76:79], a[68:71]
ds_read_b64_tr_b16 v[172:173], v20 offset:36000
v_mfma_f32_16x16x32_bf16 a[68:71], v[188:191], v[92:95], a[68:71]
ds_read_b64_tr_b16 v[174:175], v20 offset:39584
v_mfma_f32_16x16x32_bf16 a[72:75], v[184:187], v[80:83], a[72:75]
v_mfma_f32_16x16x32_bf16 a[72:75], v[188:191], v[96:99], a[72:75]
v_mfma_f32_16x16x32_bf16 a[76:79], v[184:187], v[84:87], a[76:79]
v_mfma_f32_16x16x32_bf16 a[76:79], v[188:191], v[100:103], a[76:79]
s_waitcnt lgkmcnt(4)
v_mfma_f32_16x16x32_bf16 a[176:179], v[192:195], v[72:75], a[176:179]
ds_read_b64_tr_b16 v[176:177], v20 offset:43168
v_mfma_f32_16x16x32_bf16 a[176:179], v[196:199], v[88:91], a[176:179]
ds_read_b64_tr_b16 v[178:179], v20 offset:46752
v_mfma_f32_16x16x32_bf16 a[180:183], v[192:195], v[76:79], a[180:183]
ds_read_b64_tr_b16 v[180:181], v20 offset:50336
v_mfma_f32_16x16x32_bf16 a[180:183], v[196:199], v[92:95], a[180:183]
ds_read_b64_tr_b16 v[182:183], v20 offset:53920
v_mfma_f32_16x16x32_bf16 a[184:187], v[192:195], v[80:83], a[184:187]
v_mfma_f32_16x16x32_bf16 a[184:187], v[196:199], v[96:99], a[184:187]
v_mfma_f32_16x16x32_bf16 a[188:191], v[192:195], v[84:87], a[188:191]
v_mfma_f32_16x16x32_bf16 a[188:191], v[196:199], v[100:103], a[188:191]
s_waitcnt lgkmcnt(4)
v_mfma_f32_16x16x32_bf16 a[80:83], v[168:171], v[72:75], a[80:83]
ds_read_b64_tr_b16 v[184:185], v20 offset:28864
v_mfma_f32_16x16x32_bf16 a[80:83], v[172:175], v[88:91], a[80:83]
ds_read_b64_tr_b16 v[186:187], v20 offset:32448
v_mfma_f32_16x16x32_bf16 a[84:87], v[168:171], v[76:79], a[84:87]
ds_read_b64_tr_b16 v[188:189], v20 offset:36032
v_mfma_f32_16x16x32_bf16 a[84:87], v[172:175], v[92:95], a[84:87]
ds_read_b64_tr_b16 v[190:191], v20 offset:39616
v_mfma_f32_16x16x32_bf16 a[88:91], v[168:171], v[80:83], a[88:91]
v_mfma_f32_16x16x32_bf16 a[88:91], v[172:175], v[96:99], a[88:91]
v_mfma_f32_16x16x32_bf16 a[92:95], v[168:171], v[84:87], a[92:95]
v_mfma_f32_16x16x32_bf16 a[92:95], v[172:175], v[100:103], a[92:95]
s_waitcnt lgkmcnt(4)
v_mfma_f32_16x16x32_bf16 a[192:195], v[176:179], v[72:75], a[192:195]
ds_read_b64_tr_b16 v[192:193], v20 offset:43200
v_mfma_f32_16x16x32_bf16 a[192:195], v[180:183], v[88:91], a[192:195]
ds_read_b64_tr_b16 v[194:195], v20 offset:46784
v_mfma_f32_16x16x32_bf16 a[196:199], v[176:179], v[76:79], a[196:199]
ds_read_b64_tr_b16 v[196:197], v20 offset:50368
v_mfma_f32_16x16x32_bf16 a[196:199], v[180:183], v[92:95], a[196:199]
ds_read_b64_tr_b16 v[198:199], v20 offset:53952
v_mfma_f32_16x16x32_bf16 a[200:203], v[176:179], v[80:83], a[200:203]
v_mfma_f32_16x16x32_bf16 a[200:203], v[180:183], v[96:99], a[200:203]
v_mfma_f32_16x16x32_bf16 a[204:207], v[176:179], v[84:87], a[204:207]
v_mfma_f32_16x16x32_bf16 a[204:207], v[180:183], v[100:103], a[204:207]
s_waitcnt vmcnt(23) lgkmcnt(4)
s_barrier
v_mfma_f32_16x16x32_bf16 a[96:99], v[184:187], v[72:75], a[96:99]
ds_read_b64_tr_b16 v[168:169], v21 offset:0
v_mfma_f32_16x16x32_bf16 a[96:99], v[188:191], v[88:91], a[96:99]
ds_read_b64_tr_b16 v[170:171], v21 offset:3584
v_mfma_f32_16x16x32_bf16 a[100:103], v[184:187], v[76:79], a[100:103]
ds_read_b64_tr_b16 v[172:173], v21 offset:7168
v_mfma_f32_16x16x32_bf16 a[100:103], v[188:191], v[92:95], a[100:103]
ds_read_b64_tr_b16 v[174:175], v21 offset:10752
v_mfma_f32_16x16x32_bf16 a[104:107], v[184:187], v[80:83], a[104:107]
v_mfma_f32_16x16x32_bf16 a[104:107], v[188:191], v[96:99], a[104:107]
v_mfma_f32_16x16x32_bf16 a[108:111], v[184:187], v[84:87], a[108:111]
v_mfma_f32_16x16x32_bf16 a[108:111], v[188:191], v[100:103], a[108:111]
s_waitcnt lgkmcnt(4)
v_mfma_f32_16x16x32_bf16 a[208:211], v[192:195], v[72:75], a[208:211]
ds_read_b64_tr_b16 v[176:177], v21 offset:14336
v_mfma_f32_16x16x32_bf16 a[208:211], v[196:199], v[88:91], a[208:211]
ds_read_b64_tr_b16 v[178:179], v21 offset:17920
v_mfma_f32_16x16x32_bf16 a[212:215], v[192:195], v[76:79], a[212:215]
ds_read_b64_tr_b16 v[180:181], v21 offset:21504
v_mfma_f32_16x16x32_bf16 a[212:215], v[196:199], v[92:95], a[212:215]
ds_read_b64_tr_b16 v[182:183], v21 offset:25088
v_mfma_f32_16x16x32_bf16 a[216:219], v[192:195], v[80:83], a[216:219]
v_mfma_f32_16x16x32_bf16 a[216:219], v[196:199], v[96:99], a[216:219]
v_mfma_f32_16x16x32_bf16 a[220:223], v[192:195], v[84:87], a[220:223]
v_mfma_f32_16x16x32_bf16 a[220:223], v[196:199], v[100:103], a[220:223]
s_waitcnt vmcnt(15) lgkmcnt(4)
v_mfma_f32_16x16x32_bf16 a[0:3], v[168:171], v[104:107], a[0:3]
ds_read_b64_tr_b16 v[184:185], v21 offset:32
v_mfma_f32_16x16x32_bf16 a[0:3], v[172:175], v[120:123], a[0:3]
ds_read_b64_tr_b16 v[186:187], v21 offset:3616
v_mfma_f32_16x16x32_bf16 a[4:7], v[168:171], v[108:111], a[4:7]
ds_read_b64_tr_b16 v[188:189], v21 offset:7200
v_mfma_f32_16x16x32_bf16 a[4:7], v[172:175], v[124:127], a[4:7]
ds_read_b64_tr_b16 v[190:191], v21 offset:10784
v_mfma_f32_16x16x32_bf16 a[8:11], v[168:171], v[112:115], a[8:11]
v_mfma_f32_16x16x32_bf16 a[8:11], v[172:175], v[128:131], a[8:11]
v_mfma_f32_16x16x32_bf16 a[12:15], v[168:171], v[116:119], a[12:15]
v_mfma_f32_16x16x32_bf16 a[12:15], v[172:175], v[132:135], a[12:15]
s_waitcnt lgkmcnt(4)
v_mfma_f32_16x16x32_bf16 a[112:115], v[176:179], v[104:107], a[112:115]
ds_read_b64_tr_b16 v[192:193], v21 offset:14368
v_mfma_f32_16x16x32_bf16 a[112:115], v[180:183], v[120:123], a[112:115]
ds_read_b64_tr_b16 v[194:195], v21 offset:17952
v_mfma_f32_16x16x32_bf16 a[116:119], v[176:179], v[108:111], a[116:119]
ds_read_b64_tr_b16 v[196:197], v21 offset:21536
v_mfma_f32_16x16x32_bf16 a[116:119], v[180:183], v[124:127], a[116:119]
ds_read_b64_tr_b16 v[198:199], v21 offset:25120
v_mfma_f32_16x16x32_bf16 a[120:123], v[176:179], v[112:115], a[120:123]
v_mfma_f32_16x16x32_bf16 a[120:123], v[180:183], v[128:131], a[120:123]
v_mfma_f32_16x16x32_bf16 a[124:127], v[176:179], v[116:119], a[124:127]
v_mfma_f32_16x16x32_bf16 a[124:127], v[180:183], v[132:135], a[124:127]
s_waitcnt lgkmcnt(4)
v_mfma_f32_16x16x32_bf16 a[16:19], v[184:187], v[104:107], a[16:19]
ds_read_b64_tr_b16 v[168:169], v21 offset:64
v_mfma_f32_16x16x32_bf16 a[16:19], v[188:191], v[120:123], a[16:19]
ds_read_b64_tr_b16 v[170:171], v21 offset:3648
v_mfma_f32_16x16x32_bf16 a[20:23], v[184:187], v[108:111], a[20:23]
ds_read_b64_tr_b16 v[172:173], v21 offset:7232
v_mfma_f32_16x16x32_bf16 a[20:23], v[188:191], v[124:127], a[20:23]
ds_read_b64_tr_b16 v[174:175], v21 offset:10816
v_mfma_f32_16x16x32_bf16 a[24:27], v[184:187], v[112:115], a[24:27]
v_mfma_f32_16x16x32_bf16 a[24:27], v[188:191], v[128:131], a[24:27]
v_mfma_f32_16x16x32_bf16 a[28:31], v[184:187], v[116:119], a[28:31]
v_mfma_f32_16x16x32_bf16 a[28:31], v[188:191], v[132:135], a[28:31]
s_waitcnt lgkmcnt(4)
v_mfma_f32_16x16x32_bf16 a[128:131], v[192:195], v[104:107], a[128:131]
ds_read_b64_tr_b16 v[176:177], v21 offset:14400
v_mfma_f32_16x16x32_bf16 a[128:131], v[196:199], v[120:123], a[128:131]
ds_read_b64_tr_b16 v[178:179], v21 offset:17984
v_mfma_f32_16x16x32_bf16 a[132:135], v[192:195], v[108:111], a[132:135]
ds_read_b64_tr_b16 v[180:181], v21 offset:21568
v_mfma_f32_16x16x32_bf16 a[132:135], v[196:199], v[124:127], a[132:135]
ds_read_b64_tr_b16 v[182:183], v21 offset:25152
v_mfma_f32_16x16x32_bf16 a[136:139], v[192:195], v[112:115], a[136:139]
v_mfma_f32_16x16x32_bf16 a[136:139], v[196:199], v[128:131], a[136:139]
v_mfma_f32_16x16x32_bf16 a[140:143], v[192:195], v[116:119], a[140:143]
v_mfma_f32_16x16x32_bf16 a[140:143], v[196:199], v[132:135], a[140:143]
s_waitcnt lgkmcnt(4)
v_mfma_f32_16x16x32_bf16 a[32:35], v[168:171], v[104:107], a[32:35]
ds_read_b64_tr_b16 v[184:185], v21 offset:96
v_mfma_f32_16x16x32_bf16 a[32:35], v[172:175], v[120:123], a[32:35]
ds_read_b64_tr_b16 v[186:187], v21 offset:3680
v_mfma_f32_16x16x32_bf16 a[36:39], v[168:171], v[108:111], a[36:39]
ds_read_b64_tr_b16 v[188:189], v21 offset:7264
v_mfma_f32_16x16x32_bf16 a[36:39], v[172:175], v[124:127], a[36:39]
ds_read_b64_tr_b16 v[190:191], v21 offset:10848
v_mfma_f32_16x16x32_bf16 a[40:43], v[168:171], v[112:115], a[40:43]
v_mfma_f32_16x16x32_bf16 a[40:43], v[172:175], v[128:131], a[40:43]
v_mfma_f32_16x16x32_bf16 a[44:47], v[168:171], v[116:119], a[44:47]
v_mfma_f32_16x16x32_bf16 a[44:47], v[172:175], v[132:135], a[44:47]
s_waitcnt lgkmcnt(4)
v_mfma_f32_16x16x32_bf16 a[144:147], v[176:179], v[104:107], a[144:147]
ds_read_b64_tr_b16 v[192:193], v21 offset:14432
v_mfma_f32_16x16x32_bf16 a[144:147], v[180:183], v[120:123], a[144:147]
ds_read_b64_tr_b16 v[194:195], v21 offset:18016
v_mfma_f32_16x16x32_bf16 a[148:151], v[176:179], v[108:111], a[148:151]
ds_read_b64_tr_b16 v[196:197], v21 offset:21600
v_mfma_f32_16x16x32_bf16 a[148:151], v[180:183], v[124:127], a[148:151]
ds_read_b64_tr_b16 v[198:199], v21 offset:25184
v_mfma_f32_16x16x32_bf16 a[152:155], v[176:179], v[112:115], a[152:155]
v_mfma_f32_16x16x32_bf16 a[152:155], v[180:183], v[128:131], a[152:155]
v_mfma_f32_16x16x32_bf16 a[156:159], v[176:179], v[116:119], a[156:159]
v_mfma_f32_16x16x32_bf16 a[156:159], v[180:183], v[132:135], a[156:159]
s_waitcnt lgkmcnt(4)
v_mfma_f32_16x16x32_bf16 a[48:51], v[184:187], v[104:107], a[48:51]
ds_read_b64_tr_b16 v[168:169], v21 offset:128
v_mfma_f32_16x16x32_bf16 a[48:51], v[188:191], v[120:123], a[48:51]
ds_read_b64_tr_b16 v[170:171], v21 offset:3712
v_mfma_f32_16x16x32_bf16 a[52:55], v[184:187], v[108:111], a[52:55]
ds_read_b64_tr_b16 v[172:173], v21 offset:7296
v_mfma_f32_16x16x32_bf16 a[52:55], v[188:191], v[124:127], a[52:55]
ds_read_b64_tr_b16 v[174:175], v21 offset:10880
v_mfma_f32_16x16x32_bf16 a[56:59], v[184:187], v[112:115], a[56:59]
v_mfma_f32_16x16x32_bf16 a[56:59], v[188:191], v[128:131], a[56:59]
v_mfma_f32_16x16x32_bf16 a[60:63], v[184:187], v[116:119], a[60:63]
v_mfma_f32_16x16x32_bf16 a[60:63], v[188:191], v[132:135], a[60:63]
s_waitcnt lgkmcnt(4)
v_mfma_f32_16x16x32_bf16 a[160:163], v[192:195], v[104:107], a[160:163]
ds_read_b64_tr_b16 v[176:177], v21 offset:14464
v_mfma_f32_16x16x32_bf16 a[160:163], v[196:199], v[120:123], a[160:163]
ds_read_b64_tr_b16 v[178:179], v21 offset:18048
v_mfma_f32_16x16x32_bf16 a[164:167], v[192:195], v[108:111], a[164:167]
ds_read_b64_tr_b16 v[180:181], v21 offset:21632
v_mfma_f32_16x16x32_bf16 a[164:167], v[196:199], v[124:127], a[164:167]
ds_read_b64_tr_b16 v[182:183], v21 offset:25216
v_mfma_f32_16x16x32_bf16 a[168:171], v[192:195], v[112:115], a[168:171]
v_mfma_f32_16x16x32_bf16 a[168:171], v[196:199], v[128:131], a[168:171]
v_mfma_f32_16x16x32_bf16 a[172:175], v[192:195], v[116:119], a[172:175]
v_mfma_f32_16x16x32_bf16 a[172:175], v[196:199], v[132:135], a[172:175]
s_waitcnt lgkmcnt(4)
v_mfma_f32_16x16x32_bf16 a[64:67], v[168:171], v[104:107], a[64:67]
ds_read_b64_tr_b16 v[184:185], v21 offset:160
v_mfma_f32_16x16x32_bf16 a[64:67], v[172:175], v[120:123], a[64:67]
ds_read_b64_tr_b16 v[186:187], v21 offset:3744
v_mfma_f32_16x16x32_bf16 a[68:71], v[168:171], v[108:111], a[68:71]
ds_read_b64_tr_b16 v[188:189], v21 offset:7328
v_mfma_f32_16x16x32_bf16 a[68:71], v[172:175], v[124:127], a[68:71]
ds_read_b64_tr_b16 v[190:191], v21 offset:10912
v_mfma_f32_16x16x32_bf16 a[72:75], v[168:171], v[112:115], a[72:75]
v_mfma_f32_16x16x32_bf16 a[72:75], v[172:175], v[128:131], a[72:75]
v_mfma_f32_16x16x32_bf16 a[76:79], v[168:171], v[116:119], a[76:79]
v_mfma_f32_16x16x32_bf16 a[76:79], v[172:175], v[132:135], a[76:79]
s_waitcnt lgkmcnt(4)
v_mfma_f32_16x16x32_bf16 a[176:179], v[176:179], v[104:107], a[176:179]
ds_read_b64_tr_b16 v[192:193], v21 offset:14496
v_mfma_f32_16x16x32_bf16 a[176:179], v[180:183], v[120:123], a[176:179]
ds_read_b64_tr_b16 v[194:195], v21 offset:18080
v_mfma_f32_16x16x32_bf16 a[180:183], v[176:179], v[108:111], a[180:183]
ds_read_b64_tr_b16 v[196:197], v21 offset:21664
v_mfma_f32_16x16x32_bf16 a[180:183], v[180:183], v[124:127], a[180:183]
ds_read_b64_tr_b16 v[198:199], v21 offset:25248
v_mfma_f32_16x16x32_bf16 a[184:187], v[176:179], v[112:115], a[184:187]
v_mfma_f32_16x16x32_bf16 a[184:187], v[180:183], v[128:131], a[184:187]
v_mfma_f32_16x16x32_bf16 a[188:191], v[176:179], v[116:119], a[188:191]
v_mfma_f32_16x16x32_bf16 a[188:191], v[180:183], v[132:135], a[188:191]
s_waitcnt lgkmcnt(4)
v_mfma_f32_16x16x32_bf16 a[80:83], v[184:187], v[104:107], a[80:83]
ds_read_b64_tr_b16 v[168:169], v21 offset:192
v_mfma_f32_16x16x32_bf16 a[80:83], v[188:191], v[120:123], a[80:83]
ds_read_b64_tr_b16 v[170:171], v21 offset:3776
v_mfma_f32_16x16x32_bf16 a[84:87], v[184:187], v[108:111], a[84:87]
ds_read_b64_tr_b16 v[172:173], v21 offset:7360
v_mfma_f32_16x16x32_bf16 a[84:87], v[188:191], v[124:127], a[84:87]
ds_read_b64_tr_b16 v[174:175], v21 offset:10944
v_mfma_f32_16x16x32_bf16 a[88:91], v[184:187], v[112:115], a[88:91]
v_mfma_f32_16x16x32_bf16 a[88:91], v[188:191], v[128:131], a[88:91]
v_mfma_f32_16x16x32_bf16 a[92:95], v[184:187], v[116:119], a[92:95]
v_mfma_f32_16x16x32_bf16 a[92:95], v[188:191], v[132:135], a[92:95]
s_waitcnt lgkmcnt(4)
v_mfma_f32_16x16x32_bf16 a[192:195], v[192:195], v[104:107], a[192:195]
ds_read_b64_tr_b16 v[176:177], v21 offset:14528
v_mfma_f32_16x16x32_bf16 a[192:195], v[196:199], v[120:123], a[192:195]
ds_read_b64_tr_b16 v[178:179], v21 offset:18112
v_mfma_f32_16x16x32_bf16 a[196:199], v[192:195], v[108:111], a[196:199]
ds_read_b64_tr_b16 v[180:181], v21 offset:21696
v_mfma_f32_16x16x32_bf16 a[196:199], v[196:199], v[124:127], a[196:199]
ds_read_b64_tr_b16 v[182:183], v21 offset:25280
v_mfma_f32_16x16x32_bf16 a[200:203], v[192:195], v[112:115], a[200:203]
v_mfma_f32_16x16x32_bf16 a[200:203], v[196:199], v[128:131], a[200:203]
v_mfma_f32_16x16x32_bf16 a[204:207], v[192:195], v[116:119], a[204:207]
v_mfma_f32_16x16x32_bf16 a[204:207], v[196:199], v[132:135], a[204:207]
s_waitcnt vmcnt(8) lgkmcnt(4)
s_barrier
v_mfma_f32_16x16x32_bf16 a[96:99], v[168:171], v[104:107], a[96:99]
ds_read_b64_tr_b16 v[184:185], v21 offset:28672
v_mfma_f32_16x16x32_bf16 a[96:99], v[172:175], v[120:123], a[96:99]
ds_read_b64_tr_b16 v[186:187], v21 offset:32256
v_mfma_f32_16x16x32_bf16 a[100:103], v[168:171], v[108:111], a[100:103]
ds_read_b64_tr_b16 v[188:189], v21 offset:35840
v_mfma_f32_16x16x32_bf16 a[100:103], v[172:175], v[124:127], a[100:103]
ds_read_b64_tr_b16 v[190:191], v21 offset:39424
v_mfma_f32_16x16x32_bf16 a[104:107], v[168:171], v[112:115], a[104:107]
v_mfma_f32_16x16x32_bf16 a[104:107], v[172:175], v[128:131], a[104:107]
v_mfma_f32_16x16x32_bf16 a[108:111], v[168:171], v[116:119], a[108:111]
v_mfma_f32_16x16x32_bf16 a[108:111], v[172:175], v[132:135], a[108:111]
s_waitcnt lgkmcnt(4)
v_mfma_f32_16x16x32_bf16 a[208:211], v[176:179], v[104:107], a[208:211]
ds_read_b64_tr_b16 v[192:193], v21 offset:43008
v_mfma_f32_16x16x32_bf16 a[208:211], v[180:183], v[120:123], a[208:211]
ds_read_b64_tr_b16 v[194:195], v21 offset:46592
v_mfma_f32_16x16x32_bf16 a[212:215], v[176:179], v[108:111], a[212:215]
ds_read_b64_tr_b16 v[196:197], v21 offset:50176
v_mfma_f32_16x16x32_bf16 a[212:215], v[180:183], v[124:127], a[212:215]
ds_read_b64_tr_b16 v[198:199], v21 offset:53760
v_mfma_f32_16x16x32_bf16 a[216:219], v[176:179], v[112:115], a[216:219]
v_mfma_f32_16x16x32_bf16 a[216:219], v[180:183], v[128:131], a[216:219]
v_mfma_f32_16x16x32_bf16 a[220:223], v[176:179], v[116:119], a[220:223]
v_mfma_f32_16x16x32_bf16 a[220:223], v[180:183], v[132:135], a[220:223]
s_waitcnt vmcnt(0) lgkmcnt(4)
v_mfma_f32_16x16x32_bf16 a[0:3], v[184:187], v[136:139], a[0:3]
ds_read_b64_tr_b16 v[168:169], v21 offset:28704
v_mfma_f32_16x16x32_bf16 a[0:3], v[188:191], v[152:155], a[0:3]
ds_read_b64_tr_b16 v[170:171], v21 offset:32288
v_mfma_f32_16x16x32_bf16 a[4:7], v[184:187], v[140:143], a[4:7]
ds_read_b64_tr_b16 v[172:173], v21 offset:35872
v_mfma_f32_16x16x32_bf16 a[4:7], v[188:191], v[156:159], a[4:7]
ds_read_b64_tr_b16 v[174:175], v21 offset:39456
v_mfma_f32_16x16x32_bf16 a[8:11], v[184:187], v[144:147], a[8:11]
v_mfma_f32_16x16x32_bf16 a[8:11], v[188:191], v[160:163], a[8:11]
v_mfma_f32_16x16x32_bf16 a[12:15], v[184:187], v[148:151], a[12:15]
v_mfma_f32_16x16x32_bf16 a[12:15], v[188:191], v[164:167], a[12:15]
s_waitcnt lgkmcnt(4)
v_mfma_f32_16x16x32_bf16 a[112:115], v[192:195], v[136:139], a[112:115]
ds_read_b64_tr_b16 v[176:177], v21 offset:43040
v_mfma_f32_16x16x32_bf16 a[112:115], v[196:199], v[152:155], a[112:115]
ds_read_b64_tr_b16 v[178:179], v21 offset:46624
v_mfma_f32_16x16x32_bf16 a[116:119], v[192:195], v[140:143], a[116:119]
ds_read_b64_tr_b16 v[180:181], v21 offset:50208
v_mfma_f32_16x16x32_bf16 a[116:119], v[196:199], v[156:159], a[116:119]
ds_read_b64_tr_b16 v[182:183], v21 offset:53792
v_mfma_f32_16x16x32_bf16 a[120:123], v[192:195], v[144:147], a[120:123]
v_mfma_f32_16x16x32_bf16 a[120:123], v[196:199], v[160:163], a[120:123]
v_mfma_f32_16x16x32_bf16 a[124:127], v[192:195], v[148:151], a[124:127]
v_mfma_f32_16x16x32_bf16 a[124:127], v[196:199], v[164:167], a[124:127]
s_waitcnt lgkmcnt(4)
v_mfma_f32_16x16x32_bf16 a[16:19], v[168:171], v[136:139], a[16:19]
ds_read_b64_tr_b16 v[184:185], v21 offset:28736
v_mfma_f32_16x16x32_bf16 a[16:19], v[172:175], v[152:155], a[16:19]
ds_read_b64_tr_b16 v[186:187], v21 offset:32320
v_mfma_f32_16x16x32_bf16 a[20:23], v[168:171], v[140:143], a[20:23]
ds_read_b64_tr_b16 v[188:189], v21 offset:35904
v_mfma_f32_16x16x32_bf16 a[20:23], v[172:175], v[156:159], a[20:23]
ds_read_b64_tr_b16 v[190:191], v21 offset:39488
v_mfma_f32_16x16x32_bf16 a[24:27], v[168:171], v[144:147], a[24:27]
v_mfma_f32_16x16x32_bf16 a[24:27], v[172:175], v[160:163], a[24:27]
v_mfma_f32_16x16x32_bf16 a[28:31], v[168:171], v[148:151], a[28:31]
v_mfma_f32_16x16x32_bf16 a[28:31], v[172:175], v[164:167], a[28:31]
s_waitcnt lgkmcnt(4)
v_mfma_f32_16x16x32_bf16 a[128:131], v[176:179], v[136:139], a[128:131]
ds_read_b64_tr_b16 v[192:193], v21 offset:43072
v_mfma_f32_16x16x32_bf16 a[128:131], v[180:183], v[152:155], a[128:131]
ds_read_b64_tr_b16 v[194:195], v21 offset:46656
v_mfma_f32_16x16x32_bf16 a[132:135], v[176:179], v[140:143], a[132:135]
ds_read_b64_tr_b16 v[196:197], v21 offset:50240
v_mfma_f32_16x16x32_bf16 a[132:135], v[180:183], v[156:159], a[132:135]
ds_read_b64_tr_b16 v[198:199], v21 offset:53824
v_mfma_f32_16x16x32_bf16 a[136:139], v[176:179], v[144:147], a[136:139]
v_mfma_f32_16x16x32_bf16 a[136:139], v[180:183], v[160:163], a[136:139]
v_mfma_f32_16x16x32_bf16 a[140:143], v[176:179], v[148:151], a[140:143]
v_mfma_f32_16x16x32_bf16 a[140:143], v[180:183], v[164:167], a[140:143]
s_waitcnt lgkmcnt(4)
v_mfma_f32_16x16x32_bf16 a[32:35], v[184:187], v[136:139], a[32:35]
ds_read_b64_tr_b16 v[168:169], v21 offset:28768
v_mfma_f32_16x16x32_bf16 a[32:35], v[188:191], v[152:155], a[32:35]
ds_read_b64_tr_b16 v[170:171], v21 offset:32352
v_mfma_f32_16x16x32_bf16 a[36:39], v[184:187], v[140:143], a[36:39]
ds_read_b64_tr_b16 v[172:173], v21 offset:35936
v_mfma_f32_16x16x32_bf16 a[36:39], v[188:191], v[156:159], a[36:39]
ds_read_b64_tr_b16 v[174:175], v21 offset:39520
v_mfma_f32_16x16x32_bf16 a[40:43], v[184:187], v[144:147], a[40:43]
v_mfma_f32_16x16x32_bf16 a[40:43], v[188:191], v[160:163], a[40:43]
v_mfma_f32_16x16x32_bf16 a[44:47], v[184:187], v[148:151], a[44:47]
v_mfma_f32_16x16x32_bf16 a[44:47], v[188:191], v[164:167], a[44:47]
s_waitcnt lgkmcnt(4)
v_mfma_f32_16x16x32_bf16 a[144:147], v[192:195], v[136:139], a[144:147]
ds_read_b64_tr_b16 v[176:177], v21 offset:43104
v_mfma_f32_16x16x32_bf16 a[144:147], v[196:199], v[152:155], a[144:147]
ds_read_b64_tr_b16 v[178:179], v21 offset:46688
v_mfma_f32_16x16x32_bf16 a[148:151], v[192:195], v[140:143], a[148:151]
ds_read_b64_tr_b16 v[180:181], v21 offset:50272
v_mfma_f32_16x16x32_bf16 a[148:151], v[196:199], v[156:159], a[148:151]
ds_read_b64_tr_b16 v[182:183], v21 offset:53856
v_mfma_f32_16x16x32_bf16 a[152:155], v[192:195], v[144:147], a[152:155]
v_mfma_f32_16x16x32_bf16 a[152:155], v[196:199], v[160:163], a[152:155]
v_mfma_f32_16x16x32_bf16 a[156:159], v[192:195], v[148:151], a[156:159]
v_mfma_f32_16x16x32_bf16 a[156:159], v[196:199], v[164:167], a[156:159]
s_waitcnt lgkmcnt(4)
v_mfma_f32_16x16x32_bf16 a[48:51], v[168:171], v[136:139], a[48:51]
ds_read_b64_tr_b16 v[184:185], v21 offset:28800
v_mfma_f32_16x16x32_bf16 a[48:51], v[172:175], v[152:155], a[48:51]
ds_read_b64_tr_b16 v[186:187], v21 offset:32384
v_mfma_f32_16x16x32_bf16 a[52:55], v[168:171], v[140:143], a[52:55]
ds_read_b64_tr_b16 v[188:189], v21 offset:35968
v_mfma_f32_16x16x32_bf16 a[52:55], v[172:175], v[156:159], a[52:55]
ds_read_b64_tr_b16 v[190:191], v21 offset:39552
v_mfma_f32_16x16x32_bf16 a[56:59], v[168:171], v[144:147], a[56:59]
v_mfma_f32_16x16x32_bf16 a[56:59], v[172:175], v[160:163], a[56:59]
v_mfma_f32_16x16x32_bf16 a[60:63], v[168:171], v[148:151], a[60:63]
v_mfma_f32_16x16x32_bf16 a[60:63], v[172:175], v[164:167], a[60:63]
s_waitcnt lgkmcnt(4)
v_mfma_f32_16x16x32_bf16 a[160:163], v[176:179], v[136:139], a[160:163]
ds_read_b64_tr_b16 v[192:193], v21 offset:43136
v_mfma_f32_16x16x32_bf16 a[160:163], v[180:183], v[152:155], a[160:163]
ds_read_b64_tr_b16 v[194:195], v21 offset:46720
v_mfma_f32_16x16x32_bf16 a[164:167], v[176:179], v[140:143], a[164:167]
ds_read_b64_tr_b16 v[196:197], v21 offset:50304
v_mfma_f32_16x16x32_bf16 a[164:167], v[180:183], v[156:159], a[164:167]
ds_read_b64_tr_b16 v[198:199], v21 offset:53888
v_mfma_f32_16x16x32_bf16 a[168:171], v[176:179], v[144:147], a[168:171]
v_mfma_f32_16x16x32_bf16 a[168:171], v[180:183], v[160:163], a[168:171]
v_mfma_f32_16x16x32_bf16 a[172:175], v[176:179], v[148:151], a[172:175]
v_mfma_f32_16x16x32_bf16 a[172:175], v[180:183], v[164:167], a[172:175]
s_waitcnt lgkmcnt(4)
v_mfma_f32_16x16x32_bf16 a[64:67], v[184:187], v[136:139], a[64:67]
ds_read_b64_tr_b16 v[168:169], v21 offset:28832
v_mfma_f32_16x16x32_bf16 a[64:67], v[188:191], v[152:155], a[64:67]
ds_read_b64_tr_b16 v[170:171], v21 offset:32416
v_mfma_f32_16x16x32_bf16 a[68:71], v[184:187], v[140:143], a[68:71]
ds_read_b64_tr_b16 v[172:173], v21 offset:36000
v_mfma_f32_16x16x32_bf16 a[68:71], v[188:191], v[156:159], a[68:71]
ds_read_b64_tr_b16 v[174:175], v21 offset:39584
v_mfma_f32_16x16x32_bf16 a[72:75], v[184:187], v[144:147], a[72:75]
v_mfma_f32_16x16x32_bf16 a[72:75], v[188:191], v[160:163], a[72:75]
v_mfma_f32_16x16x32_bf16 a[76:79], v[184:187], v[148:151], a[76:79]
v_mfma_f32_16x16x32_bf16 a[76:79], v[188:191], v[164:167], a[76:79]
s_waitcnt lgkmcnt(4)
v_mfma_f32_16x16x32_bf16 a[176:179], v[192:195], v[136:139], a[176:179]
ds_read_b64_tr_b16 v[176:177], v21 offset:43168
v_mfma_f32_16x16x32_bf16 a[176:179], v[196:199], v[152:155], a[176:179]
ds_read_b64_tr_b16 v[178:179], v21 offset:46752
v_mfma_f32_16x16x32_bf16 a[180:183], v[192:195], v[140:143], a[180:183]
ds_read_b64_tr_b16 v[180:181], v21 offset:50336
v_mfma_f32_16x16x32_bf16 a[180:183], v[196:199], v[156:159], a[180:183]
ds_read_b64_tr_b16 v[182:183], v21 offset:53920
v_mfma_f32_16x16x32_bf16 a[184:187], v[192:195], v[144:147], a[184:187]
v_mfma_f32_16x16x32_bf16 a[184:187], v[196:199], v[160:163], a[184:187]
v_mfma_f32_16x16x32_bf16 a[188:191], v[192:195], v[148:151], a[188:191]
v_mfma_f32_16x16x32_bf16 a[188:191], v[196:199], v[164:167], a[188:191]
s_waitcnt lgkmcnt(4)
v_mfma_f32_16x16x32_bf16 a[80:83], v[168:171], v[136:139], a[80:83]
ds_read_b64_tr_b16 v[184:185], v21 offset:28864
v_mfma_f32_16x16x32_bf16 a[80:83], v[172:175], v[152:155], a[80:83]
ds_read_b64_tr_b16 v[186:187], v21 offset:32448
v_mfma_f32_16x16x32_bf16 a[84:87], v[168:171], v[140:143], a[84:87]
ds_read_b64_tr_b16 v[188:189], v21 offset:36032
v_mfma_f32_16x16x32_bf16 a[84:87], v[172:175], v[156:159], a[84:87]
ds_read_b64_tr_b16 v[190:191], v21 offset:39616
v_mfma_f32_16x16x32_bf16 a[88:91], v[168:171], v[144:147], a[88:91]
v_mfma_f32_16x16x32_bf16 a[88:91], v[172:175], v[160:163], a[88:91]
v_mfma_f32_16x16x32_bf16 a[92:95], v[168:171], v[148:151], a[92:95]
v_mfma_f32_16x16x32_bf16 a[92:95], v[172:175], v[164:167], a[92:95]
s_waitcnt lgkmcnt(4)
v_mfma_f32_16x16x32_bf16 a[192:195], v[176:179], v[136:139], a[192:195]
ds_read_b64_tr_b16 v[192:193], v21 offset:43200
v_mfma_f32_16x16x32_bf16 a[192:195], v[180:183], v[152:155], a[192:195]
ds_read_b64_tr_b16 v[194:195], v21 offset:46784
v_mfma_f32_16x16x32_bf16 a[196:199], v[176:179], v[140:143], a[196:199]
ds_read_b64_tr_b16 v[196:197], v21 offset:50368
v_mfma_f32_16x16x32_bf16 a[196:199], v[180:183], v[156:159], a[196:199]
ds_read_b64_tr_b16 v[198:199], v21 offset:53952
v_mfma_f32_16x16x32_bf16 a[200:203], v[176:179], v[144:147], a[200:203]
v_mfma_f32_16x16x32_bf16 a[200:203], v[180:183], v[160:163], a[200:203]
v_mfma_f32_16x16x32_bf16 a[204:207], v[176:179], v[148:151], a[204:207]
v_mfma_f32_16x16x32_bf16 a[204:207], v[180:183], v[164:167], a[204:207]
s_waitcnt lgkmcnt(4)
v_mfma_f32_16x16x32_bf16 a[96:99], v[184:187], v[136:139], a[96:99]
v_mfma_f32_16x16x32_bf16 a[96:99], v[188:191], v[152:155], a[96:99]
v_mfma_f32_16x16x32_bf16 a[100:103], v[184:187], v[140:143], a[100:103]
v_mfma_f32_16x16x32_bf16 a[100:103], v[188:191], v[156:159], a[100:103]
v_mfma_f32_16x16x32_bf16 a[104:107], v[184:187], v[144:147], a[104:107]
v_mfma_f32_16x16x32_bf16 a[104:107], v[188:191], v[160:163], a[104:107]
v_mfma_f32_16x16x32_bf16 a[108:111], v[184:187], v[148:151], a[108:111]
v_mfma_f32_16x16x32_bf16 a[108:111], v[188:191], v[164:167], a[108:111]
s_waitcnt lgkmcnt(0)
v_mfma_f32_16x16x32_bf16 a[208:211], v[192:195], v[136:139], a[208:211]
v_mfma_f32_16x16x32_bf16 a[208:211], v[196:199], v[152:155], a[208:211]
v_mfma_f32_16x16x32_bf16 a[212:215], v[192:195], v[140:143], a[212:215]
v_mfma_f32_16x16x32_bf16 a[212:215], v[196:199], v[156:159], a[212:215]
v_mfma_f32_16x16x32_bf16 a[216:219], v[192:195], v[144:147], a[216:219]
v_mfma_f32_16x16x32_bf16 a[216:219], v[196:199], v[160:163], a[216:219]
v_mfma_f32_16x16x32_bf16 a[220:223], v[192:195], v[148:151], a[220:223]
v_mfma_f32_16x16x32_bf16 a[220:223], v[196:199], v[164:167], a[220:223]
s_lshl_b32 s33, s39, 4
s_lshl_b32 s42, s32, 2
s_add_u32 s33, s33, s42
s_mul_i32 s33, s33, 114688
s_mul_i32 s41, s40, 7
s_lshr_b32 s41, s41, 1
s_lshl_b32 s41, s41, 10
s_add_u32 s33, s33, s41
v_mov_b32 v8, v3
v_add_u32 v9, 114688, v3
v_add_u32 v10, 229376, v3
v_add_u32 v11, 344064, v3
s_mov_b32 s52, 0xbfb8aa3b
s_mov_b32 s53, s52
s_mov_b32 s54, 1.0
s_mov_b32 s55, 1.0
s_bitcmp1_b32 s40, 0
s_cbranch_scc1 L_attn_kernel_gu_odd
v_accvgpr_read_b32 v40, a0
v_accvgpr_read_b32 v41, a1
v_accvgpr_read_b32 v42, a2
v_accvgpr_read_b32 v43, a3
v_accvgpr_read_b32 v44, a112
v_accvgpr_read_b32 v45, a113
v_accvgpr_read_b32 v46, a114
v_accvgpr_read_b32 v47, a115
v_pk_mul_f32 v[48:49], v[40:41], s[52:53]
v_pk_mul_f32 v[50:51], v[42:43], s[52:53]
v_exp_f32 v48, v48
v_exp_f32 v49, v49
v_exp_f32 v50, v50
v_exp_f32 v51, v51
v_pk_mul_f32 v[40:41], v[40:41], v[44:45]
v_pk_mul_f32 v[42:43], v[42:43], v[46:47]
v_pk_add_f32 v[48:49], v[48:49], s[54:55]
v_pk_add_f32 v[50:51], v[50:51], s[54:55]
v_rcp_f32 v48, v48
v_rcp_f32 v49, v49
v_rcp_f32 v50, v50
v_rcp_f32 v51, v51
s_nop 0
v_pk_mul_f32 v[40:41], v[40:41], v[48:49]
v_pk_mul_f32 v[42:43], v[42:43], v[50:51]
v_cvt_pk_bf16_f32 v64, v40, v41
v_cvt_pk_bf16_f32 v65, v42, v43
v_accvgpr_read_b32 v52, a16
v_accvgpr_read_b32 v53, a17
v_accvgpr_read_b32 v54, a18
v_accvgpr_read_b32 v55, a19
v_accvgpr_read_b32 v56, a128
v_accvgpr_read_b32 v57, a129
v_accvgpr_read_b32 v58, a130
v_accvgpr_read_b32 v59, a131
v_pk_mul_f32 v[60:61], v[52:53], s[52:53]
v_pk_mul_f32 v[62:63], v[54:55], s[52:53]
v_exp_f32 v60, v60
v_exp_f32 v61, v61
v_exp_f32 v62, v62
v_exp_f32 v63, v63
v_pk_mul_f32 v[52:53], v[52:53], v[56:57]
v_pk_mul_f32 v[54:55], v[54:55], v[58:59]
v_pk_add_f32 v[60:61], v[60:61], s[54:55]
v_pk_add_f32 v[62:63], v[62:63], s[54:55]
v_rcp_f32 v60, v60
v_rcp_f32 v61, v61
v_rcp_f32 v62, v62
v_rcp_f32 v63, v63
s_nop 0
v_pk_mul_f32 v[52:53], v[52:53], v[60:61]
v_pk_mul_f32 v[54:55], v[54:55], v[62:63]
v_cvt_pk_bf16_f32 v66, v52, v53
v_cvt_pk_bf16_f32 v67, v54, v55
buffer_store_dwordx4 v[64:67], v8, s[20:23], s33 offen offset:0 sc1
v_accvgpr_read_b32 v72, a4
v_accvgpr_read_b32 v73, a5
v_accvgpr_read_b32 v74, a6
v_accvgpr_read_b32 v75, a7
v_accvgpr_read_b32 v76, a116
v_accvgpr_read_b32 v77, a117
v_accvgpr_read_b32 v78, a118
v_accvgpr_read_b32 v79, a119
v_pk_mul_f32 v[80:81], v[72:73], s[52:53]
v_pk_mul_f32 v[82:83], v[74:75], s[52:53]
v_exp_f32 v80, v80
v_exp_f32 v81, v81
v_exp_f32 v82, v82
v_exp_f32 v83, v83
v_pk_mul_f32 v[72:73], v[72:73], v[76:77]
v_pk_mul_f32 v[74:75], v[74:75], v[78:79]
v_pk_add_f32 v[80:81], v[80:81], s[54:55]
v_pk_add_f32 v[82:83], v[82:83], s[54:55]
v_rcp_f32 v80, v80
v_rcp_f32 v81, v81
v_rcp_f32 v82, v82
v_rcp_f32 v83, v83
s_nop 0
v_pk_mul_f32 v[72:73], v[72:73], v[80:81]
v_pk_mul_f32 v[74:75], v[74:75], v[82:83]
v_cvt_pk_bf16_f32 v96, v72, v73
v_cvt_pk_bf16_f32 v97, v74, v75
v_accvgpr_read_b32 v84, a20
v_accvgpr_read_b32 v85, a21
v_accvgpr_read_b32 v86, a22
v_accvgpr_read_b32 v87, a23
v_accvgpr_read_b32 v88, a132
v_accvgpr_read_b32 v89, a133
v_accvgpr_read_b32 v90, a134
v_accvgpr_read_b32 v91, a135
v_pk_mul_f32 v[92:93], v[84:85], s[52:53]
v_pk_mul_f32 v[94:95], v[86:87], s[52:53]
v_exp_f32 v92, v92
v_exp_f32 v93, v93
v_exp_f32 v94, v94
v_exp_f32 v95, v95
v_pk_mul_f32 v[84:85], v[84:85], v[88:89]
v_pk_mul_f32 v[86:87], v[86:87], v[90:91]
v_pk_add_f32 v[92:93], v[92:93], s[54:55]
v_pk_add_f32 v[94:95], v[94:95], s[54:55]
v_rcp_f32 v92, v92
v_rcp_f32 v93, v93
v_rcp_f32 v94, v94
v_rcp_f32 v95, v95
s_nop 0
v_pk_mul_f32 v[84:85], v[84:85], v[92:93]
v_pk_mul_f32 v[86:87], v[86:87], v[94:95]
v_cvt_pk_bf16_f32 v98, v84, v85
v_cvt_pk_bf16_f32 v99, v86, v87
buffer_store_dwordx4 v[96:99], v9, s[20:23], s33 offen offset:0 sc1
v_accvgpr_read_b32 v104, a8
v_accvgpr_read_b32 v105, a9
v_accvgpr_read_b32 v106, a10
v_accvgpr_read_b32 v107, a11
v_accvgpr_read_b32 v108, a120
v_accvgpr_read_b32 v109, a121
v_accvgpr_read_b32 v110, a122
v_accvgpr_read_b32 v111, a123
v_pk_mul_f32 v[112:113], v[104:105], s[52:53]
v_pk_mul_f32 v[114:115], v[106:107], s[52:53]
v_exp_f32 v112, v112
v_exp_f32 v113, v113
v_exp_f32 v114, v114
v_exp_f32 v115, v115
v_pk_mul_f32 v[104:105], v[104:105], v[108:109]
v_pk_mul_f32 v[106:107], v[106:107], v[110:111]
v_pk_add_f32 v[112:113], v[112:113], s[54:55]
v_pk_add_f32 v[114:115], v[114:115], s[54:55]
v_rcp_f32 v112, v112
v_rcp_f32 v113, v113
v_rcp_f32 v114, v114
v_rcp_f32 v115, v115
s_nop 0
v_pk_mul_f32 v[104:105], v[104:105], v[112:113]
v_pk_mul_f32 v[106:107], v[106:107], v[114:115]
v_cvt_pk_bf16_f32 v128, v104, v105
v_cvt_pk_bf16_f32 v129, v106, v107
v_accvgpr_read_b32 v116, a24
v_accvgpr_read_b32 v117, a25
v_accvgpr_read_b32 v118, a26
v_accvgpr_read_b32 v119, a27
v_accvgpr_read_b32 v120, a136
v_accvgpr_read_b32 v121, a137
v_accvgpr_read_b32 v122, a138
v_accvgpr_read_b32 v123, a139
v_pk_mul_f32 v[124:125], v[116:117], s[52:53]
v_pk_mul_f32 v[126:127], v[118:119], s[52:53]
v_exp_f32 v124, v124
v_exp_f32 v125, v125
v_exp_f32 v126, v126
v_exp_f32 v127, v127
v_pk_mul_f32 v[116:117], v[116:117], v[120:121]
v_pk_mul_f32 v[118:119], v[118:119], v[122:123]
v_pk_add_f32 v[124:125], v[124:125], s[54:55]
v_pk_add_f32 v[126:127], v[126:127], s[54:55]
v_rcp_f32 v124, v124
v_rcp_f32 v125, v125
v_rcp_f32 v126, v126
v_rcp_f32 v127, v127
s_nop 0
v_pk_mul_f32 v[116:117], v[116:117], v[124:125]
v_pk_mul_f32 v[118:119], v[118:119], v[126:127]
v_cvt_pk_bf16_f32 v130, v116, v117
v_cvt_pk_bf16_f32 v131, v118, v119
buffer_store_dwordx4 v[128:131], v10, s[20:23], s33 offen offset:0 sc1
v_accvgpr_read_b32 v136, a12
v_accvgpr_read_b32 v137, a13
v_accvgpr_read_b32 v138, a14
v_accvgpr_read_b32 v139, a15
v_accvgpr_read_b32 v140, a124
v_accvgpr_read_b32 v141, a125
v_accvgpr_read_b32 v142, a126
v_accvgpr_read_b32 v143, a127
v_pk_mul_f32 v[144:145], v[136:137], s[52:53]
v_pk_mul_f32 v[146:147], v[138:139], s[52:53]
v_exp_f32 v144, v144
v_exp_f32 v145, v145
v_exp_f32 v146, v146
v_exp_f32 v147, v147
v_pk_mul_f32 v[136:137], v[136:137], v[140:141]
v_pk_mul_f32 v[138:139], v[138:139], v[142:143]
v_pk_add_f32 v[144:145], v[144:145], s[54:55]
v_pk_add_f32 v[146:147], v[146:147], s[54:55]
v_rcp_f32 v144, v144
v_rcp_f32 v145, v145
v_rcp_f32 v146, v146
v_rcp_f32 v147, v147
s_nop 0
v_pk_mul_f32 v[136:137], v[136:137], v[144:145]
v_pk_mul_f32 v[138:139], v[138:139], v[146:147]
v_cvt_pk_bf16_f32 v160, v136, v137
v_cvt_pk_bf16_f32 v161, v138, v139
v_accvgpr_read_b32 v148, a28
v_accvgpr_read_b32 v149, a29
v_accvgpr_read_b32 v150, a30
v_accvgpr_read_b32 v151, a31
v_accvgpr_read_b32 v152, a140
v_accvgpr_read_b32 v153, a141
v_accvgpr_read_b32 v154, a142
v_accvgpr_read_b32 v155, a143
v_pk_mul_f32 v[156:157], v[148:149], s[52:53]
v_pk_mul_f32 v[158:159], v[150:151], s[52:53]
v_exp_f32 v156, v156
v_exp_f32 v157, v157
v_exp_f32 v158, v158
v_exp_f32 v159, v159
v_pk_mul_f32 v[148:149], v[148:149], v[152:153]
v_pk_mul_f32 v[150:151], v[150:151], v[154:155]
v_pk_add_f32 v[156:157], v[156:157], s[54:55]
v_pk_add_f32 v[158:159], v[158:159], s[54:55]
v_rcp_f32 v156, v156
v_rcp_f32 v157, v157
v_rcp_f32 v158, v158
v_rcp_f32 v159, v159
s_nop 0
v_pk_mul_f32 v[148:149], v[148:149], v[156:157]
v_pk_mul_f32 v[150:151], v[150:151], v[158:159]
v_cvt_pk_bf16_f32 v162, v148, v149
v_cvt_pk_bf16_f32 v163, v150, v151
buffer_store_dwordx4 v[160:163], v11, s[20:23], s33 offen offset:0 sc1
v_accvgpr_read_b32 v40, a32
v_accvgpr_read_b32 v41, a33
v_accvgpr_read_b32 v42, a34
v_accvgpr_read_b32 v43, a35
v_accvgpr_read_b32 v44, a144
v_accvgpr_read_b32 v45, a145
v_accvgpr_read_b32 v46, a146
v_accvgpr_read_b32 v47, a147
v_pk_mul_f32 v[48:49], v[40:41], s[52:53]
v_pk_mul_f32 v[50:51], v[42:43], s[52:53]
v_exp_f32 v48, v48
v_exp_f32 v49, v49
v_exp_f32 v50, v50
v_exp_f32 v51, v51
v_pk_mul_f32 v[40:41], v[40:41], v[44:45]
v_pk_mul_f32 v[42:43], v[42:43], v[46:47]
v_pk_add_f32 v[48:49], v[48:49], s[54:55]
v_pk_add_f32 v[50:51], v[50:51], s[54:55]
v_rcp_f32 v48, v48
v_rcp_f32 v49, v49
v_rcp_f32 v50, v50
v_rcp_f32 v51, v51
s_nop 0
v_pk_mul_f32 v[40:41], v[40:41], v[48:49]
v_pk_mul_f32 v[42:43], v[42:43], v[50:51]
v_cvt_pk_bf16_f32 v64, v40, v41
v_cvt_pk_bf16_f32 v65, v42, v43
v_accvgpr_read_b32 v52, a48
v_accvgpr_read_b32 v53, a49
v_accvgpr_read_b32 v54, a50
v_accvgpr_read_b32 v55, a51
v_accvgpr_read_b32 v56, a160
v_accvgpr_read_b32 v57, a161
v_accvgpr_read_b32 v58, a162
v_accvgpr_read_b32 v59, a163
v_pk_mul_f32 v[60:61], v[52:53], s[52:53]
v_pk_mul_f32 v[62:63], v[54:55], s[52:53]
v_exp_f32 v60, v60
v_exp_f32 v61, v61
v_exp_f32 v62, v62
v_exp_f32 v63, v63
v_pk_mul_f32 v[52:53], v[52:53], v[56:57]
v_pk_mul_f32 v[54:55], v[54:55], v[58:59]
v_pk_add_f32 v[60:61], v[60:61], s[54:55]
v_pk_add_f32 v[62:63], v[62:63], s[54:55]
v_rcp_f32 v60, v60
v_rcp_f32 v61, v61
v_rcp_f32 v62, v62
v_rcp_f32 v63, v63
s_nop 0
v_pk_mul_f32 v[52:53], v[52:53], v[60:61]
v_pk_mul_f32 v[54:55], v[54:55], v[62:63]
v_cvt_pk_bf16_f32 v66, v52, v53
v_cvt_pk_bf16_f32 v67, v54, v55
buffer_store_dwordx4 v[64:67], v8, s[20:23], s33 offen offset:1024 sc1
v_accvgpr_read_b32 v72, a36
v_accvgpr_read_b32 v73, a37
v_accvgpr_read_b32 v74, a38
v_accvgpr_read_b32 v75, a39
v_accvgpr_read_b32 v76, a148
v_accvgpr_read_b32 v77, a149
v_accvgpr_read_b32 v78, a150
v_accvgpr_read_b32 v79, a151
v_pk_mul_f32 v[80:81], v[72:73], s[52:53]
v_pk_mul_f32 v[82:83], v[74:75], s[52:53]
v_exp_f32 v80, v80
v_exp_f32 v81, v81
v_exp_f32 v82, v82
v_exp_f32 v83, v83
v_pk_mul_f32 v[72:73], v[72:73], v[76:77]
v_pk_mul_f32 v[74:75], v[74:75], v[78:79]
v_pk_add_f32 v[80:81], v[80:81], s[54:55]
v_pk_add_f32 v[82:83], v[82:83], s[54:55]
v_rcp_f32 v80, v80
v_rcp_f32 v81, v81
v_rcp_f32 v82, v82
v_rcp_f32 v83, v83
s_nop 0
v_pk_mul_f32 v[72:73], v[72:73], v[80:81]
v_pk_mul_f32 v[74:75], v[74:75], v[82:83]
v_cvt_pk_bf16_f32 v96, v72, v73
v_cvt_pk_bf16_f32 v97, v74, v75
v_accvgpr_read_b32 v84, a52
v_accvgpr_read_b32 v85, a53
v_accvgpr_read_b32 v86, a54
v_accvgpr_read_b32 v87, a55
v_accvgpr_read_b32 v88, a164
v_accvgpr_read_b32 v89, a165
v_accvgpr_read_b32 v90, a166
v_accvgpr_read_b32 v91, a167
v_pk_mul_f32 v[92:93], v[84:85], s[52:53]
v_pk_mul_f32 v[94:95], v[86:87], s[52:53]
v_exp_f32 v92, v92
v_exp_f32 v93, v93
v_exp_f32 v94, v94
v_exp_f32 v95, v95
v_pk_mul_f32 v[84:85], v[84:85], v[88:89]
v_pk_mul_f32 v[86:87], v[86:87], v[90:91]
v_pk_add_f32 v[92:93], v[92:93], s[54:55]
v_pk_add_f32 v[94:95], v[94:95], s[54:55]
v_rcp_f32 v92, v92
v_rcp_f32 v93, v93
v_rcp_f32 v94, v94
v_rcp_f32 v95, v95
s_nop 0
v_pk_mul_f32 v[84:85], v[84:85], v[92:93]
v_pk_mul_f32 v[86:87], v[86:87], v[94:95]
v_cvt_pk_bf16_f32 v98, v84, v85
v_cvt_pk_bf16_f32 v99, v86, v87
buffer_store_dwordx4 v[96:99], v9, s[20:23], s33 offen offset:1024 sc1
v_accvgpr_read_b32 v104, a40
v_accvgpr_read_b32 v105, a41
v_accvgpr_read_b32 v106, a42
v_accvgpr_read_b32 v107, a43
v_accvgpr_read_b32 v108, a152
v_accvgpr_read_b32 v109, a153
v_accvgpr_read_b32 v110, a154
v_accvgpr_read_b32 v111, a155
v_pk_mul_f32 v[112:113], v[104:105], s[52:53]
v_pk_mul_f32 v[114:115], v[106:107], s[52:53]
v_exp_f32 v112, v112
v_exp_f32 v113, v113
v_exp_f32 v114, v114
v_exp_f32 v115, v115
v_pk_mul_f32 v[104:105], v[104:105], v[108:109]
v_pk_mul_f32 v[106:107], v[106:107], v[110:111]
v_pk_add_f32 v[112:113], v[112:113], s[54:55]
v_pk_add_f32 v[114:115], v[114:115], s[54:55]
v_rcp_f32 v112, v112
v_rcp_f32 v113, v113
v_rcp_f32 v114, v114
v_rcp_f32 v115, v115
s_nop 0
v_pk_mul_f32 v[104:105], v[104:105], v[112:113]
v_pk_mul_f32 v[106:107], v[106:107], v[114:115]
v_cvt_pk_bf16_f32 v128, v104, v105
v_cvt_pk_bf16_f32 v129, v106, v107
v_accvgpr_read_b32 v116, a56
v_accvgpr_read_b32 v117, a57
v_accvgpr_read_b32 v118, a58
v_accvgpr_read_b32 v119, a59
v_accvgpr_read_b32 v120, a168
v_accvgpr_read_b32 v121, a169
v_accvgpr_read_b32 v122, a170
v_accvgpr_read_b32 v123, a171
v_pk_mul_f32 v[124:125], v[116:117], s[52:53]
v_pk_mul_f32 v[126:127], v[118:119], s[52:53]
v_exp_f32 v124, v124
v_exp_f32 v125, v125
v_exp_f32 v126, v126
v_exp_f32 v127, v127
v_pk_mul_f32 v[116:117], v[116:117], v[120:121]
v_pk_mul_f32 v[118:119], v[118:119], v[122:123]
v_pk_add_f32 v[124:125], v[124:125], s[54:55]
v_pk_add_f32 v[126:127], v[126:127], s[54:55]
v_rcp_f32 v124, v124
v_rcp_f32 v125, v125
v_rcp_f32 v126, v126
v_rcp_f32 v127, v127
s_nop 0
v_pk_mul_f32 v[116:117], v[116:117], v[124:125]
v_pk_mul_f32 v[118:119], v[118:119], v[126:127]
v_cvt_pk_bf16_f32 v130, v116, v117
v_cvt_pk_bf16_f32 v131, v118, v119
buffer_store_dwordx4 v[128:131], v10, s[20:23], s33 offen offset:1024 sc1
v_accvgpr_read_b32 v136, a44
v_accvgpr_read_b32 v137, a45
v_accvgpr_read_b32 v138, a46
v_accvgpr_read_b32 v139, a47
v_accvgpr_read_b32 v140, a156
v_accvgpr_read_b32 v141, a157
v_accvgpr_read_b32 v142, a158
v_accvgpr_read_b32 v143, a159
v_pk_mul_f32 v[144:145], v[136:137], s[52:53]
v_pk_mul_f32 v[146:147], v[138:139], s[52:53]
v_exp_f32 v144, v144
v_exp_f32 v145, v145
v_exp_f32 v146, v146
v_exp_f32 v147, v147
v_pk_mul_f32 v[136:137], v[136:137], v[140:141]
v_pk_mul_f32 v[138:139], v[138:139], v[142:143]
v_pk_add_f32 v[144:145], v[144:145], s[54:55]
v_pk_add_f32 v[146:147], v[146:147], s[54:55]
v_rcp_f32 v144, v144
v_rcp_f32 v145, v145
v_rcp_f32 v146, v146
v_rcp_f32 v147, v147
s_nop 0
v_pk_mul_f32 v[136:137], v[136:137], v[144:145]
v_pk_mul_f32 v[138:139], v[138:139], v[146:147]
v_cvt_pk_bf16_f32 v160, v136, v137
v_cvt_pk_bf16_f32 v161, v138, v139
v_accvgpr_read_b32 v148, a60
v_accvgpr_read_b32 v149, a61
v_accvgpr_read_b32 v150, a62
v_accvgpr_read_b32 v151, a63
v_accvgpr_read_b32 v152, a172
v_accvgpr_read_b32 v153, a173
v_accvgpr_read_b32 v154, a174
v_accvgpr_read_b32 v155, a175
v_pk_mul_f32 v[156:157], v[148:149], s[52:53]
v_pk_mul_f32 v[158:159], v[150:151], s[52:53]
v_exp_f32 v156, v156
v_exp_f32 v157, v157
v_exp_f32 v158, v158
v_exp_f32 v159, v159
v_pk_mul_f32 v[148:149], v[148:149], v[152:153]
v_pk_mul_f32 v[150:151], v[150:151], v[154:155]
v_pk_add_f32 v[156:157], v[156:157], s[54:55]
v_pk_add_f32 v[158:159], v[158:159], s[54:55]
v_rcp_f32 v156, v156
v_rcp_f32 v157, v157
v_rcp_f32 v158, v158
v_rcp_f32 v159, v159
s_nop 0
v_pk_mul_f32 v[148:149], v[148:149], v[156:157]
v_pk_mul_f32 v[150:151], v[150:151], v[158:159]
v_cvt_pk_bf16_f32 v162, v148, v149
v_cvt_pk_bf16_f32 v163, v150, v151
buffer_store_dwordx4 v[160:163], v11, s[20:23], s33 offen offset:1024 sc1
v_accvgpr_read_b32 v40, a64
v_accvgpr_read_b32 v41, a65
v_accvgpr_read_b32 v42, a66
v_accvgpr_read_b32 v43, a67
v_accvgpr_read_b32 v44, a176
v_accvgpr_read_b32 v45, a177
v_accvgpr_read_b32 v46, a178
v_accvgpr_read_b32 v47, a179
v_pk_mul_f32 v[48:49], v[40:41], s[52:53]
v_pk_mul_f32 v[50:51], v[42:43], s[52:53]
v_exp_f32 v48, v48
v_exp_f32 v49, v49
v_exp_f32 v50, v50
v_exp_f32 v51, v51
v_pk_mul_f32 v[40:41], v[40:41], v[44:45]
v_pk_mul_f32 v[42:43], v[42:43], v[46:47]
v_pk_add_f32 v[48:49], v[48:49], s[54:55]
v_pk_add_f32 v[50:51], v[50:51], s[54:55]
v_rcp_f32 v48, v48
v_rcp_f32 v49, v49
v_rcp_f32 v50, v50
v_rcp_f32 v51, v51
s_nop 0
v_pk_mul_f32 v[40:41], v[40:41], v[48:49]
v_pk_mul_f32 v[42:43], v[42:43], v[50:51]
v_cvt_pk_bf16_f32 v64, v40, v41
v_cvt_pk_bf16_f32 v65, v42, v43
v_accvgpr_read_b32 v52, a80
v_accvgpr_read_b32 v53, a81
v_accvgpr_read_b32 v54, a82
v_accvgpr_read_b32 v55, a83
v_accvgpr_read_b32 v56, a192
v_accvgpr_read_b32 v57, a193
v_accvgpr_read_b32 v58, a194
v_accvgpr_read_b32 v59, a195
v_pk_mul_f32 v[60:61], v[52:53], s[52:53]
v_pk_mul_f32 v[62:63], v[54:55], s[52:53]
v_exp_f32 v60, v60
v_exp_f32 v61, v61
v_exp_f32 v62, v62
v_exp_f32 v63, v63
v_pk_mul_f32 v[52:53], v[52:53], v[56:57]
v_pk_mul_f32 v[54:55], v[54:55], v[58:59]
v_pk_add_f32 v[60:61], v[60:61], s[54:55]
v_pk_add_f32 v[62:63], v[62:63], s[54:55]
v_rcp_f32 v60, v60
v_rcp_f32 v61, v61
v_rcp_f32 v62, v62
v_rcp_f32 v63, v63
s_nop 0
v_pk_mul_f32 v[52:53], v[52:53], v[60:61]
v_pk_mul_f32 v[54:55], v[54:55], v[62:63]
v_cvt_pk_bf16_f32 v66, v52, v53
v_cvt_pk_bf16_f32 v67, v54, v55
buffer_store_dwordx4 v[64:67], v8, s[20:23], s33 offen offset:2048 sc1
v_accvgpr_read_b32 v72, a68
v_accvgpr_read_b32 v73, a69
v_accvgpr_read_b32 v74, a70
v_accvgpr_read_b32 v75, a71
v_accvgpr_read_b32 v76, a180
v_accvgpr_read_b32 v77, a181
v_accvgpr_read_b32 v78, a182
v_accvgpr_read_b32 v79, a183
v_pk_mul_f32 v[80:81], v[72:73], s[52:53]
v_pk_mul_f32 v[82:83], v[74:75], s[52:53]
v_exp_f32 v80, v80
v_exp_f32 v81, v81
v_exp_f32 v82, v82
v_exp_f32 v83, v83
v_pk_mul_f32 v[72:73], v[72:73], v[76:77]
v_pk_mul_f32 v[74:75], v[74:75], v[78:79]
v_pk_add_f32 v[80:81], v[80:81], s[54:55]
v_pk_add_f32 v[82:83], v[82:83], s[54:55]
v_rcp_f32 v80, v80
v_rcp_f32 v81, v81
v_rcp_f32 v82, v82
v_rcp_f32 v83, v83
s_nop 0
v_pk_mul_f32 v[72:73], v[72:73], v[80:81]
v_pk_mul_f32 v[74:75], v[74:75], v[82:83]
v_cvt_pk_bf16_f32 v96, v72, v73
v_cvt_pk_bf16_f32 v97, v74, v75
v_accvgpr_read_b32 v84, a84
v_accvgpr_read_b32 v85, a85
v_accvgpr_read_b32 v86, a86
v_accvgpr_read_b32 v87, a87
v_accvgpr_read_b32 v88, a196
v_accvgpr_read_b32 v89, a197
v_accvgpr_read_b32 v90, a198
v_accvgpr_read_b32 v91, a199
v_pk_mul_f32 v[92:93], v[84:85], s[52:53]
v_pk_mul_f32 v[94:95], v[86:87], s[52:53]
v_exp_f32 v92, v92
v_exp_f32 v93, v93
v_exp_f32 v94, v94
v_exp_f32 v95, v95
v_pk_mul_f32 v[84:85], v[84:85], v[88:89]
v_pk_mul_f32 v[86:87], v[86:87], v[90:91]
v_pk_add_f32 v[92:93], v[92:93], s[54:55]
v_pk_add_f32 v[94:95], v[94:95], s[54:55]
v_rcp_f32 v92, v92
v_rcp_f32 v93, v93
v_rcp_f32 v94, v94
v_rcp_f32 v95, v95
s_nop 0
v_pk_mul_f32 v[84:85], v[84:85], v[92:93]
v_pk_mul_f32 v[86:87], v[86:87], v[94:95]
v_cvt_pk_bf16_f32 v98, v84, v85
v_cvt_pk_bf16_f32 v99, v86, v87
buffer_store_dwordx4 v[96:99], v9, s[20:23], s33 offen offset:2048 sc1
v_accvgpr_read_b32 v104, a72
v_accvgpr_read_b32 v105, a73
v_accvgpr_read_b32 v106, a74
v_accvgpr_read_b32 v107, a75
v_accvgpr_read_b32 v108, a184
v_accvgpr_read_b32 v109, a185
v_accvgpr_read_b32 v110, a186
v_accvgpr_read_b32 v111, a187
v_pk_mul_f32 v[112:113], v[104:105], s[52:53]
v_pk_mul_f32 v[114:115], v[106:107], s[52:53]
v_exp_f32 v112, v112
v_exp_f32 v113, v113
v_exp_f32 v114, v114
v_exp_f32 v115, v115
v_pk_mul_f32 v[104:105], v[104:105], v[108:109]
v_pk_mul_f32 v[106:107], v[106:107], v[110:111]
v_pk_add_f32 v[112:113], v[112:113], s[54:55]
v_pk_add_f32 v[114:115], v[114:115], s[54:55]
v_rcp_f32 v112, v112
v_rcp_f32 v113, v113
v_rcp_f32 v114, v114
v_rcp_f32 v115, v115
s_nop 0
v_pk_mul_f32 v[104:105], v[104:105], v[112:113]
v_pk_mul_f32 v[106:107], v[106:107], v[114:115]
v_cvt_pk_bf16_f32 v128, v104, v105
v_cvt_pk_bf16_f32 v129, v106, v107
v_accvgpr_read_b32 v116, a88
v_accvgpr_read_b32 v117, a89
v_accvgpr_read_b32 v118, a90
v_accvgpr_read_b32 v119, a91
v_accvgpr_read_b32 v120, a200
v_accvgpr_read_b32 v121, a201
v_accvgpr_read_b32 v122, a202
v_accvgpr_read_b32 v123, a203
v_pk_mul_f32 v[124:125], v[116:117], s[52:53]
v_pk_mul_f32 v[126:127], v[118:119], s[52:53]
v_exp_f32 v124, v124
v_exp_f32 v125, v125
v_exp_f32 v126, v126
v_exp_f32 v127, v127
v_pk_mul_f32 v[116:117], v[116:117], v[120:121]
v_pk_mul_f32 v[118:119], v[118:119], v[122:123]
v_pk_add_f32 v[124:125], v[124:125], s[54:55]
v_pk_add_f32 v[126:127], v[126:127], s[54:55]
v_rcp_f32 v124, v124
v_rcp_f32 v125, v125
v_rcp_f32 v126, v126
v_rcp_f32 v127, v127
s_nop 0
v_pk_mul_f32 v[116:117], v[116:117], v[124:125]
v_pk_mul_f32 v[118:119], v[118:119], v[126:127]
v_cvt_pk_bf16_f32 v130, v116, v117
v_cvt_pk_bf16_f32 v131, v118, v119
buffer_store_dwordx4 v[128:131], v10, s[20:23], s33 offen offset:2048 sc1
v_accvgpr_read_b32 v136, a76
v_accvgpr_read_b32 v137, a77
v_accvgpr_read_b32 v138, a78
v_accvgpr_read_b32 v139, a79
v_accvgpr_read_b32 v140, a188
v_accvgpr_read_b32 v141, a189
v_accvgpr_read_b32 v142, a190
v_accvgpr_read_b32 v143, a191
v_pk_mul_f32 v[144:145], v[136:137], s[52:53]
v_pk_mul_f32 v[146:147], v[138:139], s[52:53]
v_exp_f32 v144, v144
v_exp_f32 v145, v145
v_exp_f32 v146, v146
v_exp_f32 v147, v147
v_pk_mul_f32 v[136:137], v[136:137], v[140:141]
v_pk_mul_f32 v[138:139], v[138:139], v[142:143]
v_pk_add_f32 v[144:145], v[144:145], s[54:55]
v_pk_add_f32 v[146:147], v[146:147], s[54:55]
v_rcp_f32 v144, v144
v_rcp_f32 v145, v145
v_rcp_f32 v146, v146
v_rcp_f32 v147, v147
s_nop 0
v_pk_mul_f32 v[136:137], v[136:137], v[144:145]
v_pk_mul_f32 v[138:139], v[138:139], v[146:147]
v_cvt_pk_bf16_f32 v160, v136, v137
v_cvt_pk_bf16_f32 v161, v138, v139
v_accvgpr_read_b32 v148, a92
v_accvgpr_read_b32 v149, a93
v_accvgpr_read_b32 v150, a94
v_accvgpr_read_b32 v151, a95
v_accvgpr_read_b32 v152, a204
v_accvgpr_read_b32 v153, a205
v_accvgpr_read_b32 v154, a206
v_accvgpr_read_b32 v155, a207
v_pk_mul_f32 v[156:157], v[148:149], s[52:53]
v_pk_mul_f32 v[158:159], v[150:151], s[52:53]
v_exp_f32 v156, v156
v_exp_f32 v157, v157
v_exp_f32 v158, v158
v_exp_f32 v159, v159
v_pk_mul_f32 v[148:149], v[148:149], v[152:153]
v_pk_mul_f32 v[150:151], v[150:151], v[154:155]
v_pk_add_f32 v[156:157], v[156:157], s[54:55]
v_pk_add_f32 v[158:159], v[158:159], s[54:55]
v_rcp_f32 v156, v156
v_rcp_f32 v157, v157
v_rcp_f32 v158, v158
v_rcp_f32 v159, v159
s_nop 0
v_pk_mul_f32 v[148:149], v[148:149], v[156:157]
v_pk_mul_f32 v[150:151], v[150:151], v[158:159]
v_cvt_pk_bf16_f32 v162, v148, v149
v_cvt_pk_bf16_f32 v163, v150, v151
buffer_store_dwordx4 v[160:163], v11, s[20:23], s33 offen offset:2048 sc1
v_accvgpr_read_b32 v40, a96
v_accvgpr_read_b32 v41, a97
v_accvgpr_read_b32 v42, a98
v_accvgpr_read_b32 v43, a99
v_accvgpr_read_b32 v44, a208
v_accvgpr_read_b32 v45, a209
v_accvgpr_read_b32 v46, a210
v_accvgpr_read_b32 v47, a211
v_pk_mul_f32 v[48:49], v[40:41], s[52:53]
v_pk_mul_f32 v[50:51], v[42:43], s[52:53]
v_exp_f32 v48, v48
v_exp_f32 v49, v49
v_exp_f32 v50, v50
v_exp_f32 v51, v51
v_pk_mul_f32 v[40:41], v[40:41], v[44:45]
v_pk_mul_f32 v[42:43], v[42:43], v[46:47]
v_pk_add_f32 v[48:49], v[48:49], s[54:55]
v_pk_add_f32 v[50:51], v[50:51], s[54:55]
v_rcp_f32 v48, v48
v_rcp_f32 v49, v49
v_rcp_f32 v50, v50
v_rcp_f32 v51, v51
s_nop 0
v_pk_mul_f32 v[40:41], v[40:41], v[48:49]
v_pk_mul_f32 v[42:43], v[42:43], v[50:51]
v_cvt_pk_bf16_f32 v64, v40, v41
v_cvt_pk_bf16_f32 v65, v42, v43
buffer_store_dwordx2 v[64:65], v8, s[20:23], s33 offen offset:3072 sc1
v_accvgpr_read_b32 v72, a100
v_accvgpr_read_b32 v73, a101
v_accvgpr_read_b32 v74, a102
v_accvgpr_read_b32 v75, a103
v_accvgpr_read_b32 v76, a212
v_accvgpr_read_b32 v77, a213
v_accvgpr_read_b32 v78, a214
v_accvgpr_read_b32 v79, a215
v_pk_mul_f32 v[80:81], v[72:73], s[52:53]
v_pk_mul_f32 v[82:83], v[74:75], s[52:53]
v_exp_f32 v80, v80
v_exp_f32 v81, v81
v_exp_f32 v82, v82
v_exp_f32 v83, v83
v_pk_mul_f32 v[72:73], v[72:73], v[76:77]
v_pk_mul_f32 v[74:75], v[74:75], v[78:79]
v_pk_add_f32 v[80:81], v[80:81], s[54:55]
v_pk_add_f32 v[82:83], v[82:83], s[54:55]
v_rcp_f32 v80, v80
v_rcp_f32 v81, v81
v_rcp_f32 v82, v82
v_rcp_f32 v83, v83
s_nop 0
v_pk_mul_f32 v[72:73], v[72:73], v[80:81]
v_pk_mul_f32 v[74:75], v[74:75], v[82:83]
v_cvt_pk_bf16_f32 v96, v72, v73
v_cvt_pk_bf16_f32 v97, v74, v75
buffer_store_dwordx2 v[96:97], v9, s[20:23], s33 offen offset:3072 sc1
v_accvgpr_read_b32 v104, a104
v_accvgpr_read_b32 v105, a105
v_accvgpr_read_b32 v106, a106
v_accvgpr_read_b32 v107, a107
v_accvgpr_read_b32 v108, a216
v_accvgpr_read_b32 v109, a217
v_accvgpr_read_b32 v110, a218
v_accvgpr_read_b32 v111, a219
v_pk_mul_f32 v[112:113], v[104:105], s[52:53]
v_pk_mul_f32 v[114:115], v[106:107], s[52:53]
v_exp_f32 v112, v112
v_exp_f32 v113, v113
v_exp_f32 v114, v114
v_exp_f32 v115, v115
v_pk_mul_f32 v[104:105], v[104:105], v[108:109]
v_pk_mul_f32 v[106:107], v[106:107], v[110:111]
v_pk_add_f32 v[112:113], v[112:113], s[54:55]
v_pk_add_f32 v[114:115], v[114:115], s[54:55]
v_rcp_f32 v112, v112
v_rcp_f32 v113, v113
v_rcp_f32 v114, v114
v_rcp_f32 v115, v115
s_nop 0
v_pk_mul_f32 v[104:105], v[104:105], v[112:113]
v_pk_mul_f32 v[106:107], v[106:107], v[114:115]
v_cvt_pk_bf16_f32 v128, v104, v105
v_cvt_pk_bf16_f32 v129, v106, v107
buffer_store_dwordx2 v[128:129], v10, s[20:23], s33 offen offset:3072 sc1
v_accvgpr_read_b32 v136, a108
v_accvgpr_read_b32 v137, a109
v_accvgpr_read_b32 v138, a110
v_accvgpr_read_b32 v139, a111
v_accvgpr_read_b32 v140, a220
v_accvgpr_read_b32 v141, a221
v_accvgpr_read_b32 v142, a222
v_accvgpr_read_b32 v143, a223
v_pk_mul_f32 v[144:145], v[136:137], s[52:53]
v_pk_mul_f32 v[146:147], v[138:139], s[52:53]
v_exp_f32 v144, v144
v_exp_f32 v145, v145
v_exp_f32 v146, v146
v_exp_f32 v147, v147
v_pk_mul_f32 v[136:137], v[136:137], v[140:141]
v_pk_mul_f32 v[138:139], v[138:139], v[142:143]
v_pk_add_f32 v[144:145], v[144:145], s[54:55]
v_pk_add_f32 v[146:147], v[146:147], s[54:55]
v_rcp_f32 v144, v144
v_rcp_f32 v145, v145
v_rcp_f32 v146, v146
v_rcp_f32 v147, v147
s_nop 0
v_pk_mul_f32 v[136:137], v[136:137], v[144:145]
v_pk_mul_f32 v[138:139], v[138:139], v[146:147]
v_cvt_pk_bf16_f32 v160, v136, v137
v_cvt_pk_bf16_f32 v161, v138, v139
buffer_store_dwordx2 v[160:161], v11, s[20:23], s33 offen offset:3072 sc1
s_branch L_attn_kernel_gu_epidone
L_attn_kernel_gu_odd:
v_accvgpr_read_b32 v40, a0
v_accvgpr_read_b32 v41, a1
v_accvgpr_read_b32 v42, a2
v_accvgpr_read_b32 v43, a3
v_accvgpr_read_b32 v44, a112
v_accvgpr_read_b32 v45, a113
v_accvgpr_read_b32 v46, a114
v_accvgpr_read_b32 v47, a115
v_pk_mul_f32 v[48:49], v[40:41], s[52:53]
v_pk_mul_f32 v[50:51], v[42:43], s[52:53]
v_exp_f32 v48, v48
v_exp_f32 v49, v49
v_exp_f32 v50, v50
v_exp_f32 v51, v51
v_pk_mul_f32 v[40:41], v[40:41], v[44:45]
v_pk_mul_f32 v[42:43], v[42:43], v[46:47]
v_pk_add_f32 v[48:49], v[48:49], s[54:55]
v_pk_add_f32 v[50:51], v[50:51], s[54:55]
v_rcp_f32 v48, v48
v_rcp_f32 v49, v49
v_rcp_f32 v50, v50
v_rcp_f32 v51, v51
s_nop 0
v_pk_mul_f32 v[40:41], v[40:41], v[48:49]
v_pk_mul_f32 v[42:43], v[42:43], v[50:51]
v_cvt_pk_bf16_f32 v64, v40, v41
v_cvt_pk_bf16_f32 v65, v42, v43
buffer_store_dwordx2 v[64:65], v8, s[20:23], s33 offen offset:8 sc1
v_accvgpr_read_b32 v72, a4
v_accvgpr_read_b32 v73, a5
v_accvgpr_read_b32 v74, a6
v_accvgpr_read_b32 v75, a7
v_accvgpr_read_b32 v76, a116
v_accvgpr_read_b32 v77, a117
v_accvgpr_read_b32 v78, a118
v_accvgpr_read_b32 v79, a119
v_pk_mul_f32 v[80:81], v[72:73], s[52:53]
v_pk_mul_f32 v[82:83], v[74:75], s[52:53]
v_exp_f32 v80, v80
v_exp_f32 v81, v81
v_exp_f32 v82, v82
v_exp_f32 v83, v83
v_pk_mul_f32 v[72:73], v[72:73], v[76:77]
v_pk_mul_f32 v[74:75], v[74:75], v[78:79]
v_pk_add_f32 v[80:81], v[80:81], s[54:55]
v_pk_add_f32 v[82:83], v[82:83], s[54:55]
v_rcp_f32 v80, v80
v_rcp_f32 v81, v81
v_rcp_f32 v82, v82
v_rcp_f32 v83, v83
s_nop 0
v_pk_mul_f32 v[72:73], v[72:73], v[80:81]
v_pk_mul_f32 v[74:75], v[74:75], v[82:83]
v_cvt_pk_bf16_f32 v96, v72, v73
v_cvt_pk_bf16_f32 v97, v74, v75
buffer_store_dwordx2 v[96:97], v9, s[20:23], s33 offen offset:8 sc1
v_accvgpr_read_b32 v104, a8
v_accvgpr_read_b32 v105, a9
v_accvgpr_read_b32 v106, a10
v_accvgpr_read_b32 v107, a11
v_accvgpr_read_b32 v108, a120
v_accvgpr_read_b32 v109, a121
v_accvgpr_read_b32 v110, a122
v_accvgpr_read_b32 v111, a123
v_pk_mul_f32 v[112:113], v[104:105], s[52:53]
v_pk_mul_f32 v[114:115], v[106:107], s[52:53]
v_exp_f32 v112, v112
v_exp_f32 v113, v113
v_exp_f32 v114, v114
v_exp_f32 v115, v115
v_pk_mul_f32 v[104:105], v[104:105], v[108:109]
v_pk_mul_f32 v[106:107], v[106:107], v[110:111]
v_pk_add_f32 v[112:113], v[112:113], s[54:55]
v_pk_add_f32 v[114:115], v[114:115], s[54:55]
v_rcp_f32 v112, v112
v_rcp_f32 v113, v113
v_rcp_f32 v114, v114
v_rcp_f32 v115, v115
s_nop 0
v_pk_mul_f32 v[104:105], v[104:105], v[112:113]
v_pk_mul_f32 v[106:107], v[106:107], v[114:115]
v_cvt_pk_bf16_f32 v128, v104, v105
v_cvt_pk_bf16_f32 v129, v106, v107
buffer_store_dwordx2 v[128:129], v10, s[20:23], s33 offen offset:8 sc1
v_accvgpr_read_b32 v136, a12
v_accvgpr_read_b32 v137, a13
v_accvgpr_read_b32 v138, a14
v_accvgpr_read_b32 v139, a15
v_accvgpr_read_b32 v140, a124
v_accvgpr_read_b32 v141, a125
v_accvgpr_read_b32 v142, a126
v_accvgpr_read_b32 v143, a127
v_pk_mul_f32 v[144:145], v[136:137], s[52:53]
v_pk_mul_f32 v[146:147], v[138:139], s[52:53]
v_exp_f32 v144, v144
v_exp_f32 v145, v145
v_exp_f32 v146, v146
v_exp_f32 v147, v147
v_pk_mul_f32 v[136:137], v[136:137], v[140:141]
v_pk_mul_f32 v[138:139], v[138:139], v[142:143]
v_pk_add_f32 v[144:145], v[144:145], s[54:55]
v_pk_add_f32 v[146:147], v[146:147], s[54:55]
v_rcp_f32 v144, v144
v_rcp_f32 v145, v145
v_rcp_f32 v146, v146
v_rcp_f32 v147, v147
s_nop 0
v_pk_mul_f32 v[136:137], v[136:137], v[144:145]
v_pk_mul_f32 v[138:139], v[138:139], v[146:147]
v_cvt_pk_bf16_f32 v160, v136, v137
v_cvt_pk_bf16_f32 v161, v138, v139
buffer_store_dwordx2 v[160:161], v11, s[20:23], s33 offen offset:8 sc1
v_accvgpr_read_b32 v40, a16
v_accvgpr_read_b32 v41, a17
v_accvgpr_read_b32 v42, a18
v_accvgpr_read_b32 v43, a19
v_accvgpr_read_b32 v44, a128
v_accvgpr_read_b32 v45, a129
v_accvgpr_read_b32 v46, a130
v_accvgpr_read_b32 v47, a131
v_pk_mul_f32 v[48:49], v[40:41], s[52:53]
v_pk_mul_f32 v[50:51], v[42:43], s[52:53]
v_exp_f32 v48, v48
v_exp_f32 v49, v49
v_exp_f32 v50, v50
v_exp_f32 v51, v51
v_pk_mul_f32 v[40:41], v[40:41], v[44:45]
v_pk_mul_f32 v[42:43], v[42:43], v[46:47]
v_pk_add_f32 v[48:49], v[48:49], s[54:55]
v_pk_add_f32 v[50:51], v[50:51], s[54:55]
v_rcp_f32 v48, v48
v_rcp_f32 v49, v49
v_rcp_f32 v50, v50
v_rcp_f32 v51, v51
s_nop 0
v_pk_mul_f32 v[40:41], v[40:41], v[48:49]
v_pk_mul_f32 v[42:43], v[42:43], v[50:51]
v_cvt_pk_bf16_f32 v64, v40, v41
v_cvt_pk_bf16_f32 v65, v42, v43
v_accvgpr_read_b32 v52, a32
v_accvgpr_read_b32 v53, a33
v_accvgpr_read_b32 v54, a34
v_accvgpr_read_b32 v55, a35
v_accvgpr_read_b32 v56, a144
v_accvgpr_read_b32 v57, a145
v_accvgpr_read_b32 v58, a146
v_accvgpr_read_b32 v59, a147
v_pk_mul_f32 v[60:61], v[52:53], s[52:53]
v_pk_mul_f32 v[62:63], v[54:55], s[52:53]
v_exp_f32 v60, v60
v_exp_f32 v61, v61
v_exp_f32 v62, v62
v_exp_f32 v63, v63
v_pk_mul_f32 v[52:53], v[52:53], v[56:57]
v_pk_mul_f32 v[54:55], v[54:55], v[58:59]
v_pk_add_f32 v[60:61], v[60:61], s[54:55]
v_pk_add_f32 v[62:63], v[62:63], s[54:55]
v_rcp_f32 v60, v60
v_rcp_f32 v61, v61
v_rcp_f32 v62, v62
v_rcp_f32 v63, v63
s_nop 0
v_pk_mul_f32 v[52:53], v[52:53], v[60:61]
v_pk_mul_f32 v[54:55], v[54:55], v[62:63]
v_cvt_pk_bf16_f32 v66, v52, v53
v_cvt_pk_bf16_f32 v67, v54, v55
buffer_store_dwordx4 v[64:67], v8, s[20:23], s33 offen offset:1024 sc1
v_accvgpr_read_b32 v72, a20
v_accvgpr_read_b32 v73, a21
v_accvgpr_read_b32 v74, a22
v_accvgpr_read_b32 v75, a23
v_accvgpr_read_b32 v76, a132
v_accvgpr_read_b32 v77, a133
v_accvgpr_read_b32 v78, a134
v_accvgpr_read_b32 v79, a135
v_pk_mul_f32 v[80:81], v[72:73], s[52:53]
v_pk_mul_f32 v[82:83], v[74:75], s[52:53]
v_exp_f32 v80, v80
v_exp_f32 v81, v81
v_exp_f32 v82, v82
v_exp_f32 v83, v83
v_pk_mul_f32 v[72:73], v[72:73], v[76:77]
v_pk_mul_f32 v[74:75], v[74:75], v[78:79]
v_pk_add_f32 v[80:81], v[80:81], s[54:55]
v_pk_add_f32 v[82:83], v[82:83], s[54:55]
v_rcp_f32 v80, v80
v_rcp_f32 v81, v81
v_rcp_f32 v82, v82
v_rcp_f32 v83, v83
s_nop 0
v_pk_mul_f32 v[72:73], v[72:73], v[80:81]
v_pk_mul_f32 v[74:75], v[74:75], v[82:83]
v_cvt_pk_bf16_f32 v96, v72, v73
v_cvt_pk_bf16_f32 v97, v74, v75
v_accvgpr_read_b32 v84, a36
v_accvgpr_read_b32 v85, a37
v_accvgpr_read_b32 v86, a38
v_accvgpr_read_b32 v87, a39
v_accvgpr_read_b32 v88, a148
v_accvgpr_read_b32 v89, a149
v_accvgpr_read_b32 v90, a150
v_accvgpr_read_b32 v91, a151
v_pk_mul_f32 v[92:93], v[84:85], s[52:53]
v_pk_mul_f32 v[94:95], v[86:87], s[52:53]
v_exp_f32 v92, v92
v_exp_f32 v93, v93
v_exp_f32 v94, v94
v_exp_f32 v95, v95
v_pk_mul_f32 v[84:85], v[84:85], v[88:89]
v_pk_mul_f32 v[86:87], v[86:87], v[90:91]
v_pk_add_f32 v[92:93], v[92:93], s[54:55]
v_pk_add_f32 v[94:95], v[94:95], s[54:55]
v_rcp_f32 v92, v92
v_rcp_f32 v93, v93
v_rcp_f32 v94, v94
v_rcp_f32 v95, v95
s_nop 0
v_pk_mul_f32 v[84:85], v[84:85], v[92:93]
v_pk_mul_f32 v[86:87], v[86:87], v[94:95]
v_cvt_pk_bf16_f32 v98, v84, v85
v_cvt_pk_bf16_f32 v99, v86, v87
buffer_store_dwordx4 v[96:99], v9, s[20:23], s33 offen offset:1024 sc1
v_accvgpr_read_b32 v104, a24
v_accvgpr_read_b32 v105, a25
v_accvgpr_read_b32 v106, a26
v_accvgpr_read_b32 v107, a27
v_accvgpr_read_b32 v108, a136
v_accvgpr_read_b32 v109, a137
v_accvgpr_read_b32 v110, a138
v_accvgpr_read_b32 v111, a139
v_pk_mul_f32 v[112:113], v[104:105], s[52:53]
v_pk_mul_f32 v[114:115], v[106:107], s[52:53]
v_exp_f32 v112, v112
v_exp_f32 v113, v113
v_exp_f32 v114, v114
v_exp_f32 v115, v115
v_pk_mul_f32 v[104:105], v[104:105], v[108:109]
v_pk_mul_f32 v[106:107], v[106:107], v[110:111]
v_pk_add_f32 v[112:113], v[112:113], s[54:55]
v_pk_add_f32 v[114:115], v[114:115], s[54:55]
v_rcp_f32 v112, v112
v_rcp_f32 v113, v113
v_rcp_f32 v114, v114
v_rcp_f32 v115, v115
s_nop 0
v_pk_mul_f32 v[104:105], v[104:105], v[112:113]
v_pk_mul_f32 v[106:107], v[106:107], v[114:115]
v_cvt_pk_bf16_f32 v128, v104, v105
v_cvt_pk_bf16_f32 v129, v106, v107
v_accvgpr_read_b32 v116, a40
v_accvgpr_read_b32 v117, a41
v_accvgpr_read_b32 v118, a42
v_accvgpr_read_b32 v119, a43
v_accvgpr_read_b32 v120, a152
v_accvgpr_read_b32 v121, a153
v_accvgpr_read_b32 v122, a154
v_accvgpr_read_b32 v123, a155
v_pk_mul_f32 v[124:125], v[116:117], s[52:53]
v_pk_mul_f32 v[126:127], v[118:119], s[52:53]
v_exp_f32 v124, v124
v_exp_f32 v125, v125
v_exp_f32 v126, v126
v_exp_f32 v127, v127
v_pk_mul_f32 v[116:117], v[116:117], v[120:121]
v_pk_mul_f32 v[118:119], v[118:119], v[122:123]
v_pk_add_f32 v[124:125], v[124:125], s[54:55]
v_pk_add_f32 v[126:127], v[126:127], s[54:55]
v_rcp_f32 v124, v124
v_rcp_f32 v125, v125
v_rcp_f32 v126, v126
v_rcp_f32 v127, v127
s_nop 0
v_pk_mul_f32 v[116:117], v[116:117], v[124:125]
v_pk_mul_f32 v[118:119], v[118:119], v[126:127]
v_cvt_pk_bf16_f32 v130, v116, v117
v_cvt_pk_bf16_f32 v131, v118, v119
buffer_store_dwordx4 v[128:131], v10, s[20:23], s33 offen offset:1024 sc1
v_accvgpr_read_b32 v136, a28
v_accvgpr_read_b32 v137, a29
v_accvgpr_read_b32 v138, a30
v_accvgpr_read_b32 v139, a31
v_accvgpr_read_b32 v140, a140
v_accvgpr_read_b32 v141, a141
v_accvgpr_read_b32 v142, a142
v_accvgpr_read_b32 v143, a143
v_pk_mul_f32 v[144:145], v[136:137], s[52:53]
v_pk_mul_f32 v[146:147], v[138:139], s[52:53]
v_exp_f32 v144, v144
v_exp_f32 v145, v145
v_exp_f32 v146, v146
v_exp_f32 v147, v147
v_pk_mul_f32 v[136:137], v[136:137], v[140:141]
v_pk_mul_f32 v[138:139], v[138:139], v[142:143]
v_pk_add_f32 v[144:145], v[144:145], s[54:55]
v_pk_add_f32 v[146:147], v[146:147], s[54:55]
v_rcp_f32 v144, v144
v_rcp_f32 v145, v145
v_rcp_f32 v146, v146
v_rcp_f32 v147, v147
s_nop 0
v_pk_mul_f32 v[136:137], v[136:137], v[144:145]
v_pk_mul_f32 v[138:139], v[138:139], v[146:147]
v_cvt_pk_bf16_f32 v160, v136, v137
v_cvt_pk_bf16_f32 v161, v138, v139
v_accvgpr_read_b32 v148, a44
v_accvgpr_read_b32 v149, a45
v_accvgpr_read_b32 v150, a46
v_accvgpr_read_b32 v151, a47
v_accvgpr_read_b32 v152, a156
v_accvgpr_read_b32 v153, a157
v_accvgpr_read_b32 v154, a158
v_accvgpr_read_b32 v155, a159
v_pk_mul_f32 v[156:157], v[148:149], s[52:53]
v_pk_mul_f32 v[158:159], v[150:151], s[52:53]
v_exp_f32 v156, v156
v_exp_f32 v157, v157
v_exp_f32 v158, v158
v_exp_f32 v159, v159
v_pk_mul_f32 v[148:149], v[148:149], v[152:153]
v_pk_mul_f32 v[150:151], v[150:151], v[154:155]
v_pk_add_f32 v[156:157], v[156:157], s[54:55]
v_pk_add_f32 v[158:159], v[158:159], s[54:55]
v_rcp_f32 v156, v156
v_rcp_f32 v157, v157
v_rcp_f32 v158, v158
v_rcp_f32 v159, v159
s_nop 0
v_pk_mul_f32 v[148:149], v[148:149], v[156:157]
v_pk_mul_f32 v[150:151], v[150:151], v[158:159]
v_cvt_pk_bf16_f32 v162, v148, v149
v_cvt_pk_bf16_f32 v163, v150, v151
buffer_store_dwordx4 v[160:163], v11, s[20:23], s33 offen offset:1024 sc1
v_accvgpr_read_b32 v40, a48
v_accvgpr_read_b32 v41, a49
v_accvgpr_read_b32 v42, a50
v_accvgpr_read_b32 v43, a51
v_accvgpr_read_b32 v44, a160
v_accvgpr_read_b32 v45, a161
v_accvgpr_read_b32 v46, a162
v_accvgpr_read_b32 v47, a163
v_pk_mul_f32 v[48:49], v[40:41], s[52:53]
v_pk_mul_f32 v[50:51], v[42:43], s[52:53]
v_exp_f32 v48, v48
v_exp_f32 v49, v49
v_exp_f32 v50, v50
v_exp_f32 v51, v51
v_pk_mul_f32 v[40:41], v[40:41], v[44:45]
v_pk_mul_f32 v[42:43], v[42:43], v[46:47]
v_pk_add_f32 v[48:49], v[48:49], s[54:55]
v_pk_add_f32 v[50:51], v[50:51], s[54:55]
v_rcp_f32 v48, v48
v_rcp_f32 v49, v49
v_rcp_f32 v50, v50
v_rcp_f32 v51, v51
s_nop 0
v_pk_mul_f32 v[40:41], v[40:41], v[48:49]
v_pk_mul_f32 v[42:43], v[42:43], v[50:51]
v_cvt_pk_bf16_f32 v64, v40, v41
v_cvt_pk_bf16_f32 v65, v42, v43
v_accvgpr_read_b32 v52, a64
v_accvgpr_read_b32 v53, a65
v_accvgpr_read_b32 v54, a66
v_accvgpr_read_b32 v55, a67
v_accvgpr_read_b32 v56, a176
v_accvgpr_read_b32 v57, a177
v_accvgpr_read_b32 v58, a178
v_accvgpr_read_b32 v59, a179
v_pk_mul_f32 v[60:61], v[52:53], s[52:53]
v_pk_mul_f32 v[62:63], v[54:55], s[52:53]
v_exp_f32 v60, v60
v_exp_f32 v61, v61
v_exp_f32 v62, v62
v_exp_f32 v63, v63
v_pk_mul_f32 v[52:53], v[52:53], v[56:57]
v_pk_mul_f32 v[54:55], v[54:55], v[58:59]
v_pk_add_f32 v[60:61], v[60:61], s[54:55]
v_pk_add_f32 v[62:63], v[62:63], s[54:55]
v_rcp_f32 v60, v60
v_rcp_f32 v61, v61
v_rcp_f32 v62, v62
v_rcp_f32 v63, v63
s_nop 0
v_pk_mul_f32 v[52:53], v[52:53], v[60:61]
v_pk_mul_f32 v[54:55], v[54:55], v[62:63]
v_cvt_pk_bf16_f32 v66, v52, v53
v_cvt_pk_bf16_f32 v67, v54, v55
buffer_store_dwordx4 v[64:67], v8, s[20:23], s33 offen offset:2048 sc1
v_accvgpr_read_b32 v72, a52
v_accvgpr_read_b32 v73, a53
v_accvgpr_read_b32 v74, a54
v_accvgpr_read_b32 v75, a55
v_accvgpr_read_b32 v76, a164
v_accvgpr_read_b32 v77, a165
v_accvgpr_read_b32 v78, a166
v_accvgpr_read_b32 v79, a167
v_pk_mul_f32 v[80:81], v[72:73], s[52:53]
v_pk_mul_f32 v[82:83], v[74:75], s[52:53]
v_exp_f32 v80, v80
v_exp_f32 v81, v81
v_exp_f32 v82, v82
v_exp_f32 v83, v83
v_pk_mul_f32 v[72:73], v[72:73], v[76:77]
v_pk_mul_f32 v[74:75], v[74:75], v[78:79]
v_pk_add_f32 v[80:81], v[80:81], s[54:55]
v_pk_add_f32 v[82:83], v[82:83], s[54:55]
v_rcp_f32 v80, v80
v_rcp_f32 v81, v81
v_rcp_f32 v82, v82
v_rcp_f32 v83, v83
s_nop 0
v_pk_mul_f32 v[72:73], v[72:73], v[80:81]
v_pk_mul_f32 v[74:75], v[74:75], v[82:83]
v_cvt_pk_bf16_f32 v96, v72, v73
v_cvt_pk_bf16_f32 v97, v74, v75
v_accvgpr_read_b32 v84, a68
v_accvgpr_read_b32 v85, a69
v_accvgpr_read_b32 v86, a70
v_accvgpr_read_b32 v87, a71
v_accvgpr_read_b32 v88, a180
v_accvgpr_read_b32 v89, a181
v_accvgpr_read_b32 v90, a182
v_accvgpr_read_b32 v91, a183
v_pk_mul_f32 v[92:93], v[84:85], s[52:53]
v_pk_mul_f32 v[94:95], v[86:87], s[52:53]
v_exp_f32 v92, v92
v_exp_f32 v93, v93
v_exp_f32 v94, v94
v_exp_f32 v95, v95
v_pk_mul_f32 v[84:85], v[84:85], v[88:89]
v_pk_mul_f32 v[86:87], v[86:87], v[90:91]
v_pk_add_f32 v[92:93], v[92:93], s[54:55]
v_pk_add_f32 v[94:95], v[94:95], s[54:55]
v_rcp_f32 v92, v92
v_rcp_f32 v93, v93
v_rcp_f32 v94, v94
v_rcp_f32 v95, v95
s_nop 0
v_pk_mul_f32 v[84:85], v[84:85], v[92:93]
v_pk_mul_f32 v[86:87], v[86:87], v[94:95]
v_cvt_pk_bf16_f32 v98, v84, v85
v_cvt_pk_bf16_f32 v99, v86, v87
buffer_store_dwordx4 v[96:99], v9, s[20:23], s33 offen offset:2048 sc1
v_accvgpr_read_b32 v104, a56
v_accvgpr_read_b32 v105, a57
v_accvgpr_read_b32 v106, a58
v_accvgpr_read_b32 v107, a59
v_accvgpr_read_b32 v108, a168
v_accvgpr_read_b32 v109, a169
v_accvgpr_read_b32 v110, a170
v_accvgpr_read_b32 v111, a171
v_pk_mul_f32 v[112:113], v[104:105], s[52:53]
v_pk_mul_f32 v[114:115], v[106:107], s[52:53]
v_exp_f32 v112, v112
v_exp_f32 v113, v113
v_exp_f32 v114, v114
v_exp_f32 v115, v115
v_pk_mul_f32 v[104:105], v[104:105], v[108:109]
v_pk_mul_f32 v[106:107], v[106:107], v[110:111]
v_pk_add_f32 v[112:113], v[112:113], s[54:55]
v_pk_add_f32 v[114:115], v[114:115], s[54:55]
v_rcp_f32 v112, v112
v_rcp_f32 v113, v113
v_rcp_f32 v114, v114
v_rcp_f32 v115, v115
s_nop 0
v_pk_mul_f32 v[104:105], v[104:105], v[112:113]
v_pk_mul_f32 v[106:107], v[106:107], v[114:115]
v_cvt_pk_bf16_f32 v128, v104, v105
v_cvt_pk_bf16_f32 v129, v106, v107
v_accvgpr_read_b32 v116, a72
v_accvgpr_read_b32 v117, a73
v_accvgpr_read_b32 v118, a74
v_accvgpr_read_b32 v119, a75
v_accvgpr_read_b32 v120, a184
v_accvgpr_read_b32 v121, a185
v_accvgpr_read_b32 v122, a186
v_accvgpr_read_b32 v123, a187
v_pk_mul_f32 v[124:125], v[116:117], s[52:53]
v_pk_mul_f32 v[126:127], v[118:119], s[52:53]
v_exp_f32 v124, v124
v_exp_f32 v125, v125
v_exp_f32 v126, v126
v_exp_f32 v127, v127
v_pk_mul_f32 v[116:117], v[116:117], v[120:121]
v_pk_mul_f32 v[118:119], v[118:119], v[122:123]
v_pk_add_f32 v[124:125], v[124:125], s[54:55]
v_pk_add_f32 v[126:127], v[126:127], s[54:55]
v_rcp_f32 v124, v124
v_rcp_f32 v125, v125
v_rcp_f32 v126, v126
v_rcp_f32 v127, v127
s_nop 0
v_pk_mul_f32 v[116:117], v[116:117], v[124:125]
v_pk_mul_f32 v[118:119], v[118:119], v[126:127]
v_cvt_pk_bf16_f32 v130, v116, v117
v_cvt_pk_bf16_f32 v131, v118, v119
buffer_store_dwordx4 v[128:131], v10, s[20:23], s33 offen offset:2048 sc1
v_accvgpr_read_b32 v136, a60
v_accvgpr_read_b32 v137, a61
v_accvgpr_read_b32 v138, a62
v_accvgpr_read_b32 v139, a63
v_accvgpr_read_b32 v140, a172
v_accvgpr_read_b32 v141, a173
v_accvgpr_read_b32 v142, a174
v_accvgpr_read_b32 v143, a175
v_pk_mul_f32 v[144:145], v[136:137], s[52:53]
v_pk_mul_f32 v[146:147], v[138:139], s[52:53]
v_exp_f32 v144, v144
v_exp_f32 v145, v145
v_exp_f32 v146, v146
v_exp_f32 v147, v147
v_pk_mul_f32 v[136:137], v[136:137], v[140:141]
v_pk_mul_f32 v[138:139], v[138:139], v[142:143]
v_pk_add_f32 v[144:145], v[144:145], s[54:55]
v_pk_add_f32 v[146:147], v[146:147], s[54:55]
v_rcp_f32 v144, v144
v_rcp_f32 v145, v145
v_rcp_f32 v146, v146
v_rcp_f32 v147, v147
s_nop 0
v_pk_mul_f32 v[136:137], v[136:137], v[144:145]
v_pk_mul_f32 v[138:139], v[138:139], v[146:147]
v_cvt_pk_bf16_f32 v160, v136, v137
v_cvt_pk_bf16_f32 v161, v138, v139
v_accvgpr_read_b32 v148, a76
v_accvgpr_read_b32 v149, a77
v_accvgpr_read_b32 v150, a78
v_accvgpr_read_b32 v151, a79
v_accvgpr_read_b32 v152, a188
v_accvgpr_read_b32 v153, a189
v_accvgpr_read_b32 v154, a190
v_accvgpr_read_b32 v155, a191
v_pk_mul_f32 v[156:157], v[148:149], s[52:53]
v_pk_mul_f32 v[158:159], v[150:151], s[52:53]
v_exp_f32 v156, v156
v_exp_f32 v157, v157
v_exp_f32 v158, v158
v_exp_f32 v159, v159
v_pk_mul_f32 v[148:149], v[148:149], v[152:153]
v_pk_mul_f32 v[150:151], v[150:151], v[154:155]
v_pk_add_f32 v[156:157], v[156:157], s[54:55]
v_pk_add_f32 v[158:159], v[158:159], s[54:55]
v_rcp_f32 v156, v156
v_rcp_f32 v157, v157
v_rcp_f32 v158, v158
v_rcp_f32 v159, v159
s_nop 0
v_pk_mul_f32 v[148:149], v[148:149], v[156:157]
v_pk_mul_f32 v[150:151], v[150:151], v[158:159]
v_cvt_pk_bf16_f32 v162, v148, v149
v_cvt_pk_bf16_f32 v163, v150, v151
buffer_store_dwordx4 v[160:163], v11, s[20:23], s33 offen offset:2048 sc1
v_accvgpr_read_b32 v40, a80
v_accvgpr_read_b32 v41, a81
v_accvgpr_read_b32 v42, a82
v_accvgpr_read_b32 v43, a83
v_accvgpr_read_b32 v44, a192
v_accvgpr_read_b32 v45, a193
v_accvgpr_read_b32 v46, a194
v_accvgpr_read_b32 v47, a195
v_pk_mul_f32 v[48:49], v[40:41], s[52:53]
v_pk_mul_f32 v[50:51], v[42:43], s[52:53]
v_exp_f32 v48, v48
v_exp_f32 v49, v49
v_exp_f32 v50, v50
v_exp_f32 v51, v51
v_pk_mul_f32 v[40:41], v[40:41], v[44:45]
v_pk_mul_f32 v[42:43], v[42:43], v[46:47]
v_pk_add_f32 v[48:49], v[48:49], s[54:55]
v_pk_add_f32 v[50:51], v[50:51], s[54:55]
v_rcp_f32 v48, v48
v_rcp_f32 v49, v49
v_rcp_f32 v50, v50
v_rcp_f32 v51, v51
s_nop 0
v_pk_mul_f32 v[40:41], v[40:41], v[48:49]
v_pk_mul_f32 v[42:43], v[42:43], v[50:51]
v_cvt_pk_bf16_f32 v64, v40, v41
v_cvt_pk_bf16_f32 v65, v42, v43
v_accvgpr_read_b32 v52, a96
v_accvgpr_read_b32 v53, a97
v_accvgpr_read_b32 v54, a98
v_accvgpr_read_b32 v55, a99
v_accvgpr_read_b32 v56, a208
v_accvgpr_read_b32 v57, a209
v_accvgpr_read_b32 v58, a210
v_accvgpr_read_b32 v59, a211
v_pk_mul_f32 v[60:61], v[52:53], s[52:53]
v_pk_mul_f32 v[62:63], v[54:55], s[52:53]
v_exp_f32 v60, v60
v_exp_f32 v61, v61
v_exp_f32 v62, v62
v_exp_f32 v63, v63
v_pk_mul_f32 v[52:53], v[52:53], v[56:57]
v_pk_mul_f32 v[54:55], v[54:55], v[58:59]
v_pk_add_f32 v[60:61], v[60:61], s[54:55]
v_pk_add_f32 v[62:63], v[62:63], s[54:55]
v_rcp_f32 v60, v60
v_rcp_f32 v61, v61
v_rcp_f32 v62, v62
v_rcp_f32 v63, v63
s_nop 0
v_pk_mul_f32 v[52:53], v[52:53], v[60:61]
v_pk_mul_f32 v[54:55], v[54:55], v[62:63]
v_cvt_pk_bf16_f32 v66, v52, v53
v_cvt_pk_bf16_f32 v67, v54, v55
buffer_store_dwordx4 v[64:67], v8, s[20:23], s33 offen offset:3072 sc1
v_accvgpr_read_b32 v72, a84
v_accvgpr_read_b32 v73, a85
v_accvgpr_read_b32 v74, a86
v_accvgpr_read_b32 v75, a87
v_accvgpr_read_b32 v76, a196
v_accvgpr_read_b32 v77, a197
v_accvgpr_read_b32 v78, a198
v_accvgpr_read_b32 v79, a199
v_pk_mul_f32 v[80:81], v[72:73], s[52:53]
v_pk_mul_f32 v[82:83], v[74:75], s[52:53]
v_exp_f32 v80, v80
v_exp_f32 v81, v81
v_exp_f32 v82, v82
v_exp_f32 v83, v83
v_pk_mul_f32 v[72:73], v[72:73], v[76:77]
v_pk_mul_f32 v[74:75], v[74:75], v[78:79]
v_pk_add_f32 v[80:81], v[80:81], s[54:55]
v_pk_add_f32 v[82:83], v[82:83], s[54:55]
v_rcp_f32 v80, v80
v_rcp_f32 v81, v81
v_rcp_f32 v82, v82
v_rcp_f32 v83, v83
s_nop 0
v_pk_mul_f32 v[72:73], v[72:73], v[80:81]
v_pk_mul_f32 v[74:75], v[74:75], v[82:83]
v_cvt_pk_bf16_f32 v96, v72, v73
v_cvt_pk_bf16_f32 v97, v74, v75
v_accvgpr_read_b32 v84, a100
v_accvgpr_read_b32 v85, a101
v_accvgpr_read_b32 v86, a102
v_accvgpr_read_b32 v87, a103
v_accvgpr_read_b32 v88, a212
v_accvgpr_read_b32 v89, a213
v_accvgpr_read_b32 v90, a214
v_accvgpr_read_b32 v91, a215
v_pk_mul_f32 v[92:93], v[84:85], s[52:53]
v_pk_mul_f32 v[94:95], v[86:87], s[52:53]
v_exp_f32 v92, v92
v_exp_f32 v93, v93
v_exp_f32 v94, v94
v_exp_f32 v95, v95
v_pk_mul_f32 v[84:85], v[84:85], v[88:89]
v_pk_mul_f32 v[86:87], v[86:87], v[90:91]
v_pk_add_f32 v[92:93], v[92:93], s[54:55]
v_pk_add_f32 v[94:95], v[94:95], s[54:55]
v_rcp_f32 v92, v92
v_rcp_f32 v93, v93
v_rcp_f32 v94, v94
v_rcp_f32 v95, v95
s_nop 0
v_pk_mul_f32 v[84:85], v[84:85], v[92:93]
v_pk_mul_f32 v[86:87], v[86:87], v[94:95]
v_cvt_pk_bf16_f32 v98, v84, v85
v_cvt_pk_bf16_f32 v99, v86, v87
buffer_store_dwordx4 v[96:99], v9, s[20:23], s33 offen offset:3072 sc1
v_accvgpr_read_b32 v104, a88
v_accvgpr_read_b32 v105, a89
v_accvgpr_read_b32 v106, a90
v_accvgpr_read_b32 v107, a91
v_accvgpr_read_b32 v108, a200
v_accvgpr_read_b32 v109, a201
v_accvgpr_read_b32 v110, a202
v_accvgpr_read_b32 v111, a203
v_pk_mul_f32 v[112:113], v[104:105], s[52:53]
v_pk_mul_f32 v[114:115], v[106:107], s[52:53]
v_exp_f32 v112, v112
v_exp_f32 v113, v113
v_exp_f32 v114, v114
v_exp_f32 v115, v115
v_pk_mul_f32 v[104:105], v[104:105], v[108:109]
v_pk_mul_f32 v[106:107], v[106:107], v[110:111]
v_pk_add_f32 v[112:113], v[112:113], s[54:55]
v_pk_add_f32 v[114:115], v[114:115], s[54:55]
v_rcp_f32 v112, v112
v_rcp_f32 v113, v113
v_rcp_f32 v114, v114
v_rcp_f32 v115, v115
s_nop 0
v_pk_mul_f32 v[104:105], v[104:105], v[112:113]
v_pk_mul_f32 v[106:107], v[106:107], v[114:115]
v_cvt_pk_bf16_f32 v128, v104, v105
v_cvt_pk_bf16_f32 v129, v106, v107
v_accvgpr_read_b32 v116, a104
v_accvgpr_read_b32 v117, a105
v_accvgpr_read_b32 v118, a106
v_accvgpr_read_b32 v119, a107
v_accvgpr_read_b32 v120, a216
v_accvgpr_read_b32 v121, a217
v_accvgpr_read_b32 v122, a218
v_accvgpr_read_b32 v123, a219
v_pk_mul_f32 v[124:125], v[116:117], s[52:53]
v_pk_mul_f32 v[126:127], v[118:119], s[52:53]
v_exp_f32 v124, v124
v_exp_f32 v125, v125
v_exp_f32 v126, v126
v_exp_f32 v127, v127
v_pk_mul_f32 v[116:117], v[116:117], v[120:121]
v_pk_mul_f32 v[118:119], v[118:119], v[122:123]
v_pk_add_f32 v[124:125], v[124:125], s[54:55]
v_pk_add_f32 v[126:127], v[126:127], s[54:55]
v_rcp_f32 v124, v124
v_rcp_f32 v125, v125
v_rcp_f32 v126, v126
v_rcp_f32 v127, v127
s_nop 0
v_pk_mul_f32 v[116:117], v[116:117], v[124:125]
v_pk_mul_f32 v[118:119], v[118:119], v[126:127]
v_cvt_pk_bf16_f32 v130, v116, v117
v_cvt_pk_bf16_f32 v131, v118, v119
buffer_store_dwordx4 v[128:131], v10, s[20:23], s33 offen offset:3072 sc1
v_accvgpr_read_b32 v136, a92
v_accvgpr_read_b32 v137, a93
v_accvgpr_read_b32 v138, a94
v_accvgpr_read_b32 v139, a95
v_accvgpr_read_b32 v140, a204
v_accvgpr_read_b32 v141, a205
v_accvgpr_read_b32 v142, a206
v_accvgpr_read_b32 v143, a207
v_pk_mul_f32 v[144:145], v[136:137], s[52:53]
v_pk_mul_f32 v[146:147], v[138:139], s[52:53]
v_exp_f32 v144, v144
v_exp_f32 v145, v145
v_exp_f32 v146, v146
v_exp_f32 v147, v147
v_pk_mul_f32 v[136:137], v[136:137], v[140:141]
v_pk_mul_f32 v[138:139], v[138:139], v[142:143]
v_pk_add_f32 v[144:145], v[144:145], s[54:55]
v_pk_add_f32 v[146:147], v[146:147], s[54:55]
v_rcp_f32 v144, v144
v_rcp_f32 v145, v145
v_rcp_f32 v146, v146
v_rcp_f32 v147, v147
s_nop 0
v_pk_mul_f32 v[136:137], v[136:137], v[144:145]
v_pk_mul_f32 v[138:139], v[138:139], v[146:147]
v_cvt_pk_bf16_f32 v160, v136, v137
v_cvt_pk_bf16_f32 v161, v138, v139
v_accvgpr_read_b32 v148, a108
v_accvgpr_read_b32 v149, a109
v_accvgpr_read_b32 v150, a110
v_accvgpr_read_b32 v151, a111
v_accvgpr_read_b32 v152, a220
v_accvgpr_read_b32 v153, a221
v_accvgpr_read_b32 v154, a222
v_accvgpr_read_b32 v155, a223
v_pk_mul_f32 v[156:157], v[148:149], s[52:53]
v_pk_mul_f32 v[158:159], v[150:151], s[52:53]
v_exp_f32 v156, v156
v_exp_f32 v157, v157
v_exp_f32 v158, v158
v_exp_f32 v159, v159
v_pk_mul_f32 v[148:149], v[148:149], v[152:153]
v_pk_mul_f32 v[150:151], v[150:151], v[154:155]
v_pk_add_f32 v[156:157], v[156:157], s[54:55]
v_pk_add_f32 v[158:159], v[158:159], s[54:55]
v_rcp_f32 v156, v156
v_rcp_f32 v157, v157
v_rcp_f32 v158, v158
v_rcp_f32 v159, v159
s_nop 0
v_pk_mul_f32 v[148:149], v[148:149], v[156:157]
v_pk_mul_f32 v[150:151], v[150:151], v[158:159]
v_cvt_pk_bf16_f32 v162, v148, v149
v_cvt_pk_bf16_f32 v163, v150, v151
buffer_store_dwordx4 v[160:163], v11, s[20:23], s33 offen offset:3072 sc1
L_attn_kernel_gu_epidone:
s_lshl_b32 s61, s39, 1
s_lshr_b32 s43, s40, 4
s_add_u32 s61, s61, s43
s_lshl_b32 s61, s61, 7
s_add_u32 s61, s61, 73728
s_and_b32 s62, s40, 15
s_lshl_b32 s62, s62, 2
s_waitcnt vmcnt(0)
s_barrier
s_cmp_lg_u32 s32, 0
s_cbranch_scc1 L_attn_kernel_gu_apub
s_add_u32 s52, s4, 0x80000
s_addc_u32 s53, s5, 0
s_mov_b32 s54, 0x20000
s_mov_b32 s55, 0x20000
v_mov_b32 v6, s62
v_mov_b32 v7, 1
s_mov_b64 s[46:47], exec
s_mov_b64 exec, 1
buffer_store_dword v7, v6, s[52:55], s61 offen sc1
s_mov_b64 exec, s[46:47]
L_attn_kernel_gu_apub:
s_load_dwordx2 s[4:5], s[0:1], 104
s_load_dwordx2 s[6:7], s[0:1], 64
s_load_dwordx2 s[8:9], s[0:1], 88
s_load_dwordx2 s[10:11], s[0:1], 96
v_lshrrev_b32 v2, 6, v0
v_and_b32 v1, 63, v0
v_readfirstlane_b32 s32, v2
s_and_b32 s37, s2, 7
s_lshr_b32 s38, s2, 3
s_and_b32 s41, s37, 1
s_lshr_b32 s39, s37, 1
s_lshl_b32 s39, s39, 2
s_lshr_b32 s40, s38, 3
s_add_u32 s39, s39, s40
s_and_b32 s40, s38, 7
s_xor_b32 s58, s41, 1
s_lshl_b32 s44, s39, 3
s_add_u32 s44, s44, s40
s_lshl_b32 s35, s32, 12
v_lshrrev_b32 v4, 4, v1
v_and_b32 v5, 15, v1
v_lshlrev_b32 v3, 4, v1
v_mov_b32 v8, v3
v_add_u32 v9, 114688, v3
s_lshl_b32 s33, s39, 3
s_lshl_b32 s42, s32, 1
s_add_u32 s33, s33, s42
s_mul_i32 s33, s33, 114688
s_mul_i32 s42, s41, 57344
s_add_u32 s33, s33, s42
v_add_u32 v6, 0, v4
v_and_b32 v7, 7, v6
v_lshrrev_b32 v2, 1, v5
v_xor_b32 v7, v7, v2
v_lshlrev_b32 v7, 5, v7
v_and_b32 v2, 1, v5
v_lshl_add_u32 v7, v2, 4, v7
v_lshl_add_u32 v7, v6, 11, v7
v_subrev_u32 v10, 0, v7
v_add_u32 v6, 4, v4
v_and_b32 v7, 7, v6
v_lshrrev_b32 v2, 1, v5
v_xor_b32 v7, v7, v2
v_lshlrev_b32 v7, 5, v7
v_and_b32 v2, 1, v5
v_lshl_add_u32 v7, v2, 4, v7
v_lshl_add_u32 v7, v6, 11, v7
v_subrev_u32 v11, 1024, v7
v_add_u32 v6, 8, v4
v_and_b32 v7, 7, v6
v_lshrrev_b32 v2, 1, v5
v_xor_b32 v7, v7, v2
v_lshlrev_b32 v7, 5, v7
v_and_b32 v2, 1, v5
v_lshl_add_u32 v7, v2, 4, v7
v_lshl_add_u32 v7, v6, 11, v7
v_subrev_u32 v12, 2048, v7
v_add_u32 v6, 12, v4
v_and_b32 v7, 7, v6
v_lshrrev_b32 v2, 1, v5
v_xor_b32 v7, v7, v2
v_lshlrev_b32 v7, 5, v7
v_and_b32 v2, 1, v5
v_lshl_add_u32 v7, v2, 4, v7
v_lshl_add_u32 v7, v6, 11, v7
v_subrev_u32 v13, 3072, v7
s_mul_i32 s34, s41, 3670016
s_lshl_b32 s42, s32, 15
s_add_u32 s34, s34, s42
s_lshl_b32 s42, s40, 8
s_add_u32 s34, s34, s42
v_bfe_u32 v6, v1, 2, 2
v_lshl_add_u32 v6, v4, 2, v6
v_and_b32 v7, 7, v6
v_lshlrev_b32 v7, 5, v7
v_lshl_add_u32 v7, v6, 8, v7
v_and_b32 v6, 3, v1
v_lshl_add_u32 v7, v6, 3, v7
s_lshl_b32 s42, s41, 7
v_xor_b32 v7, s42, v7
v_xor_b32 v16, 0, v7
v_xor_b32 v17, 32, v7
v_xor_b32 v18, 64, v7
v_xor_b32 v19, 96, v7
v_xor_b32 v20, 128, v7
v_xor_b32 v21, 160, v7
v_xor_b32 v22, 192, v7
v_xor_b32 v23, 224, v7
s_waitcnt lgkmcnt(0)
s_add_u32 s12, s4, 0x2000000
s_addc_u32 s13, s5, 0
s_mov_b32 s14, 0xe00000
s_mov_b32 s15, 0x20000
s_mov_b32 s16, s6
s_mov_b32 s17, s7
s_mov_b32 s18, 0x700000
s_mov_b32 s19, 0x20000
s_mov_b32 s20, s4
s_mov_b32 s21, s5
s_mov_b32 s22, 0x20000
s_mov_b32 s23, 0x20000
s_add_u32 s24, s4, 0x500000
s_addc_u32 s25, s5, 0
s_mov_b32 s26, 0x400000
s_mov_b32 s27, 0x20000
s_mov_b32 s28, s8
s_mov_b32 s29, s9
s_mov_b32 s30, 0x400000
s_mov_b32 s31, 0x20000
s_add_u32 s48, s4, 0x4000000
s_addc_u32 s49, s5, 0
s_mov_b32 s50, 0x800000
s_mov_b32 s51, 0x20000
s_add_u32 m0, s35, 0
s_nop 0
buffer_load_dwordx4 v10, s[16:19], s34 offen offset:0 lds
buffer_load_dwordx4 v11, s[16:19], s34 offen offset:1024 lds
buffer_load_dwordx4 v12, s[16:19], s34 offen offset:2048 lds
buffer_load_dwordx4 v13, s[16:19], s34 offen offset:3072 lds
s_add_u32 s34, s34, 131072
s_add_u32 m0, s35, 16384
s_nop 0
buffer_load_dwordx4 v10, s[16:19], s34 offen offset:0 lds
buffer_load_dwordx4 v11, s[16:19], s34 offen offset:1024 lds
buffer_load_dwordx4 v12, s[16:19], s34 offen offset:2048 lds
buffer_load_dwordx4 v13, s[16:19], s34 offen offset:3072 lds
s_add_u32 s34, s34, 131072
s_add_u32 s52, s4, 0x80000
s_addc_u32 s53, s5, 0
s_mov_b32 s54, 0x20000
s_mov_b32 s55, 0x20000
s_cmp_lg_u32 s32, 0
s_cbranch_scc1 L_attn_kernel_down_dpolled
s_lshr_b32 s42, s39, 1
s_lshl_b32 s42, s42, 1
s_add_u32 s42, s42, s41
s_lshl_b32 s42, s42, 7
s_add_u32 s42, s42, 73728
v_lshlrev_b32 v6, 2, v1
s_mov_b32 s43, 0x40000
s_mov_b64 s[46:47], exec
s_mov_b32 exec_lo, 0xffff
s_mov_b32 exec_hi, 0
L_attn_kernel_down_dpoll:
buffer_load_dword v7, v6, s[52:55], s42 offen sc1
s_waitcnt vmcnt(0)
v_cmp_ne_u32 vcc, 1, v7
s_sub_u32 s43, s43, 1
s_cmp_eq_u32 s43, 0
s_cbranch_scc1 L_attn_kernel_down_dpdone
s_cbranch_vccnz L_attn_kernel_down_dpoll
L_attn_kernel_down_dpdone:
s_mov_b64 exec, s[46:47]
L_attn_kernel_down_dpolled:
s_barrier
buffer_load_dwordx4 v[64:67], v8, s[12:15], s33 offen offset:0 sc1
buffer_load_dwordx4 v[68:71], v9, s[12:15], s33 offen offset:0 sc1
buffer_load_dwordx4 v[72:75], v8, s[12:15], s33 offen offset:1024 sc1
buffer_load_dwordx4 v[76:79], v9, s[12:15], s33 offen offset:1024 sc1
s_add_u32 s33, s33, 2048
buffer_load_dwordx4 v[80:83], v8, s[12:15], s33 offen offset:0 sc1
buffer_load_dwordx4 v[84:87], v9, s[12:15], s33 offen offset:0 sc1
buffer_load_dwordx4 v[88:91], v8, s[12:15], s33 offen offset:1024 sc1
buffer_load_dwordx4 v[92:95], v9, s[12:15], s33 offen offset:1024 sc1
s_add_u32 s33, s33, 2048
s_waitcnt vmcnt(12)
s_barrier
ds_read_b64_tr_b16 a[64:65], v16 offset:0
ds_read_b64_tr_b16 a[66:67], v16 offset:4096
ds_read_b64_tr_b16 a[68:69], v16 offset:8192
ds_read_b64_tr_b16 a[70:71], v16 offset:12288
ds_read_b64_tr_b16 a[72:73], v17 offset:0
ds_read_b64_tr_b16 a[74:75], v17 offset:4096
ds_read_b64_tr_b16 a[76:77], v17 offset:8192
ds_read_b64_tr_b16 a[78:79], v17 offset:12288
ds_read_b64_tr_b16 a[80:81], v18 offset:0
ds_read_b64_tr_b16 a[82:83], v18 offset:4096
ds_read_b64_tr_b16 a[84:85], v18 offset:8192
ds_read_b64_tr_b16 a[86:87], v18 offset:12288
ds_read_b64_tr_b16 a[88:89], v19 offset:0
ds_read_b64_tr_b16 a[90:91], v19 offset:4096
ds_read_b64_tr_b16 a[92:93], v19 offset:8192
ds_read_b64_tr_b16 a[94:95], v19 offset:12288
s_waitcnt vmcnt(4) lgkmcnt(8)
v_mfma_f32_16x16x32_bf16 a[0:3], a[64:67], v[64:67], 0
ds_read_b64_tr_b16 a[96:97], v20 offset:0
s_add_u32 m0, s35, 32768
v_mfma_f32_16x16x32_bf16 a[0:3], a[68:71], v[72:75], a[0:3]
buffer_load_dwordx4 v10, s[16:19], s34 offen offset:0 lds
v_mfma_f32_16x16x32_bf16 a[4:7], a[64:67], v[68:71], 0
ds_read_b64_tr_b16 a[98:99], v20 offset:4096
ds_read_b64_tr_b16 a[100:101], v20 offset:8192
v_mfma_f32_16x16x32_bf16 a[4:7], a[68:71], v[76:79], a[4:7]
buffer_load_dwordx4 v[96:99], v8, s[12:15], s33 offen offset:0 sc1
ds_read_b64_tr_b16 a[102:103], v20 offset:12288
v_mfma_f32_16x16x32_bf16 a[8:11], a[72:75], v[64:67], 0
buffer_load_dwordx4 v11, s[16:19], s34 offen offset:1024 lds
ds_read_b64_tr_b16 a[104:105], v21 offset:0
v_mfma_f32_16x16x32_bf16 a[8:11], a[76:79], v[72:75], a[8:11]
v_mfma_f32_16x16x32_bf16 a[12:15], a[72:75], v[68:71], 0
buffer_load_dwordx4 v12, s[16:19], s34 offen offset:2048 lds
buffer_load_dwordx4 v[100:103], v9, s[12:15], s33 offen offset:0 sc1
ds_read_b64_tr_b16 a[106:107], v21 offset:4096
ds_read_b64_tr_b16 a[108:109], v21 offset:8192
v_mfma_f32_16x16x32_bf16 a[12:15], a[76:79], v[76:79], a[12:15]
ds_read_b64_tr_b16 a[110:111], v21 offset:12288
s_waitcnt lgkmcnt(8)
v_mfma_f32_16x16x32_bf16 a[16:19], a[80:83], v[64:67], 0
buffer_load_dwordx4 v13, s[16:19], s34 offen offset:3072 lds
ds_read_b64_tr_b16 a[112:113], v22 offset:0
v_mfma_f32_16x16x32_bf16 a[16:19], a[84:87], v[72:75], a[16:19]
buffer_load_dwordx4 v[104:107], v8, s[12:15], s33 offen offset:1024 sc1
v_mfma_f32_16x16x32_bf16 a[20:23], a[80:83], v[68:71], 0
ds_read_b64_tr_b16 a[114:115], v22 offset:4096
ds_read_b64_tr_b16 a[116:117], v22 offset:8192
v_mfma_f32_16x16x32_bf16 a[20:23], a[84:87], v[76:79], a[20:23]
ds_read_b64_tr_b16 a[118:119], v22 offset:12288
s_add_u32 s34, s34, 131072
v_mfma_f32_16x16x32_bf16 a[24:27], a[88:91], v[64:67], 0
buffer_load_dwordx4 v[108:111], v9, s[12:15], s33 offen offset:1024 sc1
ds_read_b64_tr_b16 a[120:121], v23 offset:0
v_mfma_f32_16x16x32_bf16 a[24:27], a[92:95], v[72:75], a[24:27]
s_add_u32 s33, s33, 2048
v_mfma_f32_16x16x32_bf16 a[28:31], a[88:91], v[68:71], 0
buffer_load_dwordx4 v[112:115], v8, s[12:15], s33 offen offset:0 sc1
ds_read_b64_tr_b16 a[122:123], v23 offset:4096
ds_read_b64_tr_b16 a[124:125], v23 offset:8192
v_mfma_f32_16x16x32_bf16 a[28:31], a[92:95], v[76:79], a[28:31]
ds_read_b64_tr_b16 a[126:127], v23 offset:12288
s_waitcnt vmcnt(17) lgkmcnt(8)
s_barrier
v_mfma_f32_16x16x32_bf16 a[32:35], a[96:99], v[64:67], 0
ds_read_b64_tr_b16 a[64:65], v16 offset:16384
s_add_u32 m0, s35, 49152
v_mfma_f32_16x16x32_bf16 a[32:35], a[100:103], v[72:75], a[32:35]
buffer_load_dwordx4 v10, s[16:19], s34 offen offset:0 lds
buffer_load_dwordx4 v[116:119], v9, s[12:15], s33 offen offset:0 sc1
v_mfma_f32_16x16x32_bf16 a[36:39], a[96:99], v[68:71], 0
ds_read_b64_tr_b16 a[66:67], v16 offset:20480
ds_read_b64_tr_b16 a[68:69], v16 offset:24576
v_mfma_f32_16x16x32_bf16 a[36:39], a[100:103], v[76:79], a[36:39]
ds_read_b64_tr_b16 a[70:71], v16 offset:28672
v_mfma_f32_16x16x32_bf16 a[40:43], a[104:107], v[64:67], 0
ds_read_b64_tr_b16 a[72:73], v17 offset:16384
v_mfma_f32_16x16x32_bf16 a[40:43], a[108:111], v[72:75], a[40:43]
buffer_load_dwordx4 v11, s[16:19], s34 offen offset:1024 lds
buffer_load_dwordx4 v[120:123], v8, s[12:15], s33 offen offset:1024 sc1
v_mfma_f32_16x16x32_bf16 a[44:47], a[104:107], v[68:71], 0
ds_read_b64_tr_b16 a[74:75], v17 offset:20480
ds_read_b64_tr_b16 a[76:77], v17 offset:24576
v_mfma_f32_16x16x32_bf16 a[44:47], a[108:111], v[76:79], a[44:47]
ds_read_b64_tr_b16 a[78:79], v17 offset:28672
s_waitcnt lgkmcnt(8)
v_mfma_f32_16x16x32_bf16 a[48:51], a[112:115], v[64:67], 0
ds_read_b64_tr_b16 a[80:81], v18 offset:16384
v_mfma_f32_16x16x32_bf16 a[48:51], a[116:119], v[72:75], a[48:51]
buffer_load_dwordx4 v12, s[16:19], s34 offen offset:2048 lds
buffer_load_dwordx4 v[124:127], v9, s[12:15], s33 offen offset:1024 sc1
v_mfma_f32_16x16x32_bf16 a[52:55], a[112:115], v[68:71], 0
ds_read_b64_tr_b16 a[82:83], v18 offset:20480
ds_read_b64_tr_b16 a[84:85], v18 offset:24576
v_mfma_f32_16x16x32_bf16 a[52:55], a[116:119], v[76:79], a[52:55]
ds_read_b64_tr_b16 a[86:87], v18 offset:28672
s_add_u32 s33, s33, 2048
v_mfma_f32_16x16x32_bf16 a[56:59], a[120:123], v[64:67], 0
ds_read_b64_tr_b16 a[88:89], v19 offset:16384
v_mfma_f32_16x16x32_bf16 a[56:59], a[124:127], v[72:75], a[56:59]
buffer_load_dwordx4 v13, s[16:19], s34 offen offset:3072 lds
v_mfma_f32_16x16x32_bf16 a[60:63], a[120:123], v[68:71], 0
ds_read_b64_tr_b16 a[90:91], v19 offset:20480
ds_read_b64_tr_b16 a[92:93], v19 offset:24576
v_mfma_f32_16x16x32_bf16 a[60:63], a[124:127], v[76:79], a[60:63]
ds_read_b64_tr_b16 a[94:95], v19 offset:28672
s_waitcnt vmcnt(16) lgkmcnt(8)
v_mfma_f32_16x16x32_bf16 a[0:3], a[64:67], v[80:83], a[0:3]
ds_read_b64_tr_b16 a[96:97], v20 offset:16384
s_add_u32 s34, s34, 131072
v_mfma_f32_16x16x32_bf16 a[0:3], a[68:71], v[88:91], a[0:3]
buffer_load_dwordx4 v[64:67], v8, s[12:15], s33 offen offset:0 sc1
v_mfma_f32_16x16x32_bf16 a[4:7], a[64:67], v[84:87], a[4:7]
ds_read_b64_tr_b16 a[98:99], v20 offset:20480
ds_read_b64_tr_b16 a[100:101], v20 offset:24576
v_mfma_f32_16x16x32_bf16 a[4:7], a[68:71], v[92:95], a[4:7]
ds_read_b64_tr_b16 a[102:103], v20 offset:28672
v_mfma_f32_16x16x32_bf16 a[8:11], a[72:75], v[80:83], a[8:11]
ds_read_b64_tr_b16 a[104:105], v21 offset:16384
v_mfma_f32_16x16x32_bf16 a[8:11], a[76:79], v[88:91], a[8:11]
buffer_load_dwordx4 v[68:71], v9, s[12:15], s33 offen offset:0 sc1
v_mfma_f32_16x16x32_bf16 a[12:15], a[72:75], v[84:87], a[12:15]
ds_read_b64_tr_b16 a[106:107], v21 offset:20480
ds_read_b64_tr_b16 a[108:109], v21 offset:24576
v_mfma_f32_16x16x32_bf16 a[12:15], a[76:79], v[92:95], a[12:15]
ds_read_b64_tr_b16 a[110:111], v21 offset:28672
s_waitcnt lgkmcnt(8)
v_mfma_f32_16x16x32_bf16 a[16:19], a[80:83], v[80:83], a[16:19]
ds_read_b64_tr_b16 a[112:113], v22 offset:16384
v_mfma_f32_16x16x32_bf16 a[16:19], a[84:87], v[88:91], a[16:19]
buffer_load_dwordx4 v[72:75], v8, s[12:15], s33 offen offset:1024 sc1
v_mfma_f32_16x16x32_bf16 a[20:23], a[80:83], v[84:87], a[20:23]
ds_read_b64_tr_b16 a[114:115], v22 offset:20480
ds_read_b64_tr_b16 a[116:117], v22 offset:24576
v_mfma_f32_16x16x32_bf16 a[20:23], a[84:87], v[92:95], a[20:23]
ds_read_b64_tr_b16 a[118:119], v22 offset:28672
v_mfma_f32_16x16x32_bf16 a[24:27], a[88:91], v[80:83], a[24:27]
ds_read_b64_tr_b16 a[120:121], v23 offset:16384
v_mfma_f32_16x16x32_bf16 a[24:27], a[92:95], v[88:91], a[24:27]
buffer_load_dwordx4 v[76:79], v9, s[12:15], s33 offen offset:1024 sc1
v_mfma_f32_16x16x32_bf16 a[28:31], a[88:91], v[84:87], a[28:31]
ds_read_b64_tr_b16 a[122:123], v23 offset:20480
ds_read_b64_tr_b16 a[124:125], v23 offset:24576
v_mfma_f32_16x16x32_bf16 a[28:31], a[92:95], v[92:95], a[28:31]
ds_read_b64_tr_b16 a[126:127], v23 offset:28672
s_waitcnt vmcnt(14) lgkmcnt(8)
s_barrier
v_mfma_f32_16x16x32_bf16 a[32:35], a[96:99], v[80:83], a[32:35]
ds_read_b64_tr_b16 a[64:65], v16 offset:32768
s_add_u32 m0, s35, 0
v_mfma_f32_16x16x32_bf16 a[32:35], a[100:103], v[88:91], a[32:35]
buffer_load_dwordx4 v10, s[16:19], s34 offen offset:0 lds
v_mfma_f32_16x16x32_bf16 a[36:39], a[96:99], v[84:87], a[36:39]
ds_read_b64_tr_b16 a[66:67], v16 offset:36864
ds_read_b64_tr_b16 a[68:69], v16 offset:40960
v_mfma_f32_16x16x32_bf16 a[36:39], a[100:103], v[92:95], a[36:39]
ds_read_b64_tr_b16 a[70:71], v16 offset:45056
s_add_u32 s33, s33, 2048
v_mfma_f32_16x16x32_bf16 a[40:43], a[104:107], v[80:83], a[40:43]
ds_read_b64_tr_b16 a[72:73], v17 offset:32768
v_mfma_f32_16x16x32_bf16 a[40:43], a[108:111], v[88:91], a[40:43]
buffer_load_dwordx4 v11, s[16:19], s34 offen offset:1024 lds
v_mfma_f32_16x16x32_bf16 a[44:47], a[104:107], v[84:87], a[44:47]
ds_read_b64_tr_b16 a[74:75], v17 offset:36864
ds_read_b64_tr_b16 a[76:77], v17 offset:40960
v_mfma_f32_16x16x32_bf16 a[44:47], a[108:111], v[92:95], a[44:47]
ds_read_b64_tr_b16 a[78:79], v17 offset:45056
s_waitcnt lgkmcnt(8)
v_mfma_f32_16x16x32_bf16 a[48:51], a[112:115], v[80:83], a[48:51]
ds_read_b64_tr_b16 a[80:81], v18 offset:32768
v_mfma_f32_16x16x32_bf16 a[48:51], a[116:119], v[88:91], a[48:51]
buffer_load_dwordx4 v12, s[16:19], s34 offen offset:2048 lds
v_mfma_f32_16x16x32_bf16 a[52:55], a[112:115], v[84:87], a[52:55]
ds_read_b64_tr_b16 a[82:83], v18 offset:36864
ds_read_b64_tr_b16 a[84:85], v18 offset:40960
v_mfma_f32_16x16x32_bf16 a[52:55], a[116:119], v[92:95], a[52:55]
ds_read_b64_tr_b16 a[86:87], v18 offset:45056
v_mfma_f32_16x16x32_bf16 a[56:59], a[120:123], v[80:83], a[56:59]
ds_read_b64_tr_b16 a[88:89], v19 offset:32768
v_mfma_f32_16x16x32_bf16 a[56:59], a[124:127], v[88:91], a[56:59]
buffer_load_dwordx4 v13, s[16:19], s34 offen offset:3072 lds
v_mfma_f32_16x16x32_bf16 a[60:63], a[120:123], v[84:87], a[60:63]
ds_read_b64_tr_b16 a[90:91], v19 offset:36864
ds_read_b64_tr_b16 a[92:93], v19 offset:40960
v_mfma_f32_16x16x32_bf16 a[60:63], a[124:127], v[92:95], a[60:63]
ds_read_b64_tr_b16 a[94:95], v19 offset:45056
s_waitcnt vmcnt(16) lgkmcnt(8)
v_mfma_f32_16x16x32_bf16 a[0:3], a[64:67], v[96:99], a[0:3]
ds_read_b64_tr_b16 a[96:97], v20 offset:32768
s_add_u32 s34, s34, 131072
v_mfma_f32_16x16x32_bf16 a[0:3], a[68:71], v[104:107], a[0:3]
buffer_load_dwordx4 v[80:83], v8, s[12:15], s33 offen offset:0 sc1
v_mfma_f32_16x16x32_bf16 a[4:7], a[64:67], v[100:103], a[4:7]
ds_read_b64_tr_b16 a[98:99], v20 offset:36864
ds_read_b64_tr_b16 a[100:101], v20 offset:40960
v_mfma_f32_16x16x32_bf16 a[4:7], a[68:71], v[108:111], a[4:7]
ds_read_b64_tr_b16 a[102:103], v20 offset:45056
v_mfma_f32_16x16x32_bf16 a[8:11], a[72:75], v[96:99], a[8:11]
ds_read_b64_tr_b16 a[104:105], v21 offset:32768
v_mfma_f32_16x16x32_bf16 a[8:11], a[76:79], v[104:107], a[8:11]
buffer_load_dwordx4 v[84:87], v9, s[12:15], s33 offen offset:0 sc1
v_mfma_f32_16x16x32_bf16 a[12:15], a[72:75], v[100:103], a[12:15]
ds_read_b64_tr_b16 a[106:107], v21 offset:36864
ds_read_b64_tr_b16 a[108:109], v21 offset:40960
v_mfma_f32_16x16x32_bf16 a[12:15], a[76:79], v[108:111], a[12:15]
ds_read_b64_tr_b16 a[110:111], v21 offset:45056
s_waitcnt lgkmcnt(8)
v_mfma_f32_16x16x32_bf16 a[16:19], a[80:83], v[96:99], a[16:19]
ds_read_b64_tr_b16 a[112:113], v22 offset:32768
v_mfma_f32_16x16x32_bf16 a[16:19], a[84:87], v[104:107], a[16:19]
buffer_load_dwordx4 v[88:91], v8, s[12:15], s33 offen offset:1024 sc1
v_mfma_f32_16x16x32_bf16 a[20:23], a[80:83], v[100:103], a[20:23]
ds_read_b64_tr_b16 a[114:115], v22 offset:36864
ds_read_b64_tr_b16 a[116:117], v22 offset:40960
v_mfma_f32_16x16x32_bf16 a[20:23], a[84:87], v[108:111], a[20:23]
ds_read_b64_tr_b16 a[118:119], v22 offset:45056
v_mfma_f32_16x16x32_bf16 a[24:27], a[88:91], v[96:99], a[24:27]
ds_read_b64_tr_b16 a[120:121], v23 offset:32768
v_mfma_f32_16x16x32_bf16 a[24:27], a[92:95], v[104:107], a[24:27]
buffer_load_dwordx4 v[92:95], v9, s[12:15], s33 offen offset:1024 sc1
v_mfma_f32_16x16x32_bf16 a[28:31], a[88:91], v[100:103], a[28:31]
ds_read_b64_tr_b16 a[122:123], v23 offset:36864
ds_read_b64_tr_b16 a[124:125], v23 offset:40960
v_mfma_f32_16x16x32_bf16 a[28:31], a[92:95], v[108:111], a[28:31]
ds_read_b64_tr_b16 a[126:127], v23 offset:45056
s_waitcnt vmcnt(12) lgkmcnt(8)
s_barrier
v_mfma_f32_16x16x32_bf16 a[32:35], a[96:99], v[96:99], a[32:35]
ds_read_b64_tr_b16 a[64:65], v16 offset:49152
s_add_u32 m0, s35, 16384
v_mfma_f32_16x16x32_bf16 a[32:35], a[100:103], v[104:107], a[32:35]
buffer_load_dwordx4 v10, s[16:19], s34 offen offset:0 lds
v_mfma_f32_16x16x32_bf16 a[36:39], a[96:99], v[100:103], a[36:39]
ds_read_b64_tr_b16 a[66:67], v16 offset:53248
ds_read_b64_tr_b16 a[68:69], v16 offset:57344
v_mfma_f32_16x16x32_bf16 a[36:39], a[100:103], v[108:111], a[36:39]
ds_read_b64_tr_b16 a[70:71], v16 offset:61440
s_add_u32 s33, s33, 2048
v_mfma_f32_16x16x32_bf16 a[40:43], a[104:107], v[96:99], a[40:43]
ds_read_b64_tr_b16 a[72:73], v17 offset:49152
v_mfma_f32_16x16x32_bf16 a[40:43], a[108:111], v[104:107], a[40:43]
buffer_load_dwordx4 v11, s[16:19], s34 offen offset:1024 lds
v_mfma_f32_16x16x32_bf16 a[44:47], a[104:107], v[100:103], a[44:47]
ds_read_b64_tr_b16 a[74:75], v17 offset:53248
ds_read_b64_tr_b16 a[76:77], v17 offset:57344
v_mfma_f32_16x16x32_bf16 a[44:47], a[108:111], v[108:111], a[44:47]
ds_read_b64_tr_b16 a[78:79], v17 offset:61440
s_waitcnt lgkmcnt(8)
v_mfma_f32_16x16x32_bf16 a[48:51], a[112:115], v[96:99], a[48:51]
ds_read_b64_tr_b16 a[80:81], v18 offset:49152
v_mfma_f32_16x16x32_bf16 a[48:51], a[116:119], v[104:107], a[48:51]
buffer_load_dwordx4 v12, s[16:19], s34 offen offset:2048 lds
v_mfma_f32_16x16x32_bf16 a[52:55], a[112:115], v[100:103], a[52:55]
ds_read_b64_tr_b16 a[82:83], v18 offset:53248
ds_read_b64_tr_b16 a[84:85], v18 offset:57344
v_mfma_f32_16x16x32_bf16 a[52:55], a[116:119], v[108:111], a[52:55]
ds_read_b64_tr_b16 a[86:87], v18 offset:61440
v_mfma_f32_16x16x32_bf16 a[56:59], a[120:123], v[96:99], a[56:59]
ds_read_b64_tr_b16 a[88:89], v19 offset:49152
v_mfma_f32_16x16x32_bf16 a[56:59], a[124:127], v[104:107], a[56:59]
buffer_load_dwordx4 v13, s[16:19], s34 offen offset:3072 lds
v_mfma_f32_16x16x32_bf16 a[60:63], a[120:123], v[100:103], a[60:63]
ds_read_b64_tr_b16 a[90:91], v19 offset:53248
ds_read_b64_tr_b16 a[92:93], v19 offset:57344
v_mfma_f32_16x16x32_bf16 a[60:63], a[124:127], v[108:111], a[60:63]
ds_read_b64_tr_b16 a[94:95], v19 offset:61440
s_waitcnt vmcnt(17) lgkmcnt(8)
v_mfma_f32_16x16x32_bf16 a[0:3], a[64:67], v[112:115], a[0:3]
ds_read_b64_tr_b16 a[96:97], v20 offset:49152
s_add_u32 s34, s34, 131072
v_mfma_f32_16x16x32_bf16 a[0:3], a[68:71], v[120:123], a[0:3]
buffer_load_dwordx4 v[96:99], v8, s[12:15], s33 offen offset:0 sc1
v_mfma_f32_16x16x32_bf16 a[4:7], a[64:67], v[116:119], a[4:7]
ds_read_b64_tr_b16 a[98:99], v20 offset:53248
ds_read_b64_tr_b16 a[100:101], v20 offset:57344
v_mfma_f32_16x16x32_bf16 a[4:7], a[68:71], v[124:127], a[4:7]
ds_read_b64_tr_b16 a[102:103], v20 offset:61440
v_mfma_f32_16x16x32_bf16 a[8:11], a[72:75], v[112:115], a[8:11]
ds_read_b64_tr_b16 a[104:105], v21 offset:49152
v_mfma_f32_16x16x32_bf16 a[8:11], a[76:79], v[120:123], a[8:11]
buffer_load_dwordx4 v[100:103], v9, s[12:15], s33 offen offset:0 sc1
v_mfma_f32_16x16x32_bf16 a[12:15], a[72:75], v[116:119], a[12:15]
ds_read_b64_tr_b16 a[106:107], v21 offset:53248
ds_read_b64_tr_b16 a[108:109], v21 offset:57344
v_mfma_f32_16x16x32_bf16 a[12:15], a[76:79], v[124:127], a[12:15]
ds_read_b64_tr_b16 a[110:111], v21 offset:61440
s_waitcnt lgkmcnt(8)
v_mfma_f32_16x16x32_bf16 a[16:19], a[80:83], v[112:115], a[16:19]
ds_read_b64_tr_b16 a[112:113], v22 offset:49152
v_mfma_f32_16x16x32_bf16 a[16:19], a[84:87], v[120:123], a[16:19]
buffer_load_dwordx4 v[104:107], v8, s[12:15], s33 offen offset:1024 sc1
v_mfma_f32_16x16x32_bf16 a[20:23], a[80:83], v[116:119], a[20:23]
ds_read_b64_tr_b16 a[114:115], v22 offset:53248
ds_read_b64_tr_b16 a[116:117], v22 offset:57344
v_mfma_f32_16x16x32_bf16 a[20:23], a[84:87], v[124:127], a[20:23]
ds_read_b64_tr_b16 a[118:119], v22 offset:61440
v_mfma_f32_16x16x32_bf16 a[24:27], a[88:91], v[112:115], a[24:27]
ds_read_b64_tr_b16 a[120:121], v23 offset:49152
v_mfma_f32_16x16x32_bf16 a[24:27], a[92:95], v[120:123], a[24:27]
buffer_load_dwordx4 v[108:111], v9, s[12:15], s33 offen offset:1024 sc1
v_mfma_f32_16x16x32_bf16 a[28:31], a[88:91], v[116:119], a[28:31]
ds_read_b64_tr_b16 a[122:123], v23 offset:53248
ds_read_b64_tr_b16 a[124:125], v23 offset:57344
v_mfma_f32_16x16x32_bf16 a[28:31], a[92:95], v[124:127], a[28:31]
ds_read_b64_tr_b16 a[126:127], v23 offset:61440
s_waitcnt vmcnt(12) lgkmcnt(8)
s_barrier
v_mfma_f32_16x16x32_bf16 a[32:35], a[96:99], v[112:115], a[32:35]
ds_read_b64_tr_b16 a[64:65], v16 offset:0
s_add_u32 m0, s35, 32768
v_mfma_f32_16x16x32_bf16 a[32:35], a[100:103], v[120:123], a[32:35]
buffer_load_dwordx4 v10, s[16:19], s34 offen offset:0 lds
v_mfma_f32_16x16x32_bf16 a[36:39], a[96:99], v[116:119], a[36:39]
ds_read_b64_tr_b16 a[66:67], v16 offset:4096
ds_read_b64_tr_b16 a[68:69], v16 offset:8192
v_mfma_f32_16x16x32_bf16 a[36:39], a[100:103], v[124:127], a[36:39]
ds_read_b64_tr_b16 a[70:71], v16 offset:12288
s_add_u32 s33, s33, 2048
v_mfma_f32_16x16x32_bf16 a[40:43], a[104:107], v[112:115], a[40:43]
ds_read_b64_tr_b16 a[72:73], v17 offset:0
v_mfma_f32_16x16x32_bf16 a[40:43], a[108:111], v[120:123], a[40:43]
buffer_load_dwordx4 v11, s[16:19], s34 offen offset:1024 lds
v_mfma_f32_16x16x32_bf16 a[44:47], a[104:107], v[116:119], a[44:47]
ds_read_b64_tr_b16 a[74:75], v17 offset:4096
ds_read_b64_tr_b16 a[76:77], v17 offset:8192
v_mfma_f32_16x16x32_bf16 a[44:47], a[108:111], v[124:127], a[44:47]
ds_read_b64_tr_b16 a[78:79], v17 offset:12288
s_waitcnt lgkmcnt(8)
v_mfma_f32_16x16x32_bf16 a[48:51], a[112:115], v[112:115], a[48:51]
ds_read_b64_tr_b16 a[80:81], v18 offset:0
v_mfma_f32_16x16x32_bf16 a[48:51], a[116:119], v[120:123], a[48:51]
buffer_load_dwordx4 v12, s[16:19], s34 offen offset:2048 lds
v_mfma_f32_16x16x32_bf16 a[52:55], a[112:115], v[116:119], a[52:55]
ds_read_b64_tr_b16 a[82:83], v18 offset:4096
ds_read_b64_tr_b16 a[84:85], v18 offset:8192
v_mfma_f32_16x16x32_bf16 a[52:55], a[116:119], v[124:127], a[52:55]
ds_read_b64_tr_b16 a[86:87], v18 offset:12288
v_mfma_f32_16x16x32_bf16 a[56:59], a[120:123], v[112:115], a[56:59]
ds_read_b64_tr_b16 a[88:89], v19 offset:0
v_mfma_f32_16x16x32_bf16 a[56:59], a[124:127], v[120:123], a[56:59]
buffer_load_dwordx4 v13, s[16:19], s34 offen offset:3072 lds
v_mfma_f32_16x16x32_bf16 a[60:63], a[120:123], v[116:119], a[60:63]
ds_read_b64_tr_b16 a[90:91], v19 offset:4096
ds_read_b64_tr_b16 a[92:93], v19 offset:8192
v_mfma_f32_16x16x32_bf16 a[60:63], a[124:127], v[124:127], a[60:63]
ds_read_b64_tr_b16 a[94:95], v19 offset:12288
s_add_u32 s34, s34, 131072
s_mov_b32 s36, 5
L_attn_kernel_down_loop:
s_waitcnt vmcnt(20) lgkmcnt(8)
v_mfma_f32_16x16x32_bf16 a[0:3], a[64:67], v[64:67], a[0:3]
ds_read_b64_tr_b16 a[96:97], v20 offset:0
v_mfma_f32_16x16x32_bf16 a[0:3], a[68:71], v[72:75], a[0:3]
buffer_load_dwordx4 v[112:115], v8, s[12:15], s33 offen offset:0 sc1
v_mfma_f32_16x16x32_bf16 a[4:7], a[64:67], v[68:71], a[4:7]
ds_read_b64_tr_b16 a[98:99], v20 offset:4096
ds_read_b64_tr_b16 a[100:101], v20 offset:8192
v_mfma_f32_16x16x32_bf16 a[4:7], a[68:71], v[76:79], a[4:7]
ds_read_b64_tr_b16 a[102:103], v20 offset:12288
v_mfma_f32_16x16x32_bf16 a[8:11], a[72:75], v[64:67], a[8:11]
ds_read_b64_tr_b16 a[104:105], v21 offset:0
v_mfma_f32_16x16x32_bf16 a[8:11], a[76:79], v[72:75], a[8:11]
buffer_load_dwordx4 v[116:119], v9, s[12:15], s33 offen offset:0 sc1
v_mfma_f32_16x16x32_bf16 a[12:15], a[72:75], v[68:71], a[12:15]
ds_read_b64_tr_b16 a[106:107], v21 offset:4096
ds_read_b64_tr_b16 a[108:109], v21 offset:8192
v_mfma_f32_16x16x32_bf16 a[12:15], a[76:79], v[76:79], a[12:15]
ds_read_b64_tr_b16 a[110:111], v21 offset:12288
s_waitcnt lgkmcnt(8)
v_mfma_f32_16x16x32_bf16 a[16:19], a[80:83], v[64:67], a[16:19]
ds_read_b64_tr_b16 a[112:113], v22 offset:0
v_mfma_f32_16x16x32_bf16 a[16:19], a[84:87], v[72:75], a[16:19]
buffer_load_dwordx4 v[120:123], v8, s[12:15], s33 offen offset:1024 sc1
v_mfma_f32_16x16x32_bf16 a[20:23], a[80:83], v[68:71], a[20:23]
ds_read_b64_tr_b16 a[114:115], v22 offset:4096
ds_read_b64_tr_b16 a[116:117], v22 offset:8192
v_mfma_f32_16x16x32_bf16 a[20:23], a[84:87], v[76:79], a[20:23]
ds_read_b64_tr_b16 a[118:119], v22 offset:12288
v_mfma_f32_16x16x32_bf16 a[24:27], a[88:91], v[64:67], a[24:27]
ds_read_b64_tr_b16 a[120:121], v23 offset:0
v_mfma_f32_16x16x32_bf16 a[24:27], a[92:95], v[72:75], a[24:27]
buffer_load_dwordx4 v[124:127], v9, s[12:15], s33 offen offset:1024 sc1
v_mfma_f32_16x16x32_bf16 a[28:31], a[88:91], v[68:71], a[28:31]
ds_read_b64_tr_b16 a[122:123], v23 offset:4096
ds_read_b64_tr_b16 a[124:125], v23 offset:8192
v_mfma_f32_16x16x32_bf16 a[28:31], a[92:95], v[76:79], a[28:31]
ds_read_b64_tr_b16 a[126:127], v23 offset:12288
s_waitcnt vmcnt(12) lgkmcnt(8)
s_barrier
v_mfma_f32_16x16x32_bf16 a[32:35], a[96:99], v[64:67], a[32:35]
ds_read_b64_tr_b16 a[64:65], v16 offset:16384
s_add_u32 m0, s35, 49152
v_mfma_f32_16x16x32_bf16 a[32:35], a[100:103], v[72:75], a[32:35]
buffer_load_dwordx4 v10, s[16:19], s34 offen offset:0 lds
v_mfma_f32_16x16x32_bf16 a[36:39], a[96:99], v[68:71], a[36:39]
ds_read_b64_tr_b16 a[66:67], v16 offset:20480
ds_read_b64_tr_b16 a[68:69], v16 offset:24576
v_mfma_f32_16x16x32_bf16 a[36:39], a[100:103], v[76:79], a[36:39]
ds_read_b64_tr_b16 a[70:71], v16 offset:28672
s_add_u32 s33, s33, 2048
v_mfma_f32_16x16x32_bf16 a[40:43], a[104:107], v[64:67], a[40:43]
ds_read_b64_tr_b16 a[72:73], v17 offset:16384
v_mfma_f32_16x16x32_bf16 a[40:43], a[108:111], v[72:75], a[40:43]
buffer_load_dwordx4 v11, s[16:19], s34 offen offset:1024 lds
v_mfma_f32_16x16x32_bf16 a[44:47], a[104:107], v[68:71], a[44:47]
ds_read_b64_tr_b16 a[74:75], v17 offset:20480
ds_read_b64_tr_b16 a[76:77], v17 offset:24576
v_mfma_f32_16x16x32_bf16 a[44:47], a[108:111], v[76:79], a[44:47]
ds_read_b64_tr_b16 a[78:79], v17 offset:28672
s_waitcnt lgkmcnt(8)
v_mfma_f32_16x16x32_bf16 a[48:51], a[112:115], v[64:67], a[48:51]
ds_read_b64_tr_b16 a[80:81], v18 offset:16384
v_mfma_f32_16x16x32_bf16 a[48:51], a[116:119], v[72:75], a[48:51]
buffer_load_dwordx4 v12, s[16:19], s34 offen offset:2048 lds
v_mfma_f32_16x16x32_bf16 a[52:55], a[112:115], v[68:71], a[52:55]
ds_read_b64_tr_b16 a[82:83], v18 offset:20480
ds_read_b64_tr_b16 a[84:85], v18 offset:24576
v_mfma_f32_16x16x32_bf16 a[52:55], a[116:119], v[76:79], a[52:55]
ds_read_b64_tr_b16 a[86:87], v18 offset:28672
v_mfma_f32_16x16x32_bf16 a[56:59], a[120:123], v[64:67], a[56:59]
ds_read_b64_tr_b16 a[88:89], v19 offset:16384
v_mfma_f32_16x16x32_bf16 a[56:59], a[124:127], v[72:75], a[56:59]
buffer_load_dwordx4 v13, s[16:19], s34 offen offset:3072 lds
v_mfma_f32_16x16x32_bf16 a[60:63], a[120:123], v[68:71], a[60:63]
ds_read_b64_tr_b16 a[90:91], v19 offset:20480
ds_read_b64_tr_b16 a[92:93], v19 offset:24576
v_mfma_f32_16x16x32_bf16 a[60:63], a[124:127], v[76:79], a[60:63]
ds_read_b64_tr_b16 a[94:95], v19 offset:28672
s_waitcnt vmcnt(20) lgkmcnt(8)
v_mfma_f32_16x16x32_bf16 a[0:3], a[64:67], v[80:83], a[0:3]
ds_read_b64_tr_b16 a[96:97], v20 offset:16384
s_add_u32 s34, s34, 131072
v_mfma_f32_16x16x32_bf16 a[0:3], a[68:71], v[88:91], a[0:3]
buffer_load_dwordx4 v[64:67], v8, s[12:15], s33 offen offset:0 sc1
v_mfma_f32_16x16x32_bf16 a[4:7], a[64:67], v[84:87], a[4:7]
ds_read_b64_tr_b16 a[98:99], v20 offset:20480
ds_read_b64_tr_b16 a[100:101], v20 offset:24576
v_mfma_f32_16x16x32_bf16 a[4:7], a[68:71], v[92:95], a[4:7]
ds_read_b64_tr_b16 a[102:103], v20 offset:28672
v_mfma_f32_16x16x32_bf16 a[8:11], a[72:75], v[80:83], a[8:11]
ds_read_b64_tr_b16 a[104:105], v21 offset:16384
v_mfma_f32_16x16x32_bf16 a[8:11], a[76:79], v[88:91], a[8:11]
buffer_load_dwordx4 v[68:71], v9, s[12:15], s33 offen offset:0 sc1
v_mfma_f32_16x16x32_bf16 a[12:15], a[72:75], v[84:87], a[12:15]
ds_read_b64_tr_b16 a[106:107], v21 offset:20480
ds_read_b64_tr_b16 a[108:109], v21 offset:24576
v_mfma_f32_16x16x32_bf16 a[12:15], a[76:79], v[92:95], a[12:15]
ds_read_b64_tr_b16 a[110:111], v21 offset:28672
s_waitcnt lgkmcnt(8)
v_mfma_f32_16x16x32_bf16 a[16:19], a[80:83], v[80:83], a[16:19]
ds_read_b64_tr_b16 a[112:113], v22 offset:16384
v_mfma_f32_16x16x32_bf16 a[16:19], a[84:87], v[88:91], a[16:19]
buffer_load_dwordx4 v[72:75], v8, s[12:15], s33 offen offset:1024 sc1
v_mfma_f32_16x16x32_bf16 a[20:23], a[80:83], v[84:87], a[20:23]
ds_read_b64_tr_b16 a[114:115], v22 offset:20480
ds_read_b64_tr_b16 a[116:117], v22 offset:24576
v_mfma_f32_16x16x32_bf16 a[20:23], a[84:87], v[92:95], a[20:23]
ds_read_b64_tr_b16 a[118:119], v22 offset:28672
v_mfma_f32_16x16x32_bf16 a[24:27], a[88:91], v[80:83], a[24:27]
ds_read_b64_tr_b16 a[120:121], v23 offset:16384
v_mfma_f32_16x16x32_bf16 a[24:27], a[92:95], v[88:91], a[24:27]
buffer_load_dwordx4 v[76:79], v9, s[12:15], s33 offen offset:1024 sc1
v_mfma_f32_16x16x32_bf16 a[28:31], a[88:91], v[84:87], a[28:31]
ds_read_b64_tr_b16 a[122:123], v23 offset:20480
ds_read_b64_tr_b16 a[124:125], v23 offset:24576
v_mfma_f32_16x16x32_bf16 a[28:31], a[92:95], v[92:95], a[28:31]
ds_read_b64_tr_b16 a[126:127], v23 offset:28672
s_waitcnt vmcnt(12) lgkmcnt(8)
s_barrier
v_mfma_f32_16x16x32_bf16 a[32:35], a[96:99], v[80:83], a[32:35]
ds_read_b64_tr_b16 a[64:65], v16 offset:32768
s_add_u32 m0, s35, 0
v_mfma_f32_16x16x32_bf16 a[32:35], a[100:103], v[88:91], a[32:35]
buffer_load_dwordx4 v10, s[16:19], s34 offen offset:0 lds
v_mfma_f32_16x16x32_bf16 a[36:39], a[96:99], v[84:87], a[36:39]
ds_read_b64_tr_b16 a[66:67], v16 offset:36864
ds_read_b64_tr_b16 a[68:69], v16 offset:40960
v_mfma_f32_16x16x32_bf16 a[36:39], a[100:103], v[92:95], a[36:39]
ds_read_b64_tr_b16 a[70:71], v16 offset:45056
s_add_u32 s33, s33, 2048
v_mfma_f32_16x16x32_bf16 a[40:43], a[104:107], v[80:83], a[40:43]
ds_read_b64_tr_b16 a[72:73], v17 offset:32768
v_mfma_f32_16x16x32_bf16 a[40:43], a[108:111], v[88:91], a[40:43]
buffer_load_dwordx4 v11, s[16:19], s34 offen offset:1024 lds
v_mfma_f32_16x16x32_bf16 a[44:47], a[104:107], v[84:87], a[44:47]
ds_read_b64_tr_b16 a[74:75], v17 offset:36864
ds_read_b64_tr_b16 a[76:77], v17 offset:40960
v_mfma_f32_16x16x32_bf16 a[44:47], a[108:111], v[92:95], a[44:47]
ds_read_b64_tr_b16 a[78:79], v17 offset:45056
s_waitcnt lgkmcnt(8)
v_mfma_f32_16x16x32_bf16 a[48:51], a[112:115], v[80:83], a[48:51]
ds_read_b64_tr_b16 a[80:81], v18 offset:32768
v_mfma_f32_16x16x32_bf16 a[48:51], a[116:119], v[88:91], a[48:51]
buffer_load_dwordx4 v12, s[16:19], s34 offen offset:2048 lds
v_mfma_f32_16x16x32_bf16 a[52:55], a[112:115], v[84:87], a[52:55]
ds_read_b64_tr_b16 a[82:83], v18 offset:36864
ds_read_b64_tr_b16 a[84:85], v18 offset:40960
v_mfma_f32_16x16x32_bf16 a[52:55], a[116:119], v[92:95], a[52:55]
ds_read_b64_tr_b16 a[86:87], v18 offset:45056
v_mfma_f32_16x16x32_bf16 a[56:59], a[120:123], v[80:83], a[56:59]
ds_read_b64_tr_b16 a[88:89], v19 offset:32768
v_mfma_f32_16x16x32_bf16 a[56:59], a[124:127], v[88:91], a[56:59]
buffer_load_dwordx4 v13, s[16:19], s34 offen offset:3072 lds
v_mfma_f32_16x16x32_bf16 a[60:63], a[120:123], v[84:87], a[60:63]
ds_read_b64_tr_b16 a[90:91], v19 offset:36864
ds_read_b64_tr_b16 a[92:93], v19 offset:40960
v_mfma_f32_16x16x32_bf16 a[60:63], a[124:127], v[92:95], a[60:63]
ds_read_b64_tr_b16 a[94:95], v19 offset:45056
s_waitcnt vmcnt(20) lgkmcnt(8)
v_mfma_f32_16x16x32_bf16 a[0:3], a[64:67], v[96:99], a[0:3]
ds_read_b64_tr_b16 a[96:97], v20 offset:32768
s_add_u32 s34, s34, 131072
v_mfma_f32_16x16x32_bf16 a[0:3], a[68:71], v[104:107], a[0:3]
buffer_load_dwordx4 v[80:83], v8, s[12:15], s33 offen offset:0 sc1
v_mfma_f32_16x16x32_bf16 a[4:7], a[64:67], v[100:103], a[4:7]
ds_read_b64_tr_b16 a[98:99], v20 offset:36864
ds_read_b64_tr_b16 a[100:101], v20 offset:40960
v_mfma_f32_16x16x32_bf16 a[4:7], a[68:71], v[108:111], a[4:7]
ds_read_b64_tr_b16 a[102:103], v20 offset:45056
v_mfma_f32_16x16x32_bf16 a[8:11], a[72:75], v[96:99], a[8:11]
ds_read_b64_tr_b16 a[104:105], v21 offset:32768
v_mfma_f32_16x16x32_bf16 a[8:11], a[76:79], v[104:107], a[8:11]
buffer_load_dwordx4 v[84:87], v9, s[12:15], s33 offen offset:0 sc1
v_mfma_f32_16x16x32_bf16 a[12:15], a[72:75], v[100:103], a[12:15]
ds_read_b64_tr_b16 a[106:107], v21 offset:36864
ds_read_b64_tr_b16 a[108:109], v21 offset:40960
v_mfma_f32_16x16x32_bf16 a[12:15], a[76:79], v[108:111], a[12:15]
ds_read_b64_tr_b16 a[110:111], v21 offset:45056
s_waitcnt lgkmcnt(8)
v_mfma_f32_16x16x32_bf16 a[16:19], a[80:83], v[96:99], a[16:19]
ds_read_b64_tr_b16 a[112:113], v22 offset:32768
v_mfma_f32_16x16x32_bf16 a[16:19], a[84:87], v[104:107], a[16:19]
buffer_load_dwordx4 v[88:91], v8, s[12:15], s33 offen offset:1024 sc1
v_mfma_f32_16x16x32_bf16 a[20:23], a[80:83], v[100:103], a[20:23]
ds_read_b64_tr_b16 a[114:115], v22 offset:36864
ds_read_b64_tr_b16 a[116:117], v22 offset:40960
v_mfma_f32_16x16x32_bf16 a[20:23], a[84:87], v[108:111], a[20:23]
ds_read_b64_tr_b16 a[118:119], v22 offset:45056
v_mfma_f32_16x16x32_bf16 a[24:27], a[88:91], v[96:99], a[24:27]
ds_read_b64_tr_b16 a[120:121], v23 offset:32768
v_mfma_f32_16x16x32_bf16 a[24:27], a[92:95], v[104:107], a[24:27]
buffer_load_dwordx4 v[92:95], v9, s[12:15], s33 offen offset:1024 sc1
v_mfma_f32_16x16x32_bf16 a[28:31], a[88:91], v[100:103], a[28:31]
ds_read_b64_tr_b16 a[122:123], v23 offset:36864
ds_read_b64_tr_b16 a[124:125], v23 offset:40960
v_mfma_f32_16x16x32_bf16 a[28:31], a[92:95], v[108:111], a[28:31]
ds_read_b64_tr_b16 a[126:127], v23 offset:45056
s_waitcnt vmcnt(12) lgkmcnt(8)
s_barrier
v_mfma_f32_16x16x32_bf16 a[32:35], a[96:99], v[96:99], a[32:35]
ds_read_b64_tr_b16 a[64:65], v16 offset:49152
s_add_u32 m0, s35, 16384
v_mfma_f32_16x16x32_bf16 a[32:35], a[100:103], v[104:107], a[32:35]
buffer_load_dwordx4 v10, s[16:19], s34 offen offset:0 lds
v_mfma_f32_16x16x32_bf16 a[36:39], a[96:99], v[100:103], a[36:39]
ds_read_b64_tr_b16 a[66:67], v16 offset:53248
ds_read_b64_tr_b16 a[68:69], v16 offset:57344
v_mfma_f32_16x16x32_bf16 a[36:39], a[100:103], v[108:111], a[36:39]
ds_read_b64_tr_b16 a[70:71], v16 offset:61440
s_add_u32 s33, s33, 2048
v_mfma_f32_16x16x32_bf16 a[40:43], a[104:107], v[96:99], a[40:43]
ds_read_b64_tr_b16 a[72:73], v17 offset:49152
v_mfma_f32_16x16x32_bf16 a[40:43], a[108:111], v[104:107], a[40:43]
buffer_load_dwordx4 v11, s[16:19], s34 offen offset:1024 lds
v_mfma_f32_16x16x32_bf16 a[44:47], a[104:107], v[100:103], a[44:47]
ds_read_b64_tr_b16 a[74:75], v17 offset:53248
ds_read_b64_tr_b16 a[76:77], v17 offset:57344
v_mfma_f32_16x16x32_bf16 a[44:47], a[108:111], v[108:111], a[44:47]
ds_read_b64_tr_b16 a[78:79], v17 offset:61440
s_waitcnt lgkmcnt(8)
v_mfma_f32_16x16x32_bf16 a[48:51], a[112:115], v[96:99], a[48:51]
ds_read_b64_tr_b16 a[80:81], v18 offset:49152
v_mfma_f32_16x16x32_bf16 a[48:51], a[116:119], v[104:107], a[48:51]
buffer_load_dwordx4 v12, s[16:19], s34 offen offset:2048 lds
v_mfma_f32_16x16x32_bf16 a[52:55], a[112:115], v[100:103], a[52:55]
ds_read_b64_tr_b16 a[82:83], v18 offset:53248
ds_read_b64_tr_b16 a[84:85], v18 offset:57344
v_mfma_f32_16x16x32_bf16 a[52:55], a[116:119], v[108:111], a[52:55]
ds_read_b64_tr_b16 a[86:87], v18 offset:61440
v_mfma_f32_16x16x32_bf16 a[56:59], a[120:123], v[96:99], a[56:59]
ds_read_b64_tr_b16 a[88:89], v19 offset:49152
v_mfma_f32_16x16x32_bf16 a[56:59], a[124:127], v[104:107], a[56:59]
buffer_load_dwordx4 v13, s[16:19], s34 offen offset:3072 lds
v_mfma_f32_16x16x32_bf16 a[60:63], a[120:123], v[100:103], a[60:63]
ds_read_b64_tr_b16 a[90:91], v19 offset:53248
ds_read_b64_tr_b16 a[92:93], v19 offset:57344
v_mfma_f32_16x16x32_bf16 a[60:63], a[124:127], v[108:111], a[60:63]
ds_read_b64_tr_b16 a[94:95], v19 offset:61440
s_waitcnt vmcnt(20) lgkmcnt(8)
v_mfma_f32_16x16x32_bf16 a[0:3], a[64:67], v[112:115], a[0:3]
ds_read_b64_tr_b16 a[96:97], v20 offset:49152
s_add_u32 s34, s34, 131072
v_mfma_f32_16x16x32_bf16 a[0:3], a[68:71], v[120:123], a[0:3]
buffer_load_dwordx4 v[96:99], v8, s[12:15], s33 offen offset:0 sc1
v_mfma_f32_16x16x32_bf16 a[4:7], a[64:67], v[116:119], a[4:7]
ds_read_b64_tr_b16 a[98:99], v20 offset:53248
ds_read_b64_tr_b16 a[100:101], v20 offset:57344
v_mfma_f32_16x16x32_bf16 a[4:7], a[68:71], v[124:127], a[4:7]
ds_read_b64_tr_b16 a[102:103], v20 offset:61440
v_mfma_f32_16x16x32_bf16 a[8:11], a[72:75], v[112:115], a[8:11]
ds_read_b64_tr_b16 a[104:105], v21 offset:49152
v_mfma_f32_16x16x32_bf16 a[8:11], a[76:79], v[120:123], a[8:11]
buffer_load_dwordx4 v[100:103], v9, s[12:15], s33 offen offset:0 sc1
v_mfma_f32_16x16x32_bf16 a[12:15], a[72:75], v[116:119], a[12:15]
ds_read_b64_tr_b16 a[106:107], v21 offset:53248
ds_read_b64_tr_b16 a[108:109], v21 offset:57344
v_mfma_f32_16x16x32_bf16 a[12:15], a[76:79], v[124:127], a[12:15]
ds_read_b64_tr_b16 a[110:111], v21 offset:61440
s_waitcnt lgkmcnt(8)
v_mfma_f32_16x16x32_bf16 a[16:19], a[80:83], v[112:115], a[16:19]
ds_read_b64_tr_b16 a[112:113], v22 offset:49152
v_mfma_f32_16x16x32_bf16 a[16:19], a[84:87], v[120:123], a[16:19]
buffer_load_dwordx4 v[104:107], v8, s[12:15], s33 offen offset:1024 sc1
v_mfma_f32_16x16x32_bf16 a[20:23], a[80:83], v[116:119], a[20:23]
ds_read_b64_tr_b16 a[114:115], v22 offset:53248
ds_read_b64_tr_b16 a[116:117], v22 offset:57344
v_mfma_f32_16x16x32_bf16 a[20:23], a[84:87], v[124:127], a[20:23]
ds_read_b64_tr_b16 a[118:119], v22 offset:61440
v_mfma_f32_16x16x32_bf16 a[24:27], a[88:91], v[112:115], a[24:27]
ds_read_b64_tr_b16 a[120:121], v23 offset:49152
v_mfma_f32_16x16x32_bf16 a[24:27], a[92:95], v[120:123], a[24:27]
buffer_load_dwordx4 v[108:111], v9, s[12:15], s33 offen offset:1024 sc1
v_mfma_f32_16x16x32_bf16 a[28:31], a[88:91], v[116:119], a[28:31]
ds_read_b64_tr_b16 a[122:123], v23 offset:53248
ds_read_b64_tr_b16 a[124:125], v23 offset:57344
v_mfma_f32_16x16x32_bf16 a[28:31], a[92:95], v[124:127], a[28:31]
ds_read_b64_tr_b16 a[126:127], v23 offset:61440
s_waitcnt vmcnt(12) lgkmcnt(8)
s_barrier
v_mfma_f32_16x16x32_bf16 a[32:35], a[96:99], v[112:115], a[32:35]
ds_read_b64_tr_b16 a[64:65], v16 offset:0
s_add_u32 m0, s35, 32768
v_mfma_f32_16x16x32_bf16 a[32:35], a[100:103], v[120:123], a[32:35]
buffer_load_dwordx4 v10, s[16:19], s34 offen offset:0 lds
v_mfma_f32_16x16x32_bf16 a[36:39], a[96:99], v[116:119], a[36:39]
ds_read_b64_tr_b16 a[66:67], v16 offset:4096
ds_read_b64_tr_b16 a[68:69], v16 offset:8192
v_mfma_f32_16x16x32_bf16 a[36:39], a[100:103], v[124:127], a[36:39]
ds_read_b64_tr_b16 a[70:71], v16 offset:12288
s_add_u32 s33, s33, 2048
v_mfma_f32_16x16x32_bf16 a[40:43], a[104:107], v[112:115], a[40:43]
ds_read_b64_tr_b16 a[72:73], v17 offset:0
v_mfma_f32_16x16x32_bf16 a[40:43], a[108:111], v[120:123], a[40:43]
buffer_load_dwordx4 v11, s[16:19], s34 offen offset:1024 lds
v_mfma_f32_16x16x32_bf16 a[44:47], a[104:107], v[116:119], a[44:47]
ds_read_b64_tr_b16 a[74:75], v17 offset:4096
ds_read_b64_tr_b16 a[76:77], v17 offset:8192
v_mfma_f32_16x16x32_bf16 a[44:47], a[108:111], v[124:127], a[44:47]
ds_read_b64_tr_b16 a[78:79], v17 offset:12288
s_waitcnt lgkmcnt(8)
v_mfma_f32_16x16x32_bf16 a[48:51], a[112:115], v[112:115], a[48:51]
ds_read_b64_tr_b16 a[80:81], v18 offset:0
v_mfma_f32_16x16x32_bf16 a[48:51], a[116:119], v[120:123], a[48:51]
buffer_load_dwordx4 v12, s[16:19], s34 offen offset:2048 lds
v_mfma_f32_16x16x32_bf16 a[52:55], a[112:115], v[116:119], a[52:55]
ds_read_b64_tr_b16 a[82:83], v18 offset:4096
ds_read_b64_tr_b16 a[84:85], v18 offset:8192
v_mfma_f32_16x16x32_bf16 a[52:55], a[116:119], v[124:127], a[52:55]
ds_read_b64_tr_b16 a[86:87], v18 offset:12288
v_mfma_f32_16x16x32_bf16 a[56:59], a[120:123], v[112:115], a[56:59]
ds_read_b64_tr_b16 a[88:89], v19 offset:0
v_mfma_f32_16x16x32_bf16 a[56:59], a[124:127], v[120:123], a[56:59]
buffer_load_dwordx4 v13, s[16:19], s34 offen offset:3072 lds
v_mfma_f32_16x16x32_bf16 a[60:63], a[120:123], v[116:119], a[60:63]
ds_read_b64_tr_b16 a[90:91], v19 offset:4096
ds_read_b64_tr_b16 a[92:93], v19 offset:8192
v_mfma_f32_16x16x32_bf16 a[60:63], a[124:127], v[124:127], a[60:63]
ds_read_b64_tr_b16 a[94:95], v19 offset:12288
s_add_u32 s34, s34, 131072
s_sub_u32 s36, s36, 1
s_cmp_lg_u32 s36, 0
s_cbranch_scc1 L_attn_kernel_down_loop
s_waitcnt vmcnt(20) lgkmcnt(8)
v_mfma_f32_16x16x32_bf16 a[0:3], a[64:67], v[64:67], a[0:3]
ds_read_b64_tr_b16 a[96:97], v20 offset:0
v_mfma_f32_16x16x32_bf16 a[0:3], a[68:71], v[72:75], a[0:3]
buffer_load_dwordx4 v[112:115], v8, s[12:15], s33 offen offset:0 sc1
v_mfma_f32_16x16x32_bf16 a[4:7], a[64:67], v[68:71], a[4:7]
ds_read_b64_tr_b16 a[98:99], v20 offset:4096
ds_read_b64_tr_b16 a[100:101], v20 offset:8192
v_mfma_f32_16x16x32_bf16 a[4:7], a[68:71], v[76:79], a[4:7]
ds_read_b64_tr_b16 a[102:103], v20 offset:12288
v_mfma_f32_16x16x32_bf16 a[8:11], a[72:75], v[64:67], a[8:11]
ds_read_b64_tr_b16 a[104:105], v21 offset:0
v_mfma_f32_16x16x32_bf16 a[8:11], a[76:79], v[72:75], a[8:11]
buffer_load_dwordx4 v[116:119], v9, s[12:15], s33 offen offset:0 sc1
v_mfma_f32_16x16x32_bf16 a[12:15], a[72:75], v[68:71], a[12:15]
ds_read_b64_tr_b16 a[106:107], v21 offset:4096
ds_read_b64_tr_b16 a[108:109], v21 offset:8192
v_mfma_f32_16x16x32_bf16 a[12:15], a[76:79], v[76:79], a[12:15]
ds_read_b64_tr_b16 a[110:111], v21 offset:12288
s_waitcnt lgkmcnt(8)
v_mfma_f32_16x16x32_bf16 a[16:19], a[80:83], v[64:67], a[16:19]
ds_read_b64_tr_b16 a[112:113], v22 offset:0
v_mfma_f32_16x16x32_bf16 a[16:19], a[84:87], v[72:75], a[16:19]
buffer_load_dwordx4 v[120:123], v8, s[12:15], s33 offen offset:1024 sc1
v_mfma_f32_16x16x32_bf16 a[20:23], a[80:83], v[68:71], a[20:23]
ds_read_b64_tr_b16 a[114:115], v22 offset:4096
ds_read_b64_tr_b16 a[116:117], v22 offset:8192
v_mfma_f32_16x16x32_bf16 a[20:23], a[84:87], v[76:79], a[20:23]
ds_read_b64_tr_b16 a[118:119], v22 offset:12288
v_mfma_f32_16x16x32_bf16 a[24:27], a[88:91], v[64:67], a[24:27]
ds_read_b64_tr_b16 a[120:121], v23 offset:0
v_mfma_f32_16x16x32_bf16 a[24:27], a[92:95], v[72:75], a[24:27]
buffer_load_dwordx4 v[124:127], v9, s[12:15], s33 offen offset:1024 sc1
v_mfma_f32_16x16x32_bf16 a[28:31], a[88:91], v[68:71], a[28:31]
ds_read_b64_tr_b16 a[122:123], v23 offset:4096
ds_read_b64_tr_b16 a[124:125], v23 offset:8192
v_mfma_f32_16x16x32_bf16 a[28:31], a[92:95], v[76:79], a[28:31]
ds_read_b64_tr_b16 a[126:127], v23 offset:12288
s_waitcnt vmcnt(12) lgkmcnt(8)
s_barrier
v_mfma_f32_16x16x32_bf16 a[32:35], a[96:99], v[64:67], a[32:35]
ds_read_b64_tr_b16 a[64:65], v16 offset:16384
s_add_u32 m0, s35, 49152
v_mfma_f32_16x16x32_bf16 a[32:35], a[100:103], v[72:75], a[32:35]
buffer_load_dwordx4 v10, s[16:19], s34 offen offset:0 lds
v_mfma_f32_16x16x32_bf16 a[36:39], a[96:99], v[68:71], a[36:39]
ds_read_b64_tr_b16 a[66:67], v16 offset:20480
ds_read_b64_tr_b16 a[68:69], v16 offset:24576
v_mfma_f32_16x16x32_bf16 a[36:39], a[100:103], v[76:79], a[36:39]
ds_read_b64_tr_b16 a[70:71], v16 offset:28672
s_add_u32 s33, s33, 2048
v_mfma_f32_16x16x32_bf16 a[40:43], a[104:107], v[64:67], a[40:43]
ds_read_b64_tr_b16 a[72:73], v17 offset:16384
v_mfma_f32_16x16x32_bf16 a[40:43], a[108:111], v[72:75], a[40:43]
buffer_load_dwordx4 v11, s[16:19], s34 offen offset:1024 lds
v_mfma_f32_16x16x32_bf16 a[44:47], a[104:107], v[68:71], a[44:47]
ds_read_b64_tr_b16 a[74:75], v17 offset:20480
ds_read_b64_tr_b16 a[76:77], v17 offset:24576
v_mfma_f32_16x16x32_bf16 a[44:47], a[108:111], v[76:79], a[44:47]
ds_read_b64_tr_b16 a[78:79], v17 offset:28672
s_waitcnt lgkmcnt(8)
v_mfma_f32_16x16x32_bf16 a[48:51], a[112:115], v[64:67], a[48:51]
ds_read_b64_tr_b16 a[80:81], v18 offset:16384
v_mfma_f32_16x16x32_bf16 a[48:51], a[116:119], v[72:75], a[48:51]
buffer_load_dwordx4 v12, s[16:19], s34 offen offset:2048 lds
v_mfma_f32_16x16x32_bf16 a[52:55], a[112:115], v[68:71], a[52:55]
ds_read_b64_tr_b16 a[82:83], v18 offset:20480
ds_read_b64_tr_b16 a[84:85], v18 offset:24576
v_mfma_f32_16x16x32_bf16 a[52:55], a[116:119], v[76:79], a[52:55]
ds_read_b64_tr_b16 a[86:87], v18 offset:28672
v_lshlrev_b32 v2, 4, v4
v_mfma_f32_16x16x32_bf16 a[56:59], a[120:123], v[64:67], a[56:59]
ds_read_b64_tr_b16 a[88:89], v19 offset:16384
s_lshl_b32 s42, s40, 9
s_lshl_b32 s43, s58, 8
s_add_u32 s42, s42, s43
s_add_u32 s42, s42, 20480
v_mfma_f32_16x16x32_bf16 a[56:59], a[124:127], v[72:75], a[56:59]
buffer_load_dwordx4 v13, s[16:19], s34 offen offset:3072 lds
v_mfma_f32_16x16x32_bf16 a[60:63], a[120:123], v[68:71], a[60:63]
ds_read_b64_tr_b16 a[90:91], v19 offset:20480
ds_read_b64_tr_b16 a[92:93], v19 offset:24576
v_mfma_f32_16x16x32_bf16 a[60:63], a[124:127], v[76:79], a[60:63]
ds_read_b64_tr_b16 a[94:95], v19 offset:28672
buffer_load_dwordx4 v[144:147], v2, s[20:23], s42 offen offset:0
s_waitcnt vmcnt(21) lgkmcnt(8)
v_mfma_f32_16x16x32_bf16 a[0:3], a[64:67], v[80:83], a[0:3]
ds_read_b64_tr_b16 a[96:97], v20 offset:16384
s_add_u32 s34, s34, 131072
v_mfma_f32_16x16x32_bf16 a[0:3], a[68:71], v[88:91], a[0:3]
buffer_load_dwordx4 v[148:151], v2, s[20:23], s42 offen offset:64
v_mfma_f32_16x16x32_bf16 a[4:7], a[64:67], v[84:87], a[4:7]
ds_read_b64_tr_b16 a[98:99], v20 offset:20480
ds_read_b64_tr_b16 a[100:101], v20 offset:24576
v_mfma_f32_16x16x32_bf16 a[4:7], a[68:71], v[92:95], a[4:7]
ds_read_b64_tr_b16 a[102:103], v20 offset:28672
buffer_load_dwordx4 v[152:155], v2, s[20:23], s42 offen offset:128
v_mfma_f32_16x16x32_bf16 a[8:11], a[72:75], v[80:83], a[8:11]
ds_read_b64_tr_b16 a[104:105], v21 offset:16384
v_mfma_f32_16x16x32_bf16 a[8:11], a[76:79], v[88:91], a[8:11]
buffer_load_dwordx4 v[156:159], v2, s[20:23], s42 offen offset:192
v_mfma_f32_16x16x32_bf16 a[12:15], a[72:75], v[84:87], a[12:15]
ds_read_b64_tr_b16 a[106:107], v21 offset:20480
ds_read_b64_tr_b16 a[108:109], v21 offset:24576
s_add_u32 s42, s42, 32768
v_mfma_f32_16x16x32_bf16 a[12:15], a[76:79], v[92:95], a[12:15]
ds_read_b64_tr_b16 a[110:111], v21 offset:28672
buffer_load_dwordx4 v[160:163], v2, s[20:23], s42 offen offset:0
s_waitcnt lgkmcnt(8)
v_mfma_f32_16x16x32_bf16 a[16:19], a[80:83], v[80:83], a[16:19]
ds_read_b64_tr_b16 a[112:113], v22 offset:16384
v_mfma_f32_16x16x32_bf16 a[16:19], a[84:87], v[88:91], a[16:19]
buffer_load_dwordx4 v[164:167], v2, s[20:23], s42 offen offset:64
v_mfma_f32_16x16x32_bf16 a[20:23], a[80:83], v[84:87], a[20:23]
ds_read_b64_tr_b16 a[114:115], v22 offset:20480
ds_read_b64_tr_b16 a[116:117], v22 offset:24576
v_mfma_f32_16x16x32_bf16 a[20:23], a[84:87], v[92:95], a[20:23]
ds_read_b64_tr_b16 a[118:119], v22 offset:28672
buffer_load_dwordx4 v[168:171], v2, s[20:23], s42 offen offset:128
v_mfma_f32_16x16x32_bf16 a[24:27], a[88:91], v[80:83], a[24:27]
ds_read_b64_tr_b16 a[120:121], v23 offset:16384
v_mfma_f32_16x16x32_bf16 a[24:27], a[92:95], v[88:91], a[24:27]
buffer_load_dwordx4 v[172:175], v2, s[20:23], s42 offen offset:192
v_mfma_f32_16x16x32_bf16 a[28:31], a[88:91], v[84:87], a[28:31]
ds_read_b64_tr_b16 a[122:123], v23 offset:20480
ds_read_b64_tr_b16 a[124:125], v23 offset:24576
s_lshl_b32 s42, s39, 18
s_lshl_b32 s43, s32, 16
s_add_u32 s42, s42, s43
s_lshl_b32 s43, s40, 12
s_add_u32 s42, s42, s43
s_lshl_b32 s43, s58, 11
s_add_u32 s42, s42, s43
v_mfma_f32_16x16x32_bf16 a[28:31], a[92:95], v[92:95], a[28:31]
ds_read_b64_tr_b16 a[126:127], v23 offset:28672
buffer_load_dwordx4 v[128:131], v3, s[24:27], s42 offen offset:0 sc1
s_waitcnt vmcnt(17) lgkmcnt(8)
s_barrier
v_mfma_f32_16x16x32_bf16 a[32:35], a[96:99], v[80:83], a[32:35]
ds_read_b64_tr_b16 a[64:65], v16 offset:32768
v_mfma_f32_16x16x32_bf16 a[32:35], a[100:103], v[88:91], a[32:35]
buffer_load_dwordx4 v[132:135], v3, s[24:27], s42 offen offset:1024 sc1
v_mfma_f32_16x16x32_bf16 a[36:39], a[96:99], v[84:87], a[36:39]
ds_read_b64_tr_b16 a[66:67], v16 offset:36864
ds_read_b64_tr_b16 a[68:69], v16 offset:40960
s_add_u32 s42, s42, 0x8000
v_mfma_f32_16x16x32_bf16 a[36:39], a[100:103], v[92:95], a[36:39]
ds_read_b64_tr_b16 a[70:71], v16 offset:45056
buffer_load_dwordx4 v[136:139], v3, s[24:27], s42 offen offset:0 sc1
v_mfma_f32_16x16x32_bf16 a[40:43], a[104:107], v[80:83], a[40:43]
ds_read_b64_tr_b16 a[72:73], v17 offset:32768
v_mfma_f32_16x16x32_bf16 a[40:43], a[108:111], v[88:91], a[40:43]
buffer_load_dwordx4 v[140:143], v3, s[24:27], s42 offen offset:1024 sc1
v_mfma_f32_16x16x32_bf16 a[44:47], a[104:107], v[84:87], a[44:47]
ds_read_b64_tr_b16 a[74:75], v17 offset:36864
ds_read_b64_tr_b16 a[76:77], v17 offset:40960
v_mfma_f32_16x16x32_bf16 a[44:47], a[108:111], v[92:95], a[44:47]
ds_read_b64_tr_b16 a[78:79], v17 offset:45056
s_waitcnt lgkmcnt(8)
v_mfma_f32_16x16x32_bf16 a[48:51], a[112:115], v[80:83], a[48:51]
ds_read_b64_tr_b16 a[80:81], v18 offset:32768
v_mfma_f32_16x16x32_bf16 a[48:51], a[116:119], v[88:91], a[48:51]
v_mfma_f32_16x16x32_bf16 a[52:55], a[112:115], v[84:87], a[52:55]
ds_read_b64_tr_b16 a[82:83], v18 offset:36864
ds_read_b64_tr_b16 a[84:85], v18 offset:40960
v_mfma_f32_16x16x32_bf16 a[52:55], a[116:119], v[92:95], a[52:55]
ds_read_b64_tr_b16 a[86:87], v18 offset:45056
v_mfma_f32_16x16x32_bf16 a[56:59], a[120:123], v[80:83], a[56:59]
ds_read_b64_tr_b16 a[88:89], v19 offset:32768
v_mfma_f32_16x16x32_bf16 a[56:59], a[124:127], v[88:91], a[56:59]
v_mfma_f32_16x16x32_bf16 a[60:63], a[120:123], v[84:87], a[60:63]
ds_read_b64_tr_b16 a[90:91], v19 offset:36864
ds_read_b64_tr_b16 a[92:93], v19 offset:40960
v_mfma_f32_16x16x32_bf16 a[60:63], a[124:127], v[92:95], a[60:63]
ds_read_b64_tr_b16 a[94:95], v19 offset:45056
s_waitcnt vmcnt(24) lgkmcnt(8)
v_mfma_f32_16x16x32_bf16 a[0:3], a[64:67], v[96:99], a[0:3]
ds_read_b64_tr_b16 a[96:97], v20 offset:32768
v_mfma_f32_16x16x32_bf16 a[0:3], a[68:71], v[104:107], a[0:3]
v_mfma_f32_16x16x32_bf16 a[4:7], a[64:67], v[100:103], a[4:7]
ds_read_b64_tr_b16 a[98:99], v20 offset:36864
ds_read_b64_tr_b16 a[100:101], v20 offset:40960
v_mfma_f32_16x16x32_bf16 a[4:7], a[68:71], v[108:111], a[4:7]
ds_read_b64_tr_b16 a[102:103], v20 offset:45056
v_mfma_f32_16x16x32_bf16 a[8:11], a[72:75], v[96:99], a[8:11]
ds_read_b64_tr_b16 a[104:105], v21 offset:32768
v_mfma_f32_16x16x32_bf16 a[8:11], a[76:79], v[104:107], a[8:11]
v_mfma_f32_16x16x32_bf16 a[12:15], a[72:75], v[100:103], a[12:15]
ds_read_b64_tr_b16 a[106:107], v21 offset:36864
ds_read_b64_tr_b16 a[108:109], v21 offset:40960
v_mfma_f32_16x16x32_bf16 a[12:15], a[76:79], v[108:111], a[12:15]
ds_read_b64_tr_b16 a[110:111], v21 offset:45056
s_waitcnt lgkmcnt(8)
v_mfma_f32_16x16x32_bf16 a[16:19], a[80:83], v[96:99], a[16:19]
ds_read_b64_tr_b16 a[112:113], v22 offset:32768
v_mfma_f32_16x16x32_bf16 a[16:19], a[84:87], v[104:107], a[16:19]
v_mfma_f32_16x16x32_bf16 a[20:23], a[80:83], v[100:103], a[20:23]
ds_read_b64_tr_b16 a[114:115], v22 offset:36864
ds_read_b64_tr_b16 a[116:117], v22 offset:40960
v_mfma_f32_16x16x32_bf16 a[20:23], a[84:87], v[108:111], a[20:23]
ds_read_b64_tr_b16 a[118:119], v22 offset:45056
v_mfma_f32_16x16x32_bf16 a[24:27], a[88:91], v[96:99], a[24:27]
ds_read_b64_tr_b16 a[120:121], v23 offset:32768
v_mfma_f32_16x16x32_bf16 a[24:27], a[92:95], v[104:107], a[24:27]
v_mfma_f32_16x16x32_bf16 a[28:31], a[88:91], v[100:103], a[28:31]
ds_read_b64_tr_b16 a[122:123], v23 offset:36864
ds_read_b64_tr_b16 a[124:125], v23 offset:40960
v_mfma_f32_16x16x32_bf16 a[28:31], a[92:95], v[108:111], a[28:31]
ds_read_b64_tr_b16 a[126:127], v23 offset:45056
s_waitcnt vmcnt(12) lgkmcnt(8)
s_barrier
v_mfma_f32_16x16x32_bf16 a[32:35], a[96:99], v[96:99], a[32:35]
ds_read_b64_tr_b16 a[64:65], v16 offset:49152
v_mfma_f32_16x16x32_bf16 a[32:35], a[100:103], v[104:107], a[32:35]
v_mfma_f32_16x16x32_bf16 a[36:39], a[96:99], v[100:103], a[36:39]
ds_read_b64_tr_b16 a[66:67], v16 offset:53248
ds_read_b64_tr_b16 a[68:69], v16 offset:57344
v_mfma_f32_16x16x32_bf16 a[36:39], a[100:103], v[108:111], a[36:39]
ds_read_b64_tr_b16 a[70:71], v16 offset:61440
v_mfma_f32_16x16x32_bf16 a[40:43], a[104:107], v[96:99], a[40:43]
ds_read_b64_tr_b16 a[72:73], v17 offset:49152
v_mfma_f32_16x16x32_bf16 a[40:43], a[108:111], v[104:107], a[40:43]
v_mfma_f32_16x16x32_bf16 a[44:47], a[104:107], v[100:103], a[44:47]
ds_read_b64_tr_b16 a[74:75], v17 offset:53248
ds_read_b64_tr_b16 a[76:77], v17 offset:57344
v_mfma_f32_16x16x32_bf16 a[44:47], a[108:111], v[108:111], a[44:47]
ds_read_b64_tr_b16 a[78:79], v17 offset:61440
s_waitcnt lgkmcnt(8)
v_mfma_f32_16x16x32_bf16 a[48:51], a[112:115], v[96:99], a[48:51]
ds_read_b64_tr_b16 a[80:81], v18 offset:49152
v_mfma_f32_16x16x32_bf16 a[48:51], a[116:119], v[104:107], a[48:51]
v_mfma_f32_16x16x32_bf16 a[52:55], a[112:115], v[100:103], a[52:55]
ds_read_b64_tr_b16 a[82:83], v18 offset:53248
ds_read_b64_tr_b16 a[84:85], v18 offset:57344
v_mfma_f32_16x16x32_bf16 a[52:55], a[116:119], v[108:111], a[52:55]
ds_read_b64_tr_b16 a[86:87], v18 offset:61440
v_mfma_f32_16x16x32_bf16 a[56:59], a[120:123], v[96:99], a[56:59]
ds_read_b64_tr_b16 a[88:89], v19 offset:49152
v_mfma_f32_16x16x32_bf16 a[56:59], a[124:127], v[104:107], a[56:59]
v_mfma_f32_16x16x32_bf16 a[60:63], a[120:123], v[100:103], a[60:63]
ds_read_b64_tr_b16 a[90:91], v19 offset:53248
ds_read_b64_tr_b16 a[92:93], v19 offset:57344
v_mfma_f32_16x16x32_bf16 a[60:63], a[124:127], v[108:111], a[60:63]
ds_read_b64_tr_b16 a[94:95], v19 offset:61440
s_waitcnt vmcnt(16) lgkmcnt(8)
v_mfma_f32_16x16x32_bf16 a[0:3], a[64:67], v[112:115], a[0:3]
ds_read_b64_tr_b16 a[96:97], v20 offset:49152
v_mfma_f32_16x16x32_bf16 a[0:3], a[68:71], v[120:123], a[0:3]
v_mfma_f32_16x16x32_bf16 a[4:7], a[64:67], v[116:119], a[4:7]
ds_read_b64_tr_b16 a[98:99], v20 offset:53248
ds_read_b64_tr_b16 a[100:101], v20 offset:57344
v_mfma_f32_16x16x32_bf16 a[4:7], a[68:71], v[124:127], a[4:7]
ds_read_b64_tr_b16 a[102:103], v20 offset:61440
v_mfma_f32_16x16x32_bf16 a[8:11], a[72:75], v[112:115], a[8:11]
ds_read_b64_tr_b16 a[104:105], v21 offset:49152
v_mfma_f32_16x16x32_bf16 a[8:11], a[76:79], v[120:123], a[8:11]
v_mfma_f32_16x16x32_bf16 a[12:15], a[72:75], v[116:119], a[12:15]
ds_read_b64_tr_b16 a[106:107], v21 offset:53248
ds_read_b64_tr_b16 a[108:109], v21 offset:57344
v_mfma_f32_16x16x32_bf16 a[12:15], a[76:79], v[124:127], a[12:15]
ds_read_b64_tr_b16 a[110:111], v21 offset:61440
s_waitcnt lgkmcnt(8)
v_mfma_f32_16x16x32_bf16 a[16:19], a[80:83], v[112:115], a[16:19]
ds_read_b64_tr_b16 a[112:113], v22 offset:49152
v_mfma_f32_16x16x32_bf16 a[16:19], a[84:87], v[120:123], a[16:19]
v_mfma_f32_16x16x32_bf16 a[20:23], a[80:83], v[116:119], a[20:23]
ds_read_b64_tr_b16 a[114:115], v22 offset:53248
ds_read_b64_tr_b16 a[116:117], v22 offset:57344
v_mfma_f32_16x16x32_bf16 a[20:23], a[84:87], v[124:127], a[20:23]
ds_read_b64_tr_b16 a[118:119], v22 offset:61440
v_mfma_f32_16x16x32_bf16 a[24:27], a[88:91], v[112:115], a[24:27]
ds_read_b64_tr_b16 a[120:121], v23 offset:49152
v_mfma_f32_16x16x32_bf16 a[24:27], a[92:95], v[120:123], a[24:27]
v_mfma_f32_16x16x32_bf16 a[28:31], a[88:91], v[116:119], a[28:31]
ds_read_b64_tr_b16 a[122:123], v23 offset:53248
ds_read_b64_tr_b16 a[124:125], v23 offset:57344
v_mfma_f32_16x16x32_bf16 a[28:31], a[92:95], v[124:127], a[28:31]
ds_read_b64_tr_b16 a[126:127], v23 offset:61440
s_waitcnt lgkmcnt(8)
v_mfma_f32_16x16x32_bf16 a[32:35], a[96:99], v[112:115], a[32:35]
v_mfma_f32_16x16x32_bf16 a[32:35], a[100:103], v[120:123], a[32:35]
v_mfma_f32_16x16x32_bf16 a[36:39], a[96:99], v[116:119], a[36:39]
v_mfma_f32_16x16x32_bf16 a[36:39], a[100:103], v[124:127], a[36:39]
v_mfma_f32_16x16x32_bf16 a[40:43], a[104:107], v[112:115], a[40:43]
v_mfma_f32_16x16x32_bf16 a[40:43], a[108:111], v[120:123], a[40:43]
v_mfma_f32_16x16x32_bf16 a[44:47], a[104:107], v[116:119], a[44:47]
v_mfma_f32_16x16x32_bf16 a[44:47], a[108:111], v[124:127], a[44:47]
s_waitcnt lgkmcnt(0)
v_mfma_f32_16x16x32_bf16 a[48:51], a[112:115], v[112:115], a[48:51]
v_mfma_f32_16x16x32_bf16 a[48:51], a[116:119], v[120:123], a[48:51]
v_mfma_f32_16x16x32_bf16 a[52:55], a[112:115], v[116:119], a[52:55]
v_mfma_f32_16x16x32_bf16 a[52:55], a[116:119], v[124:127], a[52:55]
v_mfma_f32_16x16x32_bf16 a[56:59], a[120:123], v[112:115], a[56:59]
v_mfma_f32_16x16x32_bf16 a[56:59], a[124:127], v[120:123], a[56:59]
v_mfma_f32_16x16x32_bf16 a[60:63], a[120:123], v[116:119], a[60:63]
v_mfma_f32_16x16x32_bf16 a[60:63], a[124:127], v[124:127], a[60:63]
s_add_u32 s16, s4, 0x80000
s_addc_u32 s17, s5, 0
s_mov_b32 s18, 0x20000
s_mov_b32 s19, 0x20000
s_lshl_b32 s42, s44, 1
s_xor_b32 s45, s41, 1
s_add_u32 s45, s42, s45
s_lshl_b32 s45, s45, 2
s_add_u32 s45, s45, s32
s_lshl_b32 s45, s45, 13
s_lshl_b32 s42, s44, 1
s_add_u32 s43, s42, s41
s_lshl_b32 s43, s43, 2
s_add_u32 s43, s43, s32
s_lshl_b32 s59, s43, 13
buffer_store_dwordx4 a[0:3], v3, s[48:51], s59 offen offset:0 sc1
buffer_store_dwordx4 a[4:7], v3, s[48:51], s59 offen offset:1024 sc1
buffer_store_dwordx4 a[8:11], v3, s[48:51], s59 offen offset:2048 sc1
buffer_store_dwordx4 a[12:15], v3, s[48:51], s59 offen offset:3072 sc1
s_add_u32 s59, s59, 4096
buffer_store_dwordx4 a[16:19], v3, s[48:51], s59 offen offset:0 sc1
buffer_store_dwordx4 a[20:23], v3, s[48:51], s59 offen offset:1024 sc1
buffer_store_dwordx4 a[24:27], v3, s[48:51], s59 offen offset:2048 sc1
buffer_store_dwordx4 a[28:31], v3, s[48:51], s59 offen offset:3072 sc1
v_accvgpr_read_b32 v64, a32
v_accvgpr_read_b32 v65, a33
v_accvgpr_read_b32 v66, a34
v_accvgpr_read_b32 v67, a35
v_accvgpr_read_b32 v68, a36
v_accvgpr_read_b32 v69, a37
v_accvgpr_read_b32 v70, a38
v_accvgpr_read_b32 v71, a39
v_accvgpr_read_b32 v72, a40
v_accvgpr_read_b32 v73, a41
v_accvgpr_read_b32 v74, a42
v_accvgpr_read_b32 v75, a43
v_accvgpr_read_b32 v76, a44
v_accvgpr_read_b32 v77, a45
v_accvgpr_read_b32 v78, a46
v_accvgpr_read_b32 v79, a47
v_accvgpr_read_b32 v80, a48
v_accvgpr_read_b32 v81, a49
v_accvgpr_read_b32 v82, a50
v_accvgpr_read_b32 v83, a51
v_accvgpr_read_b32 v84, a52
v_accvgpr_read_b32 v85, a53
v_accvgpr_read_b32 v86, a54
v_accvgpr_read_b32 v87, a55
v_accvgpr_read_b32 v88, a56
v_accvgpr_read_b32 v89, a57
v_accvgpr_read_b32 v90, a58
v_accvgpr_read_b32 v91, a59
v_accvgpr_read_b32 v92, a60
v_accvgpr_read_b32 v93, a61
v_accvgpr_read_b32 v94, a62
v_accvgpr_read_b32 v95, a63
s_waitcnt vmcnt(0)
s_barrier
s_cmp_lg_u32 s32, 0
s_cbranch_scc1 L_attn_kernel_down_polled
s_lshl_b32 s42, s44, 1
s_add_u32 s46, s42, s41
s_lshl_b32 s46, s46, 7
s_add_u32 s46, s46, 32768
s_xor_b32 s47, s41, 1
s_add_u32 s47, s42, s47
s_lshl_b32 s47, s47, 7
s_add_u32 s47, s47, 32768
v_mov_b32 v6, 0
v_mov_b32 v7, 1
s_mov_b64 s[52:53], exec
s_mov_b64 exec, 1
buffer_store_dword v7, v6, s[16:19], s46 offen sc1
s_mov_b32 s54, 0x40000
L_attn_kernel_down_poll:
buffer_load_dword v7, v6, s[16:19], s47 offen sc1
s_waitcnt vmcnt(0)
v_readfirstlane_b32 s46, v7
s_sub_u32 s54, s54, 1
s_cmp_eq_u32 s54, 0
s_cbranch_scc1 L_attn_kernel_down_pdone
s_cmp_lg_u32 s46, 1
s_cbranch_scc1 L_attn_kernel_down_poll
L_attn_kernel_down_pdone:
s_mov_b64 exec, s[52:53]
L_attn_kernel_down_polled:
s_barrier
buffer_load_dwordx4 v[96:99], v3, s[48:51], s45 offen offset:0 sc1
buffer_load_dwordx4 v[100:103], v3, s[48:51], s45 offen offset:1024 sc1
buffer_load_dwordx4 v[104:107], v3, s[48:51], s45 offen offset:2048 sc1
buffer_load_dwordx4 v[108:111], v3, s[48:51], s45 offen offset:3072 sc1
s_add_u32 s45, s45, 4096
buffer_load_dwordx4 v[112:115], v3, s[48:51], s45 offen offset:0 sc1
buffer_load_dwordx4 v[116:119], v3, s[48:51], s45 offen offset:1024 sc1
buffer_load_dwordx4 v[120:123], v3, s[48:51], s45 offen offset:2048 sc1
buffer_load_dwordx4 v[124:127], v3, s[48:51], s45 offen offset:3072 sc1
v_add_f32 v144, v144, v160
v_add_f32 v145, v145, v161
v_add_f32 v146, v146, v162
v_add_f32 v147, v147, v163
v_add_f32 v148, v148, v164
v_add_f32 v149, v149, v165
v_add_f32 v150, v150, v166
v_add_f32 v151, v151, v167
v_add_f32 v152, v152, v168
v_add_f32 v153, v153, v169
v_add_f32 v154, v154, v170
v_add_f32 v155, v155, v171
v_add_f32 v156, v156, v172
v_add_f32 v157, v157, v173
v_add_f32 v158, v158, v174
v_add_f32 v159, v159, v175
v_cvt_pk_bf16_f32 v176, v144, v145
v_lshlrev_b32 v144, 16, v176
v_and_b32 v145, 0xffff0000, v176
v_cvt_pk_bf16_f32 v176, v146, v147
v_lshlrev_b32 v146, 16, v176
v_and_b32 v147, 0xffff0000, v176
v_cvt_pk_bf16_f32 v176, v148, v149
v_lshlrev_b32 v148, 16, v176
v_and_b32 v149, 0xffff0000, v176
v_cvt_pk_bf16_f32 v176, v150, v151
v_lshlrev_b32 v150, 16, v176
v_and_b32 v151, 0xffff0000, v176
v_cvt_pk_bf16_f32 v176, v152, v153
v_lshlrev_b32 v152, 16, v176
v_and_b32 v153, 0xffff0000, v176
v_cvt_pk_bf16_f32 v176, v154, v155
v_lshlrev_b32 v154, 16, v176
v_and_b32 v155, 0xffff0000, v176
v_cvt_pk_bf16_f32 v176, v156, v157
v_lshlrev_b32 v156, 16, v176
v_and_b32 v157, 0xffff0000, v176
v_cvt_pk_bf16_f32 v176, v158, v159
v_lshlrev_b32 v158, 16, v176
v_and_b32 v159, 0xffff0000, v176
s_waitcnt vmcnt(0)
v_add_f32 v64, v64, v96
v_add_f32 v65, v65, v97
v_add_f32 v66, v66, v98
v_add_f32 v67, v67, v99
v_add_f32 v68, v68, v100
v_add_f32 v69, v69, v101
v_add_f32 v70, v70, v102
v_add_f32 v71, v71, v103
v_add_f32 v72, v72, v104
v_add_f32 v73, v73, v105
v_add_f32 v74, v74, v106
v_add_f32 v75, v75, v107
v_add_f32 v76, v76, v108
v_add_f32 v77, v77, v109
v_add_f32 v78, v78, v110
v_add_f32 v79, v79, v111
v_add_f32 v80, v80, v112
v_add_f32 v81, v81, v113
v_add_f32 v82, v82, v114
v_add_f32 v83, v83, v115
v_add_f32 v84, v84, v116
v_add_f32 v85, v85, v117
v_add_f32 v86, v86, v118
v_add_f32 v87, v87, v119
v_add_f32 v88, v88, v120
v_add_f32 v89, v89, v121
v_add_f32 v90, v90, v122
v_add_f32 v91, v91, v123
v_add_f32 v92, v92, v124
v_add_f32 v93, v93, v125
v_add_f32 v94, v94, v126
v_add_f32 v95, v95, v127
v_lshlrev_b32 v176, 16, v128
v_and_b32 v177, 0xffff0000, v128
v_fma_f32 v64, v64, v144, v176
v_fma_f32 v65, v65, v145, v177
v_cvt_pk_bf16_f32 v178, v64, v65
v_lshlrev_b32 v176, 16, v129
v_and_b32 v177, 0xffff0000, v129
v_fma_f32 v66, v66, v146, v176
v_fma_f32 v67, v67, v147, v177
v_cvt_pk_bf16_f32 v179, v66, v67
v_lshlrev_b32 v176, 16, v130
v_and_b32 v177, 0xffff0000, v130
v_fma_f32 v72, v72, v148, v176
v_fma_f32 v73, v73, v149, v177
v_cvt_pk_bf16_f32 v180, v72, v73
v_lshlrev_b32 v176, 16, v131
v_and_b32 v177, 0xffff0000, v131
v_fma_f32 v74, v74, v150, v176
v_fma_f32 v75, v75, v151, v177
v_cvt_pk_bf16_f32 v181, v74, v75
v_lshlrev_b32 v176, 16, v132
v_and_b32 v177, 0xffff0000, v132
v_fma_f32 v80, v80, v152, v176
v_fma_f32 v81, v81, v153, v177
v_cvt_pk_bf16_f32 v182, v80, v81
v_lshlrev_b32 v176, 16, v133
v_and_b32 v177, 0xffff0000, v133
v_fma_f32 v82, v82, v154, v176
v_fma_f32 v83, v83, v155, v177
v_cvt_pk_bf16_f32 v183, v82, v83
v_lshlrev_b32 v176, 16, v134
v_and_b32 v177, 0xffff0000, v134
v_fma_f32 v88, v88, v156, v176
v_fma_f32 v89, v89, v157, v177
v_cvt_pk_bf16_f32 v184, v88, v89
v_lshlrev_b32 v176, 16, v135
v_and_b32 v177, 0xffff0000, v135
v_fma_f32 v90, v90, v158, v176
v_fma_f32 v91, v91, v159, v177
v_cvt_pk_bf16_f32 v185, v90, v91
v_lshlrev_b32 v176, 16, v136
v_and_b32 v177, 0xffff0000, v136
v_fma_f32 v68, v68, v144, v176
v_fma_f32 v69, v69, v145, v177
v_cvt_pk_bf16_f32 v186, v68, v69
v_lshlrev_b32 v176, 16, v137
v_and_b32 v177, 0xffff0000, v137
v_fma_f32 v70, v70, v146, v176
v_fma_f32 v71, v71, v147, v177
v_cvt_pk_bf16_f32 v187, v70, v71
v_lshlrev_b32 v176, 16, v138
v_and_b32 v177, 0xffff0000, v138
v_fma_f32 v76, v76, v148, v176
v_fma_f32 v77, v77, v149, v177
v_cvt_pk_bf16_f32 v188, v76, v77
v_lshlrev_b32 v176, 16, v139
v_and_b32 v177, 0xffff0000, v139
v_fma_f32 v78, v78, v150, v176
v_fma_f32 v79, v79, v151, v177
v_cvt_pk_bf16_f32 v189, v78, v79
v_lshlrev_b32 v176, 16, v140
v_and_b32 v177, 0xffff0000, v140
v_fma_f32 v84, v84, v152, v176
v_fma_f32 v85, v85, v153, v177
v_cvt_pk_bf16_f32 v190, v84, v85
v_lshlrev_b32 v176, 16, v141
v_and_b32 v177, 0xffff0000, v141
v_fma_f32 v86, v86, v154, v176
v_fma_f32 v87, v87, v155, v177
v_cvt_pk_bf16_f32 v191, v86, v87
v_lshlrev_b32 v176, 16, v142
v_and_b32 v177, 0xffff0000, v142
v_fma_f32 v92, v92, v156, v176
v_fma_f32 v93, v93, v157, v177
v_cvt_pk_bf16_f32 v192, v92, v93
v_lshlrev_b32 v176, 16, v143
v_and_b32 v177, 0xffff0000, v143
v_fma_f32 v94, v94, v158, v176
v_fma_f32 v95, v95, v159, v177
v_cvt_pk_bf16_f32 v193, v94, v95
v_permlane32_swap_b32 v178, v180
v_permlane32_swap_b32 v179, v181
s_nop 0
v_permlane16_swap_b32 v178, v180
v_permlane16_swap_b32 v179, v181
v_permlane32_swap_b32 v182, v184
v_permlane32_swap_b32 v183, v185
s_nop 0
v_permlane16_swap_b32 v182, v184
v_permlane16_swap_b32 v183, v185
v_permlane32_swap_b32 v186, v188
v_permlane32_swap_b32 v187, v189
s_nop 0
v_permlane16_swap_b32 v186, v188
v_permlane16_swap_b32 v187, v189
v_permlane32_swap_b32 v190, v192
v_permlane32_swap_b32 v191, v193
s_nop 0
v_permlane16_swap_b32 v190, v192
v_permlane16_swap_b32 v191, v193
v_lshlrev_b32 v6, 11, v5
v_lshl_add_u32 v6, v4, 4, v6
s_lshl_b32 s42, s39, 18
s_lshl_b32 s43, s32, 16
s_add_u32 s42, s42, s43
s_lshl_b32 s43, s40, 8
s_add_u32 s42, s42, s43
s_lshl_b32 s43, s58, 7
s_add_u32 s42, s42, s43
buffer_store_dwordx4 v[178:181], v6, s[28:31], s42 offen offset:0
buffer_store_dwordx4 v[182:185], v6, s[28:31], s42 offen offset:64
s_add_u32 s42, s42, 0x8000
buffer_store_dwordx4 v[186:189], v6, s[28:31], s42 offen offset:0
buffer_store_dwordx4 v[190:193], v6, s[28:31], s42 offen offset:64
s_endpgm
L_attn_kernel_codeend:
.section .rodata,"a"
.p2align 6
.amdhsa_kernel attn_kernel
  .amdhsa_next_free_vgpr 512
  .amdhsa_next_free_sgpr 64
  .amdhsa_accum_offset 256
  .amdhsa_group_segment_fixed_size 0
  .amdhsa_kernarg_size 112
  .amdhsa_user_sgpr_count 2
  .amdhsa_user_sgpr_kernarg_segment_ptr 1
  .amdhsa_system_sgpr_workgroup_id_x 1
  .amdhsa_float_denorm_mode_32 3
.end_amdhsa_kernel
```
